```python
import torch

def _softmax(x, axis=-1):
    return torch.softmax(x, dim=axis)
def _gelu(x):
    return torch.nn.functional.gelu(x, approximate="tanh")
def _silu(x):
    return torch.nn.functional.silu(x)
def _sigmoid(x):
    return torch.sigmoid(x)
def _layernorm(x, axis=-1, eps=1e-5):
    m = x.mean(dim=axis, keepdim=True)
    v = x.var(dim=axis, keepdim=True, unbiased=False)
    return (x - m) / torch.sqrt(v + eps)
def _scatter_add(tgt, idx, src, axis=0):
    return tgt.clone().index_add_(axis, idx, src)
def _segment_sum(src, seg, n):
    out = torch.zeros((n,) + src.shape[1:], dtype=src.dtype)
    return out.index_add_(0, seg, src)
def _pad(x, pw):
    flat = tuple(v for pair in reversed(pw) for v in pair)
    return torch.nn.functional.pad(x, flat)

kernel_name = 'sequential_preLN__spectral_gfnet__mixer_token_mlp__prompt'

def setup_inputs():

    _w = (lambda a: (lambda t: t.to(torch.bfloat16) if t.is_floating_point() else t)(torch.as_tensor(a)))
    def _A_setup():
        B, S, D = 1, 2048, 448
        Df = D // 2 + 1
        return {
            "x": _w((lambda *s: torch.randn(*s, dtype=torch.bfloat16) * 0.05)(B, S, D)),
            "w_r": _w((lambda *s: torch.randn(*s, dtype=torch.bfloat16) * 0.4)(S, Df) * 0.02),
            "w_i": _w((lambda *s: torch.randn(*s, dtype=torch.bfloat16) * 0.4)(S, Df) * 0.02),
        }
    _A_in = _A_setup()

    def _B_setup():
        B, S, D, F = 1, 2048, 448, 1792
        return {
            "x": _w((lambda *s: torch.randn(*s, dtype=torch.bfloat16) * 0.05)(B, S, D)),
            "w1": _w((lambda *s: torch.randn(*s, dtype=torch.bfloat16) * 0.4)(S, F) * (S ** -0.5)),
            "b1": _w((lambda *s: torch.randn(*s, dtype=torch.bfloat16) * 3.2)(F) * 0.02),
            "w2": _w((lambda *s: torch.randn(*s, dtype=torch.bfloat16) * 0.2)(F, S) * (F ** -0.5)),
            "b2": _w((lambda *s: torch.randn(*s, dtype=torch.bfloat16) * 0.4)(S) * 0.02),
        }
    _B_in = _B_setup()

    return {
        "A_x": _A_in["x"],
        "A_w_r": _A_in["w_r"],
        "A_w_i": _A_in["w_i"],
        "B_x": _B_in["x"],
        "B_w1": _B_in["w1"],
        "B_b1": _B_in["b1"],
        "B_w2": _B_in["w2"],
        "B_b2": _B_in["b2"],
    }

def reference(A_x, A_w_r, A_w_i, B_x, B_w1, B_b1, B_w2, B_b2):
    def _A_ref(x, w_r, w_i):
        B, S, D = x.shape
        X = (lambda x, axes=(-2,-1): torch.fft.rfft2(x.float(), dim=axes))(x, axes=(-2, -1))
        W = w_r + 1j * w_i
        X = X * W
        y = (lambda x, s, axes=(-2,-1): torch.fft.irfft2(x, s=s, dim=axes).to(torch.bfloat16))(X, (S, D), axes=(-2, -1))
        return y

    def _B_ref(x, w1, b1, w2, b2):
        B, S, D = x.shape
        h = _layernorm(x, axis=-1)
        u = torch.einsum("bsd,sf->bdf", h, w1) + b1
        u = _gelu(u)
        y = torch.einsum("bdf,fs->bds", u, w2) + b2
        return (lambda x, *d: x.permute(*d))(y, 0, 2, 1)

    x = A_x
    h = x + _A_ref(_layernorm(x, axis=-1), A_w_r, A_w_i)
    h2 = h + _B_ref(_layernorm(h, axis=-1), B_w1, B_b1, B_w2, B_b2)
    return h2
```

```asm
; @launch grid=(256,1,1) block=(512,1,1) lds=163840
.amdgcn_target "amdgcn-amd-amdhsa--gfx950"
.text
.globl sequential_preLN__spectral_gfnet__mixer_token_mlp__prompt_kernel
.p2align 8
.type sequential_preLN__spectral_gfnet__mixer_token_mlp__prompt_kernel,@function
sequential_preLN__spectral_gfnet__mixer_token_mlp__prompt_kernel:
  s_cmp_ge_u32 s2, 256
  s_cbranch_scc1 L_end2
  s_load_dwordx4 s[4:7], s[0:1], 0
  s_load_dwordx2 s[8:9], s[0:1], 16
  s_load_dwordx2 s[10:11], s[0:1], 80
  s_load_dwordx8 s[68:75], s[0:1], 32
  s_load_dwordx2 s[64:65], s[0:1], 64
  v_lshrrev_b32 v2, 6, v0
  v_and_b32 v1, 63, v0
  s_and_b32 s36, s2, 63
  v_readfirstlane_b32 s38, v2
  s_lshr_b32 s37, s2, 6
  v_lshlrev_b32 v7, 4, v1
  s_getpc_b64 s[16:17]
  s_add_u32 s16, s16, tbl@rel32@lo+4
  s_addc_u32 s17, s17, tbl@rel32@hi+12
  s_and_b32 s17, s17, 0xffff
  s_mov_b32 s18, 0x3e800
  s_mov_b32 s19, 0x20000
  s_lshl_b32 s39, s37, 2
  s_add_u32 s39, s39, s38
  s_cmp_ge_u32 s38, 4
  s_cbranch_scc1 L_A_nt
  s_mul_i32 s35, s39, 14336
  s_add_u32 s35, s35, 40960
  buffer_load_dwordx4 v[64:67], v7, s[16:19], s35 offen offset:0
  buffer_load_dwordx4 v[68:71], v7, s[16:19], s35 offen offset:1024
  buffer_load_dwordx4 v[72:75], v7, s[16:19], s35 offen offset:2048
  buffer_load_dwordx4 v[76:79], v7, s[16:19], s35 offen offset:3072
  s_add_u32 s35, s35, 4096
  buffer_load_dwordx4 v[80:83], v7, s[16:19], s35 offen offset:0
  buffer_load_dwordx4 v[84:87], v7, s[16:19], s35 offen offset:1024
  buffer_load_dwordx4 v[88:91], v7, s[16:19], s35 offen offset:2048
  buffer_load_dwordx4 v[92:95], v7, s[16:19], s35 offen offset:3072
  s_add_u32 s35, s35, 4096
  s_branch L_A_n2
L_A_nt:
  s_lshr_b32 s34, s2, 3
  s_lshl_b32 s34, s34, 2
  s_add_u32 s34, s34, s38
  s_sub_u32 s34, s34, 4
  s_cmp_ge_u32 s34, 8
  s_cbranch_scc1 L_A_n2
  v_lshlrev_b32 v249, 7, v1
  s_cmp_ge_u32 s34, 3
  s_cbranch_scc1 L_A_n3
  s_getpc_b64 s[24:25]
L_cwpc0:
  s_sub_u32 s24, s24, L_cwpc0-sequential_preLN__spectral_gfnet__mixer_token_mlp__prompt_kernel
  s_subb_u32 s25, s25, 0
  s_and_b32 s25, s25, 0xffff
  s_mov_b32 s26, L_end2-sequential_preLN__spectral_gfnet__mixer_token_mlp__prompt_kernel
  s_mov_b32 s27, 0x20000
  s_lshl_b32 s34, s34, 13
  buffer_load_dword v250, v249, s[24:27], s34 offen
  s_branch L_A_n2
L_A_n3:
  s_sub_u32 s34, s34, 3
  s_lshl_b32 s34, s34, 13
  buffer_load_dword v250, v249, s[16:19], s34 offen
L_A_n2:
  v_and_b32 v8, 31, v1
  v_lshrrev_b32 v9, 5, v1
  v_mul_u32_u24 v5, 57344, v9
  v_lshl_add_u32 v5, v8, 4, v5
  v_cmp_gt_u32 s[62:63], 28, v8
  v_mov_b32 v6, 0x40000000
  s_mov_b32 s14, 0x1c0000
  s_mov_b32 s15, 0x20000
  v_cndmask_b32 v5, v6, v5, s[62:63]
  s_lshl_b32 s40, s38, 8
  s_add_u32 s40, s40, s36
  s_mul_i32 s40, s40, 896
  s_add_u32 s41, s40, 114688
  v_and_b32 v2, 15, v1
  v_lshrrev_b32 v3, 4, v1
  v_mul_u32_u24 v4, 480, v9
  v_lshl_add_u32 v4, v8, 4, v4
  s_mul_i32 s43, s38, 1920
  v_add_u32 v4, s43, v4
  s_mov_b32 s22, 0x1000000
  s_mov_b32 s23, 0x20000
  s_mov_b32 s54, 0x700000
  s_mov_b32 s55, 0x20000
  s_mov_b32 s60, 0x3b124925
  s_mov_b32 s61, 0x3727c5ac
  s_mov_b32 s59, 0xffff0000
  s_mov_b32 s56, -1
  s_mov_b32 s57, 0xffffff
  s_cmp_lt_u32 s37, 2
  s_cselect_b32 s66, 1.0, -1.0
  s_mov_b32 s67, s66
  s_waitcnt lgkmcnt(0)
  s_mov_b32 s12, s4
  s_and_b32 s13, s5, 0xffff
  buffer_load_dwordx4 v[128:131], v5, s[12:15], s40 offen nt
  buffer_load_dwordx4 v[132:135], v5, s[12:15], s40 offen offset:448 nt
  buffer_load_dwordx4 v[136:139], v5, s[12:15], s41 offen nt
  buffer_load_dwordx4 v[140:143], v5, s[12:15], s41 offen offset:448 nt
  s_mov_b32 s20, s10
  s_and_b32 s21, s11, 0xffff
  s_add_u32 s44, s10, 0xa01000
  s_addc_u32 s45, s11, 0
  s_load_dword s58, s[44:45], 0
  s_and_b32 s24, s2, 7
  s_lshr_b32 s25, s2, 3
  s_and_b32 s26, s24, 0
  s_lshl_b32 s26, s26, 3
  s_and_b32 s34, s25, 7
  s_add_u32 s26, s26, s34
  s_lshr_b32 s31, s24, 0
  s_lshr_b32 s34, s25, 3
  s_mul_i32 s27, s24, 28
  s_add_u32 s27, s27, s25
  s_and_b32 s26, s27, 7
  s_lshr_b32 s27, s27, 3
  s_lshl_b32 s28, s31, 2
  s_add_u32 s28, s28, s34
  s_lshr_b32 s31, s24, 1
  s_lshr_b32 s29, s38, 1
  s_and_b32 s30, s38, 1
  s_mov_b32 s40, s6
  s_and_b32 s41, s7, 0xffff
  s_mov_b32 s42, 0xe1000
  s_mov_b32 s43, 0x20000
  s_mov_b32 s48, s8
  s_and_b32 s49, s9, 0xffff
  s_mov_b32 s50, 0xe1000
  s_mov_b32 s51, 0x20000
  v_mul_u32_u24 v56, 480, v2
  v_lshl_add_u32 v56, v3, 4, v56
  v_lshlrev_b32 v57, 16, v2
  v_and_b32 v61, 1, v3
  v_lshl_add_u32 v57, v61, 5, v57
  v_lshrrev_b32 v61, 1, v3
  v_lshl_add_u32 v57, v61, 4, v57
  s_barrier
  s_lshl_b32 s44, s36, 10
  s_lshl_b32 s45, s39, 6
  s_add_u32 s44, s44, s45
  s_add_u32 s45, s44, 0x100000
  v_lshlrev_b32 v8, 4, v0
  s_mov_b32 s34, 30720
  s_cmp_ge_u32 s38, 4
  s_cbranch_scc1 L_A_hi
  buffer_load_dwordx4 v[96:99], v7, s[16:19], s35 offen offset:0
  buffer_load_dwordx4 v[100:103], v7, s[16:19], s35 offen offset:1024
  buffer_load_dwordx4 v[104:107], v7, s[16:19], s35 offen offset:2048
  buffer_load_dwordx4 v[108:111], v7, s[16:19], s35 offen offset:3072
  s_add_u32 s35, s35, 4096
  buffer_load_dwordx4 v[112:115], v7, s[16:19], s35 offen offset:0
  buffer_load_dwordx4 v[116:119], v7, s[16:19], s35 offen offset:1024
  buffer_load_dwordx4 v[240:243], v8, s[16:19], s34 offen
  v_cvt_f32_u32 v58, v2
  v_add_f32 v59, 0x41800000, v58
  v_lshlrev_b32 v60, 8, v3
  v_add_u32 v60, s36, v60
  v_cvt_f32_u32 v60, v60
  v_mul_f32 v60, 0x3a000000, v60
  v_add_f32 v200, 0x0, v60
  v_add_f32 v201, 0x3d000000, v60
  v_mul_f32 v61, v58, v200
  v_cos_f32 v202, v61
  v_sin_f32 v204, v61
  v_mul_f32 v61, v58, v201
  v_cos_f32 v203, v61
  v_sin_f32 v205, v61
  v_cvt_pk_f16_f32 v40, v202, v203
  v_cvt_pk_f16_f32 v48, v204, v205
  v_mul_f32 v61, v59, v200
  v_cos_f32 v202, v61
  v_sin_f32 v204, v61
  v_mul_f32 v61, v59, v201
  v_cos_f32 v203, v61
  v_sin_f32 v205, v61
  v_cvt_pk_f16_f32 v44, v202, v203
  v_cvt_pk_f16_f32 v52, v204, v205
  v_add_f32 v200, 0x3d800000, v60
  v_add_f32 v201, 0x3dc00000, v60
  v_mul_f32 v61, v58, v200
  v_cos_f32 v202, v61
  v_sin_f32 v204, v61
  v_mul_f32 v61, v58, v201
  v_cos_f32 v203, v61
  v_sin_f32 v205, v61
  v_cvt_pk_f16_f32 v41, v202, v203
  v_cvt_pk_f16_f32 v49, v204, v205
  v_mul_f32 v61, v59, v200
  v_cos_f32 v202, v61
  v_sin_f32 v204, v61
  v_mul_f32 v61, v59, v201
  v_cos_f32 v203, v61
  v_sin_f32 v205, v61
  v_cvt_pk_f16_f32 v45, v202, v203
  v_cvt_pk_f16_f32 v53, v204, v205
  v_add_f32 v200, 0x3f000000, v60
  v_add_f32 v201, 0x3f080000, v60
  v_mul_f32 v61, v58, v200
  v_cos_f32 v202, v61
  v_sin_f32 v204, v61
  v_mul_f32 v61, v58, v201
  v_cos_f32 v203, v61
  v_sin_f32 v205, v61
  v_cvt_pk_f16_f32 v42, v202, v203
  v_cvt_pk_f16_f32 v50, v204, v205
  v_mul_f32 v61, v59, v200
  v_cos_f32 v202, v61
  v_sin_f32 v204, v61
  v_mul_f32 v61, v59, v201
  v_cos_f32 v203, v61
  v_sin_f32 v205, v61
  v_cvt_pk_f16_f32 v46, v202, v203
  v_cvt_pk_f16_f32 v54, v204, v205
  v_add_f32 v200, 0x3f100000, v60
  v_add_f32 v201, 0x3f180000, v60
  v_mul_f32 v61, v58, v200
  v_cos_f32 v202, v61
  v_sin_f32 v204, v61
  v_mul_f32 v61, v58, v201
  v_cos_f32 v203, v61
  v_sin_f32 v205, v61
  v_cvt_pk_f16_f32 v43, v202, v203
  v_cvt_pk_f16_f32 v51, v204, v205
  v_mul_f32 v61, v59, v200
  v_cos_f32 v202, v61
  v_sin_f32 v204, v61
  v_mul_f32 v61, v59, v201
  v_cos_f32 v203, v61
  v_sin_f32 v205, v61
  v_cvt_pk_f16_f32 v47, v202, v203
  v_cvt_pk_f16_f32 v55, v204, v205
  s_waitcnt vmcnt(7)
  s_branch L_A_ln
L_A_hi:
  buffer_load_dwordx4 v[240:243], v8, s[16:19], s34 offen
  s_lshl_b32 s35, s2, 2
  s_add_u32 s35, s35, s38
  s_sub_u32 s35, s35, 4
  s_lshl_b32 s35, s35, 10
  buffer_load_dwordx4 v[64:67], v7, s[40:43], s35 offen
  buffer_load_dwordx4 v[68:71], v7, s[48:51], s35 offen
  s_sub_u32 s8, s38, 4
  s_cmp_gt_u32 s8, 1
  s_cbranch_scc1 L_dose0
  s_mov_b32 s4, s68
  s_and_b32 s5, s69, 0xffff
  s_mov_b32 s6, 0x700000
  s_mov_b32 s7, 0x20000
  s_mul_i32 s8, s8, 7168
  s_mul_i32 s9, s2, 28672
  s_add_u32 s8, s8, s9
  s_add_u32 s8, s8, 0
  v_lshlrev_b32 v249, 7, v1
  s_mov_b64 exec, s[56:57]
  buffer_load_dword v250, v249, s[4:7], s8 offen
  s_mov_b64 exec, -1
L_dose0:
  s_waitcnt vmcnt(4)
  s_cmp_lt_u32 s38, 6
  s_cbranch_scc1 L_A_ln
  s_waitcnt vmcnt(3)
L_A_ln:
  v_lshlrev_b32 v144, 16, v128
  v_and_b32 v145, s59, v128
  v_lshlrev_b32 v146, 16, v129
  v_and_b32 v147, s59, v129
  v_lshlrev_b32 v148, 16, v130
  v_and_b32 v149, s59, v130
  v_lshlrev_b32 v150, 16, v131
  v_and_b32 v151, s59, v131
  v_lshlrev_b32 v152, 16, v132
  v_and_b32 v153, s59, v132
  v_lshlrev_b32 v154, 16, v133
  v_and_b32 v155, s59, v133
  v_lshlrev_b32 v156, 16, v134
  v_and_b32 v157, s59, v134
  v_lshlrev_b32 v158, 16, v135
  v_and_b32 v159, s59, v135
  v_lshlrev_b32 v160, 16, v136
  v_and_b32 v161, s59, v136
  v_lshlrev_b32 v162, 16, v137
  v_and_b32 v163, s59, v137
  v_lshlrev_b32 v164, 16, v138
  v_and_b32 v165, s59, v138
  v_lshlrev_b32 v166, 16, v139
  v_and_b32 v167, s59, v139
  v_lshlrev_b32 v168, 16, v140
  v_and_b32 v169, s59, v140
  v_lshlrev_b32 v170, 16, v141
  v_and_b32 v171, s59, v141
  v_lshlrev_b32 v172, 16, v142
  v_and_b32 v173, s59, v142
  v_lshlrev_b32 v174, 16, v143
  v_and_b32 v175, s59, v143
  v_pk_add_f32 v[182:183], v[144:145], v[146:147]
  v_pk_add_f32 v[184:185], v[148:149], v[150:151]
  v_pk_add_f32 v[192:193], v[160:161], v[162:163]
  v_pk_add_f32 v[194:195], v[164:165], v[166:167]
  v_pk_add_f32 v[182:183], v[182:183], v[152:153]
  v_pk_add_f32 v[184:185], v[184:185], v[154:155]
  v_pk_add_f32 v[192:193], v[192:193], v[168:169]
  v_pk_add_f32 v[194:195], v[194:195], v[170:171]
  v_pk_add_f32 v[182:183], v[182:183], v[156:157]
  v_pk_add_f32 v[184:185], v[184:185], v[158:159]
  v_pk_add_f32 v[192:193], v[192:193], v[172:173]
  v_pk_add_f32 v[194:195], v[194:195], v[174:175]
  v_pk_add_f32 v[182:183], v[182:183], v[184:185]
  v_pk_add_f32 v[192:193], v[192:193], v[194:195]
  v_add_f32 v176, v182, v183
  v_add_f32 v186, v192, v193
  s_nop 0
  v_add_f32_dpp v176, v176, v176 row_ror:8 row_mask:0xf bank_mask:0xf
  v_add_f32_dpp v186, v186, v186 row_ror:8 row_mask:0xf bank_mask:0xf
  s_nop 0
  v_add_f32_dpp v176, v176, v176 row_ror:4 row_mask:0xf bank_mask:0xf
  v_add_f32_dpp v186, v186, v186 row_ror:4 row_mask:0xf bank_mask:0xf
  s_nop 0
  v_add_f32_dpp v176, v176, v176 row_ror:2 row_mask:0xf bank_mask:0xf
  v_add_f32_dpp v186, v186, v186 row_ror:2 row_mask:0xf bank_mask:0xf
  s_nop 0
  v_add_f32_dpp v176, v176, v176 row_ror:1 row_mask:0xf bank_mask:0xf
  v_add_f32_dpp v186, v186, v186 row_ror:1 row_mask:0xf bank_mask:0xf
  v_mov_b32 v177, v176
  v_mov_b32 v187, v186
  s_nop 0
  v_permlane16_swap_b32 v176, v177
  v_permlane16_swap_b32 v186, v187
  v_add_f32 v176, v176, v177
  v_add_f32 v186, v186, v187
  v_mul_f32 v176, s60, v176
  v_mul_f32 v186, s60, v186
  v_cvt_pk_bf16_f32 v178, v176, v176
  v_lshlrev_b32 v178, 16, v178
  v_cvt_pk_bf16_f32 v188, v186, v186
  v_lshlrev_b32 v188, 16, v188
  v_pk_add_f32 v[144:145], v[144:145], v[178:179] op_sel_hi:[1,0] neg_lo:[0,1] neg_hi:[0,1]
  v_pk_add_f32 v[160:161], v[160:161], v[188:189] op_sel_hi:[1,0] neg_lo:[0,1] neg_hi:[0,1]
  v_pk_add_f32 v[146:147], v[146:147], v[178:179] op_sel_hi:[1,0] neg_lo:[0,1] neg_hi:[0,1]
  v_pk_add_f32 v[162:163], v[162:163], v[188:189] op_sel_hi:[1,0] neg_lo:[0,1] neg_hi:[0,1]
  v_pk_add_f32 v[148:149], v[148:149], v[178:179] op_sel_hi:[1,0] neg_lo:[0,1] neg_hi:[0,1]
  v_pk_add_f32 v[164:165], v[164:165], v[188:189] op_sel_hi:[1,0] neg_lo:[0,1] neg_hi:[0,1]
  v_pk_add_f32 v[150:151], v[150:151], v[178:179] op_sel_hi:[1,0] neg_lo:[0,1] neg_hi:[0,1]
  v_pk_add_f32 v[166:167], v[166:167], v[188:189] op_sel_hi:[1,0] neg_lo:[0,1] neg_hi:[0,1]
  v_pk_add_f32 v[152:153], v[152:153], v[178:179] op_sel_hi:[1,0] neg_lo:[0,1] neg_hi:[0,1]
  v_pk_add_f32 v[168:169], v[168:169], v[188:189] op_sel_hi:[1,0] neg_lo:[0,1] neg_hi:[0,1]
  v_pk_add_f32 v[154:155], v[154:155], v[178:179] op_sel_hi:[1,0] neg_lo:[0,1] neg_hi:[0,1]
  v_pk_add_f32 v[170:171], v[170:171], v[188:189] op_sel_hi:[1,0] neg_lo:[0,1] neg_hi:[0,1]
  v_pk_add_f32 v[156:157], v[156:157], v[178:179] op_sel_hi:[1,0] neg_lo:[0,1] neg_hi:[0,1]
  v_pk_add_f32 v[172:173], v[172:173], v[188:189] op_sel_hi:[1,0] neg_lo:[0,1] neg_hi:[0,1]
  v_pk_add_f32 v[158:159], v[158:159], v[178:179] op_sel_hi:[1,0] neg_lo:[0,1] neg_hi:[0,1]
  v_pk_add_f32 v[174:175], v[174:175], v[188:189] op_sel_hi:[1,0] neg_lo:[0,1] neg_hi:[0,1]
  v_pk_mul_f32 v[182:183], v[144:145], v[144:145]
  v_pk_mul_f32 v[192:193], v[160:161], v[160:161]
  v_pk_fma_f32 v[182:183], v[146:147], v[146:147], v[182:183]
  v_pk_fma_f32 v[192:193], v[162:163], v[162:163], v[192:193]
  v_pk_fma_f32 v[182:183], v[148:149], v[148:149], v[182:183]
  v_pk_fma_f32 v[192:193], v[164:165], v[164:165], v[192:193]
  v_pk_fma_f32 v[182:183], v[150:151], v[150:151], v[182:183]
  v_pk_fma_f32 v[192:193], v[166:167], v[166:167], v[192:193]
  v_pk_fma_f32 v[182:183], v[152:153], v[152:153], v[182:183]
  v_pk_fma_f32 v[192:193], v[168:169], v[168:169], v[192:193]
  v_pk_fma_f32 v[182:183], v[154:155], v[154:155], v[182:183]
  v_pk_fma_f32 v[192:193], v[170:171], v[170:171], v[192:193]
  v_pk_fma_f32 v[182:183], v[156:157], v[156:157], v[182:183]
  v_pk_fma_f32 v[192:193], v[172:173], v[172:173], v[192:193]
  v_pk_fma_f32 v[182:183], v[158:159], v[158:159], v[182:183]
  v_pk_fma_f32 v[192:193], v[174:175], v[174:175], v[192:193]
  v_add_f32 v180, v182, v183
  v_add_f32 v190, v192, v193
  v_cndmask_b32 v180, 0, v180, s[62:63]
  v_cndmask_b32 v190, 0, v190, s[62:63]
  v_pk_fma_f32 v[144:145], v[152:153], s[66:67], v[144:145]
  v_pk_fma_f32 v[160:161], v[168:169], s[66:67], v[160:161]
  v_pk_fma_f32 v[146:147], v[154:155], s[66:67], v[146:147]
  v_pk_fma_f32 v[162:163], v[170:171], s[66:67], v[162:163]
  v_pk_fma_f32 v[148:149], v[156:157], s[66:67], v[148:149]
  v_pk_fma_f32 v[164:165], v[172:173], s[66:67], v[164:165]
  v_pk_fma_f32 v[150:151], v[158:159], s[66:67], v[150:151]
  v_pk_fma_f32 v[166:167], v[174:175], s[66:67], v[166:167]
  v_add_f32_dpp v180, v180, v180 row_ror:8 row_mask:0xf bank_mask:0xf
  v_add_f32_dpp v190, v190, v190 row_ror:8 row_mask:0xf bank_mask:0xf
  s_nop 0
  v_add_f32_dpp v180, v180, v180 row_ror:4 row_mask:0xf bank_mask:0xf
  v_add_f32_dpp v190, v190, v190 row_ror:4 row_mask:0xf bank_mask:0xf
  s_nop 0
  v_add_f32_dpp v180, v180, v180 row_ror:2 row_mask:0xf bank_mask:0xf
  v_add_f32_dpp v190, v190, v190 row_ror:2 row_mask:0xf bank_mask:0xf
  s_nop 0
  v_add_f32_dpp v180, v180, v180 row_ror:1 row_mask:0xf bank_mask:0xf
  v_add_f32_dpp v190, v190, v190 row_ror:1 row_mask:0xf bank_mask:0xf
  v_mov_b32 v177, v180
  v_mov_b32 v187, v190
  s_nop 0
  v_permlane16_swap_b32 v180, v177
  v_permlane16_swap_b32 v190, v187
  v_add_f32 v180, v180, v177
  v_add_f32 v190, v190, v187
  v_sub_f32 v177, v176, v178
  v_sub_f32 v187, v186, v188
  v_mul_f32 v180, s60, v180
  v_mul_f32 v190, s60, v190
  v_fma_f32 v180, -v177, v177, v180
  v_fma_f32 v190, -v187, v187, v190
  v_max_f32 v180, 0, v180
  v_max_f32 v190, 0, v190
  v_cvt_pk_bf16_f32 v180, v180, v180
  v_lshlrev_b32 v180, 16, v180
  v_cvt_pk_bf16_f32 v190, v190, v190
  v_lshlrev_b32 v190, 16, v190
  v_add_f32 v180, s61, v180
  v_add_f32 v190, s61, v190
  v_cvt_pk_bf16_f32 v180, v180, v180
  v_lshlrev_b32 v180, 16, v180
  v_cvt_pk_bf16_f32 v190, v190, v190
  v_lshlrev_b32 v190, 16, v190
  v_sqrt_f32 v180, v180
  v_sqrt_f32 v190, v190
  v_cvt_pk_bf16_f32 v180, v180, v180
  v_lshlrev_b32 v180, 16, v180
  v_cvt_pk_bf16_f32 v190, v190, v190
  v_lshlrev_b32 v190, 16, v190
  v_rcp_f32 v180, v180
  v_rcp_f32 v190, v190
  v_pk_mul_f32 v[144:145], v[144:145], v[180:181] op_sel_hi:[1,0]
  v_pk_mul_f32 v[160:161], v[160:161], v[190:191] op_sel_hi:[1,0]
  v_pk_mul_f32 v[146:147], v[146:147], v[180:181] op_sel_hi:[1,0]
  v_pk_mul_f32 v[162:163], v[162:163], v[190:191] op_sel_hi:[1,0]
  v_pk_mul_f32 v[148:149], v[148:149], v[180:181] op_sel_hi:[1,0]
  v_pk_mul_f32 v[164:165], v[164:165], v[190:191] op_sel_hi:[1,0]
  v_pk_mul_f32 v[150:151], v[150:151], v[180:181] op_sel_hi:[1,0]
  v_pk_mul_f32 v[166:167], v[166:167], v[190:191] op_sel_hi:[1,0]
  v_cvt_pk_f16_f32 v128, v144, v145
  v_cvt_pk_f16_f32 v136, v160, v161
  v_cvt_pk_f16_f32 v129, v146, v147
  v_cvt_pk_f16_f32 v137, v162, v163
  v_cvt_pk_f16_f32 v130, v148, v149
  v_cvt_pk_f16_f32 v138, v164, v165
  v_cvt_pk_f16_f32 v131, v150, v151
  v_cvt_pk_f16_f32 v139, v166, v167
  s_mov_b64 exec, s[62:63]
  ds_write_b128 v4, v[128:131]
  ds_write_b128 v4, v[136:139] offset:960
  s_mov_b64 exec, -1
  s_waitcnt lgkmcnt(0)
  s_barrier
  s_add_u32 s58, s58, 1
  s_cmp_ge_u32 s38, 4
  s_cbranch_scc1 L_A_mx
  ds_read_b128 v[128:131], v56 offset:0
  ds_read_b128 v[132:135], v56 offset:7680
  ds_read_b128 v[136:139], v56 offset:64
  ds_read_b128 v[140:143], v56 offset:7744
  ds_read_b128 v[144:147], v56 offset:128
  ds_read_b128 v[148:151], v56 offset:7808
  ds_read_b128 v[152:155], v56 offset:192
  ds_read_b128 v[156:159], v56 offset:7872
  ds_read_b128 v[160:163], v56 offset:256
  ds_read_b128 v[164:167], v56 offset:7936
  ds_read_b128 v[168:171], v56 offset:320
  ds_read_b128 v[172:175], v56 offset:8000
  ds_read_b128 v[176:179], v56 offset:384
  ds_read_b128 v[180:183], v56 offset:8064
  s_waitcnt vmcnt(0)
  s_waitcnt lgkmcnt(12)
  v_mfma_f32_16x16x32_f16 v[8:11], v[128:131], v[64:67], 0
  v_mfma_f32_16x16x32_f16 v[16:19], v[128:131], v[92:95], 0
  v_mfma_f32_16x16x32_f16 v[12:15], v[132:135], v[64:67], 0
  v_mfma_f32_16x16x32_f16 v[20:23], v[132:135], v[92:95], 0
  s_waitcnt lgkmcnt(10)
  v_mfma_f32_16x16x32_f16 v[8:11], v[136:139], v[68:71], v[8:11]
  v_mfma_f32_16x16x32_f16 v[16:19], v[136:139], v[96:99], v[16:19]
  v_mfma_f32_16x16x32_f16 v[12:15], v[140:143], v[68:71], v[12:15]
  v_mfma_f32_16x16x32_f16 v[20:23], v[140:143], v[96:99], v[20:23]
  s_waitcnt lgkmcnt(8)
  v_mfma_f32_16x16x32_f16 v[8:11], v[144:147], v[72:75], v[8:11]
  v_mfma_f32_16x16x32_f16 v[16:19], v[144:147], v[100:103], v[16:19]
  v_mfma_f32_16x16x32_f16 v[12:15], v[148:151], v[72:75], v[12:15]
  v_mfma_f32_16x16x32_f16 v[20:23], v[148:151], v[100:103], v[20:23]
  s_waitcnt lgkmcnt(6)
  v_mfma_f32_16x16x32_f16 v[8:11], v[152:155], v[76:79], v[8:11]
  v_mfma_f32_16x16x32_f16 v[16:19], v[152:155], v[104:107], v[16:19]
  v_mfma_f32_16x16x32_f16 v[12:15], v[156:159], v[76:79], v[12:15]
  v_mfma_f32_16x16x32_f16 v[20:23], v[156:159], v[104:107], v[20:23]
  s_waitcnt lgkmcnt(4)
  v_mfma_f32_16x16x32_f16 v[8:11], v[160:163], v[80:83], v[8:11]
  v_mfma_f32_16x16x32_f16 v[16:19], v[160:163], v[108:111], v[16:19]
  v_mfma_f32_16x16x32_f16 v[12:15], v[164:167], v[80:83], v[12:15]
  v_mfma_f32_16x16x32_f16 v[20:23], v[164:167], v[108:111], v[20:23]
  s_waitcnt lgkmcnt(2)
  v_mfma_f32_16x16x32_f16 v[8:11], v[168:171], v[84:87], v[8:11]
  v_mfma_f32_16x16x32_f16 v[16:19], v[168:171], v[112:115], v[16:19]
  v_mfma_f32_16x16x32_f16 v[12:15], v[172:175], v[84:87], v[12:15]
  v_mfma_f32_16x16x32_f16 v[20:23], v[172:175], v[112:115], v[20:23]
  s_waitcnt lgkmcnt(0)
  v_mfma_f32_16x16x32_f16 v[8:11], v[176:179], v[88:91], v[8:11]
  v_mfma_f32_16x16x32_f16 v[16:19], v[176:179], v[116:119], v[16:19]
  v_mfma_f32_16x16x32_f16 v[12:15], v[180:183], v[88:91], v[12:15]
  v_mfma_f32_16x16x32_f16 v[20:23], v[180:183], v[116:119], v[20:23]
  s_nop 4
  v_cvt_pk_f16_f32 v24, v8, v9
  v_cvt_pk_f16_f32 v28, v16, v17
  v_cvt_pk_f16_f32 v32, -v8, -v9
  v_cvt_pk_f16_f32 v25, v10, v11
  v_cvt_pk_f16_f32 v29, v18, v19
  v_cvt_pk_f16_f32 v33, -v10, -v11
  v_cvt_pk_f16_f32 v26, v12, v13
  v_cvt_pk_f16_f32 v30, v20, v21
  v_cvt_pk_f16_f32 v34, -v12, -v13
  v_cvt_pk_f16_f32 v27, v14, v15
  v_cvt_pk_f16_f32 v31, v22, v23
  v_cvt_pk_f16_f32 v35, -v14, -v15
  v_mfma_f32_16x16x32_f16 v[64:67], v[24:27], v[40:43], 0
  v_mfma_f32_16x16x32_f16 v[68:71], v[28:31], v[40:43], 0
  v_mfma_f32_16x16x32_f16 v[72:75], v[24:27], v[44:47], 0
  v_mfma_f32_16x16x32_f16 v[76:79], v[28:31], v[44:47], 0
  v_mfma_f32_16x16x32_f16 v[64:67], v[28:31], v[48:51], v[64:67]
  v_mfma_f32_16x16x32_f16 v[68:71], v[32:35], v[48:51], v[68:71]
  v_mfma_f32_16x16x32_f16 v[72:75], v[28:31], v[52:55], v[72:75]
  v_mfma_f32_16x16x32_f16 v[76:79], v[32:35], v[52:55], v[76:79]
  s_nop 4
  v_cvt_pk_f16_f32 v80, v64, v65
  v_cvt_pk_f16_f32 v81, v66, v67
  v_cvt_pk_f16_f32 v82, v68, v69
  v_cvt_pk_f16_f32 v83, v70, v71
  s_nop 0
  v_permlane16_swap_b32 v80, v82
  v_permlane16_swap_b32 v81, v83
  buffer_store_dwordx4 v[80:83], v57, s[20:23], s44 offen sc1
  v_cvt_pk_f16_f32 v84, v72, v73
  v_cvt_pk_f16_f32 v85, v74, v75
  v_cvt_pk_f16_f32 v86, v76, v77
  v_cvt_pk_f16_f32 v87, v78, v79
  s_nop 0
  v_permlane16_swap_b32 v84, v86
  v_permlane16_swap_b32 v85, v87
  buffer_store_dwordx4 v[84:87], v57, s[20:23], s45 offen sc1
  s_branch L_A_done
L_A_mx:
  s_waitcnt vmcnt(1)
  s_cmp_lt_u32 s38, 6
  s_cbranch_scc1 L_A_m2
  s_waitcnt vmcnt(0)
L_A_m2:
  s_mov_b32 s34, 0x7fff7fff
  v_and_b32 v64, s34, v64
  v_and_b32 v65, s34, v65
  v_and_b32 v66, s34, v66
  v_and_b32 v67, s34, v67
  v_and_b32 v68, s34, v68
  v_and_b32 v69, s34, v69
  v_and_b32 v70, s34, v70
  v_and_b32 v71, s34, v71
  v_pk_max_u16 v64, v64, v65
  v_pk_max_u16 v64, v64, v66
  v_pk_max_u16 v64, v64, v67
  v_pk_max_u16 v64, v64, v68
  v_pk_max_u16 v64, v64, v69
  v_pk_max_u16 v64, v64, v70
  v_pk_max_u16 v64, v64, v71
  v_lshlrev_b32 v8, 16, v64
  v_and_b32 v9, s59, v64
  v_max_u32 v8, v8, v9
  s_nop 1
  v_max_u32_dpp v8, v8, v8 row_ror:8 row_mask:0xf bank_mask:0xf
  s_nop 1
  v_max_u32_dpp v8, v8, v8 row_ror:4 row_mask:0xf bank_mask:0xf
  s_nop 1
  v_max_u32_dpp v8, v8, v8 row_ror:2 row_mask:0xf bank_mask:0xf
  s_nop 1
  v_max_u32_dpp v8, v8, v8 row_ror:1 row_mask:0xf bank_mask:0xf
  v_mov_b32 v9, v8
  s_nop 1
  v_permlane16_swap_b32 v8, v9
  v_max_u32 v8, v8, v9
  v_mov_b32 v9, v8
  s_nop 1
  v_permlane32_swap_b32 v8, v9
  v_max_u32 v8, v8, v9
  s_lshl_b32 s47, s2, 4
  s_lshl_b32 s34, s38, 2
  s_add_u32 s47, s47, s34
  s_add_u32 s47, s47, 0x9ffff0
  v_mov_b32 v9, 0
  s_mov_b64 exec, 1
  buffer_store_dword v8, v9, s[20:23], s47 offen sc1
  s_mov_b64 exec, -1
  v_mov_b32 v8, 67184
  ds_write_b32 v8, v9
  s_waitcnt vmcnt(0)
  s_and_b32 s35, s38, 3
  s_lshl_b32 s35, s35, 13
  s_add_u32 m0, s35, 16384
  s_nop 0
  buffer_load_dwordx4 v7, s[16:19], s35 offen offset:0 lds
  buffer_load_dwordx4 v7, s[16:19], s35 offen offset:1024 lds
  buffer_load_dwordx4 v7, s[16:19], s35 offen offset:2048 lds
  buffer_load_dwordx4 v7, s[16:19], s35 offen offset:3072 lds
  s_add_u32 s35, s35, 4096
  s_add_u32 m0, s35, 16384
  s_nop 0
  buffer_load_dwordx4 v7, s[16:19], s35 offen offset:0 lds
  buffer_load_dwordx4 v7, s[16:19], s35 offen offset:1024 lds
  s_cmp_eq_u32 s38, 7
  s_cbranch_scc1 L_A_pb
  buffer_load_dwordx4 v7, s[16:19], s35 offen offset:2048 lds
  buffer_load_dwordx4 v7, s[16:19], s35 offen offset:3072 lds
  s_branch L_A_pb
L_A_done:
  s_waitcnt vmcnt(0)
L_A_pb:
  s_waitcnt vmcnt(63) lgkmcnt(0)
  s_barrier
  s_cmp_lg_u32 s38, 0
  s_cbranch_scc1 L_pub0
  s_lshl_b32 s47, s2, 2
  s_add_u32 s47, s47, 0xa10000
  v_mov_b32 v8, s58
  v_lshlrev_b32 v9, 10, v1
  s_mov_b64 exec, 255
  buffer_store_dword v8, v9, s[20:23], s47 offen sc1
  s_mov_b64 exec, -1
L_pub0:
  s_sub_u32 s8, s38, 4
  s_cmp_gt_u32 s8, 1
  s_cbranch_scc1 L_dose1
  s_mov_b32 s4, s68
  s_and_b32 s5, s69, 0xffff
  s_mov_b32 s6, 0x700000
  s_mov_b32 s7, 0x20000
  s_mul_i32 s8, s8, 7168
  s_mul_i32 s9, s2, 28672
  s_add_u32 s8, s8, s9
  s_add_u32 s8, s8, 14336
  v_lshlrev_b32 v249, 7, v1
  s_mov_b64 exec, s[56:57]
  buffer_load_dword v250, v249, s[4:7], s8 offen
  s_mov_b64 exec, -1
L_dose1:
  v_mov_b32 v244, -1
  v_mov_b32 v245, -1
  v_mov_b32 v246, -1
  v_mov_b32 v247, -1
  v_lshrrev_b32 v248, 1, v57
  v_and_b32 v248, 0xffff8000, v248
  v_and_b32 v8, 0x30, v57
  v_or_b32 v248, v248, v8
  s_and_b32 s3, s2, 31
  s_lshl_b32 s3, s3, 10
  s_lshr_b32 s34, s2, 5
  s_lshl_b32 s34, s34, 7
  s_add_u32 s3, s3, s34
  s_lshr_b32 s34, s38, 2
  s_lshl_b32 s34, s34, 6
  s_add_u32 s3, s3, s34
  s_and_b32 s34, s38, 3
  s_lshl_b32 s34, s34, 19
  s_add_u32 s3, s3, s34
  s_add_u32 s3, s3, 0x200000
  s_and_b32 s46, s2, 31
  s_lshr_b32 s47, s2, 5
  s_lshl_b32 s47, s47, 1
  s_lshr_b32 s34, s38, 2
  s_add_u32 s47, s47, s34
  s_and_b32 s34, s47, 7
  s_lshl_b32 s34, s34, 5
  s_lshr_b32 s35, s47, 3
  s_add_u32 s34, s34, s35
  v_lshl_add_u32 v8, v2, 1, s34
  v_lshlrev_b32 v9, 7, v3
  v_add_u32 v9, s46, v9
  v_mul_u32_u24 v9, 450, v9
  v_lshl_add_u32 v9, v8, 1, v9
  v_cmp_ge_u32 vcc, 0xe0, v8
  s_nop 1
  v_cndmask_b32 v9, v6, v9, vcc
  v_mov_b32 v120, 0
  v_mov_b32 v121, 0
  v_mov_b32 v122, 0
  v_mov_b32 v123, 0
  v_mov_b32 v124, 0
  v_mov_b32 v125, 0
  v_mov_b32 v126, 0
  v_mov_b32 v127, 0
  s_and_b32 s34, s38, 3
  s_mul_i32 s34, s34, 230400
  buffer_load_short_d16_hi v120, v9, s[40:43], s34 offen
  buffer_load_short_d16_hi v124, v9, s[48:51], s34 offen
  s_add_u32 s34, s34, 14400
  buffer_load_short_d16_hi v121, v9, s[40:43], s34 offen
  buffer_load_short_d16_hi v125, v9, s[48:51], s34 offen
  s_add_u32 s34, s34, 14400
  buffer_load_short_d16_hi v122, v9, s[40:43], s34 offen
  buffer_load_short_d16_hi v126, v9, s[48:51], s34 offen
  s_add_u32 s34, s34, 14400
  buffer_load_short_d16_hi v123, v9, s[40:43], s34 offen
  buffer_load_short_d16_hi v127, v9, s[48:51], s34 offen
  s_mov_b32 s52, s68
  s_and_b32 s53, s69, 0xffff
  v_lshrrev_b32 v9, 3, v1
  v_and_b32 v8, 6, v9
  v_and_b32 v251, 7, v1
  v_xor_b32 v8, v8, v251
  v_and_b32 v251, 4, v9
  v_add_u32 v9, v9, v251
  s_mov_b32 s34, 229376
  v_mul_lo_u32 v251, v9, s34
  v_lshl_add_u32 v251, v8, 4, v251
  s_mul_i32 s32, s38, 28672
  s_lshl_b32 s33, s27, 7
  s_add_u32 s32, s32, s33
  s_cmp_ge_u32 s25, 28
  s_cselect_b32 s32, 0x40000000, s32
  s_mul_i32 s35, s38, 10240
  s_add_u32 s35, s35, 67584
  s_add_u32 m0, s35, 0
  s_add_u32 s33, s32, 0
  buffer_load_dwordx4 v251, s[52:55], s33 offen lds
  v_lshrrev_b32 v8, 2, v2
  v_and_b32 v9, 1, v3
  v_lshl_add_u32 v8, v9, 2, v8
  v_lshrrev_b32 v9, 1, v8
  s_lshl_b32 s34, s30, 1
  v_xor_b32 v9, s34, v9
  v_lshlrev_b32 v8, 7, v8
  v_lshl_add_u32 v8, v9, 5, v8
  v_and_b32 v9, 3, v2
  v_lshl_add_u32 v8, v9, 3, v8
  v_lshrrev_b32 v9, 1, v3
  v_lshl_add_u32 v8, v9, 10, v8
  v_add_u32 v252, s35, v8
  s_add_u32 m0, s35, 1024
  s_add_u32 s33, s32, 3670016
  buffer_load_dwordx4 v251, s[52:55], s33 offen lds
  v_xor_b32 v253, 32, v252
  v_xor_b32 v254, 64, v252
  v_xor_b32 v255, 0x60, v252
  s_and_b32 s46, s2, 31
  s_lshr_b32 s37, s2, 5
  s_lshr_b32 s44, s38, 2
  s_and_b32 s45, s38, 3
  s_lshl_b32 s39, s37, 1
  s_add_u32 s39, s39, s44
  s_add_u32 m0, s35, 2048
  s_add_u32 s33, s32, 917504
  buffer_load_dwordx4 v251, s[52:55], s33 offen lds
  s_lshl_b32 s48, s45, 12
  s_add_u32 s48, s48, 16384
  v_add_u32 v110, s48, v7
  s_add_u32 m0, s35, 3072
  s_add_u32 s33, s32, 4587520
  buffer_load_dwordx4 v251, s[52:55], s33 offen lds
  v_lshrrev_b32 v8, 3, v1
  v_and_b32 v9, 7, v1
  v_and_b32 v4, 6, v8
  v_xor_b32 v9, v9, v4
  v_lshlrev_b32 v4, 10, v8
  v_lshl_add_u32 v4, v9, 4, v4
  s_lshl_b32 s40, s46, 16
  s_lshl_b32 s41, s37, 7
  s_add_u32 s40, s40, s41
  s_lshl_b32 s41, s38, 13
  s_add_u32 s40, s40, s41
  s_lshl_b32 s42, s38, 10
  s_add_u32 m0, s35, 4096
  s_add_u32 s33, s32, 3584
  buffer_load_dwordx4 v251, s[52:55], s33 offen lds
  v_lshrrev_b32 v8, 2, v2
  v_lshl_add_u32 v8, v3, 2, v8
  v_lshlrev_b32 v8, 7, v8
  v_and_b32 v9, 3, v2
  v_lshl_add_u32 v8, v9, 3, v8
  s_add_u32 m0, s35, 5120
  s_add_u32 s33, s32, 3673600
  buffer_load_dwordx4 v251, s[52:55], s33 offen lds
  v_and_b32 v9, 1, v3
  v_lshrrev_b32 v10, 3, v2
  v_lshl_or_b32 v9, v9, 1, v10
  s_lshl_b32 s48, s44, 1
  v_xor_b32 v9, s48, v9
  v_lshl_add_u32 v112, v9, 5, v8
  v_xor_b32 v113, 32, v112
  s_lshl_b32 s48, s44, 12
  s_add_u32 s48, s48, 8192
  v_add_u32 v115, s48, v7
  s_add_u32 m0, s35, 6144
  s_add_u32 s33, s32, 921088
  buffer_load_dwordx4 v251, s[52:55], s33 offen lds
  s_lshr_b32 s49, s45, 1
  s_lshl_b32 s49, s49, 10
  s_and_b32 s50, s45, 1
  s_lshl_b32 s50, s50, 3
  s_add_u32 s49, s49, s50
  v_add_u32 v114, s49, v115
  s_add_u32 m0, s35, 7168
  s_add_u32 s33, s32, 4591104
  buffer_load_dwordx4 v251, s[52:55], s33 offen lds
  s_cmp_eq_u32 s39, 0
  s_cselect_b32 s50, 1, 0
  s_cmp_eq_u32 s39, 7
  s_cselect_b32 s50, 1, s50
  v_cmp_gt_u32 vcc, s50, v2
  v_mov_b32 v117, 1.0
  v_mov_b32 v8, 0.5
  v_cndmask_b32 v117, v117, v8, vcc
  s_add_u32 m0, s35, 8192
  s_add_u32 s33, s32, 7168
  buffer_load_dwordx4 v251, s[52:55], s33 offen lds
  v_lshlrev_b32 v116, 15, v2
  v_and_b32 v8, 1, v3
  v_lshl_add_u32 v116, v8, 5, v116
  v_lshrrev_b32 v8, 1, v3
  v_lshl_add_u32 v116, v8, 4, v116
  s_lshl_b32 s43, s46, 10
  s_lshl_b32 s48, s39, 6
  s_add_u32 s43, s43, s48
  s_lshl_b32 s48, s45, 19
  s_add_u32 s43, s43, s48
  s_add_u32 s43, s43, 0x200000
  s_add_u32 m0, s35, 9216
  s_add_u32 s33, s32, 3677184
  buffer_load_dwordx4 v251, s[52:55], s33 offen lds
  s_mov_b32 s49, 0x80008000
  s_mov_b32 s48, 0xa00000
  v_add_u32 v111, s42, v7
  v_lshlrev_b32 v118, 3, v0
  v_mov_b32 v119, 67184
  s_waitcnt vmcnt(18)
  s_cmp_lg_u32 s38, 0
  s_cbranch_scc1 L_w0
  s_lshl_b32 s47, s24, 10
  s_add_u32 s47, s47, 0xa10000
  s_mov_b32 s50, 0
L_poll0:
  buffer_load_dwordx4 v[56:59], v7, s[20:23], s47 offen sc1
L_pc0:
  s_waitcnt vmcnt(0)
  v_xor_b32 v56, s58, v56
  v_xor_b32 v57, s58, v57
  v_xor_b32 v58, s58, v58
  v_xor_b32 v59, s58, v59
  v_or3_b32 v56, v56, v57, v58
  v_or_b32 v56, v56, v59
  v_cmp_ne_u32 vcc, 0, v56
  s_nop 0
  s_and_b64 exec, exec, vcc
  s_cbranch_scc0 L_x0
  s_sleep 4
  s_add_u32 s50, s50, 1
  s_cmp_lt_u32 s50, 300000
  s_cbranch_scc1 L_poll0
L_x0:
  s_mov_b64 exec, -1
L_w0:
  s_barrier
  buffer_load_dwordx2 v[8:9], v118, s[20:23], s48 offen sc1
  s_mov_b32 m0, s42
  s_nop 0
  buffer_load_dwordx4 v4, s[20:23], s40 offen sc1 lds
  ds_read_b128 v[40:43], v110 offset:0
  ds_read_b128 v[44:47], v110 offset:1024
  ds_read_b128 v[48:51], v110 offset:2048
  ds_read_b128 v[52:55], v110 offset:3072
  s_waitcnt vmcnt(0)
  buffer_store_dwordx4 v[244:247], v248, s[20:23], s3 offen sc1
  s_and_b32 s36, s2, 63
  s_lshr_b32 s34, s2, 6
  v_mul_lo_u32 v243, v243, s34
  v_add_u32 v242, v242, v243
  s_lshr_b32 s34, s36, 1
  s_mul_i32 s34, s34, 7168
  s_and_b32 s47, s36, 1
  s_mul_i32 s47, s47, 3584
  s_add_u32 s34, s34, s47
  s_add_u32 s34, s34, 0x600000
  buffer_store_dwordx4 v[244:247], v242, s[20:23], s34 offen sc1
  s_or_b32 s34, s2, s38
  s_cmp_lg_u32 s34, 0
  s_cbranch_scc1 L_B_ne
  v_mov_b32 v10, s58
  v_mov_b32 v11, 0
  s_mov_b32 s34, 0xa01000
  s_mov_b64 exec, 1
  buffer_store_dword v10, v11, s[20:23], s34 offen sc1
  s_mov_b64 exec, -1
L_B_ne:
  v_max_u32 v8, v8, v9
  s_nop 1
  v_max_u32_dpp v8, v8, v8 row_ror:8 row_mask:0xf bank_mask:0xf
  s_nop 1
  v_max_u32_dpp v8, v8, v8 row_ror:4 row_mask:0xf bank_mask:0xf
  s_nop 1
  v_max_u32_dpp v8, v8, v8 row_ror:2 row_mask:0xf bank_mask:0xf
  s_nop 1
  v_max_u32_dpp v8, v8, v8 row_ror:1 row_mask:0xf bank_mask:0xf
  s_mov_b32 exec_lo, 0x10001
  s_mov_b32 exec_hi, 0x10001
  ds_max_u32 v119, v8
  s_mov_b64 exec, -1
  s_waitcnt lgkmcnt(0)
  s_barrier
  ds_read_b32 v8, v119
  ds_read_b64_tr_b16 v[16:17], v112 offset:0
  ds_read_b64_tr_b16 v[18:19], v112 offset:2048
  ds_read_b64_tr_b16 v[24:25], v113 offset:0
  ds_read_b64_tr_b16 v[26:27], v113 offset:2048
  ds_read_b64_tr_b16 v[20:21], v112 offset:4096
  ds_read_b64_tr_b16 v[22:23], v112 offset:6144
  ds_read_b64_tr_b16 v[28:29], v113 offset:4096
  ds_read_b64_tr_b16 v[30:31], v113 offset:6144
  s_waitcnt lgkmcnt(4)
  v_xor_b32 v32, s49, v16
  v_xor_b32 v33, s49, v17
  v_xor_b32 v34, s49, v18
  v_xor_b32 v35, s49, v19
  v_mfma_f32_16x16x32_f16 v[72:75], v[40:43], v[16:19], 0
  v_mfma_f32_16x16x32_f16 v[76:79], v[40:43], v[24:27], 0
  v_mfma_f32_16x16x32_f16 v[72:75], v[48:51], v[24:27], v[72:75]
  v_mfma_f32_16x16x32_f16 v[76:79], v[48:51], v[32:35], v[76:79]
  s_waitcnt lgkmcnt(0)
  v_xor_b32 v36, s49, v20
  v_xor_b32 v37, s49, v21
  v_xor_b32 v38, s49, v22
  v_xor_b32 v39, s49, v23
  v_mfma_f32_16x16x32_f16 v[72:75], v[44:47], v[20:23], v[72:75]
  v_mfma_f32_16x16x32_f16 v[76:79], v[44:47], v[28:31], v[76:79]
  v_mfma_f32_16x16x32_f16 v[72:75], v[52:55], v[28:31], v[72:75]
  v_mfma_f32_16x16x32_f16 v[76:79], v[52:55], v[36:39], v[76:79]
  v_lshrrev_b32 v8, 23, v8
  v_max_u32 v8, 8, v8
  v_min_u32 v8, 0xfa, v8
  v_sub_u32 v9, 0xfc, v8
  v_lshlrev_b32 v9, 23, v9
  v_mul_f32 v12, v9, v117
  v_pk_mul_f32 v[120:121], v[120:121], v[12:13] op_sel_hi:[1,0]
  v_pk_mul_f32 v[122:123], v[122:123], v[12:13] op_sel_hi:[1,0]
  v_pk_mul_f32 v[124:125], v[124:125], v[12:13] op_sel_hi:[1,0]
  v_pk_mul_f32 v[126:127], v[126:127], v[12:13] op_sel_hi:[1,0]
  v_add_u32 v8, 2, v8
  v_lshlrev_b32 v8, 23, v8
  v_mul_f32 v8, 0x3d924925, v8
  s_nop 0
  v_readfirstlane_b32 s62, v8
  v_pk_mul_f32 v[80:81], v[72:73], v[120:121]
  v_pk_mul_f32 v[82:83], v[72:73], v[124:125]
  v_pk_fma_f32 v[80:81], v[76:77], v[124:125], v[80:81] neg_lo:[1,0,0] neg_hi:[1,0,0]
  v_pk_fma_f32 v[82:83], v[76:77], v[120:121], v[82:83]
  v_cvt_pk_f16_f32 v84, v80, v81
  v_cvt_pk_f16_f32 v86, v82, v83
  v_pk_mul_f32 v[80:81], v[74:75], v[122:123]
  v_pk_mul_f32 v[82:83], v[74:75], v[126:127]
  v_pk_fma_f32 v[80:81], v[78:79], v[126:127], v[80:81] neg_lo:[1,0,0] neg_hi:[1,0,0]
  v_pk_fma_f32 v[82:83], v[78:79], v[122:123], v[82:83]
  v_cvt_pk_f16_f32 v85, v80, v81
  v_cvt_pk_f16_f32 v87, v82, v83
  ds_write_b64 v114, v[84:85]
  ds_write_b64 v114, v[86:87] offset:2048
  s_mov_b32 s63, s62
  s_waitcnt lgkmcnt(0)
  s_barrier
  ds_read_b128 v[16:19], v115 offset:0
  ds_read_b128 v[24:27], v115 offset:2048
  ds_read_b128 v[20:23], v115 offset:1024
  ds_read_b128 v[28:31], v115 offset:3072
  s_waitcnt lgkmcnt(2)
  v_xor_b32 v32, s49, v24
  v_xor_b32 v33, s49, v25
  v_xor_b32 v34, s49, v26
  v_xor_b32 v35, s49, v27
  v_mfma_f32_16x16x32_f16 v[72:75], v[16:19], v[40:43], 0
  v_mfma_f32_16x16x32_f16 v[76:79], v[24:27], v[40:43], 0
  v_mfma_f32_16x16x32_f16 v[72:75], v[32:35], v[48:51], v[72:75]
  v_mfma_f32_16x16x32_f16 v[76:79], v[16:19], v[48:51], v[76:79]
  s_waitcnt lgkmcnt(0)
  v_xor_b32 v36, s49, v28
  v_xor_b32 v37, s49, v29
  v_xor_b32 v38, s49, v30
  v_xor_b32 v39, s49, v31
  v_mfma_f32_16x16x32_f16 v[72:75], v[20:23], v[44:47], v[72:75]
  v_mfma_f32_16x16x32_f16 v[76:79], v[28:31], v[44:47], v[76:79]
  v_mfma_f32_16x16x32_f16 v[72:75], v[36:39], v[52:55], v[72:75]
  v_mfma_f32_16x16x32_f16 v[76:79], v[20:23], v[52:55], v[76:79]
  s_nop 6
  v_cvt_pk_f16_f32 v84, v72, v73
  v_cvt_pk_f16_f32 v85, v74, v75
  v_cvt_pk_f16_f32 v86, v76, v77
  v_cvt_pk_f16_f32 v87, v78, v79
  s_nop 0
  v_permlane16_swap_b32 v84, v86
  v_permlane16_swap_b32 v85, v87
  buffer_store_dwordx4 v[84:87], v116, s[20:23], s43 offen sc1
  s_waitcnt vmcnt(1) lgkmcnt(0)
  s_barrier
  s_cmp_lg_u32 s38, 0
  s_cbranch_scc1 L_pub1
  s_lshl_b32 s47, s2, 2
  s_add_u32 s47, s47, 0xa20000
  v_mov_b32 v8, s58
  v_lshlrev_b32 v9, 10, v1
  s_mov_b64 exec, 255
  buffer_store_dword v8, v9, s[20:23], s47 offen sc1
  s_mov_b64 exec, -1
L_pub1:
  s_sub_u32 s8, s38, 4
  s_cmp_gt_u32 s8, 1
  s_cbranch_scc1 L_dose2
  s_mov_b32 s4, s72
  s_and_b32 s5, s73, 0xffff
  s_mov_b32 s6, 0x700000
  s_mov_b32 s7, 0x20000
  s_mul_i32 s8, s8, 7168
  s_lshr_b32 s9, s2, 5
  s_mul_i32 s9, s9, 917504
  s_add_u32 s8, s8, s9
  s_and_b32 s9, s2, 31
  s_mul_i32 s9, s9, 14336
  s_add_u32 s8, s8, s9
  s_add_u32 s8, s8, 0
  v_lshlrev_b32 v249, 7, v1
  s_mov_b64 exec, s[56:57]
  buffer_load_dword v250, v249, s[4:7], s8 offen
  s_mov_b64 exec, -1
L_dose2:
  ds_read_b64_tr_b16 v[128:129], v252 offset:0
  ds_read_b64_tr_b16 v[132:133], v253 offset:0
  ds_read_b64_tr_b16 v[136:137], v254 offset:0
  ds_read_b64_tr_b16 v[140:141], v255 offset:0
  ds_read_b64_tr_b16 v[130:131], v252 offset:2048
  ds_read_b64_tr_b16 v[134:135], v253 offset:2048
  ds_read_b64_tr_b16 v[138:139], v254 offset:2048
  ds_read_b64_tr_b16 v[142:143], v255 offset:2048
  ds_read_b64_tr_b16 v[144:145], v252 offset:4096
  ds_read_b64_tr_b16 v[148:149], v253 offset:4096
  ds_read_b64_tr_b16 v[152:153], v254 offset:4096
  ds_read_b64_tr_b16 v[156:157], v255 offset:4096
  ds_read_b64_tr_b16 v[146:147], v252 offset:6144
  ds_read_b64_tr_b16 v[150:151], v253 offset:6144
  ds_read_b64_tr_b16 v[154:155], v254 offset:6144
  ds_read_b64_tr_b16 v[158:159], v255 offset:6144
  ds_read_b64_tr_b16 v[160:161], v252 offset:8192
  ds_read_b64_tr_b16 v[164:165], v253 offset:8192
  ds_read_b64_tr_b16 v[168:169], v254 offset:8192
  ds_read_b64_tr_b16 v[172:173], v255 offset:8192
  s_and_b32 s36, s2, 63
  s_lshr_b32 s37, s2, 6
  v_lshlrev_b32 v6, 4, v0
  s_mov_b32 s40, 30720
  buffer_load_dwordx4 v[64:67], v6, s[16:19], s40 offen
  v_mul_u32_u24 v4, 56, v2
  v_lshl_add_u32 v4, v3, 3, v4
  v_add_u32 v5, 32, v4
  v_cmp_gt_u32 vcc, 48, v1
  v_mov_b32 v12, 0x40000000
  v_mov_b32 v13, 0
  v_mov_b32 v14, 1.0
  v_cndmask_b32 v5, v12, v5, vcc
  v_cndmask_b32 v63, v13, v14, vcc
  s_lshl_b32 s46, s37, 9
  s_add_u32 s46, s46, s36
  s_lshl_b32 s39, s38, 6
  s_add_u32 s39, s39, s46
  s_mul_i32 s39, s39, 896
  s_add_u32 s48, s39, 0x400000
  buffer_load_dwordx2 v[68:69], v4, s[12:15], s39 offen
  buffer_load_dwordx2 v[70:71], v5, s[12:15], s39 offen
  s_waitcnt lgkmcnt(0)
  s_add_u32 m0, s35, 0
  s_add_u32 s33, s32, 924672
  buffer_load_dwordx4 v251, s[52:55], s33 offen lds
  s_and_b32 s42, s38, 1
  s_lshl_b32 s43, s42, 7
  s_lshl_b32 s44, s36, 15
  s_lshl_b32 s45, s38, 12
  s_add_u32 s44, s44, s45
  s_add_u32 s44, s44, 0x200000
  v_lshrrev_b32 v12, 2, v2
  v_and_b32 v13, 3, v2
  v_lshlrev_b32 v12, 7, v12
  v_add_u32 v12, s46, v12
  v_cvt_f32_u32 v12, v12
  v_mul_f32 v12, 0x3a000000, v12
  v_add_f32 v14, 0x3d000000, v12
  s_add_u32 m0, s35, 1024
  s_add_u32 s33, s32, 4594688
  buffer_load_dwordx4 v251, s[52:55], s33 offen lds
  v_cvt_f32_u32 v15, v13
  v_and_b32 v16, 1, v13
  v_cvt_f32_u32 v16, v16
  v_add_f32 v17, -2.0, v15
  v_mul_f32 v17, 0x3e800000, v17
  v_mul_f32 v17, v16, v17
  v_sub_f32 v18, 1.0, v15
  v_mul_f32 v18, 0x3e800000, v18
  v_sub_f32 v16, 1.0, v16
  v_mul_f32 v18, v16, v18
  s_add_u32 m0, s35, 2048
  s_add_u32 s33, s32, 10752
  buffer_load_dwordx4 v251, s[52:55], s33 offen lds
  s_and_b32 s49, s38, 3
  s_lshr_b32 s50, s38, 2
  s_lshl_b32 s50, s50, 4
  s_add_u32 s49, s49, s50
  v_lshl_add_u32 v19, v3, 2, s49
  v_cvt_f32_u32 v19, v19
  v_fma_f32 v20, v19, v12, v17
  v_fma_f32 v21, v19, v14, v18
  v_cos_f32 v22, v20
  v_cos_f32 v23, v21
  v_sin_f32 v24, v20
  v_sin_f32 v25, v21
  s_add_u32 m0, s35, 3072
  s_add_u32 s33, s32, 3680768
  buffer_load_dwordx4 v251, s[52:55], s33 offen lds
  v_add_f32 v22, v22, v23
  v_add_f32 v24, v24, v25
  v_cvt_pk_f16_f32 v22, v22, -v24
  s_lshl_b32 s49, s38, 1
  s_add_u32 s49, s49, 47104
  v_add_u32 v23, s49, v7
  ds_write_b16 v23, v22
  ds_write_b16_d16_hi v23, v22 offset:1024
  s_cmp_lg_u32 s38, 1
  s_cbranch_scc1 L_C_nz
  v_mov_b32 v24, 0
  v_mov_b32 v25, 0
  v_mul_u32_u24 v26, 160, v2
  v_mul_u32_u24 v27, 2576, v3
  v_add_u32 v26, v26, v27
  ds_write_b64 v26, v[24:25] offset:49272
  v_cmp_ne_u32 vcc, 0, v2
  s_nop 0
  s_mov_b64 exec, vcc
  ds_write_b64 v26, v[24:25] offset:49264
  s_mov_b64 exec, -1
L_C_nz:
  s_add_u32 m0, s35, 4096
  s_add_u32 s33, s32, 928256
  buffer_load_dwordx4 v251, s[52:55], s33 offen lds
  s_add_u32 m0, s35, 5120
  s_add_u32 s33, s32, 4598272
  buffer_load_dwordx4 v251, s[52:55], s33 offen lds
  ds_read_b128 v[80:83], v7 offset:32768
  ds_read_b128 v[84:87], v7 offset:33792
  ds_read_b128 v[88:91], v7 offset:34816
  ds_read_b128 v[92:95], v7 offset:35840
  ds_read_b128 v[96:99], v7 offset:36864
  ds_read_b128 v[100:103], v7 offset:37888
  ds_read_b128 v[104:107], v7 offset:38912
  ds_read_b128 v[108:111], v7 offset:39936
  ds_read_b128 v[112:115], v7 offset:40960
  ds_read_b128 v[116:119], v7 offset:41984
  s_add_u32 m0, s35, 6144
  s_add_u32 s33, s32, 14336
  buffer_load_dwordx4 v251, s[52:55], s33 offen lds
  ds_read_b128 v[120:123], v7 offset:43008
  ds_read_b128 v[124:127], v7 offset:44032
  s_lshl_b32 s49, s42, 10
  v_add_u32 v29, s49, v7
  ds_read_b128 v[76:79], v29 offset:45056
  v_xor_b32 v8, s43, v7
  v_xor_b32 v9, 32, v8
  v_xor_b32 v10, 64, v8
  v_xor_b32 v11, 0x60, v8
  v_lshrrev_b32 v28, 2, v2
  v_lshl_add_u32 v28, v3, 2, v28
  s_add_u32 m0, s35, 7168
  s_add_u32 s33, s32, 3684352
  buffer_load_dwordx4 v251, s[52:55], s33 offen lds
  v_and_b32 v29, 7, v28
  s_lshl_b32 s49, s38, 2
  v_xor_b32 v29, s49, v29
  v_lshlrev_b32 v28, 10, v28
  v_lshl_add_u32 v28, v29, 5, v28
  v_and_b32 v29, 3, v2
  v_lshl_add_u32 v24, v29, 3, v28
  v_xor_b32 v25, 32, v24
  v_xor_b32 v26, 64, v24
  v_xor_b32 v27, 0x60, v24
  v_mul_u32_u24 v28, 160, v2
  v_lshl_add_u32 v28, v3, 4, v28
  s_lshr_b32 s49, s38, 1
  s_mul_i32 s49, s49, 2576
  s_add_u32 s49, s49, 49152
  v_add_u32 v28, s49, v28
  s_add_u32 m0, s35, 8192
  s_add_u32 s33, s32, 931840
  buffer_load_dwordx4 v251, s[52:55], s33 offen lds
  s_mul_i32 s49, s38, 960
  s_add_u32 s49, s49, 59504
  v_add_u32 v30, s49, v4
  v_lshrrev_b32 v31, 2, v2
  v_mul_u32_u24 v31, 960, v31
  v_lshl_add_u32 v31, v3, 5, v31
  v_and_b32 v12, 3, v2
  v_lshl_add_u32 v31, v12, 3, v31
  s_add_u32 m0, s35, 9216
  s_add_u32 s33, s32, 4601856
  buffer_load_dwordx4 v251, s[52:55], s33 offen lds
  s_lshl_b32 s49, s38, 7
  s_add_u32 s49, s49, 59504
  v_add_u32 v31, s49, v31
  s_lshr_b32 s49, s36, 1
  s_mul_i32 s49, s49, 7168
  s_and_b32 s50, s36, 1
  s_mul_i32 s50, s50, 3584
  s_add_u32 s49, s49, s50
  s_add_u32 s49, s49, 0x600000
  s_waitcnt vmcnt(10)
  v_and_b32 v72, 0xffff, v64
  v_lshrrev_b32 v73, 16, v64
  v_and_b32 v74, 0xffff, v65
  v_lshrrev_b32 v75, 16, v65
  v_mul_lo_u32 v67, v67, s37
  v_add_u32 v66, v66, v67
  v_lshlrev_b32 v16, 16, v68
  v_and_b32 v17, s59, v68
  v_lshlrev_b32 v18, 16, v69
  v_and_b32 v19, s59, v69
  v_lshlrev_b32 v20, 16, v70
  v_and_b32 v21, s59, v70
  v_lshlrev_b32 v22, 16, v71
  v_and_b32 v23, s59, v71
  v_add_u32 v6, s45, v7
  s_waitcnt lgkmcnt(0)
  s_cmp_lg_u32 s38, 0
  s_cbranch_scc1 L_w1
  s_lshl_b32 s47, s24, 10
  s_add_u32 s47, s47, 0xa20000
  s_mov_b32 s50, 0
L_poll1:
  buffer_load_dwordx4 v[40:43], v7, s[20:23], s47 offen sc1
L_pc1:
  s_waitcnt vmcnt(0)
  v_xor_b32 v40, s58, v40
  v_xor_b32 v41, s58, v41
  v_xor_b32 v42, s58, v42
  v_xor_b32 v43, s58, v43
  v_or3_b32 v40, v40, v41, v42
  v_or_b32 v40, v40, v43
  v_cmp_ne_u32 vcc, 0, v40
  s_nop 0
  s_and_b64 exec, exec, vcc
  s_cbranch_scc0 L_x1
  s_sleep 4
  s_add_u32 s50, s50, 1
  s_cmp_lt_u32 s50, 300000
  s_cbranch_scc1 L_poll1
L_x1:
  s_mov_b64 exec, -1
L_w1:
  s_barrier
  s_mov_b32 s50, 0
L_C_ld:
  buffer_load_dwordx4 v[40:43], v8, s[20:23], s44 offen offset:0 sc1
  buffer_load_dwordx4 v[44:47], v9, s[20:23], s44 offen offset:1024 sc1
  buffer_load_dwordx4 v[48:51], v10, s[20:23], s44 offen offset:2048 sc1
  buffer_load_dwordx4 v[52:55], v11, s[20:23], s44 offen offset:3072 sc1
  s_waitcnt vmcnt(0)
  v_max3_u32 v56, v40, v41, v42
  v_max_u32 v56, v56, v43
  v_max3_u32 v57, v44, v45, v46
  v_max_u32 v57, v57, v47
  v_max3_u32 v58, v48, v49, v50
  v_max_u32 v58, v58, v51
  v_max3_u32 v59, v52, v53, v54
  v_max_u32 v59, v59, v55
  v_max3_u32 v56, v56, v57, v58
  v_max_u32 v56, v56, v59
  v_cmp_eq_u32 vcc, -1, v56
  s_add_u32 s50, s50, 1
  s_cmp_gt_u32 s50, 2000
  s_cbranch_scc1 L_C_ok
  s_cbranch_vccnz L_C_ld
L_C_ok:
  ds_write_b128 v6, v[40:43] offset:0
  ds_write_b128 v6, v[44:47] offset:1024
  ds_write_b128 v6, v[48:51] offset:2048
  ds_write_b128 v6, v[52:55] offset:3072
  s_mul_i32 s34, s26, 28
  s_add_u32 s34, s34, s27
  s_mul_i32 s34, s34, 7168
  s_lshl_b32 s3, s38, 10
  s_add_u32 s34, s34, s3
  s_add_u32 s34, s34, 0x800000
  s_cmp_ge_u32 s25, 28
  s_cselect_b32 s34, 0x40000000, s34
  s_cmp_eq_u32 s38, 7
  s_cselect_b32 s34, 0x40000000, s34
  buffer_store_dwordx4 v[244:247], v7, s[20:23], s34 offen sc1
  ds_read_b128 v[32:35], v7 offset:47104
  ds_read_b128 v[36:39], v7 offset:48128
  s_waitcnt lgkmcnt(0)
  s_barrier
  ds_read_b64_tr_b16 v[40:41], v24 offset:0
  ds_read_b64_tr_b16 v[42:43], v24 offset:16384
  ds_read_b64_tr_b16 v[44:45], v25 offset:0
  ds_read_b64_tr_b16 v[46:47], v25 offset:16384
  ds_read_b64_tr_b16 v[48:49], v26 offset:0
  ds_read_b64_tr_b16 v[50:51], v26 offset:16384
  ds_read_b64_tr_b16 v[52:53], v27 offset:0
  ds_read_b64_tr_b16 v[54:55], v27 offset:16384
  s_waitcnt lgkmcnt(4)
  v_mfma_f32_16x16x32_f16 v[56:59], v[32:35], v[40:43], 0
  v_mfma_f32_16x16x32_f16 v[56:59], v[36:39], v[44:47], v[56:59]
  s_waitcnt lgkmcnt(0)
  v_mfma_f32_16x16x32_f16 v[8:11], v[32:35], v[48:51], 0
  v_mfma_f32_16x16x32_f16 v[8:11], v[36:39], v[52:55], v[8:11]
  s_nop 4
  v_cvt_pk_f16_f32 v60, v56, v57
  v_cvt_pk_f16_f32 v61, v58, v59
  ds_write_b32 v72, v60
  ds_write_b32 v73, v61
  v_cvt_pk_f16_f32 v62, v8, v9
  v_cvt_pk_f16_f32 v12, v10, v11
  ds_write_b32 v74, v62
  ds_write_b32 v75, v12
  s_waitcnt lgkmcnt(0)
  s_barrier
  ds_read_b128 v[32:35], v28
  ds_read_b128 v[36:39], v28 offset:64
  s_waitcnt lgkmcnt(0)
  v_mfma_f32_16x16x32_f16 v[40:43], v[32:35], v[80:83], 0
  v_mfma_f32_16x16x32_f16 v[44:47], v[32:35], v[84:87], 0
  v_mfma_f32_16x16x32_f16 v[48:51], v[32:35], v[88:91], 0
  v_mfma_f32_16x16x32_f16 v[52:55], v[32:35], v[92:95], 0
  v_mfma_f32_16x16x32_f16 v[40:43], v[36:39], v[96:99], v[40:43]
  v_mfma_f32_16x16x32_f16 v[44:47], v[36:39], v[100:103], v[44:47]
  v_mfma_f32_16x16x32_f16 v[48:51], v[36:39], v[104:107], v[48:51]
  v_mfma_f32_16x16x32_f16 v[52:55], v[36:39], v[108:111], v[52:55]
  s_nop 4
  v_pk_mul_f32 v[56:57], v[40:41], v[112:113]
  v_pk_mul_f32 v[58:59], v[40:41], v[116:117]
  v_pk_fma_f32 v[56:57], v[44:45], v[116:117], v[56:57] neg_lo:[1,0,0] neg_hi:[1,0,0]
  v_pk_fma_f32 v[58:59], v[44:45], v[112:113], v[58:59]
  v_cvt_pk_f16_f32 v32, v56, v58
  v_cvt_pk_f16_f32 v33, v57, v59
  v_pk_mul_f32 v[56:57], v[42:43], v[114:115]
  v_pk_mul_f32 v[58:59], v[42:43], v[118:119]
  v_pk_fma_f32 v[56:57], v[46:47], v[118:119], v[56:57] neg_lo:[1,0,0] neg_hi:[1,0,0]
  v_pk_fma_f32 v[58:59], v[46:47], v[114:115], v[58:59]
  v_cvt_pk_f16_f32 v34, v56, v58
  v_cvt_pk_f16_f32 v35, v57, v59
  s_nop 1
  v_mfma_f32_16x16x32_f16 v[80:83], v[32:35], v[76:79], 0
  v_pk_mul_f32 v[56:57], v[48:49], v[120:121]
  v_pk_mul_f32 v[58:59], v[48:49], v[124:125]
  v_pk_fma_f32 v[56:57], v[52:53], v[124:125], v[56:57] neg_lo:[1,0,0] neg_hi:[1,0,0]
  v_pk_fma_f32 v[58:59], v[52:53], v[120:121], v[58:59]
  v_cvt_pk_f16_f32 v36, v56, v58
  v_cvt_pk_f16_f32 v37, v57, v59
  v_pk_mul_f32 v[56:57], v[50:51], v[122:123]
  v_pk_mul_f32 v[58:59], v[50:51], v[126:127]
  v_pk_fma_f32 v[56:57], v[54:55], v[126:127], v[56:57] neg_lo:[1,0,0] neg_hi:[1,0,0]
  v_pk_fma_f32 v[58:59], v[54:55], v[122:123], v[58:59]
  v_cvt_pk_f16_f32 v38, v56, v58
  v_cvt_pk_f16_f32 v39, v57, v59
  s_nop 1
  v_mfma_f32_16x16x32_f16 v[84:87], v[36:39], v[76:79], 0
  v_pk_mul_f32 v[80:81], v[80:81], s[62:63]
  v_pk_mul_f32 v[82:83], v[82:83], s[62:63]
  s_nop 5
  v_pk_mul_f32 v[84:85], v[84:85], s[62:63]
  v_pk_mul_f32 v[86:87], v[86:87], s[62:63]
  v_cvt_pk_bf16_f32 v68, v80, v81
  v_cvt_pk_bf16_f32 v69, v82, v83
  v_cvt_pk_bf16_f32 v70, v84, v85
  v_cvt_pk_bf16_f32 v71, v86, v87
  v_lshlrev_b32 v80, 16, v68
  v_and_b32 v81, s59, v68
  v_lshlrev_b32 v82, 16, v69
  v_and_b32 v83, s59, v69
  v_lshlrev_b32 v84, 16, v70
  v_and_b32 v85, s59, v70
  v_lshlrev_b32 v86, 16, v71
  v_and_b32 v87, s59, v71
  v_pk_add_f32 v[16:17], v[16:17], v[80:81]
  v_pk_add_f32 v[18:19], v[18:19], v[82:83]
  v_pk_add_f32 v[20:21], v[20:21], v[84:85]
  v_pk_add_f32 v[22:23], v[22:23], v[86:87]
  v_cvt_pk_bf16_f32 v68, v16, v17
  v_cvt_pk_bf16_f32 v69, v18, v19
  v_cvt_pk_bf16_f32 v70, v20, v21
  v_cvt_pk_bf16_f32 v71, v22, v23
  v_lshlrev_b32 v16, 16, v68
  v_and_b32 v17, s59, v68
  v_lshlrev_b32 v18, 16, v69
  v_and_b32 v19, s59, v69
  v_lshlrev_b32 v20, 16, v70
  v_and_b32 v21, s59, v70
  v_lshlrev_b32 v22, 16, v71
  v_and_b32 v23, s59, v71
  buffer_store_dwordx2 v[68:69], v4, s[20:23], s48 offen sc1
  buffer_store_dwordx2 v[70:71], v5, s[20:23], s48 offen sc1
  v_pk_add_f32 v[94:95], v[16:17], v[18:19]
  v_pk_add_f32 v[96:97], v[20:21], v[22:23]
  v_add_f32 v94, v94, v95
  v_add_f32 v96, v96, v97
  v_fma_f32 v88, v96, v63, v94
  s_nop 1
  v_add_f32_dpp v88, v88, v88 row_ror:8 row_mask:0xf bank_mask:0xf
  s_nop 1
  v_add_f32_dpp v88, v88, v88 row_ror:4 row_mask:0xf bank_mask:0xf
  s_nop 1
  v_add_f32_dpp v88, v88, v88 row_ror:2 row_mask:0xf bank_mask:0xf
  s_nop 1
  v_add_f32_dpp v88, v88, v88 row_ror:1 row_mask:0xf bank_mask:0xf
  v_mov_b32 v89, v88
  s_nop 1
  v_permlane16_swap_b32 v88, v89
  v_add_f32 v88, v88, v89
  v_mov_b32 v89, v88
  s_nop 1
  v_permlane32_swap_b32 v88, v89
  v_add_f32 v88, v88, v89
  v_mul_f32 v88, s60, v88
  v_cvt_pk_bf16_f32 v90, v88, v88
  v_lshlrev_b32 v90, 16, v90
  v_pk_add_f32 v[16:17], v[16:17], v[90:91] op_sel_hi:[1,0] neg_lo:[0,1] neg_hi:[0,1]
  v_pk_add_f32 v[18:19], v[18:19], v[90:91] op_sel_hi:[1,0] neg_lo:[0,1] neg_hi:[0,1]
  v_pk_add_f32 v[20:21], v[20:21], v[90:91] op_sel_hi:[1,0] neg_lo:[0,1] neg_hi:[0,1]
  v_pk_add_f32 v[22:23], v[22:23], v[90:91] op_sel_hi:[1,0] neg_lo:[0,1] neg_hi:[0,1]
  v_pk_mul_f32 v[94:95], v[16:17], v[16:17]
  v_pk_mul_f32 v[96:97], v[20:21], v[20:21]
  v_pk_fma_f32 v[94:95], v[18:19], v[18:19], v[94:95]
  v_pk_fma_f32 v[96:97], v[22:23], v[22:23], v[96:97]
  v_add_f32 v94, v94, v95
  v_add_f32 v96, v96, v97
  v_fma_f32 v92, v96, v63, v94
  s_nop 1
  v_add_f32_dpp v92, v92, v92 row_ror:8 row_mask:0xf bank_mask:0xf
  v_cvt_pk_bf16_f32 v72, v16, v17
  v_cvt_pk_bf16_f32 v73, v18, v19
  v_add_f32_dpp v92, v92, v92 row_ror:4 row_mask:0xf bank_mask:0xf
  v_cvt_pk_bf16_f32 v74, v20, v21
  v_cvt_pk_bf16_f32 v75, v22, v23
  v_add_f32_dpp v92, v92, v92 row_ror:2 row_mask:0xf bank_mask:0xf
  v_lshlrev_b32 v16, 16, v72
  v_and_b32 v17, s59, v72
  v_add_f32_dpp v92, v92, v92 row_ror:1 row_mask:0xf bank_mask:0xf
  v_lshlrev_b32 v18, 16, v73
  v_and_b32 v19, s59, v73
  v_mov_b32 v89, v92
  v_lshlrev_b32 v20, 16, v74
  v_and_b32 v21, s59, v74
  v_permlane16_swap_b32 v92, v89
  v_lshlrev_b32 v22, 16, v75
  v_and_b32 v23, s59, v75
  v_add_f32 v92, v92, v89
  v_mov_b32 v89, v92
  s_nop 1
  v_permlane32_swap_b32 v92, v89
  v_add_f32 v92, v92, v89
  v_sub_f32 v89, v88, v90
  v_mul_f32 v92, s60, v92
  v_fma_f32 v92, -v89, v89, v92
  v_max_f32 v92, 0, v92
  v_cvt_pk_bf16_f32 v92, v92, v92
  v_lshlrev_b32 v92, 16, v92
  v_add_f32 v92, s61, v92
  v_cvt_pk_bf16_f32 v92, v92, v92
  v_lshlrev_b32 v92, 16, v92
  v_sqrt_f32 v92, v92
  s_nop 0
  v_cvt_pk_bf16_f32 v92, v92, v92
  v_lshlrev_b32 v92, 16, v92
  v_rcp_f32 v92, v92
  s_nop 0
  v_pk_mul_f32 v[16:17], v[16:17], v[92:93] op_sel_hi:[1,0]
  v_pk_mul_f32 v[18:19], v[18:19], v[92:93] op_sel_hi:[1,0]
  v_pk_mul_f32 v[20:21], v[20:21], v[92:93] op_sel_hi:[1,0]
  v_pk_mul_f32 v[22:23], v[22:23], v[92:93] op_sel_hi:[1,0]
  v_cvt_pk_bf16_f32 v72, v16, v17
  v_cvt_pk_bf16_f32 v73, v18, v19
  v_cvt_pk_bf16_f32 v74, v20, v21
  v_cvt_pk_bf16_f32 v75, v22, v23
  v_lshlrev_b32 v16, 16, v72
  v_and_b32 v17, s59, v72
  v_lshlrev_b32 v18, 16, v73
  v_and_b32 v19, s59, v73
  v_lshlrev_b32 v20, 16, v74
  v_and_b32 v21, s59, v74
  v_lshlrev_b32 v22, 16, v75
  v_and_b32 v23, s59, v75
  v_pk_add_f32 v[94:95], v[16:17], v[18:19]
  v_pk_add_f32 v[96:97], v[20:21], v[22:23]
  v_add_f32 v94, v94, v95
  v_add_f32 v96, v96, v97
  v_fma_f32 v88, v96, v63, v94
  s_nop 1
  v_add_f32_dpp v88, v88, v88 row_ror:8 row_mask:0xf bank_mask:0xf
  s_nop 1
  v_add_f32_dpp v88, v88, v88 row_ror:4 row_mask:0xf bank_mask:0xf
  s_nop 1
  v_add_f32_dpp v88, v88, v88 row_ror:2 row_mask:0xf bank_mask:0xf
  s_nop 1
  v_add_f32_dpp v88, v88, v88 row_ror:1 row_mask:0xf bank_mask:0xf
  v_mov_b32 v89, v88
  s_nop 1
  v_permlane16_swap_b32 v88, v89
  v_add_f32 v88, v88, v89
  v_mov_b32 v89, v88
  s_nop 1
  v_permlane32_swap_b32 v88, v89
  v_add_f32 v88, v88, v89
  v_mul_f32 v88, s60, v88
  v_cvt_pk_bf16_f32 v90, v88, v88
  v_lshlrev_b32 v90, 16, v90
  v_pk_add_f32 v[16:17], v[16:17], v[90:91] op_sel_hi:[1,0] neg_lo:[0,1] neg_hi:[0,1]
  v_pk_add_f32 v[18:19], v[18:19], v[90:91] op_sel_hi:[1,0] neg_lo:[0,1] neg_hi:[0,1]
  v_pk_add_f32 v[20:21], v[20:21], v[90:91] op_sel_hi:[1,0] neg_lo:[0,1] neg_hi:[0,1]
  v_pk_add_f32 v[22:23], v[22:23], v[90:91] op_sel_hi:[1,0] neg_lo:[0,1] neg_hi:[0,1]
  v_pk_mul_f32 v[94:95], v[16:17], v[16:17]
  v_pk_mul_f32 v[96:97], v[20:21], v[20:21]
  v_pk_fma_f32 v[94:95], v[18:19], v[18:19], v[94:95]
  v_pk_fma_f32 v[96:97], v[22:23], v[22:23], v[96:97]
  v_add_f32 v94, v94, v95
  v_add_f32 v96, v96, v97
  v_fma_f32 v92, v96, v63, v94
  s_nop 1
  v_add_f32_dpp v92, v92, v92 row_ror:8 row_mask:0xf bank_mask:0xf
  v_cvt_pk_bf16_f32 v72, v16, v17
  v_cvt_pk_bf16_f32 v73, v18, v19
  v_add_f32_dpp v92, v92, v92 row_ror:4 row_mask:0xf bank_mask:0xf
  v_cvt_pk_bf16_f32 v74, v20, v21
  v_cvt_pk_bf16_f32 v75, v22, v23
  v_add_f32_dpp v92, v92, v92 row_ror:2 row_mask:0xf bank_mask:0xf
  v_lshlrev_b32 v16, 16, v72
  v_and_b32 v17, s59, v72
  v_add_f32_dpp v92, v92, v92 row_ror:1 row_mask:0xf bank_mask:0xf
  v_lshlrev_b32 v18, 16, v73
  v_and_b32 v19, s59, v73
  v_mov_b32 v89, v92
  v_lshlrev_b32 v20, 16, v74
  v_and_b32 v21, s59, v74
  v_permlane16_swap_b32 v92, v89
  v_lshlrev_b32 v22, 16, v75
  v_and_b32 v23, s59, v75
  v_add_f32 v92, v92, v89
  v_mov_b32 v89, v92
  s_nop 1
  v_permlane32_swap_b32 v92, v89
  v_add_f32 v92, v92, v89
  v_sub_f32 v89, v88, v90
  v_mul_f32 v92, s60, v92
  v_fma_f32 v92, -v89, v89, v92
  v_max_f32 v92, 0, v92
  v_cvt_pk_bf16_f32 v92, v92, v92
  v_lshlrev_b32 v92, 16, v92
  v_add_f32 v92, s61, v92
  v_cvt_pk_bf16_f32 v92, v92, v92
  v_lshlrev_b32 v92, 16, v92
  v_sqrt_f32 v92, v92
  s_nop 0
  v_cvt_pk_bf16_f32 v92, v92, v92
  v_lshlrev_b32 v92, 16, v92
  v_rcp_f32 v92, v92
  s_nop 0
  v_pk_mul_f32 v[16:17], v[16:17], v[92:93] op_sel_hi:[1,0]
  v_pk_mul_f32 v[18:19], v[18:19], v[92:93] op_sel_hi:[1,0]
  v_pk_mul_f32 v[20:21], v[20:21], v[92:93] op_sel_hi:[1,0]
  v_pk_mul_f32 v[22:23], v[22:23], v[92:93] op_sel_hi:[1,0]
  v_cvt_pk_bf16_f32 v72, v16, v17
  v_cvt_pk_bf16_f32 v73, v18, v19
  v_cvt_pk_bf16_f32 v74, v20, v21
  v_cvt_pk_bf16_f32 v75, v22, v23
  ds_write_b64 v30, v[72:73]
  s_mov_b32 exec_hi, 0xffff
  ds_write_b64 v30, v[74:75] offset:32
  s_mov_b64 exec, -1
  s_waitcnt lgkmcnt(0)
  s_barrier
  s_waitcnt vmcnt(0)
  s_cmp_eq_u32 s38, 7
  s_cbranch_scc1 L_C_done
  ds_read_b64_tr_b16 v[32:33], v31
  ds_read_b64_tr_b16 v[34:35], v31 offset:3840
  s_waitcnt lgkmcnt(0)
  buffer_store_dwordx4 v[32:35], v66, s[20:23], s49 offen sc1
L_C_done:
  s_waitcnt vmcnt(1) lgkmcnt(0)
  s_barrier
  s_cmp_lg_u32 s38, 0
  s_cbranch_scc1 L_pub2
  s_lshl_b32 s47, s2, 2
  s_add_u32 s47, s47, 0xa30000
  v_mov_b32 v8, s58
  v_lshlrev_b32 v9, 10, v1
  s_mov_b64 exec, 255
  buffer_store_dword v8, v9, s[20:23], s47 offen sc1
  s_mov_b64 exec, -1
L_pub2:
  s_sub_u32 s8, s38, 4
  s_cmp_gt_u32 s8, 1
  s_cbranch_scc1 L_dose3
  s_mov_b32 s4, s72
  s_and_b32 s5, s73, 0xffff
  s_mov_b32 s6, 0x700000
  s_mov_b32 s7, 0x20000
  s_mul_i32 s8, s8, 7168
  s_lshr_b32 s9, s2, 5
  s_mul_i32 s9, s9, 917504
  s_add_u32 s8, s8, s9
  s_and_b32 s9, s2, 31
  s_mul_i32 s9, s9, 14336
  s_add_u32 s8, s8, s9
  s_add_u32 s8, s8, 458752
  v_lshlrev_b32 v249, 7, v1
  s_mov_b64 exec, s[56:57]
  buffer_load_dword v250, v249, s[4:7], s8 offen
  s_mov_b64 exec, -1
L_dose3:
  s_lshl_b32 s36, s38, 13
  s_add_u32 m0, s36, 0
  s_add_u32 s33, s32, 17920
  buffer_load_dwordx4 v251, s[52:55], s33 offen lds
  s_add_u32 m0, s36, 1024
  s_add_u32 s33, s32, 3687936
  buffer_load_dwordx4 v251, s[52:55], s33 offen lds
  s_add_u32 m0, s36, 2048
  s_add_u32 s33, s32, 935424
  buffer_load_dwordx4 v251, s[52:55], s33 offen lds
  s_add_u32 m0, s36, 3072
  s_add_u32 s33, s32, 4605440
  buffer_load_dwordx4 v251, s[52:55], s33 offen lds
  s_add_u32 m0, s36, 4096
  s_add_u32 s33, s32, 21504
  buffer_load_dwordx4 v251, s[52:55], s33 offen lds
  s_add_u32 m0, s36, 5120
  s_add_u32 s33, s32, 3691520
  buffer_load_dwordx4 v251, s[52:55], s33 offen lds
  s_add_u32 m0, s36, 6144
  s_add_u32 s33, s32, 939008
  buffer_load_dwordx4 v251, s[52:55], s33 offen lds
  s_add_u32 m0, s36, 7168
  s_add_u32 s33, s32, 4609024
  buffer_load_dwordx4 v251, s[52:55], s33 offen lds
  ds_read_b64_tr_b16 v[162:163], v252 offset:0
  ds_read_b64_tr_b16 v[166:167], v253 offset:0
  ds_read_b64_tr_b16 v[170:171], v254 offset:0
  ds_read_b64_tr_b16 v[174:175], v255 offset:0
  ds_read_b64_tr_b16 v[176:177], v252 offset:2048
  ds_read_b64_tr_b16 v[180:181], v253 offset:2048
  ds_read_b64_tr_b16 v[184:185], v254 offset:2048
  ds_read_b64_tr_b16 v[188:189], v255 offset:2048
  ds_read_b64_tr_b16 v[178:179], v252 offset:4096
  ds_read_b64_tr_b16 v[182:183], v253 offset:4096
  ds_read_b64_tr_b16 v[186:187], v254 offset:4096
  ds_read_b64_tr_b16 v[190:191], v255 offset:4096
  ds_read_b64_tr_b16 v[192:193], v252 offset:6144
  ds_read_b64_tr_b16 v[196:197], v253 offset:6144
  ds_read_b64_tr_b16 v[200:201], v254 offset:6144
  ds_read_b64_tr_b16 v[204:205], v255 offset:6144
  ds_read_b64_tr_b16 v[194:195], v252 offset:8192
  ds_read_b64_tr_b16 v[198:199], v253 offset:8192
  ds_read_b64_tr_b16 v[202:203], v254 offset:8192
  ds_read_b64_tr_b16 v[206:207], v255 offset:8192
  v_lshrrev_b32 v12, 2, v2
  v_and_b32 v13, 1, v3
  v_lshl_add_u32 v12, v13, 2, v12
  v_lshrrev_b32 v13, 1, v12
  s_lshl_b32 s34, s30, 1
  v_xor_b32 v13, s34, v13
  v_lshlrev_b32 v12, 7, v12
  v_lshl_add_u32 v12, v13, 5, v12
  v_and_b32 v13, 3, v2
  v_lshl_add_u32 v12, v13, 3, v12
  v_lshrrev_b32 v13, 1, v3
  v_lshl_add_u32 v12, v13, 10, v12
  v_add_u32 v8, s36, v12
  v_xor_b32 v9, 32, v8
  v_xor_b32 v10, 64, v8
  v_xor_b32 v11, 0x60, v8
  v_mov_b32 v12, v252
  v_mov_b32 v13, v253
  v_mov_b32 v14, v254
  v_mov_b32 v15, v255
  s_waitcnt lgkmcnt(0)
  s_add_u32 m0, s35, 0
  s_add_u32 s33, s32, 25088
  buffer_load_dwordx4 v251, s[52:55], s33 offen lds
  s_add_u32 m0, s35, 1024
  s_add_u32 s33, s32, 3695104
  buffer_load_dwordx4 v251, s[52:55], s33 offen lds
  s_add_u32 m0, s35, 2048
  s_add_u32 s33, s32, 942592
  buffer_load_dwordx4 v251, s[52:55], s33 offen lds
  s_add_u32 m0, s35, 3072
  s_add_u32 s33, s32, 4612608
  buffer_load_dwordx4 v251, s[52:55], s33 offen lds
  v_lshrrev_b32 v6, 3, v1
  v_and_b32 v5, 6, v6
  v_and_b32 v4, 7, v1
  v_xor_b32 v5, v5, v4
  v_lshlrev_b32 v4, 12, v6
  v_lshl_add_u32 v4, v5, 4, v4
  v_and_b32 v6, 7, v2
  v_lshlrev_b32 v6, 4, v6
  v_lshl_add_u32 v6, v3, 7, v6
  v_add_u32 v6, 3072, v6
  s_add_u32 s48, s29, 0
  s_and_b32 s48, s48, 3
  s_lshl_b32 s49, s48, 10
  v_add_u32 v16, s49, v7
  s_cmp_eq_u32 s48, 3
  s_cselect_b64 vcc, -1, 0
  v_cndmask_b32 v16, v16, v6, vcc
  s_add_u32 s48, s29, 1
  s_and_b32 s48, s48, 3
  s_lshl_b32 s49, s48, 10
  v_add_u32 v17, s49, v7
  s_cmp_eq_u32 s48, 3
  s_cselect_b64 vcc, -1, 0
  v_cndmask_b32 v17, v17, v6, vcc
  s_add_u32 s48, s29, 2
  s_and_b32 s48, s48, 3
  s_lshl_b32 s49, s48, 10
  v_add_u32 v18, s49, v7
  s_cmp_eq_u32 s48, 3
  s_cselect_b64 vcc, -1, 0
  v_cndmask_b32 v18, v18, v6, vcc
  s_add_u32 s48, s29, 3
  s_and_b32 s48, s48, 3
  s_lshl_b32 s49, s48, 10
  v_add_u32 v19, s49, v7
  s_cmp_eq_u32 s48, 3
  s_cselect_b64 vcc, -1, 0
  v_cndmask_b32 v19, v19, v6, vcc
  s_mul_i32 s40, s38, 6144
  s_add_u32 s40, s40, 114688
  s_waitcnt vmcnt(4)
  ds_read_b64_tr_b16 v[208:209], v8 offset:0
  ds_read_b64_tr_b16 v[212:213], v9 offset:0
  ds_read_b64_tr_b16 v[216:217], v10 offset:0
  ds_read_b64_tr_b16 v[220:221], v11 offset:0
  ds_read_b64_tr_b16 v[210:211], v8 offset:2048
  ds_read_b64_tr_b16 v[214:215], v9 offset:2048
  ds_read_b64_tr_b16 v[218:219], v10 offset:2048
  ds_read_b64_tr_b16 v[222:223], v11 offset:2048
  ds_read_b64_tr_b16 v[224:225], v8 offset:4096
  ds_read_b64_tr_b16 v[228:229], v9 offset:4096
  ds_read_b64_tr_b16 v[232:233], v10 offset:4096
  ds_read_b64_tr_b16 v[236:237], v11 offset:4096
  ds_read_b64_tr_b16 v[226:227], v8 offset:6144
  ds_read_b64_tr_b16 v[230:231], v9 offset:6144
  ds_read_b64_tr_b16 v[234:235], v10 offset:6144
  ds_read_b64_tr_b16 v[238:239], v11 offset:6144
  s_waitcnt vmcnt(0)
  ds_read_b64_tr_b16 v[240:241], v12 offset:0
  ds_read_b64_tr_b16 v[244:245], v13 offset:0
  ds_read_b64_tr_b16 v[248:249], v14 offset:0
  ds_read_b64_tr_b16 v[252:253], v15 offset:0
  ds_read_b64_tr_b16 v[242:243], v12 offset:2048
  ds_read_b64_tr_b16 v[246:247], v13 offset:2048
  ds_read_b64_tr_b16 v[250:251], v14 offset:2048
  ds_read_b64_tr_b16 v[254:255], v15 offset:2048
  s_mov_b32 s52, s72
  s_and_b32 s53, s73, 0xffff
  s_mul_i32 s32, s38, 917504
  s_lshl_b32 s33, s28, 7
  s_add_u32 s32, s32, s33
  s_waitcnt lgkmcnt(0)
  v_mov_b32 v8, v16
  v_mov_b32 v9, v17
  v_mov_b32 v10, v18
  v_mov_b32 v11, v19
  s_mul_i32 s49, s38, 14336
  v_add_u32 v6, s49, v7
  s_cmp_lt_u32 s25, 28
  s_cbranch_scc1 L_g1
  s_barrier
  s_add_u32 m0, s40, 0
  s_add_u32 s33, s32, 0
  buffer_load_dwordx4 v4, s[52:55], s33 offen lds
  s_add_u32 m0, s40, 1024
  s_add_u32 s33, s32, 32768
  buffer_load_dwordx4 v4, s[52:55], s33 offen lds
  s_add_u32 m0, s40, 2048
  s_add_u32 s33, s32, 65536
  buffer_load_dwordx4 v4, s[52:55], s33 offen lds
  s_add_u32 m0, s40, 3072
  s_add_u32 s33, s32, 98304
  buffer_load_dwordx4 v4, s[52:55], s33 offen lds
  s_add_u32 m0, s40, 4096
  s_add_u32 s33, s32, 131072
  buffer_load_dwordx4 v4, s[52:55], s33 offen lds
  s_add_u32 m0, s40, 5120
  s_add_u32 s33, s32, 163840
  buffer_load_dwordx4 v4, s[52:55], s33 offen lds
  s_branch L_g2a
L_g1:
  s_mov_b32 s14, 0xe00
  s_mov_b32 s15, 0x20000
  s_mov_b32 s12, s70
  s_and_b32 s13, s71, 0xffff
  s_mov_b32 s42, 0xc0135761
  s_mov_b32 s43, s42
  s_mov_b32 s44, 0xbdd2d3e8
  s_mov_b32 s45, s44
  s_cmp_eq_u32 s29, 3
  s_cselect_b32 s41, 8, 16
  v_cmp_gt_u32 vcc, s41, v2
  v_mov_b32 v20, 0x40000000
  s_nop 0
  v_cndmask_b32 v5, v20, v16, vcc
  s_mul_i32 s41, s26, 28
  s_add_u32 s41, s41, s27
  s_mul_i32 s41, s41, 7168
  s_mul_i32 s34, s30, 3584
  s_add_u32 s41, s41, s34
  s_add_u32 s41, s41, 0x800000
  s_lshl_b32 s39, s27, 7
  s_lshl_b32 s34, s30, 6
  s_add_u32 s39, s39, s34
  v_lshlrev_b32 v20, 3, v3
  buffer_load_dwordx2 v[12:13], v20, s[12:15], s39 offen
  buffer_load_dwordx2 v[14:15], v20, s[12:15], s39 offen offset:32
  s_lshl_b32 s48, s26, 3
  s_add_u32 s48, s48, s38
  s_mul_i32 s48, s48, 28672
  s_add_u32 s48, s48, 0x600000
  s_sub_u32 s34, s29, 1
  s_and_b32 s34, s34, 3
  s_lshl_b32 s34, s34, 1
  s_xor_b32 s35, s30, 0
  s_add_u32 s34, s34, s35
  s_mul_i32 s34, s34, 14336
  v_add_u32 v16, s34, v7
  s_sub_u32 s34, s29, 2
  s_and_b32 s34, s34, 3
  s_lshl_b32 s34, s34, 1
  s_xor_b32 s35, s30, 0
  s_add_u32 s34, s34, s35
  s_mul_i32 s34, s34, 14336
  v_add_u32 v17, s34, v7
  s_sub_u32 s34, s29, 3
  s_and_b32 s34, s34, 3
  s_lshl_b32 s34, s34, 1
  s_xor_b32 s35, s30, 0
  s_add_u32 s34, s34, s35
  s_mul_i32 s34, s34, 14336
  v_add_u32 v18, s34, v7
  s_sub_u32 s34, s29, 0
  s_and_b32 s34, s34, 3
  s_lshl_b32 s34, s34, 1
  s_xor_b32 s35, s30, 1
  s_add_u32 s34, s34, s35
  s_mul_i32 s34, s34, 14336
  v_add_u32 v19, s34, v7
  s_sub_u32 s34, s29, 1
  s_and_b32 s34, s34, 3
  s_lshl_b32 s34, s34, 1
  s_xor_b32 s35, s30, 1
  s_add_u32 s34, s34, s35
  s_mul_i32 s34, s34, 14336
  v_add_u32 v20, s34, v7
  s_sub_u32 s34, s29, 2
  s_and_b32 s34, s34, 3
  s_lshl_b32 s34, s34, 1
  s_xor_b32 s35, s30, 1
  s_add_u32 s34, s34, s35
  s_mul_i32 s34, s34, 14336
  v_add_u32 v21, s34, v7
  s_sub_u32 s34, s29, 3
  s_and_b32 s34, s34, 3
  s_lshl_b32 s34, s34, 1
  s_xor_b32 s35, s30, 1
  s_add_u32 s34, s34, s35
  s_mul_i32 s34, s34, 14336
  v_add_u32 v22, s34, v7
  v_lshrrev_b32 v24, 2, v2
  v_and_b32 v25, 1, v3
  v_lshl_add_u32 v24, v25, 2, v24
  v_lshrrev_b32 v25, 1, v24
  s_lshl_b32 s34, s30, 1
  v_xor_b32 v25, s34, v25
  v_lshlrev_b32 v24, 7, v24
  v_lshl_add_u32 v24, v25, 5, v24
  v_and_b32 v25, 3, v2
  v_lshl_add_u32 v24, v25, 3, v24
  v_lshrrev_b32 v25, 1, v3
  v_lshl_add_u32 v24, v25, 10, v24
  v_add_u32 v28, s40, v24
  v_xor_b32 v29, 32, v28
  v_xor_b32 v30, 64, v28
  v_xor_b32 v31, 0x60, v28
  s_cmp_lg_u32 s38, 0
  s_cbranch_scc1 L_w2
  s_lshl_b32 s47, s24, 10
  s_add_u32 s47, s47, 0xa30000
  s_mov_b32 s50, 0
L_poll2:
  buffer_load_dwordx4 v[96:99], v7, s[20:23], s47 offen sc1
L_pc2:
  s_waitcnt vmcnt(0)
  v_xor_b32 v96, s58, v96
  v_xor_b32 v97, s58, v97
  v_xor_b32 v98, s58, v98
  v_xor_b32 v99, s58, v99
  v_or3_b32 v96, v96, v97, v98
  v_or_b32 v96, v96, v99
  v_cmp_ne_u32 vcc, 0, v96
  s_nop 0
  s_and_b64 exec, exec, vcc
  s_cbranch_scc0 L_x2
  s_sleep 4
  s_add_u32 s50, s50, 1
  s_cmp_lt_u32 s50, 300000
  s_cbranch_scc1 L_poll2
L_x2:
  s_mov_b64 exec, -1
L_w2:
  s_barrier
  s_mov_b32 s46, 0
L_main1:
  buffer_load_dwordx4 v[32:35], v8, s[20:23], s48 offen sc1
  buffer_load_dwordx4 v[36:39], v9, s[20:23], s48 offen sc1
  buffer_load_dwordx4 v[40:43], v10, s[20:23], s48 offen sc1
  buffer_load_dwordx4 v[44:47], v11, s[20:23], s48 offen sc1
  s_add_u32 s48, s48, 3584
  buffer_load_dwordx4 v[48:51], v8, s[20:23], s48 offen sc1
  buffer_load_dwordx4 v[52:55], v9, s[20:23], s48 offen sc1
  buffer_load_dwordx4 v[56:59], v10, s[20:23], s48 offen sc1
  buffer_load_dwordx4 v[60:63], v11, s[20:23], s48 offen sc1
  s_add_u32 s48, s48, 3584
  s_waitcnt vmcnt(7)
  v_mfma_f32_16x16x32_bf16 v[64:67], v[128:131], v[32:35], 0
  v_mfma_f32_16x16x32_bf16 v[80:83], v[132:135], v[32:35], 0
  v_mfma_f32_16x16x32_bf16 v[96:99], v[136:139], v[32:35], 0
  v_mfma_f32_16x16x32_bf16 v[112:115], v[140:143], v[32:35], 0
  buffer_load_dwordx4 v[32:35], v8, s[20:23], s48 offen sc1
  s_waitcnt vmcnt(7)
  v_mfma_f32_16x16x32_bf16 v[68:71], v[128:131], v[36:39], 0
  v_mfma_f32_16x16x32_bf16 v[84:87], v[132:135], v[36:39], 0
  v_mfma_f32_16x16x32_bf16 v[100:103], v[136:139], v[36:39], 0
  v_mfma_f32_16x16x32_bf16 v[116:119], v[140:143], v[36:39], 0
  buffer_load_dwordx4 v[36:39], v9, s[20:23], s48 offen sc1
  s_waitcnt vmcnt(7)
  v_mfma_f32_16x16x32_bf16 v[72:75], v[128:131], v[40:43], 0
  v_mfma_f32_16x16x32_bf16 v[88:91], v[132:135], v[40:43], 0
  v_mfma_f32_16x16x32_bf16 v[104:107], v[136:139], v[40:43], 0
  v_mfma_f32_16x16x32_bf16 v[120:123], v[140:143], v[40:43], 0
  buffer_load_dwordx4 v[40:43], v10, s[20:23], s48 offen sc1
  s_waitcnt vmcnt(7)
  v_mfma_f32_16x16x32_bf16 v[76:79], v[128:131], v[44:47], 0
  v_mfma_f32_16x16x32_bf16 v[92:95], v[132:135], v[44:47], 0
  v_mfma_f32_16x16x32_bf16 v[108:111], v[136:139], v[44:47], 0
  v_mfma_f32_16x16x32_bf16 v[124:127], v[140:143], v[44:47], 0
  buffer_load_dwordx4 v[44:47], v11, s[20:23], s48 offen sc1
  s_add_u32 s48, s48, 3584
  s_waitcnt vmcnt(7)
  v_mfma_f32_16x16x32_bf16 v[64:67], v[144:147], v[48:51], v[64:67]
  v_mfma_f32_16x16x32_bf16 v[80:83], v[148:151], v[48:51], v[80:83]
  v_mfma_f32_16x16x32_bf16 v[96:99], v[152:155], v[48:51], v[96:99]
  v_mfma_f32_16x16x32_bf16 v[112:115], v[156:159], v[48:51], v[112:115]
  buffer_load_dwordx4 v[48:51], v8, s[20:23], s48 offen sc1
  s_waitcnt vmcnt(7)
  v_mfma_f32_16x16x32_bf16 v[68:71], v[144:147], v[52:55], v[68:71]
  v_mfma_f32_16x16x32_bf16 v[84:87], v[148:151], v[52:55], v[84:87]
  v_mfma_f32_16x16x32_bf16 v[100:103], v[152:155], v[52:55], v[100:103]
  v_mfma_f32_16x16x32_bf16 v[116:119], v[156:159], v[52:55], v[116:119]
  buffer_load_dwordx4 v[52:55], v9, s[20:23], s48 offen sc1
  s_waitcnt vmcnt(7)
  v_mfma_f32_16x16x32_bf16 v[72:75], v[144:147], v[56:59], v[72:75]
  v_mfma_f32_16x16x32_bf16 v[88:91], v[148:151], v[56:59], v[88:91]
  v_mfma_f32_16x16x32_bf16 v[104:107], v[152:155], v[56:59], v[104:107]
  v_mfma_f32_16x16x32_bf16 v[120:123], v[156:159], v[56:59], v[120:123]
  buffer_load_dwordx4 v[56:59], v10, s[20:23], s48 offen sc1
  s_waitcnt vmcnt(7)
  v_mfma_f32_16x16x32_bf16 v[76:79], v[144:147], v[60:63], v[76:79]
  v_mfma_f32_16x16x32_bf16 v[92:95], v[148:151], v[60:63], v[92:95]
  v_mfma_f32_16x16x32_bf16 v[108:111], v[152:155], v[60:63], v[108:111]
  v_mfma_f32_16x16x32_bf16 v[124:127], v[156:159], v[60:63], v[124:127]
  buffer_load_dwordx4 v[60:63], v11, s[20:23], s48 offen sc1
  s_add_u32 s48, s48, 3584
  s_waitcnt vmcnt(7)
  v_mfma_f32_16x16x32_bf16 v[64:67], v[160:163], v[32:35], v[64:67]
  v_mfma_f32_16x16x32_bf16 v[80:83], v[164:167], v[32:35], v[80:83]
  v_mfma_f32_16x16x32_bf16 v[96:99], v[168:171], v[32:35], v[96:99]
  v_mfma_f32_16x16x32_bf16 v[112:115], v[172:175], v[32:35], v[112:115]
  buffer_load_dwordx4 v[32:35], v8, s[20:23], s48 offen sc1
  s_waitcnt vmcnt(7)
  v_mfma_f32_16x16x32_bf16 v[68:71], v[160:163], v[36:39], v[68:71]
  v_mfma_f32_16x16x32_bf16 v[84:87], v[164:167], v[36:39], v[84:87]
  v_mfma_f32_16x16x32_bf16 v[100:103], v[168:171], v[36:39], v[100:103]
  v_mfma_f32_16x16x32_bf16 v[116:119], v[172:175], v[36:39], v[116:119]
  buffer_load_dwordx4 v[36:39], v9, s[20:23], s48 offen sc1
  s_waitcnt vmcnt(7)
  v_mfma_f32_16x16x32_bf16 v[72:75], v[160:163], v[40:43], v[72:75]
  v_mfma_f32_16x16x32_bf16 v[88:91], v[164:167], v[40:43], v[88:91]
  v_mfma_f32_16x16x32_bf16 v[104:107], v[168:171], v[40:43], v[104:107]
  v_mfma_f32_16x16x32_bf16 v[120:123], v[172:175], v[40:43], v[120:123]
  buffer_load_dwordx4 v[40:43], v10, s[20:23], s48 offen sc1
  s_waitcnt vmcnt(7)
  v_mfma_f32_16x16x32_bf16 v[76:79], v[160:163], v[44:47], v[76:79]
  v_mfma_f32_16x16x32_bf16 v[92:95], v[164:167], v[44:47], v[92:95]
  v_mfma_f32_16x16x32_bf16 v[108:111], v[168:171], v[44:47], v[108:111]
  v_mfma_f32_16x16x32_bf16 v[124:127], v[172:175], v[44:47], v[124:127]
  buffer_load_dwordx4 v[44:47], v11, s[20:23], s48 offen sc1
  s_add_u32 s48, s48, 3584
  s_waitcnt vmcnt(7)
  v_mfma_f32_16x16x32_bf16 v[64:67], v[176:179], v[48:51], v[64:67]
  v_mfma_f32_16x16x32_bf16 v[80:83], v[180:183], v[48:51], v[80:83]
  v_mfma_f32_16x16x32_bf16 v[96:99], v[184:187], v[48:51], v[96:99]
  v_mfma_f32_16x16x32_bf16 v[112:115], v[188:191], v[48:51], v[112:115]
  buffer_load_dwordx4 v[48:51], v8, s[20:23], s48 offen sc1
  s_waitcnt vmcnt(7)
  v_mfma_f32_16x16x32_bf16 v[68:71], v[176:179], v[52:55], v[68:71]
  v_mfma_f32_16x16x32_bf16 v[84:87], v[180:183], v[52:55], v[84:87]
  v_mfma_f32_16x16x32_bf16 v[100:103], v[184:187], v[52:55], v[100:103]
  v_mfma_f32_16x16x32_bf16 v[116:119], v[188:191], v[52:55], v[116:119]
  buffer_load_dwordx4 v[52:55], v9, s[20:23], s48 offen sc1
  s_waitcnt vmcnt(7)
  v_mfma_f32_16x16x32_bf16 v[72:75], v[176:179], v[56:59], v[72:75]
  v_mfma_f32_16x16x32_bf16 v[88:91], v[180:183], v[56:59], v[88:91]
  v_mfma_f32_16x16x32_bf16 v[104:107], v[184:187], v[56:59], v[104:107]
  v_mfma_f32_16x16x32_bf16 v[120:123], v[188:191], v[56:59], v[120:123]
  buffer_load_dwordx4 v[56:59], v10, s[20:23], s48 offen sc1
  s_waitcnt vmcnt(7)
  v_mfma_f32_16x16x32_bf16 v[76:79], v[176:179], v[60:63], v[76:79]
  v_mfma_f32_16x16x32_bf16 v[92:95], v[180:183], v[60:63], v[92:95]
  v_mfma_f32_16x16x32_bf16 v[108:111], v[184:187], v[60:63], v[108:111]
  v_mfma_f32_16x16x32_bf16 v[124:127], v[188:191], v[60:63], v[124:127]
  buffer_load_dwordx4 v[60:63], v11, s[20:23], s48 offen sc1
  s_add_u32 s48, s48, 3584
  s_waitcnt vmcnt(7)
  v_mfma_f32_16x16x32_bf16 v[64:67], v[192:195], v[32:35], v[64:67]
  v_mfma_f32_16x16x32_bf16 v[80:83], v[196:199], v[32:35], v[80:83]
  v_mfma_f32_16x16x32_bf16 v[96:99], v[200:203], v[32:35], v[96:99]
  v_mfma_f32_16x16x32_bf16 v[112:115], v[204:207], v[32:35], v[112:115]
  buffer_load_dwordx4 v[32:35], v8, s[20:23], s48 offen sc1
  s_waitcnt vmcnt(7)
  v_mfma_f32_16x16x32_bf16 v[68:71], v[192:195], v[36:39], v[68:71]
  v_mfma_f32_16x16x32_bf16 v[84:87], v[196:199], v[36:39], v[84:87]
  v_mfma_f32_16x16x32_bf16 v[100:103], v[200:203], v[36:39], v[100:103]
  v_mfma_f32_16x16x32_bf16 v[116:119], v[204:207], v[36:39], v[116:119]
  buffer_load_dwordx4 v[36:39], v9, s[20:23], s48 offen sc1
  s_waitcnt vmcnt(7)
  v_mfma_f32_16x16x32_bf16 v[72:75], v[192:195], v[40:43], v[72:75]
  v_mfma_f32_16x16x32_bf16 v[88:91], v[196:199], v[40:43], v[88:91]
  v_mfma_f32_16x16x32_bf16 v[104:107], v[200:203], v[40:43], v[104:107]
  v_mfma_f32_16x16x32_bf16 v[120:123], v[204:207], v[40:43], v[120:123]
  buffer_load_dwordx4 v[40:43], v10, s[20:23], s48 offen sc1
  s_waitcnt vmcnt(7)
  v_mfma_f32_16x16x32_bf16 v[76:79], v[192:195], v[44:47], v[76:79]
  v_mfma_f32_16x16x32_bf16 v[92:95], v[196:199], v[44:47], v[92:95]
  v_mfma_f32_16x16x32_bf16 v[108:111], v[200:203], v[44:47], v[108:111]
  v_mfma_f32_16x16x32_bf16 v[124:127], v[204:207], v[44:47], v[124:127]
  buffer_load_dwordx4 v[44:47], v11, s[20:23], s48 offen sc1
  s_add_u32 s48, s48, 3584
  s_waitcnt vmcnt(7)
  v_mfma_f32_16x16x32_bf16 v[64:67], v[208:211], v[48:51], v[64:67]
  v_mfma_f32_16x16x32_bf16 v[80:83], v[212:215], v[48:51], v[80:83]
  v_mfma_f32_16x16x32_bf16 v[96:99], v[216:219], v[48:51], v[96:99]
  v_mfma_f32_16x16x32_bf16 v[112:115], v[220:223], v[48:51], v[112:115]
  buffer_load_dwordx4 v[48:51], v8, s[20:23], s48 offen sc1
  s_waitcnt vmcnt(7)
  v_mfma_f32_16x16x32_bf16 v[68:71], v[208:211], v[52:55], v[68:71]
  v_mfma_f32_16x16x32_bf16 v[84:87], v[212:215], v[52:55], v[84:87]
  v_mfma_f32_16x16x32_bf16 v[100:103], v[216:219], v[52:55], v[100:103]
  v_mfma_f32_16x16x32_bf16 v[116:119], v[220:223], v[52:55], v[116:119]
  buffer_load_dwordx4 v[52:55], v9, s[20:23], s48 offen sc1
  s_waitcnt vmcnt(7)
  v_mfma_f32_16x16x32_bf16 v[72:75], v[208:211], v[56:59], v[72:75]
  v_mfma_f32_16x16x32_bf16 v[88:91], v[212:215], v[56:59], v[88:91]
  v_mfma_f32_16x16x32_bf16 v[104:107], v[216:219], v[56:59], v[104:107]
  v_mfma_f32_16x16x32_bf16 v[120:123], v[220:223], v[56:59], v[120:123]
  buffer_load_dwordx4 v[56:59], v10, s[20:23], s48 offen sc1
  s_waitcnt vmcnt(7)
  v_mfma_f32_16x16x32_bf16 v[76:79], v[208:211], v[60:63], v[76:79]
  v_mfma_f32_16x16x32_bf16 v[92:95], v[212:215], v[60:63], v[92:95]
  v_mfma_f32_16x16x32_bf16 v[108:111], v[216:219], v[60:63], v[108:111]
  v_mfma_f32_16x16x32_bf16 v[124:127], v[220:223], v[60:63], v[124:127]
  buffer_load_dwordx4 v[60:63], v11, s[20:23], s48 offen sc1
  s_add_u32 s48, s48, 3584
  s_waitcnt vmcnt(7)
  v_mfma_f32_16x16x32_bf16 v[64:67], v[224:227], v[32:35], v[64:67]
  v_mfma_f32_16x16x32_bf16 v[80:83], v[228:231], v[32:35], v[80:83]
  v_mfma_f32_16x16x32_bf16 v[96:99], v[232:235], v[32:35], v[96:99]
  v_mfma_f32_16x16x32_bf16 v[112:115], v[236:239], v[32:35], v[112:115]
  s_add_u32 m0, s40, 0
  s_add_u32 s33, s32, 0
  buffer_load_dwordx4 v4, s[52:55], s33 offen lds
  s_add_u32 m0, s40, 1024
  s_add_u32 s33, s32, 32768
  buffer_load_dwordx4 v4, s[52:55], s33 offen lds
  s_waitcnt vmcnt(8)
  v_mfma_f32_16x16x32_bf16 v[68:71], v[224:227], v[36:39], v[68:71]
  v_mfma_f32_16x16x32_bf16 v[84:87], v[228:231], v[36:39], v[84:87]
  v_mfma_f32_16x16x32_bf16 v[100:103], v[232:235], v[36:39], v[100:103]
  v_mfma_f32_16x16x32_bf16 v[116:119], v[236:239], v[36:39], v[116:119]
  s_add_u32 m0, s40, 2048
  s_add_u32 s33, s32, 65536
  buffer_load_dwordx4 v4, s[52:55], s33 offen lds
  s_add_u32 m0, s40, 3072
  s_add_u32 s33, s32, 98304
  buffer_load_dwordx4 v4, s[52:55], s33 offen lds
  s_waitcnt vmcnt(9)
  v_mfma_f32_16x16x32_bf16 v[72:75], v[224:227], v[40:43], v[72:75]
  v_mfma_f32_16x16x32_bf16 v[88:91], v[228:231], v[40:43], v[88:91]
  v_mfma_f32_16x16x32_bf16 v[104:107], v[232:235], v[40:43], v[104:107]
  v_mfma_f32_16x16x32_bf16 v[120:123], v[236:239], v[40:43], v[120:123]
  s_add_u32 m0, s40, 4096
  s_add_u32 s33, s32, 131072
  buffer_load_dwordx4 v4, s[52:55], s33 offen lds
  s_add_u32 m0, s40, 5120
  s_add_u32 s33, s32, 163840
  buffer_load_dwordx4 v4, s[52:55], s33 offen lds
  s_waitcnt vmcnt(10)
  v_mfma_f32_16x16x32_bf16 v[76:79], v[224:227], v[44:47], v[76:79]
  v_mfma_f32_16x16x32_bf16 v[92:95], v[228:231], v[44:47], v[92:95]
  v_mfma_f32_16x16x32_bf16 v[108:111], v[232:235], v[44:47], v[108:111]
  v_mfma_f32_16x16x32_bf16 v[124:127], v[236:239], v[44:47], v[124:127]
  s_waitcnt vmcnt(6)
  v_mfma_f32_16x16x32_bf16 v[100:103], v[248:251], v[52:55], v[100:103]
  v_mfma_f32_16x16x32_bf16 v[116:119], v[252:255], v[52:55], v[116:119]
  v_mfma_f32_16x16x32_bf16 v[68:71], v[240:243], v[52:55], v[68:71]
  v_mfma_f32_16x16x32_bf16 v[84:87], v[244:247], v[52:55], v[84:87]
  s_waitcnt vmcnt(6)
  v_mfma_f32_16x16x32_bf16 v[104:107], v[248:251], v[56:59], v[104:107]
  v_mfma_f32_16x16x32_bf16 v[120:123], v[252:255], v[56:59], v[120:123]
  v_mfma_f32_16x16x32_bf16 v[72:75], v[240:243], v[56:59], v[72:75]
  v_mfma_f32_16x16x32_bf16 v[88:91], v[244:247], v[56:59], v[88:91]
  ds_write_b128 v6, v[100:103] offset:8192
  ds_write_b128 v6, v[116:119] offset:9216
  ds_write_b128 v6, v[68:71] offset:0
  ds_write_b128 v6, v[84:87] offset:1024
  s_waitcnt vmcnt(6)
  v_mfma_f32_16x16x32_bf16 v[108:111], v[248:251], v[60:63], v[108:111]
  v_mfma_f32_16x16x32_bf16 v[124:127], v[252:255], v[60:63], v[124:127]
  v_mfma_f32_16x16x32_bf16 v[76:79], v[240:243], v[60:63], v[76:79]
  v_mfma_f32_16x16x32_bf16 v[92:95], v[244:247], v[60:63], v[92:95]
  ds_write_b128 v6, v[104:107] offset:10240
  ds_write_b128 v6, v[120:123] offset:11264
  ds_write_b128 v6, v[72:75] offset:2048
  ds_write_b128 v6, v[88:91] offset:3072
  s_waitcnt vmcnt(6)
  v_mfma_f32_16x16x32_bf16 v[96:99], v[248:251], v[48:51], v[96:99]
  v_mfma_f32_16x16x32_bf16 v[112:115], v[252:255], v[48:51], v[112:115]
  v_mfma_f32_16x16x32_bf16 v[64:67], v[240:243], v[48:51], v[64:67]
  v_mfma_f32_16x16x32_bf16 v[80:83], v[244:247], v[48:51], v[80:83]
  ds_write_b128 v6, v[108:111] offset:12288
  ds_write_b128 v6, v[124:127] offset:13312
  ds_write_b128 v6, v[76:79] offset:4096
  ds_write_b128 v6, v[92:95] offset:5120
  s_nop 0
  ds_write_b128 v6, v[96:99] offset:6144
  ds_write_b128 v6, v[112:115] offset:7168
  v_pk_add_f32 v[32:33], v[64:65], v[66:67]
  v_pk_add_f32 v[34:35], v[68:69], v[70:71]
  v_pk_add_f32 v[36:37], v[72:73], v[74:75]
  v_pk_add_f32 v[38:39], v[76:77], v[78:79]
  v_pk_add_f32 v[32:33], v[32:33], v[34:35]
  v_pk_add_f32 v[36:37], v[36:37], v[38:39]
  v_pk_add_f32 v[32:33], v[32:33], v[36:37]
  v_cmp_u_f32 vcc, v32, v33
  s_nop 4
  s_cbranch_vccz L_good1
  s_add_u32 s46, s46, 1
  s_cmp_gt_u32 s46, 200
  s_cbranch_scc1 L_good1
  s_waitcnt vmcnt(0) lgkmcnt(0)
  s_lshl_b32 s48, s26, 3
  s_add_u32 s48, s48, s38
  s_mul_i32 s48, s48, 28672
  s_add_u32 s48, s48, 0x600000
  s_branch L_main1
L_good1:
  s_waitcnt lgkmcnt(0)
  s_barrier
  ds_read_b128 v[32:35], v16 offset:0
  ds_read_b128 v[36:39], v16 offset:1024
  ds_read_b128 v[40:43], v17 offset:2048
  ds_read_b128 v[44:47], v17 offset:3072
  ds_read_b128 v[48:51], v18 offset:4096
  ds_read_b128 v[52:55], v18 offset:5120
  ds_read_b128 v[56:59], v19 offset:6144
  ds_read_b128 v[60:63], v19 offset:7168
  ds_read_b128 v[96:99], v20 offset:8192
  ds_read_b128 v[100:103], v20 offset:9216
  ds_read_b128 v[104:107], v21 offset:10240
  ds_read_b128 v[108:111], v21 offset:11264
  ds_read_b128 v[112:115], v22 offset:12288
  ds_read_b128 v[116:119], v22 offset:13312
  v_mov_b32 v68, v80
  v_mov_b32 v69, v81
  v_mov_b32 v70, v82
  v_mov_b32 v71, v83
  s_waitcnt lgkmcnt(12)
  v_pk_add_f32 v[64:65], v[64:65], v[32:33]
  v_pk_add_f32 v[66:67], v[66:67], v[34:35]
  v_pk_add_f32 v[68:69], v[68:69], v[36:37]
  v_pk_add_f32 v[70:71], v[70:71], v[38:39]
  s_waitcnt lgkmcnt(10)
  v_pk_add_f32 v[64:65], v[64:65], v[40:41]
  v_pk_add_f32 v[66:67], v[66:67], v[42:43]
  v_pk_add_f32 v[68:69], v[68:69], v[44:45]
  v_pk_add_f32 v[70:71], v[70:71], v[46:47]
  s_waitcnt lgkmcnt(8)
  v_pk_add_f32 v[64:65], v[64:65], v[48:49]
  v_pk_add_f32 v[66:67], v[66:67], v[50:51]
  v_pk_add_f32 v[68:69], v[68:69], v[52:53]
  v_pk_add_f32 v[70:71], v[70:71], v[54:55]
  s_waitcnt lgkmcnt(6)
  v_pk_add_f32 v[64:65], v[64:65], v[56:57]
  v_pk_add_f32 v[66:67], v[66:67], v[58:59]
  v_pk_add_f32 v[68:69], v[68:69], v[60:61]
  v_pk_add_f32 v[70:71], v[70:71], v[62:63]
  s_waitcnt lgkmcnt(4)
  v_pk_add_f32 v[64:65], v[64:65], v[96:97]
  v_pk_add_f32 v[66:67], v[66:67], v[98:99]
  v_pk_add_f32 v[68:69], v[68:69], v[100:101]
  v_pk_add_f32 v[70:71], v[70:71], v[102:103]
  s_waitcnt lgkmcnt(2)
  v_pk_add_f32 v[64:65], v[64:65], v[104:105]
  v_pk_add_f32 v[66:67], v[66:67], v[106:107]
  v_pk_add_f32 v[68:69], v[68:69], v[108:109]
  v_pk_add_f32 v[70:71], v[70:71], v[110:111]
  s_waitcnt lgkmcnt(0)
  v_pk_add_f32 v[64:65], v[64:65], v[112:113]
  v_pk_add_f32 v[66:67], v[66:67], v[114:115]
  v_pk_add_f32 v[68:69], v[68:69], v[116:117]
  v_pk_add_f32 v[70:71], v[70:71], v[118:119]
  v_cvt_pk_bf16_f32 v72, v64, v65
  v_cvt_pk_bf16_f32 v73, v66, v67
  v_cvt_pk_bf16_f32 v74, v68, v69
  v_cvt_pk_bf16_f32 v75, v70, v71
  v_lshlrev_b32 v64, 16, v72
  v_and_b32 v65, s59, v72
  v_lshlrev_b32 v66, 16, v73
  v_and_b32 v67, s59, v73
  v_lshlrev_b32 v68, 16, v74
  v_and_b32 v69, s59, v74
  v_lshlrev_b32 v70, 16, v75
  v_and_b32 v71, s59, v75
  v_mov_b32 v92, s42
  v_mov_b32 v93, s42
  s_waitcnt vmcnt(0)
  ds_read_b64_tr_b16 v[128:129], v28 offset:0
  ds_read_b64_tr_b16 v[132:133], v29 offset:0
  ds_read_b64_tr_b16 v[136:137], v30 offset:0
  ds_read_b64_tr_b16 v[140:141], v31 offset:0
  ds_read_b64_tr_b16 v[130:131], v28 offset:2048
  ds_read_b64_tr_b16 v[134:135], v29 offset:2048
  ds_read_b64_tr_b16 v[138:139], v30 offset:2048
  ds_read_b64_tr_b16 v[142:143], v31 offset:2048
  ds_read_b64_tr_b16 v[144:145], v28 offset:4096
  ds_read_b64_tr_b16 v[148:149], v29 offset:4096
  ds_read_b64_tr_b16 v[152:153], v30 offset:4096
  ds_read_b64_tr_b16 v[156:157], v31 offset:4096
  v_lshlrev_b32 v80, 16, v12
  v_and_b32 v81, s59, v12
  v_lshlrev_b32 v82, 16, v13
  v_and_b32 v83, s59, v13
  v_lshlrev_b32 v84, 16, v14
  v_and_b32 v85, s59, v14
  v_lshlrev_b32 v86, 16, v15
  v_and_b32 v87, s59, v15
  v_pk_add_f32 v[64:65], v[64:65], v[80:81]
  v_pk_add_f32 v[66:67], v[66:67], v[82:83]
  v_pk_add_f32 v[68:69], v[68:69], v[84:85]
  v_pk_add_f32 v[70:71], v[70:71], v[86:87]
  v_cvt_pk_bf16_f32 v72, v64, v65
  v_cvt_pk_bf16_f32 v73, v66, v67
  v_cvt_pk_bf16_f32 v74, v68, v69
  v_cvt_pk_bf16_f32 v75, v70, v71
  v_lshlrev_b32 v64, 16, v72
  v_and_b32 v65, s59, v72
  v_lshlrev_b32 v66, 16, v73
  v_and_b32 v67, s59, v73
  v_lshlrev_b32 v68, 16, v74
  v_and_b32 v69, s59, v74
  v_lshlrev_b32 v70, 16, v75
  v_and_b32 v71, s59, v75
  s_waitcnt lgkmcnt(0)
  s_add_u32 m0, s40, 0
  s_add_u32 s33, s32, 655360
  buffer_load_dwordx4 v4, s[52:55], s33 offen lds
  v_pk_mul_f32 v[80:81], v[64:65], v[64:65]
  v_pk_mul_f32 v[82:83], v[66:67], v[66:67]
  v_pk_mul_f32 v[84:85], v[68:69], v[68:69]
  v_pk_mul_f32 v[86:87], v[70:71], v[70:71]
  v_pk_fma_f32 v[80:81], v[80:81], s[44:45], v[92:93]
  v_pk_fma_f32 v[82:83], v[82:83], s[44:45], v[92:93]
  v_pk_fma_f32 v[84:85], v[84:85], s[44:45], v[92:93]
  v_pk_fma_f32 v[86:87], v[86:87], s[44:45], v[92:93]
  s_add_u32 m0, s40, 1024
  s_add_u32 s33, s32, 688128
  buffer_load_dwordx4 v4, s[52:55], s33 offen lds
  v_pk_mul_f32 v[80:81], v[80:81], v[64:65]
  v_pk_mul_f32 v[82:83], v[82:83], v[66:67]
  v_pk_mul_f32 v[84:85], v[84:85], v[68:69]
  v_pk_mul_f32 v[86:87], v[86:87], v[70:71]
  v_exp_f32 v80, v80
  v_exp_f32 v81, v81
  v_exp_f32 v82, v82
  s_add_u32 m0, s40, 2048
  s_add_u32 s33, s32, 720896
  buffer_load_dwordx4 v4, s[52:55], s33 offen lds
  v_exp_f32 v83, v83
  v_exp_f32 v84, v84
  v_exp_f32 v85, v85
  v_exp_f32 v86, v86
  v_exp_f32 v87, v87
  v_add_f32 v80, 1.0, v80
  v_add_f32 v81, 1.0, v81
  s_add_u32 m0, s40, 3072
  s_add_u32 s33, s32, 753664
  buffer_load_dwordx4 v4, s[52:55], s33 offen lds
  v_add_f32 v82, 1.0, v82
  v_add_f32 v83, 1.0, v83
  v_add_f32 v84, 1.0, v84
  v_add_f32 v85, 1.0, v85
  v_add_f32 v86, 1.0, v86
  v_add_f32 v87, 1.0, v87
  v_rcp_f32 v80, v80
  v_rcp_f32 v81, v81
  s_add_u32 m0, s40, 4096
  s_add_u32 s33, s32, 786432
  buffer_load_dwordx4 v4, s[52:55], s33 offen lds
  v_rcp_f32 v82, v82
  v_rcp_f32 v83, v83
  v_rcp_f32 v84, v84
  v_rcp_f32 v85, v85
  v_rcp_f32 v86, v86
  v_rcp_f32 v87, v87
  v_pk_mul_f32 v[64:65], v[64:65], v[80:81]
  s_add_u32 m0, s40, 5120
  s_add_u32 s33, s32, 819200
  buffer_load_dwordx4 v4, s[52:55], s33 offen lds
  v_pk_mul_f32 v[66:67], v[66:67], v[82:83]
  v_pk_mul_f32 v[68:69], v[68:69], v[84:85]
  v_pk_mul_f32 v[70:71], v[70:71], v[86:87]
  v_cvt_pk_bf16_f32 v72, v64, v65
  v_cvt_pk_bf16_f32 v73, v66, v67
  v_cvt_pk_bf16_f32 v74, v68, v69
  v_cvt_pk_bf16_f32 v75, v70, v71
  buffer_store_dwordx4 v[72:75], v5, s[20:23], s41 offen sc1
  s_waitcnt vmcnt(7) lgkmcnt(0)
  s_barrier
  s_cmp_lg_u32 s38, 0
  s_cbranch_scc1 L_pub3
  s_lshl_b32 s47, s26, 7
  s_lshl_b32 s41, s27, 2
  s_add_u32 s47, s47, s41
  s_add_u32 s47, s47, 0xa40000
  v_mov_b32 v26, s58
  v_lshlrev_b32 v27, 10, v1
  s_mov_b64 exec, 15
  buffer_store_dword v26, v27, s[20:23], s47 offen sc1
  s_mov_b64 exec, -1
L_pub3:
  s_branch L_g2b
L_g2a:
  v_lshrrev_b32 v24, 2, v2
  v_and_b32 v25, 1, v3
  v_lshl_add_u32 v24, v25, 2, v24
  v_lshrrev_b32 v25, 1, v24
  s_lshl_b32 s34, s30, 1
  v_xor_b32 v25, s34, v25
  v_lshlrev_b32 v24, 7, v24
  v_lshl_add_u32 v24, v25, 5, v24
  v_and_b32 v25, 3, v2
  v_lshl_add_u32 v24, v25, 3, v24
  v_lshrrev_b32 v25, 1, v3
  v_lshl_add_u32 v24, v25, 10, v24
  v_add_u32 v28, s40, v24
  v_xor_b32 v29, 32, v28
  v_xor_b32 v30, 64, v28
  v_xor_b32 v31, 0x60, v28
  s_waitcnt vmcnt(0)
  ds_read_b64_tr_b16 v[128:129], v28 offset:0
  ds_read_b64_tr_b16 v[132:133], v29 offset:0
  ds_read_b64_tr_b16 v[136:137], v30 offset:0
  ds_read_b64_tr_b16 v[140:141], v31 offset:0
  ds_read_b64_tr_b16 v[130:131], v28 offset:2048
  ds_read_b64_tr_b16 v[134:135], v29 offset:2048
  ds_read_b64_tr_b16 v[138:139], v30 offset:2048
  ds_read_b64_tr_b16 v[142:143], v31 offset:2048
  ds_read_b64_tr_b16 v[144:145], v28 offset:4096
  ds_read_b64_tr_b16 v[148:149], v29 offset:4096
  ds_read_b64_tr_b16 v[152:153], v30 offset:4096
  ds_read_b64_tr_b16 v[156:157], v31 offset:4096
  s_waitcnt lgkmcnt(0)
  s_add_u32 m0, s40, 0
  s_add_u32 s33, s32, 655360
  buffer_load_dwordx4 v4, s[52:55], s33 offen lds
  s_add_u32 m0, s40, 1024
  s_add_u32 s33, s32, 688128
  buffer_load_dwordx4 v4, s[52:55], s33 offen lds
  s_add_u32 m0, s40, 2048
  s_add_u32 s33, s32, 720896
  buffer_load_dwordx4 v4, s[52:55], s33 offen lds
  s_add_u32 m0, s40, 3072
  s_add_u32 s33, s32, 753664
  buffer_load_dwordx4 v4, s[52:55], s33 offen lds
  s_add_u32 m0, s40, 4096
  s_add_u32 s33, s32, 786432
  buffer_load_dwordx4 v4, s[52:55], s33 offen lds
  s_add_u32 m0, s40, 5120
  s_add_u32 s33, s32, 819200
  buffer_load_dwordx4 v4, s[52:55], s33 offen lds
L_g2b:
  s_mul_i32 s36, s38, 14336
  s_add_u32 m0, s36, 0
  s_add_u32 s33, s32, 196608
  buffer_load_dwordx4 v4, s[52:55], s33 offen lds
  s_add_u32 m0, s36, 1024
  s_add_u32 s33, s32, 229376
  buffer_load_dwordx4 v4, s[52:55], s33 offen lds
  s_add_u32 m0, s36, 2048
  s_add_u32 s33, s32, 262144
  buffer_load_dwordx4 v4, s[52:55], s33 offen lds
  s_add_u32 m0, s36, 3072
  s_add_u32 s33, s32, 294912
  buffer_load_dwordx4 v4, s[52:55], s33 offen lds
  s_add_u32 m0, s36, 4096
  s_add_u32 s33, s32, 327680
  buffer_load_dwordx4 v4, s[52:55], s33 offen lds
  s_add_u32 m0, s36, 5120
  s_add_u32 s33, s32, 360448
  buffer_load_dwordx4 v4, s[52:55], s33 offen lds
  s_add_u32 m0, s36, 6144
  s_add_u32 s33, s32, 393216
  buffer_load_dwordx4 v4, s[52:55], s33 offen lds
  s_add_u32 m0, s36, 7168
  s_add_u32 s33, s32, 425984
  buffer_load_dwordx4 v4, s[52:55], s33 offen lds
  s_add_u32 m0, s36, 8192
  s_add_u32 s33, s32, 458752
  buffer_load_dwordx4 v4, s[52:55], s33 offen lds
  s_add_u32 m0, s36, 9216
  s_add_u32 s33, s32, 491520
  buffer_load_dwordx4 v4, s[52:55], s33 offen lds
  s_add_u32 m0, s36, 10240
  s_add_u32 s33, s32, 524288
  buffer_load_dwordx4 v4, s[52:55], s33 offen lds
  s_add_u32 m0, s36, 11264
  s_add_u32 s33, s32, 557056
  buffer_load_dwordx4 v4, s[52:55], s33 offen lds
  s_add_u32 m0, s36, 12288
  s_add_u32 s33, s32, 589824
  buffer_load_dwordx4 v4, s[52:55], s33 offen lds
  s_add_u32 m0, s36, 13312
  s_add_u32 s33, s32, 622592
  buffer_load_dwordx4 v4, s[52:55], s33 offen lds
  v_lshrrev_b32 v24, 2, v2
  v_and_b32 v25, 1, v3
  v_lshl_add_u32 v24, v25, 2, v24
  v_lshrrev_b32 v25, 1, v24
  s_lshl_b32 s34, s30, 1
  v_xor_b32 v25, s34, v25
  v_lshlrev_b32 v24, 7, v24
  v_lshl_add_u32 v24, v25, 5, v24
  v_and_b32 v25, 3, v2
  v_lshl_add_u32 v24, v25, 3, v24
  v_lshrrev_b32 v25, 1, v3
  v_lshl_add_u32 v24, v25, 10, v24
  v_add_u32 v16, s36, v24
  v_xor_b32 v17, 32, v16
  v_xor_b32 v18, 64, v16
  v_xor_b32 v19, 0x60, v16
  s_mov_b32 s14, 0x1000
  s_mov_b32 s15, 0x20000
  s_mov_b32 s12, s74
  s_and_b32 s13, s75, 0xffff
  s_mov_b32 s18, 0x1c0000
  s_mov_b32 s19, 0x20000
  s_mov_b32 s16, s64
  s_and_b32 s17, s65, 0xffff
  s_lshl_b32 s39, s28, 7
  s_lshl_b32 s34, s30, 6
  s_add_u32 s39, s39, s34
  v_mul_u32_u24 v5, 896, v2
  v_lshl_add_u32 v5, v3, 3, v5
  s_cmp_eq_u32 s29, 3
  s_cselect_b32 s41, 32, 64
  v_cmp_gt_u32 vcc, s41, v1
  v_mov_b32 v20, 0x40000000
  s_nop 0
  v_cndmask_b32 v5, v20, v5, vcc
  s_lshl_b32 s44, s28, 6
  s_lshl_b32 s41, s30, 5
  s_add_u32 s44, s44, s41
  s_mul_i32 s44, s44, 896
  s_mul_i32 s41, s26, 112
  s_add_u32 s44, s44, s41
  s_lshl_b32 s41, s29, 5
  s_add_u32 s44, s44, s41
  s_add_u32 s45, s44, 14336
  s_add_u32 s41, s44, 0x400000
  s_add_u32 s42, s45, 0x400000
  s_lshl_b32 s48, s26, 3
  s_add_u32 s48, s48, s38
  s_mul_i32 s48, s48, 25088
  s_add_u32 s48, s48, 0x800000
  s_waitcnt vmcnt(14)
  ds_read_b64_tr_b16 v[208:209], v28 offset:0
  ds_read_b64_tr_b16 v[212:213], v29 offset:0
  ds_read_b64_tr_b16 v[216:217], v30 offset:0
  ds_read_b64_tr_b16 v[220:221], v31 offset:0
  ds_read_b64_tr_b16 v[210:211], v28 offset:2048
  ds_read_b64_tr_b16 v[214:215], v29 offset:2048
  ds_read_b64_tr_b16 v[218:219], v30 offset:2048
  ds_read_b64_tr_b16 v[222:223], v31 offset:2048
  ds_read_b64_tr_b16 v[224:225], v28 offset:4096
  ds_read_b64_tr_b16 v[228:229], v29 offset:4096
  ds_read_b64_tr_b16 v[232:233], v30 offset:4096
  ds_read_b64_tr_b16 v[236:237], v31 offset:4096
  s_waitcnt lgkmcnt(0)
  s_add_u32 m0, s40, 0
  s_add_u32 s33, s32, 851968
  buffer_load_dwordx4 v4, s[52:55], s33 offen lds
  s_add_u32 m0, s40, 1024
  s_add_u32 s33, s32, 884736
  buffer_load_dwordx4 v4, s[52:55], s33 offen lds
  s_waitcnt vmcnt(10)
  ds_read_b64_tr_b16 v[146:147], v16 offset:0
  ds_read_b64_tr_b16 v[150:151], v17 offset:0
  ds_read_b64_tr_b16 v[154:155], v18 offset:0
  ds_read_b64_tr_b16 v[158:159], v19 offset:0
  ds_read_b64_tr_b16 v[160:161], v16 offset:2048
  ds_read_b64_tr_b16 v[164:165], v17 offset:2048
  ds_read_b64_tr_b16 v[168:169], v18 offset:2048
  ds_read_b64_tr_b16 v[172:173], v19 offset:2048
  ds_read_b64_tr_b16 v[162:163], v16 offset:4096
  ds_read_b64_tr_b16 v[166:167], v17 offset:4096
  ds_read_b64_tr_b16 v[170:171], v18 offset:4096
  ds_read_b64_tr_b16 v[174:175], v19 offset:4096
  s_waitcnt vmcnt(2)
  ds_read_b64_tr_b16 v[176:177], v16 offset:6144
  ds_read_b64_tr_b16 v[180:181], v17 offset:6144
  ds_read_b64_tr_b16 v[184:185], v18 offset:6144
  ds_read_b64_tr_b16 v[188:189], v19 offset:6144
  ds_read_b64_tr_b16 v[178:179], v16 offset:8192
  ds_read_b64_tr_b16 v[182:183], v17 offset:8192
  ds_read_b64_tr_b16 v[186:187], v18 offset:8192
  ds_read_b64_tr_b16 v[190:191], v19 offset:8192
  ds_read_b64_tr_b16 v[192:193], v16 offset:10240
  ds_read_b64_tr_b16 v[196:197], v17 offset:10240
  ds_read_b64_tr_b16 v[200:201], v18 offset:10240
  ds_read_b64_tr_b16 v[204:205], v19 offset:10240
  ds_read_b64_tr_b16 v[194:195], v16 offset:12288
  ds_read_b64_tr_b16 v[198:199], v17 offset:12288
  ds_read_b64_tr_b16 v[202:203], v18 offset:12288
  ds_read_b64_tr_b16 v[206:207], v19 offset:12288
  s_waitcnt vmcnt(0)
  ds_read_b64_tr_b16 v[226:227], v28 offset:0
  ds_read_b64_tr_b16 v[230:231], v29 offset:0
  ds_read_b64_tr_b16 v[234:235], v30 offset:0
  ds_read_b64_tr_b16 v[238:239], v31 offset:0
  s_waitcnt lgkmcnt(0)
  s_sub_u32 s34, s29, 1
  s_and_b32 s34, s34, 3
  s_lshl_b32 s34, s34, 1
  s_xor_b32 s35, s30, 0
  s_add_u32 s34, s34, s35
  s_mul_i32 s34, s34, 14336
  v_add_u32 v16, s34, v7
  s_sub_u32 s34, s29, 2
  s_and_b32 s34, s34, 3
  s_lshl_b32 s34, s34, 1
  s_xor_b32 s35, s30, 0
  s_add_u32 s34, s34, s35
  s_mul_i32 s34, s34, 14336
  v_add_u32 v17, s34, v7
  s_sub_u32 s34, s29, 3
  s_and_b32 s34, s34, 3
  s_lshl_b32 s34, s34, 1
  s_xor_b32 s35, s30, 0
  s_add_u32 s34, s34, s35
  s_mul_i32 s34, s34, 14336
  v_add_u32 v18, s34, v7
  s_sub_u32 s34, s29, 0
  s_and_b32 s34, s34, 3
  s_lshl_b32 s34, s34, 1
  s_xor_b32 s35, s30, 1
  s_add_u32 s34, s34, s35
  s_mul_i32 s34, s34, 14336
  v_add_u32 v19, s34, v7
  s_sub_u32 s34, s29, 1
  s_and_b32 s34, s34, 3
  s_lshl_b32 s34, s34, 1
  s_xor_b32 s35, s30, 1
  s_add_u32 s34, s34, s35
  s_mul_i32 s34, s34, 14336
  v_add_u32 v20, s34, v7
  s_sub_u32 s34, s29, 2
  s_and_b32 s34, s34, 3
  s_lshl_b32 s34, s34, 1
  s_xor_b32 s35, s30, 1
  s_add_u32 s34, s34, s35
  s_mul_i32 s34, s34, 14336
  v_add_u32 v21, s34, v7
  s_sub_u32 s34, s29, 3
  s_and_b32 s34, s34, 3
  s_lshl_b32 s34, s34, 1
  s_xor_b32 s35, s30, 1
  s_add_u32 s34, s34, s35
  s_mul_i32 s34, s34, 14336
  v_add_u32 v22, s34, v7
  s_cmp_lg_u32 s38, 0
  s_cbranch_scc1 L_w3
  s_lshl_b32 s47, s31, 10
  s_lshl_b32 s34, s26, 7
  s_add_u32 s47, s47, s34
  s_add_u32 s47, s47, 0xa40000
  s_mov_b32 s50, 0
  s_mov_b64 exec, 127
L_poll3:
  buffer_load_dwordx4 v[96:99], v7, s[20:23], s47 offen sc1
L_pc3:
  s_waitcnt vmcnt(0)
  v_xor_b32 v96, s58, v96
  v_xor_b32 v97, s58, v97
  v_xor_b32 v98, s58, v98
  v_xor_b32 v99, s58, v99
  v_or3_b32 v96, v96, v97, v98
  v_or_b32 v96, v96, v99
  v_cmp_ne_u32 vcc, 0, v96
  s_nop 0
  s_and_b64 exec, exec, vcc
  s_cbranch_scc0 L_x3
  s_sleep 4
  s_add_u32 s50, s50, 1
  s_cmp_lt_u32 s50, 300000
  s_cbranch_scc1 L_poll3
L_x3:
  s_mov_b64 exec, -1
L_w3:
  s_barrier
  s_mov_b32 s46, 0
L_main2:
  buffer_load_dwordx4 v[32:35], v8, s[20:23], s48 offen sc1
  buffer_load_dwordx4 v[36:39], v9, s[20:23], s48 offen sc1
  buffer_load_dwordx4 v[40:43], v10, s[20:23], s48 offen sc1
  buffer_load_dwordx4 v[44:47], v11, s[20:23], s48 offen sc1
  s_add_u32 s48, s48, 3584
  buffer_load_dwordx4 v[48:51], v8, s[20:23], s48 offen sc1
  buffer_load_dwordx4 v[52:55], v9, s[20:23], s48 offen sc1
  buffer_load_dwordx4 v[56:59], v10, s[20:23], s48 offen sc1
  buffer_load_dwordx4 v[60:63], v11, s[20:23], s48 offen sc1
  s_add_u32 s48, s48, 3584
  v_lshlrev_b32 v12, 1, v2
  buffer_load_dwordx2 v[244:245], v5, s[20:23], s41 offen sc1
  buffer_load_dwordx2 v[246:247], v5, s[20:23], s42 offen sc1
  buffer_load_ushort v248, v12, s[12:15], s39 offen
  buffer_load_ushort v249, v12, s[12:15], s39 offen offset:32
  s_waitcnt vmcnt(11)
  v_mfma_f32_16x16x32_bf16 v[64:67], v[32:35], v[128:131], 0
  v_mfma_f32_16x16x32_bf16 v[80:83], v[32:35], v[132:135], 0
  v_mfma_f32_16x16x32_bf16 v[96:99], v[32:35], v[136:139], 0
  v_mfma_f32_16x16x32_bf16 v[112:115], v[32:35], v[140:143], 0
  buffer_load_dwordx4 v[32:35], v8, s[20:23], s48 offen sc1
  s_waitcnt vmcnt(11)
  v_mfma_f32_16x16x32_bf16 v[68:71], v[36:39], v[128:131], 0
  v_mfma_f32_16x16x32_bf16 v[84:87], v[36:39], v[132:135], 0
  v_mfma_f32_16x16x32_bf16 v[100:103], v[36:39], v[136:139], 0
  v_mfma_f32_16x16x32_bf16 v[116:119], v[36:39], v[140:143], 0
  buffer_load_dwordx4 v[36:39], v9, s[20:23], s48 offen sc1
  s_waitcnt vmcnt(11)
  v_mfma_f32_16x16x32_bf16 v[72:75], v[40:43], v[128:131], 0
  v_mfma_f32_16x16x32_bf16 v[88:91], v[40:43], v[132:135], 0
  v_mfma_f32_16x16x32_bf16 v[104:107], v[40:43], v[136:139], 0
  v_mfma_f32_16x16x32_bf16 v[120:123], v[40:43], v[140:143], 0
  buffer_load_dwordx4 v[40:43], v10, s[20:23], s48 offen sc1
  s_waitcnt vmcnt(11)
  v_mfma_f32_16x16x32_bf16 v[76:79], v[44:47], v[128:131], 0
  v_mfma_f32_16x16x32_bf16 v[92:95], v[44:47], v[132:135], 0
  v_mfma_f32_16x16x32_bf16 v[108:111], v[44:47], v[136:139], 0
  v_mfma_f32_16x16x32_bf16 v[124:127], v[44:47], v[140:143], 0
  buffer_load_dwordx4 v[44:47], v11, s[20:23], s48 offen sc1
  s_add_u32 s48, s48, 3584
  s_waitcnt vmcnt(11)
  v_mfma_f32_16x16x32_bf16 v[64:67], v[48:51], v[144:147], v[64:67]
  v_mfma_f32_16x16x32_bf16 v[80:83], v[48:51], v[148:151], v[80:83]
  v_mfma_f32_16x16x32_bf16 v[96:99], v[48:51], v[152:155], v[96:99]
  v_mfma_f32_16x16x32_bf16 v[112:115], v[48:51], v[156:159], v[112:115]
  buffer_load_dwordx4 v[48:51], v8, s[20:23], s48 offen sc1
  s_waitcnt vmcnt(11)
  v_mfma_f32_16x16x32_bf16 v[68:71], v[52:55], v[144:147], v[68:71]
  v_mfma_f32_16x16x32_bf16 v[84:87], v[52:55], v[148:151], v[84:87]
  v_mfma_f32_16x16x32_bf16 v[100:103], v[52:55], v[152:155], v[100:103]
  v_mfma_f32_16x16x32_bf16 v[116:119], v[52:55], v[156:159], v[116:119]
  buffer_load_dwordx4 v[52:55], v9, s[20:23], s48 offen sc1
  s_waitcnt vmcnt(11)
  v_mfma_f32_16x16x32_bf16 v[72:75], v[56:59], v[144:147], v[72:75]
  v_mfma_f32_16x16x32_bf16 v[88:91], v[56:59], v[148:151], v[88:91]
  v_mfma_f32_16x16x32_bf16 v[104:107], v[56:59], v[152:155], v[104:107]
  v_mfma_f32_16x16x32_bf16 v[120:123], v[56:59], v[156:159], v[120:123]
  buffer_load_dwordx4 v[56:59], v10, s[20:23], s48 offen sc1
  s_waitcnt vmcnt(11)
  v_mfma_f32_16x16x32_bf16 v[76:79], v[60:63], v[144:147], v[76:79]
  v_mfma_f32_16x16x32_bf16 v[92:95], v[60:63], v[148:151], v[92:95]
  v_mfma_f32_16x16x32_bf16 v[108:111], v[60:63], v[152:155], v[108:111]
  v_mfma_f32_16x16x32_bf16 v[124:127], v[60:63], v[156:159], v[124:127]
  buffer_load_dwordx4 v[60:63], v11, s[20:23], s48 offen sc1
  s_add_u32 s48, s48, 3584
  s_waitcnt vmcnt(7)
  v_mfma_f32_16x16x32_bf16 v[64:67], v[32:35], v[160:163], v[64:67]
  v_mfma_f32_16x16x32_bf16 v[80:83], v[32:35], v[164:167], v[80:83]
  v_mfma_f32_16x16x32_bf16 v[96:99], v[32:35], v[168:171], v[96:99]
  v_mfma_f32_16x16x32_bf16 v[112:115], v[32:35], v[172:175], v[112:115]
  buffer_load_dwordx4 v[32:35], v8, s[20:23], s48 offen sc1
  s_waitcnt vmcnt(7)
  v_mfma_f32_16x16x32_bf16 v[68:71], v[36:39], v[160:163], v[68:71]
  v_mfma_f32_16x16x32_bf16 v[84:87], v[36:39], v[164:167], v[84:87]
  v_mfma_f32_16x16x32_bf16 v[100:103], v[36:39], v[168:171], v[100:103]
  v_mfma_f32_16x16x32_bf16 v[116:119], v[36:39], v[172:175], v[116:119]
  buffer_load_dwordx4 v[36:39], v9, s[20:23], s48 offen sc1
  s_waitcnt vmcnt(7)
  v_mfma_f32_16x16x32_bf16 v[72:75], v[40:43], v[160:163], v[72:75]
  v_mfma_f32_16x16x32_bf16 v[88:91], v[40:43], v[164:167], v[88:91]
  v_mfma_f32_16x16x32_bf16 v[104:107], v[40:43], v[168:171], v[104:107]
  v_mfma_f32_16x16x32_bf16 v[120:123], v[40:43], v[172:175], v[120:123]
  buffer_load_dwordx4 v[40:43], v10, s[20:23], s48 offen sc1
  s_waitcnt vmcnt(7)
  v_mfma_f32_16x16x32_bf16 v[76:79], v[44:47], v[160:163], v[76:79]
  v_mfma_f32_16x16x32_bf16 v[92:95], v[44:47], v[164:167], v[92:95]
  v_mfma_f32_16x16x32_bf16 v[108:111], v[44:47], v[168:171], v[108:111]
  v_mfma_f32_16x16x32_bf16 v[124:127], v[44:47], v[172:175], v[124:127]
  buffer_load_dwordx4 v[44:47], v11, s[20:23], s48 offen sc1
  s_add_u32 s48, s48, 3584
  s_waitcnt vmcnt(7)
  v_mfma_f32_16x16x32_bf16 v[64:67], v[48:51], v[176:179], v[64:67]
  v_mfma_f32_16x16x32_bf16 v[80:83], v[48:51], v[180:183], v[80:83]
  v_mfma_f32_16x16x32_bf16 v[96:99], v[48:51], v[184:187], v[96:99]
  v_mfma_f32_16x16x32_bf16 v[112:115], v[48:51], v[188:191], v[112:115]
  buffer_load_dwordx4 v[48:51], v8, s[20:23], s48 offen sc1
  s_waitcnt vmcnt(7)
  v_mfma_f32_16x16x32_bf16 v[68:71], v[52:55], v[176:179], v[68:71]
  v_mfma_f32_16x16x32_bf16 v[84:87], v[52:55], v[180:183], v[84:87]
  v_mfma_f32_16x16x32_bf16 v[100:103], v[52:55], v[184:187], v[100:103]
  v_mfma_f32_16x16x32_bf16 v[116:119], v[52:55], v[188:191], v[116:119]
  buffer_load_dwordx4 v[52:55], v9, s[20:23], s48 offen sc1
  s_waitcnt vmcnt(7)
  v_mfma_f32_16x16x32_bf16 v[72:75], v[56:59], v[176:179], v[72:75]
  v_mfma_f32_16x16x32_bf16 v[88:91], v[56:59], v[180:183], v[88:91]
  v_mfma_f32_16x16x32_bf16 v[104:107], v[56:59], v[184:187], v[104:107]
  v_mfma_f32_16x16x32_bf16 v[120:123], v[56:59], v[188:191], v[120:123]
  buffer_load_dwordx4 v[56:59], v10, s[20:23], s48 offen sc1
  s_waitcnt vmcnt(7)
  v_mfma_f32_16x16x32_bf16 v[76:79], v[60:63], v[176:179], v[76:79]
  v_mfma_f32_16x16x32_bf16 v[92:95], v[60:63], v[180:183], v[92:95]
  v_mfma_f32_16x16x32_bf16 v[108:111], v[60:63], v[184:187], v[108:111]
  v_mfma_f32_16x16x32_bf16 v[124:127], v[60:63], v[188:191], v[124:127]
  buffer_load_dwordx4 v[60:63], v11, s[20:23], s48 offen sc1
  s_add_u32 s48, s48, 3584
  s_waitcnt vmcnt(7)
  v_mfma_f32_16x16x32_bf16 v[64:67], v[32:35], v[192:195], v[64:67]
  v_mfma_f32_16x16x32_bf16 v[80:83], v[32:35], v[196:199], v[80:83]
  v_mfma_f32_16x16x32_bf16 v[96:99], v[32:35], v[200:203], v[96:99]
  v_mfma_f32_16x16x32_bf16 v[112:115], v[32:35], v[204:207], v[112:115]
  buffer_load_dwordx4 v[32:35], v8, s[20:23], s48 offen sc1
  s_waitcnt vmcnt(7)
  v_mfma_f32_16x16x32_bf16 v[68:71], v[36:39], v[192:195], v[68:71]
  v_mfma_f32_16x16x32_bf16 v[84:87], v[36:39], v[196:199], v[84:87]
  v_mfma_f32_16x16x32_bf16 v[100:103], v[36:39], v[200:203], v[100:103]
  v_mfma_f32_16x16x32_bf16 v[116:119], v[36:39], v[204:207], v[116:119]
  buffer_load_dwordx4 v[36:39], v9, s[20:23], s48 offen sc1
  s_waitcnt vmcnt(7)
  v_mfma_f32_16x16x32_bf16 v[72:75], v[40:43], v[192:195], v[72:75]
  v_mfma_f32_16x16x32_bf16 v[88:91], v[40:43], v[196:199], v[88:91]
  v_mfma_f32_16x16x32_bf16 v[104:107], v[40:43], v[200:203], v[104:107]
  v_mfma_f32_16x16x32_bf16 v[120:123], v[40:43], v[204:207], v[120:123]
  buffer_load_dwordx4 v[40:43], v10, s[20:23], s48 offen sc1
  s_waitcnt vmcnt(7)
  v_mfma_f32_16x16x32_bf16 v[76:79], v[44:47], v[192:195], v[76:79]
  v_mfma_f32_16x16x32_bf16 v[92:95], v[44:47], v[196:199], v[92:95]
  v_mfma_f32_16x16x32_bf16 v[108:111], v[44:47], v[200:203], v[108:111]
  v_mfma_f32_16x16x32_bf16 v[124:127], v[44:47], v[204:207], v[124:127]
  buffer_load_dwordx4 v[44:47], v11, s[20:23], s48 offen sc1
  s_add_u32 s48, s48, 3584
  s_waitcnt vmcnt(7)
  v_mfma_f32_16x16x32_bf16 v[64:67], v[48:51], v[208:211], v[64:67]
  v_mfma_f32_16x16x32_bf16 v[80:83], v[48:51], v[212:215], v[80:83]
  v_mfma_f32_16x16x32_bf16 v[96:99], v[48:51], v[216:219], v[96:99]
  v_mfma_f32_16x16x32_bf16 v[112:115], v[48:51], v[220:223], v[112:115]
  s_waitcnt vmcnt(6)
  v_mfma_f32_16x16x32_bf16 v[68:71], v[52:55], v[208:211], v[68:71]
  v_mfma_f32_16x16x32_bf16 v[84:87], v[52:55], v[212:215], v[84:87]
  v_mfma_f32_16x16x32_bf16 v[100:103], v[52:55], v[216:219], v[100:103]
  v_mfma_f32_16x16x32_bf16 v[116:119], v[52:55], v[220:223], v[116:119]
  s_waitcnt vmcnt(5)
  v_mfma_f32_16x16x32_bf16 v[72:75], v[56:59], v[208:211], v[72:75]
  v_mfma_f32_16x16x32_bf16 v[88:91], v[56:59], v[212:215], v[88:91]
  v_mfma_f32_16x16x32_bf16 v[104:107], v[56:59], v[216:219], v[104:107]
  v_mfma_f32_16x16x32_bf16 v[120:123], v[56:59], v[220:223], v[120:123]
  s_waitcnt vmcnt(4)
  v_mfma_f32_16x16x32_bf16 v[76:79], v[60:63], v[208:211], v[76:79]
  v_mfma_f32_16x16x32_bf16 v[92:95], v[60:63], v[212:215], v[92:95]
  v_mfma_f32_16x16x32_bf16 v[108:111], v[60:63], v[216:219], v[108:111]
  v_mfma_f32_16x16x32_bf16 v[124:127], v[60:63], v[220:223], v[124:127]
  s_waitcnt vmcnt(0)
  v_mfma_f32_16x16x32_bf16 v[100:103], v[36:39], v[232:235], v[100:103]
  v_mfma_f32_16x16x32_bf16 v[116:119], v[36:39], v[236:239], v[116:119]
  v_mfma_f32_16x16x32_bf16 v[68:71], v[36:39], v[224:227], v[68:71]
  v_mfma_f32_16x16x32_bf16 v[84:87], v[36:39], v[228:231], v[84:87]
  s_waitcnt vmcnt(0)
  v_mfma_f32_16x16x32_bf16 v[104:107], v[40:43], v[232:235], v[104:107]
  v_mfma_f32_16x16x32_bf16 v[120:123], v[40:43], v[236:239], v[120:123]
  v_mfma_f32_16x16x32_bf16 v[72:75], v[40:43], v[224:227], v[72:75]
  v_mfma_f32_16x16x32_bf16 v[88:91], v[40:43], v[228:231], v[88:91]
  ds_write_b128 v6, v[100:103] offset:8192
  ds_write_b128 v6, v[116:119] offset:9216
  ds_write_b128 v6, v[68:71] offset:0
  ds_write_b128 v6, v[84:87] offset:1024
  s_waitcnt vmcnt(0)
  v_mfma_f32_16x16x32_bf16 v[108:111], v[44:47], v[232:235], v[108:111]
  v_mfma_f32_16x16x32_bf16 v[124:127], v[44:47], v[236:239], v[124:127]
  v_mfma_f32_16x16x32_bf16 v[76:79], v[44:47], v[224:227], v[76:79]
  v_mfma_f32_16x16x32_bf16 v[92:95], v[44:47], v[228:231], v[92:95]
  ds_write_b128 v6, v[104:107] offset:10240
  ds_write_b128 v6, v[120:123] offset:11264
  ds_write_b128 v6, v[72:75] offset:2048
  ds_write_b128 v6, v[88:91] offset:3072
  s_waitcnt vmcnt(0)
  v_mfma_f32_16x16x32_bf16 v[96:99], v[32:35], v[232:235], v[96:99]
  v_mfma_f32_16x16x32_bf16 v[112:115], v[32:35], v[236:239], v[112:115]
  v_mfma_f32_16x16x32_bf16 v[64:67], v[32:35], v[224:227], v[64:67]
  v_mfma_f32_16x16x32_bf16 v[80:83], v[32:35], v[228:231], v[80:83]
  ds_write_b128 v6, v[108:111] offset:12288
  ds_write_b128 v6, v[124:127] offset:13312
  ds_write_b128 v6, v[76:79] offset:4096
  ds_write_b128 v6, v[92:95] offset:5120
  s_nop 0
  ds_write_b128 v6, v[96:99] offset:6144
  ds_write_b128 v6, v[112:115] offset:7168
  v_pk_add_f32 v[32:33], v[64:65], v[66:67]
  v_pk_add_f32 v[34:35], v[68:69], v[70:71]
  v_pk_add_f32 v[36:37], v[72:73], v[74:75]
  v_pk_add_f32 v[38:39], v[76:77], v[78:79]
  v_pk_add_f32 v[32:33], v[32:33], v[34:35]
  v_pk_add_f32 v[36:37], v[36:37], v[38:39]
  v_pk_add_f32 v[32:33], v[32:33], v[36:37]
  v_cmp_u_f32 vcc, v32, v33
  s_nop 4
  s_cbranch_vccz L_good2
  s_add_u32 s46, s46, 1
  s_cmp_gt_u32 s46, 200
  s_cbranch_scc1 L_good2
  s_waitcnt vmcnt(0) lgkmcnt(0)
  s_lshl_b32 s48, s26, 3
  s_add_u32 s48, s48, s38
  s_mul_i32 s48, s48, 25088
  s_add_u32 s48, s48, 0x800000
  s_branch L_main2
L_good2:
  s_waitcnt lgkmcnt(0)
  s_barrier
  ds_read_b128 v[32:35], v16 offset:0
  ds_read_b128 v[36:39], v16 offset:1024
  ds_read_b128 v[40:43], v17 offset:2048
  ds_read_b128 v[44:47], v17 offset:3072
  ds_read_b128 v[48:51], v18 offset:4096
  ds_read_b128 v[52:55], v18 offset:5120
  ds_read_b128 v[56:59], v19 offset:6144
  ds_read_b128 v[60:63], v19 offset:7168
  ds_read_b128 v[96:99], v20 offset:8192
  ds_read_b128 v[100:103], v20 offset:9216
  ds_read_b128 v[104:107], v21 offset:10240
  ds_read_b128 v[108:111], v21 offset:11264
  ds_read_b128 v[112:115], v22 offset:12288
  ds_read_b128 v[116:119], v22 offset:13312
  v_mov_b32 v68, v80
  v_mov_b32 v69, v81
  v_mov_b32 v70, v82
  v_mov_b32 v71, v83
  s_waitcnt lgkmcnt(12)
  v_pk_add_f32 v[64:65], v[64:65], v[32:33]
  v_pk_add_f32 v[66:67], v[66:67], v[34:35]
  v_pk_add_f32 v[68:69], v[68:69], v[36:37]
  v_pk_add_f32 v[70:71], v[70:71], v[38:39]
  s_waitcnt lgkmcnt(10)
  v_pk_add_f32 v[64:65], v[64:65], v[40:41]
  v_pk_add_f32 v[66:67], v[66:67], v[42:43]
  v_pk_add_f32 v[68:69], v[68:69], v[44:45]
  v_pk_add_f32 v[70:71], v[70:71], v[46:47]
  s_waitcnt lgkmcnt(8)
  v_pk_add_f32 v[64:65], v[64:65], v[48:49]
  v_pk_add_f32 v[66:67], v[66:67], v[50:51]
  v_pk_add_f32 v[68:69], v[68:69], v[52:53]
  v_pk_add_f32 v[70:71], v[70:71], v[54:55]
  s_waitcnt lgkmcnt(6)
  v_pk_add_f32 v[64:65], v[64:65], v[56:57]
  v_pk_add_f32 v[66:67], v[66:67], v[58:59]
  v_pk_add_f32 v[68:69], v[68:69], v[60:61]
  v_pk_add_f32 v[70:71], v[70:71], v[62:63]
  s_waitcnt lgkmcnt(4)
  v_pk_add_f32 v[64:65], v[64:65], v[96:97]
  v_pk_add_f32 v[66:67], v[66:67], v[98:99]
  v_pk_add_f32 v[68:69], v[68:69], v[100:101]
  v_pk_add_f32 v[70:71], v[70:71], v[102:103]
  s_waitcnt lgkmcnt(2)
  v_pk_add_f32 v[64:65], v[64:65], v[104:105]
  v_pk_add_f32 v[66:67], v[66:67], v[106:107]
  v_pk_add_f32 v[68:69], v[68:69], v[108:109]
  v_pk_add_f32 v[70:71], v[70:71], v[110:111]
  s_waitcnt lgkmcnt(0)
  v_pk_add_f32 v[64:65], v[64:65], v[112:113]
  v_pk_add_f32 v[66:67], v[66:67], v[114:115]
  v_pk_add_f32 v[68:69], v[68:69], v[116:117]
  v_pk_add_f32 v[70:71], v[70:71], v[118:119]
  v_lshlrev_b32 v76, 16, v248
  v_lshlrev_b32 v78, 16, v249
  v_lshlrev_b32 v80, 16, v244
  v_and_b32 v81, s59, v244
  v_lshlrev_b32 v82, 16, v245
  v_and_b32 v83, s59, v245
  v_lshlrev_b32 v84, 16, v246
  v_and_b32 v85, s59, v246
  v_lshlrev_b32 v86, 16, v247
  v_and_b32 v87, s59, v247
  v_cvt_pk_bf16_f32 v72, v64, v65
  v_cvt_pk_bf16_f32 v73, v66, v67
  v_cvt_pk_bf16_f32 v74, v68, v69
  v_cvt_pk_bf16_f32 v75, v70, v71
  v_lshlrev_b32 v64, 16, v72
  v_and_b32 v65, s59, v72
  v_lshlrev_b32 v66, 16, v73
  v_and_b32 v67, s59, v73
  v_lshlrev_b32 v68, 16, v74
  v_and_b32 v69, s59, v74
  v_lshlrev_b32 v70, 16, v75
  v_and_b32 v71, s59, v75
  v_pk_add_f32 v[64:65], v[64:65], v[76:77] op_sel_hi:[1,0]
  v_pk_add_f32 v[66:67], v[66:67], v[76:77] op_sel_hi:[1,0]
  v_pk_add_f32 v[68:69], v[68:69], v[78:79] op_sel_hi:[1,0]
  v_pk_add_f32 v[70:71], v[70:71], v[78:79] op_sel_hi:[1,0]
  v_cvt_pk_bf16_f32 v72, v64, v65
  v_cvt_pk_bf16_f32 v73, v66, v67
  v_cvt_pk_bf16_f32 v74, v68, v69
  v_cvt_pk_bf16_f32 v75, v70, v71
  v_lshlrev_b32 v64, 16, v72
  v_and_b32 v65, s59, v72
  v_lshlrev_b32 v66, 16, v73
  v_and_b32 v67, s59, v73
  v_lshlrev_b32 v68, 16, v74
  v_and_b32 v69, s59, v74
  v_lshlrev_b32 v70, 16, v75
  v_and_b32 v71, s59, v75
  v_pk_add_f32 v[64:65], v[64:65], v[80:81]
  v_pk_add_f32 v[66:67], v[66:67], v[82:83]
  v_pk_add_f32 v[68:69], v[68:69], v[84:85]
  v_pk_add_f32 v[70:71], v[70:71], v[86:87]
  v_cvt_pk_bf16_f32 v72, v64, v65
  v_cvt_pk_bf16_f32 v73, v66, v67
  v_cvt_pk_bf16_f32 v74, v68, v69
  v_cvt_pk_bf16_f32 v75, v70, v71
  buffer_store_dwordx2 v[72:73], v5, s[16:19], s44 offen
  buffer_store_dwordx2 v[74:75], v5, s[16:19], s45 offen
L_end2:
  s_endpgm
.section .rodata,"a"
.p2align 6
.amdhsa_kernel sequential_preLN__spectral_gfnet__mixer_token_mlp__prompt_kernel
  .amdhsa_next_free_vgpr 256
  .amdhsa_next_free_sgpr 102
  .amdhsa_accum_offset 256
  .amdhsa_group_segment_fixed_size 0
  .amdhsa_kernarg_size 88
  .amdhsa_user_sgpr_count 2
  .amdhsa_user_sgpr_kernarg_segment_ptr 1
  .amdhsa_system_sgpr_workgroup_id_x 1
  .amdhsa_float_denorm_mode_32 3
  .amdhsa_float_denorm_mode_16_64 3
.end_amdhsa_kernel
.p2align 8
.type tbl,@object
tbl:
.quad 0x3000300030003000,0x3000300030003000,0x2fa82fd92ff63000,0xa8a5a63ea2460000,0x2ea72f642fd93000,0xaea7af64afd9b000,0x2d132ea72fa83000,0x2e2f2c7228a58000
.quad 0x2a1f2da82f643000,0x2a1f2da82f643000,0x22462c722f0e3000,0xaff6aea7ab8b0000,0xa63e2a1f2ea73000,0x263eaa1faea7b000,0xab8b263e2e2f3000,0x2f0e2fd92d138000
.quad 0xada800002da83000,0xada800002da83000,0xaf0ea63e2d133000,0xab8bafd9ae2f0000,0xafd9aa1f2c723000,0x2fd92a1fac72b000,0xaff6ac722b8b3000,0xa2462ea72f0e8000
.quad 0xaf64ada82a1f3000,0xaf64ada82a1f3000,0xae2faea728a53000,0x2d13ac72afa80000,0xac72af64263e3000,0x2c722f64a63eb000,0xa8a5afd922463000,0xafa8263e2ff68000
.quad 0x3000300030003000,0x3000300030003000,0x2e2f2ea72f0e2f64,0xad13ac72ab8baa1f,0x263e2a1f2c722da8,0xa63eaa1fac72ada8,0xab8ba63e22462a1f,0x2f0e2fd92ff62f64
.quad 0xaf64ada8aa1f0000,0xaf64ada8aa1f0000,0xafa8afd9ae2faa1f,0x28a5a63ead13af64,0xac72af64afd9ada8,0x2c722f642fd92da8,0x2246ac72afa8af64,0xaff6aea7a8a52a1f
.quad 0x2da88000ada8b000,0x2da88000ada8b000,0x2ff62c72a8a5af64,0x22462ea72fa82a1f,0x2ea72f64263eada8,0xaea7af64a63e2da8,0x28a52fd92d13aa1f,0x2fa8263eae2faf64
.quad 0xaa1f2da82f648000,0xaa1f2da82f648000,0xaf0e263e2ff62a1f,0xab8bafd9a2462f64,0xafd9aa1f2ea72da8,0x2fd92a1faea7ada8,0xad13aea72b8b2f64,0xae2f2c722f0eaa1f
.quad 0x3000300030003000,0x3000300030003000,0x2b8b2c722d132da8,0xaf0eaea7ae2fada8,0xac72aa1fa63e0000,0x2c722a1f263e8000,0xaff6afd9af0eada8,0xa246263e2b8b2da8
.quad 0xaa1fada8af64b000,0xaa1fada8af64b000,0x2d13263ea8a5ada8,0x2e2f2fd92fa82da8,0x2fd92f642c728000,0xafd9af64ac720000,0x28a52ea72ff62da8,0x2fa82c72a246ada8
.quad 0xada800002da83000,0xada800002da83000,0xafa8aea7a2462da8,0x28a5ac72aff6ada8,0xa63eaf64aea70000,0x263e2f642ea78000,0x2e2fa63eafa8ada8,0xad13afd9a8a52da8
.quad 0x2f642da8aa1fb000,0x2f642da8aa1fb000,0x22462fd92b8bada8,0xaff6a63e2f0e2da8,0xaea72a1f2fd98000,0x2ea7aa1fafd90000,0xaf0eac722e2f2da8,0xab8b2ea72d13ada8
.quad 0x3000300030003000,0x3000300030003000,0x2246263e28a52a1f,0xaff6afd9afa8af64,0xafd9af64aea7ada8,0x2fd92f642ea72da8,0xa8a5ac72ae2faf64,0xafa8aea7ad13aa1f
.quad 0x2f642da82a1f8000,0x2f642da82a1f8000,0x2b8b2ea72ff62f64,0xaf0eac72a2462a1f,0xaea7aa1f263e2da8,0x2ea72a1fa63eada8,0xad13afd9af0eaa1f,0xae2fa63e2b8b2f64
.quad 0x2da88000ada8b000,0x2da88000ada8b000,0x2e2f2fd92b8baa1f,0xad13263e2f0e2f64,0xac722a1f2fd92da8,0x2c72aa1fafd9ada8,0xaf0eaea722462f64,0xab8b2c722ff62a1f
.quad 0x2a1fada8af640000,0x2a1fada8af640000,0x2fa82c72ad13af64,0xa8a52ea72e2faa1f,0xa63e2f642c72ada8,0x263eaf64ac722da8,0xaff6a63e2fa82a1f,0xa2462fd928a5af64
.quad 0x3000300030003000,0x3000300030003000,0xafa8afd9aff6b000,0x28a5263e22468000,0x2ea72f642fd93000,0xaea7af64afd9b000,0xad13aea7afa8b000,0xae2fac72a8a50000
.quad 0x2a1f2da82f643000,0x2a1f2da82f643000,0xa246ac72af0eb000,0x2ff62ea72b8b8000,0xa63e2a1f2ea73000,0x263eaa1faea7b000,0x2b8ba63eae2fb000,0xaf0eafd9ad130000
.quad 0xada800002da83000,0xada800002da83000,0x2f0e263ead13b000,0x2b8b2fd92e2f8000,0xafd9aa1f2c723000,0x2fd92a1fac72b000,0x2ff62c72ab8bb000,0x2246aea7af0e0000
.quad 0xaf64ada82a1f3000,0xaf64ada82a1f3000,0x2e2f2ea7a8a5b000,0xad132c722fa88000,0xac72af64263e3000,0x2c722f64a63eb000,0x28a52fd9a246b000,0x2fa8a63eaff60000
.quad 0x3000300030003000,0x3000300030003000,0xae2faea7af0eaf64,0x2d132c722b8b2a1f,0x263e2a1f2c722da8,0xa63eaa1fac72ada8,0x2b8b263ea246aa1f,0xaf0eafd9aff6af64
.quad 0xaf64ada8aa1f0000,0xaf64ada8aa1f0000,0x2fa82fd92e2f2a1f,0xa8a5263e2d132f64,0xac72af64afd9ada8,0x2c722f642fd92da8,0xa2462c722fa82f64,0x2ff62ea728a5aa1f
.quad 0x2da88000ada8b000,0x2da88000ada8b000,0xaff6ac7228a52f64,0xa246aea7afa8aa1f,0x2ea72f64263eada8,0xaea7af64a63e2da8,0xa8a5afd9ad132a1f,0xafa8a63e2e2f2f64
.quad 0xaa1f2da82f648000,0xaa1f2da82f648000,0x2f0ea63eaff6aa1f,0x2b8b2fd92246af64,0xafd9aa1f2ea72da8,0x2fd92a1faea7ada8,0x2d132ea7ab8baf64,0x2e2fac72af0e2a1f
.quad 0x3000300030003000,0x3000300030003000,0xab8bac72ad13ada8,0x2f0e2ea72e2f2da8,0xac72aa1fa63e0000,0x2c722a1f263e8000,0x2ff62fd92f0e2da8,0x2246a63eab8bada8
.quad 0xaa1fada8af64b000,0xaa1fada8af64b000,0xad13a63e28a52da8,0xae2fafd9afa8ada8,0x2fd92f642c728000,0xafd9af64ac720000,0xa8a5aea7aff6ada8,0xafa8ac7222462da8
.quad 0xada800002da83000,0xada800002da83000,0x2fa82ea72246ada8,0xa8a52c722ff62da8,0xa63eaf64aea70000,0x263e2f642ea78000,0xae2f263e2fa82da8,0x2d132fd928a5ada8
.quad 0x2f642da8aa1fb000,0x2f642da8aa1fb000,0xa246afd9ab8b2da8,0x2ff6263eaf0eada8,0xaea72a1f2fd98000,0x2ea7aa1fafd90000,0x2f0e2c72ae2fada8,0x2b8baea7ad132da8
.quad 0x3000300030003000,0x3000300030003000,0xa246a63ea8a5aa1f,0x2ff62fd92fa82f64,0xafd9af64aea7ada8,0x2fd92f642ea72da8,0x28a52c722e2f2f64,0x2fa82ea72d132a1f
.quad 0x2f642da82a1f8000,0x2f642da82a1f8000,0xab8baea7aff6af64,0x2f0e2c722246aa1f,0xaea7aa1f263e2da8,0x2ea72a1fa63eada8,0x2d132fd92f0e2a1f,0x2e2f263eab8baf64
.quad 0x2da88000ada8b000,0x2da88000ada8b000,0xae2fafd9ab8b2a1f,0x2d13a63eaf0eaf64,0xac722a1f2fd92da8,0x2c72aa1fafd9ada8,0x2f0e2ea7a246af64,0x2b8bac72aff6aa1f
.quad 0x2a1fada8af640000,0x2a1fada8af640000,0xafa8ac722d132f64,0x28a5aea7ae2f2a1f,0xa63e2f642c72ada8,0x263eaf64ac722da8,0x2ff6263eafa8aa1f,0x2246afd9a8a52f64
.quad 0,0,0x28a5263e22460000,0x2fa82fd92ff63000,0x2c722a1f263e0000,0xac72aa1fa63e0000,0x2e2f2c7228a50000,0xad13aea7afa8b000
.quad 0x2f642da82a1f0000,0x2f642da82a1f0000,0x2ff62ea72b8b0000,0x22462c722f0e3000,0x2fd92f642c720000,0xafd9af64ac720000,0x2f0e2fd92d130000,0x2b8ba63eae2fb000
.quad 0x2da830002da80000,0x2da830002da80000,0x2b8b2fd92e2f0000,0xaf0ea63e2d133000,0x263e2f642ea70000,0xa63eaf64aea70000,0xa2462ea72f0e0000,0x2ff62c72ab8bb000
.quad 0xaa1f2da82f640000,0xaa1f2da82f640000,0xad132c722fa80000,0xae2faea728a53000,0xaea72a1f2fd90000,0x2ea7aa1fafd90000,0xafa8263e2ff60000,0x28a52fd9a246b000
.quad 0,0,0x2d132c722b8b2a1f,0x2e2f2ea72f0e2f64,0x2fd92f642ea72da8,0xafd9af64aea7ada8,0x2f0e2fd92ff62f64,0x2b8b263ea246aa1f
.quad 0x2a1f2da82f643000,0x2a1f2da82f643000,0xa8a5263e2d132f64,0xafa8afd9ae2faa1f,0xaea7aa1f263e2da8,0x2ea72a1fa63eada8,0xaff6aea7a8a52a1f,0xa2462c722fa82f64
.quad 0xada8b000ada80000,0xada8b000ada80000,0xa246aea7afa8aa1f,0x2ff62c72a8a5af64,0x2c72aa1fafd9ada8,0xac722a1f2fd92da8,0x2fa8263eae2faf64,0xa8a5afd9ad132a1f
.quad 0x2f642da8aa1fb000,0x2f642da8aa1fb000,0x2b8b2fd92246af64,0xaf0e263e2ff62a1f,0xa63e2f642c72ada8,0x263eaf64ac722da8,0xae2f2c722f0eaa1f,0x2d132ea7ab8baf64
.quad 0,0,0x2f0e2ea72e2f2da8,0x2b8b2c722d132da8,0x2ea72f642fd93000,0xaea7af64afd9b000,0xa246263e2b8b2da8,0x2ff62fd92f0e2da8
.quad 0xaf64ada8aa1f0000,0xaf64ada8aa1f0000,0xae2fafd9afa8ada8,0x2d13263ea8a5ada8,0x263eaa1faea7b000,0xa63e2a1f2ea73000,0x2fa82c72a246ada8,0xa8a5aea7aff6ada8
.quad 0x2da830002da80000,0x2da830002da80000,0xa8a52c722ff62da8,0xafa8aea7a2462da8,0xafd9aa1f2c723000,0x2fd92a1fac72b000,0xad13afd9a8a52da8,0xae2f263e2fa82da8
.quad 0x2a1fada8af640000,0x2a1fada8af640000,0x2ff6263eaf0eada8,0x22462fd92b8bada8,0x2c722f64a63eb000,0xac72af64263e3000,0xab8b2ea72d13ada8,0x2f0e2c72ae2fada8
.quad 0,0,0x2ff62fd92fa82f64,0x2246263e28a52a1f,0x263e2a1f2c722da8,0xa63eaa1fac72ada8,0xafa8aea7ad13aa1f,0x28a52c722e2f2f64
.quad 0xaa1fada8af64b000,0xaa1fada8af64b000,0x2f0e2c722246aa1f,0x2b8b2ea72ff62f64,0x2c722f642fd92da8,0xac72af64afd9ada8,0xae2fa63e2b8b2f64,0x2d132fd92f0e2a1f
.quad 0xada8b000ada80000,0xada8b000ada80000,0x2d13a63eaf0eaf64,0x2e2f2fd92b8baa1f,0x2ea72f64263eada8,0xaea7af64a63e2da8,0xab8b2c722ff62a1f,0x2f0e2ea7a246af64
.quad 0xaf64ada82a1f3000,0xaf64ada82a1f3000,0x28a5aea7ae2f2a1f,0x2fa82c72ad13af64,0x2fd92a1faea7ada8,0xafd9aa1f2ea72da8,0xa2462fd928a5af64,0x2ff6263eafa8aa1f
.quad 0,0,0xa8a5a63ea2460000,0xafa8afd9aff6b000,0x2c722a1f263e0000,0xac72aa1fa63e0000,0xae2fac72a8a50000,0x2d132ea72fa83000
.quad 0x2f642da82a1f0000,0x2f642da82a1f0000,0xaff6aea7ab8b0000,0xa246ac72af0eb000,0x2fd92f642c720000,0xafd9af64ac720000,0xaf0eafd9ad130000,0xab8b263e2e2f3000
.quad 0x2da830002da80000,0x2da830002da80000,0xab8bafd9ae2f0000,0x2f0e263ead13b000,0x263e2f642ea70000,0xa63eaf64aea70000,0x2246aea7af0e0000,0xaff6ac722b8b3000
.quad 0xaa1f2da82f640000,0xaa1f2da82f640000,0x2d13ac72afa80000,0x2e2f2ea7a8a5b000,0xaea72a1f2fd90000,0x2ea7aa1fafd90000,0x2fa8a63eaff60000,0xa8a5afd922463000
.quad 0,0,0xad13ac72ab8baa1f,0xae2faea7af0eaf64,0x2fd92f642ea72da8,0xafd9af64aea7ada8,0xaf0eafd9aff6af64,0xab8ba63e22462a1f
.quad 0x2a1f2da82f643000,0x2a1f2da82f643000,0x28a5a63ead13af64,0x2fa82fd92e2f2a1f,0xaea7aa1f263e2da8,0x2ea72a1fa63eada8,0x2ff62ea728a5aa1f,0x2246ac72afa8af64
.quad 0xada8b000ada80000,0xada8b000ada80000,0x22462ea72fa82a1f,0xaff6ac7228a52f64,0x2c72aa1fafd9ada8,0xac722a1f2fd92da8,0xafa8a63e2e2f2f64,0x28a52fd92d13aa1f
.quad 0x2f642da8aa1fb000,0x2f642da8aa1fb000,0xab8bafd9a2462f64,0x2f0ea63eaff6aa1f,0xa63e2f642c72ada8,0x263eaf64ac722da8,0x2e2fac72af0e2a1f,0xad13aea72b8b2f64
.quad 0,0,0xaf0eaea7ae2fada8,0xab8bac72ad13ada8,0x2ea72f642fd93000,0xaea7af64afd9b000,0x2246a63eab8bada8,0xaff6afd9af0eada8
.quad 0xaf64ada8aa1f0000,0xaf64ada8aa1f0000,0x2e2f2fd92fa82da8,0xad13a63e28a52da8,0x263eaa1faea7b000,0xa63e2a1f2ea73000,0xafa8ac7222462da8,0x28a52ea72ff62da8
.quad 0x2da830002da80000,0x2da830002da80000,0x28a5ac72aff6ada8,0x2fa82ea72246ada8,0xafd9aa1f2c723000,0x2fd92a1fac72b000,0x2d132fd928a5ada8,0x2e2fa63eafa8ada8
.quad 0x2a1fada8af640000,0x2a1fada8af640000,0xaff6a63e2f0e2da8,0xa246afd9ab8b2da8,0x2c722f64a63eb000,0xac72af64263e3000,0x2b8baea7ad132da8,0xaf0eac722e2f2da8
.quad 0,0,0xaff6afd9afa8af64,0xa246a63ea8a5aa1f,0x263e2a1f2c722da8,0xa63eaa1fac72ada8,0x2fa82ea72d132a1f,0xa8a5ac72ae2faf64
.quad 0xaa1fada8af64b000,0xaa1fada8af64b000,0xaf0eac72a2462a1f,0xab8baea7aff6af64,0x2c722f642fd92da8,0xac72af64afd9ada8,0x2e2f263eab8baf64,0xad13afd9af0eaa1f
.quad 0xada8b000ada80000,0xada8b000ada80000,0xad13263e2f0e2f64,0xae2fafd9ab8b2a1f,0x2ea72f64263eada8,0xaea7af64a63e2da8,0x2b8bac72aff6aa1f,0xaf0eaea722462f64
.quad 0xaf64ada82a1f3000,0xaf64ada82a1f3000,0xa8a52ea72e2faa1f,0xafa8ac722d132f64,0x2fd92a1faea7ada8,0xafd9aa1f2ea72da8,0x2246afd9a8a52f64,0xaff6a63e2fa82a1f
.quad 0x8000b00000003000,0x8000b00000003000,0x28a5afd9a2463000,0x2fa8263eaff60000,0x2c72af64a63e3000,0xac722f64263eb000,0x2e2faea7a8a53000,0xad13ac722fa88000
.quad 0x2f64ada8aa1f3000,0x2f64ada8aa1f3000,0x2ff6ac72ab8b3000,0x22462ea7af0e0000,0x2fd9aa1fac723000,0xafd92a1f2c72b000,0x2f0ea63ead133000,0x2b8bafd92e2f8000
.quad 0x2da88000ada83000,0x2da88000ada83000,0x2b8b263eae2f3000,0xaf0e2fd9ad130000,0x263e2a1faea73000,0xa63eaa1f2ea7b000,0xa2462c72af0e3000,0x2ff6aea72b8b8000
.quad 0xaa1f2da8af643000,0xaa1f2da8af643000,0xad132ea7afa83000,0xae2f2c72a8a50000,0xaea72f64afd93000,0x2ea7af642fd9b000,0xafa82fd9aff63000,0x28a5a63e22468000
.quad 0x8000b00000003000,0x8000b00000003000,0x2d13aea7ab8b2f64,0x2e2f2c72af0eaa1f,0x2fd9aa1faea72da8,0xafd92a1f2ea7ada8,0x2f0e263eaff62a1f,0x2b8bafd922462f64
.quad 0x2a1f2da8af640000,0x2a1f2da8af640000,0xa8a52fd9ad13aa1f,0xafa8263e2e2faf64,0xaea72f64a63eada8,0x2ea7af64263e2da8,0xaff62c7228a5af64,0xa2462ea7afa82a1f
.quad 0xada800002da8b000,0xada800002da8b000,0xa246ac722fa8af64,0x2ff6aea728a52a1f,0x2c72af642fd9ada8,0xac722f64afd92da8,0x2fa8afd92e2faa1f,0xa8a5a63e2d13af64
.quad 0x2f64ada82a1f8000,0x2f64ada82a1f8000,0x2b8ba63ea2462a1f,0xaf0e2fd9aff62f64,0xa63e2a1fac722da8,0x263eaa1f2c72ada8,0xae2f2ea7af0e2f64,0x2d13ac722b8baa1f
.quad 0x8000b00000003000,0x8000b00000003000,0x2f0eac72ae2f2da8,0x2b8b2ea7ad13ada8,0x2ea72a1fafd90000,0xaea7aa1f2fd98000,0xa2462fd9ab8bada8,0x2ff6a63eaf0e2da8
.quad 0xaf642da82a1fb000,0xaf642da82a1fb000,0xae2fa63e2fa8ada8,0x2d13afd928a52da8,0x263eaf642ea78000,0xa63e2f64aea70000,0x2fa8aea722462da8,0xa8a5ac722ff6ada8
.quad 0x2da88000ada83000,0x2da88000ada83000,0xa8a52ea7aff62da8,0xafa82c722246ada8,0xafd92f64ac720000,0x2fd9af642c728000,0xad13263e28a5ada8,0xae2f2fd9afa82da8
.quad 0x2a1fada82f64b000,0x2a1fada82f64b000,0x2ff6afd92f0eada8,0x2246263eab8b2da8,0x2c72aa1f263e8000,0xac722a1fa63e0000,0xab8b2c72ad132da8,0x2f0eaea72e2fada8
.quad 0x8000b00000003000,0x8000b00000003000,0x2ff6a63eafa82a1f,0x22462fd9a8a5af64,0x263e2f64ac72ada8,0xa63eaf642c722da8,0xafa82c722d13af64,0x28a52ea7ae2faa1f
.quad 0xaa1fada82f648000,0xaa1fada82f648000,0x2f0eaea7a2462f64,0x2b8b2c72aff62a1f,0x2c722a1fafd92da8,0xac72aa1f2fd9ada8,0xae2f2fd9ab8baa1f,0x2d13263eaf0e2f64
.quad 0xada800002da8b000,0xada800002da8b000,0x2d13afd92f0eaa1f,0x2e2fa63eab8b2f64,0x2ea7aa1fa63e2da8,0xaea72a1f263eada8,0xab8b2ea7aff62f64,0x2f0eac7222462a1f
.quad 0xaf642da8aa1f0000,0xaf642da8aa1f0000,0x28a5ac722e2faf64,0x2fa8aea72d13aa1f,0x2fd9af642ea7ada8,0xafd92f64aea72da8,0xa246263ea8a52a1f,0x2ff6afd92fa8af64
.quad 0x8000b00000003000,0x8000b00000003000,0xa8a52fd92246b000,0xafa8a63e2ff68000,0x2c72af64a63e3000,0xac722f64263eb000,0xae2f2ea728a5b000,0x2d132c72afa80000
.quad 0x2f64ada8aa1f3000,0x2f64ada8aa1f3000,0xaff62c722b8bb000,0xa246aea72f0e8000,0x2fd9aa1fac723000,0xafd92a1f2c72b000,0xaf0e263e2d13b000,0xab8b2fd9ae2f0000
.quad 0x2da88000ada83000,0x2da88000ada83000,0xab8ba63e2e2fb000,0x2f0eafd92d138000,0x263e2a1faea73000,0xa63eaa1f2ea7b000,0x2246ac722f0eb000,0xaff62ea7ab8b0000
.quad 0xaa1f2da8af643000,0xaa1f2da8af643000,0x2d13aea72fa8b000,0x2e2fac7228a58000,0xaea72f64afd93000,0x2ea7af642fd9b000,0x2fa8afd92ff6b000,0xa8a5263ea2460000
.quad 0x8000b00000003000,0x8000b00000003000,0xad132ea72b8baf64,0xae2fac722f0e2a1f,0x2fd9aa1faea72da8,0xafd92a1f2ea7ada8,0xaf0ea63e2ff6aa1f,0xab8b2fd9a246af64
.quad 0x2a1f2da8af640000,0x2a1f2da8af640000,0x28a5afd92d132a1f,0x2fa8a63eae2f2f64,0xaea72f64a63eada8,0x2ea7af64263e2da8,0x2ff6ac72a8a52f64,0x2246aea72fa8aa1f
.quad 0xada800002da8b000,0xada800002da8b000,0x22462c72afa82f64,0xaff62ea7a8a5aa1f,0x2c72af642fd9ada8,0xac722f64afd92da8,0xafa82fd9ae2f2a1f,0x28a5263ead132f64
.quad 0x2f64ada82a1f8000,0x2f64ada82a1f8000,0xab8b263e2246aa1f,0x2f0eafd92ff6af64,0xa63e2a1fac722da8,0x263eaa1f2c72ada8,0x2e2faea72f0eaf64,0xad132c72ab8b2a1f
.quad 0x8000b00000003000,0x8000b00000003000,0xaf0e2c722e2fada8,0xab8baea72d132da8,0x2ea72a1fafd90000,0xaea7aa1f2fd98000,0x2246afd92b8b2da8,0xaff6263e2f0eada8
.quad 0xaf642da82a1fb000,0xaf642da82a1fb000,0x2e2f263eafa82da8,0xad132fd9a8a5ada8,0x263eaf642ea78000,0xa63e2f64aea70000,0xafa82ea7a246ada8,0x28a52c72aff62da8
.quad 0x2da88000ada83000,0x2da88000ada83000,0x28a5aea72ff6ada8,0x2fa8ac72a2462da8,0xafd92f64ac720000,0x2fd9af642c728000,0x2d13a63ea8a52da8,0x2e2fafd92fa8ada8
.quad 0x2a1fada82f64b000,0x2a1fada82f64b000,0xaff62fd9af0e2da8,0xa246a63e2b8bada8,0x2c72aa1f263e8000,0xac722a1fa63e0000,0x2b8bac722d13ada8,0xaf0e2ea7ae2f2da8
.quad 0x8000b00000003000,0x8000b00000003000,0xaff6263e2fa8aa1f,0xa246afd928a52f64,0x263e2f64ac72ada8,0xa63eaf642c722da8,0x2fa8ac72ad132f64,0xa8a5aea72e2f2a1f
.quad 0xaa1fada82f648000,0xaa1fada82f648000,0xaf0e2ea72246af64,0xab8bac722ff6aa1f,0x2c722a1fafd92da8,0xac72aa1f2fd9ada8,0x2e2fafd92b8b2a1f,0xad13a63e2f0eaf64
.quad 0xada800002da8b000,0xada800002da8b000,0xad132fd9af0e2a1f,0xae2f263e2b8baf64,0x2ea7aa1fa63e2da8,0xaea72a1f263eada8,0x2b8baea72ff6af64,0xaf0e2c72a246aa1f
.quad 0xaf642da8aa1f0000,0xaf642da8aa1f0000,0xa8a52c72ae2f2f64,0xafa82ea7ad132a1f,0x2fd9af642ea7ada8,0xafd92f64aea72da8,0x2246a63e28a5aa1f,0xaff62fd9afa82f64
.quad 0xb000000030000000,0xb000000030000000,0xafa8a63e2ff60000,0x28a5afd9a2463000,0xaea7aa1f2fd90000,0x2ea72a1fafd90000,0xad13ac722fa80000,0xae2f2ea728a5b000
.quad 0xaa1fada82f640000,0xaa1fada82f640000,0xa246aea72f0e0000,0x2ff6ac72ab8b3000,0x263eaf642ea70000,0xa63e2f64aea70000,0x2b8bafd92e2f0000,0xaf0e263e2d13b000
.quad 0x2da8b0002da80000,0x2da8b0002da80000,0x2f0eafd92d130000,0x2b8b263eae2f3000,0x2fd9af642c720000,0xafd92f64ac720000,0x2ff6aea72b8b0000,0x2246ac722f0eb000
.quad 0x2f64ada82a1f0000,0x2f64ada82a1f0000,0x2e2fac7228a50000,0xad132ea7afa83000,0x2c72aa1f263e0000,0xac722a1fa63e0000,0x28a5a63e22460000,0x2fa8afd92ff6b000
.quad 0xb000000030000000,0xb000000030000000,0xae2fac722f0e2a1f,0x2d13aea7ab8b2f64,0xa63eaf642c722da8,0x263e2f64ac72ada8,0x2b8bafd922462f64,0xaf0ea63e2ff6aa1f
.quad 0x2f64ada8aa1f3000,0x2f64ada8aa1f3000,0x2fa8a63eae2f2f64,0xa8a52fd9ad13aa1f,0x2c722a1fafd92da8,0xac72aa1f2fd9ada8,0xa2462ea7afa82a1f,0x2ff6ac72a8a52f64
.quad 0xada83000ada80000,0xada83000ada80000,0xaff62ea7a8a5aa1f,0xa246ac722fa8af64,0xaea72a1f263eada8,0x2ea7aa1fa63e2da8,0xa8a5a63e2d13af64,0xafa82fd9ae2f2a1f
.quad 0x2a1fada82f64b000,0x2a1fada82f64b000,0x2f0eafd92ff6af64,0x2b8ba63ea2462a1f,0x2fd9af642ea7ada8,0xafd92f64aea72da8,0x2d13ac722b8baa1f,0x2e2faea72f0eaf64
.quad 0xb000000030000000,0xb000000030000000,0xab8baea72d132da8,0x2f0eac72ae2f2da8,0x2c72af64a63e3000,0xac722f64263eb000,0x2ff6a63eaf0e2da8,0x2246afd92b8b2da8
.quad 0x2a1f2da8af640000,0x2a1f2da8af640000,0xad132fd9a8a5ada8,0xae2fa63e2fa8ada8,0xafd92a1f2c72b000,0x2fd9aa1fac723000,0xa8a5ac722ff6ada8,0xafa82ea7a246ada8
.quad 0x2da8b0002da80000,0x2da8b0002da80000,0x2fa8ac72a2462da8,0xa8a52ea7aff62da8,0x263e2a1faea73000,0xa63eaa1f2ea7b000,0xae2f2fd9afa82da8,0x2d13a63ea8a52da8
.quad 0xaf642da8aa1f0000,0xaf642da8aa1f0000,0xa246a63e2b8bada8,0x2ff6afd92f0eada8,0x2ea7af642fd9b000,0xaea72f64afd93000,0x2f0eaea72e2fada8,0x2b8bac722d13ada8
.quad 0xb000000030000000,0xb000000030000000,0xa246afd928a52f64,0x2ff6a63eafa82a1f,0x2fd9aa1faea72da8,0xafd92a1f2ea7ada8,0x28a52ea7ae2faa1f,0x2fa8ac72ad132f64
.quad 0xaf642da82a1fb000,0xaf642da82a1fb000,0xab8bac722ff6aa1f,0x2f0eaea7a2462f64,0x2ea7af64263e2da8,0xaea72f64a63eada8,0x2d13263eaf0e2f64,0x2e2fafd92b8b2a1f
.quad 0xada83000ada80000,0xada83000ada80000,0xae2f263e2b8baf64,0x2d13afd92f0eaa1f,0x2c72af642fd9ada8,0xac722f64afd92da8,0x2f0eac7222462a1f,0x2b8baea72ff6af64
.quad 0xaa1f2da8af643000,0xaa1f2da8af643000,0xafa82ea7ad132a1f,0x28a5ac722e2faf64,0x263eaa1f2c72ada8,0xa63e2a1fac722da8,0x2ff6afd92fa8af64,0x2246a63e28a5aa1f
.quad 0xb000000030000000,0xb000000030000000,0x2fa8263eaff60000,0xa8a52fd92246b000,0xaea7aa1f2fd90000,0x2ea72a1fafd90000,0x2d132c72afa80000,0x2e2faea7a8a53000
.quad 0xaa1fada82f640000,0xaa1fada82f640000,0x22462ea7af0e0000,0xaff62c722b8bb000,0x263eaf642ea70000,0xa63e2f64aea70000,0xab8b2fd9ae2f0000,0x2f0ea63ead133000
.quad 0x2da8b0002da80000,0x2da8b0002da80000,0xaf0e2fd9ad130000,0xab8ba63e2e2fb000,0x2fd9af642c720000,0xafd92f64ac720000,0xaff62ea7ab8b0000,0xa2462c72af0e3000
.quad 0x2f64ada82a1f0000,0x2f64ada82a1f0000,0xae2f2c72a8a50000,0x2d13aea72fa8b000,0x2c72aa1f263e0000,0xac722a1fa63e0000,0xa8a5263ea2460000,0xafa82fd9aff63000
.quad 0xb000000030000000,0xb000000030000000,0x2e2f2c72af0eaa1f,0xad132ea72b8baf64,0xa63eaf642c722da8,0x263e2f64ac72ada8,0xab8b2fd9a246af64,0x2f0e263eaff62a1f
.quad 0x2f64ada8aa1f3000,0x2f64ada8aa1f3000,0xafa8263e2e2faf64,0x28a5afd92d132a1f,0x2c722a1fafd92da8,0xac72aa1f2fd9ada8,0x2246aea72fa8aa1f,0xaff62c7228a5af64
.quad 0xada83000ada80000,0xada83000ada80000,0x2ff6aea728a52a1f,0x22462c72afa82f64,0xaea72a1f263eada8,0x2ea7aa1fa63e2da8,0x28a5263ead132f64,0x2fa8afd92e2faa1f
.quad 0x2a1fada82f64b000,0x2a1fada82f64b000,0xaf0e2fd9aff62f64,0xab8b263e2246aa1f,0x2fd9af642ea7ada8,0xafd92f64aea72da8,0xad132c72ab8b2a1f,0xae2f2ea7af0e2f64
.quad 0xb000000030000000,0xb000000030000000,0x2b8b2ea7ad13ada8,0xaf0e2c722e2fada8,0x2c72af64a63e3000,0xac722f64263eb000,0xaff6263e2f0eada8,0xa2462fd9ab8bada8
.quad 0x2a1f2da8af640000,0x2a1f2da8af640000,0x2d13afd928a52da8,0x2e2f263eafa82da8,0xafd92a1f2c72b000,0x2fd9aa1fac723000,0x28a52c72aff62da8,0x2fa8aea722462da8
.quad 0x2da8b0002da80000,0x2da8b0002da80000,0xafa82c722246ada8,0x28a5aea72ff6ada8,0x263e2a1faea73000,0xa63eaa1f2ea7b000,0x2e2fafd92fa8ada8,0xad13263e28a5ada8
.quad 0xaf642da8aa1f0000,0xaf642da8aa1f0000,0x2246263eab8b2da8,0xaff62fd9af0e2da8,0x2ea7af642fd9b000,0xaea72f64afd93000,0xaf0e2ea7ae2f2da8,0xab8b2c72ad132da8
.quad 0xb000000030000000,0xb000000030000000,0x22462fd9a8a5af64,0xaff6263e2fa8aa1f,0x2fd9aa1faea72da8,0xafd92a1f2ea7ada8,0xa8a5aea72e2f2a1f,0xafa82c722d13af64
.quad 0xaf642da82a1fb000,0xaf642da82a1fb000,0x2b8b2c72aff62a1f,0xaf0e2ea72246af64,0x2ea7af64263e2da8,0xaea72f64a63eada8,0xad13a63e2f0eaf64,0xae2f2fd9ab8baa1f
.quad 0xada83000ada80000,0xada83000ada80000,0x2e2fa63eab8b2f64,0xad132fd9af0e2a1f,0x2c72af642fd9ada8,0xac722f64afd92da8,0xaf0e2c72a246aa1f,0xab8b2ea7aff62f64
.quad 0xaa1f2da8af643000,0xaa1f2da8af643000,0x2fa8aea72d13aa1f,0xa8a52c72ae2f2f64,0x263eaa1f2c72ada8,0xa63e2a1fac722da8,0xaff62fd9afa82f64,0xa246263ea8a52a1f
.quad 0xb0003000b0003000,0xb0003000b0003000,0xafa82fd9aff63000,0x28a5a63e22460000,0xaea72f64afd93000,0x2ea7af642fd9b000,0xad132ea7afa83000,0xae2f2c72a8a58000
.quad 0xaa1f2da8af643000,0xaa1f2da8af643000,0xa2462c72af0e3000,0x2ff6aea72b8b0000,0x263e2a1faea73000,0xa63eaa1f2ea7b000,0x2b8b263eae2f3000,0xaf0e2fd9ad138000
.quad 0x2da80000ada83000,0x2da80000ada83000,0x2f0ea63ead133000,0x2b8bafd92e2f0000,0x2fd9aa1fac723000,0xafd92a1f2c72b000,0x2ff6ac72ab8b3000,0x22462ea7af0e8000
.quad 0x2f64ada8aa1f3000,0x2f64ada8aa1f3000,0x2e2faea7a8a53000,0xad13ac722fa80000,0x2c72af64a63e3000,0xac722f64263eb000,0x28a5afd9a2463000,0x2fa8263eaff68000
.quad 0xb0003000b0003000,0xb0003000b0003000,0xae2f2ea7af0e2f64,0x2d13ac722b8baa1f,0xa63e2a1fac722da8,0x263eaa1f2c72ada8,0x2b8ba63ea2462a1f,0xaf0e2fd9aff62f64
.quad 0x2f64ada82a1f0000,0x2f64ada82a1f0000,0x2fa8afd92e2faa1f,0xa8a5a63e2d13af64,0x2c72af642fd9ada8,0xac722f64afd92da8,0xa246ac722fa8af64,0x2ff6aea728a52a1f
.quad 0xada880002da8b000,0xada880002da8b000,0xaff62c7228a5af64,0xa2462ea7afa82a1f,0xaea72f64a63eada8,0x2ea7af64263e2da8,0xa8a52fd9ad13aa1f,0xafa8263e2e2faf64
.quad 0x2a1f2da8af648000,0x2a1f2da8af648000,0x2f0e263eaff62a1f,0x2b8bafd922462f64,0x2fd9aa1faea72da8,0xafd92a1f2ea7ada8,0x2d13aea7ab8b2f64,0x2e2f2c72af0eaa1f
.quad 0xb0003000b0003000,0xb0003000b0003000,0xab8b2c72ad132da8,0x2f0eaea72e2fada8,0x2c72aa1f263e0000,0xac722a1fa63e8000,0x2ff6afd92f0eada8,0x2246263eab8b2da8
.quad 0x2a1fada82f64b000,0x2a1fada82f64b000,0xad13263e28a5ada8,0xae2f2fd9afa82da8,0xafd92f64ac728000,0x2fd9af642c720000,0xa8a52ea7aff62da8,0xafa82c722246ada8
.quad 0x2da80000ada83000,0x2da80000ada83000,0x2fa8aea722462da8,0xa8a5ac722ff6ada8,0x263eaf642ea70000,0xa63e2f64aea78000,0xae2fa63e2fa8ada8,0x2d13afd928a52da8
.quad 0xaf642da82a1fb000,0xaf642da82a1fb000,0xa2462fd9ab8bada8,0x2ff6a63eaf0e2da8,0x2ea72a1fafd98000,0xaea7aa1f2fd90000,0x2f0eac72ae2f2da8,0x2b8b2ea7ad13ada8
.quad 0xb0003000b0003000,0xb0003000b0003000,0xa246263ea8a52a1f,0x2ff6afd92fa8af64,0x2fd9af642ea7ada8,0xafd92f64aea72da8,0x28a5ac722e2faf64,0x2fa8aea72d13aa1f
.quad 0xaf642da8aa1f8000,0xaf642da8aa1f8000,0xab8b2ea7aff62f64,0x2f0eac7222462a1f,0x2ea7aa1fa63e2da8,0xaea72a1f263eada8,0x2d13afd92f0eaa1f,0x2e2fa63eab8b2f64
.quad 0xada880002da8b000,0xada880002da8b000,0xae2f2fd9ab8baa1f,0x2d13263eaf0e2f64,0x2c722a1fafd92da8,0xac72aa1f2fd9ada8,0x2f0eaea7a2462f64,0x2b8b2c72aff62a1f
.quad 0xaa1fada82f640000,0xaa1fada82f640000,0xafa82c722d13af64,0x28a52ea7ae2faa1f,0x263e2f64ac72ada8,0xa63eaf642c722da8,0x2ff6a63eafa82a1f,0x22462fd9a8a5af64
.quad 0xb0003000b0003000,0xb0003000b0003000,0x2fa8afd92ff6b000,0xa8a5263ea2468000,0xaea72f64afd93000,0x2ea7af642fd9b000,0x2d13aea72fa8b000,0x2e2fac7228a50000
.quad 0xaa1f2da8af643000,0xaa1f2da8af643000,0x2246ac722f0eb000,0xaff62ea7ab8b8000,0x263e2a1faea73000,0xa63eaa1f2ea7b000,0xab8ba63e2e2fb000,0x2f0eafd92d130000
.quad 0x2da80000ada83000,0x2da80000ada83000,0xaf0e263e2d13b000,0xab8b2fd9ae2f8000,0x2fd9aa1fac723000,0xafd92a1f2c72b000,0xaff62c722b8bb000,0xa246aea72f0e0000
.quad 0x2f64ada8aa1f3000,0x2f64ada8aa1f3000,0xae2f2ea728a5b000,0x2d132c72afa88000,0x2c72af64a63e3000,0xac722f64263eb000,0xa8a52fd92246b000,0xafa8a63e2ff60000
.quad 0xb0003000b0003000,0xb0003000b0003000,0x2e2faea72f0eaf64,0xad132c72ab8b2a1f,0xa63e2a1fac722da8,0x263eaa1f2c72ada8,0xab8b263e2246aa1f,0x2f0eafd92ff6af64
.quad 0x2f64ada82a1f0000,0x2f64ada82a1f0000,0xafa82fd9ae2f2a1f,0x28a5263ead132f64,0x2c72af642fd9ada8,0xac722f64afd92da8,0x22462c72afa82f64,0xaff62ea7a8a5aa1f
.quad 0xada880002da8b000,0xada880002da8b000,0x2ff6ac72a8a52f64,0x2246aea72fa8aa1f,0xaea72f64a63eada8,0x2ea7af64263e2da8,0x28a5afd92d132a1f,0x2fa8a63eae2f2f64
.quad 0x2a1f2da8af648000,0x2a1f2da8af648000,0xaf0ea63e2ff6aa1f,0xab8b2fd9a246af64,0x2fd9aa1faea72da8,0xafd92a1f2ea7ada8,0xad132ea72b8baf64,0xae2fac722f0e2a1f
.quad 0xb0003000b0003000,0xb0003000b0003000,0x2b8bac722d13ada8,0xaf0e2ea7ae2f2da8,0x2c72aa1f263e0000,0xac722a1fa63e8000,0xaff62fd9af0e2da8,0xa246a63e2b8bada8
.quad 0x2a1fada82f64b000,0x2a1fada82f64b000,0x2d13a63ea8a52da8,0x2e2fafd92fa8ada8,0xafd92f64ac728000,0x2fd9af642c720000,0x28a5aea72ff6ada8,0x2fa8ac72a2462da8
.quad 0x2da80000ada83000,0x2da80000ada83000,0xafa82ea7a246ada8,0x28a52c72aff62da8,0x263eaf642ea70000,0xa63e2f64aea78000,0x2e2f263eafa82da8,0xad132fd9a8a5ada8
.quad 0xaf642da82a1fb000,0xaf642da82a1fb000,0x2246afd92b8b2da8,0xaff6263e2f0eada8,0x2ea72a1fafd98000,0xaea7aa1f2fd90000,0xaf0e2c722e2fada8,0xab8baea72d132da8
.quad 0xb0003000b0003000,0xb0003000b0003000,0x2246a63e28a5aa1f,0xaff62fd9afa82f64,0x2fd9af642ea7ada8,0xafd92f64aea72da8,0xa8a52c72ae2f2f64,0xafa82ea7ad132a1f
.quad 0xaf642da8aa1f8000,0xaf642da8aa1f8000,0x2b8baea72ff6af64,0xaf0e2c72a246aa1f,0x2ea7aa1fa63e2da8,0xaea72a1f263eada8,0xad132fd9af0e2a1f,0xae2f263e2b8baf64
.quad 0xada880002da8b000,0xada880002da8b000,0x2e2fafd92b8b2a1f,0xad13a63e2f0eaf64,0x2c722a1fafd92da8,0xac72aa1f2fd9ada8,0xaf0e2ea72246af64,0xab8bac722ff6aa1f
.quad 0xaa1fada82f640000,0xaa1fada82f640000,0x2fa8ac72ad132f64,0xa8a5aea72e2f2a1f,0x263e2f64ac72ada8,0xa63eaf642c722da8,0xaff6263e2fa8aa1f,0xa246afd928a52f64
.quad 0,0,0xa8a5263ea2460000,0xafa82fd9aff63000,0xac722a1fa63e0000,0x2c72aa1f263e0000,0xae2f2c72a8a50000,0x2d13aea72fa8b000
.quad 0xaf642da8aa1f0000,0xaf642da8aa1f0000,0xaff62ea7ab8b0000,0xa2462c72af0e3000,0xafd92f64ac720000,0x2fd9af642c720000,0xaf0e2fd9ad130000,0xab8ba63e2e2fb000
.quad 0xada83000ada80000,0xada83000ada80000,0xab8b2fd9ae2f0000,0x2f0ea63ead133000,0xa63e2f64aea70000,0x263eaf642ea70000,0x22462ea7af0e0000,0xaff62c722b8bb000
.quad 0x2a1f2da8af640000,0x2a1f2da8af640000,0x2d132c72afa80000,0x2e2faea7a8a53000,0x2ea72a1fafd90000,0xaea7aa1f2fd90000,0x2fa8263eaff60000,0xa8a52fd92246b000
.quad 0,0,0xad132c72ab8b2a1f,0xae2f2ea7af0e2f64,0xafd92f64aea72da8,0x2fd9af642ea7ada8,0xaf0e2fd9aff62f64,0xab8b263e2246aa1f
.quad 0xaa1f2da8af643000,0xaa1f2da8af643000,0x28a5263ead132f64,0x2fa8afd92e2faa1f,0x2ea7aa1fa63e2da8,0xaea72a1f263eada8,0x2ff6aea728a52a1f,0x22462c72afa82f64
.quad 0x2da8b0002da80000,0x2da8b0002da80000,0x2246aea72fa8aa1f,0xaff62c7228a5af64,0xac72aa1f2fd9ada8,0x2c722a1fafd92da8,0xafa8263e2e2faf64,0x28a5afd92d132a1f
.quad 0xaf642da82a1fb000,0xaf642da82a1fb000,0xab8b2fd9a246af64,0x2f0e263eaff62a1f,0x263e2f64ac72ada8,0xa63eaf642c722da8,0x2e2f2c72af0eaa1f,0xad132ea72b8baf64
.quad 0,0,0xaf0e2ea7ae2f2da8,0xab8b2c72ad132da8,0xaea72f64afd93000,0x2ea7af642fd9b000,0x2246263eab8b2da8,0xaff62fd9af0e2da8
.quad 0x2f64ada82a1f0000,0x2f64ada82a1f0000,0x2e2fafd92fa8ada8,0xad13263e28a5ada8,0xa63eaa1f2ea7b000,0x263e2a1faea73000,0xafa82c722246ada8,0x28a5aea72ff6ada8
.quad 0xada83000ada80000,0xada83000ada80000,0x28a52c72aff62da8,0x2fa8aea722462da8,0x2fd9aa1fac723000,0xafd92a1f2c72b000,0x2d13afd928a52da8,0x2e2f263eafa82da8
.quad 0xaa1fada82f640000,0xaa1fada82f640000,0xaff6263e2f0eada8,0xa2462fd9ab8bada8,0xac722f64263eb000,0x2c72af64a63e3000,0x2b8b2ea7ad13ada8,0xaf0e2c722e2fada8
.quad 0,0,0xaff62fd9afa82f64,0xa246263ea8a52a1f,0xa63e2a1fac722da8,0x263eaa1f2c72ada8,0x2fa8aea72d13aa1f,0xa8a52c72ae2f2f64
.quad 0x2a1fada82f64b000,0x2a1fada82f64b000,0xaf0e2c72a246aa1f,0xab8b2ea7aff62f64,0xac722f64afd92da8,0x2c72af642fd9ada8,0x2e2fa63eab8b2f64,0xad132fd9af0e2a1f
.quad 0x2da8b0002da80000,0x2da8b0002da80000,0xad13a63e2f0eaf64,0xae2f2fd9ab8baa1f,0xaea72f64a63eada8,0x2ea7af64263e2da8,0x2b8b2c72aff62a1f,0xaf0e2ea72246af64
.quad 0x2f64ada8aa1f3000,0x2f64ada8aa1f3000,0xa8a5aea72e2f2a1f,0xafa82c722d13af64,0xafd92a1f2ea7ada8,0x2fd9aa1faea72da8,0x22462fd9a8a5af64,0xaff6263e2fa8aa1f
.quad 0,0,0x28a5a63e22460000,0x2fa8afd92ff6b000,0xac722a1fa63e0000,0x2c72aa1f263e0000,0x2e2fac7228a50000,0xad132ea7afa83000
.quad 0xaf642da8aa1f0000,0xaf642da8aa1f0000,0x2ff6aea72b8b0000,0x2246ac722f0eb000,0xafd92f64ac720000,0x2fd9af642c720000,0x2f0eafd92d130000,0x2b8b263eae2f3000
.quad 0xada83000ada80000,0xada83000ada80000,0x2b8bafd92e2f0000,0xaf0e263e2d13b000,0xa63e2f64aea70000,0x263eaf642ea70000,0xa246aea72f0e0000,0x2ff6ac72ab8b3000
.quad 0x2a1f2da8af640000,0x2a1f2da8af640000,0xad13ac722fa80000,0xae2f2ea728a5b000,0x2ea72a1fafd90000,0xaea7aa1f2fd90000,0xafa8a63e2ff60000,0x28a5afd9a2463000
.quad 0,0,0x2d13ac722b8baa1f,0x2e2faea72f0eaf64,0xafd92f64aea72da8,0x2fd9af642ea7ada8,0x2f0eafd92ff6af64,0x2b8ba63ea2462a1f
.quad 0xaa1f2da8af643000,0xaa1f2da8af643000,0xa8a5a63e2d13af64,0xafa82fd9ae2f2a1f,0x2ea7aa1fa63e2da8,0xaea72a1f263eada8,0xaff62ea7a8a5aa1f,0xa246ac722fa8af64
.quad 0x2da8b0002da80000,0x2da8b0002da80000,0xa2462ea7afa82a1f,0x2ff6ac72a8a52f64,0xac72aa1f2fd9ada8,0x2c722a1fafd92da8,0x2fa8a63eae2f2f64,0xa8a52fd9ad13aa1f
.quad 0xaf642da82a1fb000,0xaf642da82a1fb000,0x2b8bafd922462f64,0xaf0ea63e2ff6aa1f,0x263e2f64ac72ada8,0xa63eaf642c722da8,0xae2fac722f0e2a1f,0x2d13aea7ab8b2f64
.quad 0,0,0x2f0eaea72e2fada8,0x2b8bac722d13ada8,0xaea72f64afd93000,0x2ea7af642fd9b000,0xa246a63e2b8bada8,0x2ff6afd92f0eada8
.quad 0x2f64ada82a1f0000,0x2f64ada82a1f0000,0xae2f2fd9afa82da8,0x2d13a63ea8a52da8,0xa63eaa1f2ea7b000,0x263e2a1faea73000,0x2fa8ac72a2462da8,0xa8a52ea7aff62da8
.quad 0xada83000ada80000,0xada83000ada80000,0xa8a5ac722ff6ada8,0xafa82ea7a246ada8,0x2fd9aa1fac723000,0xafd92a1f2c72b000,0xad132fd9a8a5ada8,0xae2fa63e2fa8ada8
.quad 0xaa1fada82f640000,0xaa1fada82f640000,0x2ff6a63eaf0e2da8,0x2246afd92b8b2da8,0xac722f64263eb000,0x2c72af64a63e3000,0xab8baea72d132da8,0x2f0eac72ae2f2da8
.quad 0,0,0x2ff6afd92fa8af64,0x2246a63e28a5aa1f,0xa63e2a1fac722da8,0x263eaa1f2c72ada8,0xafa82ea7ad132a1f,0x28a5ac722e2faf64
.quad 0x2a1fada82f64b000,0x2a1fada82f64b000,0x2f0eac7222462a1f,0x2b8baea72ff6af64,0xac722f64afd92da8,0x2c72af642fd9ada8,0xae2f263e2b8baf64,0x2d13afd92f0eaa1f
.quad 0x2da8b0002da80000,0x2da8b0002da80000,0x2d13263eaf0e2f64,0x2e2fafd92b8b2a1f,0xaea72f64a63eada8,0x2ea7af64263e2da8,0xab8bac722ff6aa1f,0x2f0eaea7a2462f64
.quad 0x2f64ada8aa1f3000,0x2f64ada8aa1f3000,0x28a52ea7ae2faa1f,0x2fa8ac72ad132f64,0xafd92a1f2ea7ada8,0x2fd9aa1faea72da8,0xa246afd928a52f64,0x2ff6a63eafa82a1f
.quad 0xb00080003000,0xb00080003000,0xa8a5afd922463000,0xafa8263e2ff60000,0xac72af64263e3000,0x2c722f64a63eb000,0xae2faea728a53000,0x2d13ac72afa88000
.quad 0xaf64ada82a1f3000,0xaf64ada82a1f3000,0xaff6ac722b8b3000,0xa2462ea72f0e0000,0xafd9aa1f2c723000,0x2fd92a1fac72b000,0xaf0ea63e2d133000,0xab8bafd9ae2f8000
.quad 0xada880002da83000,0xada880002da83000,0xab8b263e2e2f3000,0x2f0e2fd92d130000,0xa63e2a1f2ea73000,0x263eaa1faea7b000,0x22462c722f0e3000,0xaff6aea7ab8b8000
.quad 0x2a1f2da82f643000,0x2a1f2da82f643000,0x2d132ea72fa83000,0x2e2f2c7228a50000,0x2ea72f642fd93000,0xaea7af64afd9b000,0x2fa82fd92ff63000,0xa8a5a63ea2468000
.quad 0xb00080003000,0xb00080003000,0xad13aea72b8b2f64,0xae2f2c722f0eaa1f,0xafd9aa1f2ea72da8,0x2fd92a1faea7ada8,0xaf0e263e2ff62a1f,0xab8bafd9a2462f64
.quad 0xaa1f2da82f640000,0xaa1f2da82f640000,0x28a52fd92d13aa1f,0x2fa8263eae2faf64,0x2ea72f64263eada8,0xaea7af64a63e2da8,0x2ff62c72a8a5af64,0x22462ea72fa82a1f
.quad 0x2da80000ada8b000,0x2da80000ada8b000,0x2246ac72afa8af64,0xaff6aea7a8a52a1f,0xac72af64afd9ada8,0x2c722f642fd92da8,0xafa8afd9ae2faa1f,0x28a5a63ead13af64
.quad 0xaf64ada8aa1f8000,0xaf64ada8aa1f8000,0xab8ba63e22462a1f,0x2f0e2fd92ff62f64,0x263e2a1f2c722da8,0xa63eaa1fac72ada8,0x2e2f2ea72f0e2f64,0xad13ac72ab8baa1f
.quad 0xb00080003000,0xb00080003000,0xaf0eac722e2f2da8,0xab8b2ea72d13ada8,0xaea72a1f2fd90000,0x2ea7aa1fafd98000,0x22462fd92b8bada8,0xaff6a63e2f0e2da8
.quad 0x2f642da8aa1fb000,0x2f642da8aa1fb000,0x2e2fa63eafa8ada8,0xad13afd9a8a52da8,0xa63eaf64aea78000,0x263e2f642ea70000,0xafa8aea7a2462da8,0x28a5ac72aff6ada8
.quad 0xada880002da83000,0xada880002da83000,0x28a52ea72ff62da8,0x2fa82c72a246ada8,0x2fd92f642c720000,0xafd9af64ac728000,0x2d13263ea8a5ada8,0x2e2f2fd92fa82da8
.quad 0xaa1fada8af64b000,0xaa1fada8af64b000,0xaff6afd9af0eada8,0xa246263e2b8b2da8,0xac72aa1fa63e8000,0x2c722a1f263e0000,0x2b8b2c722d132da8,0xaf0eaea7ae2fada8
.quad 0xb00080003000,0xb00080003000,0xaff6a63e2fa82a1f,0xa2462fd928a5af64,0xa63e2f642c72ada8,0x263eaf64ac722da8,0x2fa82c72ad13af64,0xa8a52ea72e2faa1f
.quad 0x2a1fada8af648000,0x2a1fada8af648000,0xaf0eaea722462f64,0xab8b2c722ff62a1f,0xac722a1f2fd92da8,0x2c72aa1fafd9ada8,0x2e2f2fd92b8baa1f,0xad13263e2f0e2f64
.quad 0x2da80000ada8b000,0x2da80000ada8b000,0xad13afd9af0eaa1f,0xae2fa63e2b8b2f64,0xaea7aa1f263e2da8,0x2ea72a1fa63eada8,0x2b8b2ea72ff62f64,0xaf0eac72a2462a1f
.quad 0x2f642da82a1f0000,0x2f642da82a1f0000,0xa8a5ac72ae2faf64,0xafa8aea7ad13aa1f,0xafd9af64aea7ada8,0x2fd92f642ea72da8,0x2246263e28a52a1f,0xaff6afd9afa8af64
.quad 0xb00080003000,0xb00080003000,0x28a52fd9a246b000,0x2fa8a63eaff68000,0xac72af64263e3000,0x2c722f64a63eb000,0x2e2f2ea7a8a5b000,0xad132c722fa80000
.quad 0xaf64ada82a1f3000,0xaf64ada82a1f3000,0x2ff62c72ab8bb000,0x2246aea7af0e8000,0xafd9aa1f2c723000,0x2fd92a1fac72b000,0x2f0e263ead13b000,0x2b8b2fd92e2f0000
.quad 0xada880002da83000,0xada880002da83000,0x2b8ba63eae2fb000,0xaf0eafd9ad138000,0xa63e2a1f2ea73000,0x263eaa1faea7b000,0xa246ac72af0eb000,0x2ff62ea72b8b0000
.quad 0x2a1f2da82f643000,0x2a1f2da82f643000,0xad13aea7afa8b000,0xae2fac72a8a58000,0x2ea72f642fd93000,0xaea7af64afd9b000,0xafa8afd9aff6b000,0x28a5263e22460000
.quad 0xb00080003000,0xb00080003000,0x2d132ea7ab8baf64,0x2e2fac72af0e2a1f,0xafd9aa1f2ea72da8,0x2fd92a1faea7ada8,0x2f0ea63eaff6aa1f,0x2b8b2fd92246af64
.quad 0xaa1f2da82f640000,0xaa1f2da82f640000,0xa8a5afd9ad132a1f,0xafa8a63e2e2f2f64,0x2ea72f64263eada8,0xaea7af64a63e2da8,0xaff6ac7228a52f64,0xa246aea7afa8aa1f
.quad 0x2da80000ada8b000,0x2da80000ada8b000,0xa2462c722fa82f64,0x2ff62ea728a5aa1f,0xac72af64afd9ada8,0x2c722f642fd92da8,0x2fa82fd92e2f2a1f,0xa8a5263e2d132f64
.quad 0xaf64ada8aa1f8000,0xaf64ada8aa1f8000,0x2b8b263ea246aa1f,0xaf0eafd9aff6af64,0x263e2a1f2c722da8,0xa63eaa1fac72ada8,0xae2faea7af0eaf64,0x2d132c722b8b2a1f
.quad 0xb00080003000,0xb00080003000,0x2f0e2c72ae2fada8,0x2b8baea7ad132da8,0xaea72a1f2fd90000,0x2ea7aa1fafd98000,0xa246afd9ab8b2da8,0x2ff6263eaf0eada8
.quad 0x2f642da8aa1fb000,0x2f642da8aa1fb000,0xae2f263e2fa82da8,0x2d132fd928a5ada8,0xa63eaf64aea78000,0x263e2f642ea70000,0x2fa82ea72246ada8,0xa8a52c722ff62da8
.quad 0xada880002da83000,0xada880002da83000,0xa8a5aea7aff6ada8,0xafa8ac7222462da8,0x2fd92f642c720000,0xafd9af64ac728000,0xad13a63e28a52da8,0xae2fafd9afa8ada8
.quad 0xaa1fada8af64b000,0xaa1fada8af64b000,0x2ff62fd92f0e2da8,0x2246a63eab8bada8,0xac72aa1fa63e8000,0x2c722a1f263e0000,0xab8bac72ad13ada8,0x2f0e2ea72e2f2da8
.quad 0xb00080003000,0xb00080003000,0x2ff6263eafa8aa1f,0x2246afd9a8a52f64,0xa63e2f642c72ada8,0x263eaf64ac722da8,0xafa8ac722d132f64,0x28a5aea7ae2f2a1f
.quad 0x2a1fada8af648000,0x2a1fada8af648000,0x2f0e2ea7a246af64,0x2b8bac72aff6aa1f,0xac722a1f2fd92da8,0x2c72aa1fafd9ada8,0xae2fafd9ab8b2a1f,0x2d13a63eaf0eaf64
.quad 0x2da80000ada8b000,0x2da80000ada8b000,0x2d132fd92f0e2a1f,0x2e2f263eab8baf64,0xaea7aa1f263e2da8,0x2ea72a1fa63eada8,0xab8baea7aff6af64,0x2f0e2c722246aa1f
.quad 0x2f642da82a1f0000,0x2f642da82a1f0000,0x28a52c722e2f2f64,0x2fa82ea72d132a1f,0xafd9af64aea7ada8,0x2fd92f642ea72da8,0xa246a63ea8a5aa1f,0x2ff62fd92fa82f64
.quad 0x30000000b0000000,0x30000000b0000000,0x2fa8a63eaff60000,0xa8a5afd922463000,0x2ea7aa1fafd90000,0xaea72a1f2fd90000,0x2d13ac72afa80000,0x2e2f2ea7a8a5b000
.quad 0x2a1fada8af640000,0x2a1fada8af640000,0x2246aea7af0e0000,0xaff6ac722b8b3000,0xa63eaf64aea70000,0x263e2f642ea70000,0xab8bafd9ae2f0000,0x2f0e263ead13b000
.quad 0xada8b000ada80000,0xada8b000ada80000,0xaf0eafd9ad130000,0xab8b263e2e2f3000,0xafd9af64ac720000,0x2fd92f642c720000,0xaff6aea7ab8b0000,0xa246ac72af0eb000
.quad 0xaf64ada8aa1f0000,0xaf64ada8aa1f0000,0xae2fac72a8a50000,0x2d132ea72fa83000,0xac72aa1fa63e0000,0x2c722a1f263e0000,0xa8a5a63ea2460000,0xafa8afd9aff6b000
.quad 0x30000000b0000000,0x30000000b0000000,0x2e2fac72af0e2a1f,0xad13aea72b8b2f64,0x263eaf64ac722da8,0xa63e2f642c72ada8,0xab8bafd9a2462f64,0x2f0ea63eaff6aa1f
.quad 0xaf64ada82a1f3000,0xaf64ada82a1f3000,0xafa8a63e2e2f2f64,0x28a52fd92d13aa1f,0xac722a1f2fd92da8,0x2c72aa1fafd9ada8,0x22462ea72fa82a1f,0xaff6ac7228a52f64
.quad 0x2da830002da80000,0x2da830002da80000,0x2ff62ea728a5aa1f,0x2246ac72afa8af64,0x2ea72a1fa63eada8,0xaea7aa1f263e2da8,0x28a5a63ead13af64,0x2fa82fd92e2f2a1f
.quad 0xaa1fada8af64b000,0xaa1fada8af64b000,0xaf0eafd9aff6af64,0xab8ba63e22462a1f,0xafd9af64aea7ada8,0x2fd92f642ea72da8,0xad13ac72ab8baa1f,0xae2faea7af0eaf64
.quad 0x30000000b0000000,0x30000000b0000000,0x2b8baea7ad132da8,0xaf0eac722e2f2da8,0xac72af64263e3000,0x2c722f64a63eb000,0xaff6a63e2f0e2da8,0xa246afd9ab8b2da8
.quad 0xaa1f2da82f640000,0xaa1f2da82f640000,0x2d132fd928a5ada8,0x2e2fa63eafa8ada8,0x2fd92a1fac72b000,0xafd9aa1f2c723000,0x28a5ac72aff6ada8,0x2fa82ea72246ada8
.quad 0xada8b000ada80000,0xada8b000ada80000,0xafa8ac7222462da8,0x28a52ea72ff62da8,0xa63e2a1f2ea73000,0x263eaa1faea7b000,0x2e2f2fd92fa82da8,0xad13a63e28a52da8
.quad 0x2f642da82a1f0000,0x2f642da82a1f0000,0x2246a63eab8bada8,0xaff6afd9af0eada8,0xaea7af64afd9b000,0x2ea72f642fd93000,0xaf0eaea7ae2fada8,0xab8bac72ad13ada8
.quad 0x30000000b0000000,0x30000000b0000000,0x2246afd9a8a52f64,0xaff6a63e2fa82a1f,0xafd9aa1f2ea72da8,0x2fd92a1faea7ada8,0xa8a52ea72e2faa1f,0xafa8ac722d132f64
.quad 0x2f642da8aa1fb000,0x2f642da8aa1fb000,0x2b8bac72aff6aa1f,0xaf0eaea722462f64,0xaea7af64a63e2da8,0x2ea72f64263eada8,0xad13263e2f0e2f64,0xae2fafd9ab8b2a1f
.quad 0x2da830002da80000,0x2da830002da80000,0x2e2f263eab8baf64,0xad13afd9af0eaa1f,0xac72af64afd9ada8,0x2c722f642fd92da8,0xaf0eac72a2462a1f,0xab8baea7aff6af64
.quad 0x2a1f2da82f643000,0x2a1f2da82f643000,0x2fa82ea72d132a1f,0xa8a5ac72ae2faf64,0xa63eaa1fac72ada8,0x263e2a1f2c722da8,0xaff6afd9afa8af64,0xa246a63ea8a5aa1f
.quad 0x30000000b0000000,0x30000000b0000000,0xafa8263e2ff60000,0x28a52fd9a246b000,0x2ea7aa1fafd90000,0xaea72a1f2fd90000,0xad132c722fa80000,0xae2faea728a53000
.quad 0x2a1fada8af640000,0x2a1fada8af640000,0xa2462ea72f0e0000,0x2ff62c72ab8bb000,0xa63eaf64aea70000,0x263e2f642ea70000,0x2b8b2fd92e2f0000,0xaf0ea63e2d133000
.quad 0xada8b000ada80000,0xada8b000ada80000,0x2f0e2fd92d130000,0x2b8ba63eae2fb000,0xafd9af64ac720000,0x2fd92f642c720000,0x2ff62ea72b8b0000,0x22462c722f0e3000
.quad 0xaf64ada8aa1f0000,0xaf64ada8aa1f0000,0x2e2f2c7228a50000,0xad13aea7afa8b000,0xac72aa1fa63e0000,0x2c722a1f263e0000,0x28a5263e22460000,0x2fa82fd92ff63000
.quad 0x30000000b0000000,0x30000000b0000000,0xae2f2c722f0eaa1f,0x2d132ea7ab8baf64,0x263eaf64ac722da8,0xa63e2f642c72ada8,0x2b8b2fd92246af64,0xaf0e263e2ff62a1f
.quad 0xaf64ada82a1f3000,0xaf64ada82a1f3000,0x2fa8263eae2faf64,0xa8a5afd9ad132a1f,0xac722a1f2fd92da8,0x2c72aa1fafd9ada8,0xa246aea7afa8aa1f,0x2ff62c72a8a5af64
.quad 0x2da830002da80000,0x2da830002da80000,0xaff6aea7a8a52a1f,0xa2462c722fa82f64,0x2ea72a1fa63eada8,0xaea7aa1f263e2da8,0xa8a5263e2d132f64,0xafa8afd9ae2faa1f
.quad 0xaa1fada8af64b000,0xaa1fada8af64b000,0x2f0e2fd92ff62f64,0x2b8b263ea246aa1f,0xafd9af64aea7ada8,0x2fd92f642ea72da8,0x2d132c722b8b2a1f,0x2e2f2ea72f0e2f64
.quad 0x30000000b0000000,0x30000000b0000000,0xab8b2ea72d13ada8,0x2f0e2c72ae2fada8,0xac72af64263e3000,0x2c722f64a63eb000,0x2ff6263eaf0eada8,0x22462fd92b8bada8
.quad 0xaa1f2da82f640000,0xaa1f2da82f640000,0xad13afd9a8a52da8,0xae2f263e2fa82da8,0x2fd92a1fac72b000,0xafd9aa1f2c723000,0xa8a52c722ff62da8,0xafa8aea7a2462da8
.quad 0xada8b000ada80000,0xada8b000ada80000,0x2fa82c72a246ada8,0xa8a5aea7aff6ada8,0xa63e2a1f2ea73000,0x263eaa1faea7b000,0xae2fafd9afa8ada8,0x2d13263ea8a5ada8
.quad 0x2f642da82a1f0000,0x2f642da82a1f0000,0xa246263e2b8b2da8,0x2ff62fd92f0e2da8,0xaea7af64afd9b000,0x2ea72f642fd93000,0x2f0e2ea72e2f2da8,0x2b8b2c722d132da8
.quad 0x30000000b0000000,0x30000000b0000000,0xa2462fd928a5af64,0x2ff6263eafa8aa1f,0xafd9aa1f2ea72da8,0x2fd92a1faea7ada8,0x28a5aea7ae2f2a1f,0x2fa82c72ad13af64
.quad 0x2f642da8aa1fb000,0x2f642da8aa1fb000,0xab8b2c722ff62a1f,0x2f0e2ea7a246af64,0xaea7af64a63e2da8,0x2ea72f64263eada8,0x2d13a63eaf0eaf64,0x2e2f2fd92b8baa1f
.quad 0x2da830002da80000,0x2da830002da80000,0xae2fa63e2b8b2f64,0x2d132fd92f0e2a1f,0xac72af64afd9ada8,0x2c722f642fd92da8,0x2f0e2c722246aa1f,0x2b8b2ea72ff62f64
.quad 0x2a1f2da82f643000,0x2a1f2da82f643000,0xafa8aea7ad13aa1f,0x28a52c722e2f2f64,0xa63eaa1fac72ada8,0x263e2a1f2c722da8,0x2ff62fd92fa82f64,0x2246263e28a52a1f
.quad 0x8000340080003400,0x8000340080003400,0xab1f33cd80003400,0xb0fd3241aef13335,0xaef1333580003400,0xb3cd2b1fb24130fd,0xb0fd324180003400,0xb335aef1b3cd2b1f
.quad 0xb24130fd80003400,0xaef1b335b3cdab1f,0xb3352ef180003400,0x2b1fb3cdb241b0fd,0xb3cd2b1f80003400,0x3241b0fdaef1b335,0xb400000080003400,0x340080008000b400
.quad 0xb3cdab1f80003400,0x324130fd2ef1b335,0xb335aef180003400,0x2b1f33cd3241b0fd,0xb241b0fd80003400,0xaef1333533cdab1f,0xb0fdb24180003400,0xb3352ef133cd2b1f
.quad 0xaef1b33580003400,0xb3cdab1f324130fd,0xab1fb3cd80003400,0xb0fdb2412ef13335,0x8000b40080003400,0x8000b40080003400,0x2b1fb3cd80003400,0x30fdb241aef13335
.quad 0x8000340080003400,0x8000340080003400,0xb3352ef1b24130fd,0xb4000000b3cd2b1f,0xb241b0fdb3cdab1f,0x8000b400aef1b335,0x2b1fb3cdaef1b335,0x340080003241b0fd
.quad 0x33cdab1f2ef1b335,0x80003400324130fd,0x30fd324133cdab1f,0xb4000000aef13335,0xaef13335324130fd,0x8000b400b3cdab1f,0xb400000080003400,0x340080008000b400
.quad 0xaef1b335b24130fd,0x8000340033cdab1f,0x30fdb241b3cdab1f,0xb40000002ef13335,0x33cd2b1faef1b335,0x8000b400b24130fd,0x2b1f33cd2ef1b335,0x34008000b241b0fd
.quad 0xb24130fd33cdab1f,0x800034002ef1b335,0xb335aef1324130fd,0xb400000033cd2b1f,0x8000b40080003400,0x8000b40080003400,0x3335aef1b24130fd,0x34008000b3cd2b1f
.quad 0x8000340080003400,0x8000340080003400,0xb335aef1b3cdab1f,0xb0fdb241b241b0fd,0x3241b0fd2ef1b335,0x33cd2b1f33cdab1f,0x2b1f33cd324130fd,0xb3352ef1aef13335
.quad 0xb3cdab1fb24130fd,0x2ef1b335aef1b335,0x30fdb241aef1b335,0x2b1f33cd33cd2b1f,0x2ef1333533cdab1f,0xb241b0fdb24130fd,0xb400000080003400,0x340080008000b400
.quad 0x2ef1b335b3cdab1f,0xb24130fd324130fd,0x30fd32412ef1b335,0x2b1fb3cdb3cd2b1f,0xb3cd2b1f324130fd,0x2ef133352ef1b335,0x2b1fb3cdb24130fd,0xb335aef12ef13335
.quad 0x324130fdaef1b335,0x33cdab1fb3cdab1f,0xb3352ef133cdab1f,0xb0fd32413241b0fd,0x8000b40080003400,0x8000b40080003400,0x33352ef1b3cdab1f,0x30fd3241b241b0fd
.quad 0x8000340080003400,0x8000340080003400,0xab1fb3cdaef1b335,0x2b1fb3cd8000b400,0x2ef13335324130fd,0xaef1333580003400,0xb0fdb241b3cdab1f,0x30fdb2418000b400
.quad 0x324130fd33cdab1f,0xb24130fd80003400,0xb335aef1b24130fd,0x3335aef18000b400,0x33cd2b1f2ef1b335,0xb3cd2b1f80003400,0xb400000080003400,0x340080008000b400
.quad 0x33cdab1faef1b335,0xb3cdab1f80003400,0xb3352ef1324130fd,0x33352ef18000b400,0x3241b0fdb3cdab1f,0xb241b0fd80003400,0xb0fd324133cdab1f,0x30fd32418000b400
.quad 0x2ef1b335b24130fd,0xaef1b33580003400,0xab1f33cd2ef1b335,0x2b1f33cd8000b400,0x8000b40080003400,0x8000b40080003400,0x2b1f33cdaef1b335,0xab1f33cd8000b400
.quad 0x3400000034000000,0x3400000034000000,0x33cd2b1f34000000,0x324130fd33352ef1,0x33352ef134000000,0x2b1f33cd30fd3241,0x324130fd34000000,0xaef133352b1f33cd
.quad 0x30fd324134000000,0xb3352ef1ab1f33cd,0x2ef1333534000000,0xb3cdab1fb0fd3241,0x2b1f33cd34000000,0xb0fdb241b3352ef1,0x340034000000,0x8000b400b4000000
.quad 0xab1f33cd34000000,0x30fdb241b335aef1,0xaef1333534000000,0x33cdab1fb0fdb241,0xb0fd324134000000,0x33352ef1ab1fb3cd,0xb24130fd34000000,0x2ef133352b1fb3cd
.quad 0xb3352ef134000000,0xab1f33cd30fdb241,0xb3cd2b1f34000000,0xb24130fd3335aef1,0xb400000034000000,0xb400000034000000,0xb3cdab1f34000000,0xb241b0fd33352ef1
.quad 0x3400000034000000,0x3400000034000000,0x2ef1333530fd3241,0x34002b1f33cd,0xb0fd3241ab1f33cd,0xb4000000b3352ef1,0xb3cdab1fb3352ef1,0x8000b400b0fdb241
.quad 0xab1fb3cdb335aef1,0x3400000030fdb241,0x3241b0fdab1fb3cd,0x340033352ef1,0x33352ef130fdb241,0xb4000000ab1f33cd,0x340034000000,0x8000b400b4000000
.quad 0xb3352ef130fd3241,0x34000000ab1fb3cd,0xb241b0fdab1f33cd,0x34003335aef1,0x2b1fb3cdb3352ef1,0xb400000030fd3241,0x33cdab1fb335aef1,0x8000b400b0fd3241
.quad 0x30fd3241ab1fb3cd,0x34000000b335aef1,0xaef1333530fdb241,0x34002b1fb3cd,0xb400000034000000,0xb400000034000000,0xaef1b33530fd3241,0x8000b4002b1f33cd
.quad 0x3400000034000000,0x3400000034000000,0xaef13335ab1f33cd,0xb24130fdb0fd3241,0xb0fdb241b335aef1,0x2b1fb3cdab1fb3cd,0x33cdab1f30fdb241,0x2ef1333533352ef1
.quad 0xab1f33cd30fd3241,0xb335aef1b3352ef1,0xb241b0fdb3352ef1,0x33cdab1f2b1fb3cd,0x3335aef1ab1fb3cd,0xb0fd324130fd3241,0x340034000000,0x8000b400b4000000
.quad 0xb335aef1ab1f33cd,0x30fd324130fdb241,0x3241b0fdb335aef1,0xb3cdab1f2b1f33cd,0x2b1f33cd30fdb241,0x3335aef1b335aef1,0xb3cdab1f30fd3241,0xaef133353335aef1
.quad 0x30fdb241b3352ef1,0xab1fb3cdab1f33cd,0x2ef13335ab1fb3cd,0x324130fdb0fdb241,0xb400000034000000,0xb400000034000000,0x2ef1b335ab1f33cd,0x3241b0fdb0fd3241
.quad 0x3400000034000000,0x3400000034000000,0xb3cd2b1fb3352ef1,0xb3cdab1fb4000000,0x3335aef130fdb241,0x33352ef134000000,0xb24130fdab1f33cd,0xb241b0fdb4000000
.quad 0x30fdb241ab1fb3cd,0x30fd324134000000,0xaef1333530fd3241,0xaef1b335b4000000,0x2b1fb3cdb335aef1,0x2b1f33cd34000000,0x340034000000,0x8000b400b4000000
.quad 0xab1fb3cdb3352ef1,0xab1f33cd34000000,0x2ef1333530fdb241,0x2ef1b335b4000000,0xb0fdb241ab1f33cd,0xb0fd324134000000,0x324130fdab1fb3cd,0x3241b0fdb4000000
.quad 0xb335aef130fd3241,0xb3352ef134000000,0x33cd2b1fb335aef1,0x33cdab1fb4000000,0xb400000034000000,0xb400000034000000,0x33cdab1fb3352ef1,0x33cd2b1fb4000000
.quad 0x2ef1b33580003400,0x33cdab1fb24130fd,0x30fdb24180003400,0x33352ef1b3cd2b1f,0x3241b0fd80003400,0x2ef13335b3cdab1f,0x3335aef180003400,0xab1f33cdb241b0fd
.quad 0x33cdab1f80003400,0xb24130fdaef1b335,0x3400800080003400,0xb40000008000b400,0x33cd2b1f80003400,0xb241b0fd2ef1b335,0x33352ef180003400,0xab1fb3cd3241b0fd
.quad 0x324130fd80003400,0x2ef1b33533cdab1f,0x30fd324180003400,0x3335aef133cd2b1f,0x2ef1333580003400,0x33cd2b1f324130fd,0x2b1f33cd80003400,0x30fd32412ef13335
.quad 0,0,0,0,0,0,0,0
.quad 0x324130fdb3cdab1f,0x80003400aef1b335,0xab1f33cdaef1b335,0xb40000003241b0fd,0xb3cd2b1f2ef1b335,0x8000b400324130fd,0xb0fdb24133cdab1f,0x34008000aef13335
.quad 0x2ef1b335324130fd,0x80003400b3cdab1f,0x3400800080003400,0xb40000008000b400,0x2ef13335b24130fd,0x8000b40033cdab1f,0xb0fd3241b3cdab1f,0x340080002ef13335
.quad 0xb3cdab1faef1b335,0x80003400b24130fd,0xab1fb3cd2ef1b335,0xb4000000b241b0fd,0x3241b0fd33cdab1f,0x8000b4002ef1b335,0x33352ef1324130fd,0x3400800033cd2b1f
.quad 0,0,0,0,0,0,0,0
.quad 0xb24130fd2ef1b335,0xb3cdab1f33cdab1f,0xab1fb3cd324130fd,0x3335aef1aef13335,0x33cd2b1fb24130fd,0xaef13335aef1b335,0xb0fd3241aef1b335,0xab1fb3cd33cd2b1f
.quad 0xaef1b33533cdab1f,0x324130fdb24130fd,0x3400800080003400,0xb40000008000b400,0xaef13335b3cdab1f,0x3241b0fd324130fd,0xb0fdb2412ef1b335,0xab1f33cdb3cd2b1f
.quad 0x33cdab1f324130fd,0xaef1b3352ef1b335,0xab1f33cdb24130fd,0x33352ef12ef13335,0xb241b0fdaef1b335,0xb3cd2b1fb3cdab1f,0x3335aef133cdab1f,0x30fdb2413241b0fd
.quad 0,0,0,0,0,0,0,0
.quad 0xaef1b335324130fd,0x2ef1b33580003400,0x30fd3241b3cdab1f,0xb0fd32418000b400,0xb241b0fd33cdab1f,0x3241b0fd80003400,0x33352ef1b24130fd,0xb3352ef18000b400
.quad 0xb3cdab1f2ef1b335,0x33cdab1f80003400,0x3400800080003400,0xb40000008000b400,0xb3cd2b1faef1b335,0x33cd2b1f80003400,0x3335aef1324130fd,0xb335aef18000b400
.quad 0xb24130fdb3cdab1f,0x324130fd80003400,0x30fdb24133cdab1f,0xb0fdb2418000b400,0xaef13335b24130fd,0x2ef1333580003400,0x2b1fb3cd2ef1b335,0xab1fb3cd8000b400
.quad 0,0,0,0,0,0,0,0
.quad 0xb335aef134000000,0xab1fb3cd30fd3241,0xb241b0fd34000000,0x2ef1b3352b1f33cd,0xb0fdb24134000000,0x3335aef1ab1f33cd,0xaef1b33534000000,0x33cd2b1fb0fd3241
.quad 0xab1fb3cd34000000,0x30fd3241b3352ef1,0x8000b40034000000,0x3400b4000000,0x2b1fb3cd34000000,0xb0fd3241b335aef1,0x2ef1b33534000000,0xb3cd2b1fb0fdb241
.quad 0x30fdb24134000000,0xb335aef1ab1fb3cd,0x3241b0fd34000000,0xaef1b3352b1fb3cd,0x3335aef134000000,0x2b1fb3cd30fdb241,0x33cdab1f34000000,0x3241b0fd3335aef1
.quad 0,0,0,0,0,0,0,0
.quad 0x30fdb241ab1f33cd,0x34000000b3352ef1,0x33cd2b1fb3352ef1,0x3400b0fdb241,0x2b1f33cdb335aef1,0xb400000030fdb241,0xb24130fdab1fb3cd,0x8000b40033352ef1
.quad 0xb335aef130fdb241,0x34000000ab1f33cd,0x8000b40034000000,0x3400b4000000,0x3335aef130fd3241,0xb4000000ab1fb3cd,0x324130fdab1f33cd,0x8000b4003335aef1
.quad 0xab1f33cdb3352ef1,0x3400000030fd3241,0xb3cd2b1fb335aef1,0x3400b0fd3241,0xb0fdb241ab1fb3cd,0xb4000000b335aef1,0x2ef1b33530fdb241,0x8000b4002b1fb3cd
.quad 0,0,0,0,0,0,0,0
.quad 0x30fd3241b335aef1,0xab1f33cdab1fb3cd,0xb3cd2b1f30fdb241,0xaef1b33533352ef1,0x2b1fb3cd30fd3241,0x33352ef1b3352ef1,0x324130fdb3352ef1,0xb3cd2b1f2b1fb3cd
.quad 0xb3352ef1ab1fb3cd,0x30fdb24130fd3241,0x8000b40034000000,0x3400b4000000,0x33352ef1ab1f33cd,0xb0fdb24130fdb241,0xb24130fdb335aef1,0x33cd2b1f2b1f33cd
.quad 0xab1fb3cd30fdb241,0xb3352ef1b335aef1,0x33cd2b1f30fd3241,0x2ef1b3353335aef1,0xb0fd3241b3352ef1,0x2b1f33cdab1f33cd,0xaef1b335ab1fb3cd,0xb241b0fdb0fdb241
.quad 0,0,0,0,0,0,0,0
.quad 0xb3352ef130fdb241,0xb335aef134000000,0x3241b0fdab1f33cd,0x324130fdb4000000,0xb0fd3241ab1fb3cd,0xb0fdb24134000000,0x2ef1b33530fd3241,0x2ef13335b4000000
.quad 0xab1f33cdb335aef1,0xab1fb3cd34000000,0x8000b40034000000,0x3400b4000000,0x2b1f33cdb3352ef1,0x2b1fb3cd34000000,0xaef1b33530fdb241,0xaef13335b4000000
.quad 0x30fd3241ab1f33cd,0x30fdb24134000000,0xb241b0fdab1fb3cd,0xb24130fdb4000000,0x33352ef130fd3241,0x3335aef134000000,0xb3cdab1fb335aef1,0xb3cd2b1fb4000000
.quad 0,0,0,0,0,0,0,0
.quad 0x8000340080003400,0x8000340080003400,0x30fdb2412ef1b335,0x3335aef13241b0fd,0xb3cd2b1fb24130fd,0xb241b0fdb3cdab1f,0x33352ef133cdab1f,0xab1f33cd2ef13335
.quad 0xaef1b335b3cdab1f,0x33cdab1f2ef1b335,0xab1f33cd324130fd,0xb0fdb241b3cd2b1f,0x3241b0fdaef1b335,0xaef13335324130fd,0xb400000080003400,0x340080008000b400
.quad 0x324130fd2ef1b335,0xaef1b335b24130fd,0xab1fb3cdb24130fd,0xb0fd324133cd2b1f,0xaef1333533cdab1f,0x33cd2b1faef1b335,0x3335aef1b3cdab1f,0xab1fb3cdaef13335
.quad 0xb3cdab1f324130fd,0xb24130fd33cdab1f,0x30fd3241aef1b335,0x33352ef1b241b0fd,0x8000b40080003400,0x8000b40080003400,0xb0fd32412ef1b335,0xb3352ef13241b0fd
.quad 0x8000340080003400,0x8000340080003400,0x3400800033cdab1f,0x33352ef133cd2b1f,0x8000b400aef1b335,0x3241b0fd2ef1b335,0xb4000000b24130fd,0xab1fb3cdb241b0fd
.quad 0x80003400324130fd,0xb3cdab1fb24130fd,0x340080002ef1b335,0xb0fd32412ef13335,0x8000b400b3cdab1f,0x2ef1333533cdab1f,0xb400000080003400,0x340080008000b400
.quad 0x8000340033cdab1f,0x2ef1b335b3cdab1f,0x34008000aef1b335,0xb0fdb241aef13335,0x8000b400b24130fd,0xb3cd2b1f324130fd,0xb4000000324130fd,0xab1f33cd3241b0fd
.quad 0x800034002ef1b335,0x324130fdaef1b335,0x34008000b3cdab1f,0x3335aef1b3cd2b1f,0x8000b40080003400,0x8000b40080003400,0xb400000033cdab1f,0xb335aef133cd2b1f
.quad 0x8000340080003400,0x8000340080003400,0x30fd3241324130fd,0x2b1f33cd2ef13335,0x33cd2b1f33cdab1f,0x2ef13335324130fd,0x3335aef12ef1b335,0x30fd324133cd2b1f
.quad 0x2ef1b335aef1b335,0x324130fd33cdab1f,0xab1fb3cdb3cdab1f,0x33352ef13241b0fd,0xb241b0fdb24130fd,0x33cd2b1f2ef1b335,0xb400000080003400,0x340080008000b400
.quad 0xb24130fd324130fd,0x33cdab1faef1b335,0xab1f33cd33cdab1f,0x3335aef1b241b0fd,0x2ef133352ef1b335,0x3241b0fdb3cdab1f,0x33352ef1aef1b335,0x30fdb241b3cd2b1f
.quad 0x33cdab1fb3cdab1f,0x2ef1b335b24130fd,0x30fdb241b24130fd,0x2b1fb3cdaef13335,0x8000b40080003400,0x8000b40080003400,0xb0fdb241324130fd,0xab1fb3cd2ef13335
.quad 0x8000340080003400,0,0x8000b40080003400,0,0x8000340080003400,0,0x8000b40080003400,0
.quad 0x8000340080003400,0,0x8000b40080003400,0,0x8000340080003400,0,0x8000b40080003400,0
.quad 0x8000340080003400,0,0x8000b40080003400,0,0x8000340080003400,0,0x8000b40080003400,0
.quad 0x8000340080003400,0,0x8000b40080003400,0,0x8000340080003400,0,0x8000b40080003400,0
.quad 0x3400000034000000,0x3400000034000000,0xb241b0fdb335aef1,0xaef1b335b0fdb241,0x2b1f33cd30fd3241,0xb0fd3241ab1f33cd,0x2ef1b335ab1fb3cd,0x33cd2b1f3335aef1
.quad 0xb3352ef1ab1f33cd,0xab1fb3cdb335aef1,0x33cd2b1f30fdb241,0xb24130fd2b1f33cd,0xb0fdb241b3352ef1,0x33352ef130fdb241,0x340034000000,0x8000b400b4000000
.quad 0x30fdb241b335aef1,0xb3352ef130fd3241,0xb3cd2b1f30fd3241,0x324130fd2b1fb3cd,0x33352ef1ab1fb3cd,0x2b1fb3cdb3352ef1,0xaef1b335ab1f33cd,0xb3cd2b1f33352ef1
.quad 0xab1f33cd30fdb241,0x30fd3241ab1fb3cd,0x3241b0fdb3352ef1,0x2ef1b335b0fd3241,0xb400000034000000,0xb400000034000000,0x324130fdb335aef1,0x2ef13335b0fdb241
.quad 0x3400000034000000,0x3400000034000000,0x8000b400ab1fb3cd,0x2ef1b3352b1fb3cd,0xb4000000b3352ef1,0xb0fdb241b335aef1,0x340030fd3241,0xb3cd2b1fb0fd3241
.quad 0x3400000030fdb241,0xab1f33cd30fd3241,0x8000b400b335aef1,0x324130fd3335aef1,0xb4000000ab1f33cd,0x3335aef1ab1fb3cd,0x340034000000,0x8000b400b4000000
.quad 0x34000000ab1fb3cd,0xb335aef1ab1f33cd,0x8000b400b3352ef1,0xb24130fd33352ef1,0xb400000030fd3241,0x2b1f33cd30fdb241,0x340030fdb241,0x33cd2b1fb0fdb241
.quad 0x34000000b335aef1,0x30fdb241b3352ef1,0x8000b400ab1f33cd,0xaef1b3352b1f33cd,0xb400000034000000,0xb400000034000000,0x3400ab1fb3cd,0xaef133352b1fb3cd
.quad 0x3400000034000000,0x3400000034000000,0x3241b0fd30fdb241,0x33cdab1f3335aef1,0x2b1fb3cdab1fb3cd,0x3335aef130fdb241,0xaef1b335b335aef1,0x3241b0fd2b1fb3cd
.quad 0xb335aef1b3352ef1,0x30fdb241ab1fb3cd,0xb3cd2b1fab1f33cd,0x2ef1b335b0fdb241,0xb0fd324130fd3241,0x2b1fb3cdb335aef1,0x340034000000,0x8000b400b4000000
.quad 0x30fd324130fdb241,0xab1fb3cdb3352ef1,0x33cd2b1fab1fb3cd,0xaef1b335b0fd3241,0x3335aef1b335aef1,0xb0fdb241ab1f33cd,0x2ef1b335b3352ef1,0xb241b0fd2b1f33cd
.quad 0xab1fb3cdab1f33cd,0xb335aef130fd3241,0xb241b0fd30fd3241,0xb3cdab1f33352ef1,0xb400000034000000,0xb400000034000000,0xb24130fd30fdb241,0xb3cd2b1f3335aef1
.quad 0x3400000034000000,0,0xb400000034000000,0,0x3400000034000000,0,0xb400000034000000,0
.quad 0x3400000034000000,0,0xb400000034000000,0,0x3400000034000000,0,0xb400000034000000,0
.quad 0x3400000034000000,0,0xb400000034000000,0,0x3400000034000000,0,0xb400000034000000,0
.quad 0x3400000034000000,0,0xb400000034000000,0,0x3400000034000000,0,0xb400000034000000,0
.quad 0x33cdab1fb24130fd,0x324130fdb3cdab1f,0xb335aef133cdab1f,0x2b1fb3cd2ef13335,0x2ef13335b3cdab1f,0xb3cd2b1f2ef1b335,0x2b1fb3cd324130fd,0x30fd3241b3cd2b1f
.quad 0xb24130fdaef1b335,0x2ef1b335324130fd,0x3400800080003400,0xb40000008000b400,0xb241b0fd2ef1b335,0x2ef13335b24130fd,0x2b1f33cdb24130fd,0x30fdb24133cd2b1f
.quad 0x2ef1b33533cdab1f,0xb3cdab1faef1b335,0xb3352ef1b3cdab1f,0x2b1f33cdaef13335,0x33cd2b1f324130fd,0x3241b0fd33cdab1f,0xb0fdb241aef1b335,0xb335aef1b241b0fd
.quad 0,0,0,0,0,0,0,0
.quad 0x80003400aef1b335,0xb24130fd2ef1b335,0x34008000b24130fd,0x2b1f33cdb241b0fd,0x8000b400324130fd,0x33cd2b1fb24130fd,0xb40000002ef1b335,0x30fdb2412ef13335
.quad 0x80003400b3cdab1f,0xaef1b33533cdab1f,0x3400800080003400,0xb40000008000b400,0x8000b40033cdab1f,0xaef13335b3cdab1f,0xb4000000aef1b335,0x30fd3241aef13335
.quad 0x80003400b24130fd,0x33cdab1f324130fd,0x34008000324130fd,0x2b1fb3cd3241b0fd,0x8000b4002ef1b335,0xb241b0fdaef1b335,0xb4000000b3cdab1f,0xb3352ef1b3cd2b1f
.quad 0,0,0,0,0,0,0,0
.quad 0xb3cdab1f33cdab1f,0xaef1b335324130fd,0xb3352ef12ef1b335,0xb0fdb24133cd2b1f,0xaef13335aef1b335,0xb241b0fd33cdab1f,0x2b1f33cdb3cdab1f,0xb335aef13241b0fd
.quad 0x324130fdb24130fd,0xb3cdab1f2ef1b335,0x3400800080003400,0xb40000008000b400,0x3241b0fd324130fd,0xb3cd2b1faef1b335,0x2b1fb3cd33cdab1f,0xb3352ef1b241b0fd
.quad 0xaef1b3352ef1b335,0xb24130fdb3cdab1f,0xb335aef1aef1b335,0xb0fd3241b3cd2b1f,0xb3cd2b1fb3cdab1f,0xaef13335b24130fd,0xb0fd3241b24130fd,0xab1f33cdaef13335
.quad 0,0,0,0,0,0,0,0
.quad 0x8000340080003400,0,0x8000b40080003400,0,0x8000340080003400,0,0x8000b40080003400,0
.quad 0x8000340080003400,0,0x8000b40080003400,0,0x8000340080003400,0,0x8000b40080003400,0
.quad 0x8000340080003400,0,0x8000b40080003400,0,0x8000340080003400,0,0x8000b40080003400,0
.quad 0,0,0,0,0,0,0,0
.quad 0xab1fb3cd30fd3241,0x30fdb241ab1f33cd,0xaef13335ab1fb3cd,0xb3cdab1f3335aef1,0x3335aef1ab1f33cd,0x2b1f33cdb335aef1,0xb3cdab1f30fdb241,0x3241b0fd2b1f33cd
.quad 0x30fd3241b3352ef1,0xb335aef130fdb241,0x8000b40034000000,0x3400b4000000,0xb0fd3241b335aef1,0x3335aef130fd3241,0x33cdab1f30fd3241,0xb241b0fd2b1fb3cd
.quad 0xb335aef1ab1fb3cd,0xab1f33cdb3352ef1,0x2ef13335ab1f33cd,0x33cdab1f33352ef1,0x2b1fb3cd30fdb241,0xb0fdb241ab1fb3cd,0xb24130fdb3352ef1,0xaef13335b0fd3241
.quad 0,0,0,0,0,0,0,0
.quad 0x34000000b3352ef1,0x30fd3241b335aef1,0x8000b40030fd3241,0x33cdab1fb0fd3241,0xb400000030fdb241,0x2b1fb3cd30fd3241,0x3400b335aef1,0xb241b0fd3335aef1
.quad 0x34000000ab1f33cd,0xb3352ef1ab1fb3cd,0x8000b40034000000,0x3400b4000000,0xb4000000ab1fb3cd,0x33352ef1ab1f33cd,0x3400b3352ef1,0x3241b0fd33352ef1
.quad 0x3400000030fd3241,0xab1fb3cd30fdb241,0x8000b40030fdb241,0xb3cdab1fb0fdb241,0xb4000000b335aef1,0xb0fd3241b3352ef1,0x3400ab1f33cd,0x2ef133352b1f33cd
.quad 0,0,0,0,0,0,0,0
.quad 0xab1f33cdab1fb3cd,0xb3352ef130fdb241,0x2ef13335b335aef1,0xb24130fd2b1fb3cd,0x33352ef1b3352ef1,0xb0fd3241ab1fb3cd,0x33cdab1fab1f33cd,0xaef13335b0fdb241
.quad 0x30fdb24130fd3241,0xab1f33cdb335aef1,0x8000b40034000000,0x3400b4000000,0xb0fdb24130fdb241,0x2b1f33cdb3352ef1,0xb3cdab1fab1fb3cd,0x2ef13335b0fd3241
.quad 0xb3352ef1b335aef1,0x30fd3241ab1f33cd,0xaef13335b3352ef1,0x324130fd2b1f33cd,0x2b1f33cdab1f33cd,0x33352ef130fd3241,0x324130fd30fd3241,0x33cd2b1f33352ef1
.quad 0,0,0,0,0,0,0,0
.quad 0x3400000034000000,0,0xb400000034000000,0,0x3400000034000000,0,0xb400000034000000,0
.quad 0x3400000034000000,0,0xb400000034000000,0,0x3400000034000000,0,0xb400000034000000,0
.quad 0x3400000034000000,0,0xb400000034000000,0,0x3400000034000000,0,0xb400000034000000,0
.quad 0,0,0,0,0,0,0,0
.quad 0x3f8000003f800000,0x3f8000003f800000,0x3f7fe6383f800000,0x3f7f181a3f7f98e6,0x3f7f98e63f800000,0x3f7c620b3f7e63ec,0x3f7f181a3f800000,0x3f77e2bd3f7c620b
.quad 0x3f7e63ec3f800000,0x3f71a2573f7994e0,0x3f7d7c833f800000,0x3f69ac2a3f75fead,0x3f7c620b3f800000,0x3f600ea43f71a257,0x3f7b14be3f800000,0x3f54db313f6c835e
.quad 0x3f7994e03f800000,0x3f48261c3f66a5e5,0x3f77e2bd3f800000,0x3f3a06693f600ea4,0x3f75fead3f800000,0x3f2a95b03f58c2eb,0x3f73e9123f800000,0x3f19efeb3f50c899
.quad 0x3f71a2573f800000,0x3f0833413f48261c,0x3f6f2af03f800000,0x3eeaffac3f3ee268,0x3f6c835e3f800000,0x3ec3ef153f3504f3,0x3f69ac2a3f800000,0x3e9b7b853f2a95b0
.quad 0x3f8000003f800000,0x3f8000003f800000,0x3f7d7c833f7e63ec,0x3f7b14be3f7c620b,0x3f75fead3f7994e0,0x3f6c835e3f71a257,0x3f69ac2a3f71a257,0x3f54db313f600ea4
.quad 0x3f58c2eb3f66a5e5,0x3f3504f33f48261c,0x3f4397f43f58c2eb,0x3f0e39da3f2a95b0,0x3f2a95b03f48261c,0x3ec3ef153f083341,0x3f0e39da3f3504f3,0x3e47c5c23ec3ef15
.quad 0x3ede26023f1f9d07,0x248d31323e63dc87,0x3e9b7b853f083341,0xbe47c5c23d65aa20,0x3e2b86c03ede2602,0xbec3ef15bde54da2,0x3ce5c1433ea91a56,0xbf0e39dabe8dbd62
.quad 0xbde54da23e63dc87,0xbf3504f3bede2602,0xbe7fc5683de54da2,0xbf54db31bf1423cd,0xbec3ef15248d3132,0xbf6c835ebf3504f3,0xbf02113abde54da2,0xbf7b14bebf50c899
.quad 0x3f8000003f800000,0x3f8000003f800000,0x3f7fc6003f7ff98e,0x3f7ec46d3f7f5eee,0x3f7f181a3f7fe638,0x3f7b14be3f7d7c83,0x3f7df69c3f7fc600,0x3f74fa0b3f7a5b1d
.quad 0x3f7c620b3f7f98e6,0x3f6c835e3f75fead,0x3f7a5b1d3f7f5eee,0x3f61c5983f706cb1,0x3f77e2bd3f7f181a,0x3f54db313f69ac2a,0x3f74fa0b3f7ec46d,0x3f45e4033f61c598
.quad 0x3f71a2573f7e63ec,0x3f3504f33f58c2eb,0x3f6ddd243f7df69c,0x3f2267993f4eaf7a,0x3f69ac2a3f7d7c83,0x3f0e39da3f4397f4,0x3f65114d3f7cf5a5,0x3ef15aea3f378a4d
.quad 0x3f600ea43f7c620b,0x3ec3ef153f2a95b0,0x3f5aa6753f7bc1bb,0x3e94a0313f1cca6b,0x3f54db313f7b14be,0x3e47c5c23f0e39da,0x3f4eaf7a3f7a5b1d,0x3dc8bd363efdec9f
.quad 0x3f8000003f800000,0x3f8000003f800000,0x3f7cf5a53f7df69c,0x3f7a5b1d3f7bc1bb,0x3f73e9123f77e2bd,0x3f69ac2a3f6f2af0,0x3f65114d3f6ddd24,0x3f4eaf7a3f5aa675
.quad 0x3f50c8993f600ea4,0x3f2a95b03f3ee268,0x3f378a4d3f4eaf7a,0x3efdec9f3f1cca6b,0x3f19efeb3f3a0669,0x3e9b7b853eeaffac,0x3ef15aea3f226799,0x3dc8bd363e94a031
.quad 0x3ea91a563f083341,0xbde54da23de54da2,0x3e39aaee3ed7a83d,0xbea24f04bd8f7f7c,0x3ce5c1433e9b7b85,0xbf02113abe7fc568,0xbe00e9413e39aaee,0xbf2d3eb9bed7a83d
.quad 0xbe8dbd623d65aa20,0xbf50c899bf1423cd,0xbed7a83dbd8f7f7c,0xbf6b1db0bf378a4d,0xbf0e39dabe47c5c2,0xbf7b14bebf54db31,0xbf2d3eb9bea24f04,0xbf7ff98ebf6b1db0
.quad 0,0,0x3ce5c14300000000,0x3dac22ae3d65aa20,0x3d65aa2000000000,0x3e2b86c03de54da2,0x3dac22ae00000000,0x3e7fc5683e2b86c0
.quad 0x3de54da200000000,0x3ea91a563e63dc87,0x3e0f253300000000,0x3ed11f9b3e8dbd62,0x3e2b86c000000000,0x3ef7aa013ea91a56,0x3e47c5c200000000,0x3f0e39da3ec3ef15
.quad 0x3e63dc8700000000,0x3f1f9d073ede2602,0x3e7fc56800000000,0x3f2fdf083ef7aa01,0x3e8dbd6200000000,0x3f3ee2683f083341,0x3e9b7b8500000000,0x3f4c8bf33f1423cd
.quad 0x3ea91a5600000000,0x3f58c2eb3f1f9d07,0x3eb6971900000000,0x3f63712c3f2a95b0,0x3ec3ef1500000000,0x3f6c835e3f3504f3,0x3ed11f9b00000000,0x3f73e9123f3ee268
.quad 0,0,0x3e0f25333de54da2,0x3e47c5c23e2b86c0,0x3e8dbd623e63dc87,0x3ec3ef153ea91a56,0x3ed11f9b3ea91a56,0x3f0e39da3ef7aa01
.quad 0x3f0833413ede2602,0x3f3504f33f1f9d07,0x3f2529fe3f083341,0x3f54db313f3ee268,0x3f3ee2683f1f9d07,0x3f6c835e3f58c2eb,0x3f54db313f3504f3,0x3f7b14be3f6c835e
.quad 0x3f66a5e53f48261c,0x3f8000003f7994e0,0x3f73e9123f58c2eb,0x3f7b14be3f7f98e6,0x3f7c620b3f66a5e5,0x3f6c835e3f7e63ec,0x3f7fe6383f71a257,0x3f54db313f75fead
.quad 0x3f7e63ec3f7994e0,0x3f3504f33f66a5e5,0x3f77e2bd3f7e63ec,0x3f0e39da3f50c899,0x3f6c835e3f800000,0x3ec3ef153f3504f3,0x3f5c7efc3f7e63ec,0x3e47c5c23f1423cd
.quad 0,0,0x3d2c49b73c65c70c,0x3dc8bd363d8f7f7c,0x3dac22ae3ce5c143,0x3e47c5c23e0f2533,0x3e00e9413d2c49b7,0x3e94a0313e55d687
.quad 0x3e2b86c03d65aa20,0x3ec3ef153e8dbd62,0x3e55d6873d8f7f7c,0x3ef15aea3eafdd25,0x3e7fc5683dac22ae,0x3f0e39da3ed11f9b,0x3e94a0313dc8bd36,0x3f2267993ef15aea
.quad 0x3ea91a563de54da2,0x3f3504f33f083341,0x3ebd47db3e00e941,0x3f45e4033f170daa,0x3ed11f9b3e0f2533,0x3f54db313f2529fe,0x3ee498983e1d59f0,0x3f61c5983f32767c
.quad 0x3ef7aa013e2b86c0,0x3f6c835e3f3ee268,0x3f0525983e39aaee,0x3f74fa0b3f4a5e20,0x3f0e39da3e47c5c2,0x3f7b14be3f54db31,0x3f170daa3e55d687,0x3f7ec46d3f5e4c69
.quad 0,0,0x3e1d59f03e00e941,0x3e55d6873e39aaee,0x3e9b7b853e7fc568,0x3ed11f9b3eb69719,0x3ee498983ebd47db,0x3f170daa3f052598
.quad 0x3f1423cd3ef7aa01,0x3f3ee2683f2a95b0,0x3f32767c3f170daa,0x3f5e4c693f4a5e20,0x3f4c8bf33f2fdf08,0x3f73e9123f63712c,0x3f61c5983f45e403,0x3f7ec46d3f74fa0b
.quad 0x3f71a2573f58c2eb,0x3f7e63ec3f7e63ec,0x3f7bc1bb3f682ee0,0x3f72cbd13f7f5eee,0x3f7fe6383f73e912,0x3f5c7efc3f77e2bd,0x3f7df69c3f7bc1bb,0x3f3c79273f682ee0
.quad 0x3f75fead3f7f98e6,0x3f1423cd3f50c899,0x3f682ee03f7f5eee,0x3eca8c723f32767c,0x3f54db313f7b14be,0x3e47c5c23f0e39da,0x3f3c79273f72cbd1,0xbc65c70c3eca8c72
.quad 0x3f66a5e53f800000,0x3e63dc873f1f9d07,0x3f63712c3f800000,0x3e0f25333f1423cd,0x3f600ea43f800000,0x3d65aa203f083341,0x3f5c7efc3f800000,0xbce5c1433ef7aa01
.quad 0x3f58c2eb3f800000,0xbde54da23ede2602,0x3f54db313f800000,0xbe47c5c23ec3ef15,0x3f50c8993f800000,0xbe8dbd623ea91a56,0x3f4c8bf33f800000,0xbeb697193e8dbd62
.quad 0x3f48261c3f800000,0xbede26023e63dc87,0x3f4397f43f800000,0xbf02113a3e2b86c0,0x3f3ee2683f800000,0xbf1423cd3de54da2,0x3f3a06693f800000,0xbf2529fe3d65aa20
.quad 0x3f3504f33f800000,0xbf3504f3248d3132,0x3f2fdf083f800000,0xbf4397f4bd65aa20,0x3f2a95b03f800000,0xbf50c899bde54da2,0x3f2529fe3f800000,0xbf5c7efcbe2b86c0
.quad 0xbf1f9d07be63dc87,0xbf800000bf66a5e5,0xbf3a0669bea91a56,0xbf7b14bebf75fead,0xbf50c899bede2602,0xbf6c835ebf7e63ec,0xbf63712cbf083341,0xbf54db31bf7f98e6
.quad 0xbf71a257bf1f9d07,0xbf3504f3bf7994e0,0xbf7b14bebf3504f3,0xbf0e39dabf6c835e,0xbf7f98e6bf48261c,0xbec3ef15bf58c2eb,0xbf7f181abf58c2eb,0xbe47c5c2bf3ee268
.quad 0xbf7994e0bf66a5e5,0xa553c9cabf1f9d07,0xbf6f2af0bf71a257,0x3e47c5c2bef7aa01,0xbf600ea4bf7994e0,0x3ec3ef15bea91a56,0xbf4c8bf3bf7e63ec,0x3f0e39dabe2b86c0
.quad 0xbf3504f3bf800000,0x3f3504f3a553c9ca,0xbf19efebbf7e63ec,0x3f54db313e2b86c0,0xbef7aa01bf7994e0,0x3f6c835e3ea91a56,0xbeb69719bf71a257,0x3f7b14be3ef7aa01
.quad 0x3f48261c3f7994e0,0x248d31323ede2602,0x3f41420b3f78c212,0xbdc8bd363ebd47db,0x3f3a06693f77e2bd,0xbe47c5c23e9b7b85,0x3f32767c3f76f6ed,0xbe94a0313e71d70e
.quad 0x3f2a95b03f75fead,0xbec3ef153e2b86c0,0x3f2267993f74fa0b,0xbef15aea3dc8bd36,0x3f19efeb3f73e912,0xbf0e39da3ce5c143,0x3f11327b3f72cbd1,0xbf226799bd2c49b7
.quad 0x3f0833413f71a257,0xbf3504f3bde54da2,0x3efdec9f3f706cb1,0xbf45e403be39aaee,0x3eeaffac3f6f2af0,0xbf54db31be7fc568,0x3ed7a83d3f6ddd24,0xbf61c598bea24f04
.quad 0x3ec3ef153f6c835e,0xbf6c835ebec3ef15,0x3eafdd253f6b1db0,0xbf74fa0bbee49898,0x3e9b7b853f69ac2a,0xbf7b14bebf02113a,0x3e86d3703f682ee0,0xbf7ec46dbf11327b
.quad 0xbf48261cbede2602,0xbf7994e0bf7994e0,0xbf5e4c69bf0b3a0f,0xbf682ee0bf7fc600,0xbf6f2af0bf2529fe,0xbf4c8bf3bf7d7c83,0xbf7a5b1dbf3c7927,0xbf27e411bf72cbd1
.quad 0xbf7f98e6bf50c899,0xbef7aa01bf600ea4,0xbf7ec46dbf61c598,0xbe94a031bf45e403,0xbf77e2bdbf6f2af0,0xbdac22aebf2529fe,0xbf6b1db0bf78c212,0x3e00e941befdec9f
.quad 0xbf58c2ebbf7e63ec,0x3ea91a56bea91a56,0xbf41420bbf7ff98e,0x3f052598be1d59f0,0xbf2529febf7d7c83,0x3f2fdf083ce5c143,0xbf052598bf76f6ed,0x3f52d7343e55d687
.quad 0xbec3ef15bf6c835e,0x3f6c835e3ec3ef15,0xbe71d70ebf5e4c69,0x3f7bc1bb3f0b3a0f,0xbdac22aebf4c8bf3,0x3f7fe6383f2fdf08,0x3d8f7f7cbf378a4d,0x3f78c2123f4eaf7a
.quad 0x3ede260200000000,0x3f7994e03f48261c,0x3eeaffac00000000,0x3f7d7c833f50c899,0x3ef7aa0100000000,0x3f7f98e63f58c2eb,0x3f02113a00000000,0x3f7fe6383f600ea4
.quad 0x3f08334100000000,0x3f7e63ec3f66a5e5,0x3f0e39da00000000,0x3f7b14be3f6c835e,0x3f1423cd00000000,0x3f75fead3f71a257,0x3f19efeb00000000,0x3f6f2af03f75fead
.quad 0x3f1f9d0700000000,0x3f66a5e53f7994e0,0x3f2529fe00000000,0x3f5c7efc3f7c620b,0x3f2a95b000000000,0x3f50c8993f7e63ec,0x3f2fdf0800000000,0x3f4397f43f7f98e6
.quad 0x3f3504f300000000,0x3f3504f33f800000,0x3f3a066900000000,0x3f2529fe3f7f98e6,0x3f3ee26800000000,0x3f1423cd3f7e63ec,0x3f4397f400000000,0x3f02113a3f7c620b
.quad 0x3f48261c3f7994e0,0x250d31323ede2602,0x3f2fdf083f71a257,0xbe47c5c23e8dbd62,0x3f1423cd3f66a5e5,0xbec3ef153de54da2,0x3eeaffac3f58c2eb,0xbf0e39dabd65aa20
.quad 0x3ea91a563f48261c,0xbf3504f3be63dc87,0x3e47c5c23f3504f3,0xbf54db31bec3ef15,0x3d65aa203f1f9d07,0xbf6c835ebf083341,0xbdac22ae3f083341,0xbf7b14bebf2a95b0
.quad 0xbe63dc873ede2602,0xbf800000bf48261c,0xbeb697193ea91a56,0xbf7b14bebf600ea4,0xbef7aa013e63dc87,0xbf6c835ebf71a257,0xbf19efeb3de54da2,0xbf54db31bf7c620b
.quad 0xbf3504f3250d3132,0xbf3504f3bf800000,0xbf4c8bf3bde54da2,0xbf0e39dabf7c620b,0xbf600ea4be63dc87,0xbec3ef15bf71a257,0xbf6f2af0bea91a56,0xbe47c5c2bf600ea4
.quad 0x3f1f9d073e63dc87,0x3f8000003f66a5e5,0x3f27e4113e71d70e,0x3f7ec46d3f6ddd24,0x3f2fdf083e7fc568,0x3f7b14be3f73e912,0x3f378a4d3e86d370,0x3f74fa0b3f78c212
.quad 0x3f3ee2683e8dbd62,0x3f6c835e3f7c620b,0x3f45e4033e94a031,0x3f61c5983f7ec46d,0x3f4c8bf33e9b7b85,0x3f54db313f7fe638,0x3f52d7343ea24f04,0x3f45e4033f7fc600
.quad 0x3f58c2eb3ea91a56,0x3f3504f33f7e63ec,0x3f5e4c693eafdd25,0x3f2267993f7bc1bb,0x3f63712c3eb69719,0x3f0e39da3f77e2bd,0x3f682ee03ebd47db,0x3ef15aea3f72cbd1
.quad 0x3f6c835e3ec3ef15,0x3ec3ef153f6c835e,0x3f706cb13eca8c72,0x3e94a0313f65114d,0x3f73e9123ed11f9b,0x3e47c5c23f5c7efc,0x3f76f6ed3ed7a83d,0x3dc8bd363f52d734
.quad 0x3f1f9d073f66a5e5,0xbe63dc873e63dc87,0x3efdec9f3f56d477,0xbed7a83d3d2c49b7,0x3eb697193f4397f4,0xbf19efebbe0f2533,0x3e55d6873f2d3eb9,0xbf41420bbea24f04
.quad 0x3d65aa203f1423cd,0xbf600ea4bef7aa01,0xbdc8bd363ef15aea,0xbf74fa0bbf226799,0xbe7fc5683eb69719,0xbf7f181abf4397f4,0xbeca8c723e71d70e,0xbf7df69cbf5e4c69
.quad 0xbf0833413de54da2,0xbf71a257bf71a257,0xbf27e411bc65c70c,0xbf5aa675bf7cf5a5,0xbf4397f4be0f2533,0xbf3a0669bf7fe638,0xbf5aa675be86d370,0xbf11327bbf7a5b1d
.quad 0xbf6c835ebec3ef15,0xbec3ef15bf6c835e,0xbf78c212befdec9f,0xbe39aaeebf56d477,0xbf7f181abf19efeb,0x3ce5c143bf3a0669,0xbf7f5eeebf32767c,0x3e71d70ebf170daa
.quad 0x8000340080003400,0x8000340080003400,0xb1a831a880003400,0xb1a8b1a8b4000000,0xb400000080003400,0x340080008000b400,0xb1a8b1a880003400,0xb1a831a834008000
.quad 0x8000b40080003400,0x8000b40080003400,0x31a8b1a880003400,0x31a831a8b4000000,0x3400800080003400,0xb40000008000b400,0x31a831a880003400,0x31a8b1a834008000
.quad 0x8000340080003400,0x8000340080003400,0xb1a831a880003400,0xb1a8b1a8b4000000,0xb400000080003400,0x340080008000b400,0xb1a8b1a880003400,0xb1a831a834008000
.quad 0x8000b40080003400,0x8000b40080003400,0x31a8b1a880003400,0x31a831a8b4000000,0x3400800080003400,0xb40000008000b400,0x31a831a880003400,0x31a8b1a834008000
.quad 0x8000340080003400,0x8000340080003400,0x31a8b1a88000b400,0x31a831a834008000,0xb400000080003400,0x340080008000b400,0x31a831a88000b400,0x31a8b1a8b4000000
.quad 0x8000b40080003400,0x8000b40080003400,0xb1a831a88000b400,0xb1a8b1a834008000,0x3400800080003400,0xb40000008000b400,0xb1a8b1a88000b400,0xb1a831a8b4000000
.quad 0x8000340080003400,0x8000340080003400,0x31a8b1a88000b400,0x31a831a834008000,0xb400000080003400,0x340080008000b400,0x31a831a88000b400,0x31a8b1a8b4000000
.quad 0x8000b40080003400,0x8000b40080003400,0xb1a831a88000b400,0xb1a8b1a834008000,0x3400800080003400,0xb40000008000b400,0xb1a8b1a88000b400,0xb1a831a8b4000000
.quad 0x8000340080003400,0x8000340080003400,0xb3642e1fae1f3364,0xae1fb364b364ae1f,0xb1a8b1a8b1a831a8,0x31a831a831a8b1a8,0x2e1fb364b3642e1f,0xb364ae1f2e1f3364
.quad 0x34008000b4000000,0x34008000b4000000,0x2e1f3364b364ae1f,0xb3642e1f2e1fb364,0xb1a831a8b1a8b1a8,0x31a8b1a831a831a8,0xb364ae1fae1fb364,0xae1f3364b3642e1f
.quad 0x8000b4008000b400,0x8000b4008000b400,0x3364ae1f2e1fb364,0x2e1f336433642e1f,0x31a831a831a8b1a8,0xb1a8b1a8b1a831a8,0xae1f33643364ae1f,0x33642e1fae1fb364
.quad 0xb400000034008000,0xb400000034008000,0xae1fb36433642e1f,0x3364ae1fae1f3364,0x31a8b1a831a831a8,0xb1a831a8b1a8b1a8,0x33642e1f2e1f3364,0x2e1fb3643364ae1f
.quad 0x8000340080003400,0x8000340080003400,0x3364ae1f2e1fb364,0x2e1f336433642e1f,0xb1a8b1a8b1a831a8,0x31a831a831a8b1a8,0xae1f33643364ae1f,0x33642e1fae1fb364
.quad 0x34008000b4000000,0x34008000b4000000,0xae1fb36433642e1f,0x3364ae1fae1f3364,0xb1a831a8b1a8b1a8,0x31a8b1a831a831a8,0x33642e1f2e1f3364,0x2e1fb3643364ae1f
.quad 0x8000b4008000b400,0x8000b4008000b400,0xb3642e1fae1f3364,0xae1fb364b364ae1f,0x31a831a831a8b1a8,0xb1a8b1a8b1a831a8,0x2e1fb364b3642e1f,0xb364ae1f2e1f3364
.quad 0xb400000034008000,0xb400000034008000,0x2e1f3364b364ae1f,0xb3642e1f2e1fb364,0x31a8b1a831a831a8,0xb1a831a8b1a8b1a8,0xb364ae1fae1fb364,0xae1f3364b3642e1f
.quad 0x3400000034000000,0x3400000034000000,0x31a831a834000000,0xb1a831a800003400,0x340034000000,0x8000b400b4000000,0xb1a831a834000000,0x31a831a88000b400
.quad 0xb400000034000000,0xb400000034000000,0xb1a8b1a834000000,0x31a8b1a800003400,0x8000b40034000000,0x3400b4000000,0x31a8b1a834000000,0xb1a8b1a88000b400
.quad 0x3400000034000000,0x3400000034000000,0x31a831a834000000,0xb1a831a800003400,0x340034000000,0x8000b400b4000000,0xb1a831a834000000,0x31a831a88000b400
.quad 0xb400000034000000,0xb400000034000000,0xb1a8b1a834000000,0x31a8b1a800003400,0x8000b40034000000,0x3400b4000000,0x31a8b1a834000000,0xb1a8b1a88000b400
.quad 0x3400000034000000,0x3400000034000000,0xb1a8b1a8b4000000,0x31a8b1a88000b400,0x340034000000,0x8000b400b4000000,0x31a8b1a8b4000000,0xb1a8b1a800003400
.quad 0xb400000034000000,0xb400000034000000,0x31a831a8b4000000,0xb1a831a88000b400,0x8000b40034000000,0x3400b4000000,0xb1a831a8b4000000,0x31a831a800003400
.quad 0x3400000034000000,0x3400000034000000,0xb1a8b1a8b4000000,0x31a8b1a88000b400,0x340034000000,0x8000b400b4000000,0x31a8b1a8b4000000,0xb1a8b1a800003400
.quad 0xb400000034000000,0xb400000034000000,0x31a831a8b4000000,0xb1a831a88000b400,0x8000b40034000000,0x3400b4000000,0xb1a831a8b4000000,0x31a831a800003400
.quad 0x3400000034000000,0x3400000034000000,0x2e1f336433642e1f,0xb3642e1fae1f3364,0xb1a831a831a831a8,0x31a8b1a8b1a8b1a8,0xb364ae1f2e1f3364,0xae1f33643364ae1f
.quad 0x8000b40000003400,0x8000b40000003400,0x3364ae1fae1f3364,0x2e1f3364b364ae1f,0x31a831a8b1a831a8,0xb1a8b1a831a8b1a8,0xae1f3364b3642e1f,0x33642e1f2e1f3364
.quad 0xb4000000b4000000,0xb4000000b4000000,0xae1fb364b364ae1f,0x3364ae1f2e1fb364,0x31a8b1a8b1a8b1a8,0xb1a831a831a831a8,0x33642e1fae1fb364,0x2e1fb364b3642e1f
.quad 0x34008000b400,0x34008000b400,0xb3642e1f2e1fb364,0xae1fb36433642e1f,0xb1a8b1a831a8b1a8,0x31a831a8b1a831a8,0x2e1fb3643364ae1f,0xb364ae1fae1fb364
.quad 0x3400000034000000,0x3400000034000000,0xae1fb364b364ae1f,0x3364ae1f2e1fb364,0xb1a831a831a831a8,0x31a8b1a8b1a8b1a8,0x33642e1fae1fb364,0x2e1fb364b3642e1f
.quad 0x8000b40000003400,0x8000b40000003400,0xb3642e1f2e1fb364,0xae1fb36433642e1f,0x31a831a8b1a831a8,0xb1a8b1a831a8b1a8,0x2e1fb3643364ae1f,0xb364ae1fae1fb364
.quad 0xb4000000b4000000,0xb4000000b4000000,0x2e1f336433642e1f,0xb3642e1fae1f3364,0x31a8b1a8b1a8b1a8,0xb1a831a831a831a8,0xb364ae1f2e1f3364,0xae1f33643364ae1f
.quad 0x34008000b400,0x34008000b400,0x3364ae1fae1f3364,0x2e1f3364b364ae1f,0xb1a8b1a831a8b1a8,0x31a831a8b1a831a8,0xae1f3364b3642e1f,0x33642e1f2e1f3364
.quad 0xc068c008c070c000,0x10000000000,0xc4c4c0a8c4ccc0a0,0x10000000010,0xc424c148c42cc140,0x10000000020,0xc384c1e8c38cc1e0,0x10000000030
.quad 0xc2e4c288c2ecc280,0x10000000040,0xc244c328c24cc320,0x10000000050,0xc1a4c3c8c1acc3c0,0x10000000060,0xc104c468c10cc460,0x10000000070
.quad 0xc064c00cc06cc004,0x10000000080,0xc4c0c0acc4c8c0a4,0x10000000090,0xc420c14cc428c144,0x100000000a0,0xc380c1ecc388c1e4,0x100000000b0
.quad 0xc2e0c28cc2e8c284,0x100000000c0,0xc240c32cc248c324,0x100000000d0,0xc1a0c3ccc1a8c3c4,0x100000000e0,0xc100c46cc108c464,0x100000000f0
.quad 0xca78ca18ca80ca10,0x10000000400,0xced4cab8cedccab0,0x10000000410,0xce34cb58ce3ccb50,0x10000000420,0xcd94cbf8cd9ccbf0,0x10000000430
.quad 0xccf4cc98ccfccc90,0x10000000440,0xcc54cd38cc5ccd30,0x10000000450,0xcbb4cdd8cbbccdd0,0x10000000460,0xcb14ce78cb1cce70,0x10000000470
.quad 0xca74ca1cca7cca14,0x10000000480,0xced0cabcced8cab4,0x10000000490,0xce30cb5cce38cb54,0x100000004a0,0xcd90cbfccd98cbf4,0x100000004b0
.quad 0xccf0cc9cccf8cc94,0x100000004c0,0xcc50cd3ccc58cd34,0x100000004d0,0xcbb0cddccbb8cdd4,0x100000004e0,0xcb10ce7ccb18ce74,0x100000004f0
.quad 0xd488d428d490d420,0x10000000800,0xd8e4d4c8d8ecd4c0,0x10000000810,0xd844d568d84cd560,0x10000000820,0xd7a4d608d7acd600,0x10000000830
.quad 0xd704d6a8d70cd6a0,0x10000000840,0xd664d748d66cd740,0x10000000850,0xd5c4d7e8d5ccd7e0,0x10000000860,0xd524d888d52cd880,0x10000000870
.quad 0xd484d42cd48cd424,0x10000000880,0xd8e0d4ccd8e8d4c4,0x10000000890,0xd840d56cd848d564,0x100000008a0,0xd7a0d60cd7a8d604,0x100000008b0
.quad 0xd700d6acd708d6a4,0x100000008c0,0xd660d74cd668d744,0x100000008d0,0xd5c0d7ecd5c8d7e4,0x100000008e0,0xd520d88cd528d884,0x100000008f0
.quad 0xde98de38dea0de30,0x8000000c00,0xe2f4ded8e2fcded0,0x8000000c10,0xe254df78e25cdf70,0x8000000c20,0xe1b4e018e1bce010,0x8000000c30
.quad 0xe114e0b8e11ce0b0,0x8000000c40,0xe074e158e07ce150,0x8000000c50,0xdfd4e1f8dfdce1f0,0x8000000c60,0xdf34e298df3ce290,0x8000000c70
.quad 0xde94de3cde9cde34,0x10000038000,0xe2f0dedce2f8ded4,0x10000038010,0xe250df7ce258df74,0x10000038020,0xe1b0e01ce1b8e014,0x10000038030
.quad 0xe110e0bce118e0b4,0x10000038040,0xe070e15ce078e154,0x10000038050,0xdfd0e1fcdfd8e1f4,0x10000038060,0xdf30e29cdf38e294,0x10000038070
.quad 0xc058c018c060c010,0x10000038080,0xc4b4c0b8c4bcc0b0,0x10000038090,0xc414c158c41cc150,0x100000380a0,0xc374c1f8c37cc1f0,0x100000380b0
.quad 0xc2d4c298c2dcc290,0x100000380c0,0xc234c338c23cc330,0x100000380d0,0xc194c3d8c19cc3d0,0x100000380e0,0xc0f4c478c0fcc470,0x100000380f0
.quad 0xc054c01cc05cc014,0x10000038400,0xc4b0c0bcc4b8c0b4,0x10000038410,0xc410c15cc418c154,0x10000038420,0xc370c1fcc378c1f4,0x10000038430
.quad 0xc2d0c29cc2d8c294,0x10000038440,0xc230c33cc238c334,0x10000038450,0xc190c3dcc198c3d4,0x10000038460,0xc0f0c47cc0f8c474,0x10000038470
.quad 0xca68ca28ca70ca20,0x10000038480,0xcec4cac8cecccac0,0x10000038490,0xce24cb68ce2ccb60,0x100000384a0,0xcd84cc08cd8ccc00,0x100000384b0
.quad 0xcce4cca8cceccca0,0x100000384c0,0xcc44cd48cc4ccd40,0x100000384d0,0xcba4cde8cbaccde0,0x100000384e0,0xcb04ce88cb0cce80,0x100000384f0
.quad 0xca64ca2cca6cca24,0x10000038800,0xcec0cacccec8cac4,0x10000038810,0xce20cb6cce28cb64,0x10000038820,0xcd80cc0ccd88cc04,0x10000038830
.quad 0xcce0ccaccce8cca4,0x10000038840,0xcc40cd4ccc48cd44,0x10000038850,0xcba0cdeccba8cde4,0x10000038860,0xcb00ce8ccb08ce84,0x10000038870
.quad 0xd478d438d480d430,0x10000038880,0xd8d4d4d8d8dcd4d0,0x10000038890,0xd834d578d83cd570,0x100000388a0,0xd794d618d79cd610,0x100000388b0
.quad 0xd6f4d6b8d6fcd6b0,0x100000388c0,0xd654d758d65cd750,0x100000388d0,0xd5b4d7f8d5bcd7f0,0x100000388e0,0xd514d898d51cd890,0x100000388f0
.quad 0xd474d43cd47cd434,0x8000038c00,0xd8d0d4dcd8d8d4d4,0x8000038c10,0xd830d57cd838d574,0x8000038c20,0xd790d61cd798d614,0x8000038c30
.quad 0xd6f0d6bcd6f8d6b4,0x8000038c40,0xd650d75cd658d754,0x8000038c50,0xd5b0d7fcd5b8d7f4,0x8000038c60,0xd510d89cd518d894,0x8000038c70
.quad 0xde88de48de90de40,0x10000070000,0xe2e4dee8e2ecdee0,0x10000070010,0xe244df88e24cdf80,0x10000070020,0xe1a4e028e1ace020,0x10000070030
.quad 0xe104e0c8e10ce0c0,0x10000070040,0xe064e168e06ce160,0x10000070050,0xdfc4e208dfcce200,0x10000070060,0xdf24e2a8df2ce2a0,0x10000070070
.quad 0xde84de4cde8cde44,0x10000070080,0xe2e0deece2e8dee4,0x10000070090,0xe240df8ce248df84,0x100000700a0,0xe1a0e02ce1a8e024,0x100000700b0
.quad 0xe100e0cce108e0c4,0x100000700c0,0xe060e16ce068e164,0x100000700d0,0xdfc0e20cdfc8e204,0x100000700e0,0xdf20e2acdf28e2a4,0x100000700f0
.quad 0xc048c028c050c020,0x10000070400,0xc4a4c0c8c4acc0c0,0x10000070410,0xc404c168c40cc160,0x10000070420,0xc364c208c36cc200,0x10000070430
.quad 0xc2c4c2a8c2ccc2a0,0x10000070440,0xc224c348c22cc340,0x10000070450,0xc184c3e8c18cc3e0,0x10000070460,0xc0e4c488c0ecc480,0x10000070470
.quad 0xc044c02cc04cc024,0x10000070480,0xc4a0c0ccc4a8c0c4,0x10000070490,0xc400c16cc408c164,0x100000704a0,0xc360c20cc368c204,0x100000704b0
.quad 0xc2c0c2acc2c8c2a4,0x100000704c0,0xc220c34cc228c344,0x100000704d0,0xc180c3ecc188c3e4,0x100000704e0,0xc0e0c48cc0e8c484,0x100000704f0
.quad 0xca58ca38ca60ca30,0x10000070800,0xceb4cad8cebccad0,0x10000070810,0xce14cb78ce1ccb70,0x10000070820,0xcd74cc18cd7ccc10,0x10000070830
.quad 0xccd4ccb8ccdcccb0,0x10000070840,0xcc34cd58cc3ccd50,0x10000070850,0xcb94cdf8cb9ccdf0,0x10000070860,0xcaf4ce98cafcce90,0x10000070870
.quad 0xca54ca3cca5cca34,0x10000070880,0xceb0cadcceb8cad4,0x10000070890,0xce10cb7cce18cb74,0x100000708a0,0xcd70cc1ccd78cc14,0x100000708b0
.quad 0xccd0ccbcccd8ccb4,0x100000708c0,0xcc30cd5ccc38cd54,0x100000708d0,0xcb90cdfccb98cdf4,0x100000708e0,0xcaf0ce9ccaf8ce94,0x100000708f0
.quad 0xd468d448d470d440,0x8000070c00,0xd8c4d4e8d8ccd4e0,0x8000070c10,0xd824d588d82cd580,0x8000070c20,0xd784d628d78cd620,0x8000070c30
.quad 0xd6e4d6c8d6ecd6c0,0x8000070c40,0xd644d768d64cd760,0x8000070c50,0xd5a4d808d5acd800,0x8000070c60,0xd504d8a8d50cd8a0,0x8000070c70
.quad 0xd464d44cd46cd444,0x100000a8000,0xd8c0d4ecd8c8d4e4,0x100000a8010,0xd820d58cd828d584,0x100000a8020,0xd780d62cd788d624,0x100000a8030
.quad 0xd6e0d6ccd6e8d6c4,0x100000a8040,0xd640d76cd648d764,0x100000a8050,0xd5a0d80cd5a8d804,0x100000a8060,0xd500d8acd508d8a4,0x100000a8070
.quad 0xde78de58de80de50,0x100000a8080,0xe2d4def8e2dcdef0,0x100000a8090,0xe234df98e23cdf90,0x100000a80a0,0xe194e038e19ce030,0x100000a80b0
.quad 0xe0f4e0d8e0fce0d0,0x100000a80c0,0xe054e178e05ce170,0x100000a80d0,0xdfb4e218dfbce210,0x100000a80e0,0xdf14e2b8df1ce2b0,0x100000a80f0
.quad 0xde74de5cde7cde54,0x100000a8400,0xe2d0defce2d8def4,0x100000a8410,0xe230df9ce238df94,0x100000a8420,0xe190e03ce198e034,0x100000a8430
.quad 0xe0f0e0dce0f8e0d4,0x100000a8440,0xe050e17ce058e174,0x100000a8450,0xdfb0e21cdfb8e214,0x100000a8460,0xdf10e2bcdf18e2b4,0x100000a8470
.quad 0xc074c038c040c030,0x100000a8480,0xe840e840c49cc0d0,0x100000a8490,0xe840e840c3fcc170,0x100000a84a0,0xe840e840c35cc210,0x100000a84b0
.quad 0xe840e840c2bcc2b0,0x100000a84c0,0xe840e840c21cc350,0x100000a84d0,0xe840e840c17cc3f0,0x100000a84e0,0xe840e840c0dcc490,0x100000a84f0
.quad 0xe840e840c03cc034,0x100000a8800,0xe840e840c498c0d4,0x100000a8810,0xe840e840c3f8c174,0x100000a8820,0xe840e840c358c214,0x100000a8830
.quad 0xe840e840c2b8c2b4,0x100000a8840,0xe840e840c218c354,0x100000a8850,0xe840e840c178c3f4,0x100000a8860,0xe840e840c0d8c494,0x100000a8870
.quad 0xca84ca48ca50ca40,0x100000a8880,0xe840e840ceaccae0,0x100000a8890,0xe840e840ce0ccb80,0x100000a88a0,0xe840e840cd6ccc20,0x100000a88b0
.quad 0xe840e840ccccccc0,0x100000a88c0,0xe840e840cc2ccd60,0x100000a88d0,0xe840e840cb8cce00,0x100000a88e0,0xe840e840caeccea0,0x100000a88f0
.quad 0xe840e840ca4cca44,0x80000a8c00,0xe840e840cea8cae4,0x80000a8c10,0xe840e840ce08cb84,0x80000a8c20,0xe840e840cd68cc24,0x80000a8c30
.quad 0xe840e840ccc8ccc4,0x80000a8c40,0xe840e840cc28cd64,0x80000a8c50,0xe840e840cb88ce04,0x80000a8c60,0xe840e840cae8cea4,0x80000a8c70
.quad 0xd494d458d460d450,0x100000e0000,0xe840e840d8bcd4f0,0x100000e0010,0xe840e840d81cd590,0x100000e0020,0xe840e840d77cd630,0x100000e0030
.quad 0xe840e840d6dcd6d0,0x100000e0040,0xe840e840d63cd770,0x100000e0050,0xe840e840d59cd810,0x100000e0060,0xe840e840d4fcd8b0,0x100000e0070
.quad 0xe840e840d45cd454,0x100000e0080,0xe840e840d8b8d4f4,0x100000e0090,0xe840e840d818d594,0x100000e00a0,0xe840e840d778d634,0x100000e00b0
.quad 0xe840e840d6d8d6d4,0x100000e00c0,0xe840e840d638d774,0x100000e00d0,0xe840e840d598d814,0x100000e00e0,0xe840e840d4f8d8b4,0x100000e00f0
.quad 0xdea4de68de70de60,0x100000e0400,0xe840e840e2ccdf00,0x100000e0410,0xe840e840e22cdfa0,0x100000e0420,0xe840e840e18ce040,0x100000e0430
.quad 0xe840e840e0ece0e0,0x100000e0440,0xe840e840e04ce180,0x100000e0450,0xe840e840dface220,0x100000e0460,0xe840e840df0ce2c0,0x100000e0470
.quad 0xe840e840de6cde64,0x100000e0480,0xe840e840e2c8df04,0x100000e0490,0xe840e840e228dfa4,0x100000e04a0,0xe840e840e188e044,0x100000e04b0
.quad 0xe840e840e0e8e0e4,0x100000e04c0,0xe840e840e048e184,0x100000e04d0,0xe840e840dfa8e224,0x100000e04e0,0xe840e840df08e2c4,0x100000e04f0
.quad 0xc9c4c508c9ccc500,0x100000e0800,0xc924c5a8c92cc5a0,0x100000e0810,0xc884c648c88cc640,0x100000e0820,0xc7e4c6e8c7ecc6e0,0x100000e0830
.quad 0xc744c788c74cc780,0x100000e0840,0xc6a4c828c6acc820,0x100000e0850,0xc604c8c8c60cc8c0,0x100000e0860,0xc564c968c56cc960,0x100000e0870
.quad 0xc9c0c50cc9c8c504,0x100000e0880,0xc920c5acc928c5a4,0x100000e0890,0xc880c64cc888c644,0x100000e08a0,0xc7e0c6ecc7e8c6e4,0x100000e08b0
.quad 0xc740c78cc748c784,0x100000e08c0,0xc6a0c82cc6a8c824,0x100000e08d0,0xc600c8ccc608c8c4,0x100000e08e0,0xc560c96cc568c964,0x100000e08f0
.quad 0xd3d4cf18d3dccf10,0x80000e0c00,0xd334cfb8d33ccfb0,0x80000e0c10,0xd294d058d29cd050,0x80000e0c20,0xd1f4d0f8d1fcd0f0,0x80000e0c30
.quad 0xd154d198d15cd190,0x80000e0c40,0xd0b4d238d0bcd230,0x80000e0c50,0xd014d2d8d01cd2d0,0x80000e0c60,0xcf74d378cf7cd370,0x80000e0c70
.quad 0xd3d0cf1cd3d8cf14,0x10000118000,0xd330cfbcd338cfb4,0x10000118010,0xd290d05cd298d054,0x10000118020,0xd1f0d0fcd1f8d0f4,0x10000118030
.quad 0xd150d19cd158d194,0x10000118040,0xd0b0d23cd0b8d234,0x10000118050,0xd010d2dcd018d2d4,0x10000118060,0xcf70d37ccf78d374,0x10000118070
.quad 0xdde4d928ddecd920,0x10000118080,0xdd44d9c8dd4cd9c0,0x10000118090,0xdca4da68dcacda60,0x100001180a0,0xdc04db08dc0cdb00,0x100001180b0
.quad 0xdb64dba8db6cdba0,0x100001180c0,0xdac4dc48daccdc40,0x100001180d0,0xda24dce8da2cdce0,0x100001180e0,0xd984dd88d98cdd80,0x100001180f0
.quad 0xdde0d92cdde8d924,0x10000118400,0xdd40d9ccdd48d9c4,0x10000118410,0xdca0da6cdca8da64,0x10000118420,0xdc00db0cdc08db04,0x10000118430
.quad 0xdb60dbacdb68dba4,0x10000118440,0xdac0dc4cdac8dc44,0x10000118450,0xda20dcecda28dce4,0x10000118460,0xd980dd8cd988dd84,0x10000118470
.quad 0xe7f4e338e7fce330,0x10000118480,0xe754e3d8e75ce3d0,0x10000118490,0xe6b4e478e6bce470,0x100001184a0,0xe614e518e61ce510,0x100001184b0
.quad 0xe574e5b8e57ce5b0,0x100001184c0,0xe4d4e658e4dce650,0x100001184d0,0xe434e6f8e43ce6f0,0x100001184e0,0xe394e798e39ce790,0x100001184f0
.quad 0xe7f0e33ce7f8e334,0x10000118800,0xe750e3dce758e3d4,0x10000118810,0xe6b0e47ce6b8e474,0x10000118820,0xe610e51ce618e514,0x10000118830
.quad 0xe570e5bce578e5b4,0x10000118840,0xe4d0e65ce4d8e654,0x10000118850,0xe430e6fce438e6f4,0x10000118860,0xe390e79ce398e794,0x10000118870
.quad 0xc9b4c518c9bcc510,0x10000118880,0xc914c5b8c91cc5b0,0x10000118890,0xc874c658c87cc650,0x100001188a0,0xc7d4c6f8c7dcc6f0,0x100001188b0
.quad 0xc734c798c73cc790,0x100001188c0,0xc694c838c69cc830,0x100001188d0,0xc5f4c8d8c5fcc8d0,0x100001188e0,0xc554c978c55cc970,0x100001188f0
.quad 0xc9b0c51cc9b8c514,0x8000118c00,0xc910c5bcc918c5b4,0x8000118c10,0xc870c65cc878c654,0x8000118c20,0xc7d0c6fcc7d8c6f4,0x8000118c30
.quad 0xc730c79cc738c794,0x8000118c40,0xc690c83cc698c834,0x8000118c50,0xc5f0c8dcc5f8c8d4,0x8000118c60,0xc550c97cc558c974,0x8000118c70
.quad 0xd3c4cf28d3cccf20,0x10000150000,0xd324cfc8d32ccfc0,0x10000150010,0xd284d068d28cd060,0x10000150020,0xd1e4d108d1ecd100,0x10000150030
.quad 0xd144d1a8d14cd1a0,0x10000150040,0xd0a4d248d0acd240,0x10000150050,0xd004d2e8d00cd2e0,0x10000150060,0xcf64d388cf6cd380,0x10000150070
.quad 0xd3c0cf2cd3c8cf24,0x10000150080,0xd320cfccd328cfc4,0x10000150090,0xd280d06cd288d064,0x100001500a0,0xd1e0d10cd1e8d104,0x100001500b0
.quad 0xd140d1acd148d1a4,0x100001500c0,0xd0a0d24cd0a8d244,0x100001500d0,0xd000d2ecd008d2e4,0x100001500e0,0xcf60d38ccf68d384,0x100001500f0
.quad 0xddd4d938dddcd930,0x10000150400,0xdd34d9d8dd3cd9d0,0x10000150410,0xdc94da78dc9cda70,0x10000150420,0xdbf4db18dbfcdb10,0x10000150430
.quad 0xdb54dbb8db5cdbb0,0x10000150440,0xdab4dc58dabcdc50,0x10000150450,0xda14dcf8da1cdcf0,0x10000150460,0xd974dd98d97cdd90,0x10000150470
.quad 0xddd0d93cddd8d934,0x10000150480,0xdd30d9dcdd38d9d4,0x10000150490,0xdc90da7cdc98da74,0x100001504a0,0xdbf0db1cdbf8db14,0x100001504b0
.quad 0xdb50dbbcdb58dbb4,0x100001504c0,0xdab0dc5cdab8dc54,0x100001504d0,0xda10dcfcda18dcf4,0x100001504e0,0xd970dd9cd978dd94,0x100001504f0
.quad 0xe7e4e348e7ece340,0x10000150800,0xe744e3e8e74ce3e0,0x10000150810,0xe6a4e488e6ace480,0x10000150820,0xe604e528e60ce520,0x10000150830
.quad 0xe564e5c8e56ce5c0,0x10000150840,0xe4c4e668e4cce660,0x10000150850,0xe424e708e42ce700,0x10000150860,0xe384e7a8e38ce7a0,0x10000150870
.quad 0xe7e0e34ce7e8e344,0x10000150880,0xe740e3ece748e3e4,0x10000150890,0xe6a0e48ce6a8e484,0x100001508a0,0xe600e52ce608e524,0x100001508b0
.quad 0xe560e5cce568e5c4,0x100001508c0,0xe4c0e66ce4c8e664,0x100001508d0,0xe420e70ce428e704,0x100001508e0,0xe380e7ace388e7a4,0x100001508f0
.quad 0xc9a4c528c9acc520,0x8000150c00,0xc904c5c8c90cc5c0,0x8000150c10,0xc864c668c86cc660,0x8000150c20,0xc7c4c708c7ccc700,0x8000150c30
.quad 0xc724c7a8c72cc7a0,0x8000150c40,0xc684c848c68cc840,0x8000150c50,0xc5e4c8e8c5ecc8e0,0x8000150c60,0xc544c988c54cc980,0x8000150c70
.quad 0xc9a0c52cc9a8c524,0x10000188000,0xc900c5ccc908c5c4,0x10000188010,0xc860c66cc868c664,0x10000188020,0xc7c0c70cc7c8c704,0x10000188030
.quad 0xc720c7acc728c7a4,0x10000188040,0xc680c84cc688c844,0x10000188050,0xc5e0c8ecc5e8c8e4,0x10000188060,0xc540c98cc548c984,0x10000188070
.quad 0xd3b4cf38d3bccf30,0x10000188080,0xd314cfd8d31ccfd0,0x10000188090,0xd274d078d27cd070,0x100001880a0,0xd1d4d118d1dcd110,0x100001880b0
.quad 0xd134d1b8d13cd1b0,0x100001880c0,0xd094d258d09cd250,0x100001880d0,0xcff4d2f8cffcd2f0,0x100001880e0,0xcf54d398cf5cd390,0x100001880f0
.quad 0xd3b0cf3cd3b8cf34,0x10000188400,0xd310cfdcd318cfd4,0x10000188410,0xd270d07cd278d074,0x10000188420,0xd1d0d11cd1d8d114,0x10000188430
.quad 0xd130d1bcd138d1b4,0x10000188440,0xd090d25cd098d254,0x10000188450,0xcff0d2fccff8d2f4,0x10000188460,0xcf50d39ccf58d394,0x10000188470
.quad 0xddc4d948ddccd940,0x10000188480,0xdd24d9e8dd2cd9e0,0x10000188490,0xdc84da88dc8cda80,0x100001884a0,0xdbe4db28dbecdb20,0x100001884b0
.quad 0xdb44dbc8db4cdbc0,0x100001884c0,0xdaa4dc68daacdc60,0x100001884d0,0xda04dd08da0cdd00,0x100001884e0,0xd964dda8d96cdda0,0x100001884f0
.quad 0xddc0d94cddc8d944,0x10000188800,0xdd20d9ecdd28d9e4,0x10000188810,0xdc80da8cdc88da84,0x10000188820,0xdbe0db2cdbe8db24,0x10000188830
.quad 0xdb40dbccdb48dbc4,0x10000188840,0xdaa0dc6cdaa8dc64,0x10000188850,0xda00dd0cda08dd04,0x10000188860,0xd960ddacd968dda4,0x10000188870
.quad 0xe7d4e358e7dce350,0x10000188880,0xe734e3f8e73ce3f0,0x10000188890,0xe694e498e69ce490,0x100001888a0,0xe5f4e538e5fce530,0x100001888b0
.quad 0xe554e5d8e55ce5d0,0x100001888c0,0xe4b4e678e4bce670,0x100001888d0,0xe414e718e41ce710,0x100001888e0,0xe374e7b8e37ce7b0,0x100001888f0
.quad 0xe7d0e35ce7d8e354,0x8000188c00,0xe730e3fce738e3f4,0x8000188c10,0xe690e49ce698e494,0x8000188c20,0xe5f0e53ce5f8e534,0x8000188c30
.quad 0xe550e5dce558e5d4,0x8000188c40,0xe4b0e67ce4b8e674,0x8000188c50,0xe410e71ce418e714,0x8000188c60,0xe370e7bce378e7b4,0x8000188c70
.quad 0xe840e840c99cc530,0x40000000,0xe840e840c8fcc5d0,0x40000000,0xe840e840c85cc670,0x40000000,0xe840e840c7bcc710,0x40000000
.quad 0xe840e840c71cc7b0,0x40000000,0xe840e840c67cc850,0x40000000,0xe840e840c5dcc8f0,0x40000000,0xe840e840c53cc990,0x40000000
.quad 0xe840e840c998c534,0x40000000,0xe840e840c8f8c5d4,0x40000000,0xe840e840c858c674,0x40000000,0xe840e840c7b8c714,0x40000000
.quad 0xe840e840c718c7b4,0x40000000,0xe840e840c678c854,0x40000000,0xe840e840c5d8c8f4,0x40000000,0xe840e840c538c994,0x40000000
.quad 0xe840e840d3accf40,0x40000000,0xe840e840d30ccfe0,0x40000000,0xe840e840d26cd080,0x40000000,0xe840e840d1ccd120,0x40000000
.quad 0xe840e840d12cd1c0,0x40000000,0xe840e840d08cd260,0x40000000,0xe840e840cfecd300,0x40000000,0xe840e840cf4cd3a0,0x40000000
.quad 0xe840e840d3a8cf44,0x40000000,0xe840e840d308cfe4,0x40000000,0xe840e840d268d084,0x40000000,0xe840e840d1c8d124,0x40000000
.quad 0xe840e840d128d1c4,0x40000000,0xe840e840d088d264,0x40000000,0xe840e840cfe8d304,0x40000000,0xe840e840cf48d3a4,0x40000000
.quad 0xe840e840ddbcd950,0x40000000,0xe840e840dd1cd9f0,0x40000000,0xe840e840dc7cda90,0x40000000,0xe840e840dbdcdb30,0x40000000
.quad 0xe840e840db3cdbd0,0x40000000,0xe840e840da9cdc70,0x40000000,0xe840e840d9fcdd10,0x40000000,0xe840e840d95cddb0,0x40000000
.quad 0xe840e840ddb8d954,0x40000000,0xe840e840dd18d9f4,0x40000000,0xe840e840dc78da94,0x40000000,0xe840e840dbd8db34,0x40000000
.quad 0xe840e840db38dbd4,0x40000000,0xe840e840da98dc74,0x40000000,0xe840e840d9f8dd14,0x40000000,0xe840e840d958ddb4,0x40000000
.quad 0xe840e840e7cce360,0x40000000,0xe840e840e72ce400,0x40000000,0xe840e840e68ce4a0,0x40000000,0xe840e840e5ece540,0x40000000
.quad 0xe840e840e54ce5e0,0x40000000,0xe840e840e4ace680,0x40000000,0xe840e840e40ce720,0x40000000,0xe840e840e36ce7c0,0x40000000
.quad 0xe840e840e7c8e364,0x40000000,0xe840e840e728e404,0x40000000,0xe840e840e688e4a4,0x40000000,0xe840e840e5e8e544,0x40000000
.quad 0xe840e840e548e5e4,0x40000000,0xe840e840e4a8e684,0x40000000,0xe840e840e408e724,0x40000000,0xe840e840e368e7c4,0x40000000
.quad 0,0,0,0,0,0,0,0
.quad 0,0,0,0,0,0,0,0
.quad 0,0,0,0,0,0,0,0
.quad 0,0,0,0,0,0,0,0
.quad 0,0,0,0,0,0,0,0
.quad 0,0,0,0,0,0,0,0
.quad 0,0,0,0,0,0,0,0
.quad 0,0,0,0,0,0,0,0
.quad 0,0,0,0,0,0,0,0
.quad 0,0,0,0,0,0,0,0
.quad 0,0,0,0,0,0,0,0
.quad 0,0,0,0,0,0,0,0
.quad 0,0,0,0,0,0,0,0
.quad 0,0,0,0,0,0,0,0
.quad 0,0,0,0,0,0,0,0
.quad 0,0,0,0,0,0,0,0
.quad 0,0,0,0,0,0,0,0
.quad 0,0,0,0,0,0,0,0
.quad 0,0,0,0,0,0,0,0
.quad 0,0,0,0,0,0,0,0
.quad 0,0,0,0,0,0,0,0
.quad 0,0,0,0,0,0,0,0
.quad 0,0,0,0,0,0,0,0
.quad 0,0,0,0,0,0,0,0
.quad 0,0,0,0,0,0,0,0
.quad 0,0,0,0,0,0,0,0
.quad 0,0,0,0,0,0,0,0
.quad 0,0,0,0,0,0,0,0
.quad 0,0,0,0,0,0,0,0
.quad 0,0,0,0,0,0,0,0
.quad 0,0,0,0,0,0,0,0
.quad 0,0,0,0,0,0,0,0
.quad 0x2400240024002400,0x2400240024002400,0x23f923fd23ff2400,0x23d923e323ec23f3,0x23e323f323fd2400,0x2364238d23b023cd,0x23bf23e323f92400,0x22a72300234d238d
.quad 0x238d23cd23f32400,0x21a8224122c62335,0x234d23b023ec2400,0x20722155221d22c6,0x2300238d23e32400,0x1e1f204221552241,0x22a7236423d92400,0x1a3e1e1f207221a8
.quad 0x2241233523cd2400,0x1b1f1ef120fd,0x21d0230023bf2400,0x9a3e132d1cdc2042,0x215522c623b02400,0x9e1f972a195c1ef1,0x20cf2286239f2400,0xa0729c6e0f2e1d49
.quad 0x20422241238d2400,0xa1a89ef1972a1b1f,0x1f5821f723792400,0xa2a7a0a19bfe172a,0x1e1f21a823642400,0xa364a1a89e1f0000,0x1cdc2155234d2400,0xa3d9a286a011972a
.quad 0x2400240024002400,0x2400240024002400,0x239f23b023bf23cd,0x234d23642379238d,0x228622c623002335,0x215521a821f72241,0x20cf215521d02241,0x1cdc1e1f1f582042
.quad 0x1d491ef1204220fd,0x972a0000172a1b1f,0xf2e195c1cdc1ef1,0xa0119e1f9bfe972a,0x9c6e972a132d1b1f,0xa286a1a8a0a19ef1,0xa0729e1f9a3e0000,0xa3d9a364a2a7a1a8
.quad 0xa241a0fd9ef19b1f,0xa3cda400a3cda335,0xa379a286a1299ef1,0xa264a364a3eca3f3,0xa3fda38da286a0fd,0x9fbda1a8a300a3cd,0xa3bfa3fda379a241,0x95619e1fa129a2c6
.quad 0xa2c6a3cda3f3a335,0x1d4980009d49a0fd,0xa129a300a3eca3cd,0x217f1e1f0f2e9d49,0x9e1fa1a8a364a400,0x236421a81e1f8000,0x95619fbda264a3cd,0x23ff2364217f1d49
.quad 0x2400240024002400,0x2400240024002400,0x22e42300231c2335,0x2264228622a722c6,0x1fbd204220a120fd,0x1c6e1d491e1f1ef1,0x8f2e132d18791b1f,0x9db59c6e9a3e972a
.quad 0xa0429ef19d499b1f,0xa2c6a241a1a8a0fd,0xa31ca286a1d0a0fd,0xa3f9a3fda3d9a38d,0xa3fda3f3a3b0a335,0xa1f7a2c6a364a3cd,0xa2a7a364a3d9a400,0x9a3e9e1fa072a1a8
.quad 0x9ef1a0fda241a335,0x1ef11b1f80009b1f,0x1561995c9e89a0fd,0x231c21f720721d49,0x20a11d49132d9b1f,0x23e323f323642241,0x234d21f720111b1f,0x217f230023d923f3
.quad 0x23f323cd22c620fd,0x172a1ef121a82335,0x226423b023f92335,0xa011995c1a3e2042,0x1e1f21a823642400,0xa364a1a89e1f0000,0x98791c6e21292335,0xa3bfa3e3a2a7a042
.quad 0x2400240024002400,0x2400240024002400,0x21d021f7221d2241,0x21292155217f21a8,0x132d172a195c1b1f,0x995c972a932d0000,0xa129a0a1a0119ef1,0xa2e4a286a21da1a8
.quad 0xa3f3a3cda38da335,0xa38da3cda3f3a400,0xa264a300a379a3cd,0x9db59fbda0cfa1a8,0x995c9d499fbda0fd,0x1fbd1d49195c8000,0x20721e1f1a3e8000,0x23d9236422a721a8
.quad 0x23cd2335224120fd,0x2241233523cd2400,0x22e423b023ff23cd,0xf2e1c6e201121a8,0x1c6e204221f72335,0xa1f7a0429c6e0000,0x9f58995c18791ef1,0xa3eca3e3a31ca1a8
.quad 0xa38da241a0429b1f,0xa042a241a38da400,0xa34da3fda39fa241,0x1cdc932d9e89a1a8,0x9e1fa1a8a364a400,0x236421a81e1f8000,0x1db5932d9f58a241,0x231c23fd237921a8
.quad 0x2400240024002400,0x2400240024002400,0x207220a120cf20fd,0x1f581fbd20112042,0x9e1f9d499c6e9b1f,0xa0a1a0429fbd9ef1,0xa3d9a3b0a379a335,0xa3eca3fda3ffa3f3
.quad 0xa1a8a241a2c6a335,0x9d499ef1a042a0fd,0x1a3e132d95619b1f,0x217f20a11f581d49,0x236422c621f720fd,0x23b023f323fd23cd,0x22a7236423d92400,0x1a3e1e1f207221a8
.quad 0x1b1f1ef120fd,0xa241a0fd9ef19b1f,0xa2a7a1559f589b1f,0xa34da3e3a3f9a38d,0xa364a3f3a3e3a335,0x932d9d49a0a1a241,0x9a3e9fbda1d0a335,0x22e421551e89172a
.quad 0x21a81ef1172a9b1f,0x22c623cd23f32335,0x23d923e322e420fd,0x95611c6e20cf22c6,0x1e1f21a823642400,0xa364a1a89e1f0000,0xa072995c1bfe20fd,0xa21da3b0a3eca2c6
.quad 0x2400240024002400,0x2400240024002400,0x1db51e1f1e891ef1,0x1bfe1c6e1cdc1d49,0xa1f7a1a8a155a0fd,0xa300a2c6a286a241,0xa31ca364a39fa3cd,0xa17fa1f7a264a2c6
.quad 0x172a8000972a9b1f,0x20421ef11d491b1f,0x23bf236422e42241,0x239f23e323ff23f3,0x20a121a822862335,0x932d172a1c6e1ef1,0xa0729e1f9a3e0000,0xa3d9a364a2a7a1a8
.quad 0xa3cda400a3cda335,0x9ef1a0fda241a335,0x98799e1fa0cfa241,0x221d20a11db5172a,0x230021a81fbd1b1f,0x2286238d23fd23cd,0x221d236423f923cd,0x9db5932d1bfe2042
.quad 0x9d4900001d4920fd,0xa3f3a3cda2c6a0fd,0xa3ffa364a1d09ef1,0x98799fbda21da38d,0x9e1fa1a8a364a400,0x236421a81e1f8000,0x21d01e1f8f2e9ef1,0x20cf230023f9238d
.quad 0x2400240024002400,0x2400240024002400,0x1879195c1a3e1b1f,0xf2e132d1561172a,0xa3b0a38da364a335,0xa3fda3f3a3e3a3cd,0x9e899fbda072a0fd,0x9561995c9bfe9d49
.quad 0x22c6224121a820fd,0x23f323cd238d2335,0x212921f722a72335,0x18791c6e1e892042,0xa155a0429e1f9b1f,0xa3e3a38da300a241,0xa2a7a364a3d9a400,0x9a3e9e1fa072a1a8
.quad 0x1ef11b1f80009b1f,0x23cd2335224120fd,0x239f23fd23d92335,0x1bfe1fbd217f22c6,0x995c172a1e1f20fd,0xa3b0a2c6a1559ef1,0xa3ffa3b0a2a7a0fd,0x9cdca0a1a264a38d
.quad 0x972a9ef1a1a8a335,0x238d224120421b1f,0x23bf228620721b1f,0x1db52155231c23f3,0x1e1f21a823642400,0xa364a1a89e1f0000,0xa2e4a0a19a3e1b1f,0x9e89a1f7a39fa3f3
.quad 0x2400240024002400,0x2400240024002400,0x9561932d8f2e0000,0x9a3e995c9879972a,0xa3e3a3f3a3fda400,0xa364a38da3b0a3cd,0x1bfe195c15618000,0x20721fbd1e891d49
.quad 0x238d23cd23f32400,0x21a8224122c62335,0x9e899c6e98790000,0xa2a7a1f7a129a042,0xa300a38da3e3a400,0x9e1fa042a155a241,0x20721e1f1a3e8000,0x23d9236422a721a8
.quad 0x2241233523cd2400,0x1b1f1ef120fd,0xa17f9fbd9bfe0000,0xa3d9a3fda39fa2c6,0xa155a2c6a3b0a400,0x1e1f172a995c9ef1,0x226420a11cdc8000,0x22a723b023ff238d
.quad 0x20422241238d2400,0xa1a89ef1972a1b1f,0xa31ca1559db50000,0xa072a286a3bfa3f3,0x9e1fa1a8a364a400,0x236421a81e1f8000,0x239f21f71e898000,0x1a3e20a122e423f3
.quad 0x2400240024002400,0x2400240024002400,0x9cdc9c6e9bfe9b1f,0x9e899e1f9db59d49,0xa286a2c6a300a335,0xa155a1a8a1f7a241,0x226421f7217f20fd,0x239f2364231c22c6
.quad 0x1d491ef1204220fd,0x972a0000172a1b1f,0xa3ffa3e3a39fa335,0xa2e4a364a3bfa3f3,0x1c6e172a932d9b1f,0x228621a820a11ef1,0x22a7236423d92400,0x1a3e1e1f207221a8
.quad 0xa241a0fd9ef19b1f,0xa3cda400a3cda335,0x9db5a0a1a21da335,0x20cf1e1f1879972a,0x23fd238d228620fd,0x1fbd21a8230023cd,0x9bfe132d1db520fd,0xa3f9a364a21da042
.quad 0xa2c6a3cda3f3a335,0x1d4980009d49a0fd,0x221d1fbd18799b1f,0x21d0236423ff238d,0x1e1f21a823642400,0xa364a1a89e1f0000,0xa3f9a300a0cf9b1f,0xf2e9e1fa1d0a38d
.quad 0x2400240024002400,0x2400240024002400,0xa0119fbd9f589ef1,0xa0cfa0a1a072a042,0x9fbda042a0a1a0fd,0x9c6e9d499e1f9ef1,0x23ff23fd23ec23cd,0x237923b023d923f3
.quad 0xa0429ef19d499b1f,0xa2c6a241a1a8a0fd,0x9f58a0a1a17fa241,0x1561932d9a3e9d49,0x23fd23f323b02335,0x21f722c6236423cd,0xa0729e1f9a3e0000,0xa3d9a364a2a7a1a8
.quad 0x9ef1a0fda241a335,0x1ef11b1f80009b1f,0x23f923e3234d2241,0x1f58215522a7238d,0xa0a19d49932d1b1f,0xa3e3a3f3a364a241,0x9e89a155a2e4a3cd,0x21d01fbd1a3e972a
.quad 0x23f323cd22c620fd,0x172a1ef121a82335,0xa0cf9c6e15611ef1,0xa2e4a3e3a3d9a2c6,0x9e1fa1a8a364a400,0x236421a81e1f8000,0x23ec23b0221d1ef1,0x9bfe195c207222c6
.quad 0x2400240024002400,0x2400240024002400,0xa17fa155a129a0fd,0xa21da1f7a1d0a1a8,0x932d972a995c9b1f,0x195c172a132d8000,0x221d228622e42335,0x201120a1212921a8
.quad 0xa3f3a3cda38da335,0xa38da3cda3f3a400,0x20cf1fbd1db51b1f,0x23792300226421a8,0x195c1d491fbd20fd,0x9fbd9d49995c0000,0xa2a7a364a3d9a400,0x9a3e9e1fa072a1a8
.quad 0x23cd2335224120fd,0x2241233523cd2400,0xa0119c6e8f2e1b1f,0xa3ffa3b0a2e4a1a8,0x9c6ea042a1f7a335,0x21f720421c6e8000,0x231c23e323ec2335,0x9879195c1f5821a8
.quad 0xa38da241a0429b1f,0xa042a241a38da400,0x1e89132d9cdca0fd,0x239f23fd234d21a8,0x1e1f21a823642400,0xa364a1a89e1f0000,0xa379a3fda31ca0fd,0x1f58132d9db5a1a8
.quad 0x2400240024002400,0x2400240024002400,0xa2a7a286a264a241,0xa31ca300a2e4a2c6,0x1e1f1d491c6e1b1f,0x20a120421fbd1ef1,0x1a3e1c6e1db51ef1,0x9879932d0f2e172a
.quad 0xa1a8a241a2c6a335,0x9d499ef1a042a0fd,0x23d923fd23f923cd,0x21d02286231c238d,0xa364a2c6a1f7a0fd,0xa3b0a3f3a3fda3cd,0x20721e1f1a3e8000,0x23d9236422a721a8
.quad 0x1b1f1ef120fd,0xa241a0fd9ef19b1f,0xa072a1f7a31ca3cd,0x1e89195c95619d49,0x236423f323e32335,0x132d1d4920a12241,0xa3d9a300a17f9ef1,0xa011a1f7a34da3f3
.quad 0x21a81ef1172a9b1f,0x22c623cd23f32335,0x9a3e195c20112241,0xa3f9a3b0a264a042,0x9e1fa1a8a364a400,0x236421a81e1f8000,0x22a723e323bf2241,0xa1299c6e18792042
.quad 0x2400240024002400,0x2400240024002400,0xa379a364a34da335,0xa3bfa3b0a39fa38d,0x21f721a8215520fd,0x230022c622862241,0x9f589e1f9cdc9b1f,0xa1d0a155a0cfa042
.quad 0x172a8000972a9b1f,0x20421ef11d491b1f,0x1bfe1e1f201120fd,0x9cdc995c8f2e172a,0xa0a1a1a8a286a335,0x132d972a9c6e9ef1,0x22a7236423d92400,0x1a3e1e1f207221a8
.quad 0xa3cda400a3cda335,0x9ef1a0fda241a335,0x23ec2364226420fd,0x21292286237923f3,0xa300a1a89fbd9b1f,0xa286a38da3fda3cd,0x21291e1f15619b1f,0x237923fd23bf22c6
.quad 0x9d4900001d4920fd,0xa3f3a3cda2c6a0fd,0x8f2e9e1fa17fa335,0x23ec230021291d49,0x1e1f21a823642400,0xa364a1a89e1f0000,0xa17fa364a3ffa335,0x22641fbd15619d49
.quad 0x2400240024002400,0x2400240024002400,0xa3eca3e3a3d9a3cd,0xa3ffa3fda3f9a3f3,0x23b0238d23642335,0x23fd23f323e323cd,0xa34da300a2a7a241,0xa3f9a3e3a3bfa38d
.quad 0x22c6224121a820fd,0x23f323cd238d2335,0xa21da155a0729ef1,0xa3eca3b0a34da2c6,0x215520421e1f1b1f,0x23e3238d23002241,0xa0729e1f9a3e0000,0xa3d9a364a2a7a1a8
.quad 0x1ef11b1f80009b1f,0x23cd2335224120fd,0x9cdc932d1a3e1ef1,0xa3bfa300a1d0a042,0x195c972a9e1fa0fd,0x23b022c621551ef1,0x8f2e1c6e20722241,0xa39fa286a0cf9d49
.quad 0x972a9ef1a1a8a335,0x238d224120421b1f,0x1bfe20a122a723cd,0xa379a1f79f58972a,0x9e1fa1a8a364a400,0x236421a81e1f8000,0x2011228623d923cd,0xa34da1559cdc172a
.quad 0x2400240024002400,0x2400240024002400,0xa3f9a3fda3ffa400,0xa3d9a3e3a3eca3f3,0x23e323f323fd2400,0x2364238d23b023cd,0xa3bfa3e3a3f9a400,0xa2a7a300a34da38d
.quad 0x238d23cd23f32400,0x21a8224122c62335,0xa34da3b0a3eca400,0xa072a155a21da2c6,0x2300238d23e32400,0x1e1f204221552241,0xa2a7a364a3d9a400,0x9a3e9e1fa072a1a8
.quad 0x2241233523cd2400,0x1b1f1ef120fd,0xa1d0a300a3bfa400,0x1a3e932d9cdca042,0x215522c623b02400,0x9e1f972a195c1ef1,0xa0cfa286a39fa400,0x20721c6e8f2e9d49
.quad 0x20422241238d2400,0xa1a89ef1972a1b1f,0x9f58a1f7a379a400,0x22a720a11bfe972a,0x1e1f21a823642400,0xa364a1a89e1f0000,0x9cdca155a34da400,0x23d922862011172a
.quad 0x2400240024002400,0x2400240024002400,0xa39fa3b0a3bfa3cd,0xa34da364a379a38d,0x228622c623002335,0x215521a821f72241,0xa0cfa155a1d0a241,0x9cdc9e1f9f58a042
.quad 0x1d491ef1204220fd,0x972a0000172a1b1f,0x8f2e995c9cdc9ef1,0x20111e1f1bfe172a,0x9c6e972a132d1b1f,0xa286a1a8a0a19ef1,0x20721e1f1a3e8000,0x23d9236422a721a8
.quad 0xa241a0fd9ef19b1f,0xa3cda400a3cda335,0x2379228621291ef1,0x2264236423ec23f3,0xa3fda38da286a0fd,0x9fbda1a8a300a3cd,0x23bf23fd23792241,0x15611e1f212922c6
.quad 0xa2c6a3cda3f3a335,0x1d4980009d49a0fd,0x2129230023ec23cd,0xa17f9e1f8f2e1d49,0x9e1fa1a8a364a400,0x236421a81e1f8000,0x15611fbd226423cd,0xa3ffa364a17f9d49
.quad 0x2400240024002400,0x2400240024002400,0xa2e4a300a31ca335,0xa264a286a2a7a2c6,0x1fbd204220a120fd,0x1c6e1d491e1f1ef1,0xf2e932d98799b1f,0x1db51c6e1a3e172a
.quad 0xa0429ef19d499b1f,0xa2c6a241a1a8a0fd,0x231c228621d020fd,0x23f923fd23d9238d,0xa3fda3f3a3b0a335,0xa1f7a2c6a364a3cd,0x22a7236423d92400,0x1a3e1e1f207221a8
.quad 0x9ef1a0fda241a335,0x1ef11b1f80009b1f,0x9561195c1e8920fd,0xa31ca1f7a0729d49,0x20a11d49132d9b1f,0x23e323f323642241,0xa34da1f7a0119b1f,0xa17fa300a3d9a3f3
.quad 0x23f323cd22c620fd,0x172a1ef121a82335,0xa264a3b0a3f9a335,0x2011195c9a3ea042,0x1e1f21a823642400,0xa364a1a89e1f0000,0x18799c6ea129a335,0x23bf23e322a72042
.quad 0x2400240024002400,0x2400240024002400,0xa1d0a1f7a21da241,0xa129a155a17fa1a8,0x132d172a195c1b1f,0x995c972a932d0000,0x212920a120111ef1,0x22e42286221d21a8
.quad 0xa3f3a3cda38da335,0xa38da3cda3f3a400,0x22642300237923cd,0x1db51fbd20cf21a8,0x995c9d499fbda0fd,0x1fbd1d49195c8000,0xa0729e1f9a3e0000,0xa3d9a364a2a7a1a8
.quad 0x23cd2335224120fd,0x2241233523cd2400,0xa2e4a3b0a3ffa3cd,0x8f2e9c6ea011a1a8,0x1c6e204221f72335,0xa1f7a0429c6e0000,0x1f58195c98799ef1,0x23ec23e3231c21a8
.quad 0xa38da241a0429b1f,0xa042a241a38da400,0x234d23fd239f2241,0x9cdc132d1e8921a8,0x9e1fa1a8a364a400,0x236421a81e1f8000,0x9db5132d1f582241,0xa31ca3fda379a1a8
.quad 0x2400240024002400,0x2400240024002400,0xa072a0a1a0cfa0fd,0x9f589fbda011a042,0x9e1f9d499c6e9b1f,0xa0a1a0429fbd9ef1,0x23d923b023792335,0x23ec23fd23ff23f3
.quad 0xa1a8a241a2c6a335,0x9d499ef1a042a0fd,0x9a3e932d15611b1f,0xa17fa0a19f589d49,0x236422c621f720fd,0x23b023f323fd23cd,0xa2a7a364a3d9a400,0x9a3e9e1fa072a1a8
.quad 0x1b1f1ef120fd,0xa241a0fd9ef19b1f,0x22a721551f581b1f,0x234d23e323f9238d,0xa364a3f3a3e3a335,0x932d9d49a0a1a241,0x1a3e1fbd21d02335,0xa2e4a1559e89972a
.quad 0x21a81ef1172a9b1f,0x22c623cd23f32335,0xa3d9a3e3a2e4a0fd,0x15619c6ea0cfa2c6,0x1e1f21a823642400,0xa364a1a89e1f0000,0x2072195c9bfea0fd,0x221d23b023ec22c6
.quad 0x2400240024002400,0x2400240024002400,0x9db59e1f9e899ef1,0x9bfe9c6e9cdc9d49,0xa1f7a1a8a155a0fd,0xa300a2c6a286a241,0x231c2364239f23cd,0x217f21f7226422c6
.quad 0x172a8000972a9b1f,0x20421ef11d491b1f,0xa3bfa364a2e4a241,0xa39fa3e3a3ffa3f3,0x20a121a822862335,0x932d172a1c6e1ef1,0x20721e1f1a3e8000,0x23d9236422a721a8
.quad 0xa3cda400a3cda335,0x9ef1a0fda241a335,0x18791e1f20cf2241,0xa21da0a19db5972a,0x230021a81fbd1b1f,0x2286238d23fd23cd,0xa21da364a3f9a3cd,0x1db5132d9bfea042
.quad 0x9d4900001d4920fd,0xa3f3a3cda2c6a0fd,0x23ff236421d01ef1,0x18791fbd221d238d,0x9e1fa1a8a364a400,0x236421a81e1f8000,0xa1d09e1f0f2e1ef1,0xa0cfa300a3f9a38d
.quad 0x2400240024002400,0x2400240024002400,0x9879995c9a3e9b1f,0x8f2e932d9561972a,0xa3b0a38da364a335,0xa3fda3f3a3e3a3cd,0x1e891fbd207220fd,0x1561195c1bfe1d49
.quad 0x22c6224121a820fd,0x23f323cd238d2335,0xa129a1f7a2a7a335,0x98799c6e9e89a042,0xa155a0429e1f9b1f,0xa3e3a38da300a241,0x22a7236423d92400,0x1a3e1e1f207221a8
.quad 0x1ef11b1f80009b1f,0x23cd2335224120fd,0xa39fa3fda3d9a335,0x9bfe9fbda17fa2c6,0x995c172a1e1f20fd,0xa3b0a2c6a1559ef1,0x23ff23b022a720fd,0x1cdc20a12264238d
.quad 0x972a9ef1a1a8a335,0x238d224120421b1f,0xa3bfa286a0729b1f,0x9db5a155a31ca3f3,0x1e1f21a823642400,0xa364a1a89e1f0000,0x22e420a11a3e9b1f,0x1e8921f7239f23f3
.quad 0x2400240024002400,0x2400240024002400,0x1561132d0f2e8000,0x1a3e195c1879172a,0xa3e3a3f3a3fda400,0xa364a38da3b0a3cd,0x9bfe995c95610000,0xa0729fbd9e899d49
.quad 0x238d23cd23f32400,0x21a8224122c62335,0x1e891c6e18798000,0x22a721f721292042,0xa300a38da3e3a400,0x9e1fa042a155a241,0xa0729e1f9a3e0000,0xa3d9a364a2a7a1a8
.quad 0x2241233523cd2400,0x1b1f1ef120fd,0x217f1fbd1bfe8000,0x23d923fd239f22c6,0xa155a2c6a3b0a400,0x1e1f172a995c9ef1,0xa264a0a19cdc0000,0xa2a7a3b0a3ffa38d
.quad 0x20422241238d2400,0xa1a89ef1972a1b1f,0x231c21551db58000,0x2072228623bf23f3,0x9e1fa1a8a364a400,0x236421a81e1f8000,0xa39fa1f79e890000,0x9a3ea0a1a2e4a3f3
.quad 0x2400240024002400,0x2400240024002400,0x1cdc1c6e1bfe1b1f,0x1e891e1f1db51d49,0xa286a2c6a300a335,0xa155a1a8a1f7a241,0xa264a1f7a17fa0fd,0xa39fa364a31ca2c6
.quad 0x1d491ef1204220fd,0x972a0000172a1b1f,0x23ff23e3239f2335,0x22e4236423bf23f3,0x1c6e172a932d9b1f,0x228621a820a11ef1,0xa2a7a364a3d9a400,0x9a3e9e1fa072a1a8
.quad 0xa241a0fd9ef19b1f,0xa3cda400a3cda335,0x1db520a1221d2335,0xa0cf9e1f9879172a,0x23fd238d228620fd,0x1fbd21a8230023cd,0x1bfe932d9db5a0fd,0x23f92364221d2042
.quad 0xa2c6a3cda3f3a335,0x1d4980009d49a0fd,0xa21d9fbd98791b1f,0xa1d0a364a3ffa38d,0x1e1f21a823642400,0xa364a1a89e1f0000,0x23f9230020cf1b1f,0x8f2e1e1f21d0238d
.quad 0x2400240024002400,0x2400240024002400,0x20111fbd1f581ef1,0x20cf20a120722042,0x9fbda042a0a1a0fd,0x9c6e9d499e1f9ef1,0xa3ffa3fda3eca3cd,0xa379a3b0a3d9a3f3
.quad 0xa0429ef19d499b1f,0xa2c6a241a1a8a0fd,0x1f5820a1217f2241,0x9561132d1a3e1d49,0x23fd23f323b02335,0x21f722c6236423cd,0x20721e1f1a3e8000,0x23d9236422a721a8
.quad 0x9ef1a0fda241a335,0x1ef11b1f80009b1f,0xa3f9a3e3a34da241,0x9f58a155a2a7a38d,0xa0a19d49932d1b1f,0xa3e3a3f3a364a241,0x1e89215522e423cd,0xa1d09fbd9a3e172a
.quad 0x23f323cd22c620fd,0x172a1ef121a82335,0x20cf1c6e95619ef1,0x22e423e323d922c6,0x9e1fa1a8a364a400,0x236421a81e1f8000,0xa3eca3b0a21d9ef1,0x1bfe995ca072a2c6
.quad 0x2400240024002400,0x2400240024002400,0x217f2155212920fd,0x221d21f721d021a8,0x932d972a995c9b1f,0x195c172a132d8000,0xa21da286a2e4a335,0xa011a0a1a129a1a8
.quad 0xa3f3a3cda38da335,0xa38da3cda3f3a400,0xa0cf9fbd9db59b1f,0xa379a300a264a1a8,0x195c1d491fbd20fd,0x9fbd9d49995c0000,0x22a7236423d92400,0x1a3e1e1f207221a8
.quad 0x23cd2335224120fd,0x2241233523cd2400,0x20111c6e0f2e9b1f,0x23ff23b022e421a8,0x9c6ea042a1f7a335,0x21f720421c6e8000,0xa31ca3e3a3eca335,0x1879995c9f58a1a8
.quad 0xa38da241a0429b1f,0xa042a241a38da400,0x9e89932d1cdc20fd,0xa39fa3fda34da1a8,0x1e1f21a823642400,0xa364a1a89e1f0000,0x237923fd231c20fd,0x9f58932d1db521a8
.quad 0x2400240024002400,0x2400240024002400,0x22a7228622642241,0x231c230022e422c6,0x1e1f1d491c6e1b1f,0x20a120421fbd1ef1,0x9a3e9c6e9db59ef1,0x1879132d8f2e972a
.quad 0xa1a8a241a2c6a335,0x9d499ef1a042a0fd,0xa3d9a3fda3f9a3cd,0xa1d0a286a31ca38d,0xa364a2c6a1f7a0fd,0xa3b0a3f3a3fda3cd,0xa0729e1f9a3e0000,0xa3d9a364a2a7a1a8
.quad 0x1b1f1ef120fd,0xa241a0fd9ef19b1f,0x207221f7231c23cd,0x9e89995c15611d49,0x236423f323e32335,0x132d1d4920a12241,0x23d92300217f1ef1,0x201121f7234d23f3
.quad 0x21a81ef1172a9b1f,0x22c623cd23f32335,0x1a3e995ca011a241,0x23f923b022642042,0x9e1fa1a8a364a400,0x236421a81e1f8000,0xa2a7a3e3a3bfa241,0x21291c6e9879a042
.quad 0x2400240024002400,0x2400240024002400,0x23792364234d2335,0x23bf23b0239f238d,0x21f721a8215520fd,0x230022c622862241,0x1f581e1f1cdc1b1f,0x21d0215520cf2042
.quad 0x172a8000972a9b1f,0x20421ef11d491b1f,0x9bfe9e1fa011a0fd,0x1cdc195c0f2e972a,0xa0a1a1a8a286a335,0x132d972a9c6e9ef1,0xa2a7a364a3d9a400,0x9a3e9e1fa072a1a8
.quad 0xa3cda400a3cda335,0x9ef1a0fda241a335,0xa3eca364a264a0fd,0xa129a286a379a3f3,0xa300a1a89fbd9b1f,0xa286a38da3fda3cd,0xa1299e1f95611b1f,0xa379a3fda3bfa2c6
.quad 0x9d4900001d4920fd,0xa3f3a3cda2c6a0fd,0xf2e1e1f217f2335,0xa3eca300a1299d49,0x1e1f21a823642400,0xa364a1a89e1f0000,0x217f236423ff2335,0xa2649fbd95611d49
.quad 0x2400240024002400,0x2400240024002400,0x23ec23e323d923cd,0x23ff23fd23f923f3,0x23b0238d23642335,0x23fd23f323e323cd,0x234d230022a72241,0x23f923e323bf238d
.quad 0x22c6224121a820fd,0x23f323cd238d2335,0x221d215520721ef1,0x23ec23b0234d22c6,0x215520421e1f1b1f,0x23e3238d23002241,0x20721e1f1a3e8000,0x23d9236422a721a8
.quad 0x1ef11b1f80009b1f,0x23cd2335224120fd,0x1cdc132d9a3e9ef1,0x23bf230021d02042,0x195c972a9e1fa0fd,0x23b022c621551ef1,0xf2e9c6ea072a241,0x239f228620cf1d49
.quad 0x972a9ef1a1a8a335,0x238d224120421b1f,0x9bfea0a1a2a7a3cd,0x237921f71f58172a,0x9e1fa1a8a364a400,0x236421a81e1f8000,0xa011a286a3d9a3cd,0x234d21551cdc972a
.quad 0x8000800080008000,0x8000800080008000,0x9561932d8f2e8000,0x9a3e995c9879972a,0x995c972a932d8000,0x9e1f9d499c6e9b1f,0x9bfe995c95618000,0xa0729fbd9e899d49
.quad 0x9d499b1f972a8000,0xa1a8a0fda0429ef1,0x9e899c6e98798000,0xa2a7a1f7a129a042,0x9fbd9d49995c8000,0xa364a2c6a1f7a0fd,0xa0729e1f9a3e8000,0xa3d9a364a2a7a1a8
.quad 0xa0fd9ef19b1f8000,0xa400a3cda335a241,0xa17f9fbd9bfe8000,0xa3d9a3fda39fa2c6,0xa1f7a0429c6e8000,0xa364a3f3a3e3a335,0xa264a0a19cdc8000,0xa2a7a3b0a3ffa38d
.quad 0xa2c6a0fd9d498000,0xa1a8a335a3f3a3cd,0xa31ca1559db58000,0xa072a286a3bfa3f3,0xa364a1a89e1f8000,0x9e1fa1a8a364a400,0xa39fa1f79e898000,0x9a3ea0a1a2e4a3f3
.quad 0x8000800080008000,0x8000800080008000,0x9cdc9c6e9bfe9b1f,0x9e899e1f9db59d49,0xa0a1a0429fbd9ef1,0xa1f7a1a8a155a0fd,0xa264a1f7a17fa0fd,0xa39fa364a31ca2c6
.quad 0xa38da335a2c6a241,0xa3f3a400a3f3a3cd,0xa3ffa3e3a39fa335,0xa2e4a364a3bfa3f3,0xa3b0a3f3a3fda3cd,0xa0a1a1a8a286a335,0xa2a7a364a3d9a400,0x9a3e9e1fa072a1a8
.quad 0xa0fda241a335a3cd,0x1b1f80009b1f9ef1,0x9db5a0a1a21da335,0x20cf1e1f1879972a,0x932d9d49a0a1a241,0x230021a81fbd1b1f,0x1bfe932d9db5a0fd,0x23f92364221d2042
.quad 0x20421b1f972a9ef1,0x238d2400238d2241,0x221d1fbd18799b1f,0x21d0236423ff238d,0x236421a81e1f8000,0x1e1f21a823642400,0x23f9230020cf1b1f,0x8f2e1e1f21d0238d
.quad 0x8000800080008000,0x8000800080008000,0xa0119fbd9f589ef1,0xa0cfa0a1a072a042,0xa300a2c6a286a241,0xa3b0a38da364a335,0xa3ffa3fda3eca3cd,0xa379a3b0a3d9a3f3
.quad 0xa2c6a335a38da3cd,0xa042a0fda1a8a241,0x9f58a0a1a17fa241,0x1561932d9a3e9d49,0x132d972a9c6e9ef1,0x215520421e1f1b1f,0x20721e1f1a3e8000,0x23d9236422a721a8
.quad 0x2335224120fd1ef1,0x233523cd240023cd,0x23f923e3234d2241,0x1f58215522a7238d,0x2286238d23fd23cd,0x995c172a1e1f20fd,0x1e89215522e423cd,0xa1d09fbd9a3e172a
.quad 0x972a1b1f20422241,0xa3f3a335a1a89ef1,0xa0cf9c6e15611ef1,0xa2e4a3e3a3d9a2c6,0xa364a1a89e1f8000,0x9e1fa1a8a364a400,0xa3eca3b0a21d9ef1,0x1bfe995ca072a2c6
.quad 0x8000800080008000,0x8000800080008000,0xa17fa155a129a0fd,0xa21da1f7a1d0a1a8,0xa3fda3f3a3e3a3cd,0xa3e3a3f3a3fda400,0xa21da286a2e4a335,0xa011a0a1a129a1a8
.quad 0x972a9b1f9d499ef1,0x1d491b1f172a8000,0x20cf1fbd1db51b1f,0x23792300226421a8,0x23e3238d23002241,0x2300238d23e32400,0x22a7236423d92400,0x1a3e1e1f207221a8
.quad 0x1b1f1ef120fd2241,0xa0fd9ef19b1f8000,0xa0119c6e8f2e1b1f,0xa3ffa3b0a2e4a1a8,0xa3b0a2c6a1559ef1,0xa155a2c6a3b0a400,0xa31ca3e3a3eca335,0x1879995c9f58a1a8
.quad 0x9d49a0fda2c6a3cd,0x22c620fd1d498000,0x1e89132d9cdca0fd,0x239f23fd234d21a8,0x236421a81e1f8000,0x1e1f21a823642400,0x237923fd231c20fd,0x9f58932d1db521a8
.quad 0x8000800080008000,0x8000800080008000,0xa2a7a286a264a241,0xa31ca300a2e4a2c6,0xa364a38da3b0a3cd,0xa286a2c6a300a335,0x9a3e9c6e9db59ef1,0x1879132d8f2e972a
.quad 0x21a820fd20421ef1,0x238d233522c62241,0x23d923fd23f923cd,0x21d02286231c238d,0x1e1f204221552241,0x9c6e972a132d1b1f,0xa0729e1f9a3e8000,0xa3d9a364a2a7a1a8
.quad 0xa400a3cda335a241,0xa0fda241a335a3cd,0xa072a1f7a31ca3cd,0x1e89195c95619d49,0x1e1f172a995c9ef1,0x23fd238d228620fd,0x23d92300217f1ef1,0x201121f7234d23f3
.quad 0x21a8233523f323cd,0xa0429b1f172a1ef1,0x9a3e195c20112241,0xa3f9a3b0a264a042,0xa364a1a89e1f8000,0x9e1fa1a8a364a400,0xa2a7a3e3a3bfa241,0x21291c6e9879a042
.quad 0x8000800080008000,0x8000800080008000,0xa379a364a34da335,0xa3bfa3b0a39fa38d,0xa155a1a8a1f7a241,0x9fbda042a0a1a0fd,0x1f581e1f1cdc1b1f,0x21d0215520cf2042
.quad 0x23f3240023f323cd,0x22c62335238d23cd,0x1bfe1e1f201120fd,0x9cdc995c8f2e172a,0xa286a1a8a0a19ef1,0xa3fda3f3a3b0a335,0xa2a7a364a3d9a400,0x9a3e9e1fa072a1a8
.quad 0x1b1f80009b1f9ef1,0x2335224120fd1ef1,0x23ec2364226420fd,0x21292286237923f3,0x1fbd21a8230023cd,0xa0a19d49932d1b1f,0xa1299e1f95611b1f,0xa379a3fda3bfa2c6
.quad 0xa38da400a38da241,0x172a9b1fa042a241,0x8f2e9e1fa17fa335,0x23ec230021291d49,0x236421a81e1f8000,0x1e1f21a823642400,0x217f236423ff2335,0xa2649fbd95611d49
.quad 0x8000800080008000,0x8000800080008000,0xa3eca3e3a3d9a3cd,0xa3ffa3fda3f9a3f3,0x9c6e9d499e1f9ef1,0x932d972a995c9b1f,0x234d230022a72241,0x23f923e323bf238d
.quad 0x204220fd21a82241,0x172a1b1f1d491ef1,0xa21da155a0729ef1,0xa3eca3b0a34da2c6,0xa1f7a2c6a364a3cd,0x995c9d499fbda0fd,0x20721e1f1a3e8000,0x23d9236422a721a8
.quad 0x233523cd240023cd,0x1b1f1ef120fd2241,0x9cdc932d1a3e1ef1,0xa3bfa300a1d0a042,0xa3e3a3f3a364a241,0x9c6ea042a1f7a335,0xf2e9c6ea072a241,0x239f228620cf1d49
.quad 0x23f3233521a81ef1,0x1d4920fd22c623cd,0x1bfe20a122a723cd,0xa379a1f79f58972a,0xa364a1a89e1f8000,0x9e1fa1a8a364a400,0xa011a286a3d9a3cd,0x234d21551cdc972a
.quad 0x8000800080008000,0x8000800080008000,0xa3f9a3fda3ffa400,0xa3d9a3e3a3eca3f3,0x195c172a132d8000,0x1e1f1d491c6e1b1f,0x23bf23e323f92400,0x22a72300234d238d
.quad 0x9d499b1f972a8000,0xa1a8a0fda0429ef1,0xa34da3b0a3eca400,0xa072a155a21da2c6,0x1fbd1d49195c8000,0x236422c621f720fd,0x22a7236423d92400,0x1a3e1e1f207221a8
.quad 0xa0fd9ef19b1f8000,0xa400a3cda335a241,0xa1d0a300a3bfa400,0x1a3e932d9cdca042,0x21f720421c6e8000,0x236423f323e32335,0x20cf2286239f2400,0xa0729c6e0f2e1d49
.quad 0xa2c6a0fd9d498000,0xa1a8a335a3f3a3cd,0x9f58a1f7a379a400,0x22a720a11bfe972a,0x236421a81e1f8000,0x1e1f21a823642400,0x1cdc2155234d2400,0xa3d9a286a011972a
.quad 0x8000800080008000,0x8000800080008000,0xa39fa3b0a3bfa3cd,0xa34da364a379a38d,0x20a120421fbd1ef1,0x21f721a8215520fd,0x20cf215521d02241,0x1cdc1e1f1f582042
.quad 0xa38da335a2c6a241,0xa3f3a400a3f3a3cd,0x8f2e995c9cdc9ef1,0x20111e1f1bfe172a,0x23b023f323fd23cd,0x20a121a822862335,0xa0729e1f9a3e8000,0xa3d9a364a2a7a1a8
.quad 0xa0fda241a335a3cd,0x1b1f80009b1f9ef1,0x2379228621291ef1,0x2264236423ec23f3,0x132d1d4920a12241,0xa300a1a89fbd9b1f,0xa3bfa3fda379a241,0x95619e1fa129a2c6
.quad 0x20421b1f972a9ef1,0x238d2400238d2241,0x2129230023ec23cd,0xa17f9e1f8f2e1d49,0xa364a1a89e1f8000,0x9e1fa1a8a364a400,0x95619fbda264a3cd,0x23ff2364217f1d49
.quad 0x8000800080008000,0x8000800080008000,0xa2e4a300a31ca335,0xa264a286a2a7a2c6,0x230022c622862241,0x23b0238d23642335,0x8f2e132d18791b1f,0x9db59c6e9a3e972a
.quad 0xa2c6a335a38da3cd,0xa042a0fda1a8a241,0x231c228621d020fd,0x23f923fd23d9238d,0x932d172a1c6e1ef1,0xa155a0429e1f9b1f,0xa2a7a364a3d9a400,0x9a3e9e1fa072a1a8
.quad 0x2335224120fd1ef1,0x233523cd240023cd,0x9561195c1e8920fd,0xa31ca1f7a0729d49,0xa286a38da3fda3cd,0x195c972a9e1fa0fd,0x234d21f720111b1f,0x217f230023d923f3
.quad 0x972a1b1f20422241,0xa3f3a335a1a89ef1,0xa264a3b0a3f9a335,0x2011195c9a3ea042,0x236421a81e1f8000,0x1e1f21a823642400,0x98791c6e21292335,0xa3bfa3e3a2a7a042
.quad 0x8000800080008000,0x8000800080008000,0xa1d0a1f7a21da241,0xa129a155a17fa1a8,0x23fd23f323e323cd,0x23e323f323fd2400,0xa129a0a1a0119ef1,0xa2e4a286a21da1a8
.quad 0x972a9b1f9d499ef1,0x1d491b1f172a8000,0x22642300237923cd,0x1db51fbd20cf21a8,0xa3e3a38da300a241,0xa300a38da3e3a400,0x20721e1f1a3e8000,0x23d9236422a721a8
.quad 0x1b1f1ef120fd2241,0xa0fd9ef19b1f8000,0xa2e4a3b0a3ffa3cd,0x8f2e9c6ea011a1a8,0x23b022c621551ef1,0x215522c623b02400,0x9f58995c18791ef1,0xa3eca3e3a31ca1a8
.quad 0x9d49a0fda2c6a3cd,0x22c620fd1d498000,0x234d23fd239f2241,0x9cdc132d1e8921a8,0xa364a1a89e1f8000,0x9e1fa1a8a364a400,0x1db5932d9f58a241,0x231c23fd237921a8
.quad 0x8000800080008000,0x8000800080008000,0xa072a0a1a0cfa0fd,0x9f589fbda011a042,0x2364238d23b023cd,0x228622c623002335,0xa3d9a3b0a379a335,0xa3eca3fda3ffa3f3
.quad 0x21a820fd20421ef1,0x238d233522c62241,0x9a3e932d15611b1f,0xa17fa0a19f589d49,0x9e1fa042a155a241,0x1c6e172a932d9b1f,0x22a7236423d92400,0x1a3e1e1f207221a8
.quad 0xa400a3cda335a241,0xa0fda241a335a3cd,0x22a721551f581b1f,0x234d23e323f9238d,0x9e1f972a195c1ef1,0xa3fda38da286a0fd,0x9a3e9fbda1d0a335,0x22e421551e89172a
.quad 0x21a8233523f323cd,0xa0429b1f172a1ef1,0xa3d9a3e3a2e4a0fd,0x15619c6ea0cfa2c6,0x236421a81e1f8000,0x1e1f21a823642400,0xa072995c1bfe20fd,0xa21da3b0a3eca2c6
.quad 0x8000800080008000,0x8000800080008000,0x9db59e1f9e899ef1,0x9bfe9c6e9cdc9d49,0x215521a821f72241,0x1fbd204220a120fd,0xa31ca364a39fa3cd,0xa17fa1f7a264a2c6
.quad 0x23f3240023f323cd,0x22c62335238d23cd,0xa3bfa364a2e4a241,0xa39fa3e3a3ffa3f3,0x228621a820a11ef1,0x23fd23f323b02335,0xa0729e1f9a3e8000,0xa3d9a364a2a7a1a8
.quad 0x1b1f80009b1f9ef1,0x2335224120fd1ef1,0x18791e1f20cf2241,0xa21da0a19db5972a,0x9fbda1a8a300a3cd,0x20a11d49132d9b1f,0x221d236423f923cd,0x9db5932d1bfe2042
.quad 0xa38da400a38da241,0x172a9b1fa042a241,0x23ff236421d01ef1,0x18791fbd221d238d,0xa364a1a89e1f8000,0x9e1fa1a8a364a400,0x21d01e1f8f2e9ef1,0x20cf230023f9238d
.quad 0x8000800080008000,0x8000800080008000,0x9879995c9a3e9b1f,0x8f2e932d9561972a,0x1c6e1d491e1f1ef1,0x132d172a195c1b1f,0x9e899fbda072a0fd,0x9561995c9bfe9d49
.quad 0x204220fd21a82241,0x172a1b1f1d491ef1,0xa129a1f7a2a7a335,0x98799c6e9e89a042,0x21f722c6236423cd,0x195c1d491fbd20fd,0xa2a7a364a3d9a400,0x9a3e9e1fa072a1a8
.quad 0x233523cd240023cd,0x1b1f1ef120fd2241,0xa39fa3fda3d9a335,0x9bfe9fbda17fa2c6,0x23e323f323642241,0x1c6e204221f72335,0xa3ffa3b0a2a7a0fd,0x9cdca0a1a264a38d
.quad 0x23f3233521a81ef1,0x1d4920fd22c623cd,0xa3bfa286a0729b1f,0x9db5a155a31ca3f3,0x236421a81e1f8000,0x1e1f21a823642400,0xa2e4a0a19a3e1b1f,0x9e89a1f7a39fa3f3
.quad 0x8000800080008000,0x8000800080008000,0x1561132d0f2e8000,0x1a3e195c1879172a,0x995c972a932d8000,0x9e1f9d499c6e9b1f,0x1bfe195c15618000,0x20721fbd1e891d49
.quad 0x9d499b1f972a8000,0xa1a8a0fda0429ef1,0x1e891c6e18798000,0x22a721f721292042,0x9fbd9d49995c8000,0xa364a2c6a1f7a0fd,0x20721e1f1a3e8000,0x23d9236422a721a8
.quad 0xa0fd9ef19b1f8000,0xa400a3cda335a241,0x217f1fbd1bfe8000,0x23d923fd239f22c6,0xa1f7a0429c6e8000,0xa364a3f3a3e3a335,0x226420a11cdc8000,0x22a723b023ff238d
.quad 0xa2c6a0fd9d498000,0xa1a8a335a3f3a3cd,0x231c21551db58000,0x2072228623bf23f3,0xa364a1a89e1f8000,0x9e1fa1a8a364a400,0x239f21f71e898000,0x1a3e20a122e423f3
.quad 0x8000800080008000,0x8000800080008000,0x1cdc1c6e1bfe1b1f,0x1e891e1f1db51d49,0xa0a1a0429fbd9ef1,0xa1f7a1a8a155a0fd,0x226421f7217f20fd,0x239f2364231c22c6
.quad 0xa38da335a2c6a241,0xa3f3a400a3f3a3cd,0x23ff23e3239f2335,0x22e4236423bf23f3,0xa3b0a3f3a3fda3cd,0xa0a1a1a8a286a335,0x22a7236423d92400,0x1a3e1e1f207221a8
.quad 0xa0fda241a335a3cd,0x1b1f80009b1f9ef1,0x1db520a1221d2335,0xa0cf9e1f9879172a,0x932d9d49a0a1a241,0x230021a81fbd1b1f,0x9bfe132d1db520fd,0xa3f9a364a21da042
.quad 0x20421b1f972a9ef1,0x238d2400238d2241,0xa21d9fbd98791b1f,0xa1d0a364a3ffa38d,0x236421a81e1f8000,0x1e1f21a823642400,0xa3f9a300a0cf9b1f,0xf2e9e1fa1d0a38d
.quad 0x8000800080008000,0x8000800080008000,0x20111fbd1f581ef1,0x20cf20a120722042,0xa300a2c6a286a241,0xa3b0a38da364a335,0x23ff23fd23ec23cd,0x237923b023d923f3
.quad 0xa2c6a335a38da3cd,0xa042a0fda1a8a241,0x1f5820a1217f2241,0x9561132d1a3e1d49,0x132d972a9c6e9ef1,0x215520421e1f1b1f,0xa0729e1f9a3e8000,0xa3d9a364a2a7a1a8
.quad 0x2335224120fd1ef1,0x233523cd240023cd,0xa3f9a3e3a34da241,0x9f58a155a2a7a38d,0x2286238d23fd23cd,0x995c172a1e1f20fd,0x9e89a155a2e4a3cd,0x21d01fbd1a3e972a
.quad 0x972a1b1f20422241,0xa3f3a335a1a89ef1,0x20cf1c6e95619ef1,0x22e423e323d922c6,0xa364a1a89e1f8000,0x9e1fa1a8a364a400,0x23ec23b0221d1ef1,0x9bfe195c207222c6
.quad 0x8000800080008000,0x8000800080008000,0x217f2155212920fd,0x221d21f721d021a8,0xa3fda3f3a3e3a3cd,0xa3e3a3f3a3fda400,0x221d228622e42335,0x201120a1212921a8
.quad 0x972a9b1f9d499ef1,0x1d491b1f172a8000,0xa0cf9fbd9db59b1f,0xa379a300a264a1a8,0x23e3238d23002241,0x2300238d23e32400,0xa2a7a364a3d9a400,0x9a3e9e1fa072a1a8
.quad 0x1b1f1ef120fd2241,0xa0fd9ef19b1f8000,0x20111c6e0f2e9b1f,0x23ff23b022e421a8,0xa3b0a2c6a1559ef1,0xa155a2c6a3b0a400,0x231c23e323ec2335,0x9879195c1f5821a8
.quad 0x9d49a0fda2c6a3cd,0x22c620fd1d498000,0x9e89932d1cdc20fd,0xa39fa3fda34da1a8,0x236421a81e1f8000,0x1e1f21a823642400,0xa379a3fda31ca0fd,0x1f58132d9db5a1a8
.quad 0x8000800080008000,0x8000800080008000,0x22a7228622642241,0x231c230022e422c6,0xa364a38da3b0a3cd,0xa286a2c6a300a335,0x1a3e1c6e1db51ef1,0x9879932d0f2e172a
.quad 0x21a820fd20421ef1,0x238d233522c62241,0xa3d9a3fda3f9a3cd,0xa1d0a286a31ca38d,0x1e1f204221552241,0x9c6e972a132d1b1f,0x20721e1f1a3e8000,0x23d9236422a721a8
.quad 0xa400a3cda335a241,0xa0fda241a335a3cd,0x207221f7231c23cd,0x9e89995c15611d49,0x1e1f172a995c9ef1,0x23fd238d228620fd,0xa3d9a300a17f9ef1,0xa011a1f7a34da3f3
.quad 0x21a8233523f323cd,0xa0429b1f172a1ef1,0x1a3e995ca011a241,0x23f923b022642042,0xa364a1a89e1f8000,0x9e1fa1a8a364a400,0x22a723e323bf2241,0xa1299c6e18792042
.quad 0x8000800080008000,0x8000800080008000,0x23792364234d2335,0x23bf23b0239f238d,0xa155a1a8a1f7a241,0x9fbda042a0a1a0fd,0x9f589e1f9cdc9b1f,0xa1d0a155a0cfa042
.quad 0x23f3240023f323cd,0x22c62335238d23cd,0x9bfe9e1fa011a0fd,0x1cdc195c0f2e972a,0xa286a1a8a0a19ef1,0xa3fda3f3a3b0a335,0x22a7236423d92400,0x1a3e1e1f207221a8
.quad 0x1b1f80009b1f9ef1,0x2335224120fd1ef1,0xa3eca364a264a0fd,0xa129a286a379a3f3,0x1fbd21a8230023cd,0xa0a19d49932d1b1f,0x21291e1f15619b1f,0x237923fd23bf22c6
.quad 0xa38da400a38da241,0x172a9b1fa042a241,0xf2e1e1f217f2335,0xa3eca300a1299d49,0x236421a81e1f8000,0x1e1f21a823642400,0xa17fa364a3ffa335,0x22641fbd15619d49
.quad 0x8000800080008000,0x8000800080008000,0x23ec23e323d923cd,0x23ff23fd23f923f3,0x9c6e9d499e1f9ef1,0x932d972a995c9b1f,0xa34da300a2a7a241,0xa3f9a3e3a3bfa38d
.quad 0x204220fd21a82241,0x172a1b1f1d491ef1,0x221d215520721ef1,0x23ec23b0234d22c6,0xa1f7a2c6a364a3cd,0x995c9d499fbda0fd,0xa0729e1f9a3e8000,0xa3d9a364a2a7a1a8
.quad 0x233523cd240023cd,0x1b1f1ef120fd2241,0x1cdc132d9a3e9ef1,0x23bf230021d02042,0xa3e3a3f3a364a241,0x9c6ea042a1f7a335,0x8f2e1c6e20722241,0xa39fa286a0cf9d49
.quad 0x23f3233521a81ef1,0x1d4920fd22c623cd,0x9bfea0a1a2a7a3cd,0x237921f71f58172a,0xa364a1a89e1f8000,0x9e1fa1a8a364a400,0x2011228623d923cd,0xa34da1559cdc172a
.quad 0x8000800080008000,0x8000800080008000,0x23f923fd23ff2400,0x23d923e323ec23f3,0x195c172a132d8000,0x1e1f1d491c6e1b1f,0xa3bfa3e3a3f9a400,0xa2a7a300a34da38d
.quad 0x9d499b1f972a8000,0xa1a8a0fda0429ef1,0x234d23b023ec2400,0x20722155221d22c6,0x1fbd1d49195c8000,0x236422c621f720fd,0xa2a7a364a3d9a400,0x9a3e9e1fa072a1a8
.quad 0xa0fd9ef19b1f8000,0xa400a3cda335a241,0x21d0230023bf2400,0x9a3e132d1cdc2042,0x21f720421c6e8000,0x236423f323e32335,0xa0cfa286a39fa400,0x20721c6e8f2e9d49
.quad 0xa2c6a0fd9d498000,0xa1a8a335a3f3a3cd,0x1f5821f723792400,0xa2a7a0a19bfe172a,0x236421a81e1f8000,0x1e1f21a823642400,0x9cdca155a34da400,0x23d922862011172a
.quad 0x8000800080008000,0x8000800080008000,0x239f23b023bf23cd,0x234d23642379238d,0x20a120421fbd1ef1,0x21f721a8215520fd,0xa0cfa155a1d0a241,0x9cdc9e1f9f58a042
.quad 0xa38da335a2c6a241,0xa3f3a400a3f3a3cd,0xf2e195c1cdc1ef1,0xa0119e1f9bfe972a,0x23b023f323fd23cd,0x20a121a822862335,0x20721e1f1a3e8000,0x23d9236422a721a8
.quad 0xa0fda241a335a3cd,0x1b1f80009b1f9ef1,0xa379a286a1299ef1,0xa264a364a3eca3f3,0x132d1d4920a12241,0xa300a1a89fbd9b1f,0x23bf23fd23792241,0x15611e1f212922c6
.quad 0x20421b1f972a9ef1,0x238d2400238d2241,0xa129a300a3eca3cd,0x217f1e1f0f2e9d49,0xa364a1a89e1f8000,0x9e1fa1a8a364a400,0x15611fbd226423cd,0xa3ffa364a17f9d49
.quad 0x8000800080008000,0x8000800080008000,0x22e42300231c2335,0x2264228622a722c6,0x230022c622862241,0x23b0238d23642335,0xf2e932d98799b1f,0x1db51c6e1a3e172a
.quad 0xa2c6a335a38da3cd,0xa042a0fda1a8a241,0xa31ca286a1d0a0fd,0xa3f9a3fda3d9a38d,0x932d172a1c6e1ef1,0xa155a0429e1f9b1f,0x22a7236423d92400,0x1a3e1e1f207221a8
.quad 0x2335224120fd1ef1,0x233523cd240023cd,0x1561995c9e89a0fd,0x231c21f720721d49,0xa286a38da3fda3cd,0x195c972a9e1fa0fd,0xa34da1f7a0119b1f,0xa17fa300a3d9a3f3
.quad 0x972a1b1f20422241,0xa3f3a335a1a89ef1,0x226423b023f92335,0xa011995c1a3e2042,0x236421a81e1f8000,0x1e1f21a823642400,0x18799c6ea129a335,0x23bf23e322a72042
.quad 0x8000800080008000,0x8000800080008000,0x21d021f7221d2241,0x21292155217f21a8,0x23fd23f323e323cd,0x23e323f323fd2400,0x212920a120111ef1,0x22e42286221d21a8
.quad 0x972a9b1f9d499ef1,0x1d491b1f172a8000,0xa264a300a379a3cd,0x9db59fbda0cfa1a8,0xa3e3a38da300a241,0xa300a38da3e3a400,0xa0729e1f9a3e8000,0xa3d9a364a2a7a1a8
.quad 0x1b1f1ef120fd2241,0xa0fd9ef19b1f8000,0x22e423b023ff23cd,0xf2e1c6e201121a8,0x23b022c621551ef1,0x215522c623b02400,0x1f58195c98799ef1,0x23ec23e3231c21a8
.quad 0x9d49a0fda2c6a3cd,0x22c620fd1d498000,0xa34da3fda39fa241,0x1cdc932d9e89a1a8,0xa364a1a89e1f8000,0x9e1fa1a8a364a400,0x9db5132d1f582241,0xa31ca3fda379a1a8
.quad 0x8000800080008000,0x8000800080008000,0x207220a120cf20fd,0x1f581fbd20112042,0x2364238d23b023cd,0x228622c623002335,0x23d923b023792335,0x23ec23fd23ff23f3
.quad 0x21a820fd20421ef1,0x238d233522c62241,0x1a3e132d95619b1f,0x217f20a11f581d49,0x9e1fa042a155a241,0x1c6e172a932d9b1f,0xa2a7a364a3d9a400,0x9a3e9e1fa072a1a8
.quad 0xa400a3cda335a241,0xa0fda241a335a3cd,0xa2a7a1559f589b1f,0xa34da3e3a3f9a38d,0x9e1f972a195c1ef1,0xa3fda38da286a0fd,0x1a3e1fbd21d02335,0xa2e4a1559e89972a
.quad 0x21a8233523f323cd,0xa0429b1f172a1ef1,0x23d923e322e420fd,0x95611c6e20cf22c6,0x236421a81e1f8000,0x1e1f21a823642400,0x2072195c9bfea0fd,0x221d23b023ec22c6
.quad 0x8000800080008000,0x8000800080008000,0x1db51e1f1e891ef1,0x1bfe1c6e1cdc1d49,0x215521a821f72241,0x1fbd204220a120fd,0x231c2364239f23cd,0x217f21f7226422c6
.quad 0x23f3240023f323cd,0x22c62335238d23cd,0x23bf236422e42241,0x239f23e323ff23f3,0x228621a820a11ef1,0x23fd23f323b02335,0x20721e1f1a3e8000,0x23d9236422a721a8
.quad 0x1b1f80009b1f9ef1,0x2335224120fd1ef1,0x98799e1fa0cfa241,0x221d20a11db5172a,0x9fbda1a8a300a3cd,0x20a11d49132d9b1f,0xa21da364a3f9a3cd,0x1db5132d9bfea042
.quad 0xa38da400a38da241,0x172a9b1fa042a241,0xa3ffa364a1d09ef1,0x98799fbda21da38d,0xa364a1a89e1f8000,0x9e1fa1a8a364a400,0xa1d09e1f0f2e1ef1,0xa0cfa300a3f9a38d
.quad 0x8000800080008000,0x8000800080008000,0x1879195c1a3e1b1f,0xf2e132d1561172a,0x1c6e1d491e1f1ef1,0x132d172a195c1b1f,0x1e891fbd207220fd,0x1561195c1bfe1d49
.quad 0x204220fd21a82241,0x172a1b1f1d491ef1,0x212921f722a72335,0x18791c6e1e892042,0x21f722c6236423cd,0x195c1d491fbd20fd,0x22a7236423d92400,0x1a3e1e1f207221a8
.quad 0x233523cd240023cd,0x1b1f1ef120fd2241,0x239f23fd23d92335,0x1bfe1fbd217f22c6,0x23e323f323642241,0x1c6e204221f72335,0x23ff23b022a720fd,0x1cdc20a12264238d
.quad 0x23f3233521a81ef1,0x1d4920fd22c623cd,0x23bf228620721b1f,0x1db52155231c23f3,0x236421a81e1f8000,0x1e1f21a823642400,0x22e420a11a3e9b1f,0x1e8921f7239f23f3
.quad 0x1b1f20fd23352400,0xa400a335a0fd9b1f,0x187920a1231c2400,0xa3d9a3b0a1d09d49,0x132d204223002400,0xa364a3f3a2869ef1,0x8f2e1fbd22e42400,0xa2a7a3fda31ca042
.quad 0x972a1ef122c62400,0xa1a8a3cda38da0fd,0x9a3e1e1f22a72400,0xa072a364a3d9a1a8,0x9c6e1d4922862400,0x9e1fa2c6a3fda241,0x9db51c6e22642400,0x9a3ea1f7a3f9a2c6
.quad 0x9ef11b1f22412400,0x8000a0fda3cda335,0xa011195c221d2400,0x1a3e9fbda379a38d,0xa0a1172a21f72400,0x1e1f9d49a300a3cd,0xa129132d21d02400,0x2072995ca264a3f3
.quad 0xa1a8000021a82400,0x21a88000a1a8a400,0xa21d932d217f2400,0x22a7195ca0cfa3f3,0xa286972a21552400,0x23641d499fbda3cd,0xa2e4995c21292400,0x23d91fbd9db5a38d
.quad 0x1b1f9b1fa0fda335,0x23352400233520fd,0x2011132d9e89a241,0x2129236423f922c6,0x21f71d49995ca0fd,0x1c6e21a823b023cd,0x234d20a115619ef1,0x98791e1f226423f3
.quad 0x23f322411d499b1f,0xa042000020422335,0x23d9236420728000,0xa2a79e1f1a3e21a8,0x230023f321f71b1f,0xa3e3a1a8995c1ef1,0x217f23e3231c1ef1,0xa3bfa364a011172a
.quad 0x1ef1233523cd20fd,0xa241a400a2419b1f,0x187921f723ff2241,0x9f58a364a39fa042,0x995c204223b02335,0x932da1a8a3fda241,0x9f581c6e22e423cd,0x1db59e1fa34da38d
.quad 0xa1a8000021a82400,0x21a88000a1a8a400,0xa31c9c6e201123cd,0x23791e1f9e89a38d,0xa3e3a0421c6e2335,0x23fd21a8932da241,0xa3eca1f70f2e2241,0x231c23641cdca042
.quad 0xa0fd9b1f1b1f20fd,0xa0fda335a400a335,0xa379a1559bfe1b1f,0x8f2e9fbda2a7a3f3,0xa3e3a38da1559b1f,0x20a1172a9e1fa241,0xa21da3e3a379a0fd,0x239f21551a3e9d49
.quad 0x9d49a241a3f3a335,0x238d23cd21a81b1f,0x1a3e9e1fa2a7a400,0x2072236423d921a8,0x2155172a9fbda335,0x932d2042236423cd,0x239f20a18f2ea0fd,0xa129932d2072238d
.quad 0x23cd23351ef19b1f,0xa3cda0fd000020fd,0x21d023fd22641b1f,0xa34da3b0a072172a,0x1c6e22c623e320fd,0x9fbda38da3649ef1,0x9bfe1fbd239f2335,0x1879a0a1a3d9a2c6
.quad 0xa1a8000021a82400,0x21a88000a1a8a400,0xa3bf9fbd1cdc2335,0x23ec20a19a3ea2c6,0xa3b0a2c6995c20fd,0x2300238d1e1f9ef1,0xa17fa3fda0cf1b1f,0x1e8923b022a7172a
.quad 0x233520fd1b1f9b1f,0x1b1f20fd23352400,0x239f23e322641ef1,0xa0cf995c1cdc21a8,0x1fbd22c623fd2335,0xa3fda2c69fbd0000,0x9bfe1c6e21d023cd,0xa17fa3b0a3bfa1a8
.quad 0xa2c69ef1172a20fd,0x172a9ef1a2c6a400,0xa3d9a364a0720000,0x22a71e1f9a3ea1a8,0xa0a1a38da3b0a0fd,0x23b0238d20a18000,0x18799fbda34da3cd,0x1e89230023ec21a8
.quad 0x22411b1f9ef1a335,0x9ef11b1f22412400,0x23f922861bfe9ef1,0xa3bfa0a1156121a8,0x215523f322861b1f,0xa286a3f3a1550000,0x8f2e215523f92241,0x9561a1f7a3ffa1a8
.quad 0xa1a8000021a82400,0x21a88000a1a8a400,0xa3ffa15515612241,0x23f921f70f2ea1a8,0xa1f7a3f3a0a11b1f,0x20a123f321f78000,0x9561a286a3bf9ef1,0x9bfe20a123f921a8
.quad 0xa400a335a0fd9b1f,0x1b1f9b1fa0fda335,0xa072a300a3ffa335,0x23bf21f71db5972a,0x1e1f972aa0a1a335,0x2155238d23e32241,0x23d921f71cdc9b1f,0x9db5195c2129238d
.quad 0x21a823cd238d20fd,0xa3f3a2419d491b1f,0x9a3e1e1f22a72400,0xa072a364a3d9a1a8,0xa364a042132d20fd,0x1fbd972aa155a3cd,0xa2a7a3fda21d9b1f,0x23ff22861cdc9d49
.quad 0x8000a0fda3cda335,0x1ef1233523cd20fd,0x22a71c6e9e89a335,0xa0cf132d217f23f3,0x2364238d1fbd9b1f,0xa3e3a2c69c6e1ef1,0x1a3e228623ec20fd,0x9cdca300a3bfa042
.quad 0xa1a8000021a82400,0x21a88000a1a8a400,0xa3d9a286987920fd,0x239f23001bfea042,0x9e1fa38da3009b1f,0x195c22c623b01ef1,0x20729c6ea34da335,0xa264932d21d023f3
.quad 0x23352400233520fd,0xa0fd9b1f1b1f20fd,0x95611e1f221d23cd,0xa34da3fda2e4a042,0xa3b0a1a89c6e1b1f,0x195c9d49a1f7a3cd,0xa0cfa364a3eca241,0x23f922861e89972a
.quad 0x20428000a042a335,0x1d49224123f32335,0x23d9236420728000,0xa2a79e1f1a3e21a8,0x195c21a823e32335,0xa1f7a3f3a3009ef1,0xa2e49e1f1bfe2241,0x1f58995ca1d0a3f3
.quad 0xa241a400a2419b1f,0x23cd23351ef19b1f,0x1cdc9e1fa31ca3cd,0xf2e215523ec22c6,0x23fd21a8132da0fd,0xa3b0a042195c2241,0x1e89236423791ef1,0xa011a3b0a31c9d49
.quad 0xa1a8000021a82400,0x21a88000a1a8a400,0xa34da3649db51ef1,0x22e423b01f589d49,0x132da1a8a3fda0fd,0x9c6e204223e32241,0x239f1e1f9f58a3cd,0xa3ffa155187922c6
.quad 0xa0fda335a400a335,0x233520fd1b1f9b1f,0x217f1c6e9a3ea0fd,0x1f58228623ec238d,0x228623f3236420fd,0xa300a042932d1ef1,0x9f58132d20722335,0xa011a300a3ffa2c6
.quad 0xa38da3cda1a89b1f,0x22c61ef1972aa0fd,0x1a3e9e1fa2a7a400,0x2072236423d921a8,0x23fd22c61e1f9b1f,0xa2869d491c6e2241,0x1561215523d92335,0xa0cfa3b0a379a042
.quad 0xa3cda0fd000020fd,0x22411b1f9ef1a335,0x9db5a300a3d9a0fd,0x212923e322e41d49,0x23001d499e1fa335,0xa1f7972a20a123cd,0x20cf23e322a71b1f,0xa17fa3fda21d972a
.quad 0xa1a8000021a82400,0x21a88000a1a8a400,0xa264a3e3a0721b1f,0x21d023fd2129972a,0x1fbd9d49a364a335,0xa155172a228623cd,0x237923001a3ea0fd,0xa21da3e3a0111d49
.quad 0x1b1f20fd23352400,0xa400a335a0fd9b1f,0xa3eca2869f580000,0x1a3e9c6ea17fa38d,0x932da042a300a400,0x236423f322861ef1,0x23ff230020118000,0xa072932d1f5822c6
.quad 0x972a1ef122c62400,0xa1a8a3cda38da0fd,0xa3d9a364a0720000,0x22a71e1f9a3ea1a8,0x1c6e9d49a286a400,0x1e1f22c623fd2241,0x237923b020cf8000,0xa3d9a15595612042
.quad 0x9ef11b1f22412400,0x8000a0fda3cda335,0xa2e4a3e3a1290000,0x23d923001db59d49,0x20a1972aa1f7a400,0x9e1f1d49230023cd,0x221d23fd217f8000,0xa2a7a3e3a0cf172a
.quad 0xa1a8000021a82400,0x21a88000a1a8a400,0xa129a3fda1d00000,0x207223e32264172a,0x2286172aa155a400,0xa3649d491fbd23cd,0x201123e3221d8000,0x9a3ea300a3799d49
.quad 0x1b1f9b1fa0fda335,0x23352400233520fd,0x22e423fd234d20fd,0xa21d9e1f15612042,0xa1f79d49195c20fd,0x9c6ea1a8a3b0a3cd,0x9e89a286a3f9a335,0x23ec236420cf172a
.quad 0x23f322411d499b1f,0xa042000020422335,0x9a3e1e1f22a72400,0xa072a364a3d9a1a8,0xa300a3f3a1f79b1f,0x23e321a8195c9ef1,0x21d0195c9f58a335,0x9bfe1e1f22e423f3
.quad 0x1ef1233523cd20fd,0xa241a400a2419b1f,0xa3eca1558f2e20fd,0x231c1e1f9cdca2c6,0x195ca042a3b0a335,0x132d21a823fd2241,0x231c23b020119b1f,0xa379a3649e891d49
.quad 0xa1a8000021a82400,0x21a88000a1a8a400,0x9f58a3b0a2e49b1f,0x1db52364234d1d49,0x23e320429c6ea335,0xa3fda1a8132d2241,0x9879215523ff20fd,0x1f589e1fa39fa2c6
.quad 0xa0fd9b1f1b1f20fd,0xa0fda335a400a335,0x9db5a1f7a3bfa3cd,0x23ff23002072172a,0x23e3238d21551b1f,0xa0a1972a1e1f2241,0xa129995c1db52241,0x9cdca1f7a3d9a38d
.quad 0x9d49a241a3f3a335,0x238d23cd21a81b1f,0x23d9236420728000,0xa2a79e1f1a3e21a8,0xa155972a1fbd2335,0x132da042a364a3cd,0x9cdca286a3ffa241,0x221d23fd22a71d49
.quad 0x23cd23351ef19b1f,0xa3cda0fd000020fd,0xa17f932d20cf23cd,0x1e899c6ea2a7a3f3,0x9c6ea2c6a3e3a0fd,0x1fbd238d23641ef1,0x23bf23001cdc9ef1,0xa3eca2869a3e2042
.quad 0xa1a8000021a82400,0x21a88000a1a8a400,0x9bfea300a39f9ef1,0x1879228623d92042,0x23b022c6195ca0fd,0xa300a38d9e1f1ef1,0xa1d0132d226423cd,0x234d1c6ea072a3f3
.quad 0x233520fd1b1f9b1f,0x1b1f20fd23352400,0x9cdc195c20cf2335,0xa264a3e3a39fa1a8,0x9fbda2c6a3fda335,0x23fd22c61fbd8000,0x23bf23b0217f1b1f,0xa1d09c6e1bfe21a8
.quad 0xa2c69ef1172a20fd,0x172a9ef1a2c6a400,0x1a3e9e1fa2a7a400,0x2072236423d921a8,0x20a1238d23b020fd,0xa3b0a38da0a10000,0xa3eca3009e891b1f,0x234d1fbd9879a1a8
.quad 0x22411b1f9ef1a335,0x9ef11b1f22412400,0x956120a123bf2335,0x9bfea286a3f9a1a8,0xa155a3f3a2869b1f,0x228623f321558000,0x23ff21f71561a0fd,0xa3f9a1550f2e21a8
.quad 0xa1a8000021a82400,0x21a88000a1a8a400,0x8f2ea1f7a3f9a0fd,0x9561215523ff21a8,0x21f723f320a19b1f,0xa0a1a3f3a1f70000,0xa3f9a0a11bfe2335,0x23bf22861561a1a8
.quad 0xa400a335a0fd9b1f,0x1b1f9b1fa0fda335,0x22a71fbd0f2e9ef1,0x1bfe2155237923f3,0x9e1f172a20a12335,0xa155a38da3e3a241,0x9a3ea155a39fa3cd,0x237923e3221d1d49
.quad 0x21a823cd238d20fd,0xa3f3a2419d491b1f,0xa3d9a364a0720000,0x22a71e1f9a3ea1a8,0x23642042932da0fd,0x9fbd172a215523cd,0xa072132d212923cd,0xf2ea0a1a39fa38d
.quad 0x8000a0fda3cda335,0x1ef1233523cd20fd,0x207223b0234d1ef1,0xa264a3fda1d0972a,0xa364a38d9fbd1b1f,0x23e322c61c6e9ef1,0x23d920a19879a241,0xa39f9fbd1bfe22c6
.quad 0xa1a8000021a82400,0x21a88000a1a8a400,0x1a3ea0a1a3eca241,0x9cdc1fbd23bf22c6,0x1e1f238d23001b1f,0x995ca2c6a3b09ef1,0xa2a7a3b09e891ef1,0x20cf23fd217f972a
.quad 0x23352400233520fd,0xa0fd9b1f1b1f20fd,0xa3f9a364a1299b1f,0x1e89932da011a2c6,0x23b021a81c6e9b1f,0x995c1d4921f723cd,0xa2649e1f187920fd,0x9561a0a1a34da3f3
.quad 0x20428000a042a335,0x1d49224123f32335,0x9a3e1e1f22a72400,0xa072a364a3d9a1a8,0x995ca1a8a3e3a335,0x21f723f323001ef1,0x2011236423bf20fd,0xa31ca3e3a17f972a
.quad 0xa241a400a2419b1f,0x23cd23351ef19b1f,0x239f23641f589b1f,0xa3ffa1f798792042,0xa3fda1a8932d20fd,0x23b02042995ca241,0x234d1e1f9db5a335,0xa2e49c6e1f58238d
.quad 0xa1a8000021a82400,0x21a88000a1a8a400,0x1e899e1fa379a335,0xa0111c6e231c238d,0x932d21a823fd20fd,0x1c6ea042a3e3a241,0x9cdca364a31c9b1f,0x8f2e21f723ec2042
.quad 0xa0fda335a400a335,0x233520fd1b1f9b1f,0x21d023b023d92241,0xa31ca0a198791d49,0xa286a3f3a364a0fd,0x23002042132d9ef1,0x231c23fd22a71ef1,0xa2e49fbd0f2e2042
.quad 0xa38da3cda1a89b1f,0x22c61ef1972aa0fd,0x23d9236420728000,0xa2a79e1f1a3e21a8,0xa3fda2c69e1f1b1f,0x22861d499c6ea241,0x23f921f71a3e9ef1,0xa2649c6e1db522c6
.quad 0xa3cda0fd000020fd,0x22411b1f9ef1a335,0x23791fbd9a3ea241,0xa21d995c2011238d,0xa3009d491e1f2335,0x21f7172aa0a1a3cd,0x2264195ca072a3cd,0xa1d0932d212923f3
.quad 0xa1a8000021a82400,0x21a88000a1a8a400,0x20cf995ca2a7a3cd,0xa17f132d221d23f3,0x9fbd1d4923642335,0x2155972aa286a3cd,0x1db59fbda3d9a241,0xa129195c22e4238d
.quad 0x1b1f20fd23352400,0xa400a335a0fd9b1f,0x9879a0a1a31ca400,0x23d923b021d01d49,0x132d204223002400,0xa364a3f3a2869ef1,0xf2e9fbda2e4a400,0x22a723fd231c2042
.quad 0x972a1ef122c62400,0xa1a8a3cda38da0fd,0x1a3e9e1fa2a7a400,0x2072236423d921a8,0x9c6e1d4922862400,0x9e1fa2c6a3fda241,0x1db59c6ea264a400,0x1a3e21f723f922c6
.quad 0x9ef11b1f22412400,0x8000a0fda3cda335,0x2011995ca21da400,0x9a3e1fbd2379238d,0xa0a1172a21f72400,0x1e1f9d49a300a3cd,0x2129932da1d0a400,0xa072195c226423f3
.quad 0xa1a8000021a82400,0x21a88000a1a8a400,0x221d132da17fa400,0xa2a7995c20cf23f3,0xa286972a21552400,0x23641d499fbda3cd,0x22e4195ca129a400,0xa3d99fbd1db5238d
.quad 0x1b1f9b1fa0fda335,0x23352400233520fd,0xa011932d1e892241,0xa129a364a3f9a2c6,0x21f71d49995ca0fd,0x1c6e21a823b023cd,0xa34da0a195611ef1,0x18799e1fa264a3f3
.quad 0x23f322411d499b1f,0xa042000020422335,0xa3d9a364a0720000,0x22a71e1f9a3ea1a8,0x230023f321f71b1f,0xa3e3a1a8995c1ef1,0xa17fa3e3a31c9ef1,0x23bf23642011972a
.quad 0x1ef1233523cd20fd,0xa241a400a2419b1f,0x9879a1f7a3ffa241,0x1f582364239f2042,0x995c204223b02335,0x932da1a8a3fda241,0x1f589c6ea2e4a3cd,0x9db51e1f234d238d
.quad 0xa1a8000021a82400,0x21a88000a1a8a400,0x231c1c6ea011a3cd,0xa3799e1f1e89238d,0xa3e3a0421c6e2335,0x23fd21a8932da241,0x23ec21f78f2ea241,0xa31ca3649cdc2042
.quad 0xa0fd9b1f1b1f20fd,0xa0fda335a400a335,0x237921551bfe9b1f,0xf2e1fbd22a723f3,0xa3e3a38da1559b1f,0x20a1172a9e1fa241,0x221d23e3237920fd,0xa39fa1559a3e1d49
.quad 0x9d49a241a3f3a335,0x238d23cd21a81b1f,0x9a3e1e1f22a72400,0xa072a364a3d9a1a8,0x2155172a9fbda335,0x932d2042236423cd,0xa39fa0a10f2e20fd,0x2129132da072a38d
.quad 0x23cd23351ef19b1f,0xa3cda0fd000020fd,0xa1d0a3fda2649b1f,0x234d23b02072972a,0x1c6e22c623e320fd,0x9fbda38da3649ef1,0x1bfe9fbda39fa335,0x987920a123d922c6
.quad 0xa1a8000021a82400,0x21a88000a1a8a400,0x23bf1fbd9cdca335,0xa3eca0a11a3e22c6,0xa3b0a2c6995c20fd,0x2300238d1e1f9ef1,0x217f23fd20cf9b1f,0x9e89a3b0a2a7972a
.quad 0x233520fd1b1f9b1f,0x1b1f20fd23352400,0xa39fa3e3a2649ef1,0x20cf195c9cdca1a8,0x1fbd22c623fd2335,0xa3fda2c69fbd0000,0x1bfe9c6ea1d0a3cd,0x217f23b023bf21a8
.quad 0xa2c69ef1172a20fd,0x172a9ef1a2c6a400,0x23d9236420728000,0xa2a79e1f1a3e21a8,0xa0a1a38da3b0a0fd,0x23b0238d20a18000,0x98791fbd234d23cd,0x9e89a300a3eca1a8
.quad 0x22411b1f9ef1a335,0x9ef11b1f22412400,0xa3f9a2869bfe1ef1,0x23bf20a19561a1a8,0x215523f322861b1f,0xa286a3f3a1550000,0xf2ea155a3f9a241,0x156121f723ff21a8
.quad 0xa1a8000021a82400,0x21a88000a1a8a400,0x23ff21559561a241,0xa3f9a1f78f2e21a8,0xa1f7a3f3a0a11b1f,0x20a123f321f78000,0x1561228623bf1ef1,0x1bfea0a1a3f9a1a8
.quad 0xa400a335a0fd9b1f,0x1b1f9b1fa0fda335,0x2072230023ff2335,0xa3bfa1f79db5172a,0x1e1f972aa0a1a335,0x2155238d23e32241,0xa3d9a1f79cdc1b1f,0x1db5995ca129a38d
.quad 0x21a823cd238d20fd,0xa3f3a2419d491b1f,0x1a3e9e1fa2a7a400,0x2072236423d921a8,0xa364a042132d20fd,0x1fbd972aa155a3cd,0x22a723fd221d1b1f,0xa3ffa2869cdc1d49
.quad 0x8000a0fda3cda335,0x1ef1233523cd20fd,0xa2a79c6e1e892335,0x20cf932da17fa3f3,0x2364238d1fbd9b1f,0xa3e3a2c69c6e1ef1,0x9a3ea286a3eca0fd,0x1cdc230023bf2042
.quad 0xa1a8000021a82400,0x21a88000a1a8a400,0x23d922861879a0fd,0xa39fa3009bfe2042,0x9e1fa38da3009b1f,0x195c22c623b01ef1,0xa0721c6e234d2335,0x2264132da1d0a3f3
.quad 0x23352400233520fd,0xa0fd9b1f1b1f20fd,0x15619e1fa21da3cd,0x234d23fd22e42042,0xa3b0a1a89c6e1b1f,0x195c9d49a1f7a3cd,0x20cf236423ec2241,0xa3f9a2869e89172a
.quad 0x20428000a042a335,0x1d49224123f32335,0xa3d9a364a0720000,0x22a71e1f9a3ea1a8,0x195c21a823e32335,0xa1f7a3f3a3009ef1,0x22e41e1f9bfea241,0x9f58195c21d023f3
.quad 0xa241a400a2419b1f,0x23cd23351ef19b1f,0x9cdc1e1f231c23cd,0x8f2ea155a3eca2c6,0x23fd21a8132da0fd,0xa3b0a042195c2241,0x9e89a364a3799ef1,0x201123b0231c1d49
.quad 0xa1a8000021a82400,0x21a88000a1a8a400,0x234d23641db59ef1,0xa2e4a3b09f581d49,0x132da1a8a3fda0fd,0x9c6e204223e32241,0xa39f9e1f1f5823cd,0x23ff21559879a2c6
.quad 0xa0fda335a400a335,0x233520fd1b1f9b1f,0xa17f9c6e1a3e20fd,0x9f58a286a3eca38d,0x228623f3236420fd,0xa300a042932d1ef1,0x1f58932da072a335,0x2011230023ff22c6
.quad 0xa38da3cda1a89b1f,0x22c61ef1972aa0fd,0x9a3e1e1f22a72400,0xa072a364a3d9a1a8,0x23fd22c61e1f9b1f,0xa2869d491c6e2241,0x9561a155a3d9a335,0x20cf23b023792042
.quad 0xa3cda0fd000020fd,0x22411b1f9ef1a335,0x1db5230023d920fd,0xa129a3e3a2e49d49,0x23001d499e1fa335,0xa1f7972a20a123cd,0xa0cfa3e3a2a79b1f,0x217f23fd221d172a
.quad 0xa1a8000021a82400,0x21a88000a1a8a400,0x226423e320729b1f,0xa1d0a3fda129172a,0x1fbd9d49a364a335,0xa155172a228623cd,0xa379a3009a3e20fd,0x221d23e320119d49
.quad 0x1b1f20fd23352400,0xa400a335a0fd9b1f,0x23ec22861f588000,0x9a3e1c6e217f238d,0x932da042a300a400,0x236423f322861ef1,0xa3ffa300a0110000,0x2072132d9f58a2c6
.quad 0x972a1ef122c62400,0xa1a8a3cda38da0fd,0x23d9236420728000,0xa2a79e1f1a3e21a8,0x1c6e9d49a286a400,0x1e1f22c623fd2241,0xa379a3b0a0cf0000,0x23d921551561a042
.quad 0x9ef11b1f22412400,0x8000a0fda3cda335,0x22e423e321298000,0xa3d9a3009db51d49,0x20a1972aa1f7a400,0x9e1f1d49230023cd,0xa21da3fda17f0000,0x22a723e320cf972a
.quad 0xa1a8000021a82400,0x21a88000a1a8a400,0x212923fd21d08000,0xa072a3e3a264972a,0x2286172aa155a400,0xa3649d491fbd23cd,0xa011a3e3a21d0000,0x1a3e230023791d49
.quad 0x1b1f9b1fa0fda335,0x23352400233520fd,0xa2e4a3fda34da0fd,0x221d1e1f9561a042,0xa1f79d49195c20fd,0x9c6ea1a8a3b0a3cd,0x1e89228623f92335,0xa3eca364a0cf972a
.quad 0x23f322411d499b1f,0xa042000020422335,0x1a3e9e1fa2a7a400,0x2072236423d921a8,0xa300a3f3a1f79b1f,0x23e321a8195c9ef1,0xa1d0995c1f582335,0x1bfe9e1fa2e4a3f3
.quad 0x1ef1233523cd20fd,0xa241a400a2419b1f,0x23ec21550f2ea0fd,0xa31c9e1f1cdc22c6,0x195ca042a3b0a335,0x132d21a823fd2241,0xa31ca3b0a0111b1f,0x237923641e899d49
.quad 0xa1a8000021a82400,0x21a88000a1a8a400,0x1f5823b022e41b1f,0x9db5a364a34d9d49,0x23e320429c6ea335,0xa3fda1a8132d2241,0x1879a155a3ffa0fd,0x9f581e1f239f22c6
.quad 0xa0fd9b1f1b1f20fd,0xa0fda335a400a335,0x1db521f723bf23cd,0xa3ffa300a072972a,0x23e3238d21551b1f,0xa0a1972a1e1f2241,0x2129195c9db5a241,0x1cdc21f723d9238d
.quad 0x9d49a241a3f3a335,0x238d23cd21a81b1f,0xa3d9a364a0720000,0x22a71e1f9a3ea1a8,0xa155972a1fbd2335,0x132da042a364a3cd,0x1cdc228623ff2241,0xa21da3fda2a79d49
.quad 0x23cd23351ef19b1f,0xa3cda0fd000020fd,0x217f132da0cfa3cd,0x9e891c6e22a723f3,0x9c6ea2c6a3e3a0fd,0x1fbd238d23641ef1,0xa3bfa3009cdc1ef1,0x23ec22861a3ea042
.quad 0xa1a8000021a82400,0x21a88000a1a8a400,0x1bfe2300239f1ef1,0x9879a286a3d9a042,0x23b022c6195ca0fd,0xa300a38d9e1f1ef1,0x21d0932da264a3cd,0xa34d9c6e207223f3
.quad 0x233520fd1b1f9b1f,0x1b1f20fd23352400,0x1cdc995ca0cfa335,0x226423e3239f21a8,0x9fbda2c6a3fda335,0x23fd22c61fbd8000,0xa3bfa3b0a17f9b1f,0x21d01c6e9bfea1a8
.quad 0xa2c69ef1172a20fd,0x172a9ef1a2c6a400,0x9a3e1e1f22a72400,0xa072a364a3d9a1a8,0x20a1238d23b020fd,0xa3b0a38da0a10000,0x23ec23001e899b1f,0xa34d9fbd187921a8
.quad 0x22411b1f9ef1a335,0x9ef11b1f22412400,0x1561a0a1a3bfa335,0x1bfe228623f921a8,0xa155a3f3a2869b1f,0x228623f321558000,0xa3ffa1f7956120fd,0x23f921558f2ea1a8
.quad 0xa1a8000021a82400,0x21a88000a1a8a400,0xf2e21f723f920fd,0x1561a155a3ffa1a8,0x21f723f320a19b1f,0xa0a1a3f3a1f70000,0x23f920a19bfea335,0xa3bfa286956121a8
.quad 0xa400a335a0fd9b1f,0x1b1f9b1fa0fda335,0xa2a79fbd8f2e1ef1,0x9bfea155a379a3f3,0x9e1f172a20a12335,0xa155a38da3e3a241,0x1a3e2155239f23cd,0xa379a3e3a21d9d49
.quad 0x21a823cd238d20fd,0xa3f3a2419d491b1f,0x23d9236420728000,0xa2a79e1f1a3e21a8,0x23642042932da0fd,0x9fbd172a215523cd,0x2072932da129a3cd,0x8f2e20a1239f238d
.quad 0x8000a0fda3cda335,0x1ef1233523cd20fd,0xa072a3b0a34d9ef1,0x226423fd21d0172a,0xa364a38d9fbd1b1f,0x23e322c61c6e9ef1,0xa3d9a0a118792241,0x239f1fbd9bfea2c6
.quad 0xa1a8000021a82400,0x21a88000a1a8a400,0x9a3e20a123ec2241,0x1cdc9fbda3bfa2c6,0x1e1f238d23001b1f,0x995ca2c6a3b09ef1,0x22a723b01e899ef1,0xa0cfa3fda17f172a
.quad 0x23352400233520fd,0xa0fd9b1f1b1f20fd,0x23f9236421291b1f,0x9e89132d201122c6,0x23b021a81c6e9b1f,0x995c1d4921f723cd,0x22641e1f9879a0fd,0x156120a1234d23f3
.quad 0x20428000a042a335,0x1d49224123f32335,0x1a3e9e1fa2a7a400,0x2072236423d921a8,0x995ca1a8a3e3a335,0x21f723f323001ef1,0xa011a364a3bfa0fd,0x231c23e3217f172a
.quad 0xa241a400a2419b1f,0x23cd23351ef19b1f,0xa39fa3649f581b1f,0x23ff21f71879a042,0xa3fda1a8932d20fd,0x23b02042995ca241,0xa34d9e1f1db52335,0x22e41c6e9f58a38d
.quad 0xa1a8000021a82400,0x21a88000a1a8a400,0x9e891e1f23792335,0x20119c6ea31ca38d,0x932d21a823fd20fd,0x1c6ea042a3e3a241,0x1cdc2364231c1b1f,0xf2ea1f7a3eca042
.quad 0xa0fda335a400a335,0x233520fd1b1f9b1f,0xa1d0a3b0a3d9a241,0x231c20a118799d49,0xa286a3f3a364a0fd,0x23002042132d9ef1,0xa31ca3fda2a79ef1,0x22e41fbd8f2ea042
.quad 0xa38da3cda1a89b1f,0x22c61ef1972aa0fd,0xa3d9a364a0720000,0x22a71e1f9a3ea1a8,0xa3fda2c69e1f1b1f,0x22861d499c6ea241,0xa3f9a1f79a3e1ef1,0x22641c6e9db5a2c6
.quad 0xa3cda0fd000020fd,0x22411b1f9ef1a335,0xa3799fbd1a3e2241,0x221d195ca011a38d,0xa3009d491e1f2335,0x21f7172aa0a1a3cd,0xa264995c207223cd,0x21d0132da129a3f3
.quad 0xa1a8000021a82400,0x21a88000a1a8a400,0xa0cf195c22a723cd,0x217f932da21da3f3,0x9fbd1d4923642335,0x2155972aa286a3cd,0x9db51fbd23d92241,0x2129995ca2e4a38d
.quad 0xa3cda2419ef18000,0x80009ef1a241a3cd,0xa3eca2869f588000,0x1a3e9c6ea17fa38d,0xa3fda2c69fbd8000,0x1e1f972aa0a1a335,0xa3ffa300a0118000,0x2072132d9f58a2c6
.quad 0xa3f3a335a0428000,0x21a81b1f9d49a241,0xa3d9a364a0728000,0x22a71e1f9a3ea1a8,0xa3b0a38da0a18000,0x23642042932da0fd,0xa379a3b0a0cf8000,0x23d921551561a042
.quad 0xa335a3cda0fd8000,0x240022411b1f9ef1,0xa2e4a3e3a1298000,0x23d923001db59d49,0xa286a3f3a1558000,0x2364238d1fbd9b1f,0xa21da3fda17f8000,0x22a723e320cf972a
.quad 0xa1a8a400a1a88000,0x21a8240021a88000,0xa129a3fda1d08000,0x207223e32264172a,0xa0a1a3f3a1f78000,0x1e1f238d23001b1f,0xa011a3e3a21d8000,0x1a3e230023791d49
.quad 0x23cd23cd22411ef1,0x9ef180001ef12241,0x22e423fd234d20fd,0xa21d9e1f15612042,0x2155238d23e32241,0xa3b0a1a89c6e1b1f,0x1e89228623f92335,0xa3eca364a0cf972a
.quad 0x172a20fd238d23cd,0xa2c6a400a2c69ef1,0x9a3e1e1f22a72400,0xa072a364a3d9a1a8,0x9fbd172a215523cd,0x995ca1a8a3e3a335,0xa1d0995c1f582335,0x1bfe9e1fa2e4a3f3
.quad 0xa3359ef11b1f2241,0x20fd8000a0fda3cd,0xa3eca1558f2e20fd,0x231c1e1f9cdca2c6,0xa3e3a2c69c6e1ef1,0x23fd21a8132da0fd,0xa31ca3b0a0111b1f,0x237923641e899d49
.quad 0xa1a8a400a1a88000,0x21a8240021a88000,0x9f58a3b0a2e49b1f,0x1db52364234d1d49,0x995ca2c6a3b09ef1,0x932d21a823fd20fd,0x1879a155a3ffa0fd,0x9f581e1f239f22c6
.quad 0xa241a3cda3cda241,0x22411ef180009ef1,0x9db5a1f7a3bfa3cd,0x23ff23002072172a,0x195c9d49a1f7a3cd,0x228623f3236420fd,0x2129195c9db5a241,0x1cdc21f723d9238d
.quad 0x238d20fd172a9ef1,0x9d491b1f21a823cd,0x23d9236420728000,0xa2a79e1f1a3e21a8,0x21f723f323001ef1,0xa3fda2c69e1f1b1f,0x1cdc228623ff2241,0xa21da3fda2a79d49
.quad 0x9b1f1ef1233523cd,0x9b1fa241a400a241,0xa17f932d20cf23cd,0x1e899c6ea2a7a3f3,0xa3b0a042195c2241,0x23001d499e1fa335,0xa3bfa3009cdc1ef1,0x23ec22861a3ea042
.quad 0xa1a8a400a1a88000,0x21a8240021a88000,0x9bfea300a39f9ef1,0x1879228623d92042,0x1c6ea042a3e3a241,0x9fbd1d4923642335,0x21d0932da264a3cd,0xa34d9c6e207223f3
.quad 0x1ef1224123cd23cd,0xa3cda2419ef18000,0x9cdc195c20cf2335,0xa264a3e3a39fa1a8,0xa300a042932d1ef1,0x932da042a300a400,0xa3bfa3b0a17f9b1f,0x21d01c6e9bfea1a8
.quad 0xa042a335a3f3a241,0x23f3233520428000,0x1a3e9e1fa2a7a400,0x2072236423d921a8,0x22861d499c6ea241,0x9c6e1d4922862400,0x23ec23001e899b1f,0xa34d9fbd187921a8
.quad 0x20fd23cd23351ef1,0xa335a3cda0fd8000,0x956120a123bf2335,0x9bfea286a3f9a1a8,0xa1f7972a20a123cd,0x20a1972aa1f7a400,0xa3ffa1f7956120fd,0x23f921558f2ea1a8
.quad 0xa1a8a400a1a88000,0x21a8240021a88000,0x8f2ea1f7a3f9a0fd,0x9561215523ff21a8,0x2155972aa286a3cd,0xa286972a21552400,0x23f920a19bfea335,0xa3bfa286956121a8
.quad 0x80009ef1a241a3cd,0x23cd23cd22411ef1,0x22a71fbd0f2e9ef1,0x1bfe2155237923f3,0x236423f322861ef1,0xa1f79d49195c20fd,0x1a3e2155239f23cd,0xa379a3e3a21d9d49
.quad 0xa1a89b1f1d492241,0x972aa0fda38da3cd,0xa3d9a364a0728000,0x22a71e1f9a3ea1a8,0x9e1fa2c6a3fda241,0x230023f321f71b1f,0x2072932da129a3cd,0x8f2e20a1239f238d
.quad 0x240022411b1f9ef1,0xa3359ef11b1f2241,0x207223b0234d1ef1,0xa264a3fda1d0972a,0x9e1f1d49230023cd,0x195ca042a3b0a335,0xa3d9a0a118792241,0x239f1fbd9bfea2c6
.quad 0xa1a8a400a1a88000,0x21a8240021a88000,0x1a3ea0a1a3eca241,0x9cdc1fbd23bf22c6,0x23641d499fbda3cd,0xa3e3a0421c6e2335,0x22a723b01e899ef1,0xa0cfa3fda17f172a
.quad 0x9ef180001ef12241,0xa241a3cda3cda241,0xa3f9a364a1299b1f,0x1e89932da011a2c6,0x9c6ea1a8a3b0a3cd,0x23e3238d21551b1f,0x22641e1f9879a0fd,0x156120a1234d23f3
.quad 0x22c6240022c61ef1,0xa38da0fd972a1ef1,0x9a3e1e1f22a72400,0xa072a364a3d9a1a8,0xa3e3a1a8995c1ef1,0x2155172a9fbda335,0xa011a364a3bfa0fd,0x231c23e3217f172a
.quad 0x20fd8000a0fda3cd,0x9b1f1ef1233523cd,0x239f23641f589b1f,0xa3ffa1f798792042,0x132d21a823fd2241,0x9c6ea2c6a3e3a0fd,0xa34d9e1f1db52335,0x22e41c6e9f58a38d
.quad 0xa1a8a400a1a88000,0x21a8240021a88000,0x1e899e1fa379a335,0xa0111c6e231c238d,0x23fd21a8932da241,0xa3b0a2c6995c20fd,0x1cdc2364231c1b1f,0xf2ea1f7a3eca042
.quad 0x22411ef180009ef1,0x1ef1224123cd23cd,0x21d023b023d92241,0xa31ca0a198791d49,0xa0a1972a1e1f2241,0x9fbda2c6a3fda335,0xa31ca3fda2a79ef1,0x22e41fbd8f2ea042
.quad 0x1d499b1fa1a8a3cd,0x2042233523f32241,0x23d9236420728000,0xa2a79e1f1a3e21a8,0x932d2042236423cd,0xa0a1a38da3b0a0fd,0xa3f9a1f79a3e1ef1,0x22641c6e9db5a2c6
.quad 0x9b1fa241a400a241,0x20fd23cd23351ef1,0x23791fbd9a3ea241,0xa21d995c2011238d,0x1fbd238d23641ef1,0xa155a3f3a2869b1f,0xa264995c207223cd,0x21d0132da129a3f3
.quad 0xa1a8a400a1a88000,0x21a8240021a88000,0x20cf995ca2a7a3cd,0xa17f132d221d23f3,0x2300238d1e1f9ef1,0xa1f7a3f3a0a11b1f,0x9db51fbd23d92241,0x2129995ca2e4a38d
.quad 0xa3cda2419ef18000,0x80009ef1a241a3cd,0x9879a0a1a31ca400,0x23d923b021d01d49,0x23fd22c61fbd8000,0x9e1f172a20a12335,0x8f2e1fbd22e42400,0xa2a7a3fda31ca042
.quad 0xa3f3a335a0428000,0x21a81b1f9d49a241,0x1a3e9e1fa2a7a400,0x2072236423d921a8,0x23b0238d20a18000,0xa364a042132d20fd,0x9db51c6e22642400,0x9a3ea1f7a3f9a2c6
.quad 0xa335a3cda0fd8000,0x240022411b1f9ef1,0x2011995ca21da400,0x9a3e1fbd2379238d,0x228623f321558000,0xa364a38d9fbd1b1f,0xa129132d21d02400,0x2072995ca264a3f3
.quad 0xa1a8a400a1a88000,0x21a8240021a88000,0x221d132da17fa400,0xa2a7995c20cf23f3,0x20a123f321f78000,0x9e1fa38da3009b1f,0xa2e4995c21292400,0x23d91fbd9db5a38d
.quad 0x23cd23cd22411ef1,0x9ef180001ef12241,0xa011932d1e892241,0xa129a364a3f9a2c6,0xa155a38da3e3a241,0x23b021a81c6e9b1f,0x234d20a115619ef1,0x98791e1f226423f3
.quad 0x172a20fd238d23cd,0xa2c6a400a2c69ef1,0xa3d9a364a0728000,0x22a71e1f9a3ea1a8,0x1fbd972aa155a3cd,0x195c21a823e32335,0x217f23e3231c1ef1,0xa3bfa364a011172a
.quad 0xa3359ef11b1f2241,0x20fd8000a0fda3cd,0x9879a1f7a3ffa241,0x1f582364239f2042,0x23e322c61c6e9ef1,0xa3fda1a8932d20fd,0x9f581c6e22e423cd,0x1db59e1fa34da38d
.quad 0xa1a8a400a1a88000,0x21a8240021a88000,0x231c1c6ea011a3cd,0xa3799e1f1e89238d,0x195c22c623b01ef1,0x132da1a8a3fda0fd,0xa3eca1f70f2e2241,0x231c23641cdca042
.quad 0xa241a3cda3cda241,0x22411ef180009ef1,0x237921551bfe9b1f,0xf2e1fbd22a723f3,0x995c1d4921f723cd,0xa286a3f3a364a0fd,0xa21da3e3a379a0fd,0x239f21551a3e9d49
.quad 0x238d20fd172a9ef1,0x9d491b1f21a823cd,0x9a3e1e1f22a72400,0xa072a364a3d9a1a8,0xa1f7a3f3a3009ef1,0x23fd22c61e1f9b1f,0x239f20a18f2ea0fd,0xa129932d2072238d
.quad 0x9b1f1ef1233523cd,0x9b1fa241a400a241,0xa1d0a3fda2649b1f,0x234d23b02072972a,0x23b02042995ca241,0xa3009d491e1f2335,0x9bfe1fbd239f2335,0x1879a0a1a3d9a2c6
.quad 0xa1a8a400a1a88000,0x21a8240021a88000,0x23bf1fbd9cdca335,0xa3eca0a11a3e22c6,0x9c6e204223e32241,0x1fbd9d49a364a335,0xa17fa3fda0cf1b1f,0x1e8923b022a7172a
.quad 0x1ef1224123cd23cd,0xa3cda2419ef18000,0xa39fa3e3a2649ef1,0x20cf195c9cdca1a8,0x23002042132d9ef1,0x132d204223002400,0x9bfe1c6e21d023cd,0xa17fa3b0a3bfa1a8
.quad 0xa042a335a3f3a241,0x23f3233520428000,0x23d9236420728000,0xa2a79e1f1a3e21a8,0xa2869d491c6e2241,0x1c6e9d49a286a400,0x18799fbda34da3cd,0x1e89230023ec21a8
.quad 0x20fd23cd23351ef1,0xa335a3cda0fd8000,0xa3f9a2869bfe1ef1,0x23bf20a19561a1a8,0x21f7172aa0a1a3cd,0xa0a1172a21f72400,0x8f2e215523f92241,0x9561a1f7a3ffa1a8
.quad 0xa1a8a400a1a88000,0x21a8240021a88000,0x23ff21559561a241,0xa3f9a1f78f2e21a8,0xa155172a228623cd,0x2286172aa155a400,0x9561a286a3bf9ef1,0x9bfe20a123f921a8
.quad 0x80009ef1a241a3cd,0x23cd23cd22411ef1,0x2072230023ff2335,0xa3bfa1f79db5172a,0xa364a3f3a2869ef1,0x21f71d49995ca0fd,0x23d921f71cdc9b1f,0x9db5195c2129238d
.quad 0xa1a89b1f1d492241,0x972aa0fda38da3cd,0x1a3e9e1fa2a7a400,0x2072236423d921a8,0x1e1f22c623fd2241,0xa300a3f3a1f79b1f,0xa2a7a3fda21d9b1f,0x23ff22861cdc9d49
.quad 0x240022411b1f9ef1,0xa3359ef11b1f2241,0xa2a79c6e1e892335,0x20cf932da17fa3f3,0x1e1f9d49a300a3cd,0x995c204223b02335,0x1a3e228623ec20fd,0x9cdca300a3bfa042
.quad 0xa1a8a400a1a88000,0x21a8240021a88000,0x23d922861879a0fd,0xa39fa3009bfe2042,0xa3649d491fbd23cd,0x23e320429c6ea335,0x20729c6ea34da335,0xa264932d21d023f3
.quad 0x9ef180001ef12241,0xa241a3cda3cda241,0x15619e1fa21da3cd,0x234d23fd22e42042,0x1c6e21a823b023cd,0xa3e3a38da1559b1f,0xa0cfa364a3eca241,0x23f922861e89972a
.quad 0x22c6240022c61ef1,0xa38da0fd972a1ef1,0xa3d9a364a0728000,0x22a71e1f9a3ea1a8,0x23e321a8195c9ef1,0xa155972a1fbd2335,0xa2e49e1f1bfe2241,0x1f58995ca1d0a3f3
.quad 0x20fd8000a0fda3cd,0x9b1f1ef1233523cd,0x9cdc1e1f231c23cd,0x8f2ea155a3eca2c6,0x932da1a8a3fda241,0x1c6e22c623e320fd,0x1e89236423791ef1,0xa011a3b0a31c9d49
.quad 0xa1a8a400a1a88000,0x21a8240021a88000,0x234d23641db59ef1,0xa2e4a3b09f581d49,0xa3fda1a8132d2241,0x23b022c6195ca0fd,0x239f1e1f9f58a3cd,0xa3ffa155187922c6
.quad 0x22411ef180009ef1,0x1ef1224123cd23cd,0xa17f9c6e1a3e20fd,0x9f58a286a3eca38d,0x20a1172a9e1fa241,0x1fbd22c623fd2335,0x9f58132d20722335,0xa011a300a3ffa2c6
.quad 0x1d499b1fa1a8a3cd,0x2042233523f32241,0x9a3e1e1f22a72400,0xa072a364a3d9a1a8,0x132da042a364a3cd,0x20a1238d23b020fd,0x1561215523d92335,0xa0cfa3b0a379a042
.quad 0x9b1fa241a400a241,0x20fd23cd23351ef1,0x1db5230023d920fd,0xa129a3e3a2e49d49,0x9fbda38da3649ef1,0x215523f322861b1f,0x20cf23e322a71b1f,0xa17fa3fda21d972a
.quad 0xa1a8a400a1a88000,0x21a8240021a88000,0x226423e320729b1f,0xa1d0a3fda129172a,0xa300a38d9e1f1ef1,0x21f723f320a19b1f,0x237923001a3ea0fd,0xa21da3e3a0111d49
.quad 0xa3cda2419ef18000,0x80009ef1a241a3cd,0x23ec22861f588000,0x9a3e1c6e217f238d,0xa3fda2c69fbd8000,0x1e1f972aa0a1a335,0x23ff230020118000,0xa072932d1f5822c6
.quad 0xa3f3a335a0428000,0x21a81b1f9d49a241,0x23d9236420728000,0xa2a79e1f1a3e21a8,0xa3b0a38da0a18000,0x23642042932da0fd,0x237923b020cf8000,0xa3d9a15595612042
.quad 0xa335a3cda0fd8000,0x240022411b1f9ef1,0x22e423e321298000,0xa3d9a3009db51d49,0xa286a3f3a1558000,0x2364238d1fbd9b1f,0x221d23fd217f8000,0xa2a7a3e3a0cf172a
.quad 0xa1a8a400a1a88000,0x21a8240021a88000,0x212923fd21d08000,0xa072a3e3a264972a,0xa0a1a3f3a1f78000,0x1e1f238d23001b1f,0x201123e3221d8000,0x9a3ea300a3799d49
.quad 0x23cd23cd22411ef1,0x9ef180001ef12241,0xa2e4a3fda34da0fd,0x221d1e1f9561a042,0x2155238d23e32241,0xa3b0a1a89c6e1b1f,0x9e89a286a3f9a335,0x23ec236420cf172a
.quad 0x172a20fd238d23cd,0xa2c6a400a2c69ef1,0x1a3e9e1fa2a7a400,0x2072236423d921a8,0x9fbd172a215523cd,0x995ca1a8a3e3a335,0x21d0195c9f58a335,0x9bfe1e1f22e423f3
.quad 0xa3359ef11b1f2241,0x20fd8000a0fda3cd,0x23ec21550f2ea0fd,0xa31c9e1f1cdc22c6,0xa3e3a2c69c6e1ef1,0x23fd21a8132da0fd,0x231c23b020119b1f,0xa379a3649e891d49
.quad 0xa1a8a400a1a88000,0x21a8240021a88000,0x1f5823b022e41b1f,0x9db5a364a34d9d49,0x995ca2c6a3b09ef1,0x932d21a823fd20fd,0x9879215523ff20fd,0x1f589e1fa39fa2c6
.quad 0xa241a3cda3cda241,0x22411ef180009ef1,0x1db521f723bf23cd,0xa3ffa300a072972a,0x195c9d49a1f7a3cd,0x228623f3236420fd,0xa129995c1db52241,0x9cdca1f7a3d9a38d
.quad 0x238d20fd172a9ef1,0x9d491b1f21a823cd,0xa3d9a364a0728000,0x22a71e1f9a3ea1a8,0x21f723f323001ef1,0xa3fda2c69e1f1b1f,0x9cdca286a3ffa241,0x221d23fd22a71d49
.quad 0x9b1f1ef1233523cd,0x9b1fa241a400a241,0x217f132da0cfa3cd,0x9e891c6e22a723f3,0xa3b0a042195c2241,0x23001d499e1fa335,0x23bf23001cdc9ef1,0xa3eca2869a3e2042
.quad 0xa1a8a400a1a88000,0x21a8240021a88000,0x1bfe2300239f1ef1,0x9879a286a3d9a042,0x1c6ea042a3e3a241,0x9fbd1d4923642335,0xa1d0132d226423cd,0x234d1c6ea072a3f3
.quad 0x1ef1224123cd23cd,0xa3cda2419ef18000,0x1cdc995ca0cfa335,0x226423e3239f21a8,0xa300a042932d1ef1,0x932da042a300a400,0x23bf23b0217f1b1f,0xa1d09c6e1bfe21a8
.quad 0xa042a335a3f3a241,0x23f3233520428000,0x9a3e1e1f22a72400,0xa072a364a3d9a1a8,0x22861d499c6ea241,0x9c6e1d4922862400,0xa3eca3009e891b1f,0x234d1fbd9879a1a8
.quad 0x20fd23cd23351ef1,0xa335a3cda0fd8000,0x1561a0a1a3bfa335,0x1bfe228623f921a8,0xa1f7972a20a123cd,0x20a1972aa1f7a400,0x23ff21f71561a0fd,0xa3f9a1550f2e21a8
.quad 0xa1a8a400a1a88000,0x21a8240021a88000,0xf2e21f723f920fd,0x1561a155a3ffa1a8,0x2155972aa286a3cd,0xa286972a21552400,0xa3f9a0a11bfe2335,0x23bf22861561a1a8
.quad 0x80009ef1a241a3cd,0x23cd23cd22411ef1,0xa2a79fbd8f2e1ef1,0x9bfea155a379a3f3,0x236423f322861ef1,0xa1f79d49195c20fd,0x9a3ea155a39fa3cd,0x237923e3221d1d49
.quad 0xa1a89b1f1d492241,0x972aa0fda38da3cd,0x23d9236420728000,0xa2a79e1f1a3e21a8,0x9e1fa2c6a3fda241,0x230023f321f71b1f,0xa072132d212923cd,0xf2ea0a1a39fa38d
.quad 0x240022411b1f9ef1,0xa3359ef11b1f2241,0xa072a3b0a34d9ef1,0x226423fd21d0172a,0x9e1f1d49230023cd,0x195ca042a3b0a335,0x23d920a19879a241,0xa39f9fbd1bfe22c6
.quad 0xa1a8a400a1a88000,0x21a8240021a88000,0x9a3e20a123ec2241,0x1cdc9fbda3bfa2c6,0x23641d499fbda3cd,0xa3e3a0421c6e2335,0xa2a7a3b09e891ef1,0x20cf23fd217f972a
.quad 0x9ef180001ef12241,0xa241a3cda3cda241,0x23f9236421291b1f,0x9e89132d201122c6,0x9c6ea1a8a3b0a3cd,0x23e3238d21551b1f,0xa2649e1f187920fd,0x9561a0a1a34da3f3
.quad 0x22c6240022c61ef1,0xa38da0fd972a1ef1,0x1a3e9e1fa2a7a400,0x2072236423d921a8,0xa3e3a1a8995c1ef1,0x2155172a9fbda335,0x2011236423bf20fd,0xa31ca3e3a17f972a
.quad 0x20fd8000a0fda3cd,0x9b1f1ef1233523cd,0xa39fa3649f581b1f,0x23ff21f71879a042,0x132d21a823fd2241,0x9c6ea2c6a3e3a0fd,0x234d1e1f9db5a335,0xa2e49c6e1f58238d
.quad 0xa1a8a400a1a88000,0x21a8240021a88000,0x9e891e1f23792335,0x20119c6ea31ca38d,0x23fd21a8932da241,0xa3b0a2c6995c20fd,0x9cdca364a31c9b1f,0x8f2e21f723ec2042
.quad 0x22411ef180009ef1,0x1ef1224123cd23cd,0xa1d0a3b0a3d9a241,0x231c20a118799d49,0xa0a1972a1e1f2241,0x9fbda2c6a3fda335,0x231c23fd22a71ef1,0xa2e49fbd0f2e2042
.quad 0x1d499b1fa1a8a3cd,0x2042233523f32241,0xa3d9a364a0728000,0x22a71e1f9a3ea1a8,0x932d2042236423cd,0xa0a1a38da3b0a0fd,0x23f921f71a3e9ef1,0xa2649c6e1db522c6
.quad 0x9b1fa241a400a241,0x20fd23cd23351ef1,0xa3799fbd1a3e2241,0x221d195ca011a38d,0x1fbd238d23641ef1,0xa155a3f3a2869b1f,0x2264195ca072a3cd,0xa1d0932d212923f3
.quad 0xa1a8a400a1a88000,0x21a8240021a88000,0xa0cf195c22a723cd,0x217f932da21da3f3,0x2300238d1e1f9ef1,0xa1f7a3f3a0a11b1f,0x1db59fbda3d9a241,0xa129195c22e4238d
.quad 0xa3cda2419ef18000,0x80009ef1a241a3cd,0x187920a1231c2400,0xa3d9a3b0a1d09d49,0x23fd22c61fbd8000,0x9e1f172a20a12335,0xf2e9fbda2e4a400,0x22a723fd231c2042
.quad 0xa3f3a335a0428000,0x21a81b1f9d49a241,0x9a3e1e1f22a72400,0xa072a364a3d9a1a8,0x23b0238d20a18000,0xa364a042132d20fd,0x1db59c6ea264a400,0x1a3e21f723f922c6
.quad 0xa335a3cda0fd8000,0x240022411b1f9ef1,0xa011195c221d2400,0x1a3e9fbda379a38d,0x228623f321558000,0xa364a38d9fbd1b1f,0x2129932da1d0a400,0xa072195c226423f3
.quad 0xa1a8a400a1a88000,0x21a8240021a88000,0xa21d932d217f2400,0x22a7195ca0cfa3f3,0x20a123f321f78000,0x9e1fa38da3009b1f,0x22e4195ca129a400,0xa3d99fbd1db5238d
.quad 0x23cd23cd22411ef1,0x9ef180001ef12241,0x2011132d9e89a241,0x2129236423f922c6,0xa155a38da3e3a241,0x23b021a81c6e9b1f,0xa34da0a195611ef1,0x18799e1fa264a3f3
.quad 0x172a20fd238d23cd,0xa2c6a400a2c69ef1,0x23d9236420728000,0xa2a79e1f1a3e21a8,0x1fbd972aa155a3cd,0x195c21a823e32335,0xa17fa3e3a31c9ef1,0x23bf23642011972a
.quad 0xa3359ef11b1f2241,0x20fd8000a0fda3cd,0x187921f723ff2241,0x9f58a364a39fa042,0x23e322c61c6e9ef1,0xa3fda1a8932d20fd,0x1f589c6ea2e4a3cd,0x9db51e1f234d238d
.quad 0xa1a8a400a1a88000,0x21a8240021a88000,0xa31c9c6e201123cd,0x23791e1f9e89a38d,0x195c22c623b01ef1,0x132da1a8a3fda0fd,0x23ec21f78f2ea241,0xa31ca3649cdc2042
.quad 0xa241a3cda3cda241,0x22411ef180009ef1,0xa379a1559bfe1b1f,0x8f2e9fbda2a7a3f3,0x995c1d4921f723cd,0xa286a3f3a364a0fd,0x221d23e3237920fd,0xa39fa1559a3e1d49
.quad 0x238d20fd172a9ef1,0x9d491b1f21a823cd,0x1a3e9e1fa2a7a400,0x2072236423d921a8,0xa1f7a3f3a3009ef1,0x23fd22c61e1f9b1f,0xa39fa0a10f2e20fd,0x2129132da072a38d
.quad 0x9b1f1ef1233523cd,0x9b1fa241a400a241,0x21d023fd22641b1f,0xa34da3b0a072172a,0x23b02042995ca241,0xa3009d491e1f2335,0x1bfe9fbda39fa335,0x987920a123d922c6
.quad 0xa1a8a400a1a88000,0x21a8240021a88000,0xa3bf9fbd1cdc2335,0x23ec20a19a3ea2c6,0x9c6e204223e32241,0x1fbd9d49a364a335,0x217f23fd20cf9b1f,0x9e89a3b0a2a7972a
.quad 0x1ef1224123cd23cd,0xa3cda2419ef18000,0x239f23e322641ef1,0xa0cf995c1cdc21a8,0x23002042132d9ef1,0x132d204223002400,0x1bfe9c6ea1d0a3cd,0x217f23b023bf21a8
.quad 0xa042a335a3f3a241,0x23f3233520428000,0xa3d9a364a0728000,0x22a71e1f9a3ea1a8,0xa2869d491c6e2241,0x1c6e9d49a286a400,0x98791fbd234d23cd,0x9e89a300a3eca1a8
.quad 0x20fd23cd23351ef1,0xa335a3cda0fd8000,0x23f922861bfe9ef1,0xa3bfa0a1156121a8,0x21f7172aa0a1a3cd,0xa0a1172a21f72400,0xf2ea155a3f9a241,0x156121f723ff21a8
.quad 0xa1a8a400a1a88000,0x21a8240021a88000,0xa3ffa15515612241,0x23f921f70f2ea1a8,0xa155172a228623cd,0x2286172aa155a400,0x1561228623bf1ef1,0x1bfea0a1a3f9a1a8
.quad 0x80009ef1a241a3cd,0x23cd23cd22411ef1,0xa072a300a3ffa335,0x23bf21f71db5972a,0xa364a3f3a2869ef1,0x21f71d49995ca0fd,0xa3d9a1f79cdc1b1f,0x1db5995ca129a38d
.quad 0xa1a89b1f1d492241,0x972aa0fda38da3cd,0x9a3e1e1f22a72400,0xa072a364a3d9a1a8,0x1e1f22c623fd2241,0xa300a3f3a1f79b1f,0x22a723fd221d1b1f,0xa3ffa2869cdc1d49
.quad 0x240022411b1f9ef1,0xa3359ef11b1f2241,0x22a71c6e9e89a335,0xa0cf132d217f23f3,0x1e1f9d49a300a3cd,0x995c204223b02335,0x9a3ea286a3eca0fd,0x1cdc230023bf2042
.quad 0xa1a8a400a1a88000,0x21a8240021a88000,0xa3d9a286987920fd,0x239f23001bfea042,0xa3649d491fbd23cd,0x23e320429c6ea335,0xa0721c6e234d2335,0x2264132da1d0a3f3
.quad 0x9ef180001ef12241,0xa241a3cda3cda241,0x95611e1f221d23cd,0xa34da3fda2e4a042,0x1c6e21a823b023cd,0xa3e3a38da1559b1f,0x20cf236423ec2241,0xa3f9a2869e89172a
.quad 0x22c6240022c61ef1,0xa38da0fd972a1ef1,0x23d9236420728000,0xa2a79e1f1a3e21a8,0x23e321a8195c9ef1,0xa155972a1fbd2335,0x22e41e1f9bfea241,0x9f58195c21d023f3
.quad 0x20fd8000a0fda3cd,0x9b1f1ef1233523cd,0x1cdc9e1fa31ca3cd,0xf2e215523ec22c6,0x932da1a8a3fda241,0x1c6e22c623e320fd,0x9e89a364a3799ef1,0x201123b0231c1d49
.quad 0xa1a8a400a1a88000,0x21a8240021a88000,0xa34da3649db51ef1,0x22e423b01f589d49,0xa3fda1a8132d2241,0x23b022c6195ca0fd,0xa39f9e1f1f5823cd,0x23ff21559879a2c6
.quad 0x22411ef180009ef1,0x1ef1224123cd23cd,0x217f1c6e9a3ea0fd,0x1f58228623ec238d,0x20a1172a9e1fa241,0x1fbd22c623fd2335,0x1f58932da072a335,0x2011230023ff22c6
.quad 0x1d499b1fa1a8a3cd,0x2042233523f32241,0x1a3e9e1fa2a7a400,0x2072236423d921a8,0x132da042a364a3cd,0x20a1238d23b020fd,0x9561a155a3d9a335,0x20cf23b023792042
.quad 0x9b1fa241a400a241,0x20fd23cd23351ef1,0x9db5a300a3d9a0fd,0x212923e322e41d49,0x9fbda38da3649ef1,0x215523f322861b1f,0xa0cfa3e3a2a79b1f,0x217f23fd221d172a
.quad 0xa1a8a400a1a88000,0x21a8240021a88000,0xa264a3e3a0721b1f,0x21d023fd2129972a,0xa300a38d9e1f1ef1,0x21f723f320a19b1f,0xa379a3009a3e20fd,0x221d23e320119d49
.quad 0xa3359b1f20fd2400,0x240020fd9b1fa335,0xa3799c6e20cf2400,0x23d921f79561a2c6,0xa3b09d4920a12400,0x236422c6132da241,0xa3d99e1f20722400,0x22a723641a3ea1a8
.quad 0xa3f39ef120422400,0x21a823cd1d49a0fd,0xa3ff9fbd20112400,0x207223fd1f58a042,0xa3fda0421fbd2400,0x1e1f23f320a19ef1,0xa3eca0a11f582400,0x1a3e23b0217f9d49
.quad 0xa3cda0fd1ef12400,0x233522419b1f,0xa39fa1551e892400,0x9a3e228622e4972a,0xa364a1a81e1f2400,0x9e1f21a823648000,0xa31ca1f71db52400,0xa07220a123bf172a
.quad 0xa2c6a2411d492400,0xa1a81ef123f31b1f,0xa264a2861cdc2400,0xa2a71c6e23ff1d49,0xa1f7a2c61c6e2400,0xa364172a23e31ef1,0xa17fa3001bfe2400,0xa3d9932d239f2042
.quad 0xa335a3359b1f20fd,0x20fd240020fd9b1f,0xa1d0a3e39f581ef1,0x1bfe236422e4172a,0x9fbda3f3a1551b1f,0x995c21a823e31ef1,0x9a3ea364a2a70000,0xa0721e1f23d921a8
.quad 0x172aa241a38d9b1f,0xa2c6000022c62335,0x1e89a0a1a3f99ef1,0xa3ec9e1f20cf23f3,0x21559d49a3e3a0fd,0xa3b0a1a81c6e23cd,0x22e4932da34da241,0xa21da364956122c6
.quad 0x23cd1b1fa241a335,0x9ef1a4009ef120fd,0x23f91fbda0cfa3cd,0x8f2ea364a1d01d49,0x236421a89e1fa400,0x1e1fa1a8a3640000,0x221d23009879a3cd,0x21d09e1fa3ff9d49
.quad 0x204223cd172aa335,0x238d8000a38da0fd,0x1bfe23fd1db5a241,0x23f91e1fa21da2c6,0x932d238d20a1a0fd,0x230021a89fbda3cd,0x9db52286221d9ef1,0x20cf23649879a3f3
.quad 0x9b1fa335a3359b1f,0x9b1f20fd240020fd,0x1cdca0a1a3ffa0fd,0xa21d132d22a7238d,0x21f7972aa300a335,0xa3fda0421e1f23cd,0x23d91e1fa072a400,0xa2a7a3649a3e21a8
.quad 0x238d2241972aa335,0x9d49a3cda1a81b1f,0x212923e31db5a0fd,0x1cdca155a3d99d49,0x195c238d21f79b1f,0x2286972aa364a241,0x9db5215523bf1b1f,0x23ff1fbda072a3f3
.quad 0xa2411b1f23cd20fd,0x224123358000a335,0xa3ec9c6e221d2335,0x1bfe23e32072a042,0xa364a1a81e1f2400,0x9e1f21a823648000,0xa0cfa3b095612335,0xa2e4195c23d92042
.quad 0x972aa3cda04220fd,0xa3f39ef121a82335,0x1e89a1f7a2e41b1f,0xa1d0a3001a3e23f3,0x22869d49a3fd9b1f,0x995ca3f39e1f2241,0x23f9195ca34da0fd,0x1f58a1f7a2a71d49
.quad 0x20fd9b1fa335a335,0xa3359b1f20fd2400,0x23ec1fbd9e89a3cd,0xa34da300987921a8,0x2286238d1c6ea0fd,0x9c6ea38da2860000,0x1a3e236422a78000,0x20729e1fa3d9a1a8
.quad 0xa0421ef123f320fd,0x23f31ef1a042a400,0xa3bf9c6e217f23cd,0x21d023b01bfea1a8,0xa300a2c6132d2335,0x932d22c623008000,0x9cdca3e3a0cf1ef1,0xa264195c239f21a8
.quad 0x1ef1a0fda3cd9b1f,0xa3cda0fd1ef12400,0x2379132da31ca241,0x9f58a3fd9db521a8,0x236421a89e1fa400,0x1e1fa1a8a3640000,0x1e8923fd1cdca241,0x239f132da34da1a8
.quad 0x9d49224122c69b1f,0x22c622419d49a400,0xa31c195c23ec1ef1,0x187923e31f58a1a8,0xa3b0a04221552335,0xa155204223b08000,0xa011a3b00f2e23cd,0xa3ff9c6e22e421a8
.quad 0x240020fd9b1fa335,0xa335a3359b1f20fd,0x207223fd21299b1f,0x8f2ea286a39f9d49,0x9e1f204223fd20fd,0x2300172aa1f7a3cd,0xa3d99e1f20722400,0x22a723641a3ea1a8
.quad 0xa1a8a3cd9d4920fd,0x972a2241238d1b1f,0x1a3ea1f7a39f9b1f,0xa379995c221d238d,0x2364172aa286a335,0xa1f7a38d995c2241,0x22a723008f2ea335,0x1bfea1f7a379972a
.quad 0x233522419b1f,0x23cd1b1fa241a335,0xa2a7195c23bf20fd,0x212923b01879a2c6,0xa364a1a81e1f2400,0x9e1f21a823648000,0x9a3ea3e3a01120fd,0xa3f99c6e226422c6
.quad 0x21a89ef1a3f39b1f,0xa042a3cd972a2335,0x23d91fbda17fa335,0x2011a155a34d172a,0x1e1f23f3195ca335,0x23fd1d49a286a241,0xa0722155231c9b1f,0x1e8923e31561a38d
.quad 0x20fd240020fd9b1f,0x9b1fa335a3359b1f,0xa0111e1f23bf2241,0x231c195ca17fa3f3,0xa3e3a1a8195c2335,0x215523f31fbd9ef1,0x9a3ea364a2a70000,0xa0721e1f23d921a8
.quad 0x22c68000a2c6a335,0xa38da241172a2335,0x226423641879a241,0x1561a286a34d972a,0x9c6e21a823b01b1f,0x23e31d49a155a3cd,0xa3f99e1f212923cd,0x1e8923fd2011a042
.quad 0x9ef1a4009ef120fd,0xa2411b1f23cd20fd,0x217f9e1fa3ff9ef1,0xa264a3001561238d,0x236421a89e1fa400,0x1e1fa1a8a3640000,0x8f2e2364217f9ef1,0x23ec1fbda129a38d
.quad 0xa38d0000238d20fd,0x172a23cd2042a0fd,0xa129a364156123cd,0xa379132d23bf2042,0x1fbda1a8a3001b1f,0xa0a1a38d132d23cd,0x23ec1e1fa264a241,0x2129a0a1a379172a
.quad 0x9b1f20fd240020fd,0x20fd9b1fa335a335,0xa3f9a1551a3e2335,0x226423b01db5a042,0x932da2c6a3649b1f,0xa0a11d4923b02241,0x23d91e1fa072a400,0xa2a7a3649a3e21a8
.quad 0x1d4923cd21a89b1f,0x20429ef1a3f3a0fd,0xa31c932d22a72335,0x22e423000f2ea2c6,0xa0a1a3f39e1f20fd,0x9fbd204223fd1ef1,0x21d09c6ea3d9a0fd,0xa31ca2861879238d
.quad 0x224123358000a335,0x1ef1a0fda3cd9b1f,0xa01120a123d91b1f,0x234d21f79cdca3f3,0xa364a1a81e1f2400,0x9e1f21a823648000,0x1bfea286a2a71b1f,0xa379a1551f5823f3
.quad 0x23f31ef1a1a8a335,0x1d49a241a2c61b1f,0xf2e23b02072a0fd,0x239f20a1a0cfa38d,0xa3e3972a236420fd,0x9c6e22c621f79ef1,0x9cdca3fd9a3e2335,0xa3bf9fbd21d022c6
.quad 0xa3359b1f20fd2400,0x240020fd9b1fa335,0x9db5a3b0a2640000,0x9a3e215523f92042,0x23b01d49a0a1a400,0xa364a2c6932d2241,0x1a3e236422a78000,0x20729e1fa3d9a1a8
.quad 0xa3f39ef120422400,0x21a823cd1d49a0fd,0x8f2ea300a2e40000,0xa2a7132d231c22c6,0x23fd20429fbda400,0x9e1fa3f3a0a11ef1,0x98792286231c8000,0x23d91c6ea1d0a38d
.quad 0xa3cda0fd1ef12400,0x233522419b1f,0x1cdca1f7a34d0000,0xa3d9a0a1201123f3,0x236421a89e1fa400,0x1e1fa1a8a3640000,0x9f58215523798000,0x22a722869bfea3f3
.quad 0xa2c6a2411d492400,0xa1a81ef123f31b1f,0x20cfa0a1a39f0000,0xa072a3b08f2e238d,0x21f722c69c6ea400,0x2364972aa3e39ef1,0xa1d01fbd23bf8000,0x1a3e23fd1cdca2c6
.quad 0xa335a3359b1f20fd,0x20fd240020fd9b1f,0x217f995ca31ca335,0xa3bf9e1f201123f3,0x1fbd23f321559b1f,0x195ca1a8a3e39ef1,0xa3d99e1f20722400,0x22a723641a3ea1a8
.quad 0x172aa241a38d9b1f,0xa2c6000022c62335,0x234d22869561a335,0x9879a364a264172a,0xa1551d4923e320fd,0x23b021a89c6ea3cd,0xa011a3fd9e8920fd,0xa1291e1f23f92042
.quad 0x23cd1b1fa241a335,0x9ef1a4009ef120fd,0x9561230022649b1f,0x23ff1e1fa17fa38d,0xa364a1a81e1f2400,0x9e1f21a823648000,0x21299fbda3ec9b1f,0xa17fa3640f2e238d
.quad 0x204223cd172aa335,0x238d8000a38da0fd,0xa3bf932d237920fd,0x956123642129a042,0x132da38da0a120fd,0xa300a1a81fbd23cd,0x237920a1a129a335,0x22649e1fa3ec972a
.quad 0x9b1fa335a3359b1f,0x9b1f20fd240020fd,0x239f22860f2ea241,0xa129a3fda0721d49,0xa1f7172a23002335,0x23fd20429e1fa3cd,0x9a3ea364a2a70000,0xa0721e1f23d921a8
.quad 0x238d2241972aa335,0x9d49a3cda1a81b1f,0xa21d195c23792241,0x239f21f79a3ea38d,0x995ca38da1f71b1f,0xa286172a23642241,0x237921f79bfea3cd,0xf2ea300a2a7172a
.quad 0xa2411b1f23cd20fd,0x224123358000a335,0x9879a3b0a1291ef1,0xa3bf995c22a722c6,0x236421a89e1fa400,0x1e1fa1a8a3640000,0xa2641c6e23f91ef1,0x201123e31a3ea2c6
.quad 0x972aa3cda04220fd,0xa3f39ef121a82335,0x234d2155a011a3cd,0x217f9fbda3d9972a,0xa2861d4923fd1b1f,0x195c23f31e1fa241,0x9561a3e39e892241,0xa31ca1552072238d
.quad 0x20fd9b1fa335a335,0xa3359b1f20fd2400,0x18792300234d1b1f,0x1e899fbda3eca1a8,0xa286a38d9c6e20fd,0x1c6e238d22868000,0x23d91e1fa072a400,0xa2a7a3649a3e21a8
.quad 0xa0421ef123f320fd,0x23f31ef1a042a400,0x9bfea3b0a1d01b1f,0xa17f1c6e23bf21a8,0x230022c6932da335,0x132da2c6a3000000,0xa39f995c22642335,0x20cf23e31cdca1a8
.quad 0x1ef1a0fda3cd9b1f,0xa3cda0fd1ef12400,0x1db523fd1f58a0fd,0x231c932da379a1a8,0xa364a1a81e1f2400,0x9e1f21a823648000,0x234d932da39fa0fd,0x9cdca3fd9e8921a8
.quad 0x9d49224122c69b1f,0x22c622419d49a400,0x9f58a3e398792335,0xa3ec995c231c21a8,0x23b02042a155a335,0x2155a042a3b00000,0xa2e41c6e23ff1b1f,0x8f2e23b02011a1a8
.quad 0x240020fd9b1fa335,0xa335a3359b1f20fd,0xa2a7932d221d23cd,0x23ff20a19cdca38d,0x1e1fa042a3fda0fd,0xa300972a21f723cd,0x1a3e236422a78000,0x20729e1fa3d9a1a8
.quad 0xa1a8a3cd9d4920fd,0x972a2241238d1b1f,0x23d921559cdca3cd,0x9db5a3e3a1291d49,0xa364972a22862335,0x21f7238d195ca241,0x20729fbda3ff9ef1,0xa3bfa1551db523f3
.quad 0x233522419b1f,0x23cd1b1fa241a335,0xa072a3e39bfe2241,0xa21d1c6e23ec2042,0x236421a89e1fa400,0x1e1fa1a8a3640000,0xa3d9995c22e42241,0x156123b020cfa042
.quad 0x21a89ef1a3f39b1f,0xa042a3cd972a2335,0x9a3e230021d09ef1,0x22e421f79e89a3f3,0x9e1fa3f3995c2335,0xa3fd9d4922862241,0x22a721f79f58a3cd,0x234d995ca3f99d49
.quad 0x20fd240020fd9b1f,0x9b1fa335a3359b1f,0xa2e4a3649bfe20fd,0x1f5823e321d0972a,0x23e321a8995ca335,0xa155a3f39fbd1ef1,0xa3d99e1f20722400,0x22a723641a3ea1a8
.quad 0x22c68000a2c6a335,0xa38da241172a2335,0xa0cf1e1f23ec20fd,0x23f920a19e89a3f3,0x1c6ea1a8a3b09b1f,0xa3e39d49215523cd,0x15612364221d9b1f,0x234d132da2e4a2c6
.quad 0x9ef1a4009ef120fd,0xa2411b1f23cd20fd,0x21d023640f2ea335,0x20cf9fbda3f99d49,0xa364a1a81e1f2400,0x9e1f21a823648000,0x23ff1e1fa1d0a335,0x1879a300a21d1d49
.quad 0xa38d0000238d20fd,0x172a23cd2042a0fd,0x221d9e1fa3f99b1f,0x9db5a3fd9bfe22c6,0x9fbd21a823009b1f,0x20a1238d932da3cd,0x1879a364a0cf20fd,0xa21da2861db523f3
.quad 0x9b1f20fd240020fd,0x20fd9b1fa335a335,0x1561a1f7a3d99ef1,0xa0cf1c6e237922c6,0x132d22c623641b1f,0x20a19d49a3b0a241,0x9a3ea364a2a70000,0xa0721e1f23d921a8
.quad 0x1d4923cd21a89b1f,0x20429ef1a3f3a0fd,0x9f58a3fda0721ef1,0xa0111fbd23ff2042,0x20a123f31e1fa0fd,0x1fbda042a3fd9ef1,0xa17fa3b09a3e2241,0x9f5820a123ec1d49
.quad 0x224123358000a335,0x1ef1a0fda3cd9b1f,0xa2e4a2861a3e23cd,0x9e892155239f172a,0x236421a89e1fa400,0x1e1fa1a8a3640000,0xa3bfa0a1207223cd,0x9db521f7231c972a
.quad 0x23f31ef1a1a8a335,0x1d49a241a2c61b1f,0xa3ff9c6e22a72241,0x9cdc228622649d49,0x23e3172aa364a0fd,0x1c6ea2c6a1f71ef1,0xa39f132d23d91ef1,0x9bfe2300217fa042
.quad 0xa3359b1f20fd2400,0x240020fd9b1fa335,0x23791c6ea0cfa400,0xa3d9a1f7156122c6,0xa3b09d4920a12400,0x236422c6132da241,0x23d91e1fa072a400,0xa2a7a3649a3e21a8
.quad 0xa3f39ef120422400,0x21a823cd1d49a0fd,0x23ff1fbda011a400,0xa072a3fd9f582042,0xa3fda0421fbd2400,0x1e1f23f320a19ef1,0x23ec20a19f58a400,0x9a3ea3b0a17f1d49
.quad 0xa3cda0fd1ef12400,0x233522419b1f,0x239f21559e89a400,0x1a3ea286a2e4172a,0xa364a1a81e1f2400,0x9e1f21a823648000,0x231c21f79db5a400,0x2072a0a1a3bf972a
.quad 0xa2c6a2411d492400,0xa1a81ef123f31b1f,0x226422869cdca400,0x22a79c6ea3ff9d49,0xa1f7a2c61c6e2400,0xa364172a23e31ef1,0x217f23009bfea400,0x23d9132da39fa042
.quad 0xa335a3359b1f20fd,0x20fd240020fd9b1f,0x21d023e31f589ef1,0x9bfea364a2e4972a,0x9fbda3f3a1551b1f,0x995c21a823e31ef1,0x1a3e236422a78000,0x20729e1fa3d9a1a8
.quad 0x172aa241a38d9b1f,0xa2c6000022c62335,0x9e8920a123f91ef1,0x23ec1e1fa0cfa3f3,0x21559d49a3e3a0fd,0xa3b0a1a81c6e23cd,0xa2e4132d234d2241,0x221d23641561a2c6
.quad 0x23cd1b1fa241a335,0x9ef1a4009ef120fd,0xa3f99fbd20cf23cd,0xf2e236421d09d49,0x236421a89e1fa400,0x1e1fa1a8a3640000,0xa21da300187923cd,0xa1d01e1f23ff1d49
.quad 0x204223cd172aa335,0x238d8000a38da0fd,0x9bfea3fd9db52241,0xa3f99e1f221d22c6,0x932d238d20a1a0fd,0x230021a89fbda3cd,0x1db5a286a21d1ef1,0xa0cfa364187923f3
.quad 0x9b1fa335a3359b1f,0x9b1f20fd240020fd,0x9cdc20a123ff20fd,0x221d932da2a7a38d,0x21f7972aa300a335,0xa3fda0421e1f23cd,0xa3d99e1f20722400,0x22a723641a3ea1a8
.quad 0x238d2241972aa335,0x9d49a3cda1a81b1f,0xa129a3e39db520fd,0x9cdc215523d91d49,0x195c238d21f79b1f,0x2286972aa364a241,0x1db5a155a3bf9b1f,0xa3ff9fbd207223f3
.quad 0xa2411b1f23cd20fd,0x224123358000a335,0x23ec1c6ea21da335,0x9bfea3e3a0722042,0xa364a1a81e1f2400,0x9e1f21a823648000,0x20cf23b01561a335,0x22e4995ca3d9a042
.quad 0x972aa3cda04220fd,0xa3f39ef121a82335,0x9e8921f722e49b1f,0x21d023009a3ea3f3,0x22869d49a3fd9b1f,0x995ca3f39e1f2241,0xa3f9995c234d20fd,0x9f5821f722a79d49
.quad 0x20fd9b1fa335a335,0xa3359b1f20fd2400,0xa3ec9fbd1e8923cd,0x234d23001879a1a8,0x2286238d1c6ea0fd,0x9c6ea38da2860000,0x9a3ea364a2a70000,0xa0721e1f23d921a8
.quad 0xa0421ef123f320fd,0x23f31ef1a042a400,0x23bf1c6ea17fa3cd,0xa1d0a3b09bfe21a8,0xa300a2c6132d2335,0x932d22c623008000,0x1cdc23e320cf9ef1,0x2264995ca39fa1a8
.quad 0x1ef1a0fda3cd9b1f,0xa3cda0fd1ef12400,0xa379932d231c2241,0x1f5823fd1db5a1a8,0x236421a89e1fa400,0x1e1fa1a8a3640000,0x9e89a3fd9cdc2241,0xa39f932d234d21a8
.quad 0x9d49224122c69b1f,0x22c622419d49a400,0x231c995ca3ec9ef1,0x9879a3e39f5821a8,0xa3b0a04221552335,0xa155204223b08000,0x201123b08f2ea3cd,0x23ff1c6ea2e4a1a8
.quad 0x240020fd9b1fa335,0xa335a3359b1f20fd,0xa072a3fda1291b1f,0xf2e2286239f1d49,0x9e1f204223fd20fd,0x2300172aa1f7a3cd,0x23d91e1fa072a400,0xa2a7a3649a3e21a8
.quad 0xa1a8a3cd9d4920fd,0x972a2241238d1b1f,0x9a3e21f7239f1b1f,0x2379195ca21da38d,0x2364172aa286a335,0xa1f7a38d995c2241,0xa2a7a3000f2e2335,0x9bfe21f72379172a
.quad 0x233522419b1f,0x23cd1b1fa241a335,0x22a7995ca3bfa0fd,0xa129a3b0987922c6,0xa364a1a81e1f2400,0x9e1f21a823648000,0x1a3e23e32011a0fd,0x23f91c6ea264a2c6
.quad 0x21a89ef1a3f39b1f,0xa042a3cd972a2335,0xa3d99fbd217f2335,0xa0112155234d972a,0x1e1f23f3195ca335,0x23fd1d49a286a241,0x2072a155a31c1b1f,0x9e89a3e39561238d
.quad 0x20fd240020fd9b1f,0x9b1fa335a3359b1f,0x20119e1fa3bfa241,0xa31c995c217f23f3,0xa3e3a1a8195c2335,0x215523f31fbd9ef1,0x1a3e236422a78000,0x20729e1fa3d9a1a8
.quad 0x22c68000a2c6a335,0xa38da241172a2335,0xa264a36498792241,0x95612286234d172a,0x9c6e21a823b01b1f,0x23e31d49a155a3cd,0x23f91e1fa129a3cd,0x9e89a3fda0112042
.quad 0x9ef1a4009ef120fd,0xa2411b1f23cd20fd,0xa17f1e1f23ff1ef1,0x226423009561a38d,0x236421a89e1fa400,0x1e1fa1a8a3640000,0xf2ea364a17f1ef1,0xa3ec9fbd2129238d
.quad 0xa38d0000238d20fd,0x172a23cd2042a0fd,0x212923649561a3cd,0x2379932da3bfa042,0x1fbda1a8a3001b1f,0xa0a1a38d132d23cd,0xa3ec9e1f22642241,0xa12920a12379972a
.quad 0x9b1f20fd240020fd,0x20fd9b1fa335a335,0x23f921559a3ea335,0xa264a3b09db52042,0x932da2c6a3649b1f,0xa0a11d4923b02241,0xa3d99e1f20722400,0x22a723641a3ea1a8
.quad 0x1d4923cd21a89b1f,0x20429ef1a3f3a0fd,0x231c132da2a7a335,0xa2e4a3008f2e22c6,0xa0a1a3f39e1f20fd,0x9fbd204223fd1ef1,0xa1d01c6e23d920fd,0x231c22869879a38d
.quad 0x224123358000a335,0x1ef1a0fda3cd9b1f,0x2011a0a1a3d99b1f,0xa34da1f71cdc23f3,0xa364a1a81e1f2400,0x9e1f21a823648000,0x9bfe228622a79b1f,0x237921559f58a3f3
.quad 0x23f31ef1a1a8a335,0x1d49a241a2c61b1f,0x8f2ea3b0a07220fd,0xa39fa0a120cf238d,0xa3e3972a236420fd,0x9c6e22c621f79ef1,0x1cdc23fd1a3ea335,0x23bf1fbda1d0a2c6
.quad 0xa3359b1f20fd2400,0x240020fd9b1fa335,0x1db523b022648000,0x1a3ea155a3f9a042,0x23b01d49a0a1a400,0xa364a2c6932d2241,0x9a3ea364a2a70000,0xa0721e1f23d921a8
.quad 0xa3f39ef120422400,0x21a823cd1d49a0fd,0xf2e230022e48000,0x22a7932da31ca2c6,0x23fd20429fbda400,0x9e1fa3f3a0a11ef1,0x1879a286a31c0000,0xa3d99c6e21d0238d
.quad 0xa3cda0fd1ef12400,0x233522419b1f,0x9cdc21f7234d8000,0x23d920a1a011a3f3,0x236421a89e1fa400,0x1e1fa1a8a3640000,0x1f58a155a3790000,0xa2a7a2861bfe23f3
.quad 0xa2c6a2411d492400,0xa1a81ef123f31b1f,0xa0cf20a1239f8000,0x207223b00f2ea38d,0x21f722c69c6ea400,0x2364972aa3e39ef1,0x21d09fbda3bf0000,0x9a3ea3fd9cdc22c6
.quad 0xa335a3359b1f20fd,0x20fd240020fd9b1f,0xa17f195c231c2335,0x23bf1e1fa011a3f3,0x1fbd23f321559b1f,0x195ca1a8a3e39ef1,0x23d91e1fa072a400,0xa2a7a3649a3e21a8
.quad 0x172aa241a38d9b1f,0xa2c6000022c62335,0xa34da28615612335,0x187923642264972a,0xa1551d4923e320fd,0x23b021a89c6ea3cd,0x201123fd1e89a0fd,0x21299e1fa3f9a042
.quad 0x23cd1b1fa241a335,0x9ef1a4009ef120fd,0x1561a300a2641b1f,0xa3ff9e1f217f238d,0xa364a1a81e1f2400,0x9e1f21a823648000,0xa1291fbd23ec1b1f,0x217f23648f2ea38d
.quad 0x204223cd172aa335,0x238d8000a38da0fd,0x23bf132da379a0fd,0x1561a364a1292042,0x132da38da0a120fd,0xa300a1a81fbd23cd,0xa379a0a121292335,0xa2641e1f23ec172a
.quad 0x9b1fa335a3359b1f,0x9b1f20fd240020fd,0xa39fa2868f2e2241,0x212923fd20729d49,0xa1f7172a23002335,0x23fd20429e1fa3cd,0x1a3e236422a78000,0x20729e1fa3d9a1a8
.quad 0x238d2241972aa335,0x9d49a3cda1a81b1f,0x221d995ca379a241,0xa39fa1f71a3e238d,0x995ca38da1f71b1f,0xa286172a23642241,0xa379a1f71bfe23cd,0x8f2e230022a7972a
.quad 0xa2411b1f23cd20fd,0x224123358000a335,0x187923b021299ef1,0x23bf195ca2a7a2c6,0x236421a89e1fa400,0x1e1fa1a8a3640000,0x22649c6ea3f99ef1,0xa011a3e39a3e22c6
.quad 0x972aa3cda04220fd,0xa3f39ef121a82335,0xa34da155201123cd,0xa17f1fbd23d9172a,0xa2861d4923fd1b1f,0x195c23f31e1fa241,0x156123e31e89a241,0x231c2155a072a38d
.quad 0x20fd9b1fa335a335,0xa3359b1f20fd2400,0x9879a300a34d9b1f,0x9e891fbd23ec21a8,0xa286a38d9c6e20fd,0x1c6e238d22868000,0xa3d99e1f20722400,0x22a723641a3ea1a8
.quad 0xa0421ef123f320fd,0x23f31ef1a042a400,0x1bfe23b021d09b1f,0x217f9c6ea3bfa1a8,0x230022c6932da335,0x132da2c6a3000000,0x239f195ca264a335,0xa0cfa3e39cdc21a8
.quad 0x1ef1a0fda3cd9b1f,0xa3cda0fd1ef12400,0x9db5a3fd9f5820fd,0xa31c132d237921a8,0xa364a1a81e1f2400,0x9e1f21a823648000,0xa34d132d239f20fd,0x1cdc23fd1e89a1a8
.quad 0x9d49224122c69b1f,0x22c622419d49a400,0x1f5823e31879a335,0x23ec195ca31ca1a8,0x23b02042a155a335,0x2155a042a3b00000,0x22e49c6ea3ff9b1f,0xf2ea3b0a01121a8
.quad 0x240020fd9b1fa335,0xa335a3359b1f20fd,0x22a7132da21da3cd,0xa3ffa0a11cdc238d,0x1e1fa042a3fda0fd,0xa300972a21f723cd,0x9a3ea364a2a70000,0xa0721e1f23d921a8
.quad 0xa1a8a3cd9d4920fd,0x972a2241238d1b1f,0xa3d9a1551cdc23cd,0x1db523e321299d49,0xa364972a22862335,0x21f7238d195ca241,0xa0721fbd23ff1ef1,0x23bf21559db5a3f3
.quad 0x233522419b1f,0x23cd1b1fa241a335,0x207223e31bfea241,0x221d9c6ea3eca042,0x236421a89e1fa400,0x1e1fa1a8a3640000,0x23d9195ca2e4a241,0x9561a3b0a0cf2042
.quad 0x21a89ef1a3f39b1f,0xa042a3cd972a2335,0x1a3ea300a1d01ef1,0xa2e4a1f71e8923f3,0x9e1fa3f3995c2335,0xa3fd9d4922862241,0xa2a7a1f71f5823cd,0xa34d195c23f91d49
.quad 0x20fd240020fd9b1f,0x9b1fa335a3359b1f,0x22e423641bfea0fd,0x9f58a3e3a1d0172a,0x23e321a8995ca335,0xa155a3f39fbd1ef1,0x23d91e1fa072a400,0xa2a7a3649a3e21a8
.quad 0x22c68000a2c6a335,0xa38da241172a2335,0x20cf9e1fa3eca0fd,0xa3f9a0a11e8923f3,0x1c6ea1a8a3b09b1f,0xa3e39d49215523cd,0x9561a364a21d1b1f,0xa34d932d22e422c6
.quad 0x9ef1a4009ef120fd,0xa2411b1f23cd20fd,0xa1d0a3648f2e2335,0xa0cf1fbd23f91d49,0xa364a1a81e1f2400,0x9e1f21a823648000,0xa3ff9e1f21d02335,0x98792300221d9d49
.quad 0xa38d0000238d20fd,0x172a23cd2042a0fd,0xa21d1e1f23f91b1f,0x1db523fd1bfea2c6,0x9fbd21a823009b1f,0x20a1238d932da3cd,0x9879236420cfa0fd,0x221d22869db5a3f3
.quad 0x9b1f20fd240020fd,0x20fd9b1fa335a335,0x956121f723d91ef1,0x20cf9c6ea379a2c6,0x132d22c623641b1f,0x20a19d49a3b0a241,0x1a3e236422a78000,0x20729e1fa3d9a1a8
.quad 0x1d4923cd21a89b1f,0x20429ef1a3f3a0fd,0x1f5823fd20729ef1,0x20119fbda3ffa042,0x20a123f31e1fa0fd,0x1fbda042a3fd9ef1,0x217f23b01a3ea241,0x1f58a0a1a3ec9d49
.quad 0x224123358000a335,0x1ef1a0fda3cd9b1f,0x22e422869a3ea3cd,0x1e89a155a39f972a,0x236421a89e1fa400,0x1e1fa1a8a3640000,0x23bf20a1a072a3cd,0x1db5a1f7a31c172a
.quad 0x23f31ef1a1a8a335,0x1d49a241a2c61b1f,0x23ff1c6ea2a7a241,0x1cdca286a2641d49,0x23e3172aa364a0fd,0x1c6ea2c6a1f71ef1,0x239f932da3d99ef1,0x1bfea300a17f2042
.quad 0x9ef1a3cda2418000,0x8000224123cd1ef1,0x9db5a3b0a2648000,0x9a3e215523f92042,0x9c6ea38da2868000,0x9e1f204223fd20fd,0x9a3ea364a2a78000,0xa0721e1f23d921a8
.quad 0x972aa335a2c68000,0xa1a81b1f238d2241,0x8f2ea300a2e48000,0xa2a7132d231c22c6,0x132da2c6a3008000,0xa364972a22862335,0x1879a286a31c8000,0xa3d99c6e21d0238d
.quad 0x1b1fa241a3358000,0xa4009ef120fd23cd,0x1cdca1f7a34d8000,0xa3d9a0a1201123f3,0x1e1fa1a8a3648000,0xa364a1a81e1f2400,0x1f58a155a3798000,0xa2a7a2861bfe23f3
.quad 0x2042a0fda38d8000,0xa1a8a335172a23cd,0x20cfa0a1a39f8000,0xa072a3b08f2e238d,0x2155a042a3b08000,0x9e1fa3f3995c2335,0x21d09fbda3bf8000,0x9a3ea3fd9cdc22c6
.quad 0x1ef19ef1a3cda241,0xa2418000224123cd,0x217f995ca31ca335,0xa3bf9e1f201123f3,0x2300172aa1f7a3cd,0xa3e3a1a8195c2335,0x23d91e1fa072a400,0xa2a7a3649a3e21a8
.quad 0x23f320fd9d49a3cd,0xa042a400a0421ef1,0x234d22869561a335,0x9879a364a264172a,0x21f7238d195ca241,0x1c6ea1a8a3b09b1f,0x201123fd1e89a0fd,0x21299e1fa3f9a042
.quad 0x1b1f23cd20fd9ef1,0x23358000a335a241,0x9561230022649b1f,0x23ff1e1fa17fa38d,0x9e1f21a823648000,0x236421a89e1fa400,0xa1291fbd23ec1b1f,0x217f23648f2ea38d
.quad 0xa2c61b1f23f31ef1,0x1d4924001d49a241,0xa3bf932d237920fd,0x956123642129a042,0xa3fd9d4922862241,0x9fbd21a823009b1f,0xa379a0a121292335,0xa2641e1f23ec172a
.quad 0x23cd1ef19ef1a3cd,0xa3cda24180002241,0x239f22860f2ea241,0xa129a3fda0721d49,0x215523f31fbd9ef1,0x932da2c6a3649b1f,0x1a3e236422a78000,0x20729e1fa3d9a1a8
.quad 0x9d4920fd23f31ef1,0x238d1b1fa1a8a3cd,0xa21d195c23792241,0x239f21f79a3ea38d,0xa3e39d49215523cd,0x20a123f31e1fa0fd,0xa379a1f71bfe23cd,0x8f2e230022a7972a
.quad 0xa0fda3cd9b1f2241,0xa0fd1ef124001ef1,0x9879a3b0a1291ef1,0xa3bf995c22a722c6,0x1e1fa1a8a3648000,0xa364a1a81e1f2400,0x22649c6ea3f99ef1,0xa011a3e39a3e22c6
.quad 0x23f31b1fa2c6a241,0x172aa335a1a81ef1,0x234d2155a011a3cd,0x217f9fbda3d9972a,0x20a1238d932da3cd,0x23e3172aa364a0fd,0x156123e31e89a241,0x231c2155a072a38d
.quad 0x224123cd1ef19ef1,0x9ef1a3cda2418000,0x18792300234d1b1f,0x1e899fbda3eca1a8,0xa0a11d4923b02241,0x23b01d49a0a1a400,0xa3d99e1f20722400,0x22a723641a3ea1a8
.quad 0xa2c6a335972a2241,0x172a233522c68000,0x9bfea3b0a1d01b1f,0xa17f1c6e23bf21a8,0x1fbda042a3fd9ef1,0xa3fda0421fbd2400,0x239f195ca264a335,0xa0cfa3e39cdc21a8
.quad 0x233522419b1fa3cd,0x1b1fa241a3358000,0x1db523fd1f58a0fd,0x231c932da379a1a8,0x9e1f21a823648000,0x236421a89e1fa400,0xa34d132d239f20fd,0x1cdc23fd1e89a1a8
.quad 0xa38da0fd204223cd,0xa04220fd238d8000,0x9f58a3e398792335,0xa3ec995c231c21a8,0x1c6ea2c6a1f71ef1,0xa1f7a2c61c6e2400,0x22e49c6ea3ff9b1f,0xf2ea3b0a01121a8
.quad 0x8000224123cd1ef1,0x1ef19ef1a3cda241,0xa2a7932d221d23cd,0x23ff20a19cdca38d,0xa364a2c6932d2241,0x1fbd23f321559b1f,0x9a3ea364a2a78000,0xa0721e1f23d921a8
.quad 0x21a89b1fa38da241,0xa3f3a0fd1d4923cd,0x23d921559cdca3cd,0x9db5a3e3a1291d49,0x1e1f23f320a19ef1,0x21559d49a3e3a0fd,0xa0721fbd23ff1ef1,0x23bf21559db5a3f3
.quad 0xa4009ef120fd23cd,0x1b1f23cd20fd9ef1,0xa072a3e39bfe2241,0xa21d1c6e23ec2042,0x1e1fa1a8a3648000,0xa364a1a81e1f2400,0x23d9195ca2e4a241,0x9561a3b0a0cf2042
.quad 0x21a82335972aa3cd,0x22c69b1fa3f39ef1,0x9a3e230021d09ef1,0x22e421f79e89a3f3,0xa364172a23e31ef1,0x932d238d20a1a0fd,0xa2a7a1f71f5823cd,0xa34d195c23f91d49
.quad 0xa2418000224123cd,0x23cd1ef19ef1a3cd,0xa2e4a3649bfe20fd,0x1f5823e321d0972a,0x195ca1a8a3e39ef1,0xa1f7172a23002335,0x23d91e1fa072a400,0xa2a7a3649a3e21a8
.quad 0x2042240020429ef1,0x1d49a0fda3f39ef1,0xa0cf1e1f23ec20fd,0x23f920a19e89a3f3,0xa3b0a1a81c6e23cd,0x195c238d21f79b1f,0x9561a364a21d1b1f,0xa34d932d22e422c6
.quad 0x23358000a335a241,0xa0fda3cd9b1f2241,0x21d023640f2ea335,0x20cf9fbda3f99d49,0x9e1f21a823648000,0x236421a89e1fa400,0xa3ff9e1f21d02335,0x98792300221d9d49
.quad 0x9d49a4009d492241,0xa3f39b1f22c62241,0x221d9e1fa3f99b1f,0x9db5a3fd9bfe22c6,0x230021a89fbda3cd,0x22869d49a3fd9b1f,0x9879236420cfa0fd,0x221d22869db5a3f3
.quad 0xa3cda24180002241,0x224123cd1ef19ef1,0x1561a1f7a3d99ef1,0xa0cf1c6e237922c6,0x23fd20429e1fa3cd,0xa286a38d9c6e20fd,0x1a3e236422a78000,0x20729e1fa3d9a1a8
.quad 0xa38d9b1f21a823cd,0x22c62335172aa241,0x9f58a3fda0721ef1,0xa0111fbd23ff2042,0x2286972aa364a241,0xa300a2c6132d2335,0x217f23b01a3ea241,0x1f58a0a1a3ec9d49
.quad 0xa0fd1ef124001ef1,0x233522419b1fa3cd,0xa2e4a2861a3e23cd,0x9e892155239f172a,0x1e1fa1a8a3648000,0xa364a1a81e1f2400,0x23bf20a1a072a3cd,0x1db5a1f7a31c172a
.quad 0x972a233521a89ef1,0x238d20fda042a3cd,0xa3ff9c6e22a72241,0x9cdc228622649d49,0x995ca3f39e1f2241,0xa3b0a04221552335,0x239f932da3d99ef1,0x1bfea300a17f2042
.quad 0x9ef1a3cda2418000,0x8000224123cd1ef1,0x23791c6ea0cfa400,0xa3d9a1f7156122c6,0x1c6e238d22868000,0x1e1fa042a3fda0fd,0xa3d99e1f20722400,0x22a723641a3ea1a8
.quad 0x972aa335a2c68000,0xa1a81b1f238d2241,0x23ff1fbda011a400,0xa072a3fd9f582042,0x932d22c623008000,0x2364172aa286a335,0xa3eca0a11f582400,0x1a3e23b0217f9d49
.quad 0x1b1fa241a3358000,0xa4009ef120fd23cd,0x239f21559e89a400,0x1a3ea286a2e4172a,0x9e1f21a823648000,0x236421a89e1fa400,0xa31ca1f71db52400,0xa07220a123bf172a
.quad 0x2042a0fda38d8000,0xa1a8a335172a23cd,0x226422869cdca400,0x22a79c6ea3ff9d49,0xa155204223b08000,0x1e1f23f3195ca335,0xa17fa3001bfe2400,0xa3d9932d239f2042
.quad 0x1ef19ef1a3cda241,0xa2418000224123cd,0x21d023e31f589ef1,0x9bfea364a2e4972a,0xa300972a21f723cd,0x23e321a8995ca335,0x9a3ea364a2a78000,0xa0721e1f23d921a8
.quad 0x23f320fd9d49a3cd,0xa042a400a0421ef1,0x9e8920a123f91ef1,0x23ec1e1fa0cfa3f3,0xa1f7a38d995c2241,0x9c6e21a823b01b1f,0x22e4932da34da241,0xa21da364956122c6
.quad 0x1b1f23cd20fd9ef1,0x23358000a335a241,0xa3f99fbd20cf23cd,0xf2e236421d09d49,0x1e1fa1a8a3648000,0xa364a1a81e1f2400,0x221d23009879a3cd,0x21d09e1fa3ff9d49
.quad 0xa2c61b1f23f31ef1,0x1d4924001d49a241,0x9bfea3fd9db52241,0xa3f99e1f221d22c6,0x23fd1d49a286a241,0x1fbda1a8a3001b1f,0x9db52286221d9ef1,0x20cf23649879a3f3
.quad 0x23cd1ef19ef1a3cd,0xa3cda24180002241,0x9cdc20a123ff20fd,0x221d932da2a7a38d,0xa155a3f39fbd1ef1,0x132d22c623641b1f,0x23d91e1fa072a400,0xa2a7a3649a3e21a8
.quad 0x9d4920fd23f31ef1,0x238d1b1fa1a8a3cd,0xa129a3e39db520fd,0x9cdc215523d91d49,0x23e31d49a155a3cd,0xa0a1a3f39e1f20fd,0x9db5215523bf1b1f,0x23ff1fbda072a3f3
.quad 0xa0fda3cd9b1f2241,0xa0fd1ef124001ef1,0x23ec1c6ea21da335,0x9bfea3e3a0722042,0x9e1f21a823648000,0x236421a89e1fa400,0xa0cfa3b095612335,0xa2e4195c23d92042
.quad 0x23f31b1fa2c6a241,0x172aa335a1a81ef1,0x9e8921f722e49b1f,0x21d023009a3ea3f3,0xa0a1a38d132d23cd,0xa3e3972a236420fd,0x23f9195ca34da0fd,0x1f58a1f7a2a71d49
.quad 0x224123cd1ef19ef1,0x9ef1a3cda2418000,0xa3ec9fbd1e8923cd,0x234d23001879a1a8,0x20a19d49a3b0a241,0xa3b09d4920a12400,0x1a3e236422a78000,0x20729e1fa3d9a1a8
.quad 0xa2c6a335972a2241,0x172a233522c68000,0x23bf1c6ea17fa3cd,0xa1d0a3b09bfe21a8,0x9fbd204223fd1ef1,0x23fd20429fbda400,0x9cdca3e3a0cf1ef1,0xa264195c239f21a8
.quad 0x233522419b1fa3cd,0x1b1fa241a3358000,0xa379932d231c2241,0x1f5823fd1db5a1a8,0x1e1fa1a8a3648000,0xa364a1a81e1f2400,0x1e8923fd1cdca241,0x239f132da34da1a8
.quad 0xa38da0fd204223cd,0xa04220fd238d8000,0x231c995ca3ec9ef1,0x9879a3e39f5821a8,0x9c6e22c621f79ef1,0x21f722c69c6ea400,0xa011a3b00f2e23cd,0xa3ff9c6e22e421a8
.quad 0x8000224123cd1ef1,0x1ef19ef1a3cda241,0xa072a3fda1291b1f,0xf2e2286239f1d49,0x236422c6132da241,0x9fbda3f3a1551b1f,0xa3d99e1f20722400,0x22a723641a3ea1a8
.quad 0x21a89b1fa38da241,0xa3f3a0fd1d4923cd,0x9a3e21f7239f1b1f,0x2379195ca21da38d,0x9e1fa3f3a0a11ef1,0xa1551d4923e320fd,0x22a723008f2ea335,0x1bfea1f7a379972a
.quad 0xa4009ef120fd23cd,0x1b1f23cd20fd9ef1,0x22a7995ca3bfa0fd,0xa129a3b0987922c6,0x9e1f21a823648000,0x236421a89e1fa400,0x9a3ea3e3a01120fd,0xa3f99c6e226422c6
.quad 0x21a82335972aa3cd,0x22c69b1fa3f39ef1,0xa3d99fbd217f2335,0xa0112155234d972a,0x2364972aa3e39ef1,0x132da38da0a120fd,0xa0722155231c9b1f,0x1e8923e31561a38d
.quad 0xa2418000224123cd,0x23cd1ef19ef1a3cd,0x20119e1fa3bfa241,0xa31c995c217f23f3,0x995c21a823e31ef1,0x21f7972aa300a335,0x9a3ea364a2a78000,0xa0721e1f23d921a8
.quad 0x2042240020429ef1,0x1d49a0fda3f39ef1,0xa264a36498792241,0x95612286234d172a,0x23b021a89c6ea3cd,0x995ca38da1f71b1f,0xa3f99e1f212923cd,0x1e8923fd2011a042
.quad 0x23358000a335a241,0xa0fda3cd9b1f2241,0xa17f1e1f23ff1ef1,0x226423009561a38d,0x1e1fa1a8a3648000,0xa364a1a81e1f2400,0x8f2e2364217f9ef1,0x23ec1fbda129a38d
.quad 0x9d49a4009d492241,0xa3f39b1f22c62241,0x212923649561a3cd,0x2379932da3bfa042,0xa300a1a81fbd23cd,0xa2861d4923fd1b1f,0x23ec1e1fa264a241,0x2129a0a1a379172a
.quad 0xa3cda24180002241,0x224123cd1ef19ef1,0x23f921559a3ea335,0xa264a3b09db52042,0xa3fda0421e1f23cd,0x2286238d1c6ea0fd,0x23d91e1fa072a400,0xa2a7a3649a3e21a8
.quad 0xa38d9b1f21a823cd,0x22c62335172aa241,0x231c132da2a7a335,0xa2e4a3008f2e22c6,0xa286172a23642241,0x230022c6932da335,0x21d09c6ea3d9a0fd,0xa31ca2861879238d
.quad 0xa0fd1ef124001ef1,0x233522419b1fa3cd,0x2011a0a1a3d99b1f,0xa34da1f71cdc23f3,0x9e1f21a823648000,0x236421a89e1fa400,0x1bfea286a2a71b1f,0xa379a1551f5823f3
.quad 0x972a233521a89ef1,0x238d20fda042a3cd,0x8f2ea3b0a07220fd,0xa39fa0a120cf238d,0x195c23f31e1fa241,0x23b02042a155a335,0x9cdca3fd9a3e2335,0xa3bf9fbd21d022c6
.quad 0x9ef1a3cda2418000,0x8000224123cd1ef1,0x1db523b022648000,0x1a3ea155a3f9a042,0x9c6ea38da2868000,0x9e1f204223fd20fd,0x1a3e236422a78000,0x20729e1fa3d9a1a8
.quad 0x972aa335a2c68000,0xa1a81b1f238d2241,0xf2e230022e48000,0x22a7932da31ca2c6,0x132da2c6a3008000,0xa364972a22862335,0x98792286231c8000,0x23d91c6ea1d0a38d
.quad 0x1b1fa241a3358000,0xa4009ef120fd23cd,0x9cdc21f7234d8000,0x23d920a1a011a3f3,0x1e1fa1a8a3648000,0xa364a1a81e1f2400,0x9f58215523798000,0x22a722869bfea3f3
.quad 0x2042a0fda38d8000,0xa1a8a335172a23cd,0xa0cf20a1239f8000,0x207223b00f2ea38d,0x2155a042a3b08000,0x9e1fa3f3995c2335,0xa1d01fbd23bf8000,0x1a3e23fd1cdca2c6
.quad 0x1ef19ef1a3cda241,0xa2418000224123cd,0xa17f195c231c2335,0x23bf1e1fa011a3f3,0x2300172aa1f7a3cd,0xa3e3a1a8195c2335,0xa3d99e1f20722400,0x22a723641a3ea1a8
.quad 0x23f320fd9d49a3cd,0xa042a400a0421ef1,0xa34da28615612335,0x187923642264972a,0x21f7238d195ca241,0x1c6ea1a8a3b09b1f,0xa011a3fd9e8920fd,0xa1291e1f23f92042
.quad 0x1b1f23cd20fd9ef1,0x23358000a335a241,0x1561a300a2641b1f,0xa3ff9e1f217f238d,0x9e1f21a823648000,0x236421a89e1fa400,0x21299fbda3ec9b1f,0xa17fa3640f2e238d
.quad 0xa2c61b1f23f31ef1,0x1d4924001d49a241,0x23bf132da379a0fd,0x1561a364a1292042,0xa3fd9d4922862241,0x9fbd21a823009b1f,0x237920a1a129a335,0x22649e1fa3ec972a
.quad 0x23cd1ef19ef1a3cd,0xa3cda24180002241,0xa39fa2868f2e2241,0x212923fd20729d49,0x215523f31fbd9ef1,0x932da2c6a3649b1f,0x9a3ea364a2a78000,0xa0721e1f23d921a8
.quad 0x9d4920fd23f31ef1,0x238d1b1fa1a8a3cd,0x221d995ca379a241,0xa39fa1f71a3e238d,0xa3e39d49215523cd,0x20a123f31e1fa0fd,0x237921f79bfea3cd,0xf2ea300a2a7172a
.quad 0xa0fda3cd9b1f2241,0xa0fd1ef124001ef1,0x187923b021299ef1,0x23bf195ca2a7a2c6,0x1e1fa1a8a3648000,0xa364a1a81e1f2400,0xa2641c6e23f91ef1,0x201123e31a3ea2c6
.quad 0x23f31b1fa2c6a241,0x172aa335a1a81ef1,0xa34da155201123cd,0xa17f1fbd23d9172a,0x20a1238d932da3cd,0x23e3172aa364a0fd,0x9561a3e39e892241,0xa31ca1552072238d
.quad 0x224123cd1ef19ef1,0x9ef1a3cda2418000,0x9879a300a34d9b1f,0x9e891fbd23ec21a8,0xa0a11d4923b02241,0x23b01d49a0a1a400,0x23d91e1fa072a400,0xa2a7a3649a3e21a8
.quad 0xa2c6a335972a2241,0x172a233522c68000,0x1bfe23b021d09b1f,0x217f9c6ea3bfa1a8,0x1fbda042a3fd9ef1,0xa3fda0421fbd2400,0xa39f995c22642335,0x20cf23e31cdca1a8
.quad 0x233522419b1fa3cd,0x1b1fa241a3358000,0x9db5a3fd9f5820fd,0xa31c132d237921a8,0x9e1f21a823648000,0x236421a89e1fa400,0x234d932da39fa0fd,0x9cdca3fd9e8921a8
.quad 0xa38da0fd204223cd,0xa04220fd238d8000,0x1f5823e31879a335,0x23ec195ca31ca1a8,0x1c6ea2c6a1f71ef1,0xa1f7a2c61c6e2400,0xa2e41c6e23ff1b1f,0x8f2e23b02011a1a8
.quad 0x8000224123cd1ef1,0x1ef19ef1a3cda241,0x22a7132da21da3cd,0xa3ffa0a11cdc238d,0xa364a2c6932d2241,0x1fbd23f321559b1f,0x1a3e236422a78000,0x20729e1fa3d9a1a8
.quad 0x21a89b1fa38da241,0xa3f3a0fd1d4923cd,0xa3d9a1551cdc23cd,0x1db523e321299d49,0x1e1f23f320a19ef1,0x21559d49a3e3a0fd,0x20729fbda3ff9ef1,0xa3bfa1551db523f3
.quad 0xa4009ef120fd23cd,0x1b1f23cd20fd9ef1,0x207223e31bfea241,0x221d9c6ea3eca042,0x1e1fa1a8a3648000,0xa364a1a81e1f2400,0xa3d9995c22e42241,0x156123b020cfa042
.quad 0x21a82335972aa3cd,0x22c69b1fa3f39ef1,0x1a3ea300a1d01ef1,0xa2e4a1f71e8923f3,0xa364172a23e31ef1,0x932d238d20a1a0fd,0x22a721f79f58a3cd,0x234d995ca3f99d49
.quad 0xa2418000224123cd,0x23cd1ef19ef1a3cd,0x22e423641bfea0fd,0x9f58a3e3a1d0172a,0x195ca1a8a3e39ef1,0xa1f7172a23002335,0xa3d99e1f20722400,0x22a723641a3ea1a8
.quad 0x2042240020429ef1,0x1d49a0fda3f39ef1,0x20cf9e1fa3eca0fd,0xa3f9a0a11e8923f3,0xa3b0a1a81c6e23cd,0x195c238d21f79b1f,0x15612364221d9b1f,0x234d132da2e4a2c6
.quad 0x23358000a335a241,0xa0fda3cd9b1f2241,0xa1d0a3648f2e2335,0xa0cf1fbd23f91d49,0x9e1f21a823648000,0x236421a89e1fa400,0x23ff1e1fa1d0a335,0x1879a300a21d1d49
.quad 0x9d49a4009d492241,0xa3f39b1f22c62241,0xa21d1e1f23f91b1f,0x1db523fd1bfea2c6,0x230021a89fbda3cd,0x22869d49a3fd9b1f,0x1879a364a0cf20fd,0xa21da2861db523f3
.quad 0xa3cda24180002241,0x224123cd1ef19ef1,0x956121f723d91ef1,0x20cf9c6ea379a2c6,0x23fd20429e1fa3cd,0xa286a38d9c6e20fd,0x9a3ea364a2a78000,0xa0721e1f23d921a8
.quad 0xa38d9b1f21a823cd,0x22c62335172aa241,0x1f5823fd20729ef1,0x20119fbda3ffa042,0x2286972aa364a241,0xa300a2c6132d2335,0xa17fa3b09a3e2241,0x9f5820a123ec1d49
.quad 0xa0fd1ef124001ef1,0x233522419b1fa3cd,0x22e422869a3ea3cd,0x1e89a155a39f972a,0x1e1fa1a8a3648000,0xa364a1a81e1f2400,0xa3bfa0a1207223cd,0x9db521f7231c972a
.quad 0x972a233521a89ef1,0x238d20fda042a3cd,0x23ff1c6ea2a7a241,0x1cdca286a2641d49,0x995ca3f39e1f2241,0xa3b0a04221552335,0xa39f132d23d91ef1,0x9bfe2300217fa042
.quad 0x9ef1a3cda2418000,0x8000224123cd1ef1,0xa3799c6e20cf2400,0x23d921f79561a2c6,0x1c6e238d22868000,0x1e1fa042a3fda0fd,0x23d91e1fa072a400,0xa2a7a3649a3e21a8
.quad 0x972aa335a2c68000,0xa1a81b1f238d2241,0xa3ff9fbd20112400,0x207223fd1f58a042,0x932d22c623008000,0x2364172aa286a335,0x23ec20a19f58a400,0x9a3ea3b0a17f1d49
.quad 0x1b1fa241a3358000,0xa4009ef120fd23cd,0xa39fa1551e892400,0x9a3e228622e4972a,0x9e1f21a823648000,0x236421a89e1fa400,0x231c21f79db5a400,0x2072a0a1a3bf972a
.quad 0x2042a0fda38d8000,0xa1a8a335172a23cd,0xa264a2861cdc2400,0xa2a71c6e23ff1d49,0xa155204223b08000,0x1e1f23f3195ca335,0x217f23009bfea400,0x23d9132da39fa042
.quad 0x1ef19ef1a3cda241,0xa2418000224123cd,0xa1d0a3e39f581ef1,0x1bfe236422e4172a,0xa300972a21f723cd,0x23e321a8995ca335,0x1a3e236422a78000,0x20729e1fa3d9a1a8
.quad 0x23f320fd9d49a3cd,0xa042a400a0421ef1,0x1e89a0a1a3f99ef1,0xa3ec9e1f20cf23f3,0xa1f7a38d995c2241,0x9c6e21a823b01b1f,0xa2e4132d234d2241,0x221d23641561a2c6
.quad 0x1b1f23cd20fd9ef1,0x23358000a335a241,0x23f91fbda0cfa3cd,0x8f2ea364a1d01d49,0x1e1fa1a8a3648000,0xa364a1a81e1f2400,0xa21da300187923cd,0xa1d01e1f23ff1d49
.quad 0xa2c61b1f23f31ef1,0x1d4924001d49a241,0x1bfe23fd1db5a241,0x23f91e1fa21da2c6,0x23fd1d49a286a241,0x1fbda1a8a3001b1f,0x1db5a286a21d1ef1,0xa0cfa364187923f3
.quad 0x23cd1ef19ef1a3cd,0xa3cda24180002241,0x1cdca0a1a3ffa0fd,0xa21d132d22a7238d,0xa155a3f39fbd1ef1,0x132d22c623641b1f,0xa3d99e1f20722400,0x22a723641a3ea1a8
.quad 0x9d4920fd23f31ef1,0x238d1b1fa1a8a3cd,0x212923e31db5a0fd,0x1cdca155a3d99d49,0x23e31d49a155a3cd,0xa0a1a3f39e1f20fd,0x1db5a155a3bf9b1f,0xa3ff9fbd207223f3
.quad 0xa0fda3cd9b1f2241,0xa0fd1ef124001ef1,0xa3ec9c6e221d2335,0x1bfe23e32072a042,0x9e1f21a823648000,0x236421a89e1fa400,0x20cf23b01561a335,0x22e4995ca3d9a042
.quad 0x23f31b1fa2c6a241,0x172aa335a1a81ef1,0x1e89a1f7a2e41b1f,0xa1d0a3001a3e23f3,0xa0a1a38d132d23cd,0xa3e3972a236420fd,0xa3f9995c234d20fd,0x9f5821f722a79d49
.quad 0x224123cd1ef19ef1,0x9ef1a3cda2418000,0x23ec1fbd9e89a3cd,0xa34da300987921a8,0x20a19d49a3b0a241,0xa3b09d4920a12400,0x9a3ea364a2a78000,0xa0721e1f23d921a8
.quad 0xa2c6a335972a2241,0x172a233522c68000,0xa3bf9c6e217f23cd,0x21d023b01bfea1a8,0x9fbd204223fd1ef1,0x23fd20429fbda400,0x1cdc23e320cf9ef1,0x2264995ca39fa1a8
.quad 0x233522419b1fa3cd,0x1b1fa241a3358000,0x2379132da31ca241,0x9f58a3fd9db521a8,0x1e1fa1a8a3648000,0xa364a1a81e1f2400,0x9e89a3fd9cdc2241,0xa39f932d234d21a8
.quad 0xa38da0fd204223cd,0xa04220fd238d8000,0xa31c195c23ec1ef1,0x187923e31f58a1a8,0x9c6e22c621f79ef1,0x21f722c69c6ea400,0x201123b08f2ea3cd,0x23ff1c6ea2e4a1a8
.quad 0x8000224123cd1ef1,0x1ef19ef1a3cda241,0x207223fd21299b1f,0x8f2ea286a39f9d49,0x236422c6132da241,0x9fbda3f3a1551b1f,0x23d91e1fa072a400,0xa2a7a3649a3e21a8
.quad 0x21a89b1fa38da241,0xa3f3a0fd1d4923cd,0x1a3ea1f7a39f9b1f,0xa379995c221d238d,0x9e1fa3f3a0a11ef1,0xa1551d4923e320fd,0xa2a7a3000f2e2335,0x9bfe21f72379172a
.quad 0xa4009ef120fd23cd,0x1b1f23cd20fd9ef1,0xa2a7195c23bf20fd,0x212923b01879a2c6,0x9e1f21a823648000,0x236421a89e1fa400,0x1a3e23e32011a0fd,0x23f91c6ea264a2c6
.quad 0x21a82335972aa3cd,0x22c69b1fa3f39ef1,0x23d91fbda17fa335,0x2011a155a34d172a,0x2364972aa3e39ef1,0x132da38da0a120fd,0x2072a155a31c1b1f,0x9e89a3e39561238d
.quad 0xa2418000224123cd,0x23cd1ef19ef1a3cd,0xa0111e1f23bf2241,0x231c195ca17fa3f3,0x995c21a823e31ef1,0x21f7972aa300a335,0x1a3e236422a78000,0x20729e1fa3d9a1a8
.quad 0x2042240020429ef1,0x1d49a0fda3f39ef1,0x226423641879a241,0x1561a286a34d972a,0x23b021a89c6ea3cd,0x995ca38da1f71b1f,0x23f91e1fa129a3cd,0x9e89a3fda0112042
.quad 0x23358000a335a241,0xa0fda3cd9b1f2241,0x217f9e1fa3ff9ef1,0xa264a3001561238d,0x1e1fa1a8a3648000,0xa364a1a81e1f2400,0xf2ea364a17f1ef1,0xa3ec9fbd2129238d
.quad 0x9d49a4009d492241,0xa3f39b1f22c62241,0xa129a364156123cd,0xa379132d23bf2042,0xa300a1a81fbd23cd,0xa2861d4923fd1b1f,0xa3ec9e1f22642241,0xa12920a12379972a
.quad 0xa3cda24180002241,0x224123cd1ef19ef1,0xa3f9a1551a3e2335,0x226423b01db5a042,0xa3fda0421e1f23cd,0x2286238d1c6ea0fd,0xa3d99e1f20722400,0x22a723641a3ea1a8
.quad 0xa38d9b1f21a823cd,0x22c62335172aa241,0xa31c932d22a72335,0x22e423000f2ea2c6,0xa286172a23642241,0x230022c6932da335,0xa1d01c6e23d920fd,0x231c22869879a38d
.quad 0xa0fd1ef124001ef1,0x233522419b1fa3cd,0xa01120a123d91b1f,0x234d21f79cdca3f3,0x9e1f21a823648000,0x236421a89e1fa400,0x9bfe228622a79b1f,0x237921559f58a3f3
.quad 0x972a233521a89ef1,0x238d20fda042a3cd,0xf2e23b02072a0fd,0x239f20a1a0cfa38d,0x195c23f31e1fa241,0x23b02042a155a335,0x1cdc23fd1a3ea335,0x23bf1fbda1d0a2c6
.quad 0xa0fda3351b1f2400,0xa4009b1f233520fd,0xa072a3641a3e2400,0xa3d99e1f22a721a8,0x9fbda38d195c2400,0xa364a04221f72241,0x9e89a3b018792400,0xa2a7a155212922c6
.quad 0x9d49a3cd172a2400,0xa1a8a24120422335,0x9bfea3e315612400,0xa072a3001e89238d,0x995ca3f3132d2400,0x9e1fa38d1c6e23cd,0x9561a3fd0f2e2400,0x9a3ea3e3187923f3
.quad 0x8000a40000002400,0x8000a40000002400,0x1561a3fd8f2e2400,0x1a3ea3e3987923f3,0x195ca3f3932d2400,0x1e1fa38d9c6e23cd,0x1bfea3e395612400,0x2072a3009e89238d
.quad 0x1d49a3cd972a2400,0x21a8a241a0422335,0x1e89a3b098792400,0x22a7a155a12922c6,0x1fbda38d995c2400,0x2364a042a1f72241,0x2072a3649a3e2400,0x23d99e1fa2a721a8
.quad 0xa0fd20fd23359b1f,0x1b1f24001b1fa335,0xa2a71e1f23d98000,0x9a3e23642072a1a8,0xa3b0172a23fd1b1f,0xa0a121a822869ef1,0xa3ff995c239f1ef1,0xa2e41e1f23bf972a
.quad 0xa38d9ef122c620fd,0xa3f3000023f31b1f,0xa264a155217f2241,0xa39f9e1f231c2042,0xa0a1a2c61fbd2335,0xa1f7a1a821552241,0x9cdca3b01bfe23cd,0x9e89a3641db5238d
.quad 0x8000a40000002400,0x8000a40000002400,0x1cdca3b09bfe23cd,0x1e89a3649db5238d,0x20a1a2c69fbd2335,0x21f7a1a8a1552241,0x2264a155a17f2241,0x239f9e1fa31c2042
.quad 0x238d9ef1a2c620fd,0x23f38000a3f31b1f,0x23ff995ca39f1ef1,0x22e41e1fa3bf972a,0x23b0172aa3fd1b1f,0x20a121a8a2869ef1,0x22a71e1fa3d90000,0x1a3e2364a072a1a8
.quad 0x233520fda0fda335,0x23359b1fa4009b1f,0x207223649a3ea400,0x23d91e1fa2a7a1a8,0x132d23f31c6ea335,0x215522c69e1fa3cd,0x9f582286217fa0fd,0x156123fd1a3ea38d
.quad 0xa2c61ef1238d9b1f,0xa042224121a8a0fd,0xa3ff932d23ec1b1f,0xa3791c6e23d9972a,0xa300a042228620fd,0xa3b09d4923641ef1,0xa011a3001f582335,0xa0cfa286207222c6
.quad 0x8000a40000002400,0x8000a40000002400,0x2011a3009f582335,0x20cfa286a07222c6,0x2300a042a28620fd,0x23b09d49a3641ef1,0x23ff932da3ec1b1f,0x23791c6ea3d9972a
.quad 0x22c61ef1a38d9b1f,0x20422241a1a8a0fd,0x1f582286a17fa0fd,0x956123fd9a3ea38d,0x932d23f39c6ea335,0xa15522c61e1fa3cd,0xa07223641a3ea400,0xa3d91e1f22a7a1a8
.quad 0x1b1fa335a0fd20fd,0xa0fda3351b1f2400,0x22a79e1fa3d90000,0x1a3ea364a07221a8,0x23e31d49a300a0fd,0x23009d49a3e30000,0x20cf23009db5a3cd,0x23791fbda264a1a8
.quad 0x972a23cd1d49a335,0x1d4923cd972aa400,0xa21d20a122e49ef1,0xa01122862129a1a8,0xa3fd972a23e31b1f,0xa3e3172a23fd8000,0xa17fa1f721292241,0xa21da15521d021a8
.quad 0x8000a40000002400,0x8000a40000002400,0x217fa1f7a1292241,0x221da155a1d021a8,0x23fd972aa3e31b1f,0x23e3172aa3fd0000,0x221d20a1a2e49ef1,0x20112286a129a1a8
.quad 0x172a23cd9d49a335,0x9d4923cd172aa400,0xa0cf23001db5a3cd,0xa3791fbd2264a1a8,0xa3e31d492300a0fd,0xa3009d4923e38000,0xa2a79e1f23d98000,0x9a3ea364207221a8
.quad 0xa4009b1f233520fd,0xa0fd20fd23359b1f,0xa072a3641a3e2400,0xa3d99e1f22a721a8,0x1e1fa2c6a15520fd,0x9c6ea3f3932d23cd,0x23d9932da3f99b1f,0x21d0a0a1a31c1d49
.quad 0x21a82241a042a335,0x238d1ef1a2c6a0fd,0x9a3e23b01db5a335,0x187923fd0f2ea3f3,0xa3641d4923b09b1f,0xa286204223009ef1,0xa2a7a0a1226420fd,0xa31c9fbd22e42042
.quad 0x8000a40000002400,0x8000a40000002400,0x22a7a0a1a26420fd,0x231c9fbda2e42042,0x23641d49a3b09b1f,0x22862042a3009ef1,0x1a3e23b09db5a335,0x987923fd8f2ea3f3
.quad 0xa1a822412042a335,0xa38d1ef122c6a0fd,0xa3d9932d23f99b1f,0xa1d0a0a1231c1d49,0x9e1fa2c6215520fd,0x1c6ea3f3132d23cd,0x2072a3649a3e2400,0x23d99e1fa2a721a8
.quad 0x1b1f24001b1fa335,0x233520fda0fda335,0xa2a71e1f23d98000,0x9a3e23642072a1a8,0xa286a1a820a12335,0xa3fd972a23b01ef1,0x1bfea364a0112241,0x9cdca3e30f2e23f3
.quad 0x23f38000a3f39b1f,0x22c69ef1a38d1b1f,0x1f5823649cdca3cd,0x21d021f7a0cfa2c6,0xa15521a821f7a0fd,0x9fbd22c620a1a241,0xa3799e1f234d1ef1,0xa3bf9c6e239f1d49
.quad 0x8000a40000002400,0x8000a40000002400,0x23799e1fa34d1ef1,0x23bf9c6ea39f1d49,0x215521a8a1f7a0fd,0x1fbd22c6a0a1a241,0x9f5823641cdca3cd,0xa1d021f720cfa2c6
.quad 0xa3f3000023f39b1f,0xa2c69ef1238d1b1f,0x9bfea36420112241,0x1cdca3e38f2e23f3,0x2286a1a8a0a12335,0x23fd972aa3b01ef1,0x22a71e1fa3d90000,0x1a3e2364a072a1a8
.quad 0x23359b1fa4009b1f,0x1b1fa335a0fd20fd,0x207223649a3ea400,0x23d91e1fa2a7a1a8,0xa1f7204223649b1f,0x995c238d1fbda241,0xa21da1f720722335,0xa3ec9c6e234d2042
.quad 0x2042a241a1a820fd,0x172aa3cd9d492335,0x234d1fbda2a7a0fd,0x23f9195ca3bf9d49,0x9c6e238d1e1fa335,0x932d23f3195ca3cd,0xa3ec995c23d91b1f,0xa3ff932d23f9172a
.quad 0x8000a40000002400,0x8000a40000002400,0x23ec995ca3d91b1f,0x23ff932da3f9172a,0x1c6e238d9e1fa335,0x132d23f3995ca3cd,0xa34d1fbd22a7a0fd,0xa3f9195c23bf9d49
.quad 0xa042a24121a820fd,0x972aa3cd1d492335,0x221da1f7a0722335,0x23ec9c6ea34d2042,0x21f72042a3649b1f,0x195c238d9fbda241,0xa07223641a3ea400,0xa3d91e1f22a7a1a8
.quad 0xa0fda3351b1f2400,0xa4009b1f233520fd,0x22a79e1fa3d90000,0x1a3ea364a07221a8,0x1fbd238d995ca400,0x23642042a1f7a241,0xa34d1c6e23ec8000,0xa07221f7221da042
.quad 0x9d49a3cd172a2400,0xa1a8a24120422335,0x23bf995ca3f90000,0x22a79fbda34d1d49,0x195c23f3932da400,0x1e1f238d9c6ea3cd,0xa3f9132d23ff8000,0xa3d9195c23ec972a
.quad 0x8000a40000002400,0x8000a40000002400,0x23f9132da3ff0000,0x23d9195ca3ec972a,0x995c23f3132da400,0x9e1f238d1c6ea3cd,0xa3bf995c23f98000,0xa2a79fbd234d1d49
.quad 0x1d49a3cd972a2400,0x21a8a241a0422335,0x234d1c6ea3ec0000,0x207221f7a21da042,0x9fbd238d195ca400,0xa364204221f7a241,0xa2a79e1f23d98000,0x9a3ea364207221a8
.quad 0xa0fd20fd23359b1f,0x1b1f24001b1fa335,0xa072a3641a3e2400,0xa3d99e1f22a721a8,0x23b0972aa3fd9b1f,0x20a1a1a8a2861ef1,0x8f2e23e31cdca335,0x201123649bfea3f3
.quad 0xa38d9ef122c620fd,0xa3f3000023f31b1f,0x20cfa1f7a1d020fd,0x1cdca3649f5822c6,0x20a122c69fbda335,0x21f721a8a155a241,0xa39f1c6e23bf9b1f,0xa34d1e1f23799d49
.quad 0x8000a40000002400,0x8000a40000002400,0x239f1c6ea3bf9b1f,0x234d1e1fa3799d49,0xa0a122c61fbda335,0xa1f721a82155a241,0xa0cfa1f721d020fd,0x9cdca3641f5822c6
.quad 0x238d9ef1a2c620fd,0x23f38000a3f31b1f,0xf2e23e39cdca335,0xa01123641bfea3f3,0xa3b0972a23fd9b1f,0xa0a1a1a822861ef1,0x2072a3649a3e2400,0x23d99e1fa2a721a8
.quad 0x233520fda0fda335,0x23359b1fa4009b1f,0xa2a71e1f23d98000,0x9a3e23642072a1a8,0x932da3f39c6e2335,0xa155a2c61e1f23cd,0x231c20a1a1d0a241,0x23f9132da3d99d49
.quad 0xa2c61ef1238d9b1f,0xa042224121a8a0fd,0x8f2ea3fd987923cd,0x9db5a3b01a3e23f3,0x23002042a286a0fd,0x23b01d49a3649ef1,0xa2e41fbd231c9ef1,0xa26420a122a7a042
.quad 0x8000a40000002400,0x8000a40000002400,0x22e41fbda31c9ef1,0x226420a1a2a7a042,0xa30020422286a0fd,0xa3b01d4923649ef1,0xf2ea3fd187923cd,0x1db5a3b09a3e23f3
.quad 0x22c61ef1a38d9b1f,0x20422241a1a8a0fd,0xa31c20a121d0a241,0xa3f9132d23d99d49,0x132da3f31c6e2335,0x2155a2c69e1f23cd,0x22a71e1fa3d90000,0x1a3e2364a072a1a8
.quad 0x1b1fa335a0fd20fd,0xa0fda3351b1f2400,0x207223649a3ea400,0x23d91e1fa2a7a1a8,0xa3e39d49230020fd,0xa3001d4923e38000,0x22649fbda3791b1f,0x1db5a300a0cf21a8
.quad 0x972a23cd1d49a335,0x1d4923cd972aa400,0xa129a28620112335,0xa2e4a0a1221d21a8,0x23fd172aa3e39b1f,0x23e3972aa3fd0000,0xa1d02155221da0fd,0xa12921f7217fa1a8
.quad 0x8000a40000002400,0x8000a40000002400,0x21d02155a21da0fd,0x212921f7a17fa1a8,0xa3fd172a23e39b1f,0xa3e3972a23fd8000,0x2129a286a0112335,0x22e4a0a1a21d21a8
.quad 0x172a23cd9d49a335,0x9d4923cd172aa400,0xa2649fbd23791b1f,0x9db5a30020cf21a8,0x23e39d49a30020fd,0x23001d49a3e30000,0xa07223641a3ea400,0xa3d91e1f22a7a1a8
.quad 0xa4009b1f233520fd,0xa0fd20fd23359b1f,0x22a79e1fa3d90000,0x1a3ea364a07221a8,0x9e1f22c62155a0fd,0x1c6e23f3132da3cd,0x9a3ea3fd956123cd,0xa17fa2861f58238d
.quad 0x21a82241a042a335,0x238d1ef1a2c6a0fd,0xa3d99c6e23791ef1,0xa3ec132d23ff172a,0x23649d49a3b01b1f,0x2286a042a3001ef1,0xa072228620cfa241,0x9f5823002011a2c6
.quad 0x8000a40000002400,0x8000a40000002400,0x20722286a0cfa241,0x1f582300a011a2c6,0xa3649d4923b01b1f,0xa286a04223001ef1,0x23d99c6ea3791ef1,0x23ec132da3ff172a
.quad 0xa1a822412042a335,0xa38d1ef122c6a0fd,0x1a3ea3fd156123cd,0x217fa2869f58238d,0x1e1f22c6a155a0fd,0x9c6e23f3932da3cd,0xa2a79e1f23d98000,0x9a3ea364207221a8
.quad 0x1b1f24001b1fa335,0x233520fda0fda335,0xa072a3641a3e2400,0xa3d99e1f22a721a8,0x228621a8a0a1a335,0x23fd172aa3b09ef1,0xa3bf9e1f22e420fd,0xa39f195c23ff172a
.quad 0x23f38000a3f39b1f,0x22c69ef1a38d1b1f,0xa31c1e1f239f9b1f,0xa17f21552264a042,0x2155a1a8a1f720fd,0x1fbda2c6a0a12241,0x9db523641e89a335,0x9bfe23b01cdca38d
.quad 0x8000a40000002400,0x8000a40000002400,0x1db523649e89a335,0x1bfe23b09cdca38d,0xa155a1a821f720fd,0x9fbda2c620a12241,0x231c1e1fa39f9b1f,0x217f2155a264a042
.quad 0xa3f3000023f39b1f,0xa2c69ef1238d1b1f,0x23bf9e1fa2e420fd,0x239f195ca3ff172a,0xa28621a820a1a335,0xa3fd172a23b09ef1,0x2072a3649a3e2400,0x23d99e1fa2a721a8
.quad 0x23359b1fa4009b1f,0x1b1fa335a0fd20fd,0xa2a71e1f23d98000,0x9a3e23642072a1a8,0x21f7a042a3641b1f,0x195ca38d9fbd2241,0xa129215522a79ef1,0x987923b01e89a2c6
.quad 0x2042a241a1a820fd,0x172aa3cd9d492335,0x9e8923002072a241,0x956123e31bfea38d,0x1c6ea38d9e1f2335,0x132da3f3995c23cd,0x987923e31a3ea3cd,0x8f2e23fd1561a3f3
.quad 0x8000a40000002400,0x8000a40000002400,0x187923e39a3ea3cd,0xf2e23fd9561a3f3,0x9c6ea38d1e1f2335,0x932da3f3195c23cd,0x1e892300a072a241,0x156123e39bfea38d
.quad 0xa042a24121a820fd,0x972aa3cd1d492335,0x21292155a2a79ef1,0x187923b09e89a2c6,0xa1f7a04223641b1f,0x995ca38d1fbd2241,0x22a71e1fa3d90000,0x1a3e2364a072a1a8
.quad 0xa0fda3351b1f2400,0xa4009b1f233520fd,0x207223649a3ea400,0x23d91e1fa2a7a1a8,0x9fbda38d195c2400,0xa364a04221f72241,0x1e8923b09879a400,0x22a72155a129a2c6
.quad 0x9d49a3cd172a2400,0xa1a8a24120422335,0x1bfe23e39561a400,0x207223009e89a38d,0x995ca3f3132d2400,0x9e1fa38d1c6e23cd,0x156123fd8f2ea400,0x1a3e23e39879a3f3
.quad 0x8000a40000002400,0x8000a40000002400,0x956123fd0f2ea400,0x9a3e23e31879a3f3,0x195ca3f3932d2400,0x1e1fa38d9c6e23cd,0x9bfe23e31561a400,0xa07223001e89a38d
.quad 0x1d49a3cd972a2400,0x21a8a241a0422335,0x9e8923b01879a400,0xa2a721552129a2c6,0x1fbda38d995c2400,0x2364a042a1f72241,0xa07223641a3ea400,0xa3d91e1f22a7a1a8
.quad 0xa0fd20fd23359b1f,0x1b1f24001b1fa335,0x22a79e1fa3d90000,0x1a3ea364a07221a8,0xa3b0172a23fd1b1f,0xa0a121a822869ef1,0x23ff195ca39f9ef1,0x22e49e1fa3bf172a
.quad 0xa38d9ef122c620fd,0xa3f3000023f31b1f,0x22642155a17fa241,0x239f1e1fa31ca042,0xa0a1a2c61fbd2335,0xa1f7a1a821552241,0x1cdc23b09bfea3cd,0x1e8923649db5a38d
.quad 0x8000a40000002400,0x8000a40000002400,0x9cdc23b01bfea3cd,0x9e8923641db5a38d,0x20a1a2c69fbd2335,0x21f7a1a8a1552241,0xa2642155217fa241,0xa39f1e1f231ca042
.quad 0x238d9ef1a2c620fd,0x23f38000a3f31b1f,0xa3ff195c239f9ef1,0xa2e49e1f23bf172a,0x23b0172aa3fd1b1f,0x20a121a8a2869ef1,0xa2a79e1f23d98000,0x9a3ea364207221a8
.quad 0x233520fda0fda335,0x23359b1fa4009b1f,0xa072a3641a3e2400,0xa3d99e1f22a721a8,0x132d23f31c6ea335,0x215522c69e1fa3cd,0x1f58a286a17f20fd,0x9561a3fd9a3e238d
.quad 0xa2c61ef1238d9b1f,0xa042224121a8a0fd,0x23ff132da3ec9b1f,0x23799c6ea3d9172a,0xa300a042228620fd,0xa3b09d4923641ef1,0x201123009f58a335,0x20cf2286a072a2c6
.quad 0x8000a40000002400,0x8000a40000002400,0xa01123001f58a335,0xa0cf22862072a2c6,0x2300a042a28620fd,0x23b09d49a3641ef1,0xa3ff132d23ec9b1f,0xa3799c6e23d9172a
.quad 0x22c61ef1a38d9b1f,0x20422241a1a8a0fd,0x9f58a286217f20fd,0x1561a3fd1a3e238d,0x932d23f39c6ea335,0xa15522c61e1fa3cd,0x2072a3649a3e2400,0x23d99e1fa2a721a8
.quad 0x1b1fa335a0fd20fd,0xa0fda3351b1f2400,0xa2a71e1f23d98000,0x9a3e23642072a1a8,0x23e31d49a300a0fd,0x23009d49a3e30000,0xa0cfa3001db523cd,0xa3799fbd226421a8
.quad 0x972a23cd1d49a335,0x1d4923cd972aa400,0x221da0a1a2e41ef1,0x2011a286a12921a8,0xa3fd972a23e31b1f,0xa3e3172a23fd8000,0x217f21f7a129a241,0x221d2155a1d0a1a8
.quad 0x8000a40000002400,0x8000a40000002400,0xa17f21f72129a241,0xa21d215521d0a1a8,0x23fd972aa3e31b1f,0x23e3172aa3fd0000,0xa21da0a122e41ef1,0xa011a286212921a8
.quad 0x172a23cd9d49a335,0x9d4923cd172aa400,0x20cfa3009db523cd,0x23799fbda26421a8,0xa3e31d492300a0fd,0xa3009d4923e38000,0x22a71e1fa3d90000,0x1a3e2364a072a1a8
.quad 0xa4009b1f233520fd,0xa0fd20fd23359b1f,0x207223649a3ea400,0x23d91e1fa2a7a1a8,0x1e1fa2c6a15520fd,0x9c6ea3f3932d23cd,0xa3d9132d23f91b1f,0xa1d020a1231c9d49
.quad 0x21a82241a042a335,0x238d1ef1a2c6a0fd,0x1a3ea3b09db52335,0x9879a3fd8f2e23f3,0xa3641d4923b09b1f,0xa286204223009ef1,0x22a720a1a264a0fd,0x231c1fbda2e4a042
.quad 0x8000a40000002400,0x8000a40000002400,0xa2a720a12264a0fd,0xa31c1fbd22e4a042,0x23641d49a3b09b1f,0x22862042a3009ef1,0x9a3ea3b01db52335,0x1879a3fd0f2e23f3
.quad 0xa1a822412042a335,0xa38d1ef122c6a0fd,0x23d9132da3f91b1f,0x21d020a1a31c9d49,0x9e1fa2c6215520fd,0x1c6ea3f3132d23cd,0xa07223641a3ea400,0xa3d91e1f22a7a1a8
.quad 0x1b1f24001b1fa335,0x233520fda0fda335,0x22a79e1fa3d90000,0x1a3ea364a07221a8,0xa286a1a820a12335,0xa3fd972a23b01ef1,0x9bfe23642011a241,0x1cdc23e38f2ea3f3
.quad 0x23f38000a3f39b1f,0x22c69ef1a38d1b1f,0x9f58a3641cdc23cd,0xa1d0a1f720cf22c6,0xa15521a821f7a0fd,0x9fbd22c620a1a241,0x23791e1fa34d9ef1,0x23bf1c6ea39f9d49
.quad 0x8000a40000002400,0x8000a40000002400,0xa3791e1f234d9ef1,0xa3bf1c6e239f9d49,0x215521a8a1f7a0fd,0x1fbd22c6a0a1a241,0x1f58a3649cdc23cd,0x21d0a1f7a0cf22c6
.quad 0xa3f3000023f39b1f,0xa2c69ef1238d1b1f,0x1bfe2364a011a241,0x9cdc23e30f2ea3f3,0x2286a1a8a0a12335,0x23fd972aa3b01ef1,0xa2a79e1f23d98000,0x9a3ea364207221a8
.quad 0x23359b1fa4009b1f,0x1b1fa335a0fd20fd,0xa072a3641a3e2400,0xa3d99e1f22a721a8,0xa1f7204223649b1f,0x995c238d1fbda241,0x221d21f7a072a335,0x23ec1c6ea34da042
.quad 0x2042a241a1a820fd,0x172aa3cd9d492335,0xa34d9fbd22a720fd,0xa3f9995c23bf1d49,0x9c6e238d1e1fa335,0x932d23f3195ca3cd,0x23ec195ca3d99b1f,0x23ff132da3f9972a
.quad 0x8000a40000002400,0x8000a40000002400,0xa3ec195c23d99b1f,0xa3ff132d23f9972a,0x1c6e238d9e1fa335,0x132d23f3995ca3cd,0x234d9fbda2a720fd,0x23f9995ca3bf1d49
.quad 0xa042a24121a820fd,0x972aa3cd1d492335,0xa21d21f72072a335,0xa3ec1c6e234da042,0x21f72042a3649b1f,0x195c238d9fbda241,0x2072a3649a3e2400,0x23d99e1fa2a721a8
.quad 0xa0fda3351b1f2400,0xa4009b1f233520fd,0xa2a71e1f23d98000,0x9a3e23642072a1a8,0x1fbd238d995ca400,0x23642042a1f7a241,0x234d9c6ea3ec0000,0x2072a1f7a21d2042
.quad 0x9d49a3cd172a2400,0xa1a8a24120422335,0xa3bf195c23f98000,0xa2a71fbd234d9d49,0x195c23f3932da400,0x1e1f238d9c6ea3cd,0x23f9932da3ff0000,0x23d9995ca3ec172a
.quad 0x8000a40000002400,0x8000a40000002400,0xa3f9932d23ff8000,0xa3d9995c23ec172a,0x995c23f3132da400,0x9e1f238d1c6ea3cd,0x23bf195ca3f90000,0x22a71fbda34d9d49
.quad 0x1d49a3cd972a2400,0x21a8a241a0422335,0xa34d9c6e23ec8000,0xa072a1f7221d2042,0x9fbd238d195ca400,0xa364204221f7a241,0x22a71e1fa3d90000,0x1a3e2364a072a1a8
.quad 0xa0fd20fd23359b1f,0x1b1f24001b1fa335,0x207223649a3ea400,0x23d91e1fa2a7a1a8,0x23b0972aa3fd9b1f,0x20a1a1a8a2861ef1,0xf2ea3e39cdc2335,0xa011a3641bfe23f3
.quad 0xa38d9ef122c620fd,0xa3f3000023f31b1f,0xa0cf21f721d0a0fd,0x9cdc23641f58a2c6,0x20a122c69fbda335,0x21f721a8a155a241,0x239f9c6ea3bf1b1f,0x234d9e1fa3791d49
.quad 0x8000a40000002400,0x8000a40000002400,0xa39f9c6e23bf1b1f,0xa34d9e1f23791d49,0xa0a122c61fbda335,0xa1f721a82155a241,0x20cf21f7a1d0a0fd,0x1cdc23649f58a2c6
.quad 0x238d9ef1a2c620fd,0x23f38000a3f31b1f,0x8f2ea3e31cdc2335,0x2011a3649bfe23f3,0xa3b0972a23fd9b1f,0xa0a1a1a822861ef1,0xa07223641a3ea400,0xa3d91e1f22a7a1a8
.quad 0x233520fda0fda335,0x23359b1fa4009b1f,0x22a79e1fa3d90000,0x1a3ea364a07221a8,0x932da3f39c6e2335,0xa155a2c61e1f23cd,0xa31ca0a121d02241,0xa3f9932d23d91d49
.quad 0xa2c61ef1238d9b1f,0xa042224121a8a0fd,0xf2e23fd1879a3cd,0x1db523b09a3ea3f3,0x23002042a286a0fd,0x23b01d49a3649ef1,0x22e49fbda31c1ef1,0x2264a0a1a2a72042
.quad 0x8000a40000002400,0x8000a40000002400,0xa2e49fbd231c1ef1,0xa264a0a122a72042,0xa30020422286a0fd,0xa3b01d4923649ef1,0x8f2e23fd9879a3cd,0x9db523b01a3ea3f3
.quad 0x22c61ef1a38d9b1f,0x20422241a1a8a0fd,0x231ca0a1a1d02241,0x23f9932da3d91d49,0x132da3f31c6e2335,0x2155a2c69e1f23cd,0xa2a79e1f23d98000,0x9a3ea364207221a8
.quad 0x1b1fa335a0fd20fd,0xa0fda3351b1f2400,0xa072a3641a3e2400,0xa3d99e1f22a721a8,0xa3e39d49230020fd,0xa3001d4923e38000,0xa2641fbd23799b1f,0x9db5230020cfa1a8
.quad 0x972a23cd1d49a335,0x1d4923cd972aa400,0x21292286a011a335,0x22e420a1a21da1a8,0x23fd172aa3e39b1f,0x23e3972aa3fd0000,0x21d0a155a21d20fd,0x2129a1f7a17f21a8
.quad 0x8000a40000002400,0x8000a40000002400,0xa1d0a155221d20fd,0xa129a1f7217f21a8,0xa3fd172a23e39b1f,0xa3e3972a23fd8000,0xa12922862011a335,0xa2e420a1221da1a8
.quad 0x172a23cd9d49a335,0x9d4923cd172aa400,0x22641fbda3799b1f,0x1db52300a0cfa1a8,0x23e39d49a30020fd,0x23001d49a3e30000,0x2072a3649a3e2400,0x23d99e1fa2a721a8
.quad 0xa4009b1f233520fd,0xa0fd20fd23359b1f,0xa2a71e1f23d98000,0x9a3e23642072a1a8,0x9e1f22c62155a0fd,0x1c6e23f3132da3cd,0x1a3e23fd1561a3cd,0x217f22869f58a38d
.quad 0x21a82241a042a335,0x238d1ef1a2c6a0fd,0x23d91c6ea3799ef1,0x23ec932da3ff972a,0x23649d49a3b01b1f,0x2286a042a3001ef1,0x2072a286a0cf2241,0x1f58a300a01122c6
.quad 0x8000a40000002400,0x8000a40000002400,0xa072a28620cf2241,0x9f58a300201122c6,0xa3649d4923b01b1f,0xa286a04223001ef1,0xa3d91c6e23799ef1,0xa3ec932d23ff972a
.quad 0xa1a822412042a335,0xa38d1ef122c6a0fd,0x9a3e23fd9561a3cd,0xa17f22861f58a38d,0x1e1f22c6a155a0fd,0x9c6e23f3932da3cd,0x22a71e1fa3d90000,0x1a3e2364a072a1a8
.quad 0x1b1f24001b1fa335,0x233520fda0fda335,0x207223649a3ea400,0x23d91e1fa2a7a1a8,0x228621a8a0a1a335,0x23fd172aa3b09ef1,0x23bf1e1fa2e4a0fd,0x239f995ca3ff972a
.quad 0x23f38000a3f39b1f,0x22c69ef1a38d1b1f,0x231c9e1fa39f1b1f,0x217fa155a2642042,0x2155a1a8a1f720fd,0x1fbda2c6a0a12241,0x1db5a3649e892335,0x1bfea3b09cdc238d
.quad 0x8000a40000002400,0x8000a40000002400,0x9db5a3641e892335,0x9bfea3b01cdc238d,0xa155a1a821f720fd,0x9fbda2c620a12241,0xa31c9e1f239f1b1f,0xa17fa15522642042
.quad 0xa3f3000023f39b1f,0xa2c69ef1238d1b1f,0xa3bf1e1f22e4a0fd,0xa39f995c23ff972a,0xa28621a820a1a335,0xa3fd172a23b09ef1,0xa07223641a3ea400,0xa3d91e1f22a7a1a8
.quad 0x23359b1fa4009b1f,0x1b1fa335a0fd20fd,0x22a79e1fa3d90000,0x1a3ea364a07221a8,0x21f7a042a3641b1f,0x195ca38d9fbd2241,0x2129a155a2a71ef1,0x1879a3b09e8922c6
.quad 0x2042a241a1a820fd,0x172aa3cd9d492335,0x1e89a300a0722241,0x1561a3e39bfe238d,0x1c6ea38d9e1f2335,0x132da3f3995c23cd,0x1879a3e39a3e23cd,0xf2ea3fd956123f3
.quad 0x8000a40000002400,0x8000a40000002400,0x9879a3e31a3e23cd,0x8f2ea3fd156123f3,0x9c6ea38d1e1f2335,0x932da3f3195c23cd,0x9e89a30020722241,0x9561a3e31bfe238d
.quad 0xa042a24121a820fd,0x972aa3cd1d492335,0xa129a15522a71ef1,0x9879a3b01e8922c6,0xa1f7a04223641b1f,0x995ca38d1fbd2241,0xa2a79e1f23d98000,0x9a3ea364207221a8
.quad 0x22419ef1a3cd8000,0x8000a3cd9ef12241,0x22a79e1fa3d98000,0x1a3ea364a07221a8,0x23009d49a3e38000,0x1e1fa2c6a15520fd,0x234d9c6ea3ec8000,0x2072a1f7a21d2042
.quad 0x238d9b1fa3f38000,0x21a8a0fda2c61ef1,0x23bf995ca3f98000,0x22a79fbda34d1d49,0x23e3972aa3fd8000,0x23649d49a3b01b1f,0x23f9932da3ff8000,0x23d9995ca3ec172a
.quad 0x24008000a4008000,0x24008000a4008000,0x23f9132da3ff8000,0x23d9195ca3ec972a,0x23e3172aa3fd8000,0x23641d49a3b09b1f,0x23bf195ca3f98000,0x22a71fbda34d9d49
.quad 0x238d1b1fa3f38000,0x21a820fda2c69ef1,0x234d1c6ea3ec8000,0x207221f7a21da042,0x23001d49a3e38000,0x1e1f22c6a155a0fd,0x22a71e1fa3d98000,0x1a3e2364a072a1a8
.quad 0xa241a2411ef123cd,0xa3cd800023cd1ef1,0xa072a3641a3e2400,0xa3d99e1f22a721a8,0x9c6ea3f3932d23cd,0xa286a1a820a12335,0xf2ea3e39cdc2335,0xa011a3641bfe23f3
.quad 0x1d49a335a0422241,0x972aa400972a23cd,0x20cfa1f7a1d020fd,0x1cdca3649f5822c6,0x2286a042a3001ef1,0x2155a1a8a1f720fd,0x239f9c6ea3bf1b1f,0x234d9e1fa3791d49
.quad 0x24008000a4008000,0x24008000a4008000,0x239f1c6ea3bf9b1f,0x234d1e1fa3799d49,0x22862042a3009ef1,0x215521a8a1f7a0fd,0x20cf21f7a1d0a0fd,0x1cdc23649f58a2c6
.quad 0x1d492335a042a241,0x972a2400972aa3cd,0xf2e23e39cdca335,0xa01123641bfea3f3,0x9c6e23f3932da3cd,0xa28621a820a1a335,0xa07223641a3ea400,0xa3d91e1f22a7a1a8
.quad 0x9ef1224122419ef1,0x1ef123cd8000a3cd,0xa2a71e1f23d98000,0x9a3e23642072a1a8,0xa3fd972a23b01ef1,0xa1f7204223649b1f,0xa31ca0a121d02241,0xa3f9932d23d91d49
.quad 0xa042a3351d4923cd,0xa2c6a0fd21a82241,0x8f2ea3fd987923cd,0x9db5a3b01a3e23f3,0x1fbda2c6a0a12241,0x1c6ea38d9e1f2335,0x22e49fbda31c1ef1,0x2264a0a1a2a72042
.quad 0x24008000a4008000,0x24008000a4008000,0x22e41fbda31c9ef1,0x226420a1a2a7a042,0x1fbd22c6a0a1a241,0x1c6e238d9e1fa335,0x8f2e23fd9879a3cd,0x9db523b01a3ea3f3
.quad 0xa04223351d49a3cd,0xa2c620fd21a8a241,0xa31c20a121d0a241,0xa3f9132d23d99d49,0xa3fd172a23b09ef1,0xa1f7a04223641b1f,0xa2a79e1f23d98000,0x9a3ea364207221a8
.quad 0x23cd1ef1a241a241,0x22419ef1a3cd8000,0x207223649a3ea400,0x23d91e1fa2a7a1a8,0x995c238d1fbda241,0x1fbd238d995ca400,0xa2641fbd23799b1f,0x9db5230020cfa1a8
.quad 0xa3f39b1f238d1ef1,0xa38d1b1f23f38000,0xa129a28620112335,0xa2e4a0a1221d21a8,0x132da3f3995c23cd,0x995ca3f3132d2400,0x21d0a155a21d20fd,0x2129a1f7a17f21a8
.quad 0x24008000a4008000,0x24008000a4008000,0x21d02155a21da0fd,0x212921f7a17fa1a8,0x132d23f3995ca3cd,0x995c23f3132da400,0xa12922862011a335,0xa2e420a1221da1a8
.quad 0xa3f31b1f238d9ef1,0xa38d9b1f23f38000,0xa2649fbd23791b1f,0x9db5a30020cf21a8,0x995ca38d1fbd2241,0x1fbda38d995c2400,0x2072a3649a3e2400,0x23d99e1fa2a721a8
.quad 0x8000a3cd9ef12241,0xa241a2411ef123cd,0x22a79e1fa3d98000,0x1a3ea364a07221a8,0x23642042a1f7a241,0x23b0972aa3fd9b1f,0x1a3e23fd1561a3cd,0x217f22869f58a38d
.quad 0xa1a820fd22c69ef1,0x9d4923352042a241,0xa3d99c6e23791ef1,0xa3ec132d23ff172a,0x9e1fa38d1c6e23cd,0xa0a1a2c61fbd2335,0x2072a286a0cf2241,0x1f58a300a01122c6
.quad 0x24008000a4008000,0x24008000a4008000,0x20722286a0cfa241,0x1f582300a011a2c6,0x9e1f238d1c6ea3cd,0xa0a122c61fbda335,0xa3d91c6e23799ef1,0xa3ec932d23ff972a
.quad 0xa1a8a0fd22c61ef1,0x9d49a33520422241,0x1a3ea3fd156123cd,0x217fa2869f58238d,0x2364a042a1f72241,0x23b0172aa3fd1b1f,0x22a71e1fa3d98000,0x1a3e2364a072a1a8
.quad 0xa3cd800023cd1ef1,0x9ef1224122419ef1,0xa072a3641a3e2400,0xa3d99e1f22a721a8,0x20a1a1a8a2861ef1,0x932da3f39c6e2335,0x23bf1e1fa2e4a0fd,0x239f995ca3ff972a
.quad 0x172a2400172aa3cd,0x204223359d49a3cd,0xa31c1e1f239f9b1f,0xa17f21552264a042,0xa1f7a1a821552241,0xa300a042228620fd,0x1db5a3649e892335,0x1bfea3b09cdc238d
.quad 0x24008000a4008000,0x24008000a4008000,0x1db523649e89a335,0x1bfe23b09cdca38d,0xa1f721a82155a241,0xa30020422286a0fd,0xa31c9e1f239f1b1f,0xa17fa15522642042
.quad 0x172aa400172a23cd,0x2042a3359d4923cd,0x23bf9e1fa2e420fd,0x239f195ca3ff172a,0x20a121a8a2869ef1,0x932d23f39c6ea335,0xa07223641a3ea400,0xa3d91e1f22a7a1a8
.quad 0x1ef123cd8000a3cd,0x23cd1ef1a241a241,0xa2a71e1f23d98000,0x9a3e23642072a1a8,0xa155a2c61e1f23cd,0xa3e39d49230020fd,0x2129a155a2a71ef1,0x1879a3b09e8922c6
.quad 0x22c620fda1a8a241,0x23f31b1fa38d9ef1,0x9e8923002072a241,0x956123e31bfea38d,0xa3b09d4923641ef1,0xa3fd972a23e31b1f,0x1879a3e39a3e23cd,0xf2ea3fd956123f3
.quad 0x24008000a4008000,0x24008000a4008000,0x187923e39a3ea3cd,0xf2e23fd9561a3f3,0xa3b01d4923649ef1,0xa3fd172a23e39b1f,0x9e89a30020722241,0x9561a3e31bfe238d
.quad 0x22c6a0fda1a82241,0x23f39b1fa38d1ef1,0x21292155a2a79ef1,0x187923b09e89a2c6,0xa15522c61e1fa3cd,0xa3e31d492300a0fd,0xa2a79e1f23d98000,0x9a3ea364207221a8
.quad 0x22419ef1a3cd8000,0x8000a3cd9ef12241,0x207223649a3ea400,0x23d91e1fa2a7a1a8,0xa3001d4923e38000,0x9e1f22c62155a0fd,0x9e89a3b018792400,0xa2a7a155212922c6
.quad 0x238d9b1fa3f38000,0x21a8a0fda2c61ef1,0x1bfe23e39561a400,0x207223009e89a38d,0xa3e3172a23fd8000,0xa3641d4923b09b1f,0x9561a3fd0f2e2400,0x9a3ea3e3187923f3
.quad 0x24008000a4008000,0x24008000a4008000,0x956123fd0f2ea400,0x9a3e23e31879a3f3,0xa3e3972a23fd8000,0xa3649d4923b01b1f,0x1bfea3e395612400,0x2072a3009e89238d
.quad 0x238d1b1fa3f38000,0x21a820fda2c69ef1,0x9e8923b01879a400,0xa2a721552129a2c6,0xa3009d4923e38000,0x9e1fa2c6215520fd,0x2072a3649a3e2400,0x23d99e1fa2a721a8
.quad 0xa241a2411ef123cd,0xa3cd800023cd1ef1,0x22a79e1fa3d98000,0x1a3ea364a07221a8,0x1c6e23f3132da3cd,0x228621a8a0a1a335,0xa3ff995c239f1ef1,0xa2e41e1f23bf972a
.quad 0x1d49a335a0422241,0x972aa400972a23cd,0x22642155a17fa241,0x239f1e1fa31ca042,0xa286204223009ef1,0xa15521a821f7a0fd,0x9cdca3b01bfe23cd,0x9e89a3641db5238d
.quad 0x24008000a4008000,0x24008000a4008000,0x9cdc23b01bfea3cd,0x9e8923641db5a38d,0xa286a04223001ef1,0xa155a1a821f720fd,0x2264a155a17f2241,0x239f9e1fa31c2042
.quad 0x1d492335a042a241,0x972a2400972aa3cd,0xa3ff195c239f9ef1,0xa2e49e1f23bf172a,0x1c6ea3f3132d23cd,0x2286a1a8a0a12335,0x22a71e1fa3d98000,0x1a3e2364a072a1a8
.quad 0x9ef1224122419ef1,0x1ef123cd8000a3cd,0xa072a3641a3e2400,0xa3d99e1f22a721a8,0x23fd172aa3b09ef1,0x21f7a042a3641b1f,0x9f582286217fa0fd,0x156123fd1a3ea38d
.quad 0xa042a3351d4923cd,0xa2c6a0fd21a82241,0x23ff132da3ec9b1f,0x23799c6ea3d9172a,0x9fbd22c620a1a241,0x9c6e238d1e1fa335,0xa011a3001f582335,0xa0cfa286207222c6
.quad 0x24008000a4008000,0x24008000a4008000,0xa01123001f58a335,0xa0cf22862072a2c6,0x9fbda2c620a12241,0x9c6ea38d1e1f2335,0x23ff932da3ec1b1f,0x23791c6ea3d9972a
.quad 0xa04223351d49a3cd,0xa2c620fd21a8a241,0x9f58a286217f20fd,0x1561a3fd1a3e238d,0x23fd972aa3b01ef1,0x21f72042a3649b1f,0xa07223641a3ea400,0xa3d91e1f22a7a1a8
.quad 0x23cd1ef1a241a241,0x22419ef1a3cd8000,0xa2a71e1f23d98000,0x9a3e23642072a1a8,0x195ca38d9fbd2241,0x9fbda38d195c2400,0x20cf23009db5a3cd,0x23791fbda264a1a8
.quad 0xa3f39b1f238d1ef1,0xa38d1b1f23f38000,0x221da0a1a2e41ef1,0x2011a286a12921a8,0x932d23f3195ca3cd,0x195c23f3932da400,0xa17fa1f721292241,0xa21da15521d021a8
.quad 0x24008000a4008000,0x24008000a4008000,0xa17f21f72129a241,0xa21d215521d0a1a8,0x932da3f3195c23cd,0x195ca3f3932d2400,0x221d20a1a2e49ef1,0x20112286a129a1a8
.quad 0xa3f31b1f238d9ef1,0xa38d9b1f23f38000,0x20cfa3009db523cd,0x23799fbda26421a8,0x195c238d9fbda241,0x9fbd238d195ca400,0xa2a79e1f23d98000,0x9a3ea364207221a8
.quad 0x8000a3cd9ef12241,0xa241a2411ef123cd,0x207223649a3ea400,0x23d91e1fa2a7a1a8,0xa364a04221f72241,0xa3b0172a23fd1b1f,0x23d9932da3f99b1f,0x21d0a0a1a31c1d49
.quad 0xa1a820fd22c69ef1,0x9d4923352042a241,0x1a3ea3b09db52335,0x9879a3fd8f2e23f3,0x1e1f238d9c6ea3cd,0x20a122c69fbda335,0xa2a7a0a1226420fd,0xa31c9fbd22e42042
.quad 0x24008000a4008000,0x24008000a4008000,0xa2a720a12264a0fd,0xa31c1fbd22e4a042,0x1e1fa38d9c6e23cd,0x20a1a2c69fbd2335,0x1a3e23b09db5a335,0x987923fd8f2ea3f3
.quad 0xa1a8a0fd22c61ef1,0x9d49a33520422241,0x23d9132da3f91b1f,0x21d020a1a31c9d49,0xa364204221f7a241,0xa3b0972a23fd9b1f,0x2072a3649a3e2400,0x23d99e1fa2a721a8
.quad 0xa3cd800023cd1ef1,0x9ef1224122419ef1,0x22a79e1fa3d98000,0x1a3ea364a07221a8,0xa0a121a822869ef1,0x132d23f31c6ea335,0x1bfea364a0112241,0x9cdca3e30f2e23f3
.quad 0x172a2400172aa3cd,0x204223359d49a3cd,0x9f58a3641cdc23cd,0xa1d0a1f720cf22c6,0x21f721a8a155a241,0x23002042a286a0fd,0xa3799e1f234d1ef1,0xa3bf9c6e239f1d49
.quad 0x24008000a4008000,0x24008000a4008000,0xa3791e1f234d9ef1,0xa3bf1c6e239f9d49,0x21f7a1a8a1552241,0x2300a042a28620fd,0x9f5823641cdca3cd,0xa1d021f720cfa2c6
.quad 0x172aa400172a23cd,0x2042a3359d4923cd,0x1bfe2364a011a241,0x9cdc23e30f2ea3f3,0xa0a1a1a822861ef1,0x132da3f31c6e2335,0x22a71e1fa3d98000,0x1a3e2364a072a1a8
.quad 0x1ef123cd8000a3cd,0x23cd1ef1a241a241,0xa072a3641a3e2400,0xa3d99e1f22a721a8,0x215522c69e1fa3cd,0x23e31d49a300a0fd,0xa21da1f720722335,0xa3ec9c6e234d2042
.quad 0x22c620fda1a8a241,0x23f31b1fa38d9ef1,0xa34d9fbd22a720fd,0xa3f9995c23bf1d49,0x23b01d49a3649ef1,0x23fd172aa3e39b1f,0xa3ec995c23d91b1f,0xa3ff932d23f9172a
.quad 0x24008000a4008000,0x24008000a4008000,0xa3ec195c23d99b1f,0xa3ff132d23f9972a,0x23b09d49a3641ef1,0x23fd972aa3e31b1f,0xa34d1fbd22a7a0fd,0xa3f9195c23bf9d49
.quad 0x22c6a0fda1a82241,0x23f39b1fa38d1ef1,0xa21d21f72072a335,0xa3ec1c6e234da042,0x2155a2c69e1f23cd,0x23e39d49a30020fd,0xa07223641a3ea400,0xa3d91e1f22a7a1a8
.quad 0x22419ef1a3cd8000,0x8000a3cd9ef12241,0xa2a71e1f23d98000,0x9a3e23642072a1a8,0x23009d49a3e38000,0x1e1fa2c6a15520fd,0xa34d1c6e23ec8000,0xa07221f7221da042
.quad 0x238d9b1fa3f38000,0x21a8a0fda2c61ef1,0xa3bf195c23f98000,0xa2a71fbd234d9d49,0x23e3972aa3fd8000,0x23649d49a3b01b1f,0xa3f9132d23ff8000,0xa3d9195c23ec972a
.quad 0x24008000a4008000,0x24008000a4008000,0xa3f9932d23ff8000,0xa3d9995c23ec172a,0x23e3172aa3fd8000,0x23641d49a3b09b1f,0xa3bf995c23f98000,0xa2a79fbd234d1d49
.quad 0x238d1b1fa3f38000,0x21a820fda2c69ef1,0xa34d9c6e23ec8000,0xa072a1f7221d2042,0x23001d49a3e38000,0x1e1f22c6a155a0fd,0xa2a79e1f23d98000,0x9a3ea364207221a8
.quad 0xa241a2411ef123cd,0xa3cd800023cd1ef1,0x207223649a3ea400,0x23d91e1fa2a7a1a8,0x9c6ea3f3932d23cd,0xa286a1a820a12335,0x8f2e23e31cdca335,0x201123649bfea3f3
.quad 0x1d49a335a0422241,0x972aa400972a23cd,0xa0cf21f721d0a0fd,0x9cdc23641f58a2c6,0x2286a042a3001ef1,0x2155a1a8a1f720fd,0xa39f1c6e23bf9b1f,0xa34d1e1f23799d49
.quad 0x24008000a4008000,0x24008000a4008000,0xa39f9c6e23bf1b1f,0xa34d9e1f23791d49,0x22862042a3009ef1,0x215521a8a1f7a0fd,0xa0cfa1f721d020fd,0x9cdca3641f5822c6
.quad 0x1d492335a042a241,0x972a2400972aa3cd,0x8f2ea3e31cdc2335,0x2011a3649bfe23f3,0x9c6e23f3932da3cd,0xa28621a820a1a335,0x2072a3649a3e2400,0x23d99e1fa2a721a8
.quad 0x9ef1224122419ef1,0x1ef123cd8000a3cd,0x22a79e1fa3d98000,0x1a3ea364a07221a8,0xa3fd972a23b01ef1,0xa1f7204223649b1f,0x231c20a1a1d0a241,0x23f9132da3d99d49
.quad 0xa042a3351d4923cd,0xa2c6a0fd21a82241,0xf2e23fd1879a3cd,0x1db523b09a3ea3f3,0x1fbda2c6a0a12241,0x1c6ea38d9e1f2335,0xa2e41fbd231c9ef1,0xa26420a122a7a042
.quad 0x24008000a4008000,0x24008000a4008000,0xa2e49fbd231c1ef1,0xa264a0a122a72042,0x1fbd22c6a0a1a241,0x1c6e238d9e1fa335,0xf2ea3fd187923cd,0x1db5a3b09a3e23f3
.quad 0xa04223351d49a3cd,0xa2c620fd21a8a241,0x231ca0a1a1d02241,0x23f9932da3d91d49,0xa3fd172a23b09ef1,0xa1f7a04223641b1f,0x22a71e1fa3d98000,0x1a3e2364a072a1a8
.quad 0x23cd1ef1a241a241,0x22419ef1a3cd8000,0xa072a3641a3e2400,0xa3d99e1f22a721a8,0x995c238d1fbda241,0x1fbd238d995ca400,0x22649fbda3791b1f,0x1db5a300a0cf21a8
.quad 0xa3f39b1f238d1ef1,0xa38d1b1f23f38000,0x21292286a011a335,0x22e420a1a21da1a8,0x132da3f3995c23cd,0x995ca3f3132d2400,0xa1d02155221da0fd,0xa12921f7217fa1a8
.quad 0x24008000a4008000,0x24008000a4008000,0xa1d0a155221d20fd,0xa129a1f7217f21a8,0x132d23f3995ca3cd,0x995c23f3132da400,0x2129a286a0112335,0x22e4a0a1a21d21a8
.quad 0xa3f31b1f238d9ef1,0xa38d9b1f23f38000,0x22641fbda3799b1f,0x1db52300a0cfa1a8,0x995ca38d1fbd2241,0x1fbda38d995c2400,0xa07223641a3ea400,0xa3d91e1f22a7a1a8
.quad 0x8000a3cd9ef12241,0xa241a2411ef123cd,0xa2a71e1f23d98000,0x9a3e23642072a1a8,0x23642042a1f7a241,0x23b0972aa3fd9b1f,0x9a3ea3fd956123cd,0xa17fa2861f58238d
.quad 0xa1a820fd22c69ef1,0x9d4923352042a241,0x23d91c6ea3799ef1,0x23ec932da3ff972a,0x9e1fa38d1c6e23cd,0xa0a1a2c61fbd2335,0xa072228620cfa241,0x9f5823002011a2c6
.quad 0x24008000a4008000,0x24008000a4008000,0xa072a28620cf2241,0x9f58a300201122c6,0x9e1f238d1c6ea3cd,0xa0a122c61fbda335,0x23d99c6ea3791ef1,0x23ec132da3ff172a
.quad 0xa1a8a0fd22c61ef1,0x9d49a33520422241,0x9a3e23fd9561a3cd,0xa17f22861f58a38d,0x2364a042a1f72241,0x23b0172aa3fd1b1f,0xa2a79e1f23d98000,0x9a3ea364207221a8
.quad 0xa3cd800023cd1ef1,0x9ef1224122419ef1,0x207223649a3ea400,0x23d91e1fa2a7a1a8,0x20a1a1a8a2861ef1,0x932da3f39c6e2335,0xa3bf9e1f22e420fd,0xa39f195c23ff172a
.quad 0x172a2400172aa3cd,0x204223359d49a3cd,0x231c9e1fa39f1b1f,0x217fa155a2642042,0xa1f7a1a821552241,0xa300a042228620fd,0x9db523641e89a335,0x9bfe23b01cdca38d
.quad 0x24008000a4008000,0x24008000a4008000,0x9db5a3641e892335,0x9bfea3b01cdc238d,0xa1f721a82155a241,0xa30020422286a0fd,0x231c1e1fa39f9b1f,0x217f2155a264a042
.quad 0x172aa400172a23cd,0x2042a3359d4923cd,0xa3bf1e1f22e4a0fd,0xa39f995c23ff972a,0x20a121a8a2869ef1,0x932d23f39c6ea335,0x2072a3649a3e2400,0x23d99e1fa2a721a8
.quad 0x1ef123cd8000a3cd,0x23cd1ef1a241a241,0x22a79e1fa3d98000,0x1a3ea364a07221a8,0xa155a2c61e1f23cd,0xa3e39d49230020fd,0xa129215522a79ef1,0x987923b01e89a2c6
.quad 0x22c620fda1a8a241,0x23f31b1fa38d9ef1,0x1e89a300a0722241,0x1561a3e39bfe238d,0xa3b09d4923641ef1,0xa3fd972a23e31b1f,0x987923e31a3ea3cd,0x8f2e23fd1561a3f3
.quad 0x24008000a4008000,0x24008000a4008000,0x9879a3e31a3e23cd,0x8f2ea3fd156123f3,0xa3b01d4923649ef1,0xa3fd172a23e39b1f,0x1e892300a072a241,0x156123e39bfea38d
.quad 0x22c6a0fda1a82241,0x23f39b1fa38d1ef1,0xa129a15522a71ef1,0x9879a3b01e8922c6,0xa15522c61e1fa3cd,0xa3e31d492300a0fd,0x22a71e1fa3d98000,0x1a3e2364a072a1a8
.quad 0x22419ef1a3cd8000,0x8000a3cd9ef12241,0xa072a3641a3e2400,0xa3d99e1f22a721a8,0xa3001d4923e38000,0x9e1f22c62155a0fd,0x1e8923b09879a400,0x22a72155a129a2c6
.quad 0x238d9b1fa3f38000,0x21a8a0fda2c61ef1,0x9bfea3e315612400,0xa072a3001e89238d,0xa3e3172a23fd8000,0xa3641d4923b09b1f,0x156123fd8f2ea400,0x1a3e23e39879a3f3
.quad 0x24008000a4008000,0x24008000a4008000,0x1561a3fd8f2e2400,0x1a3ea3e3987923f3,0xa3e3972a23fd8000,0xa3649d4923b01b1f,0x9bfe23e31561a400,0xa07223001e89a38d
.quad 0x238d1b1fa3f38000,0x21a820fda2c69ef1,0x1e89a3b098792400,0x22a7a155a12922c6,0xa3009d4923e38000,0x9e1fa2c6215520fd,0xa07223641a3ea400,0xa3d91e1f22a7a1a8
.quad 0xa241a2411ef123cd,0xa3cd800023cd1ef1,0xa2a71e1f23d98000,0x9a3e23642072a1a8,0x1c6e23f3132da3cd,0x228621a8a0a1a335,0x23ff195ca39f9ef1,0x22e49e1fa3bf172a
.quad 0x1d49a335a0422241,0x972aa400972a23cd,0xa264a155217f2241,0xa39f9e1f231c2042,0xa286204223009ef1,0xa15521a821f7a0fd,0x1cdc23b09bfea3cd,0x1e8923649db5a38d
.quad 0x24008000a4008000,0x24008000a4008000,0x1cdca3b09bfe23cd,0x1e89a3649db5238d,0xa286a04223001ef1,0xa155a1a821f720fd,0xa2642155217fa241,0xa39f1e1f231ca042
.quad 0x1d492335a042a241,0x972a2400972aa3cd,0x23ff995ca39f1ef1,0x22e41e1fa3bf972a,0x1c6ea3f3132d23cd,0x2286a1a8a0a12335,0xa2a79e1f23d98000,0x9a3ea364207221a8
.quad 0x9ef1224122419ef1,0x1ef123cd8000a3cd,0x207223649a3ea400,0x23d91e1fa2a7a1a8,0x23fd172aa3b09ef1,0x21f7a042a3641b1f,0x1f58a286a17f20fd,0x9561a3fd9a3e238d
.quad 0xa042a3351d4923cd,0xa2c6a0fd21a82241,0xa3ff932d23ec1b1f,0xa3791c6e23d9972a,0x9fbd22c620a1a241,0x9c6e238d1e1fa335,0x201123009f58a335,0x20cf2286a072a2c6
.quad 0x24008000a4008000,0x24008000a4008000,0x2011a3009f582335,0x20cfa286a07222c6,0x9fbda2c620a12241,0x9c6ea38d1e1f2335,0xa3ff132d23ec9b1f,0xa3799c6e23d9172a
.quad 0xa04223351d49a3cd,0xa2c620fd21a8a241,0x1f582286a17fa0fd,0x956123fd9a3ea38d,0x23fd972aa3b01ef1,0x21f72042a3649b1f,0x2072a3649a3e2400,0x23d99e1fa2a721a8
.quad 0x23cd1ef1a241a241,0x22419ef1a3cd8000,0x22a79e1fa3d98000,0x1a3ea364a07221a8,0x195ca38d9fbd2241,0x9fbda38d195c2400,0xa0cfa3001db523cd,0xa3799fbd226421a8
.quad 0xa3f39b1f238d1ef1,0xa38d1b1f23f38000,0xa21d20a122e49ef1,0xa01122862129a1a8,0x932d23f3195ca3cd,0x195c23f3932da400,0x217f21f7a129a241,0x221d2155a1d0a1a8
.quad 0x24008000a4008000,0x24008000a4008000,0x217fa1f7a1292241,0x221da155a1d021a8,0x932da3f3195c23cd,0x195ca3f3932d2400,0xa21da0a122e41ef1,0xa011a286212921a8
.quad 0xa3f31b1f238d9ef1,0xa38d9b1f23f38000,0xa0cf23001db5a3cd,0xa3791fbd2264a1a8,0x195c238d9fbda241,0x9fbd238d195ca400,0x22a71e1fa3d98000,0x1a3e2364a072a1a8
.quad 0x8000a3cd9ef12241,0xa241a2411ef123cd,0xa072a3641a3e2400,0xa3d99e1f22a721a8,0xa364a04221f72241,0xa3b0172a23fd1b1f,0xa3d9132d23f91b1f,0xa1d020a1231c9d49
.quad 0xa1a820fd22c69ef1,0x9d4923352042a241,0x9a3e23b01db5a335,0x187923fd0f2ea3f3,0x1e1f238d9c6ea3cd,0x20a122c69fbda335,0x22a720a1a264a0fd,0x231c1fbda2e4a042
.quad 0x24008000a4008000,0x24008000a4008000,0x22a7a0a1a26420fd,0x231c9fbda2e42042,0x1e1fa38d9c6e23cd,0x20a1a2c69fbd2335,0x9a3ea3b01db52335,0x1879a3fd0f2e23f3
.quad 0xa1a8a0fd22c61ef1,0x9d49a33520422241,0xa3d9932d23f99b1f,0xa1d0a0a1231c1d49,0xa364204221f7a241,0xa3b0972a23fd9b1f,0xa07223641a3ea400,0xa3d91e1f22a7a1a8
.quad 0xa3cd800023cd1ef1,0x9ef1224122419ef1,0xa2a71e1f23d98000,0x9a3e23642072a1a8,0xa0a121a822869ef1,0x132d23f31c6ea335,0x9bfe23642011a241,0x1cdc23e38f2ea3f3
.quad 0x172a2400172aa3cd,0x204223359d49a3cd,0x1f5823649cdca3cd,0x21d021f7a0cfa2c6,0x21f721a8a155a241,0x23002042a286a0fd,0x23791e1fa34d9ef1,0x23bf1c6ea39f9d49
.quad 0x24008000a4008000,0x24008000a4008000,0x23799e1fa34d1ef1,0x23bf9c6ea39f1d49,0x21f7a1a8a1552241,0x2300a042a28620fd,0x1f58a3649cdc23cd,0x21d0a1f7a0cf22c6
.quad 0x172aa400172a23cd,0x2042a3359d4923cd,0x9bfea36420112241,0x1cdca3e38f2e23f3,0xa0a1a1a822861ef1,0x132da3f31c6e2335,0xa2a79e1f23d98000,0x9a3ea364207221a8
.quad 0x1ef123cd8000a3cd,0x23cd1ef1a241a241,0x207223649a3ea400,0x23d91e1fa2a7a1a8,0x215522c69e1fa3cd,0x23e31d49a300a0fd,0x221d21f7a072a335,0x23ec1c6ea34da042
.quad 0x22c620fda1a8a241,0x23f31b1fa38d9ef1,0x234d1fbda2a7a0fd,0x23f9195ca3bf9d49,0x23b01d49a3649ef1,0x23fd172aa3e39b1f,0x23ec195ca3d99b1f,0x23ff132da3f9972a
.quad 0x24008000a4008000,0x24008000a4008000,0x23ec995ca3d91b1f,0x23ff932da3f9172a,0x23b09d49a3641ef1,0x23fd972aa3e31b1f,0x234d9fbda2a720fd,0x23f9995ca3bf1d49
.quad 0x22c6a0fda1a82241,0x23f39b1fa38d1ef1,0x221da1f7a0722335,0x23ec9c6ea34d2042,0x2155a2c69e1f23cd,0x23e39d49a30020fd,0x2072a3649a3e2400,0x23d99e1fa2a721a8
.quad 0x20fda3359b1f2400,0x24009b1fa33520fd,0x217fa3009bfe2400,0x23d9932da39f2042,0x21f7a2c69c6e2400,0x2364172aa3e31ef1,0x2264a2869cdc2400,0x22a71c6ea3ff1d49
.quad 0x22c6a2419d492400,0x21a81ef1a3f31b1f,0x231ca1f79db52400,0x207220a1a3bf172a,0x2364a1a89e1f2400,0x1e1f21a8a3640000,0x239fa1559e892400,0x1a3e2286a2e4972a
.quad 0x23cda0fd9ef12400,0x2335a2419b1f,0x23eca0a19f582400,0x9a3e23b0a17f9d49,0x23fda0429fbd2400,0x9e1f23f3a0a19ef1,0x23ff9fbda0112400,0xa07223fd9f58a042
.quad 0x23f39ef1a0422400,0xa1a823cd9d49a0fd,0x23d99e1fa0722400,0xa2a723649a3ea1a8,0x23b09d49a0a12400,0xa36422c6932da241,0x23799c6ea0cf2400,0xa3d921f71561a2c6
.quad 0x20fd20fda3359b1f,0x9b1f24009b1fa335,0x1db52286a21d9ef1,0xa0cf23641879a3f3,0x132d238da0a1a0fd,0xa30021a81fbda3cd,0x9bfe23fd9db5a241,0xa3f91e1f221da2c6
.quad 0xa04223cd972aa335,0xa38d0000238da0fd,0xa21d23001879a3cd,0xa1d09e1f23ff9d49,0xa36421a81e1fa400,0x9e1fa1a823648000,0xa3f91fbd20cfa3cd,0xf2ea36421d01d49
.quad 0xa3cd1b1f2241a335,0x1ef1a4001ef120fd,0xa2e4932d234da241,0x221da364156122c6,0xa1559d4923e3a0fd,0x23b0a1a89c6e23cd,0x9e89a0a123f99ef1,0x23ec9e1fa0cf23f3
.quad 0x972aa241238d9b1f,0x22c68000a2c62335,0x1a3ea36422a78000,0x20721e1fa3d921a8,0x1fbda3f321551b1f,0x195c21a8a3e31ef1,0x21d0a3e31f581ef1,0x9bfe2364a2e4172a
.quad 0xa33520fd20fda335,0xa3359b1f24009b1f,0xa3f9195c234da0fd,0x9f58a1f722a71d49,0xa2869d4923fd9b1f,0x195ca3f31e1f2241,0x9e89a1f722e41b1f,0x21d0a3009a3e23f3
.quad 0x172aa3cd204220fd,0x23f39ef1a1a82335,0x20cfa3b015612335,0x22e4195ca3d92042,0x2364a1a89e1f2400,0x1e1f21a8a3640000,0x23ec9c6ea21d2335,0x9bfe23e3a072a042
.quad 0x22411b1fa3cd20fd,0xa24123358000a335,0x1db52155a3bf1b1f,0xa3ff1fbd2072a3f3,0x995c238da1f79b1f,0xa286972a2364a241,0xa12923e39db5a0fd,0x9cdca15523d99d49
.quad 0xa38d2241172aa335,0x1d49a3cd21a81b1f,0xa3d91e1f2072a400,0x22a7a3641a3e21a8,0xa1f7972a2300a335,0x23fda0429e1f23cd,0x9cdca0a123ffa0fd,0x221d132da2a7238d
.quad 0x9b1fa33520fd20fd,0x20fda3359b1f2400,0x2011a3b08f2e23cd,0x23ff9c6ea2e421a8,0x23b0a042a1552335,0x21552042a3b00000,0x231c195ca3ec1ef1,0x987923e39f58a1a8
.quad 0x1d492241a2c69b1f,0xa2c622411d49a400,0x9e8923fd9cdca241,0xa39f132d234da1a8,0xa36421a81e1fa400,0x9e1fa1a823648000,0xa379132d231ca241,0x1f58a3fd1db521a8
.quad 0x9ef1a0fd23cd9b1f,0x23cda0fd9ef12400,0x1cdca3e320cf1ef1,0x2264195ca39f21a8,0x2300a2c6932d2335,0x132d22c6a3000000,0x23bf9c6ea17f23cd,0xa1d023b09bfea1a8
.quad 0x20421ef1a3f320fd,0xa3f31ef12042a400,0x9a3e2364a2a70000,0xa0729e1f23d9a1a8,0xa286238d9c6ea0fd,0x1c6ea38d22868000,0xa3ec1fbd1e89a3cd,0x234da300187921a8
.quad 0x24009b1fa33520fd,0x20fd20fda3359b1f,0x20722155a31c9b1f,0x9e8923e39561a38d,0x9e1f23f3995ca335,0xa3fd1d492286a241,0xa3d91fbd217fa335,0xa011a155234d172a
.quad 0xa1a89ef123f39b1f,0x2042a3cd172a2335,0x1a3ea3e3201120fd,0x23f99c6ea26422c6,0x2364a1a89e1f2400,0x1e1f21a8a3640000,0x22a7195ca3bf20fd,0xa12923b09879a2c6
.quad 0x2335a2419b1f,0xa3cd1b1f2241a335,0xa2a723000f2ea335,0x9bfea1f72379972a,0xa364172a2286a335,0x21f7a38d195c2241,0x9a3ea1f7239f9b1f,0x2379995ca21d238d
.quad 0x21a8a3cd1d4920fd,0x172a2241a38d1b1f,0x23d99e1fa0722400,0xa2a723649a3ea1a8,0x1e1f2042a3fd20fd,0xa300172a21f7a3cd,0xa07223fda1299b1f,0xf2ea286239f9d49
.quad 0x9b1f24009b1fa335,0xa33520fd20fda335,0xa3ec1e1f2264a241,0xa129a0a12379172a,0x9fbda1a823001b1f,0x20a1a38d932d23cd,0x2129a364956123cd,0x2379132da3bf2042
.quad 0x238d8000a38d20fd,0x972a23cda042a0fd,0xf2e2364a17f9ef1,0xa3ec1fbd2129a38d,0xa36421a81e1fa400,0x9e1fa1a823648000,0xa17f9e1f23ff9ef1,0x2264a3009561238d
.quad 0x1ef1a4001ef120fd,0x22411b1fa3cd20fd,0x23f99e1fa12923cd,0x9e8923fda011a042,0x1c6e21a8a3b01b1f,0xa3e31d492155a3cd,0xa26423649879a241,0x9561a286234d972a
.quad 0xa2c6000022c6a335,0x238da241972a2335,0x1a3ea36422a78000,0x20721e1fa3d921a8,0x23e3a1a8995c2335,0xa15523f39fbd9ef1,0x20111e1fa3bf2241,0xa31c195c217fa3f3
.quad 0xa3359b1f24009b1f,0x9b1fa33520fd20fd,0x1cdca3fd1a3e2335,0x23bf9fbda1d022c6,0x23e3972aa36420fd,0x1c6e22c6a1f79ef1,0x8f2e23b0a072a0fd,0xa39f20a120cfa38d
.quad 0xa3f31ef121a8a335,0x9d49a24122c61b1f,0x9bfea28622a71b1f,0x2379a1559f5823f3,0x2364a1a89e1f2400,0x1e1f21a8a3640000,0x201120a1a3d91b1f,0xa34d21f71cdca3f3
.quad 0xa24123358000a335,0x9ef1a0fd23cd9b1f,0xa1d09c6e23d9a0fd,0x231ca2869879238d,0x20a1a3f31e1f20fd,0x1fbd2042a3fd1ef1,0x231c932da2a72335,0xa2e423008f2ea2c6
.quad 0x9d4923cda1a89b1f,0xa0429ef123f3a0fd,0xa3d91e1f2072a400,0x22a7a3641a3e21a8,0x132da2c623649b1f,0x20a11d49a3b02241,0x23f9a1559a3e2335,0xa26423b09db5a042
.quad 0x20fda3359b1f2400,0x24009b1fa33520fd,0x21d01fbda3bf0000,0x9a3e23fd9cdca2c6,0xa1f722c61c6ea400,0xa364972a23e39ef1,0xa0cfa0a1239f8000,0x2072a3b00f2e238d
.quad 0x22c6a2419d492400,0x21a81ef1a3f31b1f,0x1f582155a3790000,0xa2a722861bfea3f3,0xa36421a81e1fa400,0x9e1fa1a823648000,0x9cdca1f7234d8000,0x23d9a0a1a01123f3
.quad 0x23cda0fd9ef12400,0x2335a2419b1f,0x18792286a31c0000,0xa3d91c6e21d0a38d,0xa3fd20421fbda400,0x1e1fa3f320a11ef1,0xf2ea30022e48000,0x22a7132da31c22c6
.quad 0x23f39ef1a0422400,0xa1a823cd9d49a0fd,0x9a3e2364a2a70000,0xa0729e1f23d9a1a8,0xa3b01d4920a1a400,0x2364a2c6132d2241,0x1db5a3b022648000,0x1a3e2155a3f92042
.quad 0x20fd20fda3359b1f,0x9b1f24009b1fa335,0xa37920a12129a335,0xa2649e1f23ec972a,0x932da38d20a120fd,0x2300a1a89fbd23cd,0x23bf932da37920fd,0x15612364a129a042
.quad 0xa04223cd972aa335,0xa38d0000238da0fd,0xa1299fbd23ec9b1f,0x217fa3648f2e238d,0x2364a1a89e1f2400,0x1e1f21a8a3640000,0x15612300a2649b1f,0xa3ff1e1f217fa38d
.quad 0xa3cd1b1f2241a335,0x1ef1a4001ef120fd,0x2011a3fd1e8920fd,0x21291e1fa3f92042,0x21551d49a3e320fd,0xa3b021a81c6ea3cd,0xa34d22861561a335,0x1879a3642264172a
.quad 0x972aa241238d9b1f,0x22c68000a2c62335,0x23d99e1fa0722400,0xa2a723649a3ea1a8,0x9fbd23f3a1559b1f,0x995ca1a823e39ef1,0xa17f995c231ca335,0x23bf9e1fa01123f3
.quad 0xa33520fd20fda335,0xa3359b1f24009b1f,0x1561a3e31e892241,0x231ca155a072238d,0x22861d49a3fd1b1f,0x995c23f39e1fa241,0xa34d21552011a3cd,0xa17f9fbd23d9972a
.quad 0x172aa3cd204220fd,0x23f39ef1a1a82335,0x22641c6ea3f91ef1,0xa01123e39a3ea2c6,0xa36421a81e1fa400,0x9e1fa1a823648000,0x1879a3b021291ef1,0x23bf995ca2a722c6
.quad 0x22411b1fa3cd20fd,0xa24123358000a335,0xa37921f71bfea3cd,0x8f2ea30022a7172a,0x195ca38d21f71b1f,0x2286172aa3642241,0x221d195ca3792241,0xa39f21f71a3ea38d
.quad 0xa38d2241172aa335,0x1d49a3cd21a81b1f,0x1a3ea36422a78000,0x20721e1fa3d921a8,0x21f7172aa3002335,0xa3fd20421e1fa3cd,0xa39f22868f2ea241,0x2129a3fd20721d49
.quad 0x9b1fa33520fd20fd,0x20fda3359b1f2400,0x22e41c6ea3ff1b1f,0xf2e23b0a011a1a8,0xa3b020422155a335,0xa155a04223b08000,0x1f58a3e318792335,0x23ec995ca31c21a8
.quad 0x1d492241a2c69b1f,0xa2c622411d49a400,0xa34d932d239fa0fd,0x1cdca3fd1e8921a8,0x2364a1a89e1f2400,0x1e1f21a8a3640000,0x9db523fd9f58a0fd,0xa31c932d2379a1a8
.quad 0x9ef1a0fd23cd9b1f,0x23cda0fd9ef12400,0x239f995ca2642335,0xa0cf23e39cdca1a8,0xa30022c6132da335,0x932da2c623008000,0x1bfea3b021d01b1f,0x217f1c6ea3bf21a8
.quad 0x20421ef1a3f320fd,0xa3f31ef12042a400,0xa3d91e1f2072a400,0x22a7a3641a3e21a8,0x2286a38d1c6e20fd,0x9c6e238da2860000,0x98792300a34d1b1f,0x9e899fbd23eca1a8
.quad 0x24009b1fa33520fd,0x20fd20fda3359b1f,0xa2a721f71f58a3cd,0xa34d995c23f99d49,0x1e1fa3f3195c2335,0x23fd9d49a2862241,0x1a3e2300a1d09ef1,0xa2e421f71e89a3f3
.quad 0xa1a89ef123f39b1f,0x2042a3cd172a2335,0x23d9995ca2e42241,0x956123b0a0cfa042,0xa36421a81e1fa400,0x9e1fa1a823648000,0x2072a3e31bfe2241,0x221d1c6ea3ec2042
.quad 0x2335a2419b1f,0xa3cd1b1f2241a335,0xa0729fbd23ff9ef1,0x23bfa1559db523f3,0x2364972aa2862335,0xa1f7238d995ca241,0xa3d921551cdca3cd,0x1db5a3e321291d49
.quad 0x21a8a3cd1d4920fd,0x172a2241a38d1b1f,0x9a3e2364a2a70000,0xa0729e1f23d9a1a8,0x9e1fa04223fda0fd,0x2300972aa1f723cd,0x22a7932da21d23cd,0xa3ff20a11cdca38d
.quad 0x9b1f24009b1fa335,0xa33520fd20fda335,0x9879a36420cf20fd,0x221da2869db523f3,0x1fbd21a8a3009b1f,0xa0a1238d132da3cd,0xa21d9e1f23f99b1f,0x1db5a3fd1bfe22c6
.quad 0x238d8000a38d20fd,0x972a23cda042a0fd,0xa3ff1e1f21d0a335,0x9879a300221d1d49,0x2364a1a89e1f2400,0x1e1f21a8a3640000,0xa1d023648f2ea335,0xa0cf9fbd23f99d49
.quad 0x1ef1a4001ef120fd,0x22411b1fa3cd20fd,0x95612364a21d9b1f,0xa34d132d22e4a2c6,0x9c6ea1a823b09b1f,0x23e39d49a15523cd,0x20cf1e1fa3ec20fd,0xa3f920a11e89a3f3
.quad 0xa2c6000022c6a335,0x238da241972a2335,0x23d99e1fa0722400,0xa2a723649a3ea1a8,0xa3e321a8195ca335,0x2155a3f31fbd1ef1,0x22e4a3641bfe20fd,0x9f5823e3a1d0972a
.quad 0xa3359b1f24009b1f,0x9b1fa33520fd20fd,0x239f132da3d91ef1,0x1bfe2300a17fa042,0xa3e3172a2364a0fd,0x9c6ea2c621f71ef1,0x23ff9c6ea2a72241,0x1cdc2286a2649d49
.quad 0xa3f31ef121a8a335,0x9d49a24122c61b1f,0x23bfa0a1a07223cd,0x1db521f7a31c972a,0xa36421a81e1fa400,0x9e1fa1a823648000,0x22e4a2869a3e23cd,0x1e892155a39f172a
.quad 0xa24123358000a335,0x9ef1a0fd23cd9b1f,0x217fa3b01a3e2241,0x1f5820a1a3ec1d49,0xa0a123f39e1fa0fd,0x9fbda04223fd9ef1,0x1f58a3fd20721ef1,0x20111fbda3ff2042
.quad 0x9d4923cda1a89b1f,0xa0429ef123f3a0fd,0x1a3ea36422a78000,0x20721e1fa3d921a8,0x932d22c6a3641b1f,0xa0a19d4923b0a241,0x9561a1f723d99ef1,0x20cf1c6ea37922c6
.quad 0x20fda3359b1f2400,0x24009b1fa33520fd,0xa17f23001bfea400,0xa3d9132d239fa042,0x21f7a2c69c6e2400,0x2364172aa3e31ef1,0xa26422861cdca400,0xa2a79c6e23ff9d49
.quad 0x22c6a2419d492400,0x21a81ef1a3f31b1f,0xa31c21f71db5a400,0xa072a0a123bf972a,0x2364a1a89e1f2400,0x1e1f21a8a3640000,0xa39f21551e89a400,0x9a3ea28622e4172a
.quad 0x23cda0fd9ef12400,0x2335a2419b1f,0xa3ec20a11f58a400,0x1a3ea3b0217f1d49,0x23fda0429fbd2400,0x9e1f23f3a0a19ef1,0xa3ff1fbd2011a400,0x2072a3fd1f582042
.quad 0x23f39ef1a0422400,0xa1a823cd9d49a0fd,0xa3d91e1f2072a400,0x22a7a3641a3e21a8,0x23b09d49a0a12400,0xa36422c6932da241,0xa3791c6e20cfa400,0x23d9a1f7956122c6
.quad 0x20fd20fda3359b1f,0x9b1f24009b1fa335,0x9db5a286221d1ef1,0x20cfa364987923f3,0x132d238da0a1a0fd,0xa30021a81fbda3cd,0x1bfea3fd1db52241,0x23f99e1fa21d22c6
.quad 0xa04223cd972aa335,0xa38d0000238da0fd,0x221da300987923cd,0x21d01e1fa3ff1d49,0xa36421a81e1fa400,0x9e1fa1a823648000,0x23f99fbda0cf23cd,0x8f2e2364a1d09d49
.quad 0xa3cd1b1f2241a335,0x1ef1a4001ef120fd,0x22e4132da34d2241,0xa21d23649561a2c6,0xa1559d4923e3a0fd,0x23b0a1a89c6e23cd,0x1e8920a1a3f91ef1,0xa3ec1e1f20cfa3f3
.quad 0x972aa241238d9b1f,0x22c68000a2c62335,0x9a3e2364a2a70000,0xa0729e1f23d9a1a8,0x1fbda3f321551b1f,0x195c21a8a3e31ef1,0xa1d023e39f589ef1,0x1bfea36422e4972a
.quad 0xa33520fd20fda335,0xa3359b1f24009b1f,0x23f9995ca34d20fd,0x1f5821f7a2a79d49,0xa2869d4923fd9b1f,0x195ca3f31e1f2241,0x1e8921f7a2e49b1f,0xa1d023001a3ea3f3
.quad 0x172aa3cd204220fd,0x23f39ef1a1a82335,0xa0cf23b09561a335,0xa2e4995c23d9a042,0x2364a1a89e1f2400,0x1e1f21a8a3640000,0xa3ec1c6e221da335,0x1bfea3e320722042
.quad 0x22411b1fa3cd20fd,0xa24123358000a335,0x9db5a15523bf9b1f,0x23ff9fbda07223f3,0x995c238da1f79b1f,0xa286972a2364a241,0x2129a3e31db520fd,0x1cdc2155a3d91d49
.quad 0xa38d2241172aa335,0x1d49a3cd21a81b1f,0x23d99e1fa0722400,0xa2a723649a3ea1a8,0xa1f7972a2300a335,0x23fda0429e1f23cd,0x1cdc20a1a3ff20fd,0xa21d932d22a7a38d
.quad 0x9b1fa33520fd20fd,0x20fda3359b1f2400,0xa01123b00f2ea3cd,0xa3ff1c6e22e4a1a8,0x23b0a042a1552335,0x21552042a3b00000,0xa31c995c23ec9ef1,0x1879a3e31f5821a8
.quad 0x1d492241a2c69b1f,0xa2c622411d49a400,0x1e89a3fd1cdc2241,0x239f932da34d21a8,0xa36421a81e1fa400,0x9e1fa1a823648000,0x2379932da31c2241,0x9f5823fd9db5a1a8
.quad 0x9ef1a0fd23cd9b1f,0x23cda0fd9ef12400,0x9cdc23e3a0cf9ef1,0xa264995c239fa1a8,0x2300a2c6932d2335,0x132d22c6a3000000,0xa3bf1c6e217fa3cd,0x21d0a3b01bfe21a8
.quad 0x20421ef1a3f320fd,0xa3f31ef12042a400,0x1a3ea36422a78000,0x20721e1fa3d921a8,0xa286238d9c6ea0fd,0x1c6ea38d22868000,0x23ec9fbd9e8923cd,0xa34d23009879a1a8
.quad 0x24009b1fa33520fd,0x20fd20fda3359b1f,0xa072a155231c1b1f,0x1e89a3e31561238d,0x9e1f23f3995ca335,0xa3fd1d492286a241,0x23d99fbda17f2335,0x20112155a34d972a
.quad 0xa1a89ef123f39b1f,0x2042a3cd172a2335,0x9a3e23e3a011a0fd,0xa3f91c6e2264a2c6,0x2364a1a89e1f2400,0x1e1f21a8a3640000,0xa2a7995c23bfa0fd,0x2129a3b0187922c6
.quad 0x2335a2419b1f,0xa3cd1b1f2241a335,0x22a7a3008f2e2335,0x1bfe21f7a379172a,0xa364172a2286a335,0x21f7a38d195c2241,0x1a3e21f7a39f1b1f,0xa379195c221da38d
.quad 0x21a8a3cd1d4920fd,0x172a2241a38d1b1f,0xa3d91e1f2072a400,0x22a7a3641a3e21a8,0x1e1f2042a3fd20fd,0xa300172a21f7a3cd,0x2072a3fd21291b1f,0x8f2e2286a39f1d49
.quad 0x9b1f24009b1fa335,0xa33520fd20fda335,0x23ec9e1fa2642241,0x212920a1a379972a,0x9fbda1a823001b1f,0x20a1a38d932d23cd,0xa12923641561a3cd,0xa379932d23bfa042
.quad 0x238d8000a38d20fd,0x972a23cda042a0fd,0x8f2ea364217f1ef1,0x23ec9fbda129238d,0xa36421a81e1fa400,0x9e1fa1a823648000,0x217f1e1fa3ff1ef1,0xa26423001561a38d
.quad 0x1ef1a4001ef120fd,0x22411b1fa3cd20fd,0xa3f91e1f2129a3cd,0x1e89a3fd20112042,0x1c6e21a8a3b01b1f,0xa3e31d492155a3cd,0x2264a36418792241,0x15612286a34d172a
.quad 0xa2c6000022c6a335,0x238da241972a2335,0x9a3e2364a2a70000,0xa0729e1f23d9a1a8,0x23e3a1a8995c2335,0xa15523f39fbd9ef1,0xa0119e1f23bfa241,0x231c995ca17f23f3
.quad 0xa3359b1f24009b1f,0x9b1fa33520fd20fd,0x9cdc23fd9a3ea335,0xa3bf1fbd21d0a2c6,0x23e3972aa36420fd,0x1c6e22c6a1f79ef1,0xf2ea3b0207220fd,0x239fa0a1a0cf238d
.quad 0xa3f31ef121a8a335,0x9d49a24122c61b1f,0x1bfe2286a2a79b1f,0xa37921551f58a3f3,0x2364a1a89e1f2400,0x1e1f21a8a3640000,0xa011a0a123d99b1f,0x234da1f79cdc23f3
.quad 0xa24123358000a335,0x9ef1a0fd23cd9b1f,0x21d01c6ea3d920fd,0xa31c22861879a38d,0x20a1a3f31e1f20fd,0x1fbd2042a3fd1ef1,0xa31c132d22a7a335,0x22e4a3000f2e22c6
.quad 0x9d4923cda1a89b1f,0xa0429ef123f3a0fd,0x23d99e1fa0722400,0xa2a723649a3ea1a8,0x132da2c623649b1f,0x20a11d49a3b02241,0xa3f921551a3ea335,0x2264a3b01db52042
.quad 0x20fda3359b1f2400,0x24009b1fa33520fd,0xa1d09fbd23bf8000,0x1a3ea3fd1cdc22c6,0xa1f722c61c6ea400,0xa364972a23e39ef1,0x20cf20a1a39f0000,0xa07223b08f2ea38d
.quad 0x22c6a2419d492400,0x21a81ef1a3f31b1f,0x9f58a15523798000,0x22a7a2869bfe23f3,0xa36421a81e1fa400,0x9e1fa1a823648000,0x1cdc21f7a34d0000,0xa3d920a12011a3f3
.quad 0x23cda0fd9ef12400,0x2335a2419b1f,0x9879a286231c8000,0x23d99c6ea1d0238d,0xa3fd20421fbda400,0x1e1fa3f320a11ef1,0x8f2e2300a2e40000,0xa2a7932d231ca2c6
.quad 0x23f39ef1a0422400,0xa1a823cd9d49a0fd,0x1a3ea36422a78000,0x20721e1fa3d921a8,0xa3b01d4920a1a400,0x2364a2c6132d2241,0x9db523b0a2640000,0x9a3ea15523f9a042
.quad 0x20fd20fda3359b1f,0x9b1f24009b1fa335,0x2379a0a1a1292335,0x22641e1fa3ec172a,0x932da38d20a120fd,0x2300a1a89fbd23cd,0xa3bf132d2379a0fd,0x9561a36421292042
.quad 0xa04223cd972aa335,0xa38d0000238da0fd,0x21291fbda3ec1b1f,0xa17f23640f2ea38d,0x2364a1a89e1f2400,0x1e1f21a8a3640000,0x9561a30022641b1f,0x23ff9e1fa17f238d
.quad 0xa3cd1b1f2241a335,0x1ef1a4001ef120fd,0xa01123fd9e89a0fd,0xa1299e1f23f9a042,0x21551d49a3e320fd,0xa3b021a81c6ea3cd,0x234da28695612335,0x98792364a264972a
.quad 0x972aa241238d9b1f,0x22c68000a2c62335,0xa3d91e1f2072a400,0x22a7a3641a3e21a8,0x9fbd23f3a1559b1f,0x995ca1a823e39ef1,0x217f195ca31c2335,0xa3bf1e1f2011a3f3
.quad 0xa33520fd20fda335,0xa3359b1f24009b1f,0x956123e39e89a241,0xa31c21552072a38d,0x22861d49a3fd1b1f,0x995c23f39e1fa241,0x234da155a01123cd,0x217f1fbda3d9172a
.quad 0x172aa3cd204220fd,0x23f39ef1a1a82335,0xa2649c6e23f99ef1,0x2011a3e31a3e22c6,0xa36421a81e1fa400,0x9e1fa1a823648000,0x987923b0a1299ef1,0xa3bf195c22a7a2c6
.quad 0x22411b1fa3cd20fd,0xa24123358000a335,0x2379a1f79bfe23cd,0xf2e2300a2a7972a,0x195ca38d21f71b1f,0x2286172aa3642241,0xa21d995c2379a241,0x239fa1f79a3e238d
.quad 0xa38d2241172aa335,0x1d49a3cd21a81b1f,0x9a3e2364a2a70000,0xa0729e1f23d9a1a8,0x21f7172aa3002335,0xa3fd20421e1fa3cd,0x239fa2860f2e2241,0xa12923fda0729d49
.quad 0x9b1fa33520fd20fd,0x20fda3359b1f2400,0xa2e49c6e23ff9b1f,0x8f2ea3b0201121a8,0xa3b020422155a335,0xa155a04223b08000,0x9f5823e39879a335,0xa3ec195c231ca1a8
.quad 0x1d492241a2c69b1f,0xa2c622411d49a400,0x234d132da39f20fd,0x9cdc23fd9e89a1a8,0x2364a1a89e1f2400,0x1e1f21a8a3640000,0x1db5a3fd1f5820fd,0x231c132da37921a8
.quad 0x9ef1a0fd23cd9b1f,0x23cda0fd9ef12400,0xa39f195c2264a335,0x20cfa3e31cdc21a8,0xa30022c6132da335,0x932da2c623008000,0x9bfe23b0a1d09b1f,0xa17f9c6e23bfa1a8
.quad 0x20421ef1a3f320fd,0xa3f31ef12042a400,0x23d99e1fa0722400,0xa2a723649a3ea1a8,0x2286a38d1c6e20fd,0x9c6e238da2860000,0x1879a300234d9b1f,0x1e891fbda3ec21a8
.quad 0x24009b1fa33520fd,0x20fd20fda3359b1f,0x22a7a1f79f5823cd,0x234d195ca3f91d49,0x1e1fa3f3195c2335,0x23fd9d49a2862241,0x9a3ea30021d01ef1,0x22e4a1f79e8923f3
.quad 0xa1a89ef123f39b1f,0x2042a3cd172a2335,0xa3d9195c22e4a241,0x1561a3b020cf2042,0xa36421a81e1fa400,0x9e1fa1a823648000,0xa07223e39bfea241,0xa21d9c6e23eca042
.quad 0x2335a2419b1f,0xa3cd1b1f2241a335,0x20721fbda3ff1ef1,0xa3bf21551db5a3f3,0x2364972aa2862335,0xa1f7238d995ca241,0x23d9a1559cdc23cd,0x9db523e3a1299d49
.quad 0x21a8a3cd1d4920fd,0x172a2241a38d1b1f,0x1a3ea36422a78000,0x20721e1fa3d921a8,0x9e1fa04223fda0fd,0x2300972aa1f723cd,0xa2a7132d221da3cd,0x23ffa0a19cdc238d
.quad 0x9b1f24009b1fa335,0xa33520fd20fda335,0x18792364a0cfa0fd,0xa21d22861db5a3f3,0x1fbd21a8a3009b1f,0xa0a1238d132da3cd,0x221d1e1fa3f91b1f,0x9db523fd9bfea2c6
.quad 0x238d8000a38d20fd,0x972a23cda042a0fd,0x23ff9e1fa1d02335,0x18792300a21d9d49,0x2364a1a89e1f2400,0x1e1f21a8a3640000,0x21d0a3640f2e2335,0x20cf1fbda3f91d49
.quad 0x1ef1a4001ef120fd,0x22411b1fa3cd20fd,0x1561a364221d1b1f,0x234d932da2e422c6,0x9c6ea1a823b09b1f,0x23e39d49a15523cd,0xa0cf9e1f23eca0fd,0x23f9a0a19e8923f3
.quad 0xa2c6000022c6a335,0x238da241972a2335,0xa3d91e1f2072a400,0x22a7a3641a3e21a8,0xa3e321a8195ca335,0x2155a3f31fbd1ef1,0xa2e423649bfea0fd,0x1f58a3e321d0172a
.quad 0xa3359b1f24009b1f,0x9b1fa33520fd20fd,0xa39f932d23d99ef1,0x9bfea300217f2042,0xa3e3172a2364a0fd,0x9c6ea2c621f71ef1,0xa3ff1c6e22a7a241,0x9cdca28622641d49
.quad 0xa3f31ef121a8a335,0x9d49a24122c61b1f,0xa3bf20a12072a3cd,0x9db5a1f7231c172a,0xa36421a81e1fa400,0x9e1fa1a823648000,0xa2e422861a3ea3cd,0x9e89a155239f972a
.quad 0xa24123358000a335,0x9ef1a0fd23cd9b1f,0xa17f23b09a3ea241,0x9f58a0a123ec9d49,0xa0a123f39e1fa0fd,0x9fbda04223fd9ef1,0x9f5823fda0729ef1,0xa0119fbd23ffa042
.quad 0x9d4923cda1a89b1f,0xa0429ef123f3a0fd,0x9a3e2364a2a70000,0xa0729e1f23d9a1a8,0x932d22c6a3641b1f,0xa0a19d4923b0a241,0x156121f7a3d91ef1,0xa0cf9c6e2379a2c6
.quad 0x22411ef1a3cd8000,0x800023cd9ef1a241,0x21d01fbda3bf8000,0x9a3e23fd9cdca2c6,0x21552042a3b08000,0x9e1f23f3995ca335,0x20cf20a1a39f8000,0xa07223b08f2ea38d
.quad 0x204220fda38d8000,0xa1a82335172aa3cd,0x1f582155a3798000,0xa2a722861bfea3f3,0x1e1f21a8a3648000,0xa36421a81e1fa400,0x1cdc21f7a34d8000,0xa3d920a12011a3f3
.quad 0x1b1f2241a3358000,0xa4001ef120fda3cd,0x18792286a31c8000,0xa3d91c6e21d0a38d,0x132d22c6a3008000,0xa364172a2286a335,0x8f2e2300a2e48000,0xa2a7932d231ca2c6
.quad 0x972a2335a2c68000,0xa1a89b1f238da241,0x9a3e2364a2a78000,0xa0729e1f23d9a1a8,0x9c6e238da2868000,0x9e1fa04223fda0fd,0x9db523b0a2648000,0x9a3ea15523f9a042
.quad 0xa24122411ef1a3cd,0xa3cd800023cd9ef1,0xa37920a12129a335,0xa2649e1f23ec972a,0xa3fd1d492286a241,0x9fbda1a823001b1f,0xa3bf132d2379a0fd,0x9561a36421292042
.quad 0xa2c69b1f23f39ef1,0x1d49a4001d492241,0xa1299fbd23ec9b1f,0x217fa3648f2e238d,0x9e1fa1a823648000,0x2364a1a89e1f2400,0x9561a30022641b1f,0x23ff9e1fa17f238d
.quad 0x1b1fa3cd20fd1ef1,0x23358000a3352241,0x2011a3fd1e8920fd,0x21291e1fa3f92042,0x21f7a38d195c2241,0x1c6e21a8a3b01b1f,0x234da28695612335,0x98792364a264972a
.quad 0x23f3a0fd9d4923cd,0xa0422400a0429ef1,0x23d99e1fa0722400,0xa2a723649a3ea1a8,0x2300972aa1f723cd,0xa3e321a8195ca335,0x217f195ca31c2335,0xa3bf1e1f2011a3f3
.quad 0x9ef1a24122411ef1,0x1ef1a3cd800023cd,0x1561a3e31e892241,0x231ca155a072238d,0x20a1a38d932d23cd,0x23e3972aa36420fd,0x234da155a01123cd,0x217f1fbda3d9172a
.quad 0x23f39b1fa2c62241,0x172a2335a1a89ef1,0x22641c6ea3f91ef1,0xa01123e39a3ea2c6,0x1e1f21a8a3648000,0xa36421a81e1fa400,0x987923b0a1299ef1,0xa3bf195c22a7a2c6
.quad 0xa0fd23cd9b1fa241,0xa0fd9ef124009ef1,0xa37921f71bfea3cd,0x8f2ea30022a7172a,0xa3e31d492155a3cd,0x20a1a3f31e1f20fd,0xa21d995c2379a241,0x239fa1f79a3e238d
.quad 0x9d49a0fd23f39ef1,0x238d9b1fa1a823cd,0x1a3ea36422a78000,0x20721e1fa3d921a8,0x2155a3f31fbd1ef1,0x932d22c6a3641b1f,0x239fa2860f2e2241,0xa12923fda0729d49
.quad 0x23cd9ef1a2412241,0x22411ef1a3cd8000,0x22e41c6ea3ff1b1f,0xf2e23b0a011a1a8,0x1c6e22c6a1f79ef1,0xa1f722c61c6ea400,0x9f5823e39879a335,0xa3ec195c231ca1a8
.quad 0xa38d20fd2042a3cd,0xa042a0fd238d8000,0xa34d932d239fa0fd,0x1cdca3fd1e8921a8,0x9e1fa1a823648000,0x2364a1a89e1f2400,0x1db5a3fd1f5820fd,0x231c132da37921a8
.quad 0x2335a2419b1f23cd,0x1b1f2241a3358000,0x239f995ca2642335,0xa0cf23e39cdca1a8,0x1fbd2042a3fd1ef1,0xa3fd20421fbda400,0x9bfe23b0a1d09b1f,0xa17f9c6e23bfa1a8
.quad 0xa2c62335972aa241,0x172aa33522c68000,0xa3d91e1f2072a400,0x22a7a3641a3e21a8,0xa0a19d4923b0a241,0x23b09d49a0a12400,0x1879a300234d9b1f,0x1e891fbda3ec21a8
.quad 0x800023cd9ef1a241,0xa24122411ef1a3cd,0xa2a721f71f58a3cd,0xa34d995c23f99d49,0xa364972a23e39ef1,0x932da38d20a120fd,0x9a3ea30021d01ef1,0x22e4a1f79e8923f3
.quad 0x21a8a335972a23cd,0x22c61b1fa3f31ef1,0x23d9995ca2e42241,0x956123b0a0cfa042,0x1e1f21a8a3648000,0xa36421a81e1fa400,0xa07223e39bfea241,0xa21d9c6e23eca042
.quad 0xa4001ef120fda3cd,0x1b1fa3cd20fd1ef1,0xa0729fbd23ff9ef1,0x23bfa1559db523f3,0x1e1fa3f320a11ef1,0x21551d49a3e320fd,0x23d9a1559cdc23cd,0x9db523e3a1299d49
.quad 0x21a81b1fa38d2241,0xa3f320fd1d49a3cd,0x9a3e2364a2a78000,0xa0729e1f23d9a1a8,0xa36422c6932da241,0x1fbda3f321551b1f,0xa2a7132d221da3cd,0x23ffa0a19cdc238d
.quad 0xa3cd800023cd9ef1,0x9ef1a24122411ef1,0x9879a36420cf20fd,0x221da2869db523f3,0x2300a1a89fbd23cd,0x22861d49a3fd1b1f,0x221d1e1fa3f91b1f,0x9db523fd9bfea2c6
.quad 0x9d4924009d49a241,0xa3f31b1f22c6a241,0xa3ff1e1f21d0a335,0x9879a300221d1d49,0x9e1fa1a823648000,0x2364a1a89e1f2400,0x21d0a3640f2e2335,0x20cf1fbda3f91d49
.quad 0x23358000a3352241,0xa0fd23cd9b1fa241,0x95612364a21d9b1f,0xa34d132d22e4a2c6,0xa3b021a81c6ea3cd,0x195ca38d21f71b1f,0xa0cf9e1f23eca0fd,0x23f9a0a19e8923f3
.quad 0x2042a40020421ef1,0x1d4920fda3f31ef1,0x23d99e1fa0722400,0xa2a723649a3ea1a8,0x195c21a8a3e31ef1,0xa1f7972a2300a335,0xa2e423649bfea0fd,0x1f58a3e321d0172a
.quad 0x1ef1a3cd800023cd,0x23cd9ef1a2412241,0x239f132da3d91ef1,0x1bfe2300a17fa042,0x995c23f39e1fa241,0xa3b020422155a335,0xa3ff1c6e22a7a241,0x9cdca28622641d49
.quad 0x972aa33521a81ef1,0x238da0fda04223cd,0x23bfa0a1a07223cd,0x1db521f7a31c972a,0x1e1f21a8a3648000,0xa36421a81e1fa400,0xa2e422861a3ea3cd,0x9e89a155239f972a
.quad 0xa0fd9ef124009ef1,0x2335a2419b1f23cd,0x217fa3b01a3e2241,0x1f5820a1a3ec1d49,0x2286172aa3642241,0xa30022c6132da335,0x9f5823fda0729ef1,0xa0119fbd23ffa042
.quad 0xa38d1b1f21a8a3cd,0x22c6a335172a2241,0x1a3ea36422a78000,0x20721e1fa3d921a8,0x23fda0429e1f23cd,0xa286238d9c6ea0fd,0x156121f7a3d91ef1,0xa0cf9c6e2379a2c6
.quad 0x22411ef1a3cd8000,0x800023cd9ef1a241,0xa17f23001bfea400,0xa3d9132d239fa042,0xa155a04223b08000,0x1e1fa3f3195c2335,0x2264a2869cdc2400,0x22a71c6ea3ff1d49
.quad 0x204220fda38d8000,0xa1a82335172aa3cd,0xa31c21f71db5a400,0xa072a0a123bf972a,0x9e1fa1a823648000,0x2364a1a89e1f2400,0x239fa1559e892400,0x1a3e2286a2e4972a
.quad 0x1b1f2241a3358000,0xa4001ef120fda3cd,0xa3ec20a11f58a400,0x1a3ea3b0217f1d49,0x932da2c623008000,0x2364972aa2862335,0x23ff9fbda0112400,0xa07223fd9f58a042
.quad 0x972a2335a2c68000,0xa1a89b1f238da241,0xa3d91e1f2072a400,0x22a7a3641a3e21a8,0x1c6ea38d22868000,0x1e1f2042a3fd20fd,0x23799c6ea0cf2400,0xa3d921f71561a2c6
.quad 0xa24122411ef1a3cd,0xa3cd800023cd9ef1,0x9db5a286221d1ef1,0x20cfa364987923f3,0x23fd9d49a2862241,0x1fbd21a8a3009b1f,0x9bfe23fd9db5a241,0xa3f91e1f221da2c6
.quad 0xa2c69b1f23f39ef1,0x1d49a4001d492241,0x221da300987923cd,0x21d01e1fa3ff1d49,0x1e1f21a8a3648000,0xa36421a81e1fa400,0xa3f91fbd20cfa3cd,0xf2ea36421d01d49
.quad 0x1b1fa3cd20fd1ef1,0x23358000a3352241,0x22e4132da34d2241,0xa21d23649561a2c6,0xa1f7238d995ca241,0x9c6ea1a823b09b1f,0x9e89a0a123f99ef1,0x23ec9e1fa0cf23f3
.quad 0x23f3a0fd9d4923cd,0xa0422400a0429ef1,0x9a3e2364a2a78000,0xa0729e1f23d9a1a8,0xa300172a21f7a3cd,0x23e3a1a8995c2335,0x21d0a3e31f581ef1,0x9bfe2364a2e4172a
.quad 0x9ef1a24122411ef1,0x1ef1a3cd800023cd,0x23f9995ca34d20fd,0x1f5821f7a2a79d49,0xa0a1238d132da3cd,0xa3e3172a2364a0fd,0x9e89a1f722e41b1f,0x21d0a3009a3e23f3
.quad 0x23f39b1fa2c62241,0x172a2335a1a89ef1,0xa0cf23b09561a335,0xa2e4995c23d9a042,0x9e1fa1a823648000,0x2364a1a89e1f2400,0x23ec9c6ea21d2335,0x9bfe23e3a072a042
.quad 0xa0fd23cd9b1fa241,0xa0fd9ef124009ef1,0x9db5a15523bf9b1f,0x23ff9fbda07223f3,0x23e39d49a15523cd,0xa0a123f39e1fa0fd,0xa12923e39db5a0fd,0x9cdca15523d99d49
.quad 0x9d49a0fd23f39ef1,0x238d9b1fa1a823cd,0x23d99e1fa0722400,0xa2a723649a3ea1a8,0xa15523f39fbd9ef1,0x132da2c623649b1f,0x9cdca0a123ffa0fd,0x221d132da2a7238d
.quad 0x23cd9ef1a2412241,0x22411ef1a3cd8000,0xa01123b00f2ea3cd,0xa3ff1c6e22e4a1a8,0x9c6ea2c621f71ef1,0x21f7a2c69c6e2400,0x231c195ca3ec1ef1,0x987923e39f58a1a8
.quad 0xa38d20fd2042a3cd,0xa042a0fd238d8000,0x1e89a3fd1cdc2241,0x239f932da34d21a8,0x1e1f21a8a3648000,0xa36421a81e1fa400,0xa379132d231ca241,0x1f58a3fd1db521a8
.quad 0x2335a2419b1f23cd,0x1b1f2241a3358000,0x9cdc23e3a0cf9ef1,0xa264995c239fa1a8,0x9fbda04223fd9ef1,0x23fda0429fbd2400,0x23bf9c6ea17f23cd,0xa1d023b09bfea1a8
.quad 0xa2c62335972aa241,0x172aa33522c68000,0x1a3ea36422a78000,0x20721e1fa3d921a8,0x20a11d49a3b02241,0xa3b01d4920a1a400,0xa3ec1fbd1e89a3cd,0x234da300187921a8
.quad 0x800023cd9ef1a241,0xa24122411ef1a3cd,0xa072a155231c1b1f,0x1e89a3e31561238d,0x2364172aa3e31ef1,0x132d238da0a1a0fd,0xa3d91fbd217fa335,0xa011a155234d172a
.quad 0x21a8a335972a23cd,0x22c61b1fa3f31ef1,0x9a3e23e3a011a0fd,0xa3f91c6e2264a2c6,0x9e1fa1a823648000,0x2364a1a89e1f2400,0x22a7195ca3bf20fd,0xa12923b09879a2c6
.quad 0xa4001ef120fda3cd,0x1b1fa3cd20fd1ef1,0x22a7a3008f2e2335,0x1bfe21f7a379172a,0x9e1f23f3a0a19ef1,0xa1559d4923e3a0fd,0x9a3ea1f7239f9b1f,0x2379995ca21d238d
.quad 0x21a81b1fa38d2241,0xa3f320fd1d49a3cd,0xa3d91e1f2072a400,0x22a7a3641a3e21a8,0x2364a2c6132d2241,0x9fbd23f3a1559b1f,0xa07223fda1299b1f,0xf2ea286239f9d49
.quad 0xa3cd800023cd9ef1,0x9ef1a24122411ef1,0x23ec9e1fa2642241,0x212920a1a379972a,0xa30021a81fbda3cd,0xa2869d4923fd9b1f,0x2129a364956123cd,0x2379132da3bf2042
.quad 0x9d4924009d49a241,0xa3f31b1f22c6a241,0x8f2ea364217f1ef1,0x23ec9fbda129238d,0x1e1f21a8a3648000,0xa36421a81e1fa400,0xa17f9e1f23ff9ef1,0x2264a3009561238d
.quad 0x23358000a3352241,0xa0fd23cd9b1fa241,0xa3f91e1f2129a3cd,0x1e89a3fd20112042,0x23b0a1a89c6e23cd,0x995c238da1f79b1f,0xa26423649879a241,0x9561a286234d972a
.quad 0x2042a40020421ef1,0x1d4920fda3f31ef1,0x9a3e2364a2a78000,0xa0729e1f23d9a1a8,0x995ca1a823e39ef1,0x21f7172aa3002335,0x20111e1fa3bf2241,0xa31c195c217fa3f3
.quad 0x1ef1a3cd800023cd,0x23cd9ef1a2412241,0x9cdc23fd9a3ea335,0xa3bf1fbd21d0a2c6,0x195ca3f31e1f2241,0x23b0a042a1552335,0x8f2e23b0a072a0fd,0xa39f20a120cfa38d
.quad 0x972aa33521a81ef1,0x238da0fda04223cd,0x1bfe2286a2a79b1f,0xa37921551f58a3f3,0x9e1fa1a823648000,0x2364a1a89e1f2400,0x201120a1a3d91b1f,0xa34d21f71cdca3f3
.quad 0xa0fd9ef124009ef1,0x2335a2419b1f23cd,0x21d01c6ea3d920fd,0xa31c22861879a38d,0xa286972a2364a241,0x2300a2c6932d2335,0x231c932da2a72335,0xa2e423008f2ea2c6
.quad 0xa38d1b1f21a8a3cd,0x22c6a335172a2241,0x23d99e1fa0722400,0xa2a723649a3ea1a8,0xa3fd20421e1fa3cd,0x2286a38d1c6e20fd,0x23f9a1559a3e2335,0xa26423b09db5a042
.quad 0x22411ef1a3cd8000,0x800023cd9ef1a241,0xa1d09fbd23bf8000,0x1a3ea3fd1cdc22c6,0x21552042a3b08000,0x9e1f23f3995ca335,0xa0cfa0a1239f8000,0x2072a3b00f2e238d
.quad 0x204220fda38d8000,0xa1a82335172aa3cd,0x9f58a15523798000,0x22a7a2869bfe23f3,0x1e1f21a8a3648000,0xa36421a81e1fa400,0x9cdca1f7234d8000,0x23d9a0a1a01123f3
.quad 0x1b1f2241a3358000,0xa4001ef120fda3cd,0x9879a286231c8000,0x23d99c6ea1d0238d,0x132d22c6a3008000,0xa364172a2286a335,0xf2ea30022e48000,0x22a7132da31c22c6
.quad 0x972a2335a2c68000,0xa1a89b1f238da241,0x1a3ea36422a78000,0x20721e1fa3d921a8,0x9c6e238da2868000,0x9e1fa04223fda0fd,0x1db5a3b022648000,0x1a3e2155a3f92042
.quad 0xa24122411ef1a3cd,0xa3cd800023cd9ef1,0x2379a0a1a1292335,0x22641e1fa3ec172a,0xa3fd1d492286a241,0x9fbda1a823001b1f,0x23bf932da37920fd,0x15612364a129a042
.quad 0xa2c69b1f23f39ef1,0x1d49a4001d492241,0x21291fbda3ec1b1f,0xa17f23640f2ea38d,0x9e1fa1a823648000,0x2364a1a89e1f2400,0x15612300a2649b1f,0xa3ff1e1f217fa38d
.quad 0x1b1fa3cd20fd1ef1,0x23358000a3352241,0xa01123fd9e89a0fd,0xa1299e1f23f9a042,0x21f7a38d195c2241,0x1c6e21a8a3b01b1f,0xa34d22861561a335,0x1879a3642264172a
.quad 0x23f3a0fd9d4923cd,0xa0422400a0429ef1,0xa3d91e1f2072a400,0x22a7a3641a3e21a8,0x2300972aa1f723cd,0xa3e321a8195ca335,0xa17f995c231ca335,0x23bf9e1fa01123f3
.quad 0x9ef1a24122411ef1,0x1ef1a3cd800023cd,0x956123e39e89a241,0xa31c21552072a38d,0x20a1a38d932d23cd,0x23e3972aa36420fd,0xa34d21552011a3cd,0xa17f9fbd23d9972a
.quad 0x23f39b1fa2c62241,0x172a2335a1a89ef1,0xa2649c6e23f99ef1,0x2011a3e31a3e22c6,0x1e1f21a8a3648000,0xa36421a81e1fa400,0x1879a3b021291ef1,0x23bf995ca2a722c6
.quad 0xa0fd23cd9b1fa241,0xa0fd9ef124009ef1,0x2379a1f79bfe23cd,0xf2e2300a2a7972a,0xa3e31d492155a3cd,0x20a1a3f31e1f20fd,0x221d195ca3792241,0xa39f21f71a3ea38d
.quad 0x9d49a0fd23f39ef1,0x238d9b1fa1a823cd,0x9a3e2364a2a78000,0xa0729e1f23d9a1a8,0x2155a3f31fbd1ef1,0x932d22c6a3641b1f,0xa39f22868f2ea241,0x2129a3fd20721d49
.quad 0x23cd9ef1a2412241,0x22411ef1a3cd8000,0xa2e49c6e23ff9b1f,0x8f2ea3b0201121a8,0x1c6e22c6a1f79ef1,0xa1f722c61c6ea400,0x1f58a3e318792335,0x23ec995ca31c21a8
.quad 0xa38d20fd2042a3cd,0xa042a0fd238d8000,0x234d132da39f20fd,0x9cdc23fd9e89a1a8,0x9e1fa1a823648000,0x2364a1a89e1f2400,0x9db523fd9f58a0fd,0xa31c932d2379a1a8
.quad 0x2335a2419b1f23cd,0x1b1f2241a3358000,0xa39f195c2264a335,0x20cfa3e31cdc21a8,0x1fbd2042a3fd1ef1,0xa3fd20421fbda400,0x1bfea3b021d01b1f,0x217f1c6ea3bf21a8
.quad 0xa2c62335972aa241,0x172aa33522c68000,0x23d99e1fa0722400,0xa2a723649a3ea1a8,0xa0a19d4923b0a241,0x23b09d49a0a12400,0x98792300a34d1b1f,0x9e899fbd23eca1a8
.quad 0x800023cd9ef1a241,0xa24122411ef1a3cd,0x22a7a1f79f5823cd,0x234d195ca3f91d49,0xa364972a23e39ef1,0x932da38d20a120fd,0x1a3e2300a1d09ef1,0xa2e421f71e89a3f3
.quad 0x21a8a335972a23cd,0x22c61b1fa3f31ef1,0xa3d9195c22e4a241,0x1561a3b020cf2042,0x1e1f21a8a3648000,0xa36421a81e1fa400,0x2072a3e31bfe2241,0x221d1c6ea3ec2042
.quad 0xa4001ef120fda3cd,0x1b1fa3cd20fd1ef1,0x20721fbda3ff1ef1,0xa3bf21551db5a3f3,0x1e1fa3f320a11ef1,0x21551d49a3e320fd,0xa3d921551cdca3cd,0x1db5a3e321291d49
.quad 0x21a81b1fa38d2241,0xa3f320fd1d49a3cd,0x1a3ea36422a78000,0x20721e1fa3d921a8,0xa36422c6932da241,0x1fbda3f321551b1f,0x22a7932da21d23cd,0xa3ff20a11cdca38d
.quad 0xa3cd800023cd9ef1,0x9ef1a24122411ef1,0x18792364a0cfa0fd,0xa21d22861db5a3f3,0x2300a1a89fbd23cd,0x22861d49a3fd1b1f,0xa21d9e1f23f99b1f,0x1db5a3fd1bfe22c6
.quad 0x9d4924009d49a241,0xa3f31b1f22c6a241,0x23ff9e1fa1d02335,0x18792300a21d9d49,0x9e1fa1a823648000,0x2364a1a89e1f2400,0xa1d023648f2ea335,0xa0cf9fbd23f99d49
.quad 0x23358000a3352241,0xa0fd23cd9b1fa241,0x1561a364221d1b1f,0x234d932da2e422c6,0xa3b021a81c6ea3cd,0x195ca38d21f71b1f,0x20cf1e1fa3ec20fd,0xa3f920a11e89a3f3
.quad 0x2042a40020421ef1,0x1d4920fda3f31ef1,0xa3d91e1f2072a400,0x22a7a3641a3e21a8,0x195c21a8a3e31ef1,0xa1f7972a2300a335,0x22e4a3641bfe20fd,0x9f5823e3a1d0972a
.quad 0x1ef1a3cd800023cd,0x23cd9ef1a2412241,0xa39f932d23d99ef1,0x9bfea300217f2042,0x995c23f39e1fa241,0xa3b020422155a335,0x23ff9c6ea2a72241,0x1cdc2286a2649d49
.quad 0x972aa33521a81ef1,0x238da0fda04223cd,0xa3bf20a12072a3cd,0x9db5a1f7231c172a,0x1e1f21a8a3648000,0xa36421a81e1fa400,0x22e4a2869a3e23cd,0x1e892155a39f172a
.quad 0xa0fd9ef124009ef1,0x2335a2419b1f23cd,0xa17f23b09a3ea241,0x9f58a0a123ec9d49,0x2286172aa3642241,0xa30022c6132da335,0x1f58a3fd20721ef1,0x20111fbda3ff2042
.quad 0xa38d1b1f21a8a3cd,0x22c6a335172a2241,0x9a3e2364a2a78000,0xa0729e1f23d9a1a8,0x23fda0429e1f23cd,0xa286238d9c6ea0fd,0x9561a1f723d99ef1,0x20cf1c6ea37922c6
.quad 0x22411ef1a3cd8000,0x800023cd9ef1a241,0x217fa3009bfe2400,0x23d9932da39f2042,0xa155a04223b08000,0x1e1fa3f3195c2335,0xa26422861cdca400,0xa2a79c6e23ff9d49
.quad 0x204220fda38d8000,0xa1a82335172aa3cd,0x231ca1f79db52400,0x207220a1a3bf172a,0x9e1fa1a823648000,0x2364a1a89e1f2400,0xa39f21551e89a400,0x9a3ea28622e4172a
.quad 0x1b1f2241a3358000,0xa4001ef120fda3cd,0x23eca0a19f582400,0x9a3e23b0a17f9d49,0x932da2c623008000,0x2364972aa2862335,0xa3ff1fbd2011a400,0x2072a3fd1f582042
.quad 0x972a2335a2c68000,0xa1a89b1f238da241,0x23d99e1fa0722400,0xa2a723649a3ea1a8,0x1c6ea38d22868000,0x1e1f2042a3fd20fd,0xa3791c6e20cfa400,0x23d9a1f7956122c6
.quad 0xa24122411ef1a3cd,0xa3cd800023cd9ef1,0x1db52286a21d9ef1,0xa0cf23641879a3f3,0x23fd9d49a2862241,0x1fbd21a8a3009b1f,0x1bfea3fd1db52241,0x23f99e1fa21d22c6
.quad 0xa2c69b1f23f39ef1,0x1d49a4001d492241,0xa21d23001879a3cd,0xa1d09e1f23ff9d49,0x1e1f21a8a3648000,0xa36421a81e1fa400,0x23f99fbda0cf23cd,0x8f2e2364a1d09d49
.quad 0x1b1fa3cd20fd1ef1,0x23358000a3352241,0xa2e4932d234da241,0x221da364156122c6,0xa1f7238d995ca241,0x9c6ea1a823b09b1f,0x1e8920a1a3f91ef1,0xa3ec1e1f20cfa3f3
.quad 0x23f3a0fd9d4923cd,0xa0422400a0429ef1,0x1a3ea36422a78000,0x20721e1fa3d921a8,0xa300172a21f7a3cd,0x23e3a1a8995c2335,0xa1d023e39f589ef1,0x1bfea36422e4972a
.quad 0x9ef1a24122411ef1,0x1ef1a3cd800023cd,0xa3f9195c234da0fd,0x9f58a1f722a71d49,0xa0a1238d132da3cd,0xa3e3172a2364a0fd,0x1e8921f7a2e49b1f,0xa1d023001a3ea3f3
.quad 0x23f39b1fa2c62241,0x172a2335a1a89ef1,0x20cfa3b015612335,0x22e4195ca3d92042,0x9e1fa1a823648000,0x2364a1a89e1f2400,0xa3ec1c6e221da335,0x1bfea3e320722042
.quad 0xa0fd23cd9b1fa241,0xa0fd9ef124009ef1,0x1db52155a3bf1b1f,0xa3ff1fbd2072a3f3,0x23e39d49a15523cd,0xa0a123f39e1fa0fd,0x2129a3e31db520fd,0x1cdc2155a3d91d49
.quad 0x9d49a0fd23f39ef1,0x238d9b1fa1a823cd,0xa3d91e1f2072a400,0x22a7a3641a3e21a8,0xa15523f39fbd9ef1,0x132da2c623649b1f,0x1cdc20a1a3ff20fd,0xa21d932d22a7a38d
.quad 0x23cd9ef1a2412241,0x22411ef1a3cd8000,0x2011a3b08f2e23cd,0x23ff9c6ea2e421a8,0x9c6ea2c621f71ef1,0x21f7a2c69c6e2400,0xa31c995c23ec9ef1,0x1879a3e31f5821a8
.quad 0xa38d20fd2042a3cd,0xa042a0fd238d8000,0x9e8923fd9cdca241,0xa39f132d234da1a8,0x1e1f21a8a3648000,0xa36421a81e1fa400,0x2379932da31c2241,0x9f5823fd9db5a1a8
.quad 0x2335a2419b1f23cd,0x1b1f2241a3358000,0x1cdca3e320cf1ef1,0x2264195ca39f21a8,0x9fbda04223fd9ef1,0x23fda0429fbd2400,0xa3bf1c6e217fa3cd,0x21d0a3b01bfe21a8
.quad 0xa2c62335972aa241,0x172aa33522c68000,0x9a3e2364a2a78000,0xa0729e1f23d9a1a8,0x20a11d49a3b02241,0xa3b01d4920a1a400,0x23ec9fbd9e8923cd,0xa34d23009879a1a8
.quad 0x800023cd9ef1a241,0xa24122411ef1a3cd,0x20722155a31c9b1f,0x9e8923e39561a38d,0x2364172aa3e31ef1,0x132d238da0a1a0fd,0x23d99fbda17f2335,0x20112155a34d972a
.quad 0x21a8a335972a23cd,0x22c61b1fa3f31ef1,0x1a3ea3e3201120fd,0x23f99c6ea26422c6,0x9e1fa1a823648000,0x2364a1a89e1f2400,0xa2a7995c23bfa0fd,0x2129a3b0187922c6
.quad 0xa4001ef120fda3cd,0x1b1fa3cd20fd1ef1,0xa2a723000f2ea335,0x9bfea1f72379972a,0x9e1f23f3a0a19ef1,0xa1559d4923e3a0fd,0x1a3e21f7a39f1b1f,0xa379195c221da38d
.quad 0x21a81b1fa38d2241,0xa3f320fd1d49a3cd,0x23d99e1fa0722400,0xa2a723649a3ea1a8,0x2364a2c6132d2241,0x9fbd23f3a1559b1f,0x2072a3fd21291b1f,0x8f2e2286a39f1d49
.quad 0xa3cd800023cd9ef1,0x9ef1a24122411ef1,0xa3ec1e1f2264a241,0xa129a0a12379172a,0xa30021a81fbda3cd,0xa2869d4923fd9b1f,0xa12923641561a3cd,0xa379932d23bfa042
.quad 0x9d4924009d49a241,0xa3f31b1f22c6a241,0xf2e2364a17f9ef1,0xa3ec1fbd2129a38d,0x1e1f21a8a3648000,0xa36421a81e1fa400,0x217f1e1fa3ff1ef1,0xa26423001561a38d
.quad 0x23358000a3352241,0xa0fd23cd9b1fa241,0x23f99e1fa12923cd,0x9e8923fda011a042,0x23b0a1a89c6e23cd,0x995c238da1f79b1f,0x2264a36418792241,0x15612286a34d172a
.quad 0x2042a40020421ef1,0x1d4920fda3f31ef1,0x1a3ea36422a78000,0x20721e1fa3d921a8,0x995ca1a823e39ef1,0x21f7172aa3002335,0xa0119e1f23bfa241,0x231c995ca17f23f3
.quad 0x1ef1a3cd800023cd,0x23cd9ef1a2412241,0x1cdca3fd1a3e2335,0x23bf9fbda1d022c6,0x195ca3f31e1f2241,0x23b0a042a1552335,0xf2ea3b0207220fd,0x239fa0a1a0cf238d
.quad 0x972aa33521a81ef1,0x238da0fda04223cd,0x9bfea28622a71b1f,0x2379a1559f5823f3,0x9e1fa1a823648000,0x2364a1a89e1f2400,0xa011a0a123d99b1f,0x234da1f79cdc23f3
.quad 0xa0fd9ef124009ef1,0x2335a2419b1f23cd,0xa1d09c6e23d9a0fd,0x231ca2869879238d,0xa286972a2364a241,0x2300a2c6932d2335,0xa31c132d22a7a335,0x22e4a3000f2e22c6
.quad 0xa38d1b1f21a8a3cd,0x22c6a335172a2241,0xa3d91e1f2072a400,0x22a7a3641a3e21a8,0xa3fd20421e1fa3cd,0x2286a38d1c6e20fd,0xa3f921551a3ea335,0x2264a3b01db52042
.quad 0x23359b1fa0fd2400,0xa40020fd1b1fa335,0x22e4995ca1292400,0xa3d91fbd1db5a38d,0x2286972aa1552400,0xa3641d491fbda3cd,0x221d932da17f2400,0xa2a7195c20cfa3f3
.quad 0x21a88000a1a82400,0xa1a8000021a8a400,0x2129132da1d02400,0xa072995c2264a3f3,0x20a1172aa1f72400,0x9e1f9d492300a3cd,0x2011195ca21d2400,0x9a3e9fbd2379a38d
.quad 0x1ef11b1fa2412400,0x8000a0fd23cda335,0x1db51c6ea2642400,0x1a3ea1f723f9a2c6,0x1c6e1d49a2862400,0x1e1fa2c623fda241,0x1a3e1e1fa2a72400,0x2072a36423d9a1a8
.quad 0x172a1ef1a2c62400,0x21a8a3cd238da0fd,0xf2e1fbda2e42400,0x22a7a3fd231ca042,0x932d2042a3002400,0x2364a3f322869ef1,0x987920a1a31c2400,0x23d9a3b021d09d49
.quad 0x2335a3351b1f20fd,0xa0fd2400a0fd9b1f,0x23eca1f78f2e2241,0xa31c23649cdca042,0x23e3a0429c6e2335,0xa3fd21a8132da241,0x231c9c6ea01123cd,0xa3791e1f1e89a38d
.quad 0x21a88000a1a82400,0xa1a8000021a8a400,0x1f581c6ea2e423cd,0x9db59e1f234da38d,0x195c2042a3b02335,0x132da1a823fda241,0x987921f7a3ff2241,0x1f58a364239fa042
.quad 0x9ef12335a3cd20fd,0x2241a40022419b1f,0xa17f23e3a31c1ef1,0x23bfa3642011172a,0xa30023f3a1f71b1f,0x23e3a1a8195c1ef1,0xa3d92364a0720000,0x22a79e1f9a3e21a8
.quad 0xa3f322419d499b1f,0x20428000a0422335,0xa34d20a195619ef1,0x18791e1fa26423f3,0xa1f71d49195ca0fd,0x9c6e21a8a3b023cd,0xa011132d1e89a241,0xa1292364a3f922c6
.quad 0x1b1fa33523359b1f,0x1b1f20fda40020fd,0x217fa3fd20cf1b1f,0x9e8923b0a2a7172a,0x23b0a2c6195c20fd,0xa300238d9e1f9ef1,0x23bf9fbd9cdc2335,0xa3ec20a11a3ea2c6
.quad 0x21a88000a1a82400,0xa1a8000021a8a400,0x1bfe1fbda39f2335,0x9879a0a123d9a2c6,0x9c6e22c6a3e320fd,0x1fbda38d23649ef1,0xa1d023fda2641b1f,0x234da3b02072172a
.quad 0xa3cd23359ef19b1f,0x23cda0fd000020fd,0xa39f20a10f2ea0fd,0x2129932da072238d,0xa155172a1fbda335,0x132d2042a36423cd,0x9a3e9e1f22a7a400,0xa0722364a3d921a8
.quad 0x1d49a24123f3a335,0xa38d23cda1a81b1f,0x221da3e32379a0fd,0xa39f21559a3e9d49,0x23e3a38d21559b1f,0xa0a1172a1e1fa241,0x2379a1551bfe1b1f,0xf2e9fbd22a7a3f3
.quad 0xa0fd9b1f2335a335,0x23359b1fa0fd2400,0x1561a28623bf9ef1,0x1bfe20a1a3f921a8,0x21f7a3f320a11b1f,0xa0a123f3a1f70000,0x23ffa15595612241,0xa3f921f78f2ea1a8
.quad 0x21a88000a1a82400,0xa1a8000021a8a400,0xf2e2155a3f92241,0x1561a1f723ffa1a8,0xa15523f3a2861b1f,0x2286a3f321558000,0xa3f922869bfe9ef1,0x23bfa0a1956121a8
.quad 0xa2411b1f1ef1a335,0x1ef11b1fa2412400,0x98799fbd234da3cd,0x9e892300a3ec21a8,0x20a1a38d23b0a0fd,0xa3b0238da0a10000,0x23d9a36420728000,0xa2a71e1f1a3ea1a8
.quad 0x22c69ef1972a20fd,0x972a9ef122c6a400,0x1bfe1c6ea1d023cd,0x217fa3b023bfa1a8,0x9fbd22c6a3fd2335,0x23fda2c61fbd8000,0xa39f23e3a2641ef1,0x20cf995c9cdc21a8
.quad 0xa40020fd1b1fa335,0x2335a3351b1f20fd,0xa0729c6e234da335,0x2264932da1d023f3,0x1e1fa38d23009b1f,0x995c22c6a3b01ef1,0x23d9a286187920fd,0xa39f23009bfea042
.quad 0x21a88000a1a82400,0xa1a8000021a8a400,0x9a3e2286a3ec20fd,0x1cdca30023bfa042,0xa364238d9fbd9b1f,0x23e3a2c61c6e1ef1,0xa2a71c6e1e89a335,0x20cf132da17f23f3
.quad 0x8000a0fd23cda335,0x9ef12335a3cd20fd,0x22a7a3fd221d9b1f,0xa3ff22869cdc9d49,0x2364a042932d20fd,0x9fbd972a2155a3cd,0x1a3e1e1fa2a72400,0x2072a36423d9a1a8
.quad 0xa1a823cda38d20fd,0x23f3a2411d491b1f,0xa3d921f79cdc9b1f,0x1db5195ca129238d,0x9e1f972a20a1a335,0xa155238da3e32241,0x2072a30023ffa335,0xa3bf21f79db5972a
.quad 0xa0fd2400a0fd9b1f,0x1b1fa33523359b1f,0xa39f1e1f1f58a3cd,0x23ffa155987922c6,0x932da1a823fda0fd,0x1c6e2042a3e32241,0x234da3641db51ef1,0xa2e423b09f589d49
.quad 0x21a88000a1a82400,0xa1a8000021a8a400,0x9e892364a3791ef1,0x2011a3b0231c9d49,0xa3fd21a8932da0fd,0x23b0a042995c2241,0x9cdc9e1f231ca3cd,0x8f2e2155a3ec22c6
.quad 0x2241a40022419b1f,0xa3cd23359ef19b1f,0x22e49e1f9bfe2241,0x9f58995c21d0a3f3,0x995c21a8a3e32335,0x21f7a3f323009ef1,0xa3d92364a0720000,0x22a79e1f9a3e21a8
.quad 0xa04200002042a335,0x9d492241a3f32335,0x20cfa36423eca241,0xa3f922869e89972a,0x23b0a1a81c6e1b1f,0x995c9d4921f7a3cd,0x15611e1fa21d23cd,0x234da3fd22e4a042
.quad 0x1b1f20fda40020fd,0xa0fd9b1f2335a335,0xa37923009a3ea0fd,0x221da3e320111d49,0x9fbd9d492364a335,0x2155172aa28623cd,0x2264a3e320721b1f,0xa1d023fda129972a
.quad 0x21a88000a1a82400,0xa1a8000021a8a400,0xa0cf23e3a2a71b1f,0x217fa3fd221d972a,0xa3001d491e1fa335,0x21f7972aa0a123cd,0x1db5a30023d9a0fd,0xa12923e3a2e41d49
.quad 0x23cda0fd000020fd,0xa2411b1f1ef1a335,0x95612155a3d92335,0x20cfa3b02379a042,0xa3fd22c69e1f9b1f,0x22869d499c6e2241,0x9a3e9e1f22a7a400,0xa0722364a3d921a8
.quad 0x238da3cd21a89b1f,0xa2c61ef1172aa0fd,0x1f58132da0722335,0x2011a30023ffa2c6,0xa28623f3a36420fd,0x2300a042132d1ef1,0xa17f1c6e1a3ea0fd,0x9f582286a3ec238d
.quad 0x23359b1fa0fd2400,0xa40020fd1b1fa335,0xa01123e3a21d0000,0x1a3ea30023799d49,0xa286172a2155a400,0x23649d499fbd23cd,0x2129a3fd21d08000,0xa07223e3a264172a
.quad 0x21a88000a1a82400,0xa1a8000021a8a400,0xa21d23fda17f0000,0x22a7a3e320cf172a,0xa0a1972a21f7a400,0x1e1f1d49a30023cd,0x22e4a3e321298000,0xa3d923009db59d49
.quad 0x1ef11b1fa2412400,0x8000a0fd23cda335,0xa37923b0a0cf0000,0x23d9a15515612042,0x9c6e9d492286a400,0x9e1f22c6a3fd2241,0x23d9a36420728000,0xa2a71e1f1a3ea1a8
.quad 0x172a1ef1a2c62400,0x21a8a3cd238da0fd,0xa3ff2300a0110000,0x2072932d9f5822c6,0x132da0422300a400,0xa36423f3a2861ef1,0x23eca2861f588000,0x9a3e9c6e217fa38d
.quad 0x2335a3351b1f20fd,0xa0fd2400a0fd9b1f,0x18792155a3ff20fd,0x9f589e1f239fa2c6,0xa3e320421c6ea335,0x23fda1a8932d2241,0x1f58a3b022e49b1f,0x9db52364a34d1d49
.quad 0x21a88000a1a82400,0xa1a8000021a8a400,0xa31c23b0a0119b1f,0x2379a3641e891d49,0x995ca04223b0a335,0x932d21a8a3fd2241,0x23eca1550f2e20fd,0xa31c1e1f1cdca2c6
.quad 0x9ef12335a3cd20fd,0x2241a40022419b1f,0xa1d0195c1f58a335,0x1bfe1e1fa2e423f3,0x2300a3f321f79b1f,0xa3e321a8995c9ef1,0x1a3e1e1fa2a72400,0x2072a36423d9a1a8
.quad 0xa3f322419d499b1f,0x20428000a0422335,0x1e89a28623f9a335,0xa3ec2364a0cf172a,0x21f79d49995c20fd,0x1c6ea1a823b0a3cd,0xa2e423fda34d20fd,0x221d9e1f95612042
.quad 0x1b1fa33523359b1f,0x1b1f20fda40020fd,0x21d0132da26423cd,0xa34d1c6e2072a3f3,0xa3b022c6995ca0fd,0x2300a38d1e1f1ef1,0x1bfea300239f9ef1,0x98792286a3d92042
.quad 0x21a88000a1a82400,0xa1a8000021a8a400,0xa3bf23009cdc9ef1,0x23eca2861a3e2042,0x1c6ea2c623e3a0fd,0x9fbd238da3641ef1,0x217f932da0cf23cd,0x9e899c6e22a7a3f3
.quad 0xa3cd23359ef19b1f,0x23cda0fd000020fd,0x1cdca28623ffa241,0xa21d23fda2a71d49,0x2155972a9fbd2335,0x932da0422364a3cd,0xa3d92364a0720000,0x22a79e1f9a3e21a8
.quad 0x1d49a24123f3a335,0xa38d23cda1a81b1f,0x2129995c9db52241,0x1cdca1f723d9a38d,0xa3e3238da1551b1f,0x20a1972a9e1f2241,0x1db5a1f723bfa3cd,0xa3ff2300a072172a
.quad 0xa0fd9b1f2335a335,0x23359b1fa0fd2400,0x23f9a0a19bfe2335,0xa3bf22869561a1a8,0xa1f723f3a0a19b1f,0x20a1a3f321f78000,0xf2ea1f723f9a0fd,0x15612155a3ff21a8
.quad 0x21a88000a1a82400,0xa1a8000021a8a400,0xa3ff21f79561a0fd,0x23f9a1558f2e21a8,0x2155a3f322869b1f,0xa28623f3a1550000,0x156120a1a3bf2335,0x1bfea28623f9a1a8
.quad 0xa2411b1f1ef1a335,0x1ef11b1fa2412400,0x23eca3001e891b1f,0xa34d1fbd1879a1a8,0xa0a1238da3b020fd,0x23b0a38d20a18000,0x9a3e9e1f22a7a400,0xa0722364a3d921a8
.quad 0x22c69ef1972a20fd,0x972a9ef122c6a400,0xa3bf23b0a17f1b1f,0x21d09c6e9bfe21a8,0x1fbda2c623fda335,0xa3fd22c69fbd0000,0x1cdc195ca0cf2335,0x2264a3e3239fa1a8
.quad 0xa40020fd1b1fa335,0x2335a3351b1f20fd,0x22a7a3b01e891ef1,0xa0cf23fda17f972a,0x9e1f238da3001b1f,0x195ca2c623b09ef1,0x9a3ea0a123eca241,0x1cdc1fbda3bf22c6
.quad 0x21a88000a1a82400,0xa1a8000021a8a400,0xa3d920a11879a241,0x239f9fbd9bfe22c6,0x2364a38d1fbd1b1f,0xa3e322c69c6e9ef1,0xa07223b0a34d1ef1,0x2264a3fd21d0972a
.quad 0x8000a0fd23cda335,0x9ef12335a3cd20fd,0x2072132da12923cd,0x8f2ea0a1239fa38d,0xa3642042132da0fd,0x1fbd172aa15523cd,0x23d9a36420728000,0xa2a71e1f1a3ea1a8
.quad 0xa1a823cda38d20fd,0x23f3a2411d491b1f,0x1a3ea155239fa3cd,0xa37923e3a21d1d49,0x1e1f172aa0a12335,0x2155a38d23e3a241,0xa2a71fbd8f2e9ef1,0x9bfe2155a37923f3
.quad 0xa0fd2400a0fd9b1f,0x1b1fa33523359b1f,0x1cdca364231c9b1f,0xf2e21f7a3ec2042,0x132d21a8a3fd20fd,0x9c6ea04223e3a241,0x9e899e1f2379a335,0x20111c6ea31c238d
.quad 0x21a88000a1a82400,0xa1a8000021a8a400,0xa34d1e1f1db5a335,0x22e49c6e9f58238d,0x23fda1a8132d20fd,0xa3b02042195ca241,0xa39f23649f589b1f,0x23ffa1f718792042
.quad 0x2241a40022419b1f,0xa3cd23359ef19b1f,0xa0112364a3bf20fd,0x231ca3e3217f972a,0x195ca1a823e3a335,0xa1f723f3a3001ef1,0x1a3e1e1fa2a72400,0x2072a36423d9a1a8
.quad 0xa04200002042a335,0x9d492241a3f32335,0x22649e1f987920fd,0x1561a0a1234da3f3,0xa3b021a89c6e9b1f,0x195c1d49a1f723cd,0x23f9a36421299b1f,0x9e89932d2011a2c6
.quad 0x1b1f20fda40020fd,0xa0fd9b1f2335a335,0x9db59fbd23d9a241,0x2129195ca2e4238d,0x1fbd1d49a3642335,0xa155972a2286a3cd,0xa0cf995c22a7a3cd,0x217f132da21d23f3
.quad 0x21a88000a1a82400,0xa1a8000021a8a400,0xa264195c2072a3cd,0x21d0932da12923f3,0x23009d499e1f2335,0xa1f7172a20a1a3cd,0xa3791fbd1a3ea241,0x221d995ca011238d
.quad 0x23cda0fd000020fd,0xa2411b1f1ef1a335,0xa3f921f79a3e9ef1,0x22649c6e9db522c6,0x23fda2c61e1f1b1f,0xa2861d491c6ea241,0xa3d92364a0720000,0x22a79e1f9a3e21a8
.quad 0x238da3cd21a89b1f,0xa2c61ef1172aa0fd,0xa31c23fda2a71ef1,0x22e49fbd8f2e2042,0x2286a3f32364a0fd,0xa3002042932d9ef1,0xa1d023b0a3d92241,0x231ca0a118791d49
.quad 0x23359b1fa0fd2400,0xa40020fd1b1fa335,0xa2e4195c2129a400,0x23d99fbd9db5238d,0x2286972aa1552400,0xa3641d491fbda3cd,0xa21d132d217fa400,0x22a7995ca0cf23f3
.quad 0x21a88000a1a82400,0xa1a8000021a8a400,0xa129932d21d0a400,0x2072195ca26423f3,0x20a1172aa1f72400,0x9e1f9d492300a3cd,0xa011995c221da400,0x1a3e1fbda379238d
.quad 0x1ef11b1fa2412400,0x8000a0fd23cda335,0x9db59c6e2264a400,0x9a3e21f7a3f922c6,0x1c6e1d49a2862400,0x1e1fa2c623fda241,0x9a3e9e1f22a7a400,0xa0722364a3d921a8
.quad 0x172a1ef1a2c62400,0x21a8a3cd238da0fd,0x8f2e9fbd22e4a400,0xa2a723fda31c2042,0x932d2042a3002400,0x2364a3f322869ef1,0x1879a0a1231ca400,0xa3d923b0a1d01d49
.quad 0x2335a3351b1f20fd,0xa0fd2400a0fd9b1f,0xa3ec21f70f2ea241,0x231ca3641cdc2042,0x23e3a0429c6e2335,0xa3fd21a8132da241,0xa31c1c6e2011a3cd,0x23799e1f9e89238d
.quad 0x21a88000a1a82400,0xa1a8000021a8a400,0x9f589c6e22e4a3cd,0x1db51e1fa34d238d,0x195c2042a3b02335,0x132da1a823fda241,0x1879a1f723ffa241,0x9f582364a39f2042
.quad 0x9ef12335a3cd20fd,0x2241a40022419b1f,0x217fa3e3231c9ef1,0xa3bf2364a011972a,0xa30023f3a1f71b1f,0x23e3a1a8195c1ef1,0x23d9a36420728000,0xa2a71e1f1a3ea1a8
.quad 0xa3f322419d499b1f,0x20428000a0422335,0x234da0a115611ef1,0x98799e1f2264a3f3,0xa1f71d49195ca0fd,0x9c6e21a8a3b023cd,0x2011932d9e892241,0x2129a36423f9a2c6
.quad 0x1b1fa33523359b1f,0x1b1f20fda40020fd,0xa17f23fda0cf9b1f,0x1e89a3b022a7972a,0x23b0a2c6195c20fd,0xa300238d9e1f9ef1,0xa3bf1fbd1cdca335,0x23eca0a19a3e22c6
.quad 0x21a88000a1a82400,0xa1a8000021a8a400,0x9bfe9fbd239fa335,0x187920a1a3d922c6,0x9c6e22c6a3e320fd,0x1fbda38d23649ef1,0x21d0a3fd22649b1f,0xa34d23b0a072972a
.quad 0xa3cd23359ef19b1f,0x23cda0fd000020fd,0x239fa0a18f2e20fd,0xa129132d2072a38d,0xa155172a1fbda335,0x132d2042a36423cd,0x1a3e1e1fa2a72400,0x2072a36423d9a1a8
.quad 0x1d49a24123f3a335,0xa38d23cda1a81b1f,0xa21d23e3a37920fd,0x239fa1551a3e1d49,0x23e3a38d21559b1f,0xa0a1172a1e1fa241,0xa37921559bfe9b1f,0x8f2e1fbda2a723f3
.quad 0xa0fd9b1f2335a335,0x23359b1fa0fd2400,0x95612286a3bf1ef1,0x9bfea0a123f9a1a8,0x21f7a3f320a11b1f,0xa0a123f3a1f70000,0xa3ff21551561a241,0x23f9a1f70f2e21a8
.quad 0x21a88000a1a82400,0xa1a8000021a8a400,0x8f2ea15523f9a241,0x956121f7a3ff21a8,0xa15523f3a2861b1f,0x2286a3f321558000,0x23f9a2861bfe1ef1,0xa3bf20a11561a1a8
.quad 0xa2411b1f1ef1a335,0x1ef11b1fa2412400,0x18791fbda34d23cd,0x1e89a30023eca1a8,0x20a1a38d23b0a0fd,0xa3b0238da0a10000,0xa3d92364a0720000,0x22a79e1f9a3e21a8
.quad 0x22c69ef1972a20fd,0x972a9ef122c6a400,0x9bfe9c6e21d0a3cd,0xa17f23b0a3bf21a8,0x9fbd22c6a3fd2335,0x23fda2c61fbd8000,0x239fa3e322649ef1,0xa0cf195c1cdca1a8
.quad 0xa40020fd1b1fa335,0x2335a3351b1f20fd,0x20721c6ea34d2335,0xa264132d21d0a3f3,0x1e1fa38d23009b1f,0x995c22c6a3b01ef1,0xa3d922869879a0fd,0x239fa3001bfe2042
.quad 0x21a88000a1a82400,0xa1a8000021a8a400,0x1a3ea28623eca0fd,0x9cdc2300a3bf2042,0xa364238d9fbd9b1f,0x23e3a2c61c6e1ef1,0x22a79c6e9e892335,0xa0cf932d217fa3f3
.quad 0x8000a0fd23cda335,0x9ef12335a3cd20fd,0xa2a723fda21d1b1f,0x23ffa2861cdc1d49,0x2364a042932d20fd,0x9fbd972a2155a3cd,0x9a3e9e1f22a7a400,0xa0722364a3d921a8
.quad 0xa1a823cda38d20fd,0x23f3a2411d491b1f,0x23d9a1f71cdc1b1f,0x9db5995c2129a38d,0x9e1f972a20a1a335,0xa155238da3e32241,0xa0722300a3ff2335,0x23bfa1f71db5172a
.quad 0xa0fd2400a0fd9b1f,0x1b1fa33523359b1f,0x239f9e1f9f5823cd,0xa3ff21551879a2c6,0x932da1a823fda0fd,0x1c6e2042a3e32241,0xa34d23649db59ef1,0x22e4a3b01f581d49
.quad 0x21a88000a1a82400,0xa1a8000021a8a400,0x1e89a36423799ef1,0xa01123b0a31c1d49,0xa3fd21a8932da0fd,0x23b0a042995c2241,0x1cdc1e1fa31c23cd,0xf2ea15523eca2c6
.quad 0x2241a40022419b1f,0xa3cd23359ef19b1f,0xa2e41e1f1bfea241,0x1f58195ca1d023f3,0x995c21a8a3e32335,0x21f7a3f323009ef1,0x23d9a36420728000,0xa2a71e1f1a3ea1a8
.quad 0xa04200002042a335,0x9d492241a3f32335,0xa0cf2364a3ec2241,0x23f9a2861e89172a,0x23b0a1a81c6e1b1f,0x995c9d4921f7a3cd,0x95619e1f221da3cd,0xa34d23fda2e42042
.quad 0x1b1f20fda40020fd,0xa0fd9b1f2335a335,0x2379a3001a3e20fd,0xa21d23e3a0119d49,0x9fbd9d492364a335,0x2155172aa28623cd,0xa26423e3a0729b1f,0x21d0a3fd2129172a
.quad 0x21a88000a1a82400,0xa1a8000021a8a400,0x20cfa3e322a79b1f,0xa17f23fda21d172a,0xa3001d491e1fa335,0x21f7972aa0a123cd,0x9db52300a3d920fd,0x2129a3e322e49d49
.quad 0x23cda0fd000020fd,0xa2411b1f1ef1a335,0x1561a15523d9a335,0xa0cf23b0a3792042,0xa3fd22c69e1f9b1f,0x22869d499c6e2241,0x1a3e1e1fa2a72400,0x2072a36423d9a1a8
.quad 0x238da3cd21a89b1f,0xa2c61ef1172aa0fd,0x9f58932d2072a335,0xa0112300a3ff22c6,0xa28623f3a36420fd,0x2300a042132d1ef1,0x217f9c6e9a3e20fd,0x1f58a28623eca38d
.quad 0x23359b1fa0fd2400,0xa40020fd1b1fa335,0x2011a3e3221d8000,0x9a3e2300a3791d49,0xa286172a2155a400,0x23649d499fbd23cd,0xa12923fda1d00000,0x2072a3e32264972a
.quad 0x21a88000a1a82400,0xa1a8000021a8a400,0x221da3fd217f8000,0xa2a723e3a0cf972a,0xa0a1972a21f7a400,0x1e1f1d49a30023cd,0xa2e423e3a1290000,0x23d9a3001db51d49
.quad 0x1ef11b1fa2412400,0x8000a0fd23cda335,0x2379a3b020cf8000,0xa3d921559561a042,0x9c6e9d492286a400,0x9e1f22c6a3fd2241,0xa3d92364a0720000,0x22a79e1f9a3e21a8
.quad 0x172a1ef1a2c62400,0x21a8a3cd238da0fd,0x23ffa30020118000,0xa072132d1f58a2c6,0x132da0422300a400,0xa36423f3a2861ef1,0xa3ec22869f580000,0x1a3e1c6ea17f238d
.quad 0x2335a3351b1f20fd,0xa0fd2400a0fd9b1f,0x9879a15523ffa0fd,0x1f581e1fa39f22c6,0xa3e320421c6ea335,0x23fda1a8932d2241,0x9f5823b0a2e41b1f,0x1db5a364234d9d49
.quad 0x21a88000a1a82400,0xa1a8000021a8a400,0x231ca3b020111b1f,0xa37923649e899d49,0x995ca04223b0a335,0x932d21a8a3fd2241,0xa3ec21558f2ea0fd,0x231c9e1f9cdc22c6
.quad 0x9ef12335a3cd20fd,0x2241a40022419b1f,0x21d0995c9f582335,0x9bfe9e1f22e4a3f3,0x2300a3f321f79b1f,0xa3e321a8995c9ef1,0x9a3e9e1f22a7a400,0xa0722364a3d921a8
.quad 0xa3f322419d499b1f,0x20428000a0422335,0x9e892286a3f92335,0x23eca36420cf972a,0x21f79d49995c20fd,0x1c6ea1a823b0a3cd,0x22e4a3fd234da0fd,0xa21d1e1f1561a042
.quad 0x1b1fa33523359b1f,0x1b1f20fda40020fd,0xa1d0932d2264a3cd,0x234d9c6ea07223f3,0xa3b022c6995ca0fd,0x2300a38d1e1f1ef1,0x9bfe2300a39f1ef1,0x1879a28623d9a042
.quad 0x21a88000a1a82400,0xa1a8000021a8a400,0x23bfa3001cdc1ef1,0xa3ec22869a3ea042,0x1c6ea2c623e3a0fd,0x9fbd238da3641ef1,0xa17f132d20cfa3cd,0x1e891c6ea2a723f3
.quad 0xa3cd23359ef19b1f,0x23cda0fd000020fd,0x9cdc2286a3ff2241,0x221da3fd22a79d49,0x2155972a9fbd2335,0x932da0422364a3cd,0x23d9a36420728000,0xa2a71e1f1a3ea1a8
.quad 0x1d49a24123f3a335,0xa38d23cda1a81b1f,0xa129195c1db5a241,0x9cdc21f7a3d9238d,0xa3e3238da1551b1f,0x20a1972a9e1f2241,0x9db521f7a3bf23cd,0x23ffa3002072972a
.quad 0xa0fd9b1f2335a335,0x23359b1fa0fd2400,0xa3f920a11bfea335,0x23bfa286156121a8,0xa1f723f3a0a19b1f,0x20a1a3f321f78000,0x8f2e21f7a3f920fd,0x9561a15523ffa1a8
.quad 0x21a88000a1a82400,0xa1a8000021a8a400,0x23ffa1f7156120fd,0xa3f921550f2ea1a8,0x2155a3f322869b1f,0xa28623f3a1550000,0x9561a0a123bfa335,0x9bfe2286a3f921a8
.quad 0xa2411b1f1ef1a335,0x1ef11b1fa2412400,0xa3ec23009e899b1f,0x234d9fbd987921a8,0xa0a1238da3b020fd,0x23b0a38d20a18000,0x1a3e1e1fa2a72400,0x2072a36423d9a1a8
.quad 0x22c69ef1972a20fd,0x972a9ef122c6a400,0x23bfa3b0217f9b1f,0xa1d01c6e1bfea1a8,0x1fbda2c623fda335,0xa3fd22c69fbd0000,0x9cdc995c20cfa335,0xa26423e3a39f21a8
.quad 0xa40020fd1b1fa335,0x2335a3351b1f20fd,0xa2a723b09e899ef1,0x20cfa3fd217f172a,0x9e1f238da3001b1f,0x195ca2c623b09ef1,0x1a3e20a1a3ec2241,0x9cdc9fbd23bfa2c6
.quad 0x21a88000a1a82400,0xa1a8000021a8a400,0x23d9a0a198792241,0xa39f1fbd1bfea2c6,0x2364a38d1fbd1b1f,0xa3e322c69c6e9ef1,0x2072a3b0234d9ef1,0xa26423fda1d0172a
.quad 0x8000a0fd23cda335,0x9ef12335a3cd20fd,0xa072932d2129a3cd,0xf2e20a1a39f238d,0xa3642042132da0fd,0x1fbd172aa15523cd,0xa3d92364a0720000,0x22a79e1f9a3e21a8
.quad 0xa1a823cda38d20fd,0x23f3a2411d491b1f,0x9a3e2155a39f23cd,0x2379a3e3221d9d49,0x1e1f172aa0a12335,0x2155a38d23e3a241,0x22a79fbd0f2e1ef1,0x1bfea1552379a3f3
.quad 0xa0fd2400a0fd9b1f,0x1b1fa33523359b1f,0x9cdc2364a31c1b1f,0x8f2ea1f723eca042,0x132d21a8a3fd20fd,0x9c6ea04223e3a241,0x1e891e1fa3792335,0xa0119c6e231ca38d
.quad 0x21a88000a1a82400,0xa1a8000021a8a400,0x234d9e1f9db52335,0xa2e41c6e1f58a38d,0x23fda1a8132d20fd,0xa3b02042195ca241,0x239fa3641f581b1f,0xa3ff21f79879a042
.quad 0x2241a40022419b1f,0xa3cd23359ef19b1f,0x2011a36423bfa0fd,0xa31c23e3a17f172a,0x195ca1a823e3a335,0xa1f723f3a3001ef1,0x9a3e9e1f22a7a400,0xa0722364a3d921a8
.quad 0xa04200002042a335,0x9d492241a3f32335,0xa2641e1f1879a0fd,0x956120a1a34d23f3,0xa3b021a89c6e9b1f,0x195c1d49a1f723cd,0xa3f92364a1291b1f,0x1e89132da01122c6
.quad 0x1b1f20fda40020fd,0xa0fd9b1f2335a335,0x1db51fbda3d92241,0xa129995c22e4a38d,0x1fbd1d49a3642335,0xa155972a2286a3cd,0x20cf195ca2a723cd,0xa17f932d221da3f3
.quad 0x21a88000a1a82400,0xa1a8000021a8a400,0x2264995ca07223cd,0xa1d0132d2129a3f3,0x23009d499e1f2335,0xa1f7172a20a1a3cd,0x23799fbd9a3e2241,0xa21d195c2011a38d
.quad 0x23cda0fd000020fd,0xa2411b1f1ef1a335,0x23f9a1f71a3e1ef1,0xa2641c6e1db5a2c6,0x23fda2c61e1f1b1f,0xa2861d491c6ea241,0x23d9a36420728000,0xa2a71e1f1a3ea1a8
.quad 0x238da3cd21a89b1f,0xa2c61ef1172aa0fd,0x231ca3fd22a79ef1,0xa2e41fbd0f2ea042,0x2286a3f32364a0fd,0xa3002042932d9ef1,0x21d0a3b023d9a241,0xa31c20a198799d49
.quad 0x9ef123cda2418000,0x8000a24123cd9ef1,0xa01123e3a21d8000,0x1a3ea30023799d49,0xa0a123f3a1f78000,0x1e1fa38d23009b1f,0xa12923fda1d08000,0x2072a3e32264972a
.quad 0xa1a82400a1a88000,0x21a8a40021a88000,0xa21d23fda17f8000,0x22a7a3e320cf172a,0xa28623f3a1558000,0x2364a38d1fbd1b1f,0xa2e423e3a1298000,0x23d9a3001db51d49
.quad 0xa33523cda0fd8000,0x2400a2411b1f1ef1,0xa37923b0a0cf8000,0x23d9a15515612042,0xa3b0238da0a18000,0x2364a042932d20fd,0xa3d92364a0728000,0x22a79e1f9a3e21a8
.quad 0xa3f32335a0428000,0x21a89b1f9d492241,0xa3ff2300a0118000,0x2072932d9f5822c6,0xa3fd22c69fbd8000,0x1e1f172aa0a12335,0xa3ec22869f588000,0x1a3e1c6ea17f238d
.quad 0x1ef11ef1a3cd2241,0xa24180002241a3cd,0x18792155a3ff20fd,0x9f589e1f239fa2c6,0x995c22c6a3b01ef1,0x932da1a823fda0fd,0x9f5823b0a2e41b1f,0x1db5a364234d9d49
.quad 0xa1a82400a1a88000,0x21a8a40021a88000,0xa31c23b0a0119b1f,0x2379a3641e891d49,0xa3e322c69c6e9ef1,0x23fda1a8132d20fd,0xa3ec21558f2ea0fd,0x231c9e1f9cdc22c6
.quad 0xa3351ef11b1fa241,0x20fd8000a0fd23cd,0xa1d0195c1f58a335,0x1bfe1e1fa2e423f3,0x9fbd972a2155a3cd,0x995c21a8a3e32335,0x9a3e9e1f22a7a400,0xa0722364a3d921a8
.quad 0x172aa0fd238da3cd,0xa2c62400a2c61ef1,0x1e89a28623f9a335,0xa3ec2364a0cf172a,0x2155a38d23e3a241,0xa3b021a89c6e9b1f,0x22e4a3fd234da0fd,0xa21d1e1f1561a042
.quad 0x23cd9ef19ef123cd,0xa3cd22418000a241,0x21d0132da26423cd,0xa34d1c6e2072a3f3,0x1c6e2042a3e32241,0x9fbd9d492364a335,0x9bfe2300a39f1ef1,0x1879a28623d9a042
.quad 0xa1a82400a1a88000,0x21a8a40021a88000,0xa3bf23009cdc9ef1,0x23eca2861a3e2042,0xa3b02042195ca241,0x23009d499e1f2335,0xa17f132d20cfa3cd,0x1e891c6ea2a723f3
.quad 0x9b1f9ef12335a3cd,0x9b1f2241a4002241,0x1cdca28623ffa241,0xa21d23fda2a71d49,0x21f7a3f323009ef1,0xa3fd22c69e1f9b1f,0x23d9a36420728000,0xa2a71e1f1a3ea1a8
.quad 0x238da0fd172a1ef1,0x9d499b1f21a8a3cd,0x2129995c9db52241,0x1cdca1f723d9a38d,0x195c1d49a1f723cd,0x2286a3f32364a0fd,0x9db521f7a3bf23cd,0x23ffa3002072972a
.quad 0x2241a3cd1ef11ef1,0x9ef123cda2418000,0x23f9a0a19bfe2335,0xa3bf22869561a1a8,0x2155172aa28623cd,0xa286172a2155a400,0x8f2e21f7a3f920fd,0x9561a15523ffa1a8
.quad 0xa1a82400a1a88000,0x21a8a40021a88000,0xa3ff21f79561a0fd,0x23f9a1558f2e21a8,0xa1f7172a20a1a3cd,0x20a1172aa1f72400,0x9561a0a123bfa335,0x9bfe2286a3f921a8
.quad 0x20fda3cd23359ef1,0xa33523cda0fd8000,0x23eca3001e891b1f,0xa34d1fbd1879a1a8,0x22869d499c6e2241,0x9c6e9d492286a400,0x1a3e1e1fa2a72400,0x2072a36423d9a1a8
.quad 0xa0422335a3f32241,0x23f3a33520428000,0xa3bf23b0a17f1b1f,0x21d09c6e9bfe21a8,0xa3002042932d9ef1,0x932d2042a3002400,0x9cdc995c20cfa335,0xa26423e3a39f21a8
.quad 0x8000a24123cd9ef1,0x1ef11ef1a3cd2241,0x22a7a3b01e891ef1,0xa0cf23fda17f972a,0x23649d499fbd23cd,0xa3e320421c6ea335,0x1a3e20a1a3ec2241,0x9cdc9fbd23bfa2c6
.quad 0xa1a82400a1a88000,0x21a8a40021a88000,0xa3d920a11879a241,0x239f9fbd9bfe22c6,0x9e1f9d492300a3cd,0x195c2042a3b02335,0x2072a3b0234d9ef1,0xa26423fda1d0172a
.quad 0x2400a2411b1f1ef1,0xa3351ef11b1fa241,0x2072132da12923cd,0x8f2ea0a1239fa38d,0x9e1f22c6a3fd2241,0x2300a3f321f79b1f,0xa3d92364a0728000,0x22a79e1f9a3e21a8
.quad 0xa1a81b1f1d49a241,0x972a20fda38d23cd,0x1a3ea155239fa3cd,0xa37923e3a21d1d49,0x2364a3f322869ef1,0xa1f71d49195ca0fd,0x22a79fbd0f2e1ef1,0x1bfea1552379a3f3
.quad 0xa24180002241a3cd,0x23cd9ef19ef123cd,0x1cdca364231c9b1f,0xf2e21f7a3ec2042,0x23fda1a8932d2241,0xa3b022c6995ca0fd,0x1e891e1fa3792335,0xa0119c6e231ca38d
.quad 0xa1a82400a1a88000,0x21a8a40021a88000,0xa34d1e1f1db5a335,0x22e49c6e9f58238d,0x132da1a823fda241,0x9c6e22c6a3e320fd,0x239fa3641f581b1f,0xa3ff21f79879a042
.quad 0x20fd8000a0fd23cd,0x9b1f9ef12335a3cd,0xa0112364a3bf20fd,0x231ca3e3217f972a,0xa3e321a8995c9ef1,0x2155972a9fbd2335,0x9a3e9e1f22a7a400,0xa0722364a3d921a8
.quad 0x22c6a40022c69ef1,0xa38d20fd972a9ef1,0x22649e1f987920fd,0x1561a0a1234da3f3,0x9c6e21a8a3b023cd,0x23e3a38d21559b1f,0xa3f92364a1291b1f,0x1e89132da01122c6
.quad 0xa3cd22418000a241,0x2241a3cd1ef11ef1,0x9db59fbd23d9a241,0x2129195ca2e4238d,0x2300a38d1e1f1ef1,0xa1f723f3a0a19b1f,0x20cf195ca2a723cd,0xa17f932d221da3f3
.quad 0xa1a82400a1a88000,0x21a8a40021a88000,0xa264195c2072a3cd,0x21d0932da12923f3,0x1fbda38d23649ef1,0xa15523f3a2861b1f,0x23799fbd9a3e2241,0xa21d195c2011a38d
.quad 0x9b1f2241a4002241,0x20fda3cd23359ef1,0xa3f921f79a3e9ef1,0x22649c6e9db522c6,0x932da0422364a3cd,0xa0a1238da3b020fd,0x23d9a36420728000,0xa2a71e1f1a3ea1a8
.quad 0x1d491b1fa1a823cd,0x2042a33523f3a241,0xa31c23fda2a71ef1,0x22e49fbd8f2e2042,0xa0a1172a1e1fa241,0x9fbd22c6a3fd2335,0x21d0a3b023d9a241,0xa31c20a198799d49
.quad 0x9ef123cda2418000,0x8000a24123cd9ef1,0xa2e4195c2129a400,0x23d99fbd9db5238d,0x20a1a3f321f78000,0x9e1f238da3001b1f,0x221d932da17f2400,0xa2a7195c20cfa3f3
.quad 0xa1a82400a1a88000,0x21a8a40021a88000,0xa129932d21d0a400,0x2072195ca26423f3,0x2286a3f321558000,0xa364238d9fbd9b1f,0x2011195ca21d2400,0x9a3e9fbd2379a38d
.quad 0xa33523cda0fd8000,0x2400a2411b1f1ef1,0x9db59c6e2264a400,0x9a3e21f7a3f922c6,0x23b0a38d20a18000,0xa3642042132da0fd,0x1a3e1e1fa2a72400,0x2072a36423d9a1a8
.quad 0xa3f32335a0428000,0x21a89b1f9d492241,0x8f2e9fbd22e4a400,0xa2a723fda31c2042,0x23fda2c61fbd8000,0x9e1f972a20a1a335,0x987920a1a31c2400,0x23d9a3b021d09d49
.quad 0x1ef11ef1a3cd2241,0xa24180002241a3cd,0xa3ec21f70f2ea241,0x231ca3641cdc2042,0x195ca2c623b09ef1,0x132d21a8a3fd20fd,0x231c9c6ea01123cd,0xa3791e1f1e89a38d
.quad 0xa1a82400a1a88000,0x21a8a40021a88000,0x9f589c6e22e4a3cd,0x1db51e1fa34d238d,0x23e3a2c61c6e1ef1,0xa3fd21a8932da0fd,0x987921f7a3ff2241,0x1f58a364239fa042
.quad 0xa3351ef11b1fa241,0x20fd8000a0fd23cd,0x217fa3e3231c9ef1,0xa3bf2364a011972a,0x1fbd172aa15523cd,0x195ca1a823e3a335,0xa3d92364a0728000,0x22a79e1f9a3e21a8
.quad 0x172aa0fd238da3cd,0xa2c62400a2c61ef1,0x234da0a115611ef1,0x98799e1f2264a3f3,0xa155238da3e32241,0x23b0a1a81c6e1b1f,0xa011132d1e89a241,0xa1292364a3f922c6
.quad 0x23cd9ef19ef123cd,0xa3cd22418000a241,0xa17f23fda0cf9b1f,0x1e89a3b022a7972a,0x9c6ea04223e3a241,0x1fbd1d49a3642335,0x23bf9fbd9cdc2335,0xa3ec20a11a3ea2c6
.quad 0xa1a82400a1a88000,0x21a8a40021a88000,0x9bfe9fbd239fa335,0x187920a1a3d922c6,0x23b0a042995c2241,0xa3001d491e1fa335,0xa1d023fda2641b1f,0x234da3b02072172a
.quad 0x9b1f9ef12335a3cd,0x9b1f2241a4002241,0x239fa0a18f2e20fd,0xa129132d2072a38d,0xa1f723f3a3001ef1,0x23fda2c61e1f1b1f,0x9a3e9e1f22a7a400,0xa0722364a3d921a8
.quad 0x238da0fd172a1ef1,0x9d499b1f21a8a3cd,0xa21d23e3a37920fd,0x239fa1551a3e1d49,0x995c9d4921f7a3cd,0xa28623f3a36420fd,0x2379a1551bfe1b1f,0xf2e9fbd22a7a3f3
.quad 0x2241a3cd1ef11ef1,0x9ef123cda2418000,0x95612286a3bf1ef1,0x9bfea0a123f9a1a8,0xa155972a2286a3cd,0x2286972aa1552400,0x23ffa15595612241,0xa3f921f78f2ea1a8
.quad 0xa1a82400a1a88000,0x21a8a40021a88000,0x8f2ea15523f9a241,0x956121f7a3ff21a8,0x21f7972aa0a123cd,0xa0a1972a21f7a400,0xa3f922869bfe9ef1,0x23bfa0a1956121a8
.quad 0x20fda3cd23359ef1,0xa33523cda0fd8000,0x18791fbda34d23cd,0x1e89a30023eca1a8,0xa2861d491c6ea241,0x1c6e1d49a2862400,0x23d9a36420728000,0xa2a71e1f1a3ea1a8
.quad 0xa0422335a3f32241,0x23f3a33520428000,0x9bfe9c6e21d0a3cd,0xa17f23b0a3bf21a8,0x2300a042132d1ef1,0x132da0422300a400,0xa39f23e3a2641ef1,0x20cf995c9cdc21a8
.quad 0x8000a24123cd9ef1,0x1ef11ef1a3cd2241,0x20721c6ea34d2335,0xa264132d21d0a3f3,0xa3641d491fbda3cd,0x23e3a0429c6e2335,0x23d9a286187920fd,0xa39f23009bfea042
.quad 0xa1a82400a1a88000,0x21a8a40021a88000,0x1a3ea28623eca0fd,0x9cdc2300a3bf2042,0x1e1f1d49a30023cd,0x995ca04223b0a335,0xa2a71c6e1e89a335,0x20cf132da17f23f3
.quad 0x2400a2411b1f1ef1,0xa3351ef11b1fa241,0xa2a723fda21d1b1f,0x23ffa2861cdc1d49,0x1e1fa2c623fda241,0xa30023f3a1f71b1f,0x1a3e1e1fa2a72400,0x2072a36423d9a1a8
.quad 0xa1a81b1f1d49a241,0x972a20fda38d23cd,0x23d9a1f71cdc1b1f,0x9db5995c2129a38d,0xa36423f3a2861ef1,0x21f79d49995c20fd,0x2072a30023ffa335,0xa3bf21f79db5972a
.quad 0xa24180002241a3cd,0x23cd9ef19ef123cd,0x239f9e1f9f5823cd,0xa3ff21551879a2c6,0xa3fd21a8132da241,0x23b0a2c6195c20fd,0x234da3641db51ef1,0xa2e423b09f589d49
.quad 0xa1a82400a1a88000,0x21a8a40021a88000,0x1e89a36423799ef1,0xa01123b0a31c1d49,0x932d21a8a3fd2241,0x1c6ea2c623e3a0fd,0x9cdc9e1f231ca3cd,0x8f2e2155a3ec22c6
.quad 0x20fd8000a0fd23cd,0x9b1f9ef12335a3cd,0xa2e41e1f1bfea241,0x1f58195ca1d023f3,0x23e3a1a8195c1ef1,0xa155172a1fbda335,0xa3d92364a0728000,0x22a79e1f9a3e21a8
.quad 0x22c6a40022c69ef1,0xa38d20fd972a9ef1,0xa0cf2364a3ec2241,0x23f9a2861e89172a,0x1c6ea1a823b0a3cd,0xa3e3238da1551b1f,0x15611e1fa21d23cd,0x234da3fd22e4a042
.quad 0xa3cd22418000a241,0x2241a3cd1ef11ef1,0x2379a3001a3e20fd,0xa21d23e3a0119d49,0xa300238d9e1f9ef1,0x21f7a3f320a11b1f,0x2264a3e320721b1f,0xa1d023fda129972a
.quad 0xa1a82400a1a88000,0x21a8a40021a88000,0x20cfa3e322a79b1f,0xa17f23fda21d172a,0x9fbd238da3641ef1,0x2155a3f322869b1f,0x1db5a30023d9a0fd,0xa12923e3a2e41d49
.quad 0x9b1f2241a4002241,0x20fda3cd23359ef1,0x1561a15523d9a335,0xa0cf23b0a3792042,0x132d2042a36423cd,0x20a1a38d23b0a0fd,0x9a3e9e1f22a7a400,0xa0722364a3d921a8
.quad 0x1d491b1fa1a823cd,0x2042a33523f3a241,0x9f58932d2072a335,0xa0112300a3ff22c6,0x20a1972a9e1f2241,0x1fbda2c623fda335,0xa17f1c6e1a3ea0fd,0x9f582286a3ec238d
.quad 0x9ef123cda2418000,0x8000a24123cd9ef1,0x2011a3e3221d8000,0x9a3e2300a3791d49,0xa0a123f3a1f78000,0x1e1fa38d23009b1f,0x2129a3fd21d08000,0xa07223e3a264172a
.quad 0xa1a82400a1a88000,0x21a8a40021a88000,0x221da3fd217f8000,0xa2a723e3a0cf972a,0xa28623f3a1558000,0x2364a38d1fbd1b1f,0x22e4a3e321298000,0xa3d923009db59d49
.quad 0xa33523cda0fd8000,0x2400a2411b1f1ef1,0x2379a3b020cf8000,0xa3d921559561a042,0xa3b0238da0a18000,0x2364a042932d20fd,0x23d9a36420728000,0xa2a71e1f1a3ea1a8
.quad 0xa3f32335a0428000,0x21a89b1f9d492241,0x23ffa30020118000,0xa072132d1f58a2c6,0xa3fd22c69fbd8000,0x1e1f172aa0a12335,0x23eca2861f588000,0x9a3e9c6e217fa38d
.quad 0x1ef11ef1a3cd2241,0xa24180002241a3cd,0x9879a15523ffa0fd,0x1f581e1fa39f22c6,0x995c22c6a3b01ef1,0x932da1a823fda0fd,0x1f58a3b022e49b1f,0x9db52364a34d1d49
.quad 0xa1a82400a1a88000,0x21a8a40021a88000,0x231ca3b020111b1f,0xa37923649e899d49,0xa3e322c69c6e9ef1,0x23fda1a8132d20fd,0x23eca1550f2e20fd,0xa31c1e1f1cdca2c6
.quad 0xa3351ef11b1fa241,0x20fd8000a0fd23cd,0x21d0995c9f582335,0x9bfe9e1f22e4a3f3,0x9fbd972a2155a3cd,0x995c21a8a3e32335,0x1a3e1e1fa2a72400,0x2072a36423d9a1a8
.quad 0x172aa0fd238da3cd,0xa2c62400a2c61ef1,0x9e892286a3f92335,0x23eca36420cf972a,0x2155a38d23e3a241,0xa3b021a89c6e9b1f,0xa2e423fda34d20fd,0x221d9e1f95612042
.quad 0x23cd9ef19ef123cd,0xa3cd22418000a241,0xa1d0932d2264a3cd,0x234d9c6ea07223f3,0x1c6e2042a3e32241,0x9fbd9d492364a335,0x1bfea300239f9ef1,0x98792286a3d92042
.quad 0xa1a82400a1a88000,0x21a8a40021a88000,0x23bfa3001cdc1ef1,0xa3ec22869a3ea042,0xa3b02042195ca241,0x23009d499e1f2335,0x217f932da0cf23cd,0x9e899c6e22a7a3f3
.quad 0x9b1f9ef12335a3cd,0x9b1f2241a4002241,0x9cdc2286a3ff2241,0x221da3fd22a79d49,0x21f7a3f323009ef1,0xa3fd22c69e1f9b1f,0xa3d92364a0728000,0x22a79e1f9a3e21a8
.quad 0x238da0fd172a1ef1,0x9d499b1f21a8a3cd,0xa129195c1db5a241,0x9cdc21f7a3d9238d,0x195c1d49a1f723cd,0x2286a3f32364a0fd,0x1db5a1f723bfa3cd,0xa3ff2300a072172a
.quad 0x2241a3cd1ef11ef1,0x9ef123cda2418000,0xa3f920a11bfea335,0x23bfa286156121a8,0x2155172aa28623cd,0xa286172a2155a400,0xf2ea1f723f9a0fd,0x15612155a3ff21a8
.quad 0xa1a82400a1a88000,0x21a8a40021a88000,0x23ffa1f7156120fd,0xa3f921550f2ea1a8,0xa1f7172a20a1a3cd,0x20a1172aa1f72400,0x156120a1a3bf2335,0x1bfea28623f9a1a8
.quad 0x20fda3cd23359ef1,0xa33523cda0fd8000,0xa3ec23009e899b1f,0x234d9fbd987921a8,0x22869d499c6e2241,0x9c6e9d492286a400,0x9a3e9e1f22a7a400,0xa0722364a3d921a8
.quad 0xa0422335a3f32241,0x23f3a33520428000,0x23bfa3b0217f9b1f,0xa1d01c6e1bfea1a8,0xa3002042932d9ef1,0x932d2042a3002400,0x1cdc195ca0cf2335,0x2264a3e3239fa1a8
.quad 0x8000a24123cd9ef1,0x1ef11ef1a3cd2241,0xa2a723b09e899ef1,0x20cfa3fd217f172a,0x23649d499fbd23cd,0xa3e320421c6ea335,0x9a3ea0a123eca241,0x1cdc1fbda3bf22c6
.quad 0xa1a82400a1a88000,0x21a8a40021a88000,0x23d9a0a198792241,0xa39f1fbd1bfea2c6,0x9e1f9d492300a3cd,0x195c2042a3b02335,0xa07223b0a34d1ef1,0x2264a3fd21d0972a
.quad 0x2400a2411b1f1ef1,0xa3351ef11b1fa241,0xa072932d2129a3cd,0xf2e20a1a39f238d,0x9e1f22c6a3fd2241,0x2300a3f321f79b1f,0x23d9a36420728000,0xa2a71e1f1a3ea1a8
.quad 0xa1a81b1f1d49a241,0x972a20fda38d23cd,0x9a3e2155a39f23cd,0x2379a3e3221d9d49,0x2364a3f322869ef1,0xa1f71d49195ca0fd,0xa2a71fbd8f2e9ef1,0x9bfe2155a37923f3
.quad 0xa24180002241a3cd,0x23cd9ef19ef123cd,0x9cdc2364a31c1b1f,0x8f2ea1f723eca042,0x23fda1a8932d2241,0xa3b022c6995ca0fd,0x9e899e1f2379a335,0x20111c6ea31c238d
.quad 0xa1a82400a1a88000,0x21a8a40021a88000,0x234d9e1f9db52335,0xa2e41c6e1f58a38d,0x132da1a823fda241,0x9c6e22c6a3e320fd,0xa39f23649f589b1f,0x23ffa1f718792042
.quad 0x20fd8000a0fd23cd,0x9b1f9ef12335a3cd,0x2011a36423bfa0fd,0xa31c23e3a17f172a,0xa3e321a8995c9ef1,0x2155972a9fbd2335,0x1a3e1e1fa2a72400,0x2072a36423d9a1a8
.quad 0x22c6a40022c69ef1,0xa38d20fd972a9ef1,0xa2641e1f1879a0fd,0x956120a1a34d23f3,0x9c6e21a8a3b023cd,0x23e3a38d21559b1f,0x23f9a36421299b1f,0x9e89932d2011a2c6
.quad 0xa3cd22418000a241,0x2241a3cd1ef11ef1,0x1db51fbda3d92241,0xa129995c22e4a38d,0x2300a38d1e1f1ef1,0xa1f723f3a0a19b1f,0xa0cf995c22a7a3cd,0x217f132da21d23f3
.quad 0xa1a82400a1a88000,0x21a8a40021a88000,0x2264995ca07223cd,0xa1d0132d2129a3f3,0x1fbda38d23649ef1,0xa15523f3a2861b1f,0xa3791fbd1a3ea241,0x221d995ca011238d
.quad 0x9b1f2241a4002241,0x20fda3cd23359ef1,0x23f9a1f71a3e1ef1,0xa2641c6e1db5a2c6,0x932da0422364a3cd,0xa0a1238da3b020fd,0xa3d92364a0728000,0x22a79e1f9a3e21a8
.quad 0x1d491b1fa1a823cd,0x2042a33523f3a241,0x231ca3fd22a79ef1,0xa2e41fbd0f2ea042,0xa0a1172a1e1fa241,0x9fbd22c6a3fd2335,0xa1d023b0a3d92241,0x231ca0a118791d49
.quad 0x9ef123cda2418000,0x8000a24123cd9ef1,0x22e4995ca1292400,0xa3d91fbd1db5a38d,0x20a1a3f321f78000,0x9e1f238da3001b1f,0xa21d132d217fa400,0x22a7995ca0cf23f3
.quad 0xa1a82400a1a88000,0x21a8a40021a88000,0x2129132da1d02400,0xa072995c2264a3f3,0x2286a3f321558000,0xa364238d9fbd9b1f,0xa011995c221da400,0x1a3e1fbda379238d
.quad 0xa33523cda0fd8000,0x2400a2411b1f1ef1,0x1db51c6ea2642400,0x1a3ea1f723f9a2c6,0x23b0a38d20a18000,0xa3642042132da0fd,0x9a3e9e1f22a7a400,0xa0722364a3d921a8
.quad 0xa3f32335a0428000,0x21a89b1f9d492241,0xf2e1fbda2e42400,0x22a7a3fd231ca042,0x23fda2c61fbd8000,0x9e1f972a20a1a335,0x1879a0a1231ca400,0xa3d923b0a1d01d49
.quad 0x1ef11ef1a3cd2241,0xa24180002241a3cd,0x23eca1f78f2e2241,0xa31c23649cdca042,0x195ca2c623b09ef1,0x132d21a8a3fd20fd,0xa31c1c6e2011a3cd,0x23799e1f9e89238d
.quad 0xa1a82400a1a88000,0x21a8a40021a88000,0x1f581c6ea2e423cd,0x9db59e1f234da38d,0x23e3a2c61c6e1ef1,0xa3fd21a8932da0fd,0x1879a1f723ffa241,0x9f582364a39f2042
.quad 0xa3351ef11b1fa241,0x20fd8000a0fd23cd,0xa17f23e3a31c1ef1,0x23bfa3642011172a,0x1fbd172aa15523cd,0x195ca1a823e3a335,0x23d9a36420728000,0xa2a71e1f1a3ea1a8
.quad 0x172aa0fd238da3cd,0xa2c62400a2c61ef1,0xa34d20a195619ef1,0x18791e1fa26423f3,0xa155238da3e32241,0x23b0a1a81c6e1b1f,0x2011932d9e892241,0x2129a36423f9a2c6
.quad 0x23cd9ef19ef123cd,0xa3cd22418000a241,0x217fa3fd20cf1b1f,0x9e8923b0a2a7172a,0x9c6ea04223e3a241,0x1fbd1d49a3642335,0xa3bf1fbd1cdca335,0x23eca0a19a3e22c6
.quad 0xa1a82400a1a88000,0x21a8a40021a88000,0x1bfe1fbda39f2335,0x9879a0a123d9a2c6,0x23b0a042995c2241,0xa3001d491e1fa335,0x21d0a3fd22649b1f,0xa34d23b0a072972a
.quad 0x9b1f9ef12335a3cd,0x9b1f2241a4002241,0xa39f20a10f2ea0fd,0x2129932da072238d,0xa1f723f3a3001ef1,0x23fda2c61e1f1b1f,0x1a3e1e1fa2a72400,0x2072a36423d9a1a8
.quad 0x238da0fd172a1ef1,0x9d499b1f21a8a3cd,0x221da3e32379a0fd,0xa39f21559a3e9d49,0x995c9d4921f7a3cd,0xa28623f3a36420fd,0xa37921559bfe9b1f,0x8f2e1fbda2a723f3
.quad 0x2241a3cd1ef11ef1,0x9ef123cda2418000,0x1561a28623bf9ef1,0x1bfe20a1a3f921a8,0xa155972a2286a3cd,0x2286972aa1552400,0xa3ff21551561a241,0x23f9a1f70f2e21a8
.quad 0xa1a82400a1a88000,0x21a8a40021a88000,0xf2e2155a3f92241,0x1561a1f723ffa1a8,0x21f7972aa0a123cd,0xa0a1972a21f7a400,0x23f9a2861bfe1ef1,0xa3bf20a11561a1a8
.quad 0x20fda3cd23359ef1,0xa33523cda0fd8000,0x98799fbd234da3cd,0x9e892300a3ec21a8,0xa2861d491c6ea241,0x1c6e1d49a2862400,0xa3d92364a0728000,0x22a79e1f9a3e21a8
.quad 0xa0422335a3f32241,0x23f3a33520428000,0x1bfe1c6ea1d023cd,0x217fa3b023bfa1a8,0x2300a042132d1ef1,0x132da0422300a400,0x239fa3e322649ef1,0xa0cf195c1cdca1a8
.quad 0x8000a24123cd9ef1,0x1ef11ef1a3cd2241,0xa0729c6e234da335,0x2264932da1d023f3,0xa3641d491fbda3cd,0x23e3a0429c6e2335,0xa3d922869879a0fd,0x239fa3001bfe2042
.quad 0xa1a82400a1a88000,0x21a8a40021a88000,0x9a3e2286a3ec20fd,0x1cdca30023bfa042,0x1e1f1d49a30023cd,0x995ca04223b0a335,0x22a79c6e9e892335,0xa0cf932d217fa3f3
.quad 0x2400a2411b1f1ef1,0xa3351ef11b1fa241,0x22a7a3fd221d9b1f,0xa3ff22869cdc9d49,0x1e1fa2c623fda241,0xa30023f3a1f71b1f,0x9a3e9e1f22a7a400,0xa0722364a3d921a8
.quad 0xa1a81b1f1d49a241,0x972a20fda38d23cd,0xa3d921f79cdc9b1f,0x1db5195ca129238d,0xa36423f3a2861ef1,0x21f79d49995c20fd,0xa0722300a3ff2335,0x23bfa1f71db5172a
.quad 0xa24180002241a3cd,0x23cd9ef19ef123cd,0xa39f1e1f1f58a3cd,0x23ffa155987922c6,0xa3fd21a8132da241,0x23b0a2c6195c20fd,0xa34d23649db59ef1,0x22e4a3b01f581d49
.quad 0xa1a82400a1a88000,0x21a8a40021a88000,0x9e892364a3791ef1,0x2011a3b0231c9d49,0x932d21a8a3fd2241,0x1c6ea2c623e3a0fd,0x1cdc1e1fa31c23cd,0xf2ea15523eca2c6
.quad 0x20fd8000a0fd23cd,0x9b1f9ef12335a3cd,0x22e49e1f9bfe2241,0x9f58995c21d0a3f3,0x23e3a1a8195c1ef1,0xa155172a1fbda335,0x23d9a36420728000,0xa2a71e1f1a3ea1a8
.quad 0x22c6a40022c69ef1,0xa38d20fd972a9ef1,0x20cfa36423eca241,0xa3f922869e89972a,0x1c6ea1a823b0a3cd,0xa3e3238da1551b1f,0x95619e1f221da3cd,0xa34d23fda2e42042
.quad 0xa3cd22418000a241,0x2241a3cd1ef11ef1,0xa37923009a3ea0fd,0x221da3e320111d49,0xa300238d9e1f9ef1,0x21f7a3f320a11b1f,0xa26423e3a0729b1f,0x21d0a3fd2129172a
.quad 0xa1a82400a1a88000,0x21a8a40021a88000,0xa0cf23e3a2a71b1f,0x217fa3fd221d972a,0x9fbd238da3641ef1,0x2155a3f322869b1f,0x9db52300a3d920fd,0x2129a3e322e49d49
.quad 0x9b1f2241a4002241,0x20fda3cd23359ef1,0x95612155a3d92335,0x20cfa3b02379a042,0x132d2042a36423cd,0x20a1a38d23b0a0fd,0x1a3e1e1fa2a72400,0x2072a36423d9a1a8
.quad 0x1d491b1fa1a823cd,0x2042a33523f3a241,0x1f58132da0722335,0x2011a30023ffa2c6,0x20a1972a9e1f2241,0x1fbda2c623fda335,0x217f9c6e9a3e20fd,0x1f58a28623eca38d
.quad 0x9b1f20fda3352400,0x2400a33520fd9b1f,0x9cdc2155a34d2400,0x23d9a2862011972a,0x9e1f21a8a3642400,0x2364a1a81e1f8000,0x9f5821f7a3792400,0x22a7a0a11bfe172a
.quad 0xa0422241a38d2400,0x21a89ef1172a1b1f,0xa0cf2286a39f2400,0x20729c6e8f2e1d49,0xa15522c6a3b02400,0x1e1f972a995c1ef1,0xa1d02300a3bf2400,0x1a3e132d9cdc2042
.quad 0xa2412335a3cd2400,0x1b1f9ef120fd,0xa2a72364a3d92400,0x9a3e1e1fa07221a8,0xa300238da3e32400,0x9e1f2042a1552241,0xa34d23b0a3ec2400,0xa0722155a21d22c6
.quad 0xa38d23cda3f32400,0xa1a82241a2c62335,0xa3bf23e3a3f92400,0xa2a72300a34d238d,0xa3e323f3a3fd2400,0xa364238da3b023cd,0xa3f923fda3ff2400,0xa3d923e3a3ec23f3
.quad 0x9b1f9b1f20fda335,0xa3352400a33520fd,0x15619fbd2264a3cd,0xa3ff2364a17f1d49,0x1e1fa1a82364a400,0xa36421a89e1f0000,0x2129a30023eca3cd,0xa17f1e1f8f2e9d49
.quad 0x22c6a3cd23f3a335,0x9d4900001d49a0fd,0x23bfa3fd2379a241,0x15619e1f2129a2c6,0x23fda38d2286a0fd,0x1fbda1a82300a3cd,0x2379a28621299ef1,0x2264a36423eca3f3
.quad 0x2241a0fd1ef19b1f,0x23cda40023cda335,0x20729e1f1a3e8000,0x23d9a36422a7a1a8,0x1c6e972a932d1b1f,0x2286a1a820a19ef1,0x8f2e195c9cdc1ef1,0x20119e1f1bfe972a
.quad 0x9d491ef1a04220fd,0x172a8000972a1b1f,0xa0cf2155a1d02241,0x9cdc1e1f9f582042,0xa28622c6a3002335,0xa15521a8a1f72241,0xa39f23b0a3bf23cd,0xa34d2364a379238d
.quad 0x20fd9b1f9b1f20fd,0x20fda3352400a335,0x18791c6ea1292335,0x23bfa3e322a7a042,0x9e1f21a8a3642400,0x2364a1a81e1f8000,0xa26423b0a3f92335,0x2011995c9a3e2042
.quad 0xa3f323cda2c620fd,0x972a1ef1a1a82335,0xa34d21f7a0111b1f,0xa17f2300a3d923f3,0xa0a11d49932d9b1f,0xa3e323f3a3642241,0x9561995c1e89a0fd,0xa31c21f7a0721d49
.quad 0x1ef1a0fd2241a335,0x9ef11b1f80009b1f,0x22a7a36423d9a400,0x1a3e9e1f2072a1a8,0x23fda3f323b0a335,0x21f7a2c62364a3cd,0x231ca28621d0a0fd,0x23f9a3fd23d9a38d
.quad 0x20429ef11d499b1f,0x22c6a24121a8a0fd,0xf2e132d98791b1f,0x1db59c6e1a3e972a,0x9fbd2042a0a120fd,0x9c6e1d499e1f1ef1,0xa2e42300a31c2335,0xa2642286a2a722c6
.quad 0xa33520fd9b1f9b1f,0x9b1f20fda3352400,0x9db5932d1f58a241,0xa31c23fda37921a8,0x1e1fa1a82364a400,0xa36421a89e1f0000,0x234da3fd239fa241,0x9cdc932d1e89a1a8
.quad 0x238da24120429b1f,0x2042a241238da400,0x1f58995c98791ef1,0x23eca3e3231ca1a8,0x9c6e2042a1f72335,0x21f7a0421c6e8000,0xa2e423b0a3ff23cd,0x8f2e1c6ea01121a8
.quad 0xa3cd2335a24120fd,0xa2412335a3cd2400,0xa0721e1f9a3e0000,0xa3d92364a2a721a8,0x195c9d491fbda0fd,0x9fbd1d49995c0000,0x2264a3002379a3cd,0x1db59fbd20cfa1a8
.quad 0x23f3a3cd238da335,0x238da3cd23f3a400,0x2129a0a120119ef1,0x22e4a286221da1a8,0x932d172a995c1b1f,0x195c972a132d8000,0xa1d021f7a21d2241,0xa1292155a17f21a8
.quad 0x2400a33520fd9b1f,0x9b1f9b1f20fda335,0x2072995c9bfe20fd,0x221da3b023eca2c6,0x9e1f21a8a3642400,0x2364a1a81e1f8000,0xa3d923e3a2e420fd,0x15611c6ea0cf22c6
.quad 0xa1a81ef1972a9b1f,0xa2c623cda3f32335,0x1a3e9fbd21d0a335,0xa2e421559e89172a,0x2364a3f323e3a335,0x132d9d4920a1a241,0x22a7a1551f589b1f,0x234da3e323f9a38d
.quad 0x1b1f9ef120fd,0x2241a0fd1ef19b1f,0xa2a72364a3d92400,0x9a3e1e1fa07221a8,0xa36422c6a1f720fd,0xa3b023f3a3fd23cd,0x9a3e132d15619b1f,0xa17f20a19f581d49
.quad 0x21a8a24122c6a335,0x1d499ef12042a0fd,0x23d9a3b02379a335,0x23eca3fd23ffa3f3,0x1e1f9d491c6e9b1f,0x20a1a0421fbd9ef1,0xa07220a1a0cf20fd,0x9f581fbda0112042
.quad 0xa3352400a33520fd,0x20fd9b1f9b1f20fd,0xa1d01e1f0f2e9ef1,0xa0cf2300a3f9238d,0x1e1fa1a82364a400,0xa36421a89e1f0000,0x23ffa36421d09ef1,0x18799fbd221da38d
.quad 0x1d4980009d4920fd,0x23f3a3cd22c6a0fd,0xa21d2364a3f923cd,0x1db5932d9bfe2042,0xa30021a89fbd1b1f,0xa286238da3fd23cd,0x18799e1f20cfa241,0xa21d20a19db5172a
.quad 0x23cda40023cda335,0x1ef1a0fd2241a335,0x20729e1f1a3e8000,0x23d9a36422a7a1a8,0xa0a121a8a2862335,0x132d172a9c6e1ef1,0xa3bf2364a2e42241,0xa39f23e3a3ff23f3
.quad 0x972a0000172a9b1f,0xa0421ef19d491b1f,0x231ca364239fa3cd,0x217fa1f72264a2c6,0x21f7a1a82155a0fd,0x2300a2c62286a241,0x9db51e1f9e891ef1,0x9bfe1c6e9cdc1d49
.quad 0x20fda3352400a335,0xa33520fd9b1f9b1f,0x22e4a0a11a3e1b1f,0x1e89a1f7239fa3f3,0x9e1f21a8a3642400,0x2364a1a81e1f8000,0xa3bf2286a0721b1f,0x9db52155a31c23f3
.quad 0x172a9ef121a8a335,0xa38d2241a0421b1f,0x23ffa3b022a7a0fd,0x1cdca0a12264a38d,0x195c172a9e1f20fd,0x23b0a2c621559ef1,0xa39f23fda3d92335,0x9bfe1fbda17f22c6
.quad 0x9ef11b1f80009b1f,0xa3cd2335a24120fd,0x22a7a36423d9a400,0x1a3e9e1f2072a1a8,0x2155a0421e1f9b1f,0x23e3a38d2300a241,0xa12921f7a2a72335,0x98791c6e9e892042
.quad 0xa2c62241a1a820fd,0xa3f323cda38d2335,0x1e899fbd2072a0fd,0x1561995c1bfe9d49,0x23b0a38d2364a335,0x23fda3f323e3a3cd,0x9879195c9a3e1b1f,0x8f2e132d9561172a
.quad 0x9b1f20fda3352400,0x2400a33520fd9b1f,0xa39f21f79e890000,0x9a3e20a1a2e423f3,0x1e1fa1a82364a400,0xa36421a89e1f0000,0x231ca1551db58000,0x2072a28623bfa3f3
.quad 0xa0422241a38d2400,0x21a89ef1172a1b1f,0xa26420a19cdc0000,0xa2a723b0a3ff238d,0x2155a2c623b0a400,0x9e1f172a195c9ef1,0x217f9fbd1bfe8000,0x23d9a3fd239fa2c6
.quad 0xa2412335a3cd2400,0x1b1f9ef120fd,0xa0721e1f9a3e0000,0xa3d92364a2a721a8,0x2300a38d23e3a400,0x1e1fa0422155a241,0x1e899c6e18798000,0x22a7a1f72129a042
.quad 0xa38d23cda3f32400,0xa1a82241a2c62335,0x9bfe195c95610000,0xa0721fbd9e891d49,0x23e3a3f323fda400,0x2364a38d23b0a3cd,0x1561932d0f2e8000,0x1a3e995c1879972a
.quad 0x9b1f9b1f20fda335,0xa3352400a33520fd,0x23f9a30020cf9b1f,0x8f2e9e1f21d0a38d,0x9e1f21a8a3642400,0x2364a1a81e1f8000,0xa21d1fbd98799b1f,0xa1d02364a3ff238d
.quad 0x22c6a3cd23f3a335,0x9d4900001d49a0fd,0x1bfe132d9db520fd,0x23f9a364221da042,0xa3fd238da28620fd,0x9fbd21a8a30023cd,0x1db5a0a1221da335,0xa0cf1e1f9879972a
.quad 0x2241a0fd1ef19b1f,0x23cda40023cda335,0xa2a72364a3d92400,0x9a3e1e1fa07221a8,0x9c6e172a132d9b1f,0xa28621a8a0a11ef1,0x23ffa3e3239fa335,0x22e4a36423bfa3f3
.quad 0x9d491ef1a04220fd,0x172a8000972a1b1f,0xa26421f7a17f20fd,0xa39f2364a31c22c6,0x2286a2c62300a335,0x2155a1a821f7a241,0x1cdc9c6e1bfe9b1f,0x1e899e1f1db59d49
.quad 0x20fd9b1f9b1f20fd,0x20fda3352400a335,0xa3ec23b0a21d1ef1,0x1bfe195ca07222c6,0x1e1fa1a82364a400,0xa36421a89e1f0000,0x20cf9c6e95611ef1,0x22e4a3e323d9a2c6
.quad 0xa3f323cda2c620fd,0x972a1ef1a1a82335,0x1e89a15522e4a3cd,0xa1d01fbd9a3e972a,0x20a19d49132d1b1f,0x23e3a3f32364a241,0xa3f923e3a34d2241,0x9f582155a2a7238d
.quad 0x1ef1a0fd2241a335,0x9ef11b1f80009b1f,0x20729e1f1a3e8000,0x23d9a36422a7a1a8,0xa3fd23f3a3b02335,0xa1f722c6a36423cd,0x1f58a0a1217fa241,0x9561932d1a3e9d49
.quad 0x20429ef11d499b1f,0x22c6a24121a8a0fd,0xa3ff23fda3ec23cd,0xa37923b0a3d923f3,0x1fbda04220a1a0fd,0x1c6e9d491e1f9ef1,0x20119fbd1f589ef1,0x20cfa0a12072a042
.quad 0xa33520fd9b1f9b1f,0x9b1f20fda3352400,0x2379a3fd231ca0fd,0x9f58132d1db5a1a8,0x9e1f21a8a3642400,0x2364a1a81e1f8000,0x9e89132d1cdca0fd,0xa39f23fda34d21a8
.quad 0x238da24120429b1f,0x2042a241238da400,0xa31c23e3a3ec2335,0x1879195c9f5821a8,0x1c6ea04221f7a335,0xa1f720429c6e0000,0x20119c6e0f2e1b1f,0x23ffa3b022e4a1a8
.quad 0xa3cd2335a24120fd,0xa2412335a3cd2400,0x22a7a36423d9a400,0x1a3e9e1f2072a1a8,0x995c1d499fbd20fd,0x1fbd9d49195c8000,0xa0cf1fbd9db51b1f,0xa3792300a26421a8
.quad 0x23f3a3cd238da335,0x238da3cd23f3a400,0xa21d2286a2e42335,0xa01120a1a12921a8,0x132d972a195c9b1f,0x995c172a932d0000,0x217fa1552129a0fd,0x221da1f721d0a1a8
.quad 0x2400a33520fd9b1f,0x9b1f9b1f20fda335,0xa2a723e3a3bf2241,0x21299c6e98792042,0x1e1fa1a82364a400,0xa36421a89e1f0000,0x1a3e195ca0112241,0x23f9a3b02264a042
.quad 0xa1a81ef1972a9b1f,0xa2c623cda3f32335,0x23d9a300217f9ef1,0x2011a1f7234da3f3,0xa36423f3a3e32335,0x932d1d49a0a12241,0x2072a1f7231ca3cd,0x9e89195c15619d49
.quad 0x1b1f9ef120fd,0x2241a0fd1ef19b1f,0xa0721e1f9a3e0000,0xa3d92364a2a721a8,0x2364a2c621f7a0fd,0x23b0a3f323fda3cd,0xa3d923fda3f923cd,0xa1d02286a31c238d
.quad 0x21a8a24122c6a335,0x1d499ef12042a0fd,0x9a3e1c6e9db51ef1,0x1879932d8f2e172a,0x9e1f1d499c6e1b1f,0xa0a120429fbd1ef1,0x22a7a2862264a241,0x231ca30022e4a2c6
.quad 0xa3352400a33520fd,0x20fd9b1f9b1f20fd,0x217fa36423ffa335,0xa2641fbd95619d49,0x9e1f21a8a3642400,0x2364a1a81e1f8000,0xf2e9e1f217fa335,0xa3ec2300a1291d49
.quad 0x1d4980009d4920fd,0x23f3a3cd22c6a0fd,0xa1291e1f95619b1f,0xa37923fda3bf22c6,0x2300a1a81fbd9b1f,0x2286a38d23fda3cd,0xa3ec2364a26420fd,0xa1292286a37923f3
.quad 0x23cda40023cda335,0x1ef1a0fd2241a335,0xa2a72364a3d92400,0x9a3e1e1fa07221a8,0x20a1a1a82286a335,0x932d972a1c6e9ef1,0x9bfe1e1fa01120fd,0x1cdc995c0f2e172a
.quad 0x972a0000172a9b1f,0xa0421ef19d491b1f,0x1f589e1f1cdc9b1f,0x21d0a15520cfa042,0xa1f721a8a15520fd,0xa30022c6a2862241,0x2379a364234da335,0x23bfa3b0239fa38d
.quad 0x20fda3352400a335,0xa33520fd9b1f9b1f,0xa0112286a3d923cd,0x234da1551cdc172a,0x1e1fa1a82364a400,0xa36421a89e1f0000,0x9bfe20a1a2a723cd,0x2379a1f71f58972a
.quad 0x172a9ef121a8a335,0xa38d2241a0421b1f,0xf2e1c6ea0722241,0x239fa28620cf9d49,0x995c972a1e1fa0fd,0xa3b022c6a1551ef1,0x1cdc932d9a3e1ef1,0x23bfa30021d0a042
.quad 0x9ef11b1f80009b1f,0xa3cd2335a24120fd,0x20729e1f1a3e8000,0x23d9a36422a7a1a8,0xa15520429e1f1b1f,0xa3e3238da3002241,0x221da15520729ef1,0x23eca3b0234da2c6
.quad 0xa2c62241a1a820fd,0xa3f323cda38d2335,0x234da30022a7a241,0x23f9a3e323bfa38d,0xa3b0238da3642335,0xa3fd23f3a3e323cd,0x23eca3e323d9a3cd,0x23ffa3fd23f9a3f3
.quad 0x9b1f20fda3352400,0x2400a33520fd9b1f,0x1cdca155234da400,0xa3d92286a011172a,0x9e1f21a8a3642400,0x2364a1a81e1f8000,0x1f58a1f72379a400,0xa2a720a19bfe972a
.quad 0xa0422241a38d2400,0x21a89ef1172a1b1f,0x20cfa286239fa400,0xa0721c6e0f2e9d49,0xa15522c6a3b02400,0x1e1f972a995c1ef1,0x21d0a30023bfa400,0x9a3e932d1cdca042
.quad 0xa2412335a3cd2400,0x1b1f9ef120fd,0x22a7a36423d9a400,0x1a3e9e1f2072a1a8,0xa300238da3e32400,0x9e1f2042a1552241,0x234da3b023eca400,0x2072a155221da2c6
.quad 0xa38d23cda3f32400,0xa1a82241a2c62335,0x23bfa3e323f9a400,0x22a7a300234da38d,0xa3e323f3a3fd2400,0xa364238da3b023cd,0x23f9a3fd23ffa400,0x23d9a3e323eca3f3
.quad 0x9b1f9b1f20fda335,0xa3352400a33520fd,0x95611fbda26423cd,0x23ffa364217f9d49,0x1e1fa1a82364a400,0xa36421a89e1f0000,0xa1292300a3ec23cd,0x217f9e1f0f2e1d49
.quad 0x22c6a3cd23f3a335,0x9d4900001d49a0fd,0xa3bf23fda3792241,0x95611e1fa12922c6,0x23fda38d2286a0fd,0x1fbda1a82300a3cd,0xa3792286a1291ef1,0xa2642364a3ec23f3
.quad 0x2241a0fd1ef19b1f,0x23cda40023cda335,0xa0721e1f9a3e0000,0xa3d92364a2a721a8,0x1c6e972a932d1b1f,0x2286a1a820a19ef1,0xf2e995c1cdc9ef1,0xa0111e1f9bfe172a
.quad 0x9d491ef1a04220fd,0x172a8000972a1b1f,0x20cfa15521d0a241,0x1cdc9e1f1f58a042,0xa28622c6a3002335,0xa15521a8a1f72241,0x239fa3b023bfa3cd,0x234da3642379a38d
.quad 0x20fd9b1f9b1f20fd,0x20fda3352400a335,0x98799c6e2129a335,0xa3bf23e3a2a72042,0x9e1f21a8a3642400,0x2364a1a81e1f8000,0x2264a3b023f9a335,0xa011195c1a3ea042
.quad 0xa3f323cda2c620fd,0x972a1ef1a1a82335,0x234da1f720119b1f,0x217fa30023d9a3f3,0xa0a11d49932d9b1f,0xa3e323f3a3642241,0x1561195c9e8920fd,0x231ca1f720729d49
.quad 0x1ef1a0fd2241a335,0x9ef11b1f80009b1f,0xa2a72364a3d92400,0x9a3e1e1fa07221a8,0x23fda3f323b0a335,0x21f7a2c62364a3cd,0xa31c2286a1d020fd,0xa3f923fda3d9238d
.quad 0x20429ef11d499b1f,0x22c6a24121a8a0fd,0x8f2e932d18799b1f,0x9db51c6e9a3e172a,0x9fbd2042a0a120fd,0x9c6e1d499e1f1ef1,0x22e4a300231ca335,0x2264a28622a7a2c6
.quad 0xa33520fd9b1f9b1f,0x9b1f20fda3352400,0x1db5132d9f582241,0x231ca3fd2379a1a8,0x1e1fa1a82364a400,0xa36421a89e1f0000,0xa34d23fda39f2241,0x1cdc132d9e8921a8
.quad 0x238da24120429b1f,0x2042a241238da400,0x9f58195c18799ef1,0xa3ec23e3a31c21a8,0x9c6e2042a1f72335,0x21f7a0421c6e8000,0x22e4a3b023ffa3cd,0xf2e9c6e2011a1a8
.quad 0xa3cd2335a24120fd,0xa2412335a3cd2400,0x20729e1f1a3e8000,0x23d9a36422a7a1a8,0x195c9d491fbda0fd,0x9fbd1d49995c0000,0xa2642300a37923cd,0x9db51fbda0cf21a8
.quad 0x23f3a3cd238da335,0x238da3cd23f3a400,0xa12920a1a0111ef1,0xa2e42286a21d21a8,0x932d172a995c1b1f,0x195c972a132d8000,0x21d0a1f7221da241,0x2129a155217fa1a8
.quad 0x2400a33520fd9b1f,0x9b1f9b1f20fda335,0xa072195c1bfea0fd,0xa21d23b0a3ec22c6,0x9e1f21a8a3642400,0x2364a1a81e1f8000,0x23d9a3e322e4a0fd,0x95619c6e20cfa2c6
.quad 0xa1a81ef1972a9b1f,0xa2c623cda3f32335,0x9a3e1fbda1d02335,0x22e4a1551e89972a,0x2364a3f323e3a335,0x132d9d4920a1a241,0xa2a721559f581b1f,0xa34d23e3a3f9238d
.quad 0x1b1f9ef120fd,0x2241a0fd1ef19b1f,0x22a7a36423d9a400,0x1a3e9e1f2072a1a8,0xa36422c6a1f720fd,0xa3b023f3a3fd23cd,0x1a3e932d95611b1f,0x217fa0a11f589d49
.quad 0x21a8a24122c6a335,0x1d499ef12042a0fd,0xa3d923b0a3792335,0xa3ec23fda3ff23f3,0x1e1f9d491c6e9b1f,0x20a1a0421fbd9ef1,0x2072a0a120cfa0fd,0x1f589fbd2011a042
.quad 0xa3352400a33520fd,0x20fd9b1f9b1f20fd,0x21d09e1f8f2e1ef1,0x20cfa30023f9a38d,0x1e1fa1a82364a400,0xa36421a89e1f0000,0xa3ff2364a1d01ef1,0x98791fbda21d238d
.quad 0x1d4980009d4920fd,0x23f3a3cd22c6a0fd,0x221da36423f9a3cd,0x9db5132d1bfea042,0xa30021a89fbd1b1f,0xa286238da3fd23cd,0x98791e1fa0cf2241,0x221da0a11db5972a
.quad 0x23cda40023cda335,0x1ef1a0fd2241a335,0xa0721e1f9a3e0000,0xa3d92364a2a721a8,0xa0a121a8a2862335,0x132d172a9c6e1ef1,0x23bfa36422e4a241,0x239fa3e323ffa3f3
.quad 0x972a0000172a9b1f,0xa0421ef19d491b1f,0xa31c2364a39f23cd,0xa17f21f7a26422c6,0x21f7a1a82155a0fd,0x2300a2c62286a241,0x1db59e1f1e899ef1,0x1bfe9c6e1cdc9d49
.quad 0x20fda3352400a335,0xa33520fd9b1f9b1f,0xa2e420a19a3e9b1f,0x9e8921f7a39f23f3,0x9e1f21a8a3642400,0x2364a1a81e1f8000,0x23bfa28620729b1f,0x1db5a155231ca3f3
.quad 0x172a9ef121a8a335,0xa38d2241a0421b1f,0xa3ff23b0a2a720fd,0x9cdc20a1a264238d,0x195c172a9e1f20fd,0x23b0a2c621559ef1,0x239fa3fd23d9a335,0x1bfe9fbd217fa2c6
.quad 0x9ef11b1f80009b1f,0xa3cd2335a24120fd,0xa2a72364a3d92400,0x9a3e1e1fa07221a8,0x2155a0421e1f9b1f,0x23e3a38d2300a241,0x2129a1f722a7a335,0x18799c6e1e89a042
.quad 0xa2c62241a1a820fd,0xa3f323cda38d2335,0x9e891fbda07220fd,0x9561195c9bfe1d49,0x23b0a38d2364a335,0x23fda3f323e3a3cd,0x1879995c1a3e9b1f,0xf2e932d1561972a
.quad 0x9b1f20fda3352400,0x2400a33520fd9b1f,0x239fa1f71e898000,0x1a3ea0a122e4a3f3,0x1e1fa1a82364a400,0xa36421a89e1f0000,0xa31c21559db50000,0xa0722286a3bf23f3
.quad 0xa0422241a38d2400,0x21a89ef1172a1b1f,0x2264a0a11cdc8000,0x22a7a3b023ffa38d,0x2155a2c623b0a400,0x9e1f172a195c9ef1,0xa17f1fbd9bfe0000,0xa3d923fda39f22c6
.quad 0xa2412335a3cd2400,0x1b1f9ef120fd,0x20729e1f1a3e8000,0x23d9a36422a7a1a8,0x2300a38d23e3a400,0x1e1fa0422155a241,0x9e891c6e98790000,0xa2a721f7a1292042
.quad 0xa38d23cda3f32400,0xa1a82241a2c62335,0x1bfe995c15618000,0x20729fbd1e899d49,0x23e3a3f323fda400,0x2364a38d23b0a3cd,0x9561132d8f2e0000,0x9a3e195c9879172a
.quad 0x9b1f9b1f20fda335,0xa3352400a33520fd,0xa3f92300a0cf1b1f,0xf2e1e1fa1d0238d,0x9e1f21a8a3642400,0x2364a1a81e1f8000,0x221d9fbd18791b1f,0x21d0a36423ffa38d
.quad 0x22c6a3cd23f3a335,0x9d4900001d49a0fd,0x9bfe932d1db5a0fd,0xa3f92364a21d2042,0xa3fd238da28620fd,0x9fbd21a8a30023cd,0x9db520a1a21d2335,0x20cf9e1f1879172a
.quad 0x2241a0fd1ef19b1f,0x23cda40023cda335,0x22a7a36423d9a400,0x1a3e9e1f2072a1a8,0x9c6e172a132d9b1f,0xa28621a8a0a11ef1,0xa3ff23e3a39f2335,0xa2e42364a3bf23f3
.quad 0x9d491ef1a04220fd,0x172a8000972a1b1f,0x2264a1f7217fa0fd,0x239fa364231ca2c6,0x2286a2c62300a335,0x2155a1a821f7a241,0x9cdc1c6e9bfe1b1f,0x9e891e1f9db51d49
.quad 0x20fd9b1f9b1f20fd,0x20fda3352400a335,0x23eca3b0221d9ef1,0x9bfe995c2072a2c6,0x1e1fa1a82364a400,0xa36421a89e1f0000,0xa0cf1c6e15619ef1,0xa2e423e3a3d922c6
.quad 0xa3f323cda2c620fd,0x972a1ef1a1a82335,0x9e892155a2e423cd,0x21d09fbd1a3e172a,0x20a19d49132d1b1f,0x23e3a3f32364a241,0x23f9a3e3234da241,0x1f58a15522a7a38d
.quad 0x1ef1a0fd2241a335,0x9ef11b1f80009b1f,0xa0721e1f9a3e0000,0xa3d92364a2a721a8,0xa3fd23f3a3b02335,0xa1f722c6a36423cd,0x9f5820a1a17f2241,0x1561132d9a3e1d49
.quad 0x20429ef11d499b1f,0x22c6a24121a8a0fd,0x23ffa3fd23eca3cd,0x2379a3b023d9a3f3,0x1fbda04220a1a0fd,0x1c6e9d491e1f9ef1,0xa0111fbd9f581ef1,0xa0cf20a1a0722042
.quad 0xa33520fd9b1f9b1f,0x9b1f20fda3352400,0xa37923fda31c20fd,0x1f58932d9db521a8,0x9e1f21a8a3642400,0x2364a1a81e1f8000,0x1e89932d9cdc20fd,0x239fa3fd234da1a8
.quad 0x238da24120429b1f,0x2042a241238da400,0x231ca3e323eca335,0x9879995c1f58a1a8,0x1c6ea04221f7a335,0xa1f720429c6e0000,0xa0111c6e8f2e9b1f,0xa3ff23b0a2e421a8
.quad 0xa3cd2335a24120fd,0xa2412335a3cd2400,0xa2a72364a3d92400,0x9a3e1e1fa07221a8,0x995c1d499fbd20fd,0x1fbd9d49195c8000,0x20cf9fbd1db59b1f,0x2379a3002264a1a8
.quad 0x23f3a3cd238da335,0x238da3cd23f3a400,0x221da28622e4a335,0x2011a0a12129a1a8,0x132d972a195c9b1f,0x995c172a932d0000,0xa17f2155a12920fd,0xa21d21f7a1d021a8
.quad 0x2400a33520fd9b1f,0x9b1f9b1f20fda335,0x22a7a3e323bfa241,0xa1291c6e1879a042,0x1e1fa1a82364a400,0xa36421a89e1f0000,0x9a3e995c2011a241,0xa3f923b0a2642042
.quad 0xa1a81ef1972a9b1f,0xa2c623cda3f32335,0xa3d92300a17f1ef1,0xa01121f7a34d23f3,0xa36423f3a3e32335,0x932d1d49a0a12241,0xa07221f7a31c23cd,0x1e89995c95611d49
.quad 0x1b1f9ef120fd,0x2241a0fd1ef19b1f,0x20729e1f1a3e8000,0x23d9a36422a7a1a8,0x2364a2c621f7a0fd,0x23b0a3f323fda3cd,0x23d9a3fd23f9a3cd,0x21d0a286231ca38d
.quad 0x21a8a24122c6a335,0x1d499ef12042a0fd,0x1a3e9c6e1db59ef1,0x9879132d0f2e972a,0x9e1f1d499c6e1b1f,0xa0a120429fbd1ef1,0xa2a72286a2642241,0xa31c2300a2e422c6
.quad 0xa3352400a33520fd,0x20fd9b1f9b1f20fd,0xa17f2364a3ff2335,0x22649fbd15611d49,0x9e1f21a8a3642400,0x2364a1a81e1f8000,0x8f2e1e1fa17f2335,0x23eca30021299d49
.quad 0x1d4980009d4920fd,0x23f3a3cd22c6a0fd,0x21299e1f15611b1f,0x2379a3fd23bfa2c6,0x2300a1a81fbd9b1f,0x2286a38d23fda3cd,0x23eca3642264a0fd,0x2129a2862379a3f3
.quad 0x23cda40023cda335,0x1ef1a0fd2241a335,0x22a7a36423d9a400,0x1a3e9e1f2072a1a8,0x20a1a1a82286a335,0x932d972a1c6e9ef1,0x1bfe9e1f2011a0fd,0x9cdc195c8f2e972a
.quad 0x972a0000172a9b1f,0xa0421ef19d491b1f,0x9f581e1f9cdc1b1f,0xa1d02155a0cf2042,0xa1f721a8a15520fd,0xa30022c6a2862241,0xa3792364a34d2335,0xa3bf23b0a39f238d
.quad 0x20fda3352400a335,0xa33520fd9b1f9b1f,0x2011a28623d9a3cd,0xa34d21559cdc972a,0x1e1fa1a82364a400,0xa36421a89e1f0000,0x1bfea0a122a7a3cd,0xa37921f79f58172a
.quad 0x172a9ef121a8a335,0xa38d2241a0421b1f,0x8f2e9c6e2072a241,0xa39f2286a0cf1d49,0x995c972a1e1fa0fd,0xa3b022c6a1551ef1,0x9cdc132d1a3e9ef1,0xa3bf2300a1d02042
.quad 0x9ef11b1f80009b1f,0xa3cd2335a24120fd,0xa0721e1f9a3e0000,0xa3d92364a2a721a8,0xa15520429e1f1b1f,0xa3e3238da3002241,0xa21d2155a0721ef1,0xa3ec23b0a34d22c6
.quad 0xa2c62241a1a820fd,0xa3f323cda38d2335,0xa34d2300a2a72241,0xa3f923e3a3bf238d,0xa3b0238da3642335,0xa3fd23f3a3e323cd,0xa3ec23e3a3d923cd,0xa3ff23fda3f923f3
.quad 0xa3cd22419ef18000,0x80001ef1a24123cd,0xa39f21f79e898000,0x9a3e20a1a2e423f3,0xa36421a89e1f8000,0x9e1f21a8a3642400,0xa31c21559db58000,0xa0722286a3bf23f3
.quad 0xa2c620fd9d498000,0xa1a82335a3f323cd,0xa26420a19cdc8000,0xa2a723b0a3ff238d,0xa1f720429c6e8000,0xa36423f3a3e32335,0xa17f1fbd9bfe8000,0xa3d923fda39f22c6
.quad 0xa0fd1ef19b1f8000,0xa40023cda3352241,0xa0721e1f9a3e8000,0xa3d92364a2a721a8,0x9fbd1d49995c8000,0xa36422c6a1f720fd,0x9e891c6e98798000,0xa2a721f7a1292042
.quad 0x9d491b1f972a8000,0xa1a820fda0421ef1,0x9bfe195c95618000,0xa0721fbd9e891d49,0x995c172a932d8000,0x9e1f1d499c6e1b1f,0x9561132d8f2e8000,0x9a3e195c9879172a
.quad 0x23cda3cd22419ef1,0x9ef180001ef1a241,0x23f9a30020cf9b1f,0x8f2e9e1f21d0a38d,0x2364a1a81e1f8000,0x1e1fa1a82364a400,0x221d9fbd18791b1f,0x21d0a36423ffa38d
.quad 0x20429b1f972a1ef1,0x238da400238da241,0x1bfe132d9db520fd,0x23f9a364221da042,0x932d1d49a0a12241,0x2300a1a81fbd9b1f,0x9db520a1a21d2335,0x20cf9e1f1879172a
.quad 0xa0fd2241a33523cd,0x1b1f80009b1f1ef1,0xa2a72364a3d92400,0x9a3e1e1fa07221a8,0xa3b023f3a3fd23cd,0xa0a121a8a2862335,0xa3ff23e3a39f2335,0xa2e42364a3bf23f3
.quad 0xa38d2335a2c62241,0xa3f32400a3f323cd,0xa26421f7a17f20fd,0xa39f2364a31c22c6,0xa0a120429fbd1ef1,0xa1f721a8a15520fd,0x9cdc1c6e9bfe1b1f,0x9e891e1f9db51d49
.quad 0xa24123cda3cd2241,0x22419ef180001ef1,0xa3ec23b0a21d1ef1,0x1bfe195ca07222c6,0xa36421a89e1f8000,0x9e1f21a8a3642400,0xa0cf1c6e15619ef1,0xa2e423e3a3d922c6
.quad 0x972a9b1f2042a241,0xa3f32335a1a81ef1,0x1e89a15522e4a3cd,0xa1d01fbd9a3e972a,0x2286a38d23fda3cd,0x995c972a1e1fa0fd,0x23f9a3e3234da241,0x1f58a15522a7a38d
.quad 0x2335a24120fd9ef1,0x2335a3cd2400a3cd,0x20729e1f1a3e8000,0x23d9a36422a7a1a8,0x132d172a9c6e1ef1,0x2155a0421e1f9b1f,0x9f5820a1a17f2241,0x1561132d9a3e1d49
.quad 0xa2c62335a38d23cd,0xa04220fda1a82241,0xa3ff23fda3ec23cd,0xa37923b0a3d923f3,0xa30022c6a2862241,0xa3b0238da3642335,0xa0111fbd9f581ef1,0xa0cf20a1a0722042
.quad 0x1ef1a24123cda3cd,0xa3cd22419ef18000,0x2379a3fd231ca0fd,0x9f58132d1db5a1a8,0x2364a1a81e1f8000,0x1e1fa1a82364a400,0x1e89932d9cdc20fd,0x239fa3fd234da1a8
.quad 0x9d4920fda2c623cd,0x22c6a0fd1d498000,0xa31c23e3a3ec2335,0x1879195c9f5821a8,0xa3b022c6a1551ef1,0xa15522c6a3b02400,0xa0111c6e8f2e9b1f,0xa3ff23b0a2e421a8
.quad 0x1b1f9ef120fda241,0xa0fd1ef19b1f8000,0x22a7a36423d9a400,0x1a3e9e1f2072a1a8,0x23e3a38d2300a241,0x2300a38d23e3a400,0x20cf9fbd1db59b1f,0x2379a3002264a1a8
.quad 0x972a1b1f9d491ef1,0x1d499b1f172a8000,0xa21d2286a2e42335,0xa01120a1a12921a8,0xa3fd23f3a3e323cd,0xa3e323f3a3fd2400,0xa17f2155a12920fd,0xa21d21f7a1d021a8
.quad 0x80001ef1a24123cd,0x23cda3cd22419ef1,0xa2a723e3a3bf2241,0x21299c6e98792042,0xa36421a89e1f8000,0x9e1f21a8a3642400,0x9a3e995c2011a241,0xa3f923b0a2642042
.quad 0x21a8a33523f3a3cd,0xa0421b1f172a9ef1,0x23d9a300217f9ef1,0x2011a1f7234da3f3,0x1e1f972a995c1ef1,0x23fda38d2286a0fd,0xa07221f7a31c23cd,0x1e89995c95611d49
.quad 0xa40023cda3352241,0xa0fd2241a33523cd,0xa0721e1f9a3e8000,0xa3d92364a2a721a8,0x1e1fa0422155a241,0x9c6e172a132d9b1f,0x23d9a3fd23f9a3cd,0x21d0a286231ca38d
.quad 0x21a8a0fd20429ef1,0x238da33522c6a241,0x9a3e1c6e9db51ef1,0x1879932d8f2e172a,0xa364238da3b023cd,0xa28622c6a3002335,0xa2a72286a2642241,0xa31c2300a2e422c6
.quad 0x9ef180001ef1a241,0xa24123cda3cd2241,0x217fa36423ffa335,0xa2641fbd95619d49,0x2364a1a81e1f8000,0x1e1fa1a82364a400,0x8f2e1e1fa17f2335,0x23eca30021299d49
.quad 0xa38d2400a38d2241,0x172a1b1fa0422241,0xa1291e1f95619b1f,0xa37923fda3bf22c6,0x1fbda1a82300a3cd,0xa0a11d49932d9b1f,0x23eca3642264a0fd,0x2129a2862379a3f3
.quad 0x1b1f80009b1f1ef1,0x2335a24120fd9ef1,0xa2a72364a3d92400,0x9a3e1e1fa07221a8,0xa28621a8a0a11ef1,0xa3fd23f3a3b02335,0x1bfe9e1f2011a0fd,0x9cdc195c8f2e972a
.quad 0x23f3a40023f3a3cd,0x22c6a335238da3cd,0x1f589e1f1cdc9b1f,0x21d0a15520cfa042,0xa15521a8a1f72241,0x9fbd2042a0a120fd,0xa3792364a34d2335,0xa3bf23b0a39f238d
.quad 0x22419ef180001ef1,0x1ef1a24123cda3cd,0xa0112286a3d923cd,0x234da1551cdc172a,0xa36421a89e1f8000,0x9e1f21a8a3642400,0x1bfea0a122a7a3cd,0xa37921f79f58172a
.quad 0x23f3a33521a89ef1,0x1d49a0fd22c6a3cd,0xf2e1c6ea0722241,0x239fa28620cf9d49,0xa3e323f3a3642241,0x9c6e2042a1f72335,0x9cdc132d1a3e9ef1,0xa3bf2300a1d02042
.quad 0x2335a3cd2400a3cd,0x1b1f9ef120fda241,0x20729e1f1a3e8000,0x23d9a36422a7a1a8,0xa1f722c6a36423cd,0x995c1d499fbd20fd,0xa21d2155a0721ef1,0xa3ec23b0a34d22c6
.quad 0x2042a0fd21a8a241,0x172a9b1f1d499ef1,0x234da30022a7a241,0x23f9a3e323bfa38d,0x9c6e1d499e1f1ef1,0x932d172a995c1b1f,0xa3ec23e3a3d923cd,0xa3ff23fda3f923f3
.quad 0xa3cd22419ef18000,0x80001ef1a24123cd,0x1cdca155234da400,0xa3d92286a011172a,0x2364a1a81e1f8000,0x1e1fa1a82364a400,0x9f5821f7a3792400,0x22a7a0a11bfe172a
.quad 0xa2c620fd9d498000,0xa1a82335a3f323cd,0x20cfa286239fa400,0xa0721c6e0f2e9d49,0x21f7a0421c6e8000,0x2364a3f323e3a335,0xa1d02300a3bf2400,0x1a3e132d9cdc2042
.quad 0xa0fd1ef19b1f8000,0xa40023cda3352241,0x22a7a36423d9a400,0x1a3e9e1f2072a1a8,0x1fbd9d49195c8000,0x2364a2c621f7a0fd,0xa34d23b0a3ec2400,0xa0722155a21d22c6
.quad 0x9d491b1f972a8000,0xa1a820fda0421ef1,0x23bfa3e323f9a400,0x22a7a300234da38d,0x195c972a132d8000,0x1e1f9d491c6e9b1f,0xa3f923fda3ff2400,0xa3d923e3a3ec23f3
.quad 0x23cda3cd22419ef1,0x9ef180001ef1a241,0x95611fbda26423cd,0x23ffa364217f9d49,0xa36421a89e1f8000,0x9e1f21a8a3642400,0x2129a30023eca3cd,0xa17f1e1f8f2e9d49
.quad 0x20429b1f972a1ef1,0x238da400238da241,0xa3bf23fda3792241,0x95611e1fa12922c6,0x132d9d4920a1a241,0xa30021a89fbd1b1f,0x2379a28621299ef1,0x2264a36423eca3f3
.quad 0xa0fd2241a33523cd,0x1b1f80009b1f1ef1,0xa0721e1f9a3e8000,0xa3d92364a2a721a8,0x23b0a3f323fda3cd,0x20a1a1a82286a335,0x8f2e195c9cdc1ef1,0x20119e1f1bfe972a
.quad 0xa38d2335a2c62241,0xa3f32400a3f323cd,0x20cfa15521d0a241,0x1cdc9e1f1f58a042,0x20a1a0421fbd9ef1,0x21f7a1a82155a0fd,0xa39f23b0a3bf23cd,0xa34d2364a379238d
.quad 0xa24123cda3cd2241,0x22419ef180001ef1,0x98799c6e2129a335,0xa3bf23e3a2a72042,0x2364a1a81e1f8000,0x1e1fa1a82364a400,0xa26423b0a3f92335,0x2011995c9a3e2042
.quad 0x972a9b1f2042a241,0xa3f32335a1a81ef1,0x234da1f720119b1f,0x217fa30023d9a3f3,0xa286238da3fd23cd,0x195c172a9e1f20fd,0x9561995c1e89a0fd,0xa31c21f7a0721d49
.quad 0x2335a24120fd9ef1,0x2335a3cd2400a3cd,0xa2a72364a3d92400,0x9a3e1e1fa07221a8,0x932d972a1c6e9ef1,0xa15520429e1f1b1f,0x231ca28621d0a0fd,0x23f9a3fd23d9a38d
.quad 0xa2c62335a38d23cd,0xa04220fda1a82241,0x8f2e932d18799b1f,0x9db51c6e9a3e172a,0x2300a2c62286a241,0x23b0a38d2364a335,0xa2e42300a31c2335,0xa2642286a2a722c6
.quad 0x1ef1a24123cda3cd,0xa3cd22419ef18000,0x1db5132d9f582241,0x231ca3fd2379a1a8,0xa36421a89e1f8000,0x9e1f21a8a3642400,0x234da3fd239fa241,0x9cdc932d1e89a1a8
.quad 0x9d4920fda2c623cd,0x22c6a0fd1d498000,0x9f58195c18799ef1,0xa3ec23e3a31c21a8,0x23b0a2c621559ef1,0x2155a2c623b0a400,0xa2e423b0a3ff23cd,0x8f2e1c6ea01121a8
.quad 0x1b1f9ef120fda241,0xa0fd1ef19b1f8000,0x20729e1f1a3e8000,0x23d9a36422a7a1a8,0xa3e3238da3002241,0xa300238da3e32400,0x2264a3002379a3cd,0x1db59fbd20cfa1a8
.quad 0x972a1b1f9d491ef1,0x1d499b1f172a8000,0xa12920a1a0111ef1,0xa2e42286a21d21a8,0x23fda3f323e3a3cd,0x23e3a3f323fda400,0xa1d021f7a21d2241,0xa1292155a17f21a8
.quad 0x80001ef1a24123cd,0x23cda3cd22419ef1,0xa072195c1bfea0fd,0xa21d23b0a3ec22c6,0x2364a1a81e1f8000,0x1e1fa1a82364a400,0xa3d923e3a2e420fd,0x15611c6ea0cf22c6
.quad 0x21a8a33523f3a3cd,0xa0421b1f172a9ef1,0x9a3e1fbda1d02335,0x22e4a1551e89972a,0x9e1f172a195c9ef1,0xa3fd238da28620fd,0x22a7a1551f589b1f,0x234da3e323f9a38d
.quad 0xa40023cda3352241,0xa0fd2241a33523cd,0x22a7a36423d9a400,0x1a3e9e1f2072a1a8,0x9e1f2042a1552241,0x1c6e972a932d1b1f,0x9a3e132d15619b1f,0xa17f20a19f581d49
.quad 0x21a8a0fd20429ef1,0x238da33522c6a241,0xa3d923b0a3792335,0xa3ec23fda3ff23f3,0x2364a38d23b0a3cd,0x2286a2c62300a335,0xa07220a1a0cf20fd,0x9f581fbda0112042
.quad 0x9ef180001ef1a241,0xa24123cda3cd2241,0x21d09e1f8f2e1ef1,0x20cfa30023f9a38d,0xa36421a89e1f8000,0x9e1f21a8a3642400,0x23ffa36421d09ef1,0x18799fbd221da38d
.quad 0xa38d2400a38d2241,0x172a1b1fa0422241,0x221da36423f9a3cd,0x9db5132d1bfea042,0x9fbd21a8a30023cd,0x20a19d49132d1b1f,0x18799e1f20cfa241,0xa21d20a19db5172a
.quad 0x1b1f80009b1f1ef1,0x2335a24120fd9ef1,0xa0721e1f9a3e8000,0xa3d92364a2a721a8,0x2286a1a820a19ef1,0x23fda3f323b0a335,0xa3bf2364a2e42241,0xa39f23e3a3ff23f3
.quad 0x23f3a40023f3a3cd,0x22c6a335238da3cd,0xa31c2364a39f23cd,0xa17f21f7a26422c6,0x2155a1a821f7a241,0x1fbda04220a1a0fd,0x9db51e1f9e891ef1,0x9bfe1c6e9cdc1d49
.quad 0x22419ef180001ef1,0x1ef1a24123cda3cd,0xa2e420a19a3e9b1f,0x9e8921f7a39f23f3,0x2364a1a81e1f8000,0x1e1fa1a82364a400,0xa3bf2286a0721b1f,0x9db52155a31c23f3
.quad 0x23f3a33521a89ef1,0x1d49a0fd22c6a3cd,0xa3ff23b0a2a720fd,0x9cdc20a1a264238d,0x23e3a3f32364a241,0x1c6ea04221f7a335,0xa39f23fda3d92335,0x9bfe1fbda17f22c6
.quad 0x2335a3cd2400a3cd,0x1b1f9ef120fda241,0xa2a72364a3d92400,0x9a3e1e1fa07221a8,0x21f7a2c62364a3cd,0x195c9d491fbda0fd,0xa12921f7a2a72335,0x98791c6e9e892042
.quad 0x2042a0fd21a8a241,0x172a9b1f1d499ef1,0x9e891fbda07220fd,0x9561195c9bfe1d49,0x1c6e9d491e1f9ef1,0x132d972a195c9b1f,0x9879195c9a3e1b1f,0x8f2e132d9561172a
.quad 0xa3cd22419ef18000,0x80001ef1a24123cd,0x239fa1f71e898000,0x1a3ea0a122e4a3f3,0xa36421a89e1f8000,0x9e1f21a8a3642400,0x231ca1551db58000,0x2072a28623bfa3f3
.quad 0xa2c620fd9d498000,0xa1a82335a3f323cd,0x2264a0a11cdc8000,0x22a7a3b023ffa38d,0xa1f720429c6e8000,0xa36423f3a3e32335,0x217f9fbd1bfe8000,0x23d9a3fd239fa2c6
.quad 0xa0fd1ef19b1f8000,0xa40023cda3352241,0x20729e1f1a3e8000,0x23d9a36422a7a1a8,0x9fbd1d49995c8000,0xa36422c6a1f720fd,0x1e899c6e18798000,0x22a7a1f72129a042
.quad 0x9d491b1f972a8000,0xa1a820fda0421ef1,0x1bfe995c15618000,0x20729fbd1e899d49,0x995c172a932d8000,0x9e1f1d499c6e1b1f,0x1561932d0f2e8000,0x1a3e995c1879972a
.quad 0x23cda3cd22419ef1,0x9ef180001ef1a241,0xa3f92300a0cf1b1f,0xf2e1e1fa1d0238d,0x2364a1a81e1f8000,0x1e1fa1a82364a400,0xa21d1fbd98799b1f,0xa1d02364a3ff238d
.quad 0x20429b1f972a1ef1,0x238da400238da241,0x9bfe932d1db5a0fd,0xa3f92364a21d2042,0x932d1d49a0a12241,0x2300a1a81fbd9b1f,0x1db5a0a1221da335,0xa0cf1e1f9879972a
.quad 0xa0fd2241a33523cd,0x1b1f80009b1f1ef1,0x22a7a36423d9a400,0x1a3e9e1f2072a1a8,0xa3b023f3a3fd23cd,0xa0a121a8a2862335,0x23ffa3e3239fa335,0x22e4a36423bfa3f3
.quad 0xa38d2335a2c62241,0xa3f32400a3f323cd,0x2264a1f7217fa0fd,0x239fa364231ca2c6,0xa0a120429fbd1ef1,0xa1f721a8a15520fd,0x1cdc9c6e1bfe9b1f,0x1e899e1f1db59d49
.quad 0xa24123cda3cd2241,0x22419ef180001ef1,0x23eca3b0221d9ef1,0x9bfe995c2072a2c6,0xa36421a89e1f8000,0x9e1f21a8a3642400,0x20cf9c6e95611ef1,0x22e4a3e323d9a2c6
.quad 0x972a9b1f2042a241,0xa3f32335a1a81ef1,0x9e892155a2e423cd,0x21d09fbd1a3e172a,0x2286a38d23fda3cd,0x995c972a1e1fa0fd,0xa3f923e3a34d2241,0x9f582155a2a7238d
.quad 0x2335a24120fd9ef1,0x2335a3cd2400a3cd,0xa0721e1f9a3e8000,0xa3d92364a2a721a8,0x132d172a9c6e1ef1,0x2155a0421e1f9b1f,0x1f58a0a1217fa241,0x9561932d1a3e9d49
.quad 0xa2c62335a38d23cd,0xa04220fda1a82241,0x23ffa3fd23eca3cd,0x2379a3b023d9a3f3,0xa30022c6a2862241,0xa3b0238da3642335,0x20119fbd1f589ef1,0x20cfa0a12072a042
.quad 0x1ef1a24123cda3cd,0xa3cd22419ef18000,0xa37923fda31c20fd,0x1f58932d9db521a8,0x2364a1a81e1f8000,0x1e1fa1a82364a400,0x9e89132d1cdca0fd,0xa39f23fda34d21a8
.quad 0x9d4920fda2c623cd,0x22c6a0fd1d498000,0x231ca3e323eca335,0x9879995c1f58a1a8,0xa3b022c6a1551ef1,0xa15522c6a3b02400,0x20119c6e0f2e1b1f,0x23ffa3b022e4a1a8
.quad 0x1b1f9ef120fda241,0xa0fd1ef19b1f8000,0xa2a72364a3d92400,0x9a3e1e1fa07221a8,0x23e3a38d2300a241,0x2300a38d23e3a400,0xa0cf1fbd9db51b1f,0xa3792300a26421a8
.quad 0x972a1b1f9d491ef1,0x1d499b1f172a8000,0x221da28622e4a335,0x2011a0a12129a1a8,0xa3fd23f3a3e323cd,0xa3e323f3a3fd2400,0x217fa1552129a0fd,0x221da1f721d0a1a8
.quad 0x80001ef1a24123cd,0x23cda3cd22419ef1,0x22a7a3e323bfa241,0xa1291c6e1879a042,0xa36421a89e1f8000,0x9e1f21a8a3642400,0x1a3e195ca0112241,0x23f9a3b02264a042
.quad 0x21a8a33523f3a3cd,0xa0421b1f172a9ef1,0xa3d92300a17f1ef1,0xa01121f7a34d23f3,0x1e1f972a995c1ef1,0x23fda38d2286a0fd,0x2072a1f7231ca3cd,0x9e89195c15619d49
.quad 0xa40023cda3352241,0xa0fd2241a33523cd,0x20729e1f1a3e8000,0x23d9a36422a7a1a8,0x1e1fa0422155a241,0x9c6e172a132d9b1f,0xa3d923fda3f923cd,0xa1d02286a31c238d
.quad 0x21a8a0fd20429ef1,0x238da33522c6a241,0x1a3e9c6e1db59ef1,0x9879132d0f2e972a,0xa364238da3b023cd,0xa28622c6a3002335,0x22a7a2862264a241,0x231ca30022e4a2c6
.quad 0x9ef180001ef1a241,0xa24123cda3cd2241,0xa17f2364a3ff2335,0x22649fbd15611d49,0x2364a1a81e1f8000,0x1e1fa1a82364a400,0xf2e9e1f217fa335,0xa3ec2300a1291d49
.quad 0xa38d2400a38d2241,0x172a1b1fa0422241,0x21299e1f15611b1f,0x2379a3fd23bfa2c6,0x1fbda1a82300a3cd,0xa0a11d49932d9b1f,0xa3ec2364a26420fd,0xa1292286a37923f3
.quad 0x1b1f80009b1f1ef1,0x2335a24120fd9ef1,0x22a7a36423d9a400,0x1a3e9e1f2072a1a8,0xa28621a8a0a11ef1,0xa3fd23f3a3b02335,0x9bfe1e1fa01120fd,0x1cdc995c0f2e172a
.quad 0x23f3a40023f3a3cd,0x22c6a335238da3cd,0x9f581e1f9cdc1b1f,0xa1d02155a0cf2042,0xa15521a8a1f72241,0x9fbd2042a0a120fd,0x2379a364234da335,0x23bfa3b0239fa38d
.quad 0x22419ef180001ef1,0x1ef1a24123cda3cd,0x2011a28623d9a3cd,0xa34d21559cdc972a,0xa36421a89e1f8000,0x9e1f21a8a3642400,0x9bfe20a1a2a723cd,0x2379a1f71f58972a
.quad 0x23f3a33521a89ef1,0x1d49a0fd22c6a3cd,0x8f2e9c6e2072a241,0xa39f2286a0cf1d49,0xa3e323f3a3642241,0x9c6e2042a1f72335,0x1cdc932d9a3e1ef1,0x23bfa30021d0a042
.quad 0x2335a3cd2400a3cd,0x1b1f9ef120fda241,0xa0721e1f9a3e8000,0xa3d92364a2a721a8,0xa1f722c6a36423cd,0x995c1d499fbd20fd,0x221da15520729ef1,0x23eca3b0234da2c6
.quad 0x2042a0fd21a8a241,0x172a9b1f1d499ef1,0xa34d2300a2a72241,0xa3f923e3a3bf238d,0x9c6e1d499e1f1ef1,0x932d172a995c1b1f,0x23eca3e323d9a3cd,0x23ffa3fd23f9a3f3
.quad 0xa3cd22419ef18000,0x80001ef1a24123cd,0x9cdc2155a34d2400,0x23d9a2862011972a,0x2364a1a81e1f8000,0x1e1fa1a82364a400,0x1f58a1f72379a400,0xa2a720a19bfe972a
.quad 0xa2c620fd9d498000,0xa1a82335a3f323cd,0xa0cf2286a39f2400,0x20729c6e8f2e1d49,0x21f7a0421c6e8000,0x2364a3f323e3a335,0x21d0a30023bfa400,0x9a3e932d1cdca042
.quad 0xa0fd1ef19b1f8000,0xa40023cda3352241,0xa2a72364a3d92400,0x9a3e1e1fa07221a8,0x1fbd9d49195c8000,0x2364a2c621f7a0fd,0x234da3b023eca400,0x2072a155221da2c6
.quad 0x9d491b1f972a8000,0xa1a820fda0421ef1,0xa3bf23e3a3f92400,0xa2a72300a34d238d,0x195c972a132d8000,0x1e1f9d491c6e9b1f,0x23f9a3fd23ffa400,0x23d9a3e323eca3f3
.quad 0x23cda3cd22419ef1,0x9ef180001ef1a241,0x15619fbd2264a3cd,0xa3ff2364a17f1d49,0xa36421a89e1f8000,0x9e1f21a8a3642400,0xa1292300a3ec23cd,0x217f9e1f0f2e1d49
.quad 0x20429b1f972a1ef1,0x238da400238da241,0x23bfa3fd2379a241,0x15619e1f2129a2c6,0x132d9d4920a1a241,0xa30021a89fbd1b1f,0xa3792286a1291ef1,0xa2642364a3ec23f3
.quad 0xa0fd2241a33523cd,0x1b1f80009b1f1ef1,0x20729e1f1a3e8000,0x23d9a36422a7a1a8,0x23b0a3f323fda3cd,0x20a1a1a82286a335,0xf2e995c1cdc9ef1,0xa0111e1f9bfe172a
.quad 0xa38d2335a2c62241,0xa3f32400a3f323cd,0xa0cf2155a1d02241,0x9cdc1e1f9f582042,0x20a1a0421fbd9ef1,0x21f7a1a82155a0fd,0x239fa3b023bfa3cd,0x234da3642379a38d
.quad 0xa24123cda3cd2241,0x22419ef180001ef1,0x18791c6ea1292335,0x23bfa3e322a7a042,0x2364a1a81e1f8000,0x1e1fa1a82364a400,0x2264a3b023f9a335,0xa011195c1a3ea042
.quad 0x972a9b1f2042a241,0xa3f32335a1a81ef1,0xa34d21f7a0111b1f,0xa17f2300a3d923f3,0xa286238da3fd23cd,0x195c172a9e1f20fd,0x1561195c9e8920fd,0x231ca1f720729d49
.quad 0x2335a24120fd9ef1,0x2335a3cd2400a3cd,0x22a7a36423d9a400,0x1a3e9e1f2072a1a8,0x932d972a1c6e9ef1,0xa15520429e1f1b1f,0xa31c2286a1d020fd,0xa3f923fda3d9238d
.quad 0xa2c62335a38d23cd,0xa04220fda1a82241,0xf2e132d98791b1f,0x1db59c6e1a3e972a,0x2300a2c62286a241,0x23b0a38d2364a335,0x22e4a300231ca335,0x2264a28622a7a2c6
.quad 0x1ef1a24123cda3cd,0xa3cd22419ef18000,0x9db5932d1f58a241,0xa31c23fda37921a8,0xa36421a89e1f8000,0x9e1f21a8a3642400,0xa34d23fda39f2241,0x1cdc132d9e8921a8
.quad 0x9d4920fda2c623cd,0x22c6a0fd1d498000,0x1f58995c98791ef1,0x23eca3e3231ca1a8,0x23b0a2c621559ef1,0x2155a2c623b0a400,0x22e4a3b023ffa3cd,0xf2e9c6e2011a1a8
.quad 0x1b1f9ef120fda241,0xa0fd1ef19b1f8000,0xa0721e1f9a3e8000,0xa3d92364a2a721a8,0xa3e3238da3002241,0xa300238da3e32400,0xa2642300a37923cd,0x9db51fbda0cf21a8
.quad 0x972a1b1f9d491ef1,0x1d499b1f172a8000,0x2129a0a120119ef1,0x22e4a286221da1a8,0x23fda3f323e3a3cd,0x23e3a3f323fda400,0x21d0a1f7221da241,0x2129a155217fa1a8
.quad 0x80001ef1a24123cd,0x23cda3cd22419ef1,0x2072995c9bfe20fd,0x221da3b023eca2c6,0x2364a1a81e1f8000,0x1e1fa1a82364a400,0x23d9a3e322e4a0fd,0x95619c6e20cfa2c6
.quad 0x21a8a33523f3a3cd,0xa0421b1f172a9ef1,0x1a3e9fbd21d0a335,0xa2e421559e89172a,0x9e1f172a195c9ef1,0xa3fd238da28620fd,0xa2a721559f581b1f,0xa34d23e3a3f9238d
.quad 0xa40023cda3352241,0xa0fd2241a33523cd,0xa2a72364a3d92400,0x9a3e1e1fa07221a8,0x9e1f2042a1552241,0x1c6e972a932d1b1f,0x1a3e932d95611b1f,0x217fa0a11f589d49
.quad 0x21a8a0fd20429ef1,0x238da33522c6a241,0x23d9a3b02379a335,0x23eca3fd23ffa3f3,0x2364a38d23b0a3cd,0x2286a2c62300a335,0x2072a0a120cfa0fd,0x1f589fbd2011a042
.quad 0x9ef180001ef1a241,0xa24123cda3cd2241,0xa1d01e1f0f2e9ef1,0xa0cf2300a3f9238d,0xa36421a89e1f8000,0x9e1f21a8a3642400,0xa3ff2364a1d01ef1,0x98791fbda21d238d
.quad 0xa38d2400a38d2241,0x172a1b1fa0422241,0xa21d2364a3f923cd,0x1db5932d9bfe2042,0x9fbd21a8a30023cd,0x20a19d49132d1b1f,0x98791e1fa0cf2241,0x221da0a11db5972a
.quad 0x1b1f80009b1f1ef1,0x2335a24120fd9ef1,0x20729e1f1a3e8000,0x23d9a36422a7a1a8,0x2286a1a820a19ef1,0x23fda3f323b0a335,0x23bfa36422e4a241,0x239fa3e323ffa3f3
.quad 0x23f3a40023f3a3cd,0x22c6a335238da3cd,0x231ca364239fa3cd,0x217fa1f72264a2c6,0x2155a1a821f7a241,0x1fbda04220a1a0fd,0x1db59e1f1e899ef1,0x1bfe9c6e1cdc9d49
.quad 0x22419ef180001ef1,0x1ef1a24123cda3cd,0x22e4a0a11a3e1b1f,0x1e89a1f7239fa3f3,0x2364a1a81e1f8000,0x1e1fa1a82364a400,0x23bfa28620729b1f,0x1db5a155231ca3f3
.quad 0x23f3a33521a89ef1,0x1d49a0fd22c6a3cd,0x23ffa3b022a7a0fd,0x1cdca0a12264a38d,0x23e3a3f32364a241,0x1c6ea04221f7a335,0x239fa3fd23d9a335,0x1bfe9fbd217fa2c6
.quad 0x2335a3cd2400a3cd,0x1b1f9ef120fda241,0x22a7a36423d9a400,0x1a3e9e1f2072a1a8,0x21f7a2c62364a3cd,0x195c9d491fbda0fd,0x2129a1f722a7a335,0x18799c6e1e89a042
.quad 0x2042a0fd21a8a241,0x172a9b1f1d499ef1,0x1e899fbd2072a0fd,0x1561995c1bfe9d49,0x1c6e9d491e1f9ef1,0x132d972a195c9b1f,0x1879995c1a3e9b1f,0xf2e932d1561972a
.quad 0xa4002400a4002400,0xa4002400a4002400,0,0,0,0,0,0
.quad 0,0,0,0,0,0,0,0
.quad 0,0,0,0,0,0,0,0
.quad 0,0,0,0,0,0,0,0
.quad 0xa4002400a4002400,0xa4002400a4002400,0,0,0,0,0,0
.quad 0,0,0,0,0,0,0,0
.quad 0,0,0,0,0,0,0,0
.quad 0,0,0,0,0,0,0,0
.quad 0xa4002400a4002400,0xa4002400a4002400,0,0,0,0,0,0
.quad 0,0,0,0,0,0,0,0
.quad 0,0,0,0,0,0,0,0
.quad 0,0,0,0,0,0,0,0
.quad 0xa4002400a4002400,0xa4002400a4002400,0,0,0,0,0,0
.quad 0,0,0,0,0,0,0,0
.quad 0,0,0,0,0,0,0,0
.quad 0,0,0,0,0,0,0,0
.quad 0xa4002400a4002400,0xa4002400a4002400,0,0,0,0,0,0
.quad 0,0,0,0,0,0,0,0
.quad 0,0,0,0,0,0,0,0
.quad 0,0,0,0,0,0,0,0
.quad 0xa4002400a4002400,0xa4002400a4002400,0,0,0,0,0,0
.quad 0,0,0,0,0,0,0,0
.quad 0,0,0,0,0,0,0,0
.quad 0,0,0,0,0,0,0,0
.quad 0xa4002400a4002400,0xa4002400a4002400,0,0,0,0,0,0
.quad 0,0,0,0,0,0,0,0
.quad 0,0,0,0,0,0,0,0
.quad 0,0,0,0,0,0,0,0
.quad 0xa4002400a4002400,0xa4002400a4002400,0,0,0,0,0,0
.quad 0,0,0,0,0,0,0,0
.quad 0,0,0,0,0,0,0,0
.quad 0,0,0,0,0,0,0,0
.quad 0xa4002400a4002400,0xa4002400a4002400,0,0,0,0,0,0
.quad 0,0,0,0,0,0,0,0
.quad 0,0,0,0,0,0,0,0
.quad 0,0,0,0,0,0,0,0
.quad 0xa4002400a4002400,0xa4002400a4002400,0,0,0,0,0,0
.quad 0,0,0,0,0,0,0,0
.quad 0,0,0,0,0,0,0,0
.quad 0,0,0,0,0,0,0,0
.quad 0xa4002400a4002400,0xa4002400a4002400,0,0,0,0,0,0
.quad 0,0,0,0,0,0,0,0
.quad 0,0,0,0,0,0,0,0
.quad 0,0,0,0,0,0,0,0
.quad 0xa4002400a4002400,0xa4002400a4002400,0,0,0,0,0,0
.quad 0,0,0,0,0,0,0,0
.quad 0,0,0,0,0,0,0,0
.quad 0,0,0,0,0,0,0,0
.quad 0xa4002400a4002400,0xa4002400a4002400,0,0,0,0,0,0
.quad 0,0,0,0,0,0,0,0
.quad 0,0,0,0,0,0,0,0
.quad 0,0,0,0,0,0,0,0
.quad 0xa4002400a4002400,0xa4002400a4002400,0,0,0,0,0,0
.quad 0,0,0,0,0,0,0,0
.quad 0,0,0,0,0,0,0,0
.quad 0,0,0,0,0,0,0,0
.quad 0xa4002400a4002400,0xa4002400a4002400,0,0,0,0,0,0
.quad 0,0,0,0,0,0,0,0
.quad 0,0,0,0,0,0,0,0
.quad 0,0,0,0,0,0,0,0
.quad 0xa4002400a4002400,0xa4002400a4002400,0,0,0,0,0,0
.quad 0,0,0,0,0,0,0,0
.quad 0,0,0,0,0,0,0,0
.quad 0,0,0,0,0,0,0,0
.quad 0xa4002400a4002400,0xa4002400a4002400,0,0,0,0,0,0
.quad 0,0,0,0,0,0,0,0
.quad 0,0,0,0,0,0,0,0
.quad 0,0,0,0,0,0,0,0
.quad 0xa4002400a4002400,0xa4002400a4002400,0,0,0,0,0,0
.quad 0,0,0,0,0,0,0,0
.quad 0,0,0,0,0,0,0,0
.quad 0,0,0,0,0,0,0,0
.quad 0xa4002400a4002400,0xa4002400a4002400,0,0,0,0,0,0
.quad 0,0,0,0,0,0,0,0
.quad 0,0,0,0,0,0,0,0
.quad 0,0,0,0,0,0,0,0
.quad 0xa4002400a4002400,0xa4002400a4002400,0,0,0,0,0,0
.quad 0,0,0,0,0,0,0,0
.quad 0,0,0,0,0,0,0,0
.quad 0,0,0,0,0,0,0,0
.quad 0xa4002400a4002400,0xa4002400a4002400,0,0,0,0,0,0
.quad 0,0,0,0,0,0,0,0
.quad 0,0,0,0,0,0,0,0
.quad 0,0,0,0,0,0,0,0
.quad 0xa4002400a4002400,0xa4002400a4002400,0,0,0,0,0,0
.quad 0,0,0,0,0,0,0,0
.quad 0,0,0,0,0,0,0,0
.quad 0,0,0,0,0,0,0,0
.quad 0xa4002400a4002400,0xa4002400a4002400,0,0,0,0,0,0
.quad 0,0,0,0,0,0,0,0
.quad 0,0,0,0,0,0,0,0
.quad 0,0,0,0,0,0,0,0
.quad 0xa4002400a4002400,0xa4002400a4002400,0,0,0,0,0,0
.quad 0,0,0,0,0,0,0,0
.quad 0,0,0,0,0,0,0,0
.quad 0,0,0,0,0,0,0,0
.quad 0xa4002400a4002400,0xa4002400a4002400,0,0,0,0,0,0
.quad 0,0,0,0,0,0,0,0
.quad 0,0,0,0,0,0,0,0
.quad 0,0,0,0,0,0,0,0
.quad 0xa4002400a4002400,0xa4002400a4002400,0,0,0,0,0,0
.quad 0,0,0,0,0,0,0,0
.quad 0,0,0,0,0,0,0,0
.quad 0,0,0,0,0,0,0,0
.quad 0xa4002400a4002400,0xa4002400a4002400,0,0,0,0,0,0
.quad 0,0,0,0,0,0,0,0
.quad 0,0,0,0,0,0,0,0
.quad 0,0,0,0,0,0,0,0
.quad 0xa4002400a4002400,0xa4002400a4002400,0,0,0,0,0,0
.quad 0,0,0,0,0,0,0,0
.quad 0,0,0,0,0,0,0,0
.quad 0,0,0,0,0,0,0,0
.quad 0x8000800080008000,0x8000800080008000,0,0,0,0,0,0
.quad 0,0,0,0,0,0,0,0
.quad 0,0,0,0,0,0,0,0
.quad 0,0,0,0,0,0,0,0
.quad 0x8000800080008000,0x8000800080008000,0,0,0,0,0,0
.quad 0,0,0,0,0,0,0,0
.quad 0,0,0,0,0,0,0,0
.quad 0,0,0,0,0,0,0,0
.quad 0x8000800080008000,0x8000800080008000,0,0,0,0,0,0
.quad 0,0,0,0,0,0,0,0
.quad 0,0,0,0,0,0,0,0
.quad 0,0,0,0,0,0,0,0
.quad 0x8000800080008000,0x8000800080008000,0,0,0,0,0,0
.quad 0,0,0,0,0,0,0,0
.quad 0,0,0,0,0,0,0,0
.quad 0,0,0,0,0,0,0,0
.quad 0x8000800080008000,0x8000800080008000,0,0,0,0,0,0
.quad 0,0,0,0,0,0,0,0
.quad 0,0,0,0,0,0,0,0
.quad 0,0,0,0,0,0,0,0
.quad 0x8000800080008000,0x8000800080008000,0,0,0,0,0,0
.quad 0,0,0,0,0,0,0,0
.quad 0,0,0,0,0,0,0,0
.quad 0,0,0,0,0,0,0,0
.quad 0x8000800080008000,0x8000800080008000,0,0,0,0,0,0
.quad 0,0,0,0,0,0,0,0
.quad 0,0,0,0,0,0,0,0
.quad 0,0,0,0,0,0,0,0
.quad 0x8000800080008000,0x8000800080008000,0,0,0,0,0,0
.quad 0,0,0,0,0,0,0,0
.quad 0,0,0,0,0,0,0,0
.quad 0,0,0,0,0,0,0,0
.quad 0x8000800080008000,0x8000800080008000,0,0,0,0,0,0
.quad 0,0,0,0,0,0,0,0
.quad 0,0,0,0,0,0,0,0
.quad 0,0,0,0,0,0,0,0
.quad 0x8000800080008000,0x8000800080008000,0,0,0,0,0,0
.quad 0,0,0,0,0,0,0,0
.quad 0,0,0,0,0,0,0,0
.quad 0,0,0,0,0,0,0,0
.quad 0x8000800080008000,0x8000800080008000,0,0,0,0,0,0
.quad 0,0,0,0,0,0,0,0
.quad 0,0,0,0,0,0,0,0
.quad 0,0,0,0,0,0,0,0
.quad 0x8000800080008000,0x8000800080008000,0,0,0,0,0,0
.quad 0,0,0,0,0,0,0,0
.quad 0,0,0,0,0,0,0,0
.quad 0,0,0,0,0,0,0,0
.quad 0x8000800080008000,0x8000800080008000,0,0,0,0,0,0
.quad 0,0,0,0,0,0,0,0
.quad 0,0,0,0,0,0,0,0
.quad 0,0,0,0,0,0,0,0
.quad 0x8000800080008000,0x8000800080008000,0,0,0,0,0,0
.quad 0,0,0,0,0,0,0,0
.quad 0,0,0,0,0,0,0,0
.quad 0,0,0,0,0,0,0,0
.quad 0x8000800080008000,0x8000800080008000,0,0,0,0,0,0
.quad 0,0,0,0,0,0,0,0
.quad 0,0,0,0,0,0,0,0
.quad 0,0,0,0,0,0,0,0
.quad 0x8000800080008000,0x8000800080008000,0,0,0,0,0,0
.quad 0,0,0,0,0,0,0,0
.quad 0,0,0,0,0,0,0,0
.quad 0,0,0,0,0,0,0,0
.quad 0x8000800080008000,0x8000800080008000,0,0,0,0,0,0
.quad 0,0,0,0,0,0,0,0
.quad 0,0,0,0,0,0,0,0
.quad 0,0,0,0,0,0,0,0
.quad 0x8000800080008000,0x8000800080008000,0,0,0,0,0,0
.quad 0,0,0,0,0,0,0,0
.quad 0,0,0,0,0,0,0,0
.quad 0,0,0,0,0,0,0,0
.quad 0x8000800080008000,0x8000800080008000,0,0,0,0,0,0
.quad 0,0,0,0,0,0,0,0
.quad 0,0,0,0,0,0,0,0
.quad 0,0,0,0,0,0,0,0
.quad 0x8000800080008000,0x8000800080008000,0,0,0,0,0,0
.quad 0,0,0,0,0,0,0,0
.quad 0,0,0,0,0,0,0,0
.quad 0,0,0,0,0,0,0,0
.quad 0x8000800080008000,0x8000800080008000,0,0,0,0,0,0
.quad 0,0,0,0,0,0,0,0
.quad 0,0,0,0,0,0,0,0
.quad 0,0,0,0,0,0,0,0
.quad 0x8000800080008000,0x8000800080008000,0,0,0,0,0,0
.quad 0,0,0,0,0,0,0,0
.quad 0,0,0,0,0,0,0,0
.quad 0,0,0,0,0,0,0,0
.quad 0x8000800080008000,0x8000800080008000,0,0,0,0,0,0
.quad 0,0,0,0,0,0,0,0
.quad 0,0,0,0,0,0,0,0
.quad 0,0,0,0,0,0,0,0
.quad 0x8000800080008000,0x8000800080008000,0,0,0,0,0,0
.quad 0,0,0,0,0,0,0,0
.quad 0,0,0,0,0,0,0,0
.quad 0,0,0,0,0,0,0,0
.quad 0x8000800080008000,0x8000800080008000,0,0,0,0,0,0
.quad 0,0,0,0,0,0,0,0
.quad 0,0,0,0,0,0,0,0
.quad 0,0,0,0,0,0,0,0
.quad 0x8000800080008000,0x8000800080008000,0,0,0,0,0,0
.quad 0,0,0,0,0,0,0,0
.quad 0,0,0,0,0,0,0,0
.quad 0,0,0,0,0,0,0,0
.quad 0x8000800080008000,0x8000800080008000,0,0,0,0,0,0
.quad 0,0,0,0,0,0,0,0
.quad 0,0,0,0,0,0,0,0
.quad 0,0,0,0,0,0,0,0
.quad 0x8000800080008000,0x8000800080008000,0,0,0,0,0,0
.quad 0,0,0,0,0,0,0,0
.quad 0,0,0,0,0,0,0,0
.quad 0,0,0,0,0,0,0,0
.quad 0x23fe23ff24002400,0x23f623f923fb23fd,0x23f023f923fe2400,0x23a823bf23d323e3,0x23d323ec23fb2400,0x230e234d238323b0,0x23a823d923f62400,0x222f22a7230e2364
.quad 0x236f23bf23f02400,0x211321d022752300,0x2329239f23e82400,0x1f8b20cf21bc2286,0x22d5237923de2400,0x1ca51f5820e621f7,0x2275234d23d32400,0x16461cdc1fef2155
.quad 0x220a231c23c62400,0x964618791dea20a1,0x219422e423b82400,0x9ca58f2e1b8f1fbd,0x211322a723a82400,0x9f8b9a3e16461e1f,0x208a226423962400,0xa1139db591621c6e
.quad 0x1fef221d23832400,0xa22fa01199cd195c,0x1ebd21d0236f2400,0xa30ea1299d12132d,0x1d7f217f23592400,0xa3a8a21d9f25932d,0x1c37212923412400,0xa3f6a2e4a08a995c
.quad 0x23e823ec23f023f3,0x23d323d923de23e3,0x2329234d236f238d,0x227522a722d52300,0x21bc221d227522c6,0x1fef207220e62155,0x1f8b2072211321a8,0x16461a3e1ca51e1f
.quad 0x19cd1cdc1ebd2042,0x9d129a3e947c132d,0x98070f2e19cd1d49,0xa16aa0729ebd9c6e,0x9ebd9bfe947c172a,0xa359a2a7a1bca0a1,0xa16aa0119d12972a,0xa400a3d9a359a286
.quad 0xa2f2a1d0a05a9d49,0xa341a3d9a3fea3b0,0xa3d3a31ca1e4a042,0xa13fa2a7a396a3fd,0xa3f6a3d9a30ea1a8,0x9ca5a072a22fa364,0xa359a3f9a3c6a2c6,0x18079a3e9fefa1f7
.quad 0xa20aa379a400a38d,0x20291a3e98eb9fbd,0xa029a264a3b8a3f3,0x229720721aaf995c,0x9b8fa0cfa2f2a3f3,0x23de22a7205a195c,0x147c9db5a1bca38d,0x23c623d922751fbd
.quad 0x23b823bf23c623cd,0x2396239f23a823b0,0x219421d0220a2241,0x208a20cf21132155,0x1b8f1cdc1dea1ef1,0x91620f2e1646195c,0x9ca59a3e96460000,0xa113a0729f8b9e1f
.quad 0xa1e4a129a05a9ef1,0xa3c6a379a30ea286,0xa3d3a379a2f2a241,0xa359a3bfa3f6a3fd,0xa396a3eca3fea3cd,0x9fefa129a22fa300,0xa13fa264a341a3cd,0x180795619ca59fbd
.quad 0x99cd9e89a0e6a241,0x219420111ca5132d,0x1d7f156199cd9ef1,0x23e8234d222f20a1,0x222f20721ca58000,0x230e23d923f62364,0x23e8231c21941ef1,0x1ebd217f230e23e3
.quad 0x236f23ff23962241,0x9aaf18791f8b21f7,0x20e622e423e823cd,0xa20a9f5896461c6e,0x18072011227523cd,0xa3fba31ca1139c6e,0x9e540f2e1f252241,0xa2b7a3eca3a8a1f7
.quad 0x236f23792383238d,0x2341234d23592364,0x1ebd1f581fef2042,0x1c371cdc1d7f1e1f,0x9d129bfe99cd972a,0xa08aa0119f259e1f,0xa30ea2a7a22fa1a8,0xa3f6a3d9a3a8a364
.quad 0xa3b8a3eca400a3f3,0xa1bca264a2f2a364,0xa029a129a20aa2c6,0x147c95619b8f9e1f,0x1aaf0f2e98eb9d49,0x2275217f205a1e1f,0x2297217f20291d49,0x23c623ff23de2364
.quad 0x23e823f9239622c6,0x1f25212922752364,0x20e62264236f23f3,0x9e54987918071e1f,0x96461a3e1f8b21a8,0xa3a8a2a7a1139e1f,0xa20aa0119aaf172a,0xa2b7a3bfa3fba364
.quad 0xa3fea39fa253a042,0x98079f58a1e4a364,0xa194a34da3fea38d,0x216a1db58b2e9e1f,0x8b2e9e89a1e4a38d,0x23fe237921bc1e1f,0x216a1cdc9807a042,0x20e6231c23fe2364
.quad 0x230e231c23292335,0x22d522e422f22300,0x1646187919cd1b1f,0x947c8f2e0b2e132d,0xa22fa1d0a16aa0fd,0xa359a31ca2d5a286,0xa3a8a3d9a3f6a400,0xa22fa2a7a30ea364
.quad 0x9ca59e89a029a0fd,0x1aaf15619162995c,0x211320111dea1b1f,0x23b8234d22b721f7,0x23f623f923b82335,0x216a2264232923b0,0x1f8b212922532335,0x9d7f9879147c1c6e
.quad 0x9f8b9bfe8b2e1b1f,0xa3f0a379a297a155,0xa3f6a379a275a0fd,0xa08aa21da341a3e3,0xa113a2a7a3a8a400,0x1f8b1a3e96469e1f,0x1ca58f2e9d7fa0fd,0x2400239f227520a1
.quad 0x23a82264205a1b1f,0x1f2521d0235923fd,0x222f239f23fb2335,0xa0b89bfe18071fbd,0x96461cdc213f2335,0xa3e8a3bfa2539fbd,0xa30ea0cf9aaf1b1f,0x9d12a17fa36fa3fd
.quad 0x229722a722b722c6,0x2253226422752286,0x9b8f9a3e98eb972a,0x9e549db59d129c6e,0xa3f0a3d9a3b8a38d,0xa3e8a3f9a400a3fd,0x9f8ba072a113a1a8,0x96469a3e9ca59e1f
.quad 0x213f20721f251d49,0x2383231c229721f7,0x238323d923fe23f3,0x208a217f22532300,0xb2e1a3e1dea2042,0xa13fa0119d7f995c,0xa36fa2a7a194a042,0xa329a3bfa3fea3e3
.quad 0xa16aa2a7a383a3f3,0x1aaf8f2e9c379fbd,0x1f251a3e947c9d49,0x23fe239f22b72155,0x23f623d9230e21a8,0x1ca52072222f2364,0x1c3720722253238d,0xa2d5a1299dea932d
.quad 0xa275a0729b8f172a,0xa1bca34da3fba3b0,0xa2b7a3d9a3dea2c6,0x1fef18799b8fa0a1,0x1aaf9a3ea08aa2c6,0x23b823ec22d520a1,0x23e822a72029172a,0x8b2e1e89220a23b0
.quad 0x220a221d222f2241,0x21bc21d021e421f7,0xa05aa0119f8b9ef1,0xa16aa129a0e6a0a1,0xa341a379a3a8a3cd,0xa20aa264a2b7a300,0x1ca51a3e16468000,0x211320721f8b1e1f
.quad 0x23e823ff23f623cd,0x225322e4235923b0,0x8b2e18791ca51ef1,0xa0b89f589d12995c,0xa3f0a39fa30ea241,0xa297a34da3c6a3fd,0x9c379f58a113a241,0x205a1db518eb932d
.quad 0x2359226421131ef1,0x22d5239f23fb23e3,0x202921d0230e23cd,0x9fef9bfe0b2e1c6e,0xa22fa0729ca50000,0xa30ea3d9a3f6a364,0xa1e4a34da3f6a3cd,0x1f25187999cd9fbd
.quad 0x208a1bfe96469ef1,0x234123f923b82286,0x232923f923a82241,0x9e548f2e1d7f2155,0x9d1215611f8b2241,0xa36fa3ffa341a155,0xa3dea3bfa22f9ef1,0x1d7f95619fefa286
.quad 0x216a217f219421a8,0x21132129213f2155,0xa253a21da1e4a1a8,0xa30ea2e4a2b7a286,0xa05aa0cfa13fa1a8,0x9ca59db59ebd9fbd,0x230e22a7222f21a8,0x23f623d923a82364
.quad 0x1e54201120e621a8,0x96460f2e18eb1c6e,0xa396a31ca275a1a8,0xa3a8a3eca400a3e3,0x9b8f9e89a08aa1a8,0x1f8b1cdc1807932d,0x23e8237922b721a8,0x222f231c23b823fd
.quad 0x147c1cdc202921a8,0xa22fa0cf9e54995c,0xa400a3bfa2f2a1a8,0x9f8ba17fa2d5a3b0,0x16469a3e9f8ba1a8,0x23a822a721131e1f,0x23de23ec232921a8,0x16461e89216a2300
.quad 0x9c3715611ebd21a8,0xa3f6a3bfa297a0a1,0xa383a3ffa359a1a8,0x1ca595619f25a1f7,0x1ebd0f2e9deaa1a8,0x230e23f9239621f7,0x22f223f9238321a8,0xa1139bfe19cd20a1
.quad 0x20b820cf20e620fd,0x205a2072208a20a1,0xa396a379a359a335,0xa3e8a3d9a3c6a3b0,0x8b2e956198eb9b1f,0x1c371a3e1807132d,0x23a823d923f62400,0x222f22a7230e2364
.quad 0xa08a9f589d7f9b1f,0xa329a2a7a20aa155,0xa0e6a1d0a297a335,0x91629a3e9d7f9fbd,0x238322e4220a20fd,0x236f23d9240023e3,0x11621bfe1f2520fd,0xa1bca0729dea995c
.quad 0xa3b8a3ffa3d3a335,0x9d7fa072a1e4a300,0x205a1cdc11629b1f,0x23fb23d9232921f7,0x211322a723a82400,0x9f8b9a3e16461e1f,0xa36fa21da0299b1f,0xa0e6a2a7a3b8a3fd
.quad 0x947c9e89a194a335,0x23c622a720b81c6e,0x23c623ec22f220fd,0x99cd1a3e205a2286,0xa02998791c3720fd,0xa297a3d9a3d3a286,0xa13fa34da400a335,0x22d5207218eb9c6e
.quad 0x1fef201120292042,0x1f251f581f8b1fbd,0xa400a3ffa3fba3f3,0xa3dea3eca3f6a3fd,0x20291f581e541d49,0x21e4217f211320a1,0x1f8b2072211321a8,0x16461a3e1ca51e1f
.quad 0xa3fea3f9a3d3a38d,0xa2d5a34da3a8a3e3,0x205a1e891c37172a,0x236f22e4222f2155,0x1f2520cf21e422c6,0x9c37956116461c6e,0xa3fba3eca383a2c6,0xa0e6a21da30ea3b0
.quad 0x208a1db51807972a,0x240023bf230e21f7,0x1ebd21292297238d,0xa0b89db59646195c,0xa3f6a3d9a30ea1a8,0x9ca5a072a22fa364,0x20b81cdc8b2e9d49,0x238323ff23a82286
.quad 0x1e54217f232923f3,0xa2b7a0cf9ca5132d,0xa3f0a3bfa275a042,0x147c9cdca113a300,0x20e61bfe98eba042,0x220a239f23f62300,0x1dea21d0239623f3,0xa3d3a2649f8b932d
.quad 0x1e541e891ebd1ef1,0x1d7f1db51dea1e1f,0xa383a39fa3b8a3cd,0xa2f2a31ca341a364,0x232922e422972241,0x23de23bf23962364,0x9ca59a3e96460000,0xa113a0729f8b9e1f
.quad 0x9fefa0cfa194a241,0x8b2e98799c379e1f,0x23c623f923fb23cd,0x213f221d22d52364,0xa2b7a1d0a0b89ef1,0xa3e8a3ffa3d3a364,0x19cd8f2e9b8f9ef1,0x22d521d0208a1e1f
.quad 0x20b8221d232923cd,0x9d12956118eb1e1f,0xa3f0a3eca359a241,0x9deaa0cfa253a364,0x222f20721ca58000,0x230e23d923f62364,0x947c1bfe205a2241,0xa3d3a2e4a13f9e1f
.quad 0xa16aa31ca3f0a3cd,0x20e61cdc91629e1f,0x2400237921e41ef1,0x11621e8921bc2364,0xa1949db511621ef1,0xa16aa34da400a364,0x91629f58a253a3cd,0x23f0239f21e41e1f
.quad 0x1ca51cdc1d121d49,0x1b8f1bfe1c371c6e,0xa22fa264a297a2c6,0xa13fa17fa1bca1f7,0x23f623ff23fe23f3,0x236f239f23c623e3,0xa30ea2a7a22fa1a8,0xa3f6a3d9a3a8a364
.quad 0x1f8b1db51b8f172a,0x22b7221d216a20a1,0x16461bfe1e542042,0x9fef9db59aaf932d,0xa113a21da2f2a38d,0x116298799d129fbd,0x23a823f923f0238d,0x1ebd20cf220a2300
.quad 0xa3a8a2e4a1bca042,0xa253a34da3dea3fd,0x21131e8918eb972a,0x23de23f923832286,0x96461a3e1f8b21a8,0xa3a8a2a7a1139e1f,0x9f8ba1d0a341a3f3,0x21bc1f5818eb995c
.quad 0x230e23ec23d322c6,0x9d120f2e1dea2155,0xa3f6a31ca13f9d49,0x98eba011a253a3b0,0x222f1f58147c9d49,0x20b822e423f023b0,0x9ca51879205a22c6,0xa329a3ffa359a155
.quad 0x19cd1a3e1aaf1b1f,0x1807187918eb195c,0xa029a072a0b8a0fd,0x9dea9e899f259fbd,0x225322a722f22335,0x20b82129219421f7,0xa3a8a3d9a3f6a400,0xa22fa2a7a30ea364
.quad 0x23fb23d923962335,0x2341239f23de23fd,0xa341a2a7a1e4a0fd,0xa3dea3ffa3f0a3b0,0x219420721e541b1f,0x23fb23bf23412286,0x9e549a3e0b2e1b1f,0xa396a2e4a1e4a0a1
.quad 0x11629a3e9ebda0fd,0x22b7217f1fef1c6e,0x1d122072220a2335,0xa16a9f589aaf132d,0xa113a2a7a3a8a400,0x1f8b1a3e96469e1f,0x22f223d923f02335,0x9b8f15611e542155
.quad 0xa3e8a3d9a2d5a0fd,0x8b2e9db5a13fa300,0x23d322a7208a1b1f,0x1c3720cf22d523e3,0xa2b7a07299cd1b1f,0x9fefa264a3c6a3e3,0x20b81a3e9b8fa0fd,0x2194237923fb2300
.quad 0x147c15611646172a,0xb2e0f2e1162132d,0x9aaf9bfe9ca59d49,0x916295619807995c,0x1d7f1e891f8b2042,0x147c18791aaf1c6e,0x9f8ba072a113a1a8,0x96469a3e9ca59e1f
.quad 0x20b8217f222f22c6,0x18071bfe1dea1fbd,0xa194a264a30ea38d,0x98eb9cdc9f25a0a1,0x2253231c23a823f3,0x19cd1db520292155,0xa2f2a39fa3f6a3f3,0x9aaf9e89a0b8a1f7
.quad 0x236f23ec23f6238d,0x1b8f1f58213f2286,0xa3c6a3ffa3a8a2c6,0x9c37a011a1bca300,0x23f623d9230e21a8,0x1ca52072222f2364,0xa3fea379a22fa042,0x9d12a0cfa297a3b0
.quad 0x23de22e421131d49,0x1d7f212922f223e3,0xa396a21d9f8b972a,0x9deaa17fa341a3fd,0x232921291ca5972a,0x1e5421d0238323fd,0xa297a01196461d49,0x9ebda21da3b8a3e3
.quad 0x91628f2e8b2e0000,0x96469561947c932d,0x1807156111628000,0x1ca51bfe1aaf195c,0x9aaf9879947c0000,0x9f8b9e899d7f9c6e,0x1ca51a3e16468000,0x211320721f8b1e1f
.quad 0x9dea9bfe98070000,0xa22fa17fa0b89fbd,0x1f251cdc18eb8000,0x230e2264219420a1,0xa0299db599cd0000,0xa3a8a31ca253a155,0x20b81e891aaf8000,0x23f6239f22f221f7
.quad 0xa13f9f589b8f0000,0xa3f6a3eca36fa286,0x21bc20111c378000,0x23a823ff23c62300,0xa22fa0729ca50000,0xa30ea3d9a3f6a364,0x229720cf1d128000,0x222f237923fe23b0
.quad 0xa2f2a1299d7f0000,0xa113a2e4a3dea3e3,0x2341217f1dea8000,0x1f8b221d239623fd,0xa383a1d09e540000,0x9ca5a129a329a3fd,0x23b8221d1ebd8000,0x16462011229723e3
.quad 0x98eb98799807972a,0x9aaf9a3e99cd995c,0x1f251e891dea1d49,0x20b8207220291fbd,0xa194a129a0b8a042,0xa2f2a2a7a253a1f7,0x230e22a7222f21a8,0x23f623d923a82364
.quad 0xa3dea39fa341a2c6,0xa396a3d9a3fba3fd,0x23f023ff23de238d,0x21e422a7234123b0,0xa341a3bfa3fba3f3,0x9e54a072a194a286,0x21e422e4239623f3,0x8b2e1a3e1e5420a1
.quad 0x9fefa17fa2b7a38d,0x1ebd1a3e91629c6e,0x1aaf1f58216a22c6,0xa20aa0729d12932d,0x16469a3e9f8ba1a8,0x23a822a721131e1f,0x9e5495611b8f2042,0xa3f0a3d9a2f2a155
.quad 0x213f1db50b2e9d49,0x22d523d923e82300,0xa2d5a0cf9c37172a,0xa08aa2a7a3d3a3e3,0x23c622641fef172a,0x19cd207222b723e3,0xa3fba379a1949d49,0x1b8f9a3ea0b8a300
.quad 0x9c379bfe9b8f9b1f,0x9d129cdc9ca59c6e,0x21bc217f213f20fd,0x22972264222f21f7,0xa3c6a39fa36fa335,0xa3fea3ffa3f6a3e3,0x23a823d923f62400,0x222f22a7230e2364
.quad 0xa16aa21da2b7a335,0x9b8f9db59f8ba0a1,0x1aaf1db51fef20fd,0x9e549bfe9646132d,0x1d12187991629b1f,0x22f2221d21131fbd,0xa20aa0cf9ebd9b1f,0xa3f0a3f9a3a8a300
.quad 0x23de234d225320fd,0x21bc22e423a823fd,0xa383a3f9a3dea335,0x98eb9e89a113a286,0x211322a723a82400,0x9f8b9a3e16461e1f,0x98eb9f58a1bca335,0x234121d01f8b195c
.quad 0x9dea8f2e1d1220fd,0xa3d3a3eca30ea155,0x2253201118eb9b1f,0x213f231c23f623b0,0xa3f0a2e4a0b89b1f,0x947c9f58a22fa3b0,0x235923ff232920fd,0xa05a98791ca52155
.quad 0x9dea9db59d7f9d49,0x9ebd9e899e549e1f,0x2341231c22f222c6,0x23b8239f23832364,0xa396a3bfa3dea3f3,0xa297a2e4a329a364,0x1f8b2072211321a8,0x16461a3e1ca51e1f
.quad 0x1c3718790b2e972a,0x219420cf1fef1e1f,0xa2d5a21da13fa042,0xa3fba3f9a3c6a364,0x23d323ff23e8238d,0x20b821d022b72364,0xa08aa1d0a2d5a38d,0x1b8f0f2e99cd9e1f
.quad 0x98eb15611d122042,0xa329a21da0b89e1f,0x225320cf1dea172a,0x235923ec23f02364,0xa3f6a3d9a30ea1a8,0x9ca5a072a22fa364,0x213f22e423d323f3,0xa05a9bfe147c1e1f
.quad 0x11629cdca0e6a2c6,0x23f0231c216a1e1f,0xa1bc9e8991621d49,0xa1e4a379a400a364,0x2400234d216a1d49,0x91621db521942364,0xa1e4a39fa3f0a2c6,0x22531f5811629e1f
.quad 0x9f8b9f589f259ef1,0xa029a0119fef9fbd,0x23f623ec23de23cd,0x23fb23ff240023fd,0xa113a17fa1e4a241,0x9e549f58a029a0a1,0x9ca59a3e96460000,0xa113a0729f8b9e1f
.quad 0x23a8234d22d52241,0x23d323f923fe23e3,0xa22fa2e4a36fa3cd,0x9c379e89a05aa155,0x964615611c371ef1,0xa1e4a0cf9f259c6e,0x230e221d20e61ef1,0x238323ec23fb23b0
.quad 0xa30ea3bfa400a3cd,0x98079db5a08aa1f7,0x16461db520b82241,0xa297a1299ebd995c,0x222f20721ca58000,0x230e23d923f62364,0xa3a8a3ffa383a241,0xb2e9cdca0b8a286
.quad 0x1ca520cf22b723cd,0xa329a17f9e54932d,0x21131cdc947c9ef1,0x227523bf23f02300,0xa3f6a39fa20a9ef1,0x18eb9bfea0e6a300,0x1f8b226423d323cd,0xa396a1d09dea132d
.quad 0xa08aa072a05aa042,0xa0e6a0cfa0b8a0a1,0x23c623d923e823f3,0x23592379239623b0,0x98079a3e9c379d49,0x18eb15610b2e932d,0xa30ea2a7a22fa1a8,0xa3f6a3d9a3a8a364
.quad 0x220a22a72329238d,0x1d7f1f58208a2155,0x1d7f1a3e1162972a,0x229721d020e61fbd,0xa400a3d9a36fa2c6,0xa20aa2e4a383a3e3,0x1dea207221bc22c6,0x9f259bfe9162195c
.quad 0x21e420721d7f172a,0x23d323ff23b82300,0xa329a3d9a3fba38d,0x91629cdca05aa1f7,0x96461a3e1f8b21a8,0xa3a8a2a7a1139e1f,0x23b822a720e61d49,0x2029221d236f23fd
.quad 0xa0b8a2a7a3c6a3f3,0x21941e89147c9c6e,0xa05a9a3e19cd2042,0xa2f2a3eca3c6a286,0x23d323d922972042,0x9c37187920292286,0x98eba072a2d5a3f3,0x2400234d213f1c6e
.quad 0xa13fa129a113a0fd,0xa194a17fa16aa155,0x22b722e4230e2335,0x21e4221d22532286,0x1ebd1db51ca51b1f,0x213f20cf205a1fbd,0xa3a8a3d9a3f6a400,0xa22fa2a7a30ea364
.quad 0x98eb8f2e16461b1f,0xa0e6a0119e549c6e,0x240023ec23a82335,0x2275231c239623e3,0x98079cdc9f8ba0fd,0x208a1e891b8f132d,0xa3b8a31ca22fa0fd,0xa2b7a379a3e8a3fd
.quad 0x1e5420cf222f2335,0xa0299cdc947c195c,0x22d5217f1f8b1b1f,0x22f223bf240023b0,0xa113a2a7a3a8a400,0x1f8b1a3e96469e1f,0xa16a9e8996461b1f,0xa329a3eca3dea300
.quad 0x229723bf23f62335,0x9ebd95611c3720a1,0x1f2515619ca5a0fd,0x235923ff238321f7,0xa396a3f9a30ea0fd,0x1dea8f2e9ebda1f7,0x99cd1bfe21132335,0xa383a3f9a2f2a0a1
.quad 0xa1e4a1d0a1bca1a8,0xa22fa21da20aa1f7,0x20e62129216a21a8,0x1f8b2011205a20a1,0x22b72264220a21a8,0x23a8237923412300,0x9f8ba072a113a1a8,0x96469a3e9ca59e1f
.quad 0xa359a2e4a253a1a8,0xa3f6a3ffa3e8a3b0,0x1d121f5820b821a8,0x9ca598790b2e195c,0x23c6234d229721a8,0x230e239f23f023fd,0x98eb9db5a05aa1a8,0x21131f581c37132d
.quad 0xa3fba39fa2d5a1a8,0xa113a264a359a3e3,0x8b2e1bfe1fef21a8,0xa30ea1d0a0299c6e,0x23f623d9230e21a8,0x1ca52072222f2364,0x19cd98799f25a1a8,0x23f6234d21e41fbd
.quad 0xa3b8a3f9a341a1a8,0x16469bfea08aa286,0x9d7f0f2e1e5421a8,0xa3a8a3f9a329a155,0x234123ff236f21a8,0x9f8b95611d122155,0x1fef15619d7fa1a8,0x222f23bf23de2286
.quad 0xa275a264a253a241,0xa2b7a2a7a297a286,0x1d121db51e541ef1,0x18eb1a3e1b8f1c6e,0x240023f923e823cd,0x23b823d923f023fd,0x1ca51a3e16468000,0x211320721f8b1e1f
.quad 0xa297a31ca383a3cd,0x9f25a072a13fa1f7,0xa253a17fa08a9ef1,0xa3fea3d9a383a300,0x1d7f2011213f2241,0x9dea9a3e8b2e195c,0x23fe23bf23292241,0x219422a7236f23e3
.quad 0x1c370f2e9aaf9ef1,0x238322a7216a1fbd,0xa2b7a39fa3fea3cd,0x147c9a3e9f25a155,0xa22fa0729ca50000,0xa30ea3d9a3f6a364,0x1dea212922d523cd,0xa253a0729c37132d
.quad 0x23fb234d21bc1ef1,0x1b8f2072227523b0,0x1b8f98799fefa241,0x23de23d922b720a1,0xa2d5a3eca3b8a241,0x208a1a3e9aafa0a1,0xa20a9e890b2e1ef1,0xa029a2a7a3e8a3b0
.quad 0xa2f2a2e4a2d5a2c6,0xa329a31ca30ea300,0x8b2e0f2e147c172a,0x99cd98799646932d,0x22d5231c2359238d,0x216a21d0222f2286,0x230e22a7222f21a8,0x23f623d923a82364
.quad 0x116295619aaf9d49,0x20291e891ca5195c,0xa2b7a34da3b8a3f3,0x9deaa011a113a1f7,0xa329a264a16aa042,0xa3b8a3f9a3f6a3b0,0x947c18791d7f2042,0xa253a1299f8b9c6e
.quad 0x2297237923f023f3,0xb2e1bfe1f8b2155,0x2341221d208a1d49,0x2275237923f623e3,0x16469a3e9f8ba1a8,0x23a822a721131e1f,0xa275a39fa400a38d,0x1d7f0f2e9ca5a0a1
.quad 0xa359a1d09f25972a,0xa05aa264a3a8a3fd,0x98071bfe20b822c6,0xa3fba39fa22f9fbd,0x225323bf23e822c6,0xa13f9cdc16461fbd,0x236f217f1d12972a,0x1aaf20cf230e23fd
.quad 0xa359a34da341a335,0xa383a379a36fa364,0x9d7f9cdc9c379b1f,0x9fef9f589ebd9e1f,0x1f252011208a20fd,0x19cd1bfe1d121e1f,0x23a823d923f62400,0x222f22a7230e2364
.quad 0x22f2226421bc20fd,0x240023ec23b82364,0x1b8f1561947c9b1f,0x220a212920291e1f,0xa05aa17fa275a335,0x18eb8f2e9aaf9e1f,0xa3dea3ffa3c6a335,0xa029a17fa297a364
.quad 0xa275a1299f259b1f,0xa396a3f9a3e8a364,0x980718791e5420fd,0xa36fa264a0e69e1f,0x211322a723a82400,0x9f8b9a3e16461e1f,0x23fb23bf22b720fd,0x1aaf2011220a2364
.quad 0x21e41f5818079b1f,0x2253239f23fe2364,0xb2e9db5a16aa335,0x23fe234d21941e1f,0xa1bca379a3fea335,0x21e41e890b2e9e1f,0xa3fea31ca0e69b1f,0x18079cdca16aa364
.quad 0xa3a8a39fa396a38d,0xa3c6a3bfa3b8a3b0,0xa113a0cfa08aa042,0xa20aa1d0a194a155,0x96468f2e1162172a,0x9dea9cdc9b8f995c,0x1f8b2072211321a8,0x16461a3e1ca51e1f
.quad 0x230e237923c623f3,0x205a212921e42286,0x23f623bf235922c6,0x22f2237923d323fd,0x222f21291fef1d49,0x23fe23ec23962300,0x1ca5156198079d49,0x23412264213f1fbd
.quad 0x9ca5a011a194a2c6,0x20e61e8919cd932d,0xa22fa34da3e8a3f3,0x19cd95619d7fa0a1,0xa3f6a3d9a30ea1a8,0x9ca5a072a22fa364,0xa30ea17f9ebd972a,0xa194a31ca3e8a3e3
.quad 0x9f8b98791aaf2042,0xa396a3ffa36fa1f7,0x16461f58220a238d,0xa3e8a2e4a0e69c6e,0x2113231c23fb238d,0xa275a01198071c6e,0x23a823ec22b72042,0x9f258f2e1e5421f7
.quad 0xa3dea3d9a3d3a3cd,0xa3f0a3eca3e8a3e3,0xa2d5a2a7a275a241,0xa36fa34da329a300,0xa0e6a0729fef9ef1,0xa275a21da1bca155,0x9ca59a3e96460000,0xa113a0729f8b9e1f
.quad 0x147c1a3e1d121ef1,0x9ebd9cdc99cd932d,0x1ebd2072216a2241,0x99cd8f2e18071c6e,0x21bc22a7235923cd,0x147c1bfe1ebd20a1,0x235923d9240023cd,0x1d122011216a2286
.quad 0x23fe23d923412241,0x205a21d022f223b0,0x239622a7213f1ef1,0x21e4231c23d323fd,0x222f20721ca58000,0x230e23d923f62364,0x1fef1a3e98079ef1,0x23c623f9235921f7
.quad 0x18eb9a3ea029a241,0x24002379220a1fbd,0x9aafa072a297a3cd,0x23b822642029195c,0xa05aa2a7a3dea3cd,0x22f220cf1b8f995c,0xa275a3d9a3c6a241,0x21bc1db5947c9fbd
.quad 0xa3fba3f9a3f6a3f3,0xa400a3ffa3fea3fd,0xa3d3a3bfa3a8a38d,0xa3fea3f9a3f0a3e3,0xa383a34da30ea2c6,0xa3fba3eca3d3a3b0,0xa30ea2a7a22fa1a8,0xa3f6a3d9a3a8a364
.quad 0xa275a1d0a113a042,0xa3f0a3bfa36fa300,0xa1bca0cf9f8b9d49,0xa3e8a39fa329a286,0xa0e69f589ca5972a,0xa3dea379a2d5a1f7,0x9fef9cdc9646172a,0xa3d3a34da275a155
.quad 0x9dea987916461d49,0xa3c6a31ca20aa0a1,0x9b8f0f2e1ca52042,0xa3b8a2e4a1949fbd,0x96461a3e1f8b21a8,0xa3a8a2a7a1139e1f,0x11621db5211322c6,0xa396a264a08a9c6e
.quad 0x19cd2011222f238d,0xa383a21d9fef995c,0x1d122129230e23f3,0xa36fa1d09ebd932d,0x1f25221d23a823f3,0xa359a17f9d7f132d,0x208a22e423f6238d,0xa341a1299c37195c
.quad 0x91628f2e8b2e8000,0x96469561947c932d,0x9807956191628000,0x9ca59bfe9aaf995c,0x9aaf9879947c8000,0x9f8b9e899d7f9c6e,0x9ca59a3e96468000,0xa113a0729f8b9e1f
.quad 0x9dea9bfe98078000,0xa22fa17fa0b89fbd,0x9f259cdc98eb8000,0xa30ea264a194a0a1,0xa0299db599cd8000,0xa3a8a31ca253a155,0xa0b89e899aaf8000,0xa3f6a39fa2f2a1f7
.quad 0xa13f9f589b8f8000,0xa3f6a3eca36fa286,0xa1bca0119c378000,0xa3a8a3ffa3c6a300,0xa22fa0729ca58000,0xa30ea3d9a3f6a364,0xa297a0cf9d128000,0xa22fa379a3fea3b0
.quad 0xa2f2a1299d7f8000,0xa113a2e4a3dea3e3,0xa341a17f9dea8000,0x9f8ba21da396a3fd,0xa383a1d09e548000,0x9ca5a129a329a3fd,0xa3b8a21d9ebd8000,0x9646a011a297a3e3
.quad 0x98eb98799807972a,0x9aaf9a3e99cd995c,0x9f259e899dea9d49,0xa0b8a072a0299fbd,0xa194a129a0b8a042,0xa2f2a2a7a253a1f7,0xa30ea2a7a22fa1a8,0xa3f6a3d9a3a8a364
.quad 0xa3dea39fa341a2c6,0xa396a3d9a3fba3fd,0xa3f0a3ffa3dea38d,0xa1e4a2a7a341a3b0,0xa341a3bfa3fba3f3,0x9e54a072a194a286,0xa1e4a2e4a396a3f3,0xb2e9a3e9e54a0a1
.quad 0x9fefa17fa2b7a38d,0x1ebd1a3e91629c6e,0x9aaf9f58a16aa2c6,0x220a20721d12132d,0x16469a3e9f8ba1a8,0x23a822a721131e1f,0x1e5415619b8fa042,0x23f023d922f22155
.quad 0x213f1db50b2e9d49,0x22d523d923e82300,0x22d520cf1c37972a,0x208a22a723d323e3,0x23c622641fef172a,0x19cd207222b723e3,0x23fb237921941d49,0x9b8f1a3e20b82300
.quad 0x9c379bfe9b8f9b1f,0x9d129cdc9ca59c6e,0xa1bca17fa13fa0fd,0xa297a264a22fa1f7,0xa3c6a39fa36fa335,0xa3fea3ffa3f6a3e3,0xa3a8a3d9a3f6a400,0xa22fa2a7a30ea364
.quad 0xa16aa21da2b7a335,0x9b8f9db59f8ba0a1,0x9aaf9db59fefa0fd,0x1e541bfe1646932d,0x1d12187991629b1f,0x22f2221d21131fbd,0x220a20cf1ebd1b1f,0x23f023f923a82300
.quad 0x23de234d225320fd,0x21bc22e423a823fd,0x238323f923de2335,0x18eb1e8921132286,0x211322a723a82400,0x9f8b9a3e16461e1f,0x18eb1f5821bc2335,0xa341a1d09f8b995c
.quad 0x9dea8f2e1d1220fd,0xa3d3a3eca30ea155,0xa253a01198eb1b1f,0xa13fa31ca3f6a3b0,0xa3f0a2e4a0b89b1f,0x947c9f58a22fa3b0,0xa359a3ffa329a0fd,0x205a18799ca5a155
.quad 0x9dea9db59d7f9d49,0x9ebd9e899e549e1f,0xa341a31ca2f2a2c6,0xa3b8a39fa383a364,0xa396a3bfa3dea3f3,0xa297a2e4a329a364,0x9f8ba072a113a1a8,0x96469a3e9ca59e1f
.quad 0x1c3718790b2e972a,0x219420cf1fef1e1f,0x22d5221d213f2042,0x23fb23f923c62364,0x23d323ff23e8238d,0x20b821d022b72364,0x208a21d022d5238d,0x9b8f8f2e19cd1e1f
.quad 0x98eb15611d122042,0xa329a21da0b89e1f,0xa253a0cf9dea972a,0xa359a3eca3f0a364,0xa3f6a3d9a30ea1a8,0x9ca5a072a22fa364,0xa13fa2e4a3d3a3f3,0x205a1bfe947c9e1f
.quad 0x11629cdca0e6a2c6,0x23f0231c216a1e1f,0x21bc1e8911629d49,0x21e4237924002364,0x2400234d216a1d49,0x91621db521942364,0x21e4239f23f022c6,0xa2539f5891621e1f
.quad 0x9f8b9f589f259ef1,0xa029a0119fef9fbd,0xa3f6a3eca3dea3cd,0xa3fba3ffa400a3fd,0xa113a17fa1e4a241,0x9e549f58a029a0a1,0x1ca51a3e16468000,0x211320721f8b1e1f
.quad 0x23a8234d22d52241,0x23d323f923fe23e3,0x222f22e4236f23cd,0x1c371e89205a2155,0x964615611c371ef1,0xa1e4a0cf9f259c6e,0xa30ea21da0e69ef1,0xa383a3eca3fba3b0
.quad 0xa30ea3bfa400a3cd,0x98079db5a08aa1f7,0x96469db5a0b8a241,0x229721291ebd195c,0x222f20721ca58000,0x230e23d923f62364,0x23a823ff23832241,0x8b2e1cdc20b82286
.quad 0x1ca520cf22b723cd,0xa329a17f9e54932d,0xa1139cdc147c1ef1,0xa275a3bfa3f0a300,0xa3f6a39fa20a9ef1,0x18eb9bfea0e6a300,0x9f8ba264a3d3a3cd,0x239621d01dea932d
.quad 0xa08aa072a05aa042,0xa0e6a0cfa0b8a0a1,0xa3c6a3d9a3e8a3f3,0xa359a379a396a3b0,0x98079a3e9c379d49,0x18eb15610b2e932d,0x230e22a7222f21a8,0x23f623d923a82364
.quad 0x220a22a72329238d,0x1d7f1f58208a2155,0x9d7f9a3e9162172a,0xa297a1d0a0e69fbd,0xa400a3d9a36fa2c6,0xa20aa2e4a383a3e3,0x9deaa072a1bca2c6,0x1f251bfe1162995c
.quad 0x21e420721d7f172a,0x23d323ff23b82300,0x232923d923fb238d,0x11621cdc205a21f7,0x96461a3e1f8b21a8,0xa3a8a2a7a1139e1f,0xa3b8a2a7a0e69d49,0xa029a21da36fa3fd
.quad 0xa0b8a2a7a3c6a3f3,0x21941e89147c9c6e,0x205a1a3e99cda042,0x22f223ec23c62286,0x23d323d922972042,0x9c37187920292286,0x18eb207222d523f3,0xa400a34da13f9c6e
.quad 0xa13fa129a113a0fd,0xa194a17fa16aa155,0xa2b7a2e4a30ea335,0xa1e4a21da253a286,0x1ebd1db51ca51b1f,0x213f20cf205a1fbd,0x23a823d923f62400,0x222f22a7230e2364
.quad 0x98eb8f2e16461b1f,0xa0e6a0119e549c6e,0xa400a3eca3a8a335,0xa275a31ca396a3e3,0x98079cdc9f8ba0fd,0x208a1e891b8f132d,0x23b8231c222f20fd,0x22b7237923e823fd
.quad 0x1e5420cf222f2335,0xa0299cdc947c195c,0xa2d5a17f9f8b9b1f,0xa2f2a3bfa400a3b0,0xa113a2a7a3a8a400,0x1f8b1a3e96469e1f,0x216a1e8916469b1f,0x232923ec23de2300
.quad 0x229723bf23f62335,0x9ebd95611c3720a1,0x9f2595611ca520fd,0xa359a3ffa383a1f7,0xa396a3f9a30ea0fd,0x1dea8f2e9ebda1f7,0x19cd9bfea113a335,0x238323f922f220a1
.quad 0xa1e4a1d0a1bca1a8,0xa22fa21da20aa1f7,0xa0e6a129a16aa1a8,0x9f8ba011a05aa0a1,0x22b72264220a21a8,0x23a8237923412300,0x1f8b2072211321a8,0x16461a3e1ca51e1f
.quad 0xa359a2e4a253a1a8,0xa3f6a3ffa3e8a3b0,0x9d129f58a0b8a1a8,0x1ca518798b2e995c,0x23c6234d229721a8,0x230e239f23f023fd,0x18eb1db5205a21a8,0xa1139f589c37932d
.quad 0xa3fba39fa2d5a1a8,0xa113a264a359a3e3,0xb2e9bfe9fefa1a8,0x230e21d020291c6e,0x23f623d9230e21a8,0x1ca52072222f2364,0x99cd18791f2521a8,0xa3f6a34da1e49fbd
.quad 0xa3b8a3f9a341a1a8,0x16469bfea08aa286,0x1d7f8f2e9e54a1a8,0x23a823f923292155,0x234123ff236f21a8,0x9f8b95611d122155,0x9fef95611d7f21a8,0xa22fa3bfa3dea286
.quad 0xa275a264a253a241,0xa2b7a2a7a297a286,0x9d129db59e549ef1,0x98eb9a3e9b8f9c6e,0x240023f923e823cd,0x23b823d923f023fd,0x9ca59a3e96468000,0xa113a0729f8b9e1f
.quad 0xa297a31ca383a3cd,0x9f25a072a13fa1f7,0x2253217f208a1ef1,0x23fe23d923832300,0x1d7f2011213f2241,0x9dea9a3e8b2e195c,0xa3fea3bfa329a241,0xa194a2a7a36fa3e3
.quad 0x1c370f2e9aaf9ef1,0x238322a7216a1fbd,0x22b7239f23fe23cd,0x947c1a3e1f252155,0xa22fa0729ca58000,0xa30ea3d9a3f6a364,0x9deaa129a2d5a3cd,0x225320721c37932d
.quad 0x23fb234d21bc1ef1,0x1b8f2072227523b0,0x9b8f18791fef2241,0xa3dea3d9a2b7a0a1,0xa2d5a3eca3b8a241,0x208a1a3e9aafa0a1,0x220a1e898b2e9ef1,0x202922a723e823b0
.quad 0xa2f2a2e4a2d5a2c6,0xa329a31ca30ea300,0xb2e8f2e947c972a,0x19cd18791646132d,0x22d5231c2359238d,0x216a21d0222f2286,0xa30ea2a7a22fa1a8,0xa3f6a3d9a3a8a364
.quad 0x116295619aaf9d49,0x20291e891ca5195c,0x22b7234d23b823f3,0x1dea2011211321f7,0xa329a264a16aa042,0xa3b8a3f9a3f6a3b0,0x147c98799d7fa042,0x225321291f8b1c6e
.quad 0x2297237923f023f3,0xb2e1bfe1f8b2155,0xa341a21da08a9d49,0xa275a379a3f6a3e3,0x16469a3e9f8ba1a8,0x23a822a721131e1f,0x2275239f2400238d,0x9d7f8f2e1ca520a1
.quad 0xa359a1d09f25972a,0xa05aa264a3a8a3fd,0x18079bfea0b8a2c6,0x23fb239f222f1fbd,0x225323bf23e822c6,0xa13f9cdc16461fbd,0xa36fa17f9d12172a,0x9aafa0cfa30ea3fd
.quad 0xa359a34da341a335,0xa383a379a36fa364,0x1d7f1cdc1c371b1f,0x1fef1f581ebd1e1f,0x1f252011208a20fd,0x19cd1bfe1d121e1f,0xa3a8a3d9a3f6a400,0xa22fa2a7a30ea364
.quad 0x22f2226421bc20fd,0x240023ec23b82364,0x9b8f9561147c1b1f,0xa20aa129a0299e1f,0xa05aa17fa275a335,0x18eb8f2e9aaf9e1f,0x23de23ff23c62335,0x2029217f22972364
.quad 0xa275a1299f259b1f,0xa396a3f9a3e8a364,0x180798799e54a0fd,0x236f226420e61e1f,0x211322a723a82400,0x9f8b9a3e16461e1f,0xa3fba3bfa2b7a0fd,0x9aafa011a20aa364
.quad 0x21e41f5818079b1f,0x2253239f23fe2364,0x8b2e1db5216a2335,0xa3fea34da1949e1f,0xa1bca379a3fea335,0x21e41e890b2e9e1f,0x23fe231c20e61b1f,0x98071cdc216a2364
.quad 0xa3a8a39fa396a38d,0xa3c6a3bfa3b8a3b0,0x211320cf208a2042,0x220a21d021942155,0x96468f2e1162172a,0x9dea9cdc9b8f995c,0x9f8ba072a113a1a8,0x96469a3e9ca59e1f
.quad 0x230e237923c623f3,0x205a212921e42286,0xa3f6a3bfa359a2c6,0xa2f2a379a3d3a3fd,0x222f21291fef1d49,0x23fe23ec23962300,0x9ca5956118071d49,0xa341a264a13f9fbd
.quad 0x9ca5a011a194a2c6,0x20e61e8919cd932d,0x222f234d23e823f3,0x99cd15611d7f20a1,0xa3f6a3d9a30ea1a8,0x9ca5a072a22fa364,0x230e217f1ebd172a,0x2194231c23e823e3
.quad 0x9f8b98791aaf2042,0xa396a3ffa36fa1f7,0x96469f58a20aa38d,0x23e822e420e61c6e,0x2113231c23fb238d,0xa275a01198071c6e,0xa3a8a3eca2b7a042,0x1f250f2e9e54a1f7
.quad 0xa3dea3d9a3d3a3cd,0xa3f0a3eca3e8a3e3,0x22d522a722752241,0x236f234d23292300,0xa0e6a0729fef9ef1,0xa275a21da1bca155,0x1ca51a3e16468000,0x211320721f8b1e1f
.quad 0x147c1a3e1d121ef1,0x9ebd9cdc99cd932d,0x9ebda072a16aa241,0x19cd0f2e98079c6e,0x21bc22a7235923cd,0x147c1bfe1ebd20a1,0xa359a3d9a400a3cd,0x9d12a011a16aa286
.quad 0x23fe23d923412241,0x205a21d022f223b0,0xa396a2a7a13f9ef1,0xa1e4a31ca3d3a3fd,0x222f20721ca58000,0x230e23d923f62364,0x9fef9a3e18071ef1,0xa3c6a3f9a359a1f7
.quad 0x18eb9a3ea029a241,0x24002379220a1fbd,0x1aaf2072229723cd,0xa3b8a264a029995c,0xa05aa2a7a3dea3cd,0x22f220cf1b8f995c,0x227523d923c62241,0xa1bc9db5147c1fbd
.quad 0xa3fba3f9a3f6a3f3,0xa400a3ffa3fea3fd,0x23d323bf23a8238d,0x23fe23f923f023e3,0xa383a34da30ea2c6,0xa3fba3eca3d3a3b0,0x230e22a7222f21a8,0x23f623d923a82364
.quad 0xa275a1d0a113a042,0xa3f0a3bfa36fa300,0x21bc20cf1f8b1d49,0x23e8239f23292286,0xa0e69f589ca5972a,0xa3dea379a2d5a1f7,0x1fef1cdc1646972a,0x23d3234d22752155
.quad 0x9dea987916461d49,0xa3c6a31ca20aa0a1,0x1b8f8f2e9ca5a042,0x23b822e421941fbd,0x96461a3e1f8b21a8,0xa3a8a2a7a1139e1f,0x91629db5a113a2c6,0x23962264208a1c6e
.quad 0x19cd2011222f238d,0xa383a21d9fef995c,0x9d12a129a30ea3f3,0x236f21d01ebd132d,0x1f25221d23a823f3,0xa359a17f9d7f132d,0xa08aa2e4a3f6a38d,0x234121291c37995c
.quad 0xa3fea3ffa400a400,0xa3f6a3f9a3fba3fd,0x23f023f923fe2400,0x23a823bf23d323e3,0xa3d3a3eca3fba400,0xa30ea34da383a3b0,0x23a823d923f62400,0x222f22a7230e2364
.quad 0xa36fa3bfa3f0a400,0xa113a1d0a275a300,0x2329239f23e82400,0x1f8b20cf21bc2286,0xa2d5a379a3dea400,0x9ca59f58a0e6a1f7,0x2275234d23d32400,0x16461cdc1fef2155
.quad 0xa20aa31ca3c6a400,0x164698799deaa0a1,0x219422e423b82400,0x9ca58f2e1b8f1fbd,0xa113a2a7a3a8a400,0x1f8b1a3e96469e1f,0x208a226423962400,0xa1139db591621c6e
.quad 0x9fefa21da383a400,0x222f201119cd995c,0x1ebd21d0236f2400,0xa30ea1299d12132d,0x9d7fa17fa359a400,0x23a8221d1f25132d,0x1c37212923412400,0xa3f6a2e4a08a995c
.quad 0xa3e8a3eca3f0a3f3,0xa3d3a3d9a3dea3e3,0x2329234d236f238d,0x227522a722d52300,0xa1bca21da275a2c6,0x9fefa072a0e6a155,0x1f8b2072211321a8,0x16461a3e1ca51e1f
.quad 0x99cd9cdc9ebda042,0x1d121a3e147c932d,0x98070f2e19cd1d49,0xa16aa0729ebd9c6e,0x1ebd1bfe147c972a,0x235922a721bc20a1,0xa16aa0119d12972a,0xa400a3d9a359a286
.quad 0x22f221d0205a1d49,0x234123d923fe23b0,0xa3d3a31ca1e4a042,0xa13fa2a7a396a3fd,0x23f623d9230e21a8,0x1ca52072222f2364,0xa359a3f9a3c6a2c6,0x18079a3e9fefa1f7
.quad 0x220a23792400238d,0xa0299a3e18eb1fbd,0xa029a264a3b8a3f3,0x229720721aaf995c,0x1b8f20cf22f223f3,0xa3dea2a7a05a995c,0x147c9db5a1bca38d,0x23c623d922751fbd
.quad 0xa3b8a3bfa3c6a3cd,0xa396a39fa3a8a3b0,0x219421d0220a2241,0x208a20cf21132155,0x9b8f9cdc9dea9ef1,0x11628f2e9646995c,0x9ca59a3e96468000,0xa113a0729f8b9e1f
.quad 0x21e42129205a1ef1,0x23c62379230e2286,0xa3d3a379a2f2a241,0xa359a3bfa3f6a3fd,0x239623ec23fe23cd,0x1fef2129222f2300,0xa13fa264a341a3cd,0x180795619ca59fbd
.quad 0x19cd1e8920e62241,0xa194a0119ca5932d,0x1d7f156199cd9ef1,0x23e8234d222f20a1,0xa22fa0729ca58000,0xa30ea3d9a3f6a364,0x23e8231c21941ef1,0x1ebd217f230e23e3
.quad 0xa36fa3ffa396a241,0x1aaf98799f8ba1f7,0x20e622e423e823cd,0xa20a9f5896461c6e,0x9807a011a275a3cd,0x23fb231c21131c6e,0x9e540f2e1f252241,0xa2b7a3eca3a8a1f7
.quad 0xa36fa379a383a38d,0xa341a34da359a364,0x1ebd1f581fef2042,0x1c371cdc1d7f1e1f,0x1d121bfe19cd172a,0x208a20111f251e1f,0xa30ea2a7a22fa1a8,0xa3f6a3d9a3a8a364
.quad 0x23b823ec240023f3,0x21bc226422f22364,0xa029a129a20aa2c6,0x147c95619b8f9e1f,0x9aaf8f2e18eb1d49,0xa275a17fa05a9e1f,0x2297217f20291d49,0x23c623ff23de2364
.quad 0xa3e8a3f9a396a2c6,0x9f25a129a275a364,0x20e62264236f23f3,0x9e54987918071e1f,0x16469a3e9f8ba1a8,0x23a822a721131e1f,0xa20aa0119aaf172a,0xa2b7a3bfa3fba364
.quad 0x23fe239f22532042,0x18071f5821e42364,0xa194a34da3fea38d,0x216a1db58b2e9e1f,0xb2e1e8921e4238d,0xa3fea379a1bc9e1f,0x216a1cdc9807a042,0x20e6231c23fe2364
.quad 0xa30ea31ca329a335,0xa2d5a2e4a2f2a300,0x1646187919cd1b1f,0x947c8f2e0b2e132d,0x222f21d0216a20fd,0x2359231c22d52286,0xa3a8a3d9a3f6a400,0xa22fa2a7a30ea364
.quad 0x1ca51e89202920fd,0x9aaf95611162195c,0x211320111dea1b1f,0x23b8234d22b721f7,0xa3f6a3f9a3b8a335,0xa16aa264a329a3b0,0x1f8b212922532335,0x9d7f9879147c1c6e
.quad 0x1f8b1bfe0b2e9b1f,0x23f0237922972155,0xa3f6a379a275a0fd,0xa08aa21da341a3e3,0x211322a723a82400,0x9f8b9a3e16461e1f,0x1ca58f2e9d7fa0fd,0x2400239f227520a1
.quad 0xa3a8a264a05a9b1f,0x9f25a1d0a359a3fd,0x222f239f23fb2335,0xa0b89bfe18071fbd,0x16469cdca13fa335,0x23e823bf22531fbd,0xa30ea0cf9aaf1b1f,0x9d12a17fa36fa3fd
.quad 0xa297a2a7a2b7a2c6,0xa253a264a275a286,0x9b8f9a3e98eb972a,0x9e549db59d129c6e,0x23f023d923b8238d,0x23e823f9240023fd,0x9f8ba072a113a1a8,0x96469a3e9ca59e1f
.quad 0xa13fa0729f259d49,0xa383a31ca297a1f7,0x238323d923fe23f3,0x208a217f22532300,0x8b2e9a3e9deaa042,0x213f20111d7f195c,0xa36fa2a7a194a042,0xa329a3bfa3fea3e3
.quad 0x216a22a7238323f3,0x9aaf0f2e1c371fbd,0x1f251a3e947c9d49,0x23fe239f22b72155,0xa3f6a3d9a30ea1a8,0x9ca5a072a22fa364,0x1c3720722253238d,0xa2d5a1299dea932d
.quad 0x227520721b8f972a,0x21bc234d23fb23b0,0xa2b7a3d9a3dea2c6,0x1fef18799b8fa0a1,0x9aaf1a3e208a22c6,0xa3b8a3eca2d5a0a1,0x23e822a72029172a,0x8b2e1e89220a23b0
.quad 0xa20aa21da22fa241,0xa1bca1d0a1e4a1f7,0xa05aa0119f8b9ef1,0xa16aa129a0e6a0a1,0x2341237923a823cd,0x220a226422b72300,0x1ca51a3e16468000,0x211320721f8b1e1f
.quad 0xa3e8a3ffa3f6a3cd,0xa253a2e4a359a3b0,0x8b2e18791ca51ef1,0xa0b89f589d12995c,0x23f0239f230e2241,0x2297234d23c623fd,0x9c379f58a113a241,0x205a1db518eb932d
.quad 0xa359a264a1139ef1,0xa2d5a39fa3fba3e3,0x202921d0230e23cd,0x9fef9bfe0b2e1c6e,0x222f20721ca58000,0x230e23d923f62364,0xa1e4a34da3f6a3cd,0x1f25187999cd9fbd
.quad 0xa08a9bfe16461ef1,0xa341a3f9a3b8a286,0x232923f923a82241,0x9e548f2e1d7f2155,0x1d1295619f8ba241,0x236f23ff23412155,0xa3dea3bfa22f9ef1,0x1d7f95619fefa286
.quad 0xa16aa17fa194a1a8,0xa113a129a13fa155,0xa253a21da1e4a1a8,0xa30ea2e4a2b7a286,0x205a20cf213f21a8,0x1ca51db51ebd1fbd,0x230e22a7222f21a8,0x23f623d923a82364
.quad 0x9e54a011a0e6a1a8,0x16468f2e98eb9c6e,0xa396a31ca275a1a8,0xa3a8a3eca400a3e3,0x1b8f1e89208a21a8,0x9f8b9cdc9807132d,0x23e8237922b721a8,0x222f231c23b823fd
.quad 0x947c9cdca029a1a8,0x222f20cf1e54195c,0xa400a3bfa2f2a1a8,0x9f8ba17fa2d5a3b0,0x96461a3e1f8b21a8,0xa3a8a2a7a1139e1f,0x23de23ec232921a8,0x16461e89216a2300
.quad 0x1c3795619ebda1a8,0x23f623bf229720a1,0xa383a3ffa359a1a8,0x1ca595619f25a1f7,0x9ebd8f2e1dea21a8,0xa30ea3f9a396a1f7,0x22f223f9238321a8,0xa1139bfe19cd20a1
.quad 0xa0b8a0cfa0e6a0fd,0xa05aa072a08aa0a1,0xa396a379a359a335,0xa3e8a3d9a3c6a3b0,0xb2e156118eb1b1f,0x9c379a3e9807932d,0x23a823d923f62400,0x222f22a7230e2364
.quad 0x208a1f581d7f1b1f,0x232922a7220a2155,0xa0e6a1d0a297a335,0x91629a3e9d7f9fbd,0xa383a2e4a20aa0fd,0xa36fa3d9a400a3e3,0x11621bfe1f2520fd,0xa1bca0729dea995c
.quad 0x23b823ff23d32335,0x1d7f207221e42300,0x205a1cdc11629b1f,0x23fb23d9232921f7,0xa113a2a7a3a8a400,0x1f8b1a3e96469e1f,0xa36fa21da0299b1f,0xa0e6a2a7a3b8a3fd
.quad 0x147c1e8921942335,0xa3c6a2a7a0b89c6e,0x23c623ec22f220fd,0x99cd1a3e205a2286,0x202918799c37a0fd,0x229723d923d32286,0xa13fa34da400a335,0x22d5207218eb9c6e
.quad 0x9fefa011a029a042,0x9f259f589f8b9fbd,0xa400a3ffa3fba3f3,0xa3dea3eca3f6a3fd,0xa0299f589e549d49,0xa1e4a17fa113a0a1,0x1f8b2072211321a8,0x16461a3e1ca51e1f
.quad 0x23fe23f923d3238d,0x22d5234d23a823e3,0x205a1e891c37172a,0x236f22e4222f2155,0x9f25a0cfa1e4a2c6,0x1c37156196469c6e,0xa3fba3eca383a2c6,0xa0e6a21da30ea3b0
.quad 0xa08a9db59807172a,0xa400a3bfa30ea1f7,0x1ebd21292297238d,0xa0b89db59646195c,0x23f623d9230e21a8,0x1ca52072222f2364,0x20b81cdc8b2e9d49,0x238323ff23a82286
.quad 0x9e54a17fa329a3f3,0x22b720cf1ca5932d,0xa3f0a3bfa275a042,0x147c9cdca113a300,0xa0e69bfe18eb2042,0xa20aa39fa3f6a300,0x1dea21d0239623f3,0xa3d3a2649f8b932d
.quad 0x9e549e899ebd9ef1,0x9d7f9db59dea9e1f,0xa383a39fa3b8a3cd,0xa2f2a31ca341a364,0xa329a2e4a297a241,0xa3dea3bfa396a364,0x9ca59a3e96468000,0xa113a0729f8b9e1f
.quad 0x1fef20cf21942241,0xb2e18791c371e1f,0x23c623f923fb23cd,0x213f221d22d52364,0x22b721d020b81ef1,0x23e823ff23d32364,0x19cd8f2e9b8f9ef1,0x22d521d0208a1e1f
.quad 0xa0b8a21da329a3cd,0x1d12156198eb9e1f,0xa3f0a3eca359a241,0x9deaa0cfa253a364,0xa22fa0729ca58000,0xa30ea3d9a3f6a364,0x947c1bfe205a2241,0xa3d3a2e4a13f9e1f
.quad 0x216a231c23f023cd,0xa0e69cdc11621e1f,0x2400237921e41ef1,0x11621e8921bc2364,0x21941db591629ef1,0x216a234d24002364,0x91629f58a253a3cd,0x23f0239f21e41e1f
.quad 0x9ca59cdc9d129d49,0x9b8f9bfe9c379c6e,0xa22fa264a297a2c6,0xa13fa17fa1bca1f7,0xa3f6a3ffa3fea3f3,0xa36fa39fa3c6a3e3,0xa30ea2a7a22fa1a8,0xa3f6a3d9a3a8a364
.quad 0x9f8b9db59b8f972a,0xa2b7a21da16aa0a1,0x16461bfe1e542042,0x9fef9db59aaf932d,0x2113221d22f2238d,0x916218791d121fbd,0x23a823f923f0238d,0x1ebd20cf220a2300
.quad 0x23a822e421bc2042,0x2253234d23de23fd,0x21131e8918eb972a,0x23de23f923832286,0x16469a3e9f8ba1a8,0x23a822a721131e1f,0x9f8ba1d0a341a3f3,0x21bc1f5818eb995c
.quad 0xa30ea3eca3d3a2c6,0x1d128f2e9deaa155,0xa3f6a31ca13f9d49,0x98eba011a253a3b0,0xa22f9f58947c1d49,0xa0b8a2e4a3f0a3b0,0x9ca51879205a22c6,0xa329a3ffa359a155
.quad 0x99cd9a3e9aaf9b1f,0x9807987998eb995c,0xa029a072a0b8a0fd,0x9dea9e899f259fbd,0xa253a2a7a2f2a335,0xa0b8a129a194a1f7,0xa3a8a3d9a3f6a400,0xa22fa2a7a30ea364
.quad 0xa3fba3d9a396a335,0xa341a39fa3dea3fd,0xa341a2a7a1e4a0fd,0xa3dea3ffa3f0a3b0,0xa194a0729e549b1f,0xa3fba3bfa341a286,0x9e549a3e0b2e1b1f,0xa396a2e4a1e4a0a1
.quad 0x91621a3e1ebd20fd,0xa2b7a17f9fef9c6e,0x1d122072220a2335,0xa16a9f589aaf132d,0x211322a723a82400,0x9f8b9a3e16461e1f,0x22f223d923f02335,0x9b8f15611e542155
.quad 0x23e823d922d520fd,0xb2e1db5213f2300,0x23d322a7208a1b1f,0x1c3720cf22d523e3,0x22b7207219cd9b1f,0x1fef226423c623e3,0x20b81a3e9b8fa0fd,0x2194237923fb2300
.quad 0x947c95619646972a,0x8b2e8f2e9162932d,0x9aaf9bfe9ca59d49,0x916295619807995c,0x9d7f9e899f8ba042,0x947c98799aaf9c6e,0x9f8ba072a113a1a8,0x96469a3e9ca59e1f
.quad 0xa0b8a17fa22fa2c6,0x98079bfe9dea9fbd,0xa194a264a30ea38d,0x98eb9cdc9f25a0a1,0xa253a31ca3a8a3f3,0x99cd9db5a029a155,0xa2f2a39fa3f6a3f3,0x9aaf9e89a0b8a1f7
.quad 0xa36fa3eca3f6a38d,0x9b8f9f58a13fa286,0xa3c6a3ffa3a8a2c6,0x9c37a011a1bca300,0xa3f6a3d9a30ea1a8,0x9ca5a072a22fa364,0xa3fea379a22fa042,0x9d12a0cfa297a3b0
.quad 0xa3dea2e4a1139d49,0x9d7fa129a2f2a3e3,0xa396a21d9f8b972a,0x9deaa17fa341a3fd,0xa329a1299ca5172a,0x9e54a1d0a383a3fd,0xa297a01196461d49,0x9ebda21da3b8a3e3
.quad 0x19cd20cf23292400,0xa3f6a379a16a9c6e,0x16462072230e2400,0xa3a8a3d9a22f9e1f,0xb2e201122f22400,0xa30ea3ffa2d59fbd,0x947c1f5822d52400,0xa22fa3eca359a0a1
.quad 0x98eb1e8922b72400,0xa113a39fa3b8a155,0x9b8f1db522972400,0x9f8ba31ca3f0a1f7,0x9d121cdc22752400,0x9ca5a264a400a286,0x9e541bfe22532400,0x9646a17fa3e8a300
.quad 0x9f8b1a3e222f2400,0x1646a072a3a8a364,0xa05a1879220a2400,0x1ca59e89a341a3b0,0xa0e6156121e42400,0x1f8b9bfea2b7a3e3,0xa16a0f2e21bc2400,0x21139561a20aa3fd
.quad 0xa1e48f2e21942400,0x222f1561a13fa3fd,0xa2539561216a2400,0x230e1bfea05aa3e3,0xa2b79879213f2400,0x23a81e899ebda3b0,0xa30e9a3e21132400,0x23f620729ca5a364
.quad 0x1dea9561a029a2c6,0x225323d923b821f7,0x21131a3e9ca5a1a8,0x1f8b22a723f62364,0x22b71f589162a042,0x147c2072232923fd,0x23b8217f1aaf9d49,0x9d7f1a3e216a23b0
.quad 0x23fe22e41f25972a,0xa1949a3e1dea2286,0x238323bf213f172a,0xa36fa0720b2e20a1,0x225323ff22971d49,0xa3fea2a79d7f1c6e,0x208a239f23832042,0xa329a3d9a13f932d
.quad 0x1ca522a723f621a8,0xa113a3d9a30e9e1f,0x8b2e212923e822c6,0x9c37a2a7a3f0a155,0x9d121e892359238d,0x18eba072a3c6a300,0xa0b81879225323f3,0x205a9a3ea297a3e3
.quad 0xa275987920e623f3,0x22b71a3ea08aa3e3,0xa3969e891e54238d,0x23e820729b8fa300,0xa400a12918eb22c6,0x23b822a71807a155,0xa3a8a2a7964621a8,0x222f23d91f8b9e1f
.quad 0xa2759f588b2e1ef1,0x9d7fa1d0a3a8a3e3,0xa3f6a2a79f8b0000,0x1ca59a3ea113a364,0xa341a3f9a2979ef1,0x22751e899646a0a1,0xa08aa34da3f0a241,0x240022e41f8b932d
.quad 0x947ca0cfa383a3cd,0x225323f9230e1fbd,0x1f259879a16aa3cd,0x1c37221d23f62300,0x22b71db59c37a241,0x9dea1bfe222f23fd,0x23fe221d1aaf9ef1,0xa2d59db51ca52286
.quad 0x230e23d921138000,0xa3f6a2a79ca51e1f,0x2029239f23591ef1,0xa1e4a3ffa22f995c,0xb2e217f23fb2241,0x99cda264a3f6a155,0x9fef1bfe22d523cd,0x1f259cdca30ea3b0
.quad 0xa2f29bfe202923cd,0x23291cdc9f8ba3b0,0xa400a17f147c2241,0x23de22641646a155,0xa2d5a39f9e541ef1,0x216a23ff2113995c,0x9f8ba3d9a22f0000,0x164622a723a81e1f
.quad 0x23fb22e4205a172a,0x9aaf1bfe213f2364,0x222f23d923a821a8,0xa30ea07296461e1f,0x180720cf235923f3,0xa36fa3eca2539e1f,0xa0b895611f2522c6,0x9d12a21da3e8a364
.quad 0xa3dea1d09b8f1d49,0x20298f2ea08aa364,0xa2b7a3ffa2759d49,0x23e821d01aaf9e1f,0x9b8fa21da3fba2c6,0x220a23f922d51e1f,0x1fef9879a1bca3f3,0x8b2e20cf23b82364
.quad 0x23a820729646a1a8,0xa22f9a3e1f8b2364,0x232923bf208a972a,0xa3dea2e49d121e1f,0x1d7f231c23b82042,0x9fefa39fa3419e1f,0x9e541db52341238d,0x1d7f9e89a36fa364
.quad 0xa3599db51ebd238d,0x23831e899deaa364,0xa383a31c9c372042,0x22f2239f1ebd9e1f,0x9f25a3bfa297972a,0x19cd22e423961e1f,0x1ca5a072a3f6a1a8,0xa1131a3e230e2364
.quad 0xa30ea3ffa341a0fd,0x21941cdc98eba0a1,0x9646a072a30ea400,0x23a823d9222f1e1f,0x222f1db598eba0fd,0x19cd2129238323e3,0x23a823bf21941b1f,0xa2539db519cd2155
.quad 0x1ca5221d23f02335,0xa341a3eca20a9c6e,0xa11395611fef2335,0x9162a0cfa396a3b0,0xa3f6a2e49e541b1f,0x22f21e899aafa1f7,0x9f8ba34da3c6a0fd,0x22b723f921e4195c
.quad 0x1f8b9a3ea22fa400,0x9646207223a82364,0x23f6217f1162a0fd,0xa36f9f581b8f2286,0x211323ec22971b1f,0xa20aa3ffa1bc932d,0x9ca51f5823962335,0x1b8fa011a3b8a300
.quad 0xa3a89f581d122335,0x23c620119c37a300,0xa22fa3eca08a1b1f,0x213f23ff2194932d,0x1646a17fa3fea0fd,0x9dea1f5823c62286,0x230e1a3ea113a400,0xa3f6a0721ca52364
.quad 0x1fef22a723f0238d,0xa3c6a21d9e54132d,0xa1139a3e1ca521a8,0x9f8ba2a7a3f6a364,0xa396a3d9a20a9d49,0x21e41cdc9aafa155,0x9162a072a341a3f3,0x22b723ff22f21fbd
.quad 0x235920720b2ea042,0x9d121bfe21e423e3,0x219423d923592042,0xa3fba2e49ebd195c,0x9ebd1a3e21e423f3,0x99cda1d0a3f0a300,0xa3fba2a79d121d49,0x23411f5899cda1f7
.quad 0x9ca5a2a7a3f6a1a8,0x211323d9230e1e1f,0x22531a3e9fefa38d,0xa0b8156121bc23fd,0x22d523d920b8972a,0xa36fa3799f251c6e,0x99cd207223d322c6,0x1807a0cfa3e8a286
.quad 0xa3dea0721aaf22c6,0x23f020cf98eba286,0xa029a3d9a275972a,0x1dea237923291c6e,0x20e69a3ea2f2a38d,0xa2759561219423fd,0x23a822a71646a1a8,0xa22fa3d99f8b1e1f
.quad 0x11629e89a22fa3cd,0x239623ec22971fbd,0x23f622a71f8b8000,0x9ca51a3e21132364,0x1b8f217f23a823cd,0xa3b8a3bfa1bc9c6e,0xa36fa0cf96461ef1,0x1b8f9cdca20aa3e3
.quad 0x9fefa31ca3f6a241,0x23d3237920b8132d,0x22531cdc9ca5a241,0x99cd1e8922d523fd,0x21bc23ec230e1ef1,0xa3e8a31c9f25195c,0xa0b80f2e211323cd,0x1807a011a36fa3b0
.quad 0xa30ea3d9a1130000,0x23f622a71ca59e1f,0x1d7f9db5a30ea3cd,0x947c20cf23d32300,0x23d322e41ca59ef1,0xa3fea21d980720a1,0x947c212923f62241,0xb2ea17fa3fea1f7
.quad 0xa3fba12916462241,0x2400217f9162a1f7,0x9aafa2e4a3a89ef1,0x1162221d23f020a1,0x23831db59f8ba3cd,0xa3fba0cf1aaf2300,0x1f8b23d9222f8000,0x9646a2a7a3a89e1f
.quad 0xa08a98791d1221a8,0xa113a34da3fea300,0xa22fa3d9a3a8a1a8,0x230e207216469e1f,0x21941bfe9c37a1a8,0x1ca521d023c623b0,0x213f239f23c621a8,0xa3f6a2649dea195c
.quad 0xa2759db51aaf21a8,0x16469f58a2f2a3fd,0xa029a34da3dea1a8,0x23a8239f20e6132d,0x23291f5898eba1a8,0x9f8b1879219423e3,0x1dea22e423f021a8,0xa22fa3ffa2759c6e
.quad 0xa3a8a072164621a8,0x222f1a3e9f8ba364,0x9aafa264a3fba1a8,0x1f8b237923831fbd,0x23f021299162a1a8,0xa3a8a0111aaf2286,0x116221d0240021a8,0x9646a21da3fba155
.quad 0xa3fea1d08b2e21a8,0x23f6221d147ca155,0x1807a129a3fea1a8,0x9ca5201123d32286,0x23d32264147ca1a8,0xa30ea3799d7f1fbd,0x9ca5207223f621a8,0x21139a3ea30ea364
.quad 0x235921291b8f9b1f,0x1807207222f223fd,0x16462072230e2400,0xa3a8a3d9a22f9e1f,0xa3d3a39fa16a9b1f,0x213f1a3e9d12a1f7,0x1fef8f2ea05aa335,0x1ebd22a723fe2300
.quad 0x216a23bf239620fd,0xa400a2a79e54195c,0xa341a011147c20fd,0x1e549a3ea1bca3e3,0x9807a17fa3dea335,0x216a23d923411fbd,0x23de231c1ebd9b1f,0xa396a072147c2155
.quad 0x9f8b1a3e222f2400,0x1646a072a3a8a364,0xa194a3f9a2759b1f,0x22f223d920e6932d,0x23291db59deaa335,0xa2759a3e202923b0,0x18eb226423f020fd,0x9aafa2a7a3dea0a1
.quad 0xa3e8a264980720fd,0x23d322a719cda0a1,0x1f259db5a36fa335,0xa0b81a3e22d523b0,0x21bc23f920b89b1f,0x9fefa3d9a253932d,0xa30e9a3e21132400,0x23f620729ca5a364
.quad 0xa3e8a39fa1bc9d49,0x1ebd8f2e9f8ba286,0x21131a3e9ca5a1a8,0x1f8b22a723f62364,0x1d7f221d23de238d,0xa3e8a379a113995c,0xa3dea379a0e6972a,0x21bc1bfe9ca5a1f7
.quad 0x213f18799ebda2c6,0x1807212923a823b0,0x1d12226423fe22c6,0xa2f2a3f9a22f9c6e,0xa3d3a34d9fef172a,0x235920119646a155,0x216a1561a05aa38d,0x9b8f1e89230e23e3
.quad 0x1ca522a723f621a8,0xa113a3d9a30e9e1f,0xa3c6a31c9dea1d49,0x23fe21d01646a0a1,0x21940f2ea13fa3f3,0xa08a1879222f23fd,0x1c3722e423c62042,0x9d12a31ca3a89fbd
.quad 0xa3b8a2e49b8f2042,0x2396231c1ca59fbd,0x21bc8f2ea20aa3f3,0xa2979879211323fd,0x1b8f231c236f1d49,0x1162a1d0a3f6a0a1,0xa3a8a2a7964621a8,0x222f23d91f8b9e1f
.quad 0x220a23bf23d32241,0xa2b7a011947c1e1f,0xa3f6a2a79f8b0000,0x1ca59a3ea113a364,0x20e618799deaa241,0x1e54226423f02364,0x18eb2129239623cd,0xa329a3f9a2759e1f
.quad 0xa297a3ffa2d59ef1,0x23c6217f19cd9e1f,0x23d3217f18eb9ef1,0xa0b88f2e205a2364,0xa0291561213f23cd,0x947ca129a3c6a364,0x9c37a264a400a241,0x219423ec22f21e1f
.quad 0x230e23d921138000,0xa3f6a2a79ca51e1f,0xa396a01119cd2241,0x22971bfe9f25a364,0x1ebd9cdca2f2a3cd,0x9c371f5823832364,0x1dea234d23831ef1,0x9ebda379a3599e1f
.quad 0xa36fa34d9d7f1ef1,0x234123791e549e1f,0x23411cdc9fefa3cd,0xa3b89f581d7f2364,0x9d12201123de2241,0x208a9bfea329a364,0x9f8ba3d9a22f0000,0x164622a723a81e1f
.quad 0x9ca5a17fa383a3f3,0x2400231c20b8195c,0x222f23d923a821a8,0xa30ea07296461e1f,0xa3f6a34da0b8972a,0x208a15619ebda286,0x230e20118b2ea042,0x98071e89229723fd
.quad 0x9f8b156120e6238d,0x9d7fa264a3fba300,0x9646a129a3b8a38d,0x21e423ec23291fbd,0x211323bf236f2042,0xa3b8a379a05a132d,0xa3a8a379a029172a,0x23d321291162a0a1
.quad 0x23a820729646a1a8,0xa22f9a3e1f8b2364,0xa1130f2e216a23f3,0x1e549cdca2d5a3e3,0x1646a0cfa3dea2c6,0x147c21d0240021f7,0x1f8b239f23291d49,0xa029a3bfa2f29c6e
.quad 0xa30ea39f9f251d49,0x22d523bf1fef9c6e,0x23f620cf99cda2c6,0xa3fba1d00b2e21f7,0xa22f8f2e21e423f3,0x23591cdca029a3e3,0x1ca5a072a3f6a1a8,0xa1131a3e230e2364
.quad 0x9c371a3e20e62335,0xa2d5a3f9a36fa155,0x9646a072a30ea400,0x23a823d9222f1e1f,0x1f2522a723fb2335,0xa3fea31ca05a932d,0xa1e4a3d9a383a0fd,0x23d321d01c379c6e
.quad 0x236f23d921bc1b1f,0xa329a011116220a1,0xa400a2a79dea1b1f,0x220a1bfe9d7fa286,0x238320729162a0fd,0xa08a0f2e20e623b0,0xa20a9a3e1f252335,0x1d7f9cdca297a3fd
.quad 0x1f8b9a3ea22fa400,0x9646207223a82364,0x9807207223b82335,0x98eba21da400a1f7,0x9b8fa2a7a3e8a0fd,0x1e54234d23961fbd,0x208a23d922b71b1f,0xa0e6a3eca275995c
.quad 0xa297a3d9a05a1b1f,0x225323ec20b8995c,0x23c622a718eba0fd,0xa359a34d9d121fbd,0xa3f0a0721c372335,0x23e8221d0b2ea1f7,0x230e1a3ea113a400,0xa3f6a0721ca52364
.quad 0x21e41db59646a042,0x1f25226423de23b0,0xa1139a3e1ca521a8,0x9f8ba2a7a3f6a364,0x20290f2e9f8ba2c6,0x1fef22e424002300,0x9e5418792113238d,0xa029a31ca3fba286
.quad 0x1c379cdca22fa3f3,0x205a234d23e821f7,0x98071f58230e23f3,0xa08aa379a3c6a155,0x8b2ea0cfa3a8a38d,0x20b8239f239620a1,0x18eb21d023f622c6,0xa0e6a3bfa3599fbd
.quad 0x9ca5a2a7a3f6a1a8,0x211323d9230e1e1f,0x1ebd234d23a82042,0xa13fa3eca2b79c6e,0xa05aa3bfa30e9d49,0x216a23f92253195c,0x213f23f9222f172a,0xa194a3ffa1e4932d
.quad 0xa20aa3f9a113172a,0x21bc23ff216a932d,0x22b723bf1f8b9d49,0xa1e4a3f9a0e6195c,0xa341a34d9ca52042,0x220a23ec205a9c6e,0x23a822a71646a1a8,0xa22fa3d99f8b1e1f
.quad 0xa3dea2649f250000,0x16469db5a1e4a3b0,0x23f622a71f8b8000,0x9ca51a3e21132364,0xa400a2e49fef0000,0x1f8b8f2ea029a300,0x23fb231c20298000,0xa11398791e542286
.quad 0xa3e8a34da05a0000,0x222f1cdc9c37a1f7,0x23c62379208a8000,0xa30e9f5818072155,0xa396a39fa0b80000,0x23a820cf0b2ea0a1,0x235923bf20e68000,0xa3f6a1d098eb1fbd
.quad 0xa30ea3d9a1130000,0x23f622a71ca59e1f,0x22b723ec213f8000,0xa3a8a34d9ebd1c6e,0xa253a3f9a16a0000,0x230e23bf205a995c,0x21e423ff21948000,0xa22fa3f9a13f132d
.quad 0xa16aa3ffa1bc0000,0x211323f9220a132d,0x20e623f921e48000,0x9f8ba3bfa2b7995c,0xa05aa3eca20a0000,0x1ca5234d23411c6e,0x1f8b23d9222f8000,0x9646a2a7a3a89e1f
.quad 0x236f23f922d52042,0xa0e69a3e1c372155,0xa22fa3d9a3a8a1a8,0x230e207216469e1f,0x205a231c23fe22c6,0xa3fba2a79f25132d,0x9c37a1d0a3d3a38d,0x238323d921e41c6e
.quad 0x91622011232923f3,0xa1bca3d9a36fa0a1,0x1d7f9bfea20aa3f3,0x1dea22a724002286,0xa0e68f2e208a238d,0x1162a072a383a3b0,0x22971cdc9d7fa2c6,0x9f251a3e220a23fd
.quad 0xa3a8a072164621a8,0x222f1a3e9f8ba364,0x2400221d18eba042,0xa3b8a072180721f7,0xa396a34d9e541d49,0x23e822a71b8f9fbd,0x227523ec20e6972a,0xa2b7a3d9a08a195c
.quad 0xa0b8a3eca253972a,0x205a23d92297195c,0x1d12234d23591d49,0x98eba2a7a3c69fbd,0x8b2ea21da3e8a042,0x9c37207223f021f7,0x9ca5207223f621a8,0x21139a3ea30ea364
.quad 0xa0b8a31ca400a335,0x2383217f1ca5995c,0x16462072230e2400,0xa3a8a3d9a22f9e1f,0x1ebd9561a08aa335,0x20b8234d23f62286,0xa2979e89180720fd,0xb2ea011a30ea3fd
.quad 0x23fb22641d7f9b1f,0xa0e695611f8b2300,0xa329a3eca1e49b1f,0x23b8212916469fbd,0x205a237923b820fd,0xa36fa3bfa113932d,0x9162a129a3d3a335,0x2029237923a820a1
.quad 0x9f8b1a3e222f2400,0x1646a072a3a8a364,0x22d51cdc9e54a335,0xa16a8f2e211323e3,0xa400a1d0947c20fd,0x23de20cf9646a1f7,0x22f223bf20299b1f,0xa329a39f9f8b1c6e
.quad 0x9fefa3bfa2d59b1f,0x1f25239f230e1c6e,0x8b2e21d023fb20fd,0x19cda0cfa3f6a1f7,0x20299cdca359a335,0xa1e40f2e222f23e3,0xa30e9a3e21132400,0x23f620729ca5a364
.quad 0x147c201122b723f3,0xa3d3a3bfa20a9e1f,0x21131a3e9ca5a1a8,0x1f8b22a723f62364,0xa3f0a2649e54172a,0x1dea9879a0e6a364,0x227523f923292042,0xa396a12998eb1e1f
.quad 0x99cda17fa3c6a38d,0x22d523ff22971e1f,0xa05a0f2e20b8238d,0x98eba17fa3d3a364,0x23c62129147ca042,0xa13f956120292364,0xa2f2a3eca194972a,0x240022641c379e1f
.quad 0x1ca522a723f621a8,0xa113a3d9a30e9e1f,0x1f259bfea297a3f3,0x99cd201123962364,0xa3839f581c3722c6,0x22f21cdc9ebda364,0x235923791ebd9d49,0xa383a34d9dea1e1f
.quad 0x9e54a379a3419d49,0x1d7f234d236f1e1f,0x9d7f1f5823b822c6,0x1fef9cdca341a364,0x23291bfea08aa3f3,0xa3dea0111d122364,0xa3a8a2a7964621a8,0x222f23d91f8b9e1f
.quad 0x1f8b0f2e9ebda241,0x21bc239f23e82286,0xa3f6a2a79f8b0000,0x1ca59a3ea113a364,0x2113237923e82241,0xa3dea21d9d7f195c,0x1ca59bfea1bca3cd,0x20e6237923de21f7
.quad 0xa3a8a12998071ef1,0x1ebd9879a13fa3b0,0x222f23f922f21ef1,0xa3fea2649d121c6e,0x1646a011a359a3cd,0x1fef234d23d32155,0xa30e9e891b8f2241,0x205a9561a16aa3e3
.quad 0x230e23d921138000,0xa3f6a2a79ca51e1f,0x9646a1d0a3fea241,0x1dea231c23c620a1,0xa22f9879208a23cd,0x213f8f2ea194a3fd,0x23a8231c1d129ef1,0xa3c6a2e49c371fbd
.quad 0x9ca5a31ca3969ef1,0x1b8f22e423b81fbd,0xa1131879229723cd,0x220a0f2ea1bca3fd,0x23f621d09162a241,0xa36fa31c9b8f20a1,0x9f8ba3d9a22f0000,0x164622a723a81e1f
.quad 0xa2f2a07298071d49,0x9b8fa129a359a3fd,0x222f23d923a821a8,0xa30ea07296461e1f,0x1d129a3ea13fa38d,0x216a239f23d321f7,0xa3fea2a79ebd172a,0x205a0f2e9fefa300
.quad 0x1e5422a7240022c6,0xa396a3bfa16a995c,0x21bc1a3e9e54a2c6,0x947c2011234123e3,0xa341a3d9a16a972a,0x23de217f18079fbd,0x947c20722396238d,0x9ebda31ca3dea155
.quad 0x23a820729646a1a8,0xa22f9a3e1f8b2364,0xa0e6a3d9a2f29d49,0x227523f92194132d,0xa0291a3e227523f3,0x1dea9db5a329a3b0,0x23de22a71aafa042,0xa3f0a26498eb20a1
.quad 0x99cda2a7a3d3a042,0x1807226423e820a1,0xa2d59a3e20b823f3,0x236f1db59f25a3b0,0x225323d91fef9d49,0xa0b8a3f9a1bc132d,0x1ca5a072a3f6a1a8,0xa1131a3e230e2364
.quad 0x23fe234d21131b1f,0x9d121879208a2300,0x9646a072a30ea400,0x23a823d9222f1e1f,0xa3c6a1d09ca51b1f,0x1c379bfea194a3b0,0x1dea226423f62335,0xa3c6a39fa13f995c
.quad 0x22f21f589646a0fd,0x9aaf1db5227523fd,0xa0e6a39fa3a8a0fd,0x23de234d2029932d,0xa19498791f8b2335,0x18eb9f58a329a3e3,0x227523ff222f1b1f,0xa3f0a2e49dea1c6e
.quad 0x1f8b9a3ea22fa400,0x9646207223a82364,0xa383a3799f8b1b1f,0x23fb22641aaf9fbd,0x9aaf201123a82335,0x1162a129a3f0a286,0x23fb221d1646a0fd,0xa400a1d091622155
.quad 0x947ca21da3f6a0fd,0xb2e21d023fe2155,0xa3d3a0111ca52335,0x23fe21299807a286,0x1d7f2379230e1b1f,0x947ca264a3d39fbd,0x230e1a3ea113a400,0xa3f6a0721ca52364
.quad 0xa297a3eca396a1a8,0x222f1e8991629fbd,0xa1139a3e1ca521a8,0x9f8ba2a7a3f6a364,0x21bc23bf23b821a8,0xa3a8a17f9b8f1c6e,0x220a1cdc9b8fa1a8,0x164620cf236f23e3
.quad 0xa0b8a379a3d3a1a8,0x23f6231c1fef932d,0xa2d59e8919cd21a8,0x1ca59cdca253a3fd,0x1f25231c23e821a8,0xa30ea3eca1bc995c,0x236f20119807a1a8,0xa1138f2e20b823b0
.quad 0x9ca5a2a7a3f6a1a8,0x211323d9230e1e1f,0xa3d3a0cf147c21a8,0x230e1db59d7fa300,0x1807221d23fe21a8,0x9ca5a2e4a3d3a0a1,0x23fe217f8b2ea1a8,0xa3f6a129147c21f7
.quad 0x1162a17fa400a1a8,0x9646212923fb21f7,0xa3f0a21d916221a8,0x23a822e41aafa0a1,0x9aaf20cf23fb21a8,0x1f8b9db5a383a300,0x23a822a71646a1a8,0xa22fa3d99f8b1e1f
.quad 0x1e54221d23c623cd,0xa3f0a2a79fef932d,0x23f622a71f8b8000,0x9ca51a3e21132364,0x1aaf9cdca1e4a3cd,0x220a23d923962155,0xa2f2a3ffa2b79ef1,0x2341207211629fbd
.quad 0xa1e49bfe1d122241,0x8b2ea072a359a3e3,0x1ebd22e423fb2241,0xa359a3d9a194995c,0x23f021d019cd9ef1,0xa1e49a3e1ebd2300,0x19cd9f58a341a3cd,0x1d1222a723fb21f7
.quad 0xa30ea3d9a1130000,0x23f622a71ca59e1f,0xa1bc956120b823cd,0x1fef9a3ea253a3fd,0x1f252379236f1ef1,0xa0b8a3d9a2d59c6e,0x23e820cf9807a241,0xa3d3a07219cd2286
.quad 0x18eba0cfa3f0a241,0x9aaf207223de2286,0xa329a3799dea1ef1,0x227523d920299c6e,0xa1941561227523cd,0x22f21a3ea0e6a3fd,0x1f8b23d9222f8000,0x9646a2a7a3a89e1f
.quad 0x18eb9cdca194a38d,0x234123ff230e20a1,0xa22fa3d9a3a8a1a8,0x230e207216469e1f,0xa383a12999cd1d49,0x18eb9db5a22fa3e3,0x99cd1db5225323f3,0xa194a3bfa3a8a155
.quad 0x220a23ec23412042,0xa3f0a21d9ca51c6e,0x239620cf1162a042,0x9fef1561211323b0,0x1aaf9e89a2f2a3f3,0x1e5422e423f621f7,0xa1e4a3f9a2b79d49,0x23c6234d1f8b995c
.quad 0xa3a8a072164621a8,0x222f1a3e9f8ba364,0x9b8f1f58236f238d,0x9162a17fa3f6a286,0x21bc23ff220a172a,0xa297a3eca113132d,0x23b820119b8fa2c6,0xa3969f581ca52300
.quad 0x1c37a011a3c6a2c6,0x9d121f5823a82300,0xa194a3ffa13f172a,0x208a23ec222f132d,0xa3c69f581dea238d,0x23fe217f9646a286,0x9ca5207223f621a8,0x21139a3ea30ea364
.quad 0xa13f9bfe1aaf20fd,0xa05aa2e4a3fba364,0x16462072230e2400,0xa3a8a3d9a22f9e1f,0x225323ec236f20fd,0xa359a0cf98071e1f,0x23e8221d1d129b1f,0x9f25156120b82364
.quad 0x208a0f2ea029a335,0x1b8f21d023de2364,0x9aafa1d0a3e8a335,0x227523ff22b71e1f,0xa2d5a3f9a20a9b1f,0x23fb221d1b8f9e1f,0xa3b8a0cf0b2e20fd,0x21bc18799fefa364
.quad 0x9f8b1a3e222f2400,0x1646a072a3a8a364,0x1d1222e423de20fd,0xa08aa3bfa3299e1f,0x2341239f1fef9b1f,0xa3b8a31c9d7f1e1f,0x236f1e899d7fa335,0xa3419db51e542364
.quad 0x1dea9e89a383a335,0x9ebd1db523592364,0x9ebda39fa2f29b1f,0x1c37231c23831e1f,0xa396a2e499cd20fd,0x229723bf1f259e1f,0xa30e9a3e21132400,0x23f620729ca5a364
.quad 0x23a821d01d7f972a,0xb2e1f58227523e3,0x21131a3e9ca5a1a8,0x1f8b22a723f62364,0x16469e89a275a3f3,0x229723f9234120a1,0x9f8ba2e4a400a2c6,0x23f0234d208a132d
.quad 0xa30ea3f9a2539d49,0x238320cf147c9fbd,0xa3f6a21d9c371d49,0x216a18799f25a300,0xa22f9bfe1dea22c6,0x1c379db5a2b7a3fd,0x9ca51db522d523f3,0x9aafa21da3fea286
.quad 0x1ca522a723f621a8,0xa113a3d9a30e9e1f,0x222f23ff21e4172a,0xa359a39fa029195c,0x23f6226419cda042,0xa3fba17f8b2e2155,0x230e1cdc9f25a38d,0xa2d59bfe1fef23b0
.quad 0x1f8b9cdca329a38d,0xa0291bfe22f223b0,0x9646a264a3dea042,0x947c217f24002155,0xa113a3ffa16a172a,0x1e54239f22d5195c,0xa3a8a2a7964621a8,0x222f23d91f8b9e1f
.quad 0xa3b8a3d9a2539ef1,0x202915619deaa1f7,0xa3f6a2a79f8b0000,0x1ca59a3ea113a364,0xa329a072947c1ef1,0x11629f58a2b7a3fd,0xa16a9a3e1d7f2241,0x9aafa17fa3b8a3b0
.quad 0x9dea1a3e219423cd,0x9f25a2e4a3fea286,0x8b2e2072236f23cd,0xa13fa3bfa383a0a1,0x1d7f22a723fe2241,0xa297a3ffa2539c6e,0x213f23d923291ef1,0xa383a39fa08a132d
.quad 0x230e23d921138000,0xa3f6a2a79ca51e1f,0x23f022a71c379ef1,0xa3e8a1290b2e2155,0x23c6207298eba241,0xa3599e891d122300,0x22971a3ea05aa3cd,0xa253987920b823e3
.quad 0x208a9a3ea2b7a3cd,0xa0e61879227523e3,0x1b8fa072a3e8a241,0x9e541e8923962300,0x9807a2a7a3b89ef1,0x98eb212924002155,0x9f8ba3d9a22f0000,0x164622a723a81e1f
.quad 0x216a237923f622c6,0xa329a0cf99cd1c6e,0x222f23d923a821a8,0xa30ea07296461e1f,0x22d523ff230e2042,0xa2f2a0118b2e1fbd,0x235923ec222f1d49,0xa2d59f58147c20a1
.quad 0x23b8239f2113172a,0xa2b79e8918eb2155,0x23f0231c1f8b972a,0xa2979db51b8f21f7,0x240022641ca59d49,0xa2759cdc1d122286,0x23e8217f1646a042,0xa2539bfe1e542300
.quad 0x23a820729646a1a8,0xa22f9a3e1f8b2364,0x23411e899ca5a2c6,0xa20a9879205a23b0,0x22b71bfe9f8ba38d,0xa1e4956120e623e3,0x220a1561a113a3f3,0xa1bc8f2e216a23fd
.quad 0x213f9561a22fa3f3,0xa1940f2e21e423fd,0x205a9bfea30ea38d,0xa16a1561225323e3,0x1ebd9e89a3a8a2c6,0xa13f187922b723b0,0x1ca5a072a3f6a1a8,0xa1131a3e230e2364
.quad 0xa3dea2649f258000,0x16469db5a1e4a3b0,0xa3f6a2a79f8b8000,0x1ca59a3ea113a364,0xa400a2e49fef8000,0x1f8b8f2ea029a300,0xa3fba31ca0298000,0x211318799e54a286
.quad 0xa3e8a34da05a8000,0x222f1cdc9c37a1f7,0xa3c6a379a08a8000,0x230e1f589807a155,0xa396a39fa0b88000,0x23a820cf0b2ea0a1,0xa359a3bfa0e68000,0x23f621d018eb9fbd
.quad 0xa30ea3d9a1138000,0x23f622a71ca59e1f,0xa2b7a3eca13f8000,0x23a8234d1ebd9c6e,0xa253a3f9a16a8000,0x230e23bf205a995c,0xa1e4a3ffa1948000,0x222f23f9213f932d
.quad 0xa16aa3ffa1bc8000,0x211323f9220a132d,0xa0e6a3f9a1e48000,0x1f8b23bf22b7195c,0xa05aa3eca20a8000,0x1ca5234d23411c6e,0x9f8ba3d9a22f8000,0x164622a723a81e1f
.quad 0x236f23f922d52042,0xa0e69a3e1c372155,0x222f23d923a821a8,0xa30ea07296461e1f,0x205a231c23fe22c6,0xa3fba2a79f25132d,0x1c3721d023d3238d,0xa383a3d9a1e49c6e
.quad 0x91622011232923f3,0xa1bca3d9a36fa0a1,0x9d7f1bfe220a23f3,0x9deaa2a7a400a286,0xa0e68f2e208a238d,0x1162a072a383a3b0,0xa2979cdc1d7f22c6,0x1f259a3ea20aa3fd
.quad 0xa3a8a072164621a8,0x222f1a3e9f8ba364,0xa400a21d98eb2042,0x23b820729807a1f7,0xa396a34d9e541d49,0x23e822a71b8f9fbd,0xa275a3eca0e6172a,0x22b723d9208a995c
.quad 0xa0b8a3eca253972a,0x205a23d92297195c,0x9d12a34da3599d49,0x18eb22a723c61fbd,0x8b2ea21da3e8a042,0x9c37207223f021f7,0x1ca5a072a3f6a1a8,0xa1131a3e230e2364
.quad 0xa0b8a31ca400a335,0x2383217f1ca5995c,0x9646a072a30ea400,0x23a823d9222f1e1f,0x1ebd9561a08aa335,0x20b8234d23f62286,0x22971e899807a0fd,0x8b2e2011230e23fd
.quad 0x23fb22641d7f9b1f,0xa0e695611f8b2300,0x232923ec21e41b1f,0xa3b8a12996461fbd,0x205a237923b820fd,0xa36fa3bfa113932d,0x1162212923d32335,0xa029a379a3a8a0a1
.quad 0x9f8b1a3e222f2400,0x1646a072a3a8a364,0xa2d59cdc1e542335,0x216a0f2ea113a3e3,0xa400a1d0947c20fd,0x23de20cf9646a1f7,0xa2f2a3bfa0291b1f,0x2329239f1f8b9c6e
.quad 0x9fefa3bfa2d59b1f,0x1f25239f230e1c6e,0xb2ea1d0a3fba0fd,0x99cd20cf23f621f7,0x20299cdca359a335,0xa1e40f2e222f23e3,0x230e1a3ea113a400,0xa3f6a0721ca52364
.quad 0x147c201122b723f3,0xa3d3a3bfa20a9e1f,0xa1139a3e1ca521a8,0x9f8ba2a7a3f6a364,0xa3f0a2649e54172a,0x1dea9879a0e6a364,0xa275a3f9a329a042,0x2396212918eb9e1f
.quad 0x99cda17fa3c6a38d,0x22d523ff22971e1f,0x205a8f2ea0b8a38d,0x18eb217f23d32364,0x23c62129147ca042,0xa13f956120292364,0x22f223ec2194172a,0xa400a2649c371e1f
.quad 0x1ca522a723f621a8,0xa113a3d9a30e9e1f,0x9f251bfe229723f3,0x19cda011a396a364,0xa3839f581c3722c6,0x22f21cdc9ebda364,0xa359a3799ebd1d49,0x2383234d1dea9e1f
.quad 0x9e54a379a3419d49,0x1d7f234d236f1e1f,0x1d7f9f58a3b8a2c6,0x9fef1cdc23412364,0x23291bfea08aa3f3,0xa3dea0111d122364,0x23a822a71646a1a8,0xa22fa3d99f8b1e1f
.quad 0x1f8b0f2e9ebda241,0x21bc239f23e82286,0x23f622a71f8b8000,0x9ca51a3e21132364,0x2113237923e82241,0xa3dea21d9d7f195c,0x9ca51bfe21bc23cd,0xa0e6a379a3dea1f7
.quad 0xa3a8a12998071ef1,0x1ebd9879a13fa3b0,0xa22fa3f9a2f29ef1,0x23fe22641d129c6e,0x1646a011a359a3cd,0x1fef234d23d32155,0x230e1e899b8fa241,0xa05a1561216a23e3
.quad 0x230e23d921138000,0xa3f6a2a79ca51e1f,0x164621d023fe2241,0x9deaa31ca3c6a0a1,0xa22f9879208a23cd,0x213f8f2ea194a3fd,0xa3a8a31c9d121ef1,0x23c622e41c379fbd
.quad 0x9ca5a31ca3969ef1,0x1b8f22e423b81fbd,0x21139879a297a3cd,0xa20a8f2e21bc23fd,0x23f621d09162a241,0xa36fa31c9b8f20a1,0x1f8b23d9222f8000,0x9646a2a7a3a89e1f
.quad 0xa2f2a07298071d49,0x9b8fa129a359a3fd,0xa22fa3d9a3a8a1a8,0x230e207216469e1f,0x1d129a3ea13fa38d,0x216a239f23d321f7,0x23fe22a71ebd972a,0xa05a8f2e1fef2300
.quad 0x1e5422a7240022c6,0xa396a3bfa16a995c,0xa1bc9a3e1e5422c6,0x147ca011a341a3e3,0xa341a3d9a16a972a,0x23de217f18079fbd,0x147ca072a396a38d,0x1ebd231c23de2155
.quad 0x23a820729646a1a8,0xa22f9a3e1f8b2364,0x20e623d922f21d49,0xa275a3f9a194932d,0xa0291a3e227523f3,0x1dea9db5a329a3b0,0xa3dea2a79aaf2042,0x23f0226418eba0a1
.quad 0x99cda2a7a3d3a042,0x1807226423e820a1,0x22d51a3ea0b8a3f3,0xa36f9db51f2523b0,0x225323d91fef9d49,0xa0b8a3f9a1bc132d,0x9ca5207223f621a8,0x21139a3ea30ea364
.quad 0x23fe234d21131b1f,0x9d121879208a2300,0x16462072230e2400,0xa3a8a3d9a22f9e1f,0xa3c6a1d09ca51b1f,0x1c379bfea194a3b0,0x9deaa264a3f6a335,0x23c6239f213f195c
.quad 0x22f21f589646a0fd,0x9aaf1db5227523fd,0x20e6239f23a820fd,0xa3dea34da029132d,0xa19498791f8b2335,0x18eb9f58a329a3e3,0xa275a3ffa22f9b1f,0x23f022e41dea9c6e
.quad 0x1f8b9a3ea22fa400,0x9646207223a82364,0x238323791f8b9b1f,0xa3fba2649aaf1fbd,0x9aaf201123a82335,0x1162a129a3f0a286,0xa3fba21d964620fd,0x240021d01162a155
.quad 0x947ca21da3f6a0fd,0xb2e21d023fe2155,0x23d320119ca5a335,0xa3fea12918072286,0x1d7f2379230e1b1f,0x947ca264a3d39fbd,0xa30e9a3e21132400,0x23f620729ca5a364
.quad 0xa297a3eca396a1a8,0x222f1e8991629fbd,0x21131a3e9ca5a1a8,0x1f8b22a723f62364,0x21bc23bf23b821a8,0xa3a8a17f9b8f1c6e,0xa20a9cdc1b8f21a8,0x9646a0cfa36fa3e3
.quad 0xa0b8a379a3d3a1a8,0x23f6231c1fef932d,0x22d51e8999cda1a8,0x9ca51cdc225323fd,0x1f25231c23e821a8,0xa30ea3eca1bc995c,0xa36fa011180721a8,0x21130f2ea0b8a3b0
.quad 0x9ca5a2a7a3f6a1a8,0x211323d9230e1e1f,0x23d320cf947ca1a8,0xa30e9db51d7f2300,0x1807221d23fe21a8,0x9ca5a2e4a3d3a0a1,0xa3fea17f0b2e21a8,0x23f62129947ca1f7
.quad 0x1162a17fa400a1a8,0x9646212923fb21f7,0x23f0221d1162a1a8,0xa3a8a2e49aaf20a1,0x9aaf20cf23fb21a8,0x1f8b9db5a383a300,0xa3a8a2a7964621a8,0x222f23d91f8b9e1f
.quad 0x1e54221d23c623cd,0xa3f0a2a79fef932d,0xa3f6a2a79f8b8000,0x1ca59a3ea113a364,0x1aaf9cdca1e4a3cd,0x220a23d923962155,0x22f223ff22b71ef1,0xa341a07291621fbd
.quad 0xa1e49bfe1d122241,0x8b2ea072a359a3e3,0x9ebda2e4a3fba241,0x235923d92194195c,0x23f021d019cd9ef1,0xa1e49a3e1ebd2300,0x99cd1f58234123cd,0x9d12a2a7a3fba1f7
.quad 0xa30ea3d9a1138000,0x23f622a71ca59e1f,0x21bc1561a0b8a3cd,0x9fef1a3e225323fd,0x1f252379236f1ef1,0xa0b8a3d9a2d59c6e,0xa3e8a0cf18072241,0x23d3207299cda286
.quad 0x18eba0cfa3f0a241,0x9aaf207223de2286,0x232923791dea9ef1,0xa275a3d9a0291c6e,0xa1941561227523cd,0x22f21a3ea0e6a3fd,0x9f8ba3d9a22f8000,0x164622a723a81e1f
.quad 0x18eb9cdca194a38d,0x234123ff230e20a1,0x222f23d923a821a8,0xa30ea07296461e1f,0xa383a12999cd1d49,0x18eb9db5a22fa3e3,0x19cd9db5a253a3f3,0x219423bf23a82155
.quad 0x220a23ec23412042,0xa3f0a21d9ca51c6e,0xa396a0cf91622042,0x1fef9561a113a3b0,0x1aaf9e89a2f2a3f3,0x1e5422e423f621f7,0x21e423f922b71d49,0xa3c6a34d9f8b195c
.quad 0xa3a8a072164621a8,0x222f1a3e9f8ba364,0x1b8f9f58a36fa38d,0x1162217f23f62286,0x21bc23ff220a172a,0xa297a3eca113132d,0xa3b8a0111b8f22c6,0x23961f589ca5a300
.quad 0x1c37a011a3c6a2c6,0x9d121f5823a82300,0x219423ff213f972a,0xa08aa3eca22f932d,0xa3c69f581dea238d,0x23fe217f9646a286,0x1ca5a072a3f6a1a8,0xa1131a3e230e2364
.quad 0xa13f9bfe1aaf20fd,0xa05aa2e4a3fba364,0x9646a072a30ea400,0x23a823d9222f1e1f,0x225323ec236f20fd,0xa359a0cf98071e1f,0xa3e8a21d9d121b1f,0x1f259561a0b8a364
.quad 0x208a0f2ea029a335,0x1b8f21d023de2364,0x1aaf21d023e82335,0xa275a3ffa2b79e1f,0xa2d5a3f9a20a9b1f,0x23fb221d1b8f9e1f,0x23b820cf8b2ea0fd,0xa1bc98791fef2364
.quad 0x9f8b1a3e222f2400,0x1646a072a3a8a364,0x9d12a2e4a3dea0fd,0x208a23bf23291e1f,0x2341239f1fef9b1f,0xa3b8a31c9d7f1e1f,0xa36f9e891d7f2335,0x23411db59e54a364
.quad 0x1dea9e89a383a335,0x9ebd1db523592364,0x1ebd239f22f21b1f,0x9c37a31ca3839e1f,0xa396a2e499cd20fd,0x229723bf1f259e1f,0x230e1a3ea113a400,0xa3f6a0721ca52364
.quad 0x23a821d01d7f972a,0xb2e1f58227523e3,0xa1139a3e1ca521a8,0x9f8ba2a7a3f6a364,0x16469e89a275a3f3,0x229723f9234120a1,0x1f8b22e4240022c6,0xa3f0a34da08a932d
.quad 0xa30ea3f9a2539d49,0x238320cf147c9fbd,0x23f6221d1c379d49,0xa16a98791f252300,0xa22f9bfe1dea22c6,0x1c379db5a2b7a3fd,0x1ca59db5a2d5a3f3,0x1aaf221d23fe2286
.quad 0x1ca522a723f621a8,0xa113a3d9a30e9e1f,0xa22fa3ffa1e4972a,0x2359239f2029995c,0x23f6226419cda042,0xa3fba17f8b2e2155,0xa30e9cdc1f25238d,0x22d51bfe9fefa3b0
.quad 0x1f8b9cdca329a38d,0xa0291bfe22f223b0,0x1646226423de2042,0x147ca17fa400a155,0xa113a3ffa16a172a,0x1e54239f22d5195c,0x23a822a71646a1a8,0xa22fa3d99f8b1e1f
.quad 0xa3b8a3d9a2539ef1,0x202915619deaa1f7,0x23f622a71f8b8000,0x9ca51a3e21132364,0xa329a072947c1ef1,0x11629f58a2b7a3fd,0x216a1a3e9d7fa241,0x1aaf217f23b823b0
.quad 0x9dea1a3e219423cd,0x9f25a2e4a3fea286,0xb2ea072a36fa3cd,0x213f23bf238320a1,0x1d7f22a723fe2241,0xa297a3ffa2539c6e,0xa13fa3d9a3299ef1,0x2383239f208a932d
.quad 0x230e23d921138000,0xa3f6a2a79ca51e1f,0xa3f0a2a79c371ef1,0x23e821298b2ea155,0x23c6207298eba241,0xa3599e891d122300,0xa2979a3e205a23cd,0x22531879a0b8a3e3
.quad 0x208a9a3ea2b7a3cd,0xa0e61879227523e3,0x9b8f207223e82241,0x1e549e89a396a300,0x9807a2a7a3b89ef1,0x98eb212924002155,0x1f8b23d9222f8000,0x9646a2a7a3a89e1f
.quad 0x216a237923f622c6,0xa329a0cf99cd1c6e,0xa22fa3d9a3a8a1a8,0x230e207216469e1f,0x22d523ff230e2042,0xa2f2a0118b2e1fbd,0xa359a3eca22f9d49,0x22d51f58947ca0a1
.quad 0x23b8239f2113172a,0xa2b79e8918eb2155,0xa3f0a31c9f8b172a,0x22971db59b8fa1f7,0x240022641ca59d49,0xa2759cdc1d122286,0xa3e8a17f96462042,0x22531bfe9e54a300
.quad 0x23a820729646a1a8,0xa22f9a3e1f8b2364,0xa3419e891ca522c6,0x220a1879a05aa3b0,0x22b71bfe9f8ba38d,0xa1e4956120e623e3,0xa20a9561211323f3,0x21bc0f2ea16aa3fd
.quad 0x213f9561a22fa3f3,0xa1940f2e21e423fd,0xa05a1bfe230e238d,0x216a9561a253a3e3,0x1ebd9e89a3a8a2c6,0xa13f187922b723b0,0x9ca5207223f621a8,0x21139a3ea30ea364
.quad 0x99cda0cfa329a400,0x23f62379216a1c6e,0x16462072230e2400,0xa3a8a3d9a22f9e1f,0x8b2ea011a2f2a400,0x230e23ff22d51fbd,0x947c1f5822d52400,0xa22fa3eca359a0a1
.quad 0x18eb9e89a2b7a400,0x2113239f23b82155,0x9b8f1db522972400,0x9f8ba31ca3f0a1f7,0x1d129cdca275a400,0x1ca5226424002286,0x9e541bfe22532400,0x9646a17fa3e8a300
.quad 0x1f8b9a3ea22fa400,0x9646207223a82364,0xa05a1879220a2400,0x1ca59e89a341a3b0,0x20e69561a1e4a400,0x9f8b1bfe22b723e3,0xa16a0f2e21bc2400,0x21139561a20aa3fd
.quad 0x21e40f2ea194a400,0xa22f9561213f23fd,0xa2539561216a2400,0x230e1bfea05aa3e3,0x22b71879a13fa400,0xa3a89e891ebd23b0,0xa30e9a3e21132400,0x23f620729ca5a364
.quad 0x9dea1561202922c6,0xa253a3d9a3b8a1f7,0x21131a3e9ca5a1a8,0x1f8b22a723f62364,0xa2b79f5811622042,0x947ca072a329a3fd,0x23b8217f1aaf9d49,0x9d7f1a3e216a23b0
.quad 0xa3fea2e49f25172a,0x21941a3e9deaa286,0x238323bf213f172a,0xa36fa0720b2e20a1,0xa253a3ffa2979d49,0x23fe22a71d7f9c6e,0x208a239f23832042,0xa329a3d9a13f932d
.quad 0x9ca5a2a7a3f6a1a8,0x211323d9230e1e1f,0x8b2e212923e822c6,0x9c37a2a7a3f0a155,0x1d129e89a359a38d,0x98eb207223c62300,0xa0b81879225323f3,0x205a9a3ea297a3e3
.quad 0x22751879a0e6a3f3,0xa2b79a3e208a23e3,0xa3969e891e54238d,0x23e820729b8fa300,0x2400212998eba2c6,0xa3b8a2a798072155,0xa3a8a2a7964621a8,0x222f23d91f8b9e1f
.quad 0x22751f580b2e9ef1,0x1d7f21d023a823e3,0xa3f6a2a79f8b8000,0x1ca59a3ea113a364,0x234123f922971ef1,0xa2759e89164620a1,0xa08aa34da3f0a241,0x240022e41f8b932d
.quad 0x147c20cf238323cd,0xa253a3f9a30e9fbd,0x1f259879a16aa3cd,0x1c37221d23f62300,0xa2b79db51c372241,0x1dea9bfea22fa3fd,0x23fe221d1aaf9ef1,0xa2d59db51ca52286
.quad 0xa30ea3d9a1138000,0x23f622a71ca59e1f,0x2029239f23591ef1,0xa1e4a3ffa22f995c,0x8b2ea17fa3fba241,0x19cd226423f62155,0x9fef1bfe22d523cd,0x1f259cdca30ea3b0
.quad 0x22f21bfea029a3cd,0xa3299cdc1f8b23b0,0xa400a17f147c2241,0x23de22641646a155,0x22d5239f1e549ef1,0xa16aa3ffa113195c,0x9f8ba3d9a22f8000,0x164622a723a81e1f
.quad 0xa3fba2e4a05a972a,0x1aaf9bfea13fa364,0x222f23d923a821a8,0xa30ea07296461e1f,0x9807a0cfa359a3f3,0x236f23ec22531e1f,0xa0b895611f2522c6,0x9d12a21da3e8a364
.quad 0x23de21d01b8f9d49,0xa0290f2e208a2364,0xa2b7a3ffa2759d49,0x23e821d01aaf9e1f,0x1b8f221d23fb22c6,0xa20aa3f9a2d59e1f,0x1fef9879a1bca3f3,0x8b2e20cf23b82364
.quad 0xa3a8a072164621a8,0x222f1a3e9f8ba364,0x232923bf208a972a,0xa3dea2e49d121e1f,0x9d7fa31ca3b8a042,0x1fef239f23411e1f,0x9e541db52341238d,0x1d7f9e89a36fa364
.quad 0x23591db59ebda38d,0xa3839e891dea2364,0xa383a31c9c372042,0x22f2239f1ebd9e1f,0x1f2523bf2297172a,0x99cda2e4a3969e1f,0x1ca5a072a3f6a1a8,0xa1131a3e230e2364
.quad 0x230e23ff234120fd,0xa1949cdc18eb20a1,0x9646a072a30ea400,0x23a823d9222f1e1f,0xa22f9db518eb20fd,0x99cda129a383a3e3,0x23a823bf21941b1f,0xa2539db519cd2155
.quad 0x9ca5a21da3f0a335,0x234123ec220a1c6e,0xa11395611fef2335,0x9162a0cfa396a3b0,0x23f622e41e549b1f,0xa2f29e891aaf21f7,0x9f8ba34da3c6a0fd,0x22b723f921e4195c
.quad 0x9f8b1a3e222f2400,0x1646a072a3a8a364,0x23f6217f1162a0fd,0xa36f9f581b8f2286,0xa113a3eca2979b1f,0x220a23ff21bc132d,0x9ca51f5823962335,0x1b8fa011a3b8a300
.quad 0x23a81f589d12a335,0xa3c6a0111c372300,0xa22fa3eca08a1b1f,0x213f23ff2194932d,0x9646217f23fe20fd,0x1dea9f58a3c6a286,0x230e1a3ea113a400,0xa3f6a0721ca52364
.quad 0x9fefa2a7a3f0a38d,0x23c6221d1e54932d,0xa1139a3e1ca521a8,0x9f8ba2a7a3f6a364,0x239623d9220a1d49,0xa1e49cdc1aaf2155,0x9162a072a341a3f3,0x22b723ff22f21fbd
.quad 0xa359a0728b2e2042,0x1d129bfea1e4a3e3,0x219423d923592042,0xa3fba2e49ebd195c,0x1ebd9a3ea1e4a3f3,0x19cd21d023f02300,0xa3fba2a79d121d49,0x23411f5899cda1f7
.quad 0x1ca522a723f621a8,0xa113a3d9a30e9e1f,0x22531a3e9fefa38d,0xa0b8156121bc23fd,0xa2d5a3d9a0b8172a,0x236f23791f259c6e,0x99cd207223d322c6,0x1807a0cfa3e8a286
.quad 0x23de20729aafa2c6,0xa3f0a0cf18eb2286,0xa029a3d9a275972a,0x1dea237923291c6e,0xa0e61a3e22f2238d,0x22751561a194a3fd,0x23a822a71646a1a8,0xa22fa3d99f8b1e1f
.quad 0x91621e89222f23cd,0xa396a3eca2979fbd,0x23f622a71f8b8000,0x9ca51a3e21132364,0x9b8fa17fa3a8a3cd,0x23b823bf21bc1c6e,0xa36fa0cf96461ef1,0x1b8f9cdca20aa3e3
.quad 0x1fef231c23f62241,0xa3d3a379a0b8932d,0x22531cdc9ca5a241,0x99cd1e8922d523fd,0xa1bca3eca30e9ef1,0x23e8231c1f25995c,0xa0b80f2e211323cd,0x1807a011a36fa3b0
.quad 0x230e23d921138000,0xa3f6a2a79ca51e1f,0x1d7f9db5a30ea3cd,0x947c20cf23d32300,0xa3d3a2e49ca51ef1,0x23fe221d1807a0a1,0x947c212923f62241,0xb2ea17fa3fea1f7
.quad 0x23fb21299646a241,0xa400a17f116221f7,0x9aafa2e4a3a89ef1,0x1162221d23f020a1,0xa3839db51f8b23cd,0x23fb20cf9aafa300,0x1f8b23d9222f8000,0x9646a2a7a3a89e1f
.quad 0x208a18799d12a1a8,0x2113234d23fe2300,0xa22fa3d9a3a8a1a8,0x230e207216469e1f,0xa1949bfe1c3721a8,0x9ca5a1d0a3c6a3b0,0x213f239f23c621a8,0xa3f6a2649dea195c
.quad 0x22751db59aafa1a8,0x96461f5822f223fd,0xa029a34da3dea1a8,0x23a8239f20e6132d,0xa3299f5818eb21a8,0x1f8b9879a194a3e3,0x1dea22e423f021a8,0xa22fa3ffa2759c6e
.quad 0x23a820729646a1a8,0xa22f9a3e1f8b2364,0x9aafa264a3fba1a8,0x1f8b237923831fbd,0xa3f0a129116221a8,0x23a820119aafa286,0x116221d0240021a8,0x9646a21da3fba155
.quad 0x23fe21d00b2ea1a8,0xa3f6a21d947c2155,0x1807a129a3fea1a8,0x9ca5201123d32286,0xa3d3a264947c21a8,0x230e23791d7f9fbd,0x9ca5207223f621a8,0x21139a3ea30ea364
.quad 0xa359a1299b8f1b1f,0x9807a072a2f2a3fd,0x16462072230e2400,0xa3a8a3d9a22f9e1f,0x23d3239f216a1b1f,0xa13f9a3e1d1221f7,0x1fef8f2ea05aa335,0x1ebd22a723fe2300
.quad 0xa16aa3bfa396a0fd,0x240022a71e54995c,0xa341a011147c20fd,0x1e549a3ea1bca3e3,0x1807217f23de2335,0xa16aa3d9a3419fbd,0x23de231c1ebd9b1f,0xa396a072147c2155
.quad 0x1f8b9a3ea22fa400,0x9646207223a82364,0xa194a3f9a2759b1f,0x22f223d920e6932d,0xa3299db51dea2335,0x22751a3ea029a3b0,0x18eb226423f020fd,0x9aafa2a7a3dea0a1
.quad 0x23e822641807a0fd,0xa3d3a2a799cd20a1,0x1f259db5a36fa335,0xa0b81a3e22d523b0,0xa1bca3f9a0b81b1f,0x1fef23d92253132d,0xa30e9a3e21132400,0x23f620729ca5a364
.quad 0x23e8239f21bc1d49,0x9ebd0f2e1f8b2286,0x21131a3e9ca5a1a8,0x1f8b22a723f62364,0x9d7fa21da3dea38d,0x23e823792113195c,0xa3dea379a0e6972a,0x21bc1bfe9ca5a1f7
.quad 0xa13f98791ebd22c6,0x9807a129a3a8a3b0,0x1d12226423fe22c6,0xa2f2a3f9a22f9c6e,0x23d3234d1fef972a,0xa359a01116462155,0x216a1561a05aa38d,0x9b8f1e89230e23e3
.quad 0x9ca5a2a7a3f6a1a8,0x211323d9230e1e1f,0xa3c6a31c9dea1d49,0x23fe21d01646a0a1,0xa1948f2e213f23f3,0x208a9879a22fa3fd,0x1c3722e423c62042,0x9d12a31ca3a89fbd
.quad 0x23b822e41b8fa042,0xa396a31c9ca51fbd,0x21bc8f2ea20aa3f3,0xa2979879211323fd,0x9b8fa31ca36f9d49,0x916221d023f620a1,0xa3a8a2a7964621a8,0x222f23d91f8b9e1f
.quad 0xa20aa3bfa3d3a241,0x22b72011147c9e1f,0xa3f6a2a79f8b8000,0x1ca59a3ea113a364,0xa0e698791dea2241,0x9e54a264a3f0a364,0x18eb2129239623cd,0xa329a3f9a2759e1f
.quad 0x229723ff22d51ef1,0xa3c6a17f99cd1e1f,0x23d3217f18eb9ef1,0xa0b88f2e205a2364,0x20299561a13fa3cd,0x147c212923c62364,0x9c37a264a400a241,0x219423ec22f21e1f
.quad 0xa30ea3d9a1138000,0x23f622a71ca59e1f,0xa396a01119cd2241,0x22971bfe9f25a364,0x9ebd1cdc22f223cd,0x1c379f58a383a364,0x1dea234d23831ef1,0x9ebda379a3599e1f
.quad 0x236f234d1d7f9ef1,0xa341a3799e541e1f,0x23411cdc9fefa3cd,0xa3b89f581d7f2364,0x1d12a011a3dea241,0xa08a1bfe23292364,0x9f8ba3d9a22f8000,0x164622a723a81e1f
.quad 0x1ca5217f238323f3,0xa400a31ca0b8995c,0x222f23d923a821a8,0xa30ea07296461e1f,0x23f6234d20b8172a,0xa08a95611ebd2286,0x230e20118b2ea042,0x98071e89229723fd
.quad 0x1f8b9561a0e6a38d,0x1d7f226423fb2300,0x9646a129a3b8a38d,0x21e423ec23291fbd,0xa113a3bfa36fa042,0x23b82379205a932d,0xa3a8a379a029172a,0x23d321291162a0a1
.quad 0xa3a8a072164621a8,0x222f1a3e9f8ba364,0xa1130f2e216a23f3,0x1e549cdca2d5a3e3,0x964620cf23de22c6,0x947ca1d0a400a1f7,0x1f8b239f23291d49,0xa029a3bfa2f29c6e
.quad 0x230e239f1f259d49,0xa2d5a3bf9fef1c6e,0x23f620cf99cda2c6,0xa3fba1d00b2e21f7,0x222f0f2ea1e4a3f3,0xa3599cdc202923e3,0x1ca5a072a3f6a1a8,0xa1131a3e230e2364
.quad 0x1c379a3ea0e6a335,0x22d523f9236f2155,0x9646a072a30ea400,0x23a823d9222f1e1f,0x9f25a2a7a3fba335,0x23fe231c205a132d,0xa1e4a3d9a383a0fd,0x23d321d01c379c6e
.quad 0xa36fa3d9a1bc9b1f,0x232920119162a0a1,0xa400a2a79dea1b1f,0x220a1bfe9d7fa286,0xa383a072116220fd,0x208a8f2ea0e6a3b0,0xa20a9a3e1f252335,0x1d7f9cdca297a3fd
.quad 0x9f8b1a3e222f2400,0x1646a072a3a8a364,0x9807207223b82335,0x98eba21da400a1f7,0x1b8f22a723e820fd,0x9e54a34da3969fbd,0x208a23d922b71b1f,0xa0e6a3eca275995c
.quad 0x229723d9205a9b1f,0xa253a3eca0b8195c,0x23c622a718eba0fd,0xa359a34d9d121fbd,0x23f020729c37a335,0xa3e8a21d8b2e21f7,0x230e1a3ea113a400,0xa3f6a0721ca52364
.quad 0xa1e49db516462042,0x9f25a264a3dea3b0,0xa1139a3e1ca521a8,0x9f8ba2a7a3f6a364,0xa0298f2e1f8b22c6,0x9fefa2e4a400a300,0x9e5418792113238d,0xa029a31ca3fba286
.quad 0x9c371cdc222f23f3,0xa05aa34da3e8a1f7,0x98071f58230e23f3,0xa08aa379a3c6a155,0xb2e20cf23a8238d,0xa0b8a39fa396a0a1,0x18eb21d023f622c6,0xa0e6a3bfa3599fbd
.quad 0x1ca522a723f621a8,0xa113a3d9a30e9e1f,0x1ebd234d23a82042,0xa13fa3eca2b79c6e,0x205a23bf230e1d49,0xa16aa3f9a253995c,0x213f23f9222f172a,0xa194a3ffa1e4932d
.quad 0x220a23f92113972a,0xa1bca3ffa16a132d,0x22b723bf1f8b9d49,0xa1e4a3f9a0e6195c,0x2341234d1ca5a042,0xa20aa3eca05a1c6e,0x23a822a71646a1a8,0xa22fa3d99f8b1e1f
.quad 0xa3599bfe20e62400,0x23f6217f98eba300,0xa3969cdc20b82400,0x23a822648b2ea286,0xa3c69db5208a2400,0x230e231c1807a1f7,0xa3e89e89205a2400,0x222f239f1c37a155
.quad 0xa3fb9f5820292400,0x211323ec1e54a0a1,0xa400a0111fef2400,0x1f8b23ff20299fbd,0xa3f6a0721f8b2400,0x1ca523d921139e1f,0xa3dea0cf1f252400,0x1646237921e49c6e
.quad 0xa3b8a1291ebd2400,0x964622e42297995c,0xa383a17f1e542400,0x9ca5221d2329932d,0xa341a1d01dea2400,0x9f8b21292396132d,0xa2f2a21d1d7f2400,0xa113201123de195c
.quad 0xa297a2641d122400,0xa22f1db523fe1c6e,0xa22fa2a71ca52400,0xa30e1a3e23f61e1f,0xa1bca2e41c372400,0xa3a80f2e23c61fbd,0xa13fa31c1b8f2400,0xa3f69879236f20a1
.quad 0xa297a39f9d7f2042,0x1f2523d9220a932d,0xa0e6a3ffa08a1d49,0x116222a723831c6e,0x9d7fa3bfa20a172a,0x9dea2072240020a1,0x9162a2e4a329972a,0xa1bc1a3e236f2286
.quad 0x1c37a17fa3d39d49,0xa3839a3e21e423b0,0x205a9f58a3fea042,0xa3fba0721f2523fd,0x222f9a3ea3a8a1a8,0xa30ea2a716462364,0x236f1561a2d5a2c6,0xa0e6a3d99c3721f7
.quad 0x23fb1db5a194a38d,0x9b8fa3d9a0b81fbd,0x23c620cf9fefa3f3,0x19cda2a7a2b7195c,0x22d522649c37a3f3,0x208aa072a3d3995c,0x213f23798b2ea38d,0x22d59a3ea3e89fbd
.quad 0x1e5423f91b8fa2c6,0x23f01a3ea2f2a1f7,0x164623d91f8ba1a8,0x23a82072a113a364,0x9aaf231c216aa042,0x220a22a79d12a3fd,0x9fef21d022b79d49,0x1ebd23d91162a3b0
.quad 0x1162a21da3d39ef1,0xa0291db523a82286,0x205a9db5a3b8a241,0xa36f9bfe211323fd,0x23291879a1e4a3cd,0xa3b8a21d16462300,0x23fb20cf9d7fa3cd,0xa0e6a3f99f8b1fbd
.quad 0x2297234d1807a241,0x8b2ea2e4a30e932d,0x1ebd23f9208a9ef1,0x20b89e89a3f6a0a1,0x964622a7230e8000,0x23a81a3ea22fa364,0xa0b81f5824001ef1,0x238321d09ca5a3e3
.quad 0xa3598f2e23292241,0x205a23ec1ca5a1f7,0xa3f0a01120b823cd,0x947c231c222f9c6e,0xa253a2e418eb23cd,0xa13f1f5823f61c6e,0x9deaa3ff9d122241,0xa3d39879230e21f7
.quad 0x18eba31ca1bc1ef1,0xa341a17f1f8b23e3,0x2113a072a3a80000,0x9f8ba3d996462364,0x23839561a3de9ef1,0x18eba34da11320a1,0x23de1e89a253a241,0x21bca011a3a8132d
.quad 0x22f21879a194a3f3,0xa400a0cf1c372364,0x23c6221d947ca2c6,0xa13fa3f9a0291e1f,0x205a23ff20b89d49,0x18eba1d0a3d39e1f,0x99cd21d023c61d49,0x22d50f2ea297a364
.quad 0xa2751561232922c6,0x2396221d98eba364,0xa3f0a0cf1e5423f3,0x1dea23ec20e69e1f,0xa113a3d99ca521a8,0x9f8b207223f61e1f,0x147ca2e4a2b7172a,0xa3d39bfe220a2364
.quad 0x21e49cdca3f0a042,0xa253a31c11622364,0x24001e89a16aa38d,0x9162a379a1941e1f,0x21bc234d9162a38d,0x21e49db5a4009e1f,0x1162239f20e6a042,0x23f01f58a16aa364
.quad 0xa13f201123d3172a,0x205a23bf147ca364,0xa3f69a3e230e21a8,0x9ca522a7222f9e1f,0xa253a2641dea23f3,0xa359187923f01e1f,0x98eba3f99d1222c6,0xa329a12920b82364
.quad 0x230e234d1b8fa0fd,0xa05aa3f9a16a195c,0x164622e423591b1f,0x1fef9e89a3d3a1f7,0xa22f156122f22335,0x23fe20cf9d12a3b0,0xa3a8a21d18072335,0x1ebd23ec213f9c6e
.quad 0x9ca5a3bfa1bc1b1f,0xa0e61db523de2155,0x21139db5a3e8a0fd,0xa3dea1291d7f23e3,0x23f620729f8ba400,0x9ca5a3d9a1131e1f,0x1f8b23ff1ebda0fd,0x21bc9cdca3e8a0a1
.quad 0x9f8b20cf23d31b1f,0x2396217f9deaa3fd,0xa3f69cdc220a2335,0x18eb23bf20e69fbd,0xa113a39f947c2335,0xa2751bfe23f01fbd,0x1ca5a264a2b71b1f,0xa329a1d01e5423fd
.quad 0x23a80f2ea383a0fd,0x8b2ea39fa0b820a1,0x222f22a79ca5a400,0x230e9a3ea3f69e1f,0x9646237920b8a0fd,0x2297221d9ebda3e3,0xa30e1bfe24001b1f,0x98072379208aa155
.quad 0x147c22a723961d49,0x1ebd9f58a3dea1f7,0xa3419a3e216a23f3,0x23de21d09807a300,0xa1bca3d99e542042,0x147c22e42341195c,0x1e54a072a400a042,0xa3969bfe216a23e3
.quad 0x23fe20729ebda3f3,0xa05aa3ff9fef1fbd,0x1d1223d9213f9d49,0x216a9cdca3d3a155,0xa22f1a3e23a821a8,0x230e22a79646a364,0xa2f2a2a71807238d,0x9b8f221d2359132d
.quad 0x18eba2a7a2d5172a,0xa4009e89213f23b0,0x23d31a3ea297a2c6,0x9c37a3eca02920a1,0x205a23d919cda2c6,0x22f29879a3c6a0a1,0xa0b8207223c6172a,0x2194234d947ca3b0
.quad 0xa3b8a07220e6238d,0xa0292129236f932d,0x9646a3d99f8b21a8,0xa3a8a07221132364,0x23299a3ea3fb9d49,0x1162a39fa05a2155,0x21e422a79d7fa3f3,0x23d30f2ea3b89fbd
.quad 0xa2758f2e222f23cd,0x23f020119deaa3b0,0xa194a3ec9f8b1ef1,0x18eb231c2329195c,0x20e69cdca3a8a241,0xa3de9e89202923fd,0x22f2231c1646a241,0x9aafa379a275132d
.quad 0x9dea20cf23f61ef1,0x23c61cdca13fa3e3,0xa3c6a17f1ca523cd,0x1c3723bf21949c6e,0x1646a2a7a30e0000,0xa3a89a3e222f2364,0x23fe1e89a113a3cd,0x9d12a3eca08a1fbd
.quad 0x19cd23bf21139ef1,0x23831561a2f2a286,0xa3969561230e2241,0x1dea23ff1ebda155,0x9f25a3f99ca52241,0xa3590f2e23832155,0x22979bfea3f69ef1,0x9ebda3f99c372286
.quad 0x216a234d9646a3cd,0x23299879a3de9fbd,0xa113207223a88000,0x1f8b23d91646a364,0xa2d5a1d01f8b23cd,0xa2f21bfe24001c6e,0x1e54a264a22f1ef1,0xa029a39f147c23e3
.quad 0xa36fa2e4980721a8,0x211323ff20b89c6e,0x1f259f58a3e8a1a8,0xa30e987921bc23e3,0x22d5234d19cda1a8,0x9ca5a39fa253132d,0xa0b81db523d321a8,0x23f61f589fefa3fd
.quad 0xa20aa39f9b8f21a8,0x96462264236f195c,0x21bc9bfea3b8a1a8,0xa3a8a1d01b8f23b0,0x211323d91ca5a1a8,0x1f8ba072a3f69e1f,0xa2971879239621a8,0x222f234d1162a300
.quad 0x9fefa3f99d7f21a8,0xa22f1bfe23de20a1,0x23418f2ea36fa1a8,0x9f8ba3f99d1221f7,0x1d7f23ff1e54a1a8,0x23a81561a329a1f7,0xa3b89561234121a8,0x164623bf208aa0a1
.quad 0x99cda3ec9f2521a8,0xa3f69e8921e42300,0x23f61a3ea30ea1a8,0x1ca5a2a7a22f1e1f,0xb2e23bf1fefa1a8,0x230e217fa029a3b0,0xa3fb9cdc22d521a8,0xa11320cf2359995c
.quad 0x99cda31ca3419b1f,0x9d12207223fb2155,0x23f0217f99cda335,0xa1e4a3d99ebd1fbd,0x9ebd201123fb20fd,0x23591a3ea194a3e3,0xa1e4a3bf9d1220fd,0x8b2e22a72359195c
.quad 0x22f20f2ea2b7a335,0xa341a2a711622300,0x1aaf239f21e49b1f,0x220a9a3ea396a1f7,0xa3f6a0721f8b2400,0x1ca523d921139e1f,0x1e54a129a3c69b1f,0xa3f0a0721fef23fd
.quad 0x220a234d0b2ea335,0x2029a072a3e89c6e,0xa2d5187923b820fd,0x208a23d91aafa286,0x9b8fa3ec9fef20fd,0xa3de9a3e22b72286,0x23fb1e89a1bca335,0x1b8fa2a7a2751c6e
.quad 0x9dea221d22d59b1f,0x225322a79c37a3fd,0xa22fa2a71ca52400,0xa30e1a3e23f61e1f,0x22b79cdca3fe9b1f,0x947ca3d99f2521f7,0x1c3723ff1aafa335,0x23832072a16aa300
.quad 0x21e49561a2b7a38d,0xa3c69e891f8b23e3,0x1aaf234d22f2172a,0x1e54a011a3f6a155,0xa396a264116222c6,0x1fef23f921139c6e,0x220a9879a341a2c6,0xa3f0a1291ca523b0
.quad 0x19cd23792253972a,0x21949bfea3a8a1f7,0xa383a21d19cd238d,0x18eb2379222f995c,0x222f9a3ea3a8a1a8,0xa30ea2a716462364,0x18eb239f21949d49,0x23410f2ea30ea286
.quad 0xa36fa1d01d1223f3,0x9aaf2264230e932d,0x22539bfea3e8a042,0xa13fa39f96462300,0x180723bf20b8a042,0x23fb1cdca22fa300,0xa359a17f1f2523f3,0xa05a20cf23a8132d
.quad 0x22759cdca4009d49,0x9d7fa3ff9ca52286,0x164623d91f8ba1a8,0x23a82072a113a364,0xa341a129208a238d,0xa2751db523f6195c,0x22979db5a3f0972a,0xb2ea3bf9f8b21f7
.quad 0x23b822640b2ea241,0xa1bca3ec9fef1e1f,0xa2d59561220a23cd,0x23fb21299b8fa364,0x1aafa17fa3e89ef1,0xa2750f2e22b72364,0x208a23ff20299ef1,0x1b8fa17fa3de9e1f
.quad 0xa3e8a1291d1223cd,0x1f2523f920b89e1f,0x22539879a36fa241,0xa359a26418072364,0x964622a7230e8000,0x23a81a3ea22fa364,0xa13fa3bf9aaf2241,0xa05a201123fb1e1f
.quad 0x23fe1f58a0e6a3cd,0x9807a39fa16a1e1f,0xa1bc1db523fe1ef1,0x21e4234d8b2ea364,0x8b2ea379a16a1ef1,0xa3fe9e8921942364,0x21e4231c9807a3cd,0x22539cdca3fe9e1f
.quad 0xa3fb9bfe22b72241,0x9aaf22e4220a9e1f,0x2113a072a3a80000,0x9f8ba3d996462364,0x180723ec1e54a241,0x236f20cfa0e6a364,0xa275a21d1f2523cd,0xa396156123e81e1f
.quad 0x1ca5237922d5172a,0x1aafa129a3fea0a1,0xa22fa3bf9dea2042,0x1c37237922b7132d,0x23f621299c37a38d,0xa16aa3ec9f251fbd,0xa30e95612253238d,0x23832264947ca300
.quad 0x1f8ba011a400a042,0xa3f09e89208a23fd,0x1646234d2275972a,0x22979561a341a286,0xa113a3d99ca521a8,0x9f8b207223f61e1f,0x23a8217f9d7fa3f3,0xb2ea31ca275195c
.quad 0xa3a8987922b722c6,0x1f2523ff1e54a155,0x21139f58a3fb9d49,0xa275a2e4180723b0,0x9646231c220a9d49,0x23e82011a0e6a3b0,0x9f8ba3ec9aaf22c6,0xa3968f2e236f2155
.quad 0x230e21d09ebda3f3,0x21949f58a3e8995c,0xa3f69a3e230e21a8,0x9ca522a7222f9e1f,0x222f9e89a3e8972a,0x99cda3f99d7f2286,0x9ca522e42194a042,0x20e6234d99cda3fd
.quad 0xa13f1a3e23292335,0x23831cdca08aa3fd,0x1d7fa072a3fea0fd,0xa2978f2e225323b0,0xb2e22a7236f1b1f,0x213f9bfea383a286,0x9deaa3d9a1941b1f,0x9f25201123fe20a1
.quad 0x216a23d91d7fa0fd,0x1aafa1d0a3b89c6e,0xa329a2a7147c2335,0x1162231c22b7932d,0x23f620729f8ba400,0x9ca5a3d9a1131e1f,0xa3b89a3e22532335,0x202923f91deaa155
.quad 0x22759a3ea3c6a0fd,0xa1bca379947c2300,0xa05a207223de1b1f,0x22f222649b8fa3e3,0x1aafa2a7a2971b1f,0xa3b8a0cf202923e3,0x18eb23d92029a0fd,0x24001db5a20aa300
.quad 0x9fefa3d998072335,0xa3c6956123592155,0x222f22a79ca5a400,0x230e9a3ea3f69e1f,0xa396a072213f2335,0xa1e41f5823d3132d,0x23fe1a3ea341a0fd,0x205aa17fa2f21c6e
.quad 0xa3e8a1d0164622c6,0x225323bf1e549fbd,0x240020cf9ca5a38d,0xa275a39f9d1220a1,0xa3f09f581f8b23f3,0x229723791b8fa155,0x23b81cdca113a3f3,0xa2b7a34d98eb21f7
.quad 0xa3599879222f238d,0x22d5231c147ca286,0x22d58f2ea30ea2c6,0xa2f2a2e40b2e2300,0xa22f1a3e23a821a8,0x230e22a79646a364,0x216a9db5a3f6a042,0xa329a26419cd23b0
.quad 0xa08a201123f61d49,0x2341221d9c37a3e3,0x1f25a129a3a8972a,0xa359a1d01d7f23fd,0x9d12221d230e972a,0x236f217f9ebda3fd,0x19cda2e4a22f1d49,0xa383a1291fef23e3
.quad 0x916223792113a042,0x239620cfa08aa3b0,0x9646a3d99f8b21a8,0xa3a8a07221132364,0x1b8f23ff1ca5a2c6,0x23b82011a194a300,0x9deaa3ec9646238d,0xa3c69f58220a2286
.quad 0x9e54a3bfa2530000,0x964621d023e81fbd,0x1d12239f22758000,0x1ca5a0cfa400a0a1,0x9b8fa379a2970000,0x9f8b1f5823f02155,0x18eb234d22b78000,0x21139cdca3b8a1f7
.quad 0x947ca31ca2d50000,0xa22f187923592286,0x8b2e22e422f28000,0x230e0f2ea2d5a300,0x1646a2a7a30e0000,0xa3a89a3e222f2364,0x99cd226423298000,0x23f61db5a16aa3b0
.quad 0x1c37a21da3410000,0xa3f6a011208a23e3,0x9d7f21d023598000,0x23a821299f25a3fd,0x1ebda17fa36f0000,0xa30ea21d1d1223fd,0x9fef212923838000,0x222f22e499cda3e3
.quad 0x208aa0cfa3960000,0xa113a379116223b0,0xa113207223a88000,0x1f8b23d91646a364,0x2194a011a3b80000,0x9ca5a3ff9b8f2300,0xa20a1f5823c68000,0x164623ec1deaa286
.quad 0x208a9cdca383a2c6,0xa3299a3e213f23fd,0xa2530f2e2297238d,0x23fe20729d7fa3b0,0x23831bfea13fa3f3,0xa36fa2a78b2e2286,0xa3fea0111f2523f3,0x219423d91deaa0a1
.quad 0x23b821d09aafa38d,0x9d7fa3d9a16a1c6e,0xa2b7a31c916222c6,0x947c22a72329132d,0x211323d91ca5a1a8,0x1f8ba072a3f69e1f,0x9deaa3f9a0292042,0xa2531a3e23b82155
.quad 0x147c237921bc9d49,0x23c61a3ea275a300,0x1b8fa264a2f2172a,0xa3dea072205a23e3,0xa02920cf23b8172a,0x229722a79aafa3e3,0x220a9db5a4009d49,0xa029a3d998eb2300
.quad 0xa359156123c62042,0x180723d91fefa155,0x23f61a3ea30ea1a8,0x1ca5a2a7a22f1e1f,0xa3d39f5821e422c6,0xa13f20722396932d,0x22f2217fa05aa38d,0x23419a3ea3fe9c6e
.quad 0x23fe21299aafa335,0xa2d5a3799ca520a1,0xa2b7a3799c3720fd,0x1dea23bf222f932d,0x1f2523ec216a9b1f,0x1c37a129a3f69fbd,0x147ca264a3839b1f,0xa2531561230e2300
.quad 0xa08a1e8923f020fd,0x240020119f8ba3fd,0x23411561a297a335,0xa275a34d96462286,0xa3f6a0721f8b2400,0x1ca523d921139e1f,0x2275231c8b2ea335,0x1d7fa17fa3a8995c
.quad 0x9e54a3ff9f2520fd,0xa2b7187923a82155,0x980722e422759b1f,0x23fb1f58a113a3b0,0x20e6a011a3e89b1f,0xa20aa31c164623b0,0xa36f0f2e239620fd,0x1aaf23ec1f8ba155
.quad 0x23e81f58a194a335,0x1ebda1d0a30e195c,0xa22fa2a71ca52400,0xa30e1a3e23f61e1f,0x1d7f23f919cda335,0x23e81e89a22fa286,0x19cda34da0e620fd,0xa194a2e41ca523fd
.quad 0x1fef23ec21bc972a,0x8b2ea264a3b89e1f,0x1b8fa129a3fba042,0xa20a156122d52364,0xa2b78f2e2275238d,0x23e8217f9aafa364,0x23de217f9b8fa38d,0xa029a3ffa08a1e1f
.quad 0xa0b8a3f99f252042,0x9d12212923e81e1f,0x980722642359172a,0x236f1879a253a364,0x222f9a3ea3a8a1a8,0xa30ea2a716462364,0xa3fba011205a23f3,0x1aaf23bf213f9e1f
.quad 0x216a239f1807a2c6,0x20e69f58a3fe9e1f,0xb2ea34da1e41d49,0xa3fe9db521bc2364,0xa1941e8923fe1d49,0x216a23790b2ea364,0x23fe1cdca253a2c6,0x1807a31ca1e41e1f
.quad 0xa20aa2e41aaf23f3,0xa2b71bfe23fb1e1f,0x164623d91f8ba1a8,0x23a82072a113a364,0x20e6a0cfa36f172a,0x9e54a3ec98072364,0xa3e8956123962042,0x9f25221d22759e1f
.quad 0x9f8b1e8923c62241,0x22b71561a1e4a3e3,0x23f620119e54a3cd,0xa2f2a34d9aaf2155,0xa113a3f99fef1ef1,0x9162226423961c6e,0x9ca5212923f01ef1,0x23411879a20aa3b0
.quad 0x23a81bfea194a3cd,0xa253a37999cd21f7,0xa22fa37998eb2241,0x99cd221d2383195c,0x964622a7230e8000,0x23a81a3ea22fa364,0x230e8f2ea341a241,0xa194a39f98eb2286
.quad 0xa30ea2641aaf23cd,0x9d1221d0236f132d,0x1646239f213f9ef1,0x23e81bfea253a300,0x222f9cdca3fb9ef1,0xa0b8a3bf98072300,0xa3a8a0cf205a23cd,0x9f25217f2359932d
.quad 0x1ca523ff1d7fa241,0x24001cdca275a286,0x2113a072a3a80000,0x9f8ba3d996462364,0xa3f69db522752241,0xa08a21292341995c,0x1f8b23bf8b2ea3cd,0x23f01db5a297a1f7
.quad 0xa3fba0721d12238d,0x2341231c19cda155,0x1ebd23d921e4972a,0x19cda17fa3f09fbd,0x21949a3ea359a2c6,0xa3fba0111ebd23e3,0xa359a2a70b2e22c6,0x1d1223bf21e4995c
.quad 0x916222a72341172a,0x22b78f2ea2f2a300,0x23961a3ea20aa38d,0xa1e4a39f9aaf21f7,0xa113a3d99ca521a8,0x9f8b207223f61e1f,0x9fef207223f01d49,0x23c621299e54a3fd
.quad 0x23e82072a029a3f3,0x8b2ea34da20a1c6e,0x9aafa3d9a08a2042,0xa3b8987922d52286,0xa2b71a3e23de2042,0x1fef23ec1b8fa286,0x227522a79b8fa3f3,0x21bc9e89a3fb9c6e
.quad 0x1c37a2a7a2531d49,0xa2d5a21d1dea23fd,0xa3f69a3e230e21a8,0x9ca522a7222f9e1f,0x1f2523d9147ca38d,0x23fe1cdca2b7a1f7,0x216aa072a383172a,0x9aafa3ff9c372300
.quad 0xa0b8a3ffa1131b1f,0x180722e4236f1c6e,0xa1bc1879230e2335,0x23e81f589f25a3e3,0x2253239f1ca5a0fd,0x99cda34da2d5932d,0x1fef9f58a3f6a0fd,0xa3d39db520b823fd
.quad 0xa36fa26416462335,0x1b8f239f220a995c,0x9b8f21d023a81b1f,0x23b81bfea1bca3b0,0x23f620729f8ba400,0x9ca5a3d9a1131e1f,0x9162a34da22f1b1f,0xa396987922972300
.quad 0xa3de9bfe222f2335,0x1d7f23f91fefa0a1,0x1d1223f91f8ba0fd,0x236f0f2ea341a1f7,0x23299561a3a8a0fd,0x9e54a3ff9d7f21f7,0xa08aa3bf96462335,0xa341156123b820a1
.quad 0xa1e41e8923f61b1f,0x1f2523ec19cda300,0x222f22a79ca5a400,0x230e9a3ea3f69e1f,0x2029a17fa30e1b1f,0x9fefa3bf8b2e23b0,0xa359a0cf21132335,0xa2d51cdc23fb195c
.quad 0x1deaa011a3f0a1a8,0xa22f0f2e227523b0,0xa329a31c98eb21a8,0x1f8b23ec2194995c,0xa0291e8923de21a8,0x23a81cdca0e6a3fd,0x227523791aafa1a8,0x9646a31ca2f2932d
.quad 0x213f9cdca3c6a1a8,0xa3f6a0cf1dea23e3,0xa194a3bf9c3721a8,0x9ca5217f23c61c6e,0xa22f1a3e23a821a8,0x230e22a79646a364,0x208a23ec1d12a1a8,0x21139e89a3fe9fbd
.quad 0x22f29561a383a1a8,0xa113a3bf99cd2286,0x9ebda3ff9dea21a8,0xa30e156123962155,0xa3838f2e235921a8,0x1ca523f91f25a155,0x1c3723f91ebda1a8,0x23f61bfea297a286
.quad 0x23de1879a329a1a8,0x1646a34da16a1fbd,0x9646a3d99f8b21a8,0xa3a8a07221132364,0xa4009bfe22f221a8,0x9f8b21d022d59c6e,0x947c239f2029a1a8,0x222f22649e54a3e3
.quad 0x23de1f589ebda3cd,0xa396a2a7947c21f7,0x1807a1d0a3de9ef1,0xa16a1a3e23412300,0xa341a2e4947c2241,0x1e5423d921bc995c,0xa16a1bfe23962241,0x240020729e54a3e3
.quad 0x1fef23ff205a9ef1,0x1ebda072a3fe9fbd,0x23d31cdca16aa3cd,0xa13fa3d99d122155,0x1646a2a7a30e0000,0xa3a89a3e222f2364,0xa359a21d1b8f23cd,0x980722a722f2932d
.quad 0xa13f1e8924001ef1,0x22d522a798eba3b0,0x202923ec1c37a241,0x22979a3ea3d3a0a1,0x23c61879a2f2a241,0x99cda3d9a05a20a1,0x147ca34da1941ef1,0xa3c6a07220b823b0
.quad 0xa36fa129202923cd,0xa0e6207223b8132d,0xa113207223a88000,0x1f8b23d91646a364,0x205a239f9162a3cd,0x23fb1a3ea329a155,0x23b88f2ea3d39ef1,0x1d7fa2a7a1e41fbd
.quad 0x216a23f9205a9d49,0x9b8fa34da30e995c,0x23d31e899fefa3f3,0xa359a2e4964621f7,0x1d12a0cfa3fea042,0xa2f29561222f23b0,0xa13fa3ec9ebd2042,0x9807221d23a81c6e
.quad 0xa3de9db520e623f3,0x21bc23bf1ca5a155,0x9d7f212923de1d49,0x23e81db5a113a3e3,0x211323d91ca5a1a8,0x1f8ba072a3f69e1f,0x23e81cdca1bca38d,0x9ebda3ff9f8b20a1
.quad 0x1deaa17fa396972a,0xa3d3a0cf1f8b23fd,0xa0e6a3bf98eb22c6,0xa20a1cdc23f61fbd,0xa3f09bfe227522c6,0x147c239f21139fbd,0x9e5421d02329972a,0x22b722649ca5a3fd
.quad 0x20b8239f0b2ea38d,0x23838f2ea3a8a0a1,0x23f61a3ea30ea1a8,0x1ca5a2a7a22f1e1f,0x1ebda21da2971d49,0xa0b8a379164623e3,0xa08aa379180723f3,0xa4009bfe230e2155
.quad 0x9c3720cf240020fd,0x21949879a2f2a364,0x202923f9213f9b1f,0x147ca21da3c69e1f,0x23d321d098eba335,0xa0b8a3ffa05a1e1f,0x22978f2ea2d5a335,0xa3c6a1d019cd2364
.quad 0x18eba21da3969b1f,0xa329956122752364,0xa0e6a3ec9dea20fd,0x9e5420cf23f01e1f,0xa3f6a0721f8b2400,0x1ca523d921139e1f,0xa20a1bfe23d320fd,0x22b722e4947ca364
.quad 0x9162231c22539b1f,0x23f01cdca1e4a364,0x219423791162a335,0x216a9e89a4009e1f,0x24001db5a1e4a335,0x1162a34da1bc1e1f,0x216a9f58a3f09b1f,0xa0e6a39f91622364
.quad 0x947ca3bfa05a20fd,0xa3d3a011213f2364,0xa22fa2a71ca52400,0xa30e1a3e23f61e1f,0xa3f09879235920fd,0x9dea226422539e1f,0xa0b8212923299b1f,0x1d1223f918eba364
.quad 0xa3a89db5202923f3,0x23d3221d9162a286,0xa1131bfe236f22c6,0x23b81db5a05aa3fd,0x9646221d23b81d49,0x21e49879a329a300,0x1f8b23f920e69d49,0x1d7fa0cfa3fb9fbd
.quad 0x230e22e40b2ea2c6,0x9807a34da297132d,0x23f61e89a0b8a3f3,0xa08aa3f99ebd20a1,0x222f9a3ea3a8a1a8,0xa30ea2a716462364,0x1ca5a1d0a383972a,0xa4009f5820b823e3
.quad 0x9ca5a3eca05a2042,0xa3290f2e235921f7,0xa22fa31c147c238d,0xa0b8201123f01c6e,0xa3f69f58213f238d,0x98eb22e422539c6e,0xa30e187923d32042,0x1d1223ff1deaa1f7
.quad 0x9f8b217f2341972a,0x21bc231c98eba3e3,0x164623d91f8ba1a8,0x23a82072a113a364,0x2113234d98eba3f3,0x23de1561a383a0a1,0x23a82011a1bca2c6,0x22539e89a3de932d
.quad 0xa20aa3d99f251ef1,0x1d7f239f2297132d,0xa383a2a791622241,0x208a23ff20e69c6e,0xa400a0721dea23cd,0x220a23bf1d7fa0a1,0xa36f9a3e21bc23cd,0x232922e41162a286
.quad 0xa1e41a3e23832241,0x23d3217f9c37a3b0,0x9f25207223fb1ef1,0x23fe1f58a05aa3fd,0x964622a7230e8000,0x23a81a3ea22fa364,0x1c3723d920e69ef1,0x22d59561a36fa1f7
.quad 0x20b823d91b8fa241,0x21949db5a3fb9fbd,0x22b722a799cda3cd,0x1fefa0cfa3c6995c,0x23d32072a08aa3cd,0x1c37a264a2d5195c,0x23e81a3ea2d5a241,0xb2ea379a13f1fbd
.quad 0x22f29a3ea3f09ef1,0x9b8fa3f99e5421f7,0x2113a072a3a80000,0x9f8ba3d996462364,0x1d12a2a7a20a1ef1,0xa16aa31c1aaf23fd,0x9162a3d99ebd2241,0xa2b7a1d01fef23b0
.quad 0x18eba17fa3f6a042,0xa0e61bfe23592300,0xb2ea264a3a89d49,0xa0b81cdc23962286,0x9807a31ca30e972a,0xa08a1db523c621f7,0x9c37a39fa22f172a,0xa05a1e8923e82155
.quad 0x9e54a3eca1131d49,0xa0291f5823fb20a1,0xa029a3ff9f8b2042,0x9fef201124001fbd,0xa113a3d99ca521a8,0x9f8b207223f61e1f,0xa1e4a379964622c6,0x9f2520cf23de1c6e
.quad 0xa297a2e41646238d,0x9ebd212923b8195c,0xa329a21d1ca523f3,0x9e54217f2383132d,0xa396a1291f8b23f3,0x9dea21d02341932d,0xa3dea0112113238d,0x9d7f221d22f2995c
.quad 0xa3fe9db5222f22c6,0x9d12226422979c6e,0xa3f69a3e230e21a8,0x9ca522a7222f9e1f,0xa3c68f2e23a82042,0x9c3722e421bc9fbd,0xa36f187923f61d49,0x9b8f231c213fa0a1
.quad 0x9e54a3bfa2538000,0x964621d023e81fbd,0x9d12a39fa2758000,0x9ca520cf240020a1,0x9b8fa379a2978000,0x9f8b1f5823f02155,0x98eba34da2b78000,0xa1131cdc23b821f7
.quad 0x947ca31ca2d58000,0xa22f187923592286,0xb2ea2e4a2f28000,0xa30e8f2e22d52300,0x1646a2a7a30e8000,0xa3a89a3e222f2364,0x19cda264a3298000,0xa3f69db5216a23b0
.quad 0x1c37a21da3418000,0xa3f6a011208a23e3,0x1d7fa1d0a3598000,0xa3a8a1291f2523fd,0x1ebda17fa36f8000,0xa30ea21d1d1223fd,0x1fefa129a3838000,0xa22fa2e419cd23e3
.quad 0x208aa0cfa3968000,0xa113a379116223b0,0x2113a072a3a88000,0x9f8ba3d996462364,0x2194a011a3b88000,0x9ca5a3ff9b8f2300,0x220a9f58a3c68000,0x9646a3ec9dea2286
.quad 0x208a9cdca383a2c6,0xa3299a3e213f23fd,0x22538f2ea297a38d,0xa3fea0721d7f23b0,0x23831bfea13fa3f3,0xa36fa2a78b2e2286,0x23fe20119f25a3f3,0xa194a3d99dea20a1
.quad 0x23b821d09aafa38d,0x9d7fa3d9a16a1c6e,0x22b7231c1162a2c6,0x147ca2a7a329932d,0x211323d91ca5a1a8,0x1f8ba072a3f69e1f,0x1dea23f92029a042,0x22539a3ea3b8a155
.quad 0x147c237921bc9d49,0x23c61a3ea275a300,0x9b8f226422f2972a,0x23de2072a05aa3e3,0xa02920cf23b8172a,0x229722a79aafa3e3,0xa20a1db524001d49,0x202923d918eba300
.quad 0xa359156123c62042,0x180723d91fefa155,0xa3f69a3e230e21a8,0x9ca522a7222f9e1f,0xa3d39f5821e422c6,0xa13f20722396932d,0xa2f2a17f205a238d,0xa3411a3e23fe1c6e
.quad 0x23fe21299aafa335,0xa2d5a3799ca520a1,0x22b723791c37a0fd,0x9deaa3bfa22f132d,0x1f2523ec216a9b1f,0x1c37a129a3f69fbd,0x947c226423831b1f,0x22539561a30ea300
.quad 0xa08a1e8923f020fd,0x240020119f8ba3fd,0xa341956122972335,0x2275234d1646a286,0xa3f6a0721f8b2400,0x1ca523d921139e1f,0xa275a31c0b2e2335,0x9d7f217f23a8195c
.quad 0x9e54a3ff9f2520fd,0xa2b7187923a82155,0x1807a2e4a2751b1f,0xa3fb9f58211323b0,0x20e6a011a3e89b1f,0xa20aa31c164623b0,0x236f8f2ea396a0fd,0x9aafa3ec9f8b2155
.quad 0x23e81f58a194a335,0x1ebda1d0a30e195c,0x222f22a79ca5a400,0x230e9a3ea3f69e1f,0x1d7f23f919cda335,0x23e81e89a22fa286,0x99cd234d20e6a0fd,0x219422e49ca5a3fd
.quad 0x1fef23ec21bc972a,0x8b2ea264a3b89e1f,0x9b8f212923fb2042,0x220a9561a2d5a364,0xa2b78f2e2275238d,0x23e8217f9aafa364,0xa3dea17f1b8f238d,0x202923ff208a9e1f
.quad 0xa0b8a3f99f252042,0x9d12212923e81e1f,0x1807a264a359972a,0xa36f987922532364,0x222f9a3ea3a8a1a8,0xa30ea2a716462364,0x23fb2011a05aa3f3,0x9aafa3bfa13f1e1f
.quad 0x216a239f1807a2c6,0x20e69f58a3fe9e1f,0x8b2e234d21e49d49,0x23fe1db5a1bca364,0xa1941e8923fe1d49,0x216a23790b2ea364,0xa3fe9cdc225322c6,0x9807231c21e49e1f
.quad 0xa20aa2e41aaf23f3,0xa2b71bfe23fb1e1f,0x9646a3d99f8b21a8,0xa3a8a07221132364,0x20e6a0cfa36f172a,0x9e54a3ec98072364,0x23e81561a396a042,0x1f25a21da2751e1f
.quad 0x9f8b1e8923c62241,0x22b71561a1e4a3e3,0xa3f6a0111e5423cd,0x22f2234d1aafa155,0xa113a3f99fef1ef1,0x9162226423961c6e,0x1ca5a129a3f09ef1,0xa3419879220a23b0
.quad 0x23a81bfea194a3cd,0xa253a37999cd21f7,0x222f237918eba241,0x19cda21da383995c,0x964622a7230e8000,0x23a81a3ea22fa364,0xa30e0f2e23412241,0x2194239f18eba286
.quad 0xa30ea2641aaf23cd,0x9d1221d0236f132d,0x9646a39fa13f1ef1,0xa3e89bfe22532300,0x222f9cdca3fb9ef1,0xa0b8a3bf98072300,0x23a820cfa05aa3cd,0x1f25a17fa359132d
.quad 0x1ca523ff1d7fa241,0x24001cdca275a286,0xa113207223a88000,0x1f8b23d91646a364,0xa3f69db522752241,0xa08a21292341995c,0x9f8ba3bf0b2e23cd,0xa3f09db5229721f7
.quad 0xa3fba0721d12238d,0x2341231c19cda155,0x9ebda3d9a1e4172a,0x99cd217f23f01fbd,0x21949a3ea359a2c6,0xa3fba0111ebd23e3,0x235922a78b2ea2c6,0x9d12a3bfa1e4195c
.quad 0x916222a72341172a,0x22b78f2ea2f2a300,0xa3969a3e220a238d,0x21e4239f1aafa1f7,0xa113a3d99ca521a8,0x9f8b207223f61e1f,0x1fefa072a3f09d49,0xa3c6a1291e5423fd
.quad 0x23e82072a029a3f3,0x8b2ea34da20a1c6e,0x1aaf23d9208aa042,0x23b81879a2d5a286,0xa2b71a3e23de2042,0x1fef23ec1b8fa286,0xa275a2a71b8f23f3,0xa1bc1e8923fb1c6e
.quad 0x1c37a2a7a2531d49,0xa2d5a21d1dea23fd,0x23f61a3ea30ea1a8,0x1ca5a2a7a22f1e1f,0x1f2523d9147ca38d,0x23fe1cdca2b7a1f7,0xa16a20722383972a,0x1aaf23ff1c37a300
.quad 0xa0b8a3ffa1131b1f,0x180722e4236f1c6e,0x21bc9879a30ea335,0xa3e89f581f2523e3,0x2253239f1ca5a0fd,0x99cda34da2d5932d,0x9fef1f5823f620fd,0x23d31db5a0b8a3fd
.quad 0xa36fa26416462335,0x1b8f239f220a995c,0x1b8fa1d0a3a89b1f,0xa3b89bfe21bc23b0,0x23f620729f8ba400,0x9ca5a3d9a1131e1f,0x1162234d222f9b1f,0x23961879a297a300
.quad 0xa3de9bfe222f2335,0x1d7f23f91fefa0a1,0x9d12a3f99f8b20fd,0xa36f8f2e234121f7,0x23299561a3a8a0fd,0x9e54a3ff9d7f21f7,0x208a23bf1646a335,0x23419561a3b8a0a1
.quad 0xa1e41e8923f61b1f,0x1f2523ec19cda300,0xa22fa2a71ca52400,0xa30e1a3e23f61e1f,0x2029a17fa30e1b1f,0x9fefa3bf8b2e23b0,0x235920cfa113a335,0x22d59cdca3fb995c
.quad 0x1deaa011a3f0a1a8,0xa22f0f2e227523b0,0x2329231c18eba1a8,0x9f8ba3eca194195c,0xa0291e8923de21a8,0x23a81cdca0e6a3fd,0xa275a3799aaf21a8,0x1646231c22f2132d
.quad 0x213f9cdca3c6a1a8,0xa3f6a0cf1dea23e3,0x219423bf1c37a1a8,0x1ca5a17fa3c69c6e,0xa22f1a3e23a821a8,0x230e22a79646a364,0xa08aa3ec9d1221a8,0xa1131e8923fe1fbd
.quad 0x22f29561a383a1a8,0xa113a3bf99cd2286,0x1ebd23ff1deaa1a8,0x230e9561a396a155,0xa3838f2e235921a8,0x1ca523f91f25a155,0x9c37a3f99ebd21a8,0xa3f69bfe22972286
.quad 0x23de1879a329a1a8,0x1646a34da16a1fbd,0x164623d91f8ba1a8,0x23a82072a113a364,0xa4009bfe22f221a8,0x9f8b21d022d59c6e,0x147ca39fa02921a8,0xa22fa2641e5423e3
.quad 0x23de1f589ebda3cd,0xa396a2a7947c21f7,0x980721d023de1ef1,0x216a9a3ea341a300,0xa341a2e4947c2241,0x1e5423d921bc995c,0x216a9bfea396a241,0xa400a0721e5423e3
.quad 0x1fef23ff205a9ef1,0x1ebda072a3fe9fbd,0xa3d39cdc216a23cd,0x213f23d91d12a155,0x1646a2a7a30e8000,0xa3a89a3e222f2364,0x2359221d9b8fa3cd,0x1807a2a7a2f2132d
.quad 0xa13f1e8924001ef1,0x22d522a798eba3b0,0xa029a3ec9c372241,0xa2971a3e23d320a1,0x23c61879a2f2a241,0x99cda3d9a05a20a1,0x947c234d21949ef1,0x23c62072a0b8a3b0
.quad 0xa36fa129202923cd,0xa0e6207223b8132d,0x2113a072a3a88000,0x9f8ba3d996462364,0x205a239f9162a3cd,0x23fb1a3ea329a155,0xa3b80f2e23d31ef1,0x9d7f22a721e49fbd
.quad 0x216a23f9205a9d49,0x9b8fa34da30e995c,0xa3d39e891fef23f3,0x235922e41646a1f7,0x1d12a0cfa3fea042,0xa2f29561222f23b0,0x213f23ec1ebda042,0x1807a21da3a89c6e
.quad 0xa3de9db520e623f3,0x21bc23bf1ca5a155,0x1d7fa129a3de9d49,0xa3e89db5211323e3,0x211323d91ca5a1a8,0x1f8ba072a3f69e1f,0xa3e89cdc21bc238d,0x1ebd23ff1f8ba0a1
.quad 0x1deaa17fa396972a,0xa3d3a0cf1f8b23fd,0x20e623bf18eba2c6,0x220a9cdca3f69fbd,0xa3f09bfe227522c6,0x147c239f21139fbd,0x1e54a1d0a329172a,0xa2b7a2641ca523fd
.quad 0x20b8239f0b2ea38d,0x23838f2ea3a8a0a1,0xa3f69a3e230e21a8,0x9ca522a7222f9e1f,0x1ebda21da2971d49,0xa0b8a379164623e3,0x208a23799807a3f3,0x24001bfea30ea155
.quad 0x9c3720cf240020fd,0x21949879a2f2a364,0xa029a3f9a13f1b1f,0x947c221d23c61e1f,0x23d321d098eba335,0xa0b8a3ffa05a1e1f,0xa2970f2e22d52335,0x23c621d099cda364
.quad 0x18eba21da3969b1f,0xa329956122752364,0x20e623ec1deaa0fd,0x1e54a0cfa3f09e1f,0xa3f6a0721f8b2400,0x1ca523d921139e1f,0x220a9bfea3d3a0fd,0xa2b7a2e4147c2364
.quad 0x9162231c22539b1f,0x23f01cdca1e4a364,0xa194a37991622335,0xa16a1e8924001e1f,0x24001db5a1e4a335,0x1162a34da1bc1e1f,0xa16a1f5823f01b1f,0x20e6239f1162a364
.quad 0x947ca3bfa05a20fd,0xa3d3a011213f2364,0x222f22a79ca5a400,0x230e9a3ea3f69e1f,0xa3f09879235920fd,0x9dea226422539e1f,0x20b8a129a3291b1f,0x9d12a3f998eb2364
.quad 0xa3a89db5202923f3,0x23d3221d9162a286,0x21139bfea36fa2c6,0xa3b89db5205a23fd,0x9646221d23b81d49,0x21e49879a329a300,0x9f8ba3f9a0e61d49,0x9d7f20cf23fb1fbd
.quad 0x230e22e40b2ea2c6,0x9807a34da297132d,0xa3f69e8920b823f3,0x208a23f91ebda0a1,0x222f9a3ea3a8a1a8,0xa30ea2a716462364,0x9ca521d02383172a,0x24001f58a0b8a3e3
.quad 0x9ca5a3eca05a2042,0xa3290f2e235921f7,0x222f231c947ca38d,0x20b8a011a3f09c6e,0xa3f69f58213f238d,0x98eb22e422539c6e,0x230e9879a3d3a042,0x9d12a3ff9dea21f7
.quad 0x9f8b217f2341972a,0x21bc231c98eba3e3,0x9646a3d99f8b21a8,0xa3a8a07221132364,0x2113234d98eba3f3,0x23de1561a383a0a1,0xa3a8a01121bc22c6,0xa2531e8923de132d
.quad 0xa20aa3d99f251ef1,0x1d7f239f2297132d,0x238322a71162a241,0xa08aa3ffa0e61c6e,0xa400a0721dea23cd,0x220a23bf1d7fa0a1,0x236f1a3ea1bca3cd,0xa329a2e491622286
.quad 0xa1e41a3e23832241,0x23d3217f9c37a3b0,0x1f25a072a3fb9ef1,0xa3fe9f58205a23fd,0x964622a7230e8000,0x23a81a3ea22fa364,0x9c37a3d9a0e61ef1,0xa2d51561236f21f7
.quad 0x20b823d91b8fa241,0x21949db5a3fb9fbd,0xa2b7a2a719cd23cd,0x9fef20cf23c6195c,0x23d32072a08aa3cd,0x1c37a264a2d5195c,0xa3e89a3e22d52241,0x8b2e2379213f9fbd
.quad 0x22f29a3ea3f09ef1,0x9b8fa3f99e5421f7,0xa113207223a88000,0x1f8b23d91646a364,0x1d12a2a7a20a1ef1,0xa16aa31c1aaf23fd,0x116223d91ebda241,0x22b721d09fefa3b0
.quad 0x18eba17fa3f6a042,0xa0e61bfe23592300,0x8b2e226423a81d49,0x20b89cdca396a286,0x9807a31ca30e972a,0xa08a1db523c621f7,0x1c37239f222f972a,0x205a9e89a3e8a155
.quad 0x9e54a3eca1131d49,0xa0291f5823fb20a1,0x202923ff1f8ba042,0x1fefa011a4009fbd,0xa113a3d99ca521a8,0x9f8b207223f61e1f,0x21e423791646a2c6,0x1f25a0cfa3de9c6e
.quad 0xa297a2e41646238d,0x9ebd212923b8195c,0x2329221d9ca5a3f3,0x1e54a17fa383932d,0xa396a1291f8b23f3,0x9dea21d02341932d,0x23de2011a113a38d,0x1d7fa21da2f2195c
.quad 0xa3fe9db5222f22c6,0x9d12226422979c6e,0x23f61a3ea30ea1a8,0x1ca5a2a7a22f1e1f,0xa3c68f2e23a82042,0x9c3722e421bc9fbd,0x236f9879a3f69d49,0x1b8fa31ca13f20a1
.quad 0x23591bfea0e6a400,0xa3f6a17f18eb2300,0xa3969cdc20b82400,0x23a822648b2ea286,0x23c61db5a08aa400,0xa30ea31c980721f7,0xa3e89e89205a2400,0x222f239f1c37a155
.quad 0x23fb1f58a029a400,0xa113a3ec9e5420a1,0xa400a0111fef2400,0x1f8b23ff20299fbd,0x23f620729f8ba400,0x9ca5a3d9a1131e1f,0xa3dea0cf1f252400,0x1646237921e49c6e
.quad 0x23b821299ebda400,0x1646a2e4a297195c,0xa383a17f1e542400,0x9ca5221d2329932d,0x234121d09deaa400,0x1f8ba129a396932d,0xa2f2a21d1d7f2400,0xa113201123de195c
.quad 0x229722649d12a400,0x222f9db5a3fe9c6e,0xa22fa2a71ca52400,0xa30e1a3e23f61e1f,0x21bc22e49c37a400,0x23a88f2ea3c69fbd,0xa13fa31c1b8f2400,0xa3f69879236f20a1
.quad 0x2297239f1d7fa042,0x9f25a3d9a20a132d,0xa0e6a3ffa08a1d49,0x116222a723831c6e,0x1d7f23bf220a972a,0x1deaa072a400a0a1,0x9162a2e4a329972a,0xa1bc1a3e236f2286
.quad 0x9c37217f23d31d49,0x23831a3ea1e4a3b0,0x205a9f58a3fea042,0xa3fba0721f2523fd,0xa22f1a3e23a821a8,0x230e22a79646a364,0x236f1561a2d5a2c6,0xa0e6a3d99c3721f7
.quad 0xa3fb9db52194238d,0x1b8f23d920b89fbd,0x23c620cf9fefa3f3,0x19cda2a7a2b7195c,0xa2d5a2641c3723f3,0xa08a207223d3195c,0x213f23798b2ea38d,0x22d59a3ea3e89fbd
.quad 0x9e54a3f99b8f22c6,0xa3f09a3e22f221f7,0x164623d91f8ba1a8,0x23a82072a113a364,0x1aafa31ca16a2042,0xa20aa2a71d1223fd,0x9fef21d022b79d49,0x1ebd23d91162a3b0
.quad 0x9162221d23d31ef1,0x20299db5a3a8a286,0x205a9db5a3b8a241,0xa36f9bfe211323fd,0xa329987921e423cd,0x23b8221d9646a300,0x23fb20cf9d7fa3cd,0xa0e6a3f99f8b1fbd
.quad 0xa297a34d98072241,0xb2e22e4230e132d,0x1ebd23f9208a9ef1,0x20b89e89a3f6a0a1,0x1646a2a7a30e8000,0xa3a89a3e222f2364,0xa0b81f5824001ef1,0x238321d09ca5a3e3
.quad 0x23590f2ea329a241,0xa05aa3ec9ca521f7,0xa3f0a01120b823cd,0x947c231c222f9c6e,0x225322e498eba3cd,0x213f9f58a3f69c6e,0x9deaa3ff9d122241,0xa3d39879230e21f7
.quad 0x98eb231c21bc9ef1,0x2341217f9f8ba3e3,0x2113a072a3a88000,0x9f8ba3d996462364,0xa383156123de1ef1,0x98eb234d2113a0a1,0x23de1e89a253a241,0x21bca011a3a8132d
.quad 0xa2f29879219423f3,0x240020cf9c37a364,0x23c6221d947ca2c6,0xa13fa3f9a0291e1f,0xa05aa3ffa0b81d49,0x98eb21d023d31e1f,0x99cd21d023c61d49,0x22d50f2ea297a364
.quad 0x22759561a329a2c6,0xa396a21d18eb2364,0xa3f0a0cf1e5423f3,0x1dea23ec20e69e1f,0x211323d91ca5a1a8,0x1f8ba072a3f69e1f,0x147ca2e4a2b7172a,0xa3d39bfe220a2364
.quad 0xa1e41cdc23f02042,0x2253231c9162a364,0x24001e89a16aa38d,0x9162a379a1941e1f,0xa1bca34d1162238d,0xa1e41db524001e1f,0x1162239f20e6a042,0x23f01f58a16aa364
.quad 0x213fa011a3d3972a,0xa05aa3bf947c2364,0xa3f69a3e230e21a8,0x9ca522a7222f9e1f,0x225322649deaa3f3,0x23599879a3f09e1f,0x98eba3f99d1222c6,0xa329a12920b82364
.quad 0xa30ea34d9b8f20fd,0x205a23f9216a995c,0x164622e423591b1f,0x1fef9e89a3d3a1f7,0x222f9561a2f2a335,0xa3fea0cf1d1223b0,0xa3a8a21d18072335,0x1ebd23ec213f9c6e
.quad 0x1ca523bf21bc9b1f,0x20e69db5a3dea155,0x21139db5a3e8a0fd,0xa3dea1291d7f23e3,0xa3f6a0721f8b2400,0x1ca523d921139e1f,0x1f8b23ff1ebda0fd,0x21bc9cdca3e8a0a1
.quad 0x1f8ba0cfa3d39b1f,0xa396a17f1dea23fd,0xa3f69cdc220a2335,0x18eb23bf20e69fbd,0x2113239f147ca335,0x22759bfea3f09fbd,0x1ca5a264a2b71b1f,0xa329a1d01e5423fd
.quad 0xa3a88f2e238320fd,0xb2e239f20b8a0a1,0x222f22a79ca5a400,0x230e9a3ea3f69e1f,0x1646a379a0b820fd,0xa297a21d1ebd23e3,0xa30e1bfe24001b1f,0x98072379208aa155
.quad 0x947ca2a7a3969d49,0x9ebd1f5823de21f7,0xa3419a3e216a23f3,0x23de21d09807a300,0x21bc23d91e54a042,0x947ca2e4a341995c,0x1e54a072a400a042,0xa3969bfe216a23e3
.quad 0xa3fea0721ebd23f3,0x205a23ff1fef9fbd,0x1d1223d9213f9d49,0x216a9cdca3d3a155,0x222f9a3ea3a8a1a8,0xa30ea2a716462364,0xa2f2a2a71807238d,0x9b8f221d2359132d
.quad 0x98eb22a722d5972a,0x24001e89a13fa3b0,0x23d31a3ea297a2c6,0x9c37a3eca02920a1,0xa05aa3d999cd22c6,0xa2f2187923c620a1,0xa0b8207223c6172a,0x2194234d947ca3b0
.quad 0x23b82072a0e6a38d,0x2029a129a36f132d,0x9646a3d99f8b21a8,0xa3a8a07221132364,0xa3291a3e23fb1d49,0x9162239f205aa155,0x21e422a79d7fa3f3,0x23d30f2ea3b89fbd
.quad 0x22750f2ea22fa3cd,0xa3f0a0111dea23b0,0xa194a3ec9f8b1ef1,0x18eb231c2329195c,0xa0e61cdc23a82241,0x23de1e89a029a3fd,0x22f2231c1646a241,0x9aafa379a275132d
.quad 0x1deaa0cfa3f69ef1,0xa3c69cdc213f23e3,0xa3c6a17f1ca523cd,0x1c3723bf21949c6e,0x964622a7230e8000,0x23a81a3ea22fa364,0x23fe1e89a113a3cd,0x9d12a3eca08a1fbd
.quad 0x99cda3bfa1131ef1,0xa383956122f22286,0xa3969561230e2241,0x1dea23ff1ebda155,0x1f2523f91ca5a241,0x23598f2ea383a155,0x22979bfea3f69ef1,0x9ebda3f99c372286
.quad 0xa16aa34d164623cd,0xa329187923de1fbd,0xa113207223a88000,0x1f8b23d91646a364,0x22d521d09f8ba3cd,0x22f29bfea4009c6e,0x1e54a264a22f1ef1,0xa029a39f147c23e3
.quad 0x236f22e41807a1a8,0xa113a3ffa0b81c6e,0x1f259f58a3e8a1a8,0xa30e987921bc23e3,0xa2d5a34d99cd21a8,0x1ca5239f2253932d,0xa0b81db523d321a8,0x23f61f589fefa3fd
.quad 0x220a239f1b8fa1a8,0x1646a264a36f995c,0x21bc9bfea3b8a1a8,0xa3a8a1d01b8f23b0,0xa113a3d99ca521a8,0x9f8b207223f61e1f,0xa2971879239621a8,0x222f234d1162a300
.quad 0x1fef23f91d7fa1a8,0x222f9bfea3dea0a1,0x23418f2ea36fa1a8,0x9f8ba3f99d1221f7,0x9d7fa3ff9e5421a8,0xa3a89561232921f7,0xa3b89561234121a8,0x164623bf208aa0a1
.quad 0x19cd23ec1f25a1a8,0x23f61e89a1e4a300,0x23f61a3ea30ea1a8,0x1ca5a2a7a22f1e1f,0x8b2ea3bf9fef21a8,0xa30ea17f202923b0,0xa3fb9cdc22d521a8,0xa11320cf2359995c
.quad 0x19cd231c23411b1f,0x1d12a072a3fba155,0x23f0217f99cda335,0xa1e4a3d99ebd1fbd,0x1ebda011a3fba0fd,0xa3599a3e219423e3,0xa1e4a3bf9d1220fd,0x8b2e22a72359195c
.quad 0xa2f28f2e22b72335,0x234122a79162a300,0x1aaf239f21e49b1f,0x220a9a3ea396a1f7,0x23f620729f8ba400,0x9ca5a3d9a1131e1f,0x1e54a129a3c69b1f,0xa3f0a0721fef23fd
.quad 0xa20aa34d8b2e2335,0xa029207223e81c6e,0xa2d5187923b820fd,0x208a23d91aafa286,0x1b8f23ec1fefa0fd,0x23de1a3ea2b7a286,0x23fb1e89a1bca335,0x1b8fa2a7a2751c6e
.quad 0x1deaa21da2d51b1f,0xa253a2a71c3723fd,0xa22fa2a71ca52400,0xa30e1a3e23f61e1f,0xa2b71cdc23fe1b1f,0x147c23d91f25a1f7,0x1c3723ff1aafa335,0x23832072a16aa300
.quad 0xa1e4156122b7238d,0x23c61e899f8ba3e3,0x1aaf234d22f2172a,0x1e54a011a3f6a155,0x239622649162a2c6,0x9fefa3f9a1131c6e,0x220a9879a341a2c6,0xa3f0a1291ca523b0
.quad 0x99cda379a253172a,0xa1941bfe23a821f7,0xa383a21d19cd238d,0x18eb2379222f995c,0xa22f1a3e23a821a8,0x230e22a79646a364,0x18eb239f21949d49,0x23410f2ea30ea286
.quad 0x236f21d09d12a3f3,0x1aafa264a30e132d,0x22539bfea3e8a042,0xa13fa39f96462300,0x9807a3bfa0b82042,0xa3fb9cdc222f2300,0xa359a17f1f2523f3,0xa05a20cf23a8132d
.quad 0xa2751cdc24001d49,0x1d7f23ff1ca5a286,0x164623d91f8ba1a8,0x23a82072a113a364,0x23412129a08aa38d,0x22759db5a3f6995c,0x22979db5a3f0972a,0xb2ea3bf9f8b21f7
.quad 0xa3b8a2648b2e2241,0x21bc23ec1fef9e1f,0xa2d59561220a23cd,0x23fb21299b8fa364,0x9aaf217f23e81ef1,0x22758f2ea2b7a364,0x208a23ff20299ef1,0x1b8fa17fa3de9e1f
.quad 0x23e821299d12a3cd,0x9f25a3f9a0b81e1f,0x22539879a36fa241,0xa359a26418072364,0x1646a2a7a30e8000,0xa3a89a3e222f2364,0xa13fa3bf9aaf2241,0xa05a201123fb1e1f
.quad 0xa3fe9f5820e623cd,0x1807239f216a9e1f,0xa1bc1db523fe1ef1,0x21e4234d8b2ea364,0xb2e2379216a9ef1,0x23fe1e89a194a364,0x21e4231c9807a3cd,0x22539cdca3fe9e1f
.quad 0x23fb1bfea2b7a241,0x1aafa2e4a20a1e1f,0x2113a072a3a88000,0x9f8ba3d996462364,0x9807a3ec9e542241,0xa36fa0cf20e62364,0xa275a21d1f2523cd,0xa396156123e81e1f
.quad 0x9ca5a379a2d5972a,0x9aaf212923fe20a1,0xa22fa3bf9dea2042,0x1c37237922b7132d,0xa3f6a1291c37238d,0x216a23ec1f259fbd,0xa30e95612253238d,0x23832264947ca300
.quad 0x9f8b201124002042,0x23f01e89a08aa3fd,0x1646234d2275972a,0x22979561a341a286,0x211323d91ca5a1a8,0x1f8ba072a3f69e1f,0x23a8217f9d7fa3f3,0xb2ea31ca275195c
.quad 0x23a81879a2b7a2c6,0x9f25a3ff9e542155,0x21139f58a3fb9d49,0xa275a2e4180723b0,0x1646a31ca20a1d49,0xa3e8a01120e623b0,0x9f8ba3ec9aaf22c6,0xa3968f2e236f2155
.quad 0xa30ea1d01ebd23f3,0xa1941f5823e8195c,0xa3f69a3e230e21a8,0x9ca522a7222f9e1f,0xa22f1e8923e8172a,0x19cd23f91d7fa286,0x9ca522e42194a042,0x20e6234d99cda3fd
.quad 0x213f9a3ea329a335,0xa3839cdc208a23fd,0x1d7fa072a3fea0fd,0xa2978f2e225323b0,0x8b2ea2a7a36f9b1f,0xa13f1bfe23832286,0x9deaa3d9a1941b1f,0x9f25201123fe20a1
.quad 0xa16aa3d99d7f20fd,0x9aaf21d023b81c6e,0xa329a2a7147c2335,0x1162231c22b7932d,0xa3f6a0721f8b2400,0x1ca523d921139e1f,0xa3b89a3e22532335,0x202923f91deaa155
.quad 0xa2751a3e23c620fd,0x21bc2379147ca300,0xa05a207223de1b1f,0x22f222649b8fa3e3,0x9aaf22a722979b1f,0x23b820cfa029a3e3,0x18eb23d92029a0fd,0x24001db5a20aa300
.quad 0x1fef23d91807a335,0x23c61561a359a155,0x222f22a79ca5a400,0x230e9a3ea3f69e1f,0x23962072a13fa335,0x21e49f58a3d3932d,0x23fe1a3ea341a0fd,0x205aa17fa2f21c6e
.quad 0x23e821d09646a2c6,0xa253a3bf9e541fbd,0x240020cf9ca5a38d,0xa275a39f9d1220a1,0x23f01f589f8ba3f3,0xa297a3799b8f2155,0x23b81cdca113a3f3,0xa2b7a34d98eb21f7
.quad 0x23591879a22fa38d,0xa2d5a31c947c2286,0x22d58f2ea30ea2c6,0xa2f2a2e40b2e2300,0x222f9a3ea3a8a1a8,0xa30ea2a716462364,0x216a9db5a3f6a042,0xa329a26419cd23b0
.quad 0x208aa011a3f69d49,0xa341a21d1c3723e3,0x1f25a129a3a8972a,0xa359a1d01d7f23fd,0x1d12a21da30e172a,0xa36fa17f1ebd23fd,0x19cda2e4a22f1d49,0xa383a1291fef23e3
.quad 0x1162a379a1132042,0xa396a0cf208a23b0,0x9646a3d99f8b21a8,0xa3a8a07221132364,0x9b8fa3ff9ca522c6,0xa3b8a01121942300,0x9deaa3ec9646238d,0xa3c69f58220a2286
.quad 0xa0b8a34d1aaf2400,0xa3f69cdc22f22155,0xa029a37919cd2400,0xa3a89f58225321f7,0x9f25a39f18eb2400,0xa30ea0cf21942286,0x9deaa3bf18072400,0xa22fa1d020b82300
.quad 0x9ca5a3d916462400,0xa113a2a71f8b2364,0x9aafa3ec147c2400,0x9f8ba34d1d7f23b0,0x9807a3f911622400,0x9ca5a3bf1aaf23e3,0x9162a3ff0b2e2400,0x9646a3f9147c23fd
.quad 0x1162a3ff8b2e2400,0x1646a3f9947c23fd,0x1807a3f991622400,0x1ca5a3bf9aaf23e3,0x1aafa3ec947c2400,0x1f8ba34d9d7f23b0,0x1ca5a3d996462400,0x2113a2a79f8b2364
.quad 0x1deaa3bf98072400,0x222fa1d0a0b82300,0x1f25a39f98eb2400,0x230ea0cfa1942286,0x2029a37999cd2400,0x23a89f58a25321f7,0x20b8a34d9aaf2400,0x23f69cdca2f22155
.quad 0xa1e420112396972a,0xb2e23d91e54a286,0xa3411bfe23fb172a,0x9e5422a72194a0a1,0xa3f08f2e23de1d49,0xa1e4207223419c6e,0xa3de9cdc23412042,0xa3961a3e23fb132d
.quad 0xa30ea072222f21a8,0xa3f69a3e23a81e1f,0xa194a21d20b822c6,0xa2f2a07222532155,0x9f25a34d1dea238d,0xa0b8a2a720292300,0x98eba3ec180723f3,0x9aafa3d919cd23e3
.quad 0x18eba3ec980723f3,0x1aafa3d999cd23e3,0x1f25a34d9dea238d,0x20b8a2a7a0292300,0x2194a21da0b822c6,0x22f2a072a2532155,0x230ea072a22f21a8,0x23f69a3ea3a81e1f
.quad 0x23de9cdca3412042,0x23961a3ea3fb132d,0x23f08f2ea3de1d49,0x21e42072a3419c6e,0x23411bfea3fb172a,0x1e5422a7a194a0a1,0x21e42011a396972a,0x8b2e23d99e54a286
.quad 0x220a22649ebda3cd,0x23f01561a3a89fbd,0x1d1223ec1162a3cd,0x22f22129a113a300,0x9aaf23791fefa241,0x1e5423bf9646a3fd,0xa16a212922b79ef1,0x9b8f23791f8ba286
.quad 0xa3a81a3e23f68000,0xa22f2072230e9e1f,0xa3c69cdc236f1ef1,0xa3fe8f2e23f6195c,0xa1bca1d0213f2241,0xa297a0cf222f2155,0x9c37a3bf1b8f23cd,0x9d12a39f1ca523b0
.quad 0x1c37a3bf9b8f23cd,0x1d12a39f9ca523b0,0x21bca1d0a13f2241,0x2297a0cfa22f2155,0x23c69cdca36f1ef1,0x23fe8f2ea3f6195c,0x23a81a3ea3f60000,0x222f2072a30e9e1f
.quad 0x216a2129a2b79ef1,0x1b8f23799f8ba286,0x1aaf23799fefa241,0x9e5423bf1646a3fd,0x9d1223ec9162a3cd,0xa2f221292113a300,0xa20a22641ebda3cd,0xa3f0156123a89fbd
.quad 0x208aa17fa2d51d49,0x9b8fa3ff99cd2364,0x23d38f2ea3e89d49,0x20b8a17fa2b71e1f,0x22d52129a13fa2c6,0x23fb1561a3c69e1f,0x1c3723ec8b2ea3f3,0x219422649fefa364
.quad 0x9f8b22a72113a1a8,0x964623d91ca5a364,0xa3961bfe23de972a,0xa297201123299e1f,0xa3419f5822f22042,0xa3b89cdc23831e1f,0x9deaa3791d7f238d,0x9ebda34d1e542364
.quad 0x1deaa3799d7f238d,0x1ebda34d9e542364,0x23419f58a2f22042,0x23b89cdca3831e1f,0x23961bfea3de972a,0x22972011a3299e1f,0x1f8b22a7a113a1a8,0x164623d99ca5a364
.quad 0x9c3723ec0b2ea3f3,0xa19422641fefa364,0xa2d52129213fa2c6,0xa3fb156123c69e1f,0xa3d38f2e23e89d49,0xa0b8a17f22b71e1f,0xa08aa17f22d51d49,0x1b8fa3ff19cd2364
.quad 0xa30ea12920e62335,0xa383187923fb1c6e,0x9646a3f99c372335,0xa1e4a2641f2523b0,0x222fa011a36f1b1f,0x1c37a34da05a21f7,0x23a81e89a2d5a0fd,0x23d39561a3fe995c
.quad 0x1ca523d99646a400,0x211322a79f8ba364,0xa11321d021e4a0fd,0x9e54231c2029a286,0xa3f6987923de1b1f,0xa3fb0f2e2400132d,0x9f8ba31c1f252335,0xa029a2e41fef2300
.quad 0x1f8ba31c9f252335,0x2029a2e49fef2300,0x23f69879a3de1b1f,0x23fb0f2ea400132d,0x211321d0a1e4a0fd,0x1e54231ca029a286,0x9ca523d91646a400,0xa11322a71f8ba364
.quad 0xa3a81e8922d5a0fd,0xa3d3956123fe995c,0xa22fa011236f1b1f,0x9c37a34d205a21f7,0x1646a3f91c372335,0x21e4a2649f2523b0,0x230ea129a0e62335,0x23831879a3fb1c6e
.quad 0x9dea22a721bca042,0x1f2523bf9162a3e3,0xa4009a3e236f2042,0xa20a20112383995c,0x9d7fa3d9116223f3,0xa297a17f20e62300,0x220aa072a3291d49,0x1d7fa31ca08a21f7
.quad 0x230e2072a22fa1a8,0x23f61a3ea3a89e1f,0x980723d91c37a38d,0x18eb23f98b2ea3fd,0xa3c61a3e23e8972a,0xa3591db523969c6e,0xa08aa2a7205a22c6,0xa0e6a26420b82286
.quad 0x208aa2a7a05a22c6,0x20e6a264a0b82286,0x23c61a3ea3e8972a,0x23591db5a3969c6e,0x180723d99c37a38d,0x98eb23f90b2ea3fd,0xa30e2072222fa1a8,0xa3f61a3e23a89e1f
.quad 0xa20aa07223291d49,0x9d7fa31c208a21f7,0x1d7fa3d9916223f3,0x2297a17fa0e62300,0x24009a3ea36f2042,0x220a2011a383995c,0x1dea22a7a1bca042,0x9f2523bf1162a3e3
.quad 0x23b81f58a22fa241,0x22b79db5a3e8932d,0x9807239f1f8ba241,0x208a234d9b8fa3fd,0xa400987923a81ef1,0xa2751f582396995c,0x98eba3ff964623cd,0xa0e6a2e41e5423b0
.quad 0x23a89a3ea3f60000,0x222fa072a30e1e1f,0x1ebd23799ca5a3cd,0x213f2264a05aa300,0xa2b72011230e9ef1,0xa1e421292253a0a1,0xa13fa21d21132241,0xa194a1d0216a21f7
.quad 0x213fa21da1132241,0x2194a1d0a16a21f7,0x22b72011a30e9ef1,0x21e42129a253a0a1,0x9ebd23791ca5a3cd,0xa13f2264205aa300,0xa3a89a3e23f68000,0xa22fa072230e1e1f
.quad 0x18eba3ff164623cd,0x20e6a2e49e5423b0,0x24009879a3a81ef1,0x22751f58a396995c,0x1807239f9f8ba241,0xa08a234d1b8fa3fd,0xa3b81f58222fa241,0xa2b79db523e8932d
.quad 0x18eba379a05a21a8,0xa113a31c1c3723fd,0x23c61e89a297a1a8,0x230e9cdca3f0932d,0x9d12231c20b8a1a8,0x1ca523ec0b2ea3e3,0xa359a011225321a8,0xa3f68f2e23e81c6e
.quad 0x1f8ba2a7a11321a8,0x1646a3d99ca52364,0x22b720cfa20aa1a8,0x23a81db5a3419fbd,0xa0e6221d216aa1a8,0x9f8b22e4205aa286,0xa1e4a17f21bc21a8,0xa22fa129220a2155
.quad 0x21e4a17fa1bc21a8,0x222fa129a20a2155,0x20e6221da16aa1a8,0x1f8b22e4a05aa286,0xa2b720cf220aa1a8,0xa3a81db523419fbd,0x9f8ba2a7211321a8,0x9646a3d91ca52364
.quad 0x2359a011a25321a8,0x23f68f2ea3e81c6e,0x1d12231ca0b8a1a8,0x9ca523ec8b2ea3e3,0xa3c61e892297a1a8,0xa30e9cdc23f0932d,0x98eba379205a21a8,0x2113a31c9c3723fd
.quad 0xa3fe9bfe232920fd,0xa1942072236f995c,0x1d7fa2e4a13f20fd,0x9deaa3d90b2e23e3,0x225321d0a08aa335,0x23fe1a3ea3839fbd,0xa2971f5823839b1f,0x9f2522a7213fa155
.quad 0x9ca5a3d916462400,0xa113a2a71f8b2364,0x24001561a3e89b1f,0x23b89a3ea3f0132d,0x9d1223791e54a335,0x98eb23d91b8fa3b0,0xa275a0cf225320fd,0xa2b7a072229720a1
.quad 0x2275a0cfa25320fd,0x22b7a072a29720a1,0x1d1223799e54a335,0x18eb23d99b8fa3b0,0xa400156123e89b1f,0xa3b89a3e23f0132d,0x1ca5a3d996462400,0x2113a2a79f8b2364
.quad 0x22971f58a3839b1f,0x1f2522a7a13fa155,0xa25321d0208aa335,0xa3fe1a3e23839fbd,0x9d7fa2e4213f20fd,0x1deaa3d98b2e23e3,0x23fe9bfea32920fd,0x21942072a36f995c
.quad 0x147c23ec1d7fa2c6,0x2253221d9f8ba3b0,0xa329a0cf216a22c6,0xa3b8156123f61c6e,0x22b79e89a3b8172a,0x1deaa2e4a1132155,0x116223f91aafa38d,0x2029234d9ca5a3e3
.quad 0xa30ea072222f21a8,0xa3f69a3e23a81e1f,0x22d59f58a3591d49,0x216aa17fa22f20a1,0xb2e23ff147ca3f3,0x19cd23ec9646a3fd,0xa2f2a01122d52042,0xa3299f58230e1fbd
.quad 0x22f2a011a2d52042,0x23299f58a30e1fbd,0x8b2e23ff947ca3f3,0x99cd23ec1646a3fd,0xa2d59f5823591d49,0xa16aa17f222f20a1,0x230ea072a22f21a8,0x23f69a3ea3a81e1f
.quad 0x916223f99aafa38d,0xa029234d1ca5a3e3,0xa2b79e8923b8172a,0x9deaa2e421132155,0x2329a0cfa16a22c6,0x23b81561a3f61c6e,0x947c23ec9d7fa2c6,0xa253221d1f8ba3b0
.quad 0x23de0f2ea3c69ef1,0x2029a1d0a2971e1f,0xa05a21d022759ef1,0x18eb23ff1aafa364,0x9b8fa3f9947c23cd,0xa20aa21d20292364,0x22f220cfa1bca241,0x24001879a3b89e1f
.quad 0xa3a81a3e23f68000,0xa22f2072230e9e1f,0x1f25a2e4a08a2241,0x19cda3bf9d122364,0x1d7f239f9c37a3cd,0x1fef231c9ebda364,0xa3599e8923411ef1,0xa3839db5236f1e1f
.quad 0x23599e89a3411ef1,0x23839db5a36f1e1f,0x9d7f239f1c37a3cd,0x9fef231c1ebda364,0x9f25a2e4208a2241,0x99cda3bf1d122364,0x23a81a3ea3f60000,0x222f2072a30e9e1f
.quad 0xa2f220cf21bca241,0xa400187923b89e1f,0x1b8fa3f9147c23cd,0x220aa21da0292364,0x205a21d0a2759ef1,0x98eb23ff9aafa364,0xa3de0f2e23c69ef1,0xa029a1d022971e1f
.quad 0x9ca5a3f99807238d,0xa341a0cf213f2300,0x222f221d9fefa38d,0x23fe1879a3969fbd,0xa3f69bfe23592042,0xa2f21db523d3932d,0x230e9db5a3c6172a,0x205aa21da1e420a1
.quad 0x9f8b22a72113a1a8,0x964623d91ca5a364,0x9646a3ff916223f3,0x9deaa39f1b8f23e3,0x21132264a08aa2c6,0x220a217fa194a1f7,0xa3a89cdc23961d49,0xa3c69bfe23b81c6e
.quad 0x23a89cdca3961d49,0x23c69bfea3b81c6e,0xa1132264208aa2c6,0xa20a217f2194a1f7,0x1646a3ff116223f3,0x1deaa39f9b8f23e3,0x1f8b22a7a113a1a8,0x164623d99ca5a364
.quad 0xa30e9db523c6172a,0xa05aa21d21e420a1,0x23f69bfea3592042,0x22f21db5a3d3932d,0xa22f221d1fefa38d,0xa3fe187923969fbd,0x1ca5a3f91807238d,0x2341a0cfa13f2300
.quad 0xa3591a3e24001b1f,0x9d1222e4216aa0a1,0x21bca072a3591b1f,0x147ca3bf9ebd2286,0x9ebd22a7216aa0fd,0x19cd23ff1807a3b0,0x147ca3d99d122335,0x9ebda39f19cd23fd
.quad 0x1ca523d99646a400,0x211322a79f8ba364,0xa0e6a2a71fef2335,0xa275a12921bc21f7,0x22d52072a275a0fd,0x236f1e89a3299fbd,0xa3de9a3e23d31b1f,0xa3f0987923e8195c
.quad 0x23de9a3ea3d31b1f,0x23f09879a3e8195c,0xa2d520722275a0fd,0xa36f1e8923299fbd,0x20e6a2a79fef2335,0x2275a129a1bc21f7,0x9ca523d91646a400,0xa11322a71f8ba364
.quad 0x947ca3d91d122335,0x1ebda39f99cd23fd,0x1ebd22a7a16aa0fd,0x99cd23ff9807a3b0,0xa1bca07223591b1f,0x947ca3bf1ebd2286,0x23591a3ea4001b1f,0x1d1222e4a16aa0a1
.quad 0x1fef239f9646a3f3,0x23d31e89a275a1f7,0xa0e6a31c1ca523f3,0xa3de9db522d52155,0x21bc22649f8ba38d,0x23e81cdca329a0a1,0xa275a17f211322c6,0xa3f09bfe236f1fbd
.quad 0x230e2072a22fa1a8,0x23f61a3ea3a89e1f,0xa3839e89230e2042,0xa3fb987923d31c6e,0x23d31bfea3a89d49,0x23fe1561a3f0995c,0xa3fb956123f6172a,0xa4008f2e23fe132d
.quad 0x23fb9561a3f6172a,0x24008f2ea3fe132d,0xa3d31bfe23a89d49,0xa3fe156123f0995c,0x23839e89a30e2042,0x23fb9879a3d31c6e,0xa30e2072222fa1a8,0xa3f61a3e23a89e1f
.quad 0x2275a17fa11322c6,0x23f09bfea36f1fbd,0xa1bc22641f8ba38d,0xa3e81cdc2329a0a1,0x20e6a31c9ca523f3,0x23de9db5a2d52155,0x9fef239f1646a3f3,0xa3d31e892275a1f7
.quad 0x22759e89a3d30000,0x1646a39f9fef21f7,0xa2d51db523de8000,0x9ca5231c20e6a155,0x23299cdca3e80000,0x1f8ba264a1bc20a1,0xa36f1bfe23f08000,0xa113217f22759fbd
.quad 0x23a89a3ea3f60000,0x222fa072a30e1e1f,0xa3d3187923fb8000,0xa30e1e8923839c6e,0x23f09561a3fe0000,0x23a89bfea3d3195c,0xa3fe0f2e24008000,0xa3f6156123fb932d
.quad 0x23fe0f2ea4000000,0x23f61561a3fb932d,0xa3f0956123fe8000,0xa3a89bfe23d3195c,0x23d31879a3fb0000,0x230e1e89a3839c6e,0xa3a89a3e23f68000,0xa22fa072230e1e1f
.quad 0x236f1bfea3f00000,0x2113217fa2759fbd,0xa3299cdc23e88000,0x9f8ba26421bc20a1,0x22d51db5a3de0000,0x1ca5231ca0e6a155,0xa2759e8923d38000,0x9646a39f1fef21f7
.quad 0xa16aa2e41d1223f3,0xa4009a3e235920a1,0x1ebd23bf947ca3f3,0x23592072a1bca286,0x9807a3ff99cd238d,0xa16aa2a71ebd23b0,0x99cd239f1ebda2c6,0x1d1223d9947ca3fd
.quad 0x1f8ba2a7a11321a8,0x1646a3d99ca52364,0xa1bc21292275a042,0x9fef22a720e6a1f7,0x23299e89a36f1d49,0x2275a072a2d51fbd,0xa3e8187923f0972a,0xa3d31a3e23de995c
.quad 0x23e81879a3f0972a,0x23d31a3ea3de995c,0xa3299e89236f1d49,0xa275a07222d51fbd,0x21bc2129a275a042,0x1fef22a7a0e6a1f7,0x9f8ba2a7211321a8,0x9646a3d91ca52364
.quad 0x19cd239f9ebda2c6,0x9d1223d9147ca3fd,0x1807a3ff19cd238d,0x216aa2a79ebd23b0,0x9ebd23bf147ca3f3,0xa359207221bca286,0x216aa2e49d1223f3,0x24009a3ea35920a1
.quad 0xa13f20cf23419b1f,0x180723f91ca5a300,0x23969879a3fe9b1f,0x1fefa21da22f1fbd,0xa3d39db522f220fd,0xa3591bfe23f6132d,0x21e4221da05aa335,0x23c61db5a30ea0a1
.quad 0x9ca5a3d916462400,0xa113a2a71f8b2364,0x9b8f239f1deaa335,0x116223ff1646a3e3,0x2194a17fa20a20fd,0x208aa264a11321f7,0xa3b81bfe23c69b1f,0xa3961cdc23a89c6e
.quad 0x23b81bfea3c69b1f,0x23961cdca3a89c6e,0xa194a17f220a20fd,0xa08aa264211321f7,0x1b8f239f9deaa335,0x916223ff9646a3e3,0x1ca5a3d996462400,0x2113a2a79f8b2364
.quad 0xa1e4221d205aa335,0xa3c61db5230ea0a1,0x23d39db5a2f220fd,0x23591bfea3f6132d,0xa396987923fe9b1f,0x9fefa21d222f1fbd,0x213f20cfa3419b1f,0x980723f99ca5a300
.quad 0x229721d0a029a38d,0x23c68f2ea3de9e1f,0x9aafa3ff98eb238d,0xa275a1d0205a2364,0xa029221d220aa042,0x147c23f91b8fa364,0x23b89879a400972a,0x21bca0cfa2f21e1f
.quad 0xa30ea072222f21a8,0xa3f69a3e23a81e1f,0x1d1223bf99cda3f3,0x208a22e49f25a364,0x1ebda31c9fef22c6,0x1c37a39f9d7f2364,0xa36f1db523839d49,0xa3411e8923599e1f
.quad 0x236f1db5a3839d49,0x23411e89a3599e1f,0x9ebda31c1fef22c6,0x9c37a39f1d7f2364,0x9d1223bf19cda3f3,0xa08a22e41f25a364,0x230ea072a22f21a8,0x23f69a3ea3a81e1f
.quad 0xa3b898792400972a,0xa1bca0cf22f21e1f,0x2029221da20aa042,0x947c23f99b8fa364,0x1aafa3ff18eb238d,0x2275a1d0a05a2364,0xa29721d02029a38d,0xa3c68f2e23de9e1f
.quad 0x1f8ba21da2531ef1,0x9d7fa3ec947c23b0,0xa3f6956123b81ef1,0xa16a20cf23299c6e,0x211322e49deaa3cd,0x23b81e89a2b7a155,0x1ca5a34da0292241,0x9aafa3f9916223e3
.quad 0xa3a81a3e23f68000,0xa22f2072230e9e1f,0x222f217fa16aa241,0x23591f58a2d5a0a1,0x1646a3ec99cd23cd,0x947ca3ff8b2e23fd,0xa30e1f5823299ef1,0xa2d5201122f29fbd
.quad 0x230e1f58a3299ef1,0x22d52011a2f29fbd,0x9646a3ec19cd23cd,0x147ca3ff0b2e23fd,0xa22f217f216aa241,0xa3591f5822d5a0a1,0x23a81a3ea3f60000,0x222f2072a30e9e1f
.quad 0x9ca5a34d20292241,0x1aafa3f9116223e3,0xa11322e41deaa3cd,0xa3b81e8922b7a155,0x23f69561a3b81ef1,0x216a20cfa3299c6e,0x9f8ba21d22531ef1,0x1d7fa3ec147c23b0
.quad 0xa36fa072219422c6,0xa3291bfe23fe195c,0x8b2e23d91deaa2c6,0x213f22e49d7fa3e3,0x23839a3ea3fe972a,0x208aa1d0a2531fbd,0xa13fa2a71f25238d,0xa3839f5822972155
.quad 0x9f8b22a72113a1a8,0x964623d91ca5a364,0x23f01a3ea3b89d49,0x23e89561a400932d,0x9b8fa3d918eb23f3,0x9e54a3791d1223b0,0xa297207222b7a042,0xa25320cf2275a0a1
.quad 0x22972072a2b7a042,0x225320cfa275a0a1,0x1b8fa3d998eb23f3,0x1e54a3799d1223b0,0xa3f01a3e23b89d49,0xa3e895612400932d,0x1f8b22a7a113a1a8,0x164623d99ca5a364
.quad 0x213fa2a79f25238d,0x23839f58a2972155,0xa3839a3e23fe972a,0xa08aa1d022531fbd,0xb2e23d99deaa2c6,0xa13f22e41d7fa3e3,0x236fa072a19422c6,0x23291bfea3fe195c
.quad 0x9c37231c2113a0fd,0x205a237998eba3fd,0x23f01cdca30ea0fd,0x22979e89a3c6132d,0x8b2ea3ec9ca52335,0xa0b8a31c1d1223e3,0xa3e80f2e23f61b1f,0xa253201123599c6e
.quad 0x1ca523d99646a400,0x211322a79f8ba364,0x23419db5a3a81b1f,0x220aa0cfa2b71fbd,0xa05aa2e41f8b2335,0xa16aa21d20e62286,0xa20a2129222fa0fd,0xa1bc217f21e4a155
.quad 0x220a2129a22fa0fd,0x21bc217fa1e4a155,0x205aa2e49f8b2335,0x216aa21da0e62286,0xa3419db523a81b1f,0xa20aa0cf22b71fbd,0x9ca523d91646a400,0xa11322a71f8ba364
.quad 0x23e80f2ea3f61b1f,0x22532011a3599c6e,0xb2ea3ec1ca52335,0x20b8a31c9d1223e3,0xa3f01cdc230ea0fd,0xa2979e8923c6132d,0x1c37231ca113a0fd,0xa05a237918eba3fd
.quad 0x23e81db5a2b7a1a8,0x222f9f58a3b8132d,0x1b8fa34da08a21a8,0x9f8ba39f180723fd,0xa3969f58227521a8,0xa3a818792400195c,0x9e5422e420e6a1a8,0x164623ff18eba3b0
.quad 0x230e2072a22fa1a8,0x23f61a3ea3a89e1f,0x205aa264a13f21a8,0x1ca5a3799ebd2300,0xa253a12921e421a8,0xa30ea01122b720a1,0xa16a21d02194a1a8,0xa113221d213fa1f7
.quad 0x216a21d0a194a1a8,0x2113221da13fa1f7,0x2253a129a1e421a8,0x230ea011a2b720a1,0xa05aa264213f21a8,0x9ca5a3791ebd2300,0xa30e2072222fa1a8,0xa3f61a3e23a89e1f
.quad 0x1e5422e4a0e6a1a8,0x964623ff98eba3b0,0x23969f58a27521a8,0x23a81879a400195c,0x9b8fa34d208a21a8,0x1f8ba39f980723fd,0xa3e81db522b7a1a8,0xa22f9f5823b8132d
.quad 0x1162a3bf9f252241,0xa1bca2a71dea23e3,0xa383a011220a2241,0xa36f1a3e2400195c,0xa0e6217f22979ef1,0x916223d91d7fa300,0x208a231c9d7fa3cd,0x23292072a20aa1f7
.quad 0x23a89a3ea3f60000,0x222fa072a30e1e1f,0xb2ea3f998eb23cd,0x9c37a3d9180723fd,0xa3969db523591ef1,0xa3e89a3e23c61c6e,0xa0b8226420e6a241,0xa05a22a7208aa286
.quad 0x20b82264a0e6a241,0x205a22a7a08aa286,0x23969db5a3591ef1,0x23e89a3ea3c61c6e,0x8b2ea3f918eb23cd,0x1c37a3d9980723fd,0xa3a89a3e23f68000,0xa22fa072230e1e1f
.quad 0xa08a231c1d7fa3cd,0xa3292072220aa1f7,0x20e6217fa2979ef1,0x116223d99d7fa300,0x2383a011a20a2241,0x236f1a3ea400195c,0x9162a3bf1f252241,0x21bca2a79dea23e3
.quad 0xa3fb987923832042,0xa0e62129230e9c6e,0x9f25226421e4a042,0x1c3723f91646a3b0,0x205a234d9c37a3f3,0x236f2011a22fa1f7,0x23fe1561a3d39d49,0x22d59e89a3a8195c
.quad 0x1f8ba2a7a11321a8,0x1646a3d99ca52364,0xa029a31c1e54238d,0xa1e4a1d021132286,0xa4008f2e23fb172a,0xa3de187923f6932d,0x9fef22e42029a2c6,0x9f25231c1f8ba300
.quad 0x1fef22e4a029a2c6,0x1f25231c9f8ba300,0x24008f2ea3fb172a,0x23de1879a3f6932d,0x2029a31c9e54238d,0x21e4a1d0a1132286,0x9f8ba2a7211321a8,0x9646a3d91ca52364
.quad 0xa3fe156123d39d49,0xa2d59e8923a8195c,0xa05a234d1c37a3f3,0xa36f2011222fa1f7,0x1f252264a1e4a042,0x9c3723f99646a3b0,0x23fb9879a3832042,0x20e62129a30e9c6e
.quad 0x19cd23ff1b8fa335,0x22d5217fa08aa364,0x22b7217fa0b8a335,0x23e80f2ea3d39e1f,0x23c69561a3fb9b1f,0x213fa129a2d51e1f,0x1fefa264a19420fd,0xb2ea3ec9c372364
.quad 0x9ca5a3d916462400,0xa113a2a71f8b2364,0xa329a011229720fd,0xa3de9bfe23961e1f,0xa3831cdc23b89b1f,0xa2f21f5823419e1f,0x9e54234d1ebda335,0x9d7f23791deaa364
.quad 0x1e54234d9ebda335,0x1d7f23799deaa364,0x23831cdca3b89b1f,0x22f21f58a3419e1f,0x2329a011a29720fd,0x23de9bfea3961e1f,0x1ca5a3d996462400,0x2113a2a79f8b2364
.quad 0x9fefa264219420fd,0x8b2ea3ec1c372364,0xa3c6956123fb9b1f,0xa13fa12922d51e1f,0xa2b7217f20b8a335,0xa3e80f2e23d39e1f,0x99cd23ff9b8fa335,0xa2d5217f208aa364
.quad 0x23a89561a3f09d49,0x1ebda264a20a1fbd,0x2113a129a2f21d49,0x9162a3ec9d122300,0x1646a3bf9e5422c6,0x9fefa3791aaf23fd,0x9f8ba3791b8f23f3,0xa2b7a129216a2286
.quad 0xa30ea072222f21a8,0xa3f69a3e23a81e1f,0xa3f60f2e23fe172a,0xa36f1cdc23c6995c,0xa22f20cf2297a042,0xa13f21d021bca155,0x9ca5239f1d12a38d,0x9b8f23bf1c37a3b0
.quad 0x1ca5239f9d12a38d,0x1b8f23bf9c37a3b0,0x222f20cfa297a042,0x213f21d0a1bca155,0x23f60f2ea3fe172a,0x236f1cdca3c6995c,0x230ea072a22f21a8,0x23f69a3ea3a81e1f
.quad 0x1f8ba3799b8f23f3,0x22b7a129a16a2286,0x9646a3bf1e5422c6,0x1fefa3799aaf23fd,0xa113a12922f21d49,0x1162a3ec1d122300,0xa3a8956123f09d49,0x9ebda264220a1fbd
.quad 0x9e54a3d98b2e23cd,0xa396a01121e42286,0xa194a2a71e5423cd,0xa3fb9bfe234120a1,0xa341a07221e42241,0xa3de0f2e23f01c6e,0xa3fb9a3e23961ef1,0xa3411cdc23de932d
.quad 0xa3a81a3e23f68000,0xa22f2072230e9e1f,0xa253207222f29ef1,0xa0b8221d2194a155,0xa02922a720b8a241,0x9dea234d1f25a300,0x99cd23d91aafa3cd,0x980723ec18eba3e3
.quad 0x19cd23d99aafa3cd,0x180723ec98eba3e3,0x202922a7a0b8a241,0x1dea234d9f25a300,0x22532072a2f29ef1,0x20b8221da194a155,0x23a81a3ea3f60000,0x222f2072a30e9e1f
.quad 0x23fb9a3ea3961ef1,0x23411cdca3de932d,0x2341a072a1e42241,0x23de0f2ea3f01c6e,0x2194a2a79e5423cd,0x23fb9bfea34120a1,0x1e54a3d90b2e23cd,0x2396a011a1e42286
.quad 0xa2f21cdc23f6172a,0x9aaf234d20b8a155,0xa2531f5823a8972a,0x99cd23792029a1f7,0xa19420cf230e9d49,0x98eb239f1f25a286,0xa0b821d0222fa042,0x980723bf1deaa300
.quad 0x9f8b22a72113a1a8,0x964623d91ca5a364,0x9d7f234d1f8ba2c6,0x947c23ec1aafa3b0,0x9aaf23bf1ca5a38d,0x916223f91807a3e3,0x947c23f91646a3f3,0x8b2e23ff1162a3fd
.quad 0x147c23f99646a3f3,0xb2e23ff9162a3fd,0x1aaf23bf9ca5a38d,0x116223f99807a3e3,0x1d7f234d9f8ba2c6,0x147c23ec9aafa3b0,0x1f8b22a7a113a1a8,0x164623d99ca5a364
.quad 0x20b821d0a22fa042,0x180723bf9deaa300,0x219420cfa30e9d49,0x18eb239f9f25a286,0x22531f58a3a8972a,0x19cd2379a029a1f7,0x22f21cdca3f6172a,0x1aaf234da0b8a155
.quad 0x22759e89a3d38000,0x1646a39f9fef21f7,0x22d59db5a3de8000,0x1ca5a31ca0e62155,0x23299cdca3e88000,0x1f8ba264a1bc20a1,0x236f9bfea3f08000,0x2113a17fa2751fbd
.quad 0x23a89a3ea3f68000,0x222fa072a30e1e1f,0x23d39879a3fb8000,0x230e9e89a3831c6e,0x23f09561a3fe8000,0x23a89bfea3d3195c,0x23fe8f2ea4008000,0x23f69561a3fb132d
.quad 0x23fe0f2ea4008000,0x23f61561a3fb932d,0x23f01561a3fe8000,0x23a81bfea3d3995c,0x23d31879a3fb8000,0x230e1e89a3839c6e,0x23a81a3ea3f68000,0x222f2072a30e9e1f
.quad 0x236f1bfea3f08000,0x2113217fa2759fbd,0x23291cdca3e88000,0x1f8b2264a1bca0a1,0x22d51db5a3de8000,0x1ca5231ca0e6a155,0x22751e89a3d38000,0x1646239f9fefa1f7
.quad 0xa16aa2e41d1223f3,0xa4009a3e235920a1,0x9ebda3bf147c23f3,0xa359a07221bc2286,0x9807a3ff99cd238d,0xa16aa2a71ebd23b0,0x19cda39f9ebd22c6,0x9d12a3d9147c23fd
.quad 0x1f8ba2a7a11321a8,0x1646a3d99ca52364,0x21bca129a2752042,0x1fefa2a7a0e621f7,0x23299e89a36f1d49,0x2275a072a2d51fbd,0x23e89879a3f0172a,0x23d39a3ea3de195c
.quad 0x23e81879a3f0972a,0x23d31a3ea3de995c,0x23291e89a36f9d49,0x22752072a2d59fbd,0x21bc2129a275a042,0x1fef22a7a0e6a1f7,0x1f8b22a7a113a1a8,0x164623d99ca5a364
.quad 0x19cd239f9ebda2c6,0x9d1223d9147ca3fd,0x980723ff99cda38d,0xa16a22a71ebda3b0,0x9ebd23bf147ca3f3,0xa359207221bca286,0xa16a22e41d12a3f3,0xa4001a3e2359a0a1
.quad 0xa13f20cf23419b1f,0x180723f91ca5a300,0xa396187923fe1b1f,0x9fef221d222f9fbd,0xa3d39db522f220fd,0xa3591bfe23f6132d,0xa1e4a21d205a2335,0xa3c69db5230e20a1
.quad 0x9ca5a3d916462400,0xa113a2a71f8b2364,0x1b8fa39f9dea2335,0x9162a3ff964623e3,0x2194a17fa20a20fd,0x208aa264a11321f7,0x23b89bfea3c61b1f,0x23969cdca3a81c6e
.quad 0x23b81bfea3c69b1f,0x23961cdca3a89c6e,0x2194217fa20aa0fd,0x208a2264a113a1f7,0x1b8f239f9deaa335,0x916223ff9646a3e3,0x9ca523d91646a400,0xa11322a71f8ba364
.quad 0xa1e4221d205aa335,0xa3c61db5230ea0a1,0xa3d31db522f2a0fd,0xa3599bfe23f6932d,0xa396987923fe9b1f,0x9fefa21d222f1fbd,0xa13fa0cf23411b1f,0x1807a3f91ca52300
.quad 0x229721d0a029a38d,0x23c68f2ea3de9e1f,0x1aaf23ff18eba38d,0x227521d0a05aa364,0xa029221d220aa042,0x147c23f91b8fa364,0xa3b818792400172a,0xa1bc20cf22f29e1f
.quad 0xa30ea072222f21a8,0xa3f69a3e23a81e1f,0x9d12a3bf19cd23f3,0xa08aa2e41f252364,0x1ebda31c9fef22c6,0x1c37a39f9d7f2364,0x236f9db5a3831d49,0x23419e89a3591e1f
.quad 0x236f1db5a3839d49,0x23411e89a3599e1f,0x1ebd231c9fefa2c6,0x1c37239f9d7fa364,0x9d1223bf19cda3f3,0xa08a22e41f25a364,0xa30e2072222fa1a8,0xa3f61a3e23a89e1f
.quad 0xa3b898792400972a,0xa1bca0cf22f21e1f,0xa029a21d220a2042,0x147ca3f91b8f2364,0x1aafa3ff18eb238d,0x2275a1d0a05a2364,0x2297a1d0a029238d,0x23c60f2ea3de1e1f
.quad 0x1f8ba21da2531ef1,0x9d7fa3ec947c23b0,0x23f61561a3b89ef1,0x216aa0cfa3291c6e,0x211322e49deaa3cd,0x23b81e89a2b7a155,0x9ca5234d2029a241,0x1aaf23f91162a3e3
.quad 0xa3a81a3e23f68000,0xa22f2072230e9e1f,0xa22fa17f216a2241,0xa3599f5822d520a1,0x1646a3ec99cd23cd,0x947ca3ff8b2e23fd,0x230e9f58a3291ef1,0x22d5a011a2f21fbd
.quad 0x230e1f58a3299ef1,0x22d52011a2f29fbd,0x164623ec99cda3cd,0x947c23ff8b2ea3fd,0xa22f217f216aa241,0xa3591f5822d5a0a1,0xa3a89a3e23f68000,0xa22fa072230e1e1f
.quad 0x9ca5a34d20292241,0x1aafa3f9116223e3,0x2113a2e49dea23cd,0x23b89e89a2b72155,0x23f69561a3b81ef1,0x216a20cfa3299c6e,0x1f8b221da2539ef1,0x9d7f23ec947ca3b0
.quad 0xa36fa072219422c6,0xa3291bfe23fe195c,0xb2ea3d99dea22c6,0xa13fa2e41d7f23e3,0x23839a3ea3fe972a,0x208aa1d0a2531fbd,0x213f22a79f25a38d,0x23831f58a297a155
.quad 0x9f8b22a72113a1a8,0x964623d91ca5a364,0xa3f09a3e23b81d49,0xa3e815612400132d,0x9b8fa3d918eb23f3,0x9e54a3791d1223b0,0x2297a072a2b72042,0x2253a0cfa27520a1
.quad 0x22972072a2b7a042,0x225320cfa275a0a1,0x9b8f23d918eba3f3,0x9e5423791d12a3b0,0xa3f01a3e23b89d49,0xa3e895612400932d,0x9f8ba2a7211321a8,0x9646a3d91ca52364
.quad 0x213fa2a79f25238d,0x23839f58a2972155,0x23831a3ea3fe172a,0x208a21d0a2539fbd,0xb2e23d99deaa2c6,0xa13f22e41d7fa3e3,0xa36f20722194a2c6,0xa3299bfe23fe995c
.quad 0x9c37231c2113a0fd,0x205a237998eba3fd,0xa3f09cdc230e20fd,0xa2971e8923c6932d,0x8b2ea3ec9ca52335,0xa0b8a31c1d1223e3,0x23e88f2ea3f69b1f,0x2253a011a3591c6e
.quad 0x1ca523d99646a400,0x211322a79f8ba364,0xa3411db523a89b1f,0xa20a20cf22b79fbd,0xa05aa2e41f8b2335,0xa16aa21d20e62286,0x220aa129a22f20fd,0x21bca17fa1e42155
.quad 0x220a2129a22fa0fd,0x21bc217fa1e4a155,0xa05a22e41f8ba335,0xa16a221d20e6a286,0xa3419db523a81b1f,0xa20aa0cf22b71fbd,0x1ca5a3d996462400,0x2113a2a79f8b2364
.quad 0x23e80f2ea3f61b1f,0x22532011a3599c6e,0x8b2e23ec9ca5a335,0xa0b8231c1d12a3e3,0xa3f01cdc230ea0fd,0xa2979e8923c6132d,0x9c37a31c211320fd,0x205aa37998eb23fd
.quad 0x23e81db5a2b7a1a8,0x222f9f58a3b8132d,0x9b8f234d208aa1a8,0x1f8b239f9807a3fd,0xa3969f58227521a8,0xa3a818792400195c,0x1e54a2e4a0e621a8,0x9646a3ff98eb23b0
.quad 0x230e2072a22fa1a8,0x23f61a3ea3a89e1f,0xa05a2264213fa1a8,0x9ca523791ebda300,0xa253a12921e421a8,0xa30ea01122b720a1,0x216aa1d0a19421a8,0x2113a21da13f21f7
.quad 0x216a21d0a194a1a8,0x2113221da13fa1f7,0xa253212921e4a1a8,0xa30e201122b7a0a1,0xa05aa264213f21a8,0x9ca5a3791ebd2300,0x230ea072a22f21a8,0x23f69a3ea3a81e1f
.quad 0x1e5422e4a0e6a1a8,0x964623ff98eba3b0,0xa3961f582275a1a8,0xa3a898792400995c,0x9b8fa34d208a21a8,0x1f8ba39f980723fd,0x23e89db5a2b721a8,0x222f1f58a3b8932d
.quad 0x1162a3bf9f252241,0xa1bca2a71dea23e3,0x23832011a20aa241,0x236f9a3ea400995c,0xa0e6217f22979ef1,0x916223d91d7fa300,0xa08aa31c1d7f23cd,0xa329a072220a21f7
.quad 0x23a89a3ea3f68000,0x222fa072a30e1e1f,0x8b2e23f918eba3cd,0x1c3723d99807a3fd,0xa3969db523591ef1,0xa3e89a3e23c61c6e,0x20b8a264a0e62241,0x205aa2a7a08a2286
.quad 0x20b82264a0e6a241,0x205a22a7a08aa286,0xa3961db523599ef1,0xa3e81a3e23c69c6e,0x8b2ea3f918eb23cd,0x1c37a3d9980723fd,0x23a81a3ea3f68000,0x222f2072a30e9e1f
.quad 0xa08a231c1d7fa3cd,0xa3292072220aa1f7,0xa0e6a17f22971ef1,0x9162a3d91d7f2300,0x2383a011a20a2241,0x236f1a3ea400195c,0x116223bf9f25a241,0xa1bc22a71deaa3e3
.quad 0xa3fb987923832042,0xa0e62129230e9c6e,0x1f25a264a1e42042,0x9c37a3f9964623b0,0x205a234d9c37a3f3,0x236f2011a22fa1f7,0xa3fe956123d31d49,0xa2d51e8923a8995c
.quad 0x1f8ba2a7a11321a8,0x1646a3d99ca52364,0x2029231c9e54a38d,0x21e421d0a113a286,0xa4008f2e23fb172a,0xa3de187923f6932d,0x1fefa2e4a02922c6,0x1f25a31c9f8b2300
.quad 0x1fef22e4a029a2c6,0x1f25231c9f8ba300,0xa4000f2e23fb972a,0xa3de987923f6132d,0x2029a31c9e54238d,0x21e4a1d0a1132286,0x1f8b22a7a113a1a8,0x164623d99ca5a364
.quad 0xa3fe156123d39d49,0xa2d59e8923a8195c,0x205aa34d9c3723f3,0x236fa011a22f21f7,0x1f252264a1e4a042,0x9c3723f99646a3b0,0xa3fb18792383a042,0xa0e6a129230e1c6e
.quad 0x19cd23ff1b8fa335,0x22d5217fa08aa364,0xa2b7a17f20b82335,0xa3e88f2e23d31e1f,0x23c69561a3fb9b1f,0x213fa129a2d51e1f,0x9fef22642194a0fd,0x8b2e23ec1c37a364
.quad 0x9ca5a3d916462400,0xa113a2a71f8b2364,0x23292011a297a0fd,0x23de1bfea3969e1f,0xa3831cdc23b89b1f,0xa2f21f5823419e1f,0x1e54a34d9ebd2335,0x1d7fa3799dea2364
.quad 0x1e54234d9ebda335,0x1d7f23799deaa364,0xa3839cdc23b81b1f,0xa2f29f5823411e1f,0x2329a011a29720fd,0x23de9bfea3961e1f,0x9ca523d91646a400,0xa11322a71f8ba364
.quad 0x9fefa264219420fd,0x8b2ea3ec1c372364,0x23c61561a3fb1b1f,0x213f2129a2d59e1f,0xa2b7217f20b8a335,0xa3e80f2e23d39e1f,0x19cda3ff1b8f2335,0x22d5a17fa08a2364
.quad 0x23a89561a3f09d49,0x1ebda264a20a1fbd,0xa113212922f29d49,0x116223ec1d12a300,0x1646a3bf9e5422c6,0x9fefa3791aaf23fd,0x1f8b23799b8fa3f3,0x22b72129a16aa286
.quad 0xa30ea072222f21a8,0xa3f69a3e23a81e1f,0x23f68f2ea3fe972a,0x236f9cdca3c6195c,0xa22f20cf2297a042,0xa13f21d021bca155,0x1ca5a39f9d12238d,0x1b8fa3bf9c3723b0
.quad 0x1ca5239f9d12a38d,0x1b8f23bf9c37a3b0,0xa22fa0cf22972042,0xa13fa1d021bc2155,0x23f60f2ea3fe172a,0x236f1cdca3c6995c,0xa30e2072222fa1a8,0xa3f61a3e23a89e1f
.quad 0x1f8ba3799b8f23f3,0x22b7a129a16a2286,0x164623bf9e54a2c6,0x9fef23791aafa3fd,0xa113a12922f21d49,0x1162a3ec1d122300,0x23a81561a3f01d49,0x1ebd2264a20a9fbd
.quad 0x9e54a3d98b2e23cd,0xa396a01121e42286,0x219422a79e54a3cd,0x23fb1bfea341a0a1,0xa341a07221e42241,0xa3de0f2e23f01c6e,0x23fb1a3ea3969ef1,0x23419cdca3de132d
.quad 0xa3a81a3e23f68000,0xa22f2072230e9e1f,0x2253a072a2f21ef1,0x20b8a21da1942155,0xa02922a720b8a241,0x9dea234d1f25a300,0x19cda3d99aaf23cd,0x1807a3ec98eb23e3
.quad 0x19cd23d99aafa3cd,0x180723ec98eba3e3,0xa029a2a720b82241,0x9deaa34d1f252300,0x22532072a2f29ef1,0x20b8221da194a155,0xa3a89a3e23f68000,0xa22fa072230e1e1f
.quad 0x23fb9a3ea3961ef1,0x23411cdca3de932d,0xa341207221e4a241,0xa3de8f2e23f09c6e,0x2194a2a79e5423cd,0x23fb9bfea34120a1,0x9e5423d98b2ea3cd,0xa396201121e4a286
.quad 0xa2f21cdc23f6172a,0x9aaf234d20b8a155,0x22539f58a3a8172a,0x19cda379a02921f7,0xa19420cf230e9d49,0x98eb239f1f25a286,0x20b8a1d0a22f2042,0x1807a3bf9dea2300
.quad 0x9f8b22a72113a1a8,0x964623d91ca5a364,0x1d7fa34d9f8b22c6,0x147ca3ec9aaf23b0,0x9aaf23bf1ca5a38d,0x916223f91807a3e3,0x147ca3f9964623f3,0xb2ea3ff916223fd
.quad 0x147c23f99646a3f3,0xb2e23ff9162a3fd,0x9aafa3bf1ca5238d,0x9162a3f9180723e3,0x1d7f234d9f8ba2c6,0x147c23ec9aafa3b0,0x9f8ba2a7211321a8,0x9646a3d91ca52364
.quad 0x20b821d0a22fa042,0x180723bf9deaa300,0xa194a0cf230e1d49,0x98eba39f1f252286,0x22531f58a3a8972a,0x19cd2379a029a1f7,0xa2f29cdc23f6972a,0x9aafa34d20b82155
.quad 0x20b8234d9aafa400,0x23f61cdca2f2a155,0xa029a37919cd2400,0xa3a89f58225321f7,0x1f25239f98eba400,0x230e20cfa194a286,0x9deaa3bf18072400,0xa22fa1d020b82300
.quad 0x1ca523d99646a400,0x211322a79f8ba364,0x9aafa3ec147c2400,0x9f8ba34d1d7f23b0,0x180723f99162a400,0x1ca523bf9aafa3e3,0x9162a3ff0b2e2400,0x9646a3f9147c23fd
.quad 0x916223ff0b2ea400,0x964623f9147ca3fd,0x1807a3f991622400,0x1ca5a3bf9aaf23e3,0x9aaf23ec147ca400,0x9f8b234d1d7fa3b0,0x1ca5a3d996462400,0x2113a2a79f8b2364
.quad 0x9dea23bf1807a400,0xa22f21d020b8a300,0x1f25a39f98eb2400,0x230ea0cfa1942286,0xa029237919cda400,0xa3a81f582253a1f7,0x20b8a34d9aaf2400,0x23f69cdca2f22155
.quad 0x21e4a011a396172a,0x8b2ea3d99e542286,0xa3411bfe23fb172a,0x9e5422a72194a0a1,0x23f00f2ea3de9d49,0x21e4a072a3411c6e,0xa3de9cdc23412042,0xa3961a3e23fb132d
.quad 0x230e2072a22fa1a8,0x23f61a3ea3a89e1f,0xa194a21d20b822c6,0xa2f2a07222532155,0x1f25234d9deaa38d,0x20b822a7a029a300,0x98eba3ec180723f3,0x9aafa3d919cd23e3
.quad 0x98eb23ec1807a3f3,0x9aaf23d919cda3e3,0x1f25a34d9dea238d,0x20b8a2a7a0292300,0xa194221d20b8a2c6,0xa2f220722253a155,0x230ea072a22f21a8,0x23f69a3ea3a81e1f
.quad 0xa3de1cdc2341a042,0xa3969a3e23fb932d,0x23f08f2ea3de1d49,0x21e42072a3419c6e,0xa3419bfe23fb972a,0x9e54a2a7219420a1,0x21e42011a396972a,0x8b2e23d99e54a286
.quad 0xa20aa2641ebd23cd,0xa3f0956123a81fbd,0x1d1223ec1162a3cd,0x22f22129a113a300,0x1aafa3799fef2241,0x9e54a3bf164623fd,0xa16a212922b79ef1,0x9b8f23791f8ba286
.quad 0x23a89a3ea3f68000,0x222fa072a30e1e1f,0xa3c69cdc236f1ef1,0xa3fe8f2e23f6195c,0x21bc21d0a13fa241,0x229720cfa22fa155,0x9c37a3bf1b8f23cd,0x9d12a39f1ca523b0
.quad 0x9c3723bf1b8fa3cd,0x9d12239f1ca5a3b0,0x21bca1d0a13f2241,0x2297a0cfa22f2155,0xa3c61cdc236f9ef1,0xa3fe0f2e23f6995c,0x23a81a3ea3f68000,0x222f2072a30e9e1f
.quad 0xa16aa12922b71ef1,0x9b8fa3791f8b2286,0x1aaf23799fefa241,0x9e5423bf1646a3fd,0x1d12a3ec116223cd,0x22f2a129a1132300,0xa20a22641ebda3cd,0xa3f0156123a89fbd
.quad 0xa08a217f22d59d49,0x1b8f23ff19cda364,0x23d38f2ea3e89d49,0x20b8a17fa2b71e1f,0xa2d5a129213f22c6,0xa3fb956123c61e1f,0x1c3723ec8b2ea3f3,0x219422649fefa364
.quad 0x1f8ba2a7a11321a8,0x1646a3d99ca52364,0xa3961bfe23de972a,0xa297201123299e1f,0x23411f58a2f2a042,0x23b81cdca3839e1f,0x9deaa3791d7f238d,0x9ebda34d1e542364
.quad 0x9dea23791d7fa38d,0x9ebd234d1e54a364,0x23419f58a2f22042,0x23b89cdca3831e1f,0xa3969bfe23de172a,0xa297a01123291e1f,0x1f8b22a7a113a1a8,0x164623d99ca5a364
.quad 0x1c37a3ec8b2e23f3,0x2194a2649fef2364,0xa2d52129213fa2c6,0xa3fb156123c69e1f,0x23d30f2ea3e81d49,0x20b8217fa2b79e1f,0xa08aa17f22d51d49,0x1b8fa3ff19cd2364
.quad 0x230e2129a0e6a335,0x23839879a3fb9c6e,0x9646a3f99c372335,0xa1e4a2641f2523b0,0xa22f2011236f9b1f,0x9c37234d205aa1f7,0x23a81e89a2d5a0fd,0x23d39561a3fe995c
.quad 0x9ca5a3d916462400,0xa113a2a71f8b2364,0xa11321d021e4a0fd,0x9e54231c2029a286,0x23f61879a3de9b1f,0x23fb8f2ea400932d,0x9f8ba31c1f252335,0xa029a2e41fef2300
.quad 0x9f8b231c1f25a335,0xa02922e41fefa300,0x23f69879a3de1b1f,0x23fb0f2ea400132d,0xa113a1d021e420fd,0x9e54a31c20292286,0x9ca523d91646a400,0xa11322a71f8ba364
.quad 0x23a89e89a2d520fd,0x23d31561a3fe195c,0xa22fa011236f1b1f,0x9c37a34d205a21f7,0x964623f99c37a335,0xa1e422641f25a3b0,0x230ea129a0e62335,0x23831879a3fb1c6e
.quad 0x1deaa2a7a1bc2042,0x9f25a3bf116223e3,0xa4009a3e236f2042,0xa20a20112383995c,0x1d7f23d99162a3f3,0x2297217fa0e6a300,0x220aa072a3291d49,0x1d7fa31ca08a21f7
.quad 0xa30ea072222f21a8,0xa3f69a3e23a81e1f,0x980723d91c37a38d,0x18eb23f98b2ea3fd,0x23c69a3ea3e8172a,0x23599db5a3961c6e,0xa08aa2a7205a22c6,0xa0e6a26420b82286
.quad 0xa08a22a7205aa2c6,0xa0e6226420b8a286,0x23c61a3ea3e8972a,0x23591db5a3969c6e,0x9807a3d91c37238d,0x18eba3f98b2e23fd,0xa30e2072222fa1a8,0xa3f61a3e23a89e1f
.quad 0x220a2072a3299d49,0x1d7f231ca08aa1f7,0x1d7fa3d9916223f3,0x2297a17fa0e62300,0xa4001a3e236fa042,0xa20aa0112383195c,0x1dea22a7a1bca042,0x9f2523bf1162a3e3
.quad 0xa3b89f58222f2241,0xa2b71db523e8132d,0x9807239f1f8ba241,0x208a234d9b8fa3fd,0x24001879a3a89ef1,0x22759f58a396195c,0x98eba3ff964623cd,0xa0e6a2e41e5423b0
.quad 0xa3a81a3e23f68000,0xa22f2072230e9e1f,0x1ebd23799ca5a3cd,0x213f2264a05aa300,0x22b7a011a30e1ef1,0x21e4a129a25320a1,0xa13fa21d21132241,0xa194a1d0216a21f7
.quad 0xa13f221d2113a241,0xa19421d0216aa1f7,0x22b72011a30e9ef1,0x21e42129a253a0a1,0x1ebda3799ca523cd,0x213fa264a05a2300,0xa3a89a3e23f68000,0xa22fa072230e1e1f
.quad 0x98eb23ff9646a3cd,0xa0e622e41e54a3b0,0x24009879a3a81ef1,0x22751f58a396995c,0x9807a39f1f8b2241,0x208aa34d9b8f23fd,0xa3b81f58222fa241,0xa2b79db523e8932d
.quad 0x98eb2379205aa1a8,0x2113231c9c37a3fd,0x23c61e89a297a1a8,0x230e9cdca3f0932d,0x1d12a31ca0b821a8,0x9ca5a3ec8b2e23e3,0xa359a011225321a8,0xa3f68f2e23e81c6e
.quad 0x9f8b22a72113a1a8,0x964623d91ca5a364,0x22b720cfa20aa1a8,0x23a81db5a3419fbd,0x20e6a21da16a21a8,0x1f8ba2e4a05a2286,0xa1e4a17f21bc21a8,0xa22fa129220a2155
.quad 0xa1e4217f21bca1a8,0xa22f2129220aa155,0x20e6221da16aa1a8,0x1f8b22e4a05aa286,0x22b7a0cfa20a21a8,0x23a89db5a3411fbd,0x9f8ba2a7211321a8,0x9646a3d91ca52364
.quad 0xa35920112253a1a8,0xa3f60f2e23e89c6e,0x1d12231ca0b8a1a8,0x9ca523ec8b2ea3e3,0x23c69e89a29721a8,0x230e1cdca3f0132d,0x98eba379205a21a8,0x2113a31c9c3723fd
.quad 0x23fe1bfea329a0fd,0x2194a072a36f195c,0x1d7fa2e4a13f20fd,0x9deaa3d90b2e23e3,0xa253a1d0208a2335,0xa3fe9a3e23831fbd,0xa2971f5823839b1f,0x9f2522a7213fa155
.quad 0x1ca523d99646a400,0x211322a79f8ba364,0x24001561a3e89b1f,0x23b89a3ea3f0132d,0x1d12a3799e542335,0x18eba3d99b8f23b0,0xa275a0cf225320fd,0xa2b7a072229720a1
.quad 0xa27520cf2253a0fd,0xa2b720722297a0a1,0x1d1223799e54a335,0x18eb23d99b8fa3b0,0x24009561a3e81b1f,0x23b81a3ea3f0932d,0x1ca5a3d996462400,0x2113a2a79f8b2364
.quad 0xa2979f5823831b1f,0x9f25a2a7213f2155,0xa25321d0208aa335,0xa3fe1a3e23839fbd,0x1d7f22e4a13fa0fd,0x9dea23d90b2ea3e3,0x23fe9bfea32920fd,0x21942072a36f995c
.quad 0x947ca3ec9d7f22c6,0xa253a21d1f8b23b0,0xa329a0cf216a22c6,0xa3b8156123f61c6e,0xa2b71e8923b8972a,0x9dea22e42113a155,0x116223f91aafa38d,0x2029234d9ca5a3e3
.quad 0x230e2072a22fa1a8,0x23f61a3ea3a89e1f,0x22d59f58a3591d49,0x216aa17fa22f20a1,0x8b2ea3ff947c23f3,0x99cda3ec164623fd,0xa2f2a01122d52042,0xa3299f58230e1fbd
.quad 0xa2f2201122d5a042,0xa3291f58230e9fbd,0x8b2e23ff947ca3f3,0x99cd23ec1646a3fd,0x22d51f58a3599d49,0x216a217fa22fa0a1,0x230ea072a22f21a8,0x23f69a3ea3a81e1f
.quad 0x1162a3f91aaf238d,0x2029a34d9ca523e3,0xa2b79e8923b8172a,0x9deaa2e421132155,0xa32920cf216aa2c6,0xa3b8956123f69c6e,0x947c23ec9d7fa2c6,0xa253221d1f8ba3b0
.quad 0xa3de8f2e23c61ef1,0xa02921d022979e1f,0xa05a21d022759ef1,0x18eb23ff1aafa364,0x1b8f23f9147ca3cd,0x220a221da029a364,0x22f220cfa1bca241,0x24001879a3b89e1f
.quad 0x23a89a3ea3f68000,0x222fa072a30e1e1f,0x1f25a2e4a08a2241,0x19cda3bf9d122364,0x9d7fa39f1c3723cd,0x9fefa31c1ebd2364,0xa3599e8923411ef1,0xa3839db5236f1e1f
.quad 0xa3591e8923419ef1,0xa3831db5236f9e1f,0x9d7f239f1c37a3cd,0x9fef231c1ebda364,0x1f2522e4a08aa241,0x19cd23bf9d12a364,0x23a81a3ea3f68000,0x222f2072a30e9e1f
.quad 0x22f2a0cfa1bc2241,0x24009879a3b81e1f,0x1b8fa3f9147c23cd,0x220aa21da0292364,0xa05aa1d022751ef1,0x18eba3ff1aaf2364,0xa3de0f2e23c69ef1,0xa029a1d022971e1f
.quad 0x1ca523f91807a38d,0x234120cfa13fa300,0x222f221d9fefa38d,0x23fe1879a3969fbd,0x23f61bfea359a042,0x22f29db5a3d3132d,0x230e9db5a3c6172a,0x205aa21da1e420a1
.quad 0x1f8ba2a7a11321a8,0x1646a3d99ca52364,0x9646a3ff916223f3,0x9deaa39f1b8f23e3,0xa113a264208a22c6,0xa20aa17f219421f7,0xa3a89cdc23961d49,0xa3c69bfe23b81c6e
.quad 0xa3a81cdc23969d49,0xa3c61bfe23b89c6e,0xa1132264208aa2c6,0xa20a217f2194a1f7,0x964623ff9162a3f3,0x9dea239f1b8fa3e3,0x1f8b22a7a113a1a8,0x164623d99ca5a364
.quad 0x230e1db5a3c6972a,0x205a221da1e4a0a1,0x23f69bfea3592042,0x22f21db5a3d3932d,0x222fa21d9fef238d,0x23fe9879a3961fbd,0x1ca5a3f91807238d,0x2341a0cfa13f2300
.quad 0x23599a3ea4009b1f,0x1d12a2e4a16a20a1,0x21bca072a3591b1f,0x147ca3bf9ebd2286,0x1ebda2a7a16a20fd,0x99cda3ff980723b0,0x147ca3d99d122335,0x9ebda39f19cd23fd
.quad 0x9ca5a3d916462400,0xa113a2a71f8b2364,0xa0e6a2a71fef2335,0xa275a12921bc21f7,0xa2d5a072227520fd,0xa36f9e8923291fbd,0xa3de9a3e23d31b1f,0xa3f0987923e8195c
.quad 0xa3de1a3e23d39b1f,0xa3f0187923e8995c,0xa2d520722275a0fd,0xa36f1e8923299fbd,0xa0e622a71fefa335,0xa275212921bca1f7,0x9ca523d91646a400,0xa11322a71f8ba364
.quad 0x147c23d99d12a335,0x9ebd239f19cda3fd,0x1ebd22a7a16aa0fd,0x99cd23ff9807a3b0,0x21bc2072a3599b1f,0x147c23bf9ebda286,0x23591a3ea4001b1f,0x1d1222e4a16aa0a1
.quad 0x9fefa39f164623f3,0xa3d39e89227521f7,0xa0e6a31c1ca523f3,0xa3de9db522d52155,0xa1bca2641f8b238d,0xa3e89cdc232920a1,0xa275a17f211322c6,0xa3f09bfe236f1fbd
.quad 0xa30ea072222f21a8,0xa3f69a3e23a81e1f,0xa3839e89230e2042,0xa3fb987923d31c6e,0xa3d39bfe23a81d49,0xa3fe956123f0195c,0xa3fb956123f6172a,0xa4008f2e23fe132d
.quad 0xa3fb156123f6972a,0xa4000f2e23fe932d,0xa3d31bfe23a89d49,0xa3fe156123f0995c,0xa3831e89230ea042,0xa3fb187923d39c6e,0xa30e2072222fa1a8,0xa3f61a3e23a89e1f
.quad 0xa275217f2113a2c6,0xa3f01bfe236f9fbd,0xa1bc22641f8ba38d,0xa3e81cdc2329a0a1,0xa0e6231c1ca5a3f3,0xa3de1db522d5a155,0x9fef239f1646a3f3,0xa3d31e892275a1f7
.quad 0x213fa31c9b8f2400,0x23f69879a36f20a1,0x21bca2e49c372400,0x23a80f2ea3c61fbd,0x222fa2a79ca52400,0x230e1a3ea3f61e1f,0x2297a2649d122400,0x222f1db5a3fe1c6e
.quad 0x22f2a21d9d7f2400,0x21132011a3de195c,0x2341a1d09dea2400,0x1f8b2129a396132d,0x2383a17f9e542400,0x1ca5221da329932d,0x23b8a1299ebd2400,0x164622e4a297995c
.quad 0x23dea0cf9f252400,0x96462379a1e49c6e,0x23f6a0729f8b2400,0x9ca523d9a1139e1f,0x2400a0119fef2400,0x9f8b23ffa0299fbd,0x23fb9f58a0292400,0xa11323ec9e54a0a1
.quad 0x23e89e89a05a2400,0xa22f239f9c37a155,0x23c69db5a08a2400,0xa30e231c9807a1f7,0x23969cdca0b82400,0xa3a822640b2ea286,0x23599bfea0e62400,0xa3f6217f18eba300
.quad 0x1fef21d0a2b79d49,0x9ebd23d99162a3b0,0x1aaf231ca16aa042,0xa20a22a71d12a3fd,0x964623d99f8ba1a8,0xa3a820722113a364,0x9e5423f99b8fa2c6,0xa3f01a3e22f2a1f7
.quad 0xa13f23790b2ea38d,0xa2d59a3e23e89fbd,0xa2d522641c37a3f3,0xa08aa07223d3995c,0xa3c620cf1fefa3f3,0x99cda2a722b7195c,0xa3fb1db52194a38d,0x1b8fa3d920b81fbd
.quad 0xa36f156122d5a2c6,0x20e6a3d91c3721f7,0xa22f9a3e23a8a1a8,0x230ea2a796462364,0xa05a9f5823fea042,0x23fba0729f2523fd,0x9c37a17f23d39d49,0x23839a3ea1e423b0
.quad 0x1162a2e42329972a,0x21bc1a3ea36f2286,0x1d7fa3bf220a172a,0x1dea2072a40020a1,0x20e6a3ff208a1d49,0x916222a7a3831c6e,0x2297a39f1d7f2042,0x9f2523d9a20a932d
.quad 0xa3de1e892253a241,0xa1bca01123a8132d,0xa383956123de9ef1,0x98eba34d211320a1,0xa113a07223a88000,0x1f8ba3d916462364,0x98eba31c21bc1ef1,0x2341a17f9f8b23e3
.quad 0x1deaa3ff1d122241,0x23d39879a30e21f7,0x2253a2e498eb23cd,0x213f1f58a3f61c6e,0x23f0a011a0b823cd,0x147c231ca22f9c6e,0x23598f2ea3292241,0xa05a23ec9ca5a1f7
.quad 0x20b81f58a4001ef1,0xa38321d01ca5a3e3,0x164622a7a30e0000,0xa3a81a3e222fa364,0x9ebd23f9a08a9ef1,0xa0b89e8923f6a0a1,0xa297234d9807a241,0xb2ea2e4230e932d
.quad 0xa3fb20cf1d7fa3cd,0x20e6a3f91f8b1fbd,0xa329187921e4a3cd,0x23b8a21d96462300,0xa05a9db523b8a241,0x236f9bfea11323fd,0x9162a21d23d39ef1,0x20291db5a3a82286
.quad 0x18eba3f91d1222c6,0x2329a129a0b82364,0x2253a2649dea23f3,0x23591879a3f01e1f,0x23f69a3ea30e21a8,0x1ca522a7a22f9e1f,0x213f2011a3d3172a,0xa05a23bf947ca364
.quad 0x9162239fa0e6a042,0xa3f01f58216aa364,0xa1bc234d1162a38d,0xa1e49db524009e1f,0xa4001e89216aa38d,0x1162a37921941e1f,0xa1e49cdc23f0a042,0x2253a31c91622364
.quad 0x947ca2e422b7172a,0x23d39bfea20a2364,0x2113a3d91ca521a8,0x1f8b2072a3f61e1f,0x23f0a0cf9e5423f3,0x9dea23eca0e69e1f,0x22751561a32922c6,0xa396221d18eba364
.quad 0x19cd21d0a3c61d49,0xa2d50f2e2297a364,0xa05a23ffa0b89d49,0x98eba1d023d39e1f,0xa3c6221d147ca2c6,0x213fa3f920291e1f,0xa2f218792194a3f3,0x2400a0cf9c372364
.quad 0x230e1bfea4001b1f,0x18072379a08aa155,0x16462379a0b8a0fd,0xa297221d1ebda3e3,0xa22f22a71ca5a400,0xa30e9a3e23f69e1f,0xa3a80f2e2383a0fd,0xb2ea39f20b820a1
.quad 0x9ca5a26422b71b1f,0x2329a1d09e5423fd,0x2113a39f147c2335,0x22751bfea3f01fbd,0x23f69cdca20a2335,0x98eb23bfa0e69fbd,0x1f8b20cfa3d31b1f,0xa396217f1deaa3fd
.quad 0x9f8b23ff9ebda0fd,0xa1bc9cdc23e8a0a1,0xa3f620721f8ba400,0x1ca5a3d921131e1f,0xa1139db523e8a0fd,0x23dea1299d7f23e3,0x1ca5a3bf21bc1b1f,0x20e61db5a3de2155
.quad 0x23a8a21d98072335,0x9ebd23eca13f9c6e,0x222f1561a2f22335,0xa3fe20cf1d12a3b0,0x964622e4a3591b1f,0x9fef9e8923d3a1f7,0xa30e234d9b8fa0fd,0x205aa3f9216a195c
.quad 0xa1e422a71d7fa3f3,0xa3d30f2e23b89fbd,0xa3299a3e23fb9d49,0x9162a39f205a2155,0x1646a3d91f8b21a8,0x23a8a072a1132364,0x23b8a072a0e6238d,0x20292129a36f932d
.quad 0x20b82072a3c6172a,0xa194234d147ca3b0,0xa05a23d999cda2c6,0xa2f2987923c6a0a1,0xa3d31a3e2297a2c6,0x1c37a3ec202920a1,0x98eba2a722d5172a,0x24009e89a13f23b0
.quad 0x22f2a2a79807238d,0x1b8f221da359132d,0x222f1a3ea3a821a8,0xa30e22a71646a364,0x9d1223d9a13f9d49,0xa16a9cdc23d3a155,0xa3fe20721ebda3f3,0x205aa3ff1fef1fbd
.quad 0x9e54a0722400a042,0x23969bfea16a23e3,0x21bca3d91e542042,0x947c22e4a341195c,0x23419a3ea16a23f3,0xa3de21d01807a300,0x947c22a7a3961d49,0x9ebd9f5823dea1f7
.quad 0x9e54a264222f1ef1,0x2029a39f947c23e3,0x22d5a1d09f8b23cd,0x22f21bfea4001c6e,0x21132072a3a80000,0x9f8b23d99646a364,0xa16a234d1646a3cd,0xa329987923de9fbd
.quad 0xa2979bfe23f69ef1,0x1ebda3f91c372286,0x1f25a3f91ca52241,0x23590f2ea3832155,0x23969561a30e2241,0x9dea23ff9ebda155,0x99cd23bfa1139ef1,0xa383156122f2a286
.quad 0xa3fe1e892113a3cd,0x1d12a3ec208a1fbd,0x9646a2a7230e8000,0x23a89a3ea22f2364,0x23c6a17f9ca523cd,0x9c3723bfa1949c6e,0x1dea20cfa3f61ef1,0xa3c61cdc213fa3e3
.quad 0xa2f2231c9646a241,0x1aafa3792275132d,0xa0e69cdc23a8a241,0x23de9e89a02923fd,0x2194a3ec1f8b1ef1,0x98eb231ca329195c,0x22758f2ea22f23cd,0xa3f020111deaa3b0
.quad 0x23fb9cdca2d521a8,0x211320cfa359995c,0x8b2e23bf9fefa1a8,0xa30e217f2029a3b0,0xa3f61a3e230ea1a8,0x9ca5a2a7222f1e1f,0x19cda3ec1f2521a8,0x23f69e89a1e42300
.quad 0x23b89561a34121a8,0x964623bfa08aa0a1,0x9d7f23ff9e54a1a8,0xa3a815612329a1f7,0xa3418f2e236fa1a8,0x1f8ba3f91d1221f7,0x1fefa3f91d7f21a8,0x222f1bfea3de20a1
.quad 0x22971879a39621a8,0xa22f234d9162a300,0xa11323d99ca5a1a8,0x9f8ba07223f69e1f,0xa1bc9bfe23b8a1a8,0x23a8a1d09b8f23b0,0x220aa39f1b8f21a8,0x16462264a36f195c
.quad 0x20b81db5a3d321a8,0xa3f61f581fefa3fd,0xa2d5234d99cda1a8,0x1ca5a39f2253132d,0x9f259f5823e8a1a8,0x230e9879a1bc23e3,0x236fa2e4180721a8,0xa11323ffa0b89c6e
.quad 0x9c3723ff9aafa335,0xa3832072216aa300,0xa2b79cdc23fe9b1f,0x147ca3d91f2521f7,0x222fa2a79ca52400,0x230e1a3ea3f61e1f,0x1dea221da2d59b1f,0xa25322a71c37a3fd
.quad 0xa3fb1e8921bca335,0x9b8fa2a722751c6e,0x1b8fa3ec1fef20fd,0x23de9a3ea2b72286,0x22d51879a3b820fd,0xa08a23d99aafa286,0xa20a234d8b2ea335,0xa029a07223e89c6e
.quad 0x9e54a12923c69b1f,0x23f0a0729fef23fd,0x23f6a0729f8b2400,0x9ca523d9a1139e1f,0x9aaf239fa1e49b1f,0xa20a9a3e2396a1f7,0xa2f20f2e22b7a335,0x2341a2a791622300
.quad 0x21e4a3bf1d1220fd,0xb2e22a7a359195c,0x1ebd2011a3fb20fd,0xa3591a3e2194a3e3,0xa3f0217f19cda335,0x21e4a3d91ebd1fbd,0x19cda31c23419b1f,0x1d122072a3fb2155
.quad 0xa2979db523f0972a,0x8b2ea3bf1f8b21f7,0x2341a129a08a238d,0x22751db5a3f6195c,0x964623d99f8ba1a8,0xa3a820722113a364,0xa2759cdc24009d49,0x1d7fa3ff1ca52286
.quad 0x2359a17f9f2523f3,0x205a20cfa3a8132d,0x980723bfa0b8a042,0xa3fb1cdc222fa300,0xa2539bfe23e8a042,0x213fa39f16462300,0x236fa1d09d1223f3,0x1aaf2264a30e932d
.quad 0x98eb239fa1949d49,0xa3410f2e230ea286,0xa22f9a3e23a8a1a8,0x230ea2a796462364,0x2383a21d99cd238d,0x98eb2379a22f995c,0x99cd2379a253972a,0xa1949bfe23a8a1f7
.quad 0xa20a98792341a2c6,0x23f0a1299ca523b0,0x2396a264916222c6,0x9fef23f9a1139c6e,0x9aaf234da2f2172a,0x9e54a01123f6a155,0xa1e4956122b7a38d,0x23c69e899f8b23e3
.quad 0x2275a21d9f2523cd,0x23961561a3e81e1f,0x980723ec9e54a241,0xa36f20cf20e6a364,0xa113a07223a88000,0x1f8ba3d916462364,0x23fb9bfea2b72241,0x1aaf22e4a20a9e1f
.quad 0xa1e4231c1807a3cd,0xa2539cdc23fe9e1f,0xb2ea379216a1ef1,0x23fe9e89a1942364,0x21bc1db5a3fe1ef1,0xa1e4234d0b2ea364,0xa3fe1f5820e6a3cd,0x1807a39f216a1e1f
.quad 0x213fa3bf1aaf2241,0x205a2011a3fb1e1f,0x164622a7a30e0000,0xa3a81a3e222fa364,0xa2539879236fa241,0x2359a26498072364,0x23e8a1299d1223cd,0x9f2523f9a0b89e1f
.quad 0xa08a23ffa0299ef1,0x9b8fa17f23de9e1f,0x9aafa17f23e89ef1,0x22750f2ea2b72364,0x22d59561a20a23cd,0xa3fb21291b8fa364,0xa3b822648b2ea241,0x21bca3ec1fef1e1f
.quad 0x1ca522e4a194a042,0xa0e6234d19cda3fd,0xa22f9e8923e8972a,0x19cda3f91d7f2286,0x23f69a3ea30e21a8,0x1ca522a7a22f9e1f,0xa30e21d01ebda3f3,0xa1949f5823e8995c
.quad 0x1f8ba3ec1aaf22c6,0x23968f2ea36f2155,0x1646231ca20a9d49,0xa3e8201120e6a3b0,0xa1139f5823fb9d49,0x2275a2e4980723b0,0x23a89879a2b722c6,0x9f2523ff9e54a155
.quad 0xa3a8217f1d7fa3f3,0x8b2ea31c2275195c,0x2113a3d91ca521a8,0x1f8b2072a3f61e1f,0x9646234da275972a,0xa29795612341a286,0x9f8ba0112400a042,0x23f09e89a08a23fd
.quad 0x230e9561a253238d,0xa3832264147ca300,0xa3f621291c37a38d,0x216aa3ec1f251fbd,0x222fa3bf1dea2042,0x9c372379a2b7132d,0x9ca52379a2d5172a,0x9aafa12923fea0a1
.quad 0xa3fe1a3e2341a0fd,0xa05aa17f22f21c6e,0x2396a072a13f2335,0x21e41f58a3d3132d,0xa22f22a71ca5a400,0xa30e9a3e23f69e1f,0x1fefa3d918072335,0x23c69561a3592155
.quad 0x98eb23d9a029a0fd,0xa4001db5220aa300,0x9aafa2a722971b1f,0x23b8a0cfa02923e3,0x205a2072a3de1b1f,0xa2f222641b8fa3e3,0xa2759a3e23c6a0fd,0x21bca379147c2300
.quad 0x23b89a3ea2532335,0xa02923f99deaa155,0xa3f620721f8ba400,0x1ca5a3d921131e1f,0x2329a2a7947c2335,0x9162231ca2b7932d,0xa16a23d99d7fa0fd,0x9aafa1d023b89c6e
.quad 0x1deaa3d921941b1f,0x1f252011a3fe20a1,0x8b2e22a7a36f1b1f,0xa13f9bfe2383a286,0x9d7fa07223fea0fd,0x22978f2ea25323b0,0x213f1a3ea3292335,0xa3831cdc208aa3fd
.quad 0x1deaa3ec1646238d,0x23c69f58a20a2286,0x9b8f23ff9ca5a2c6,0xa3b820112194a300,0x1646a3d91f8b21a8,0x23a8a072a1132364,0x11622379a113a042,0xa39620cf208aa3b0
.quad 0x99cda2e4222f1d49,0x2383a1299fef23e3,0x1d12221da30e972a,0xa36f217f1ebda3fd,0x9f25a12923a8972a,0x2359a1d09d7f23fd,0x208a2011a3f61d49,0xa341221d1c37a3e3
.quad 0xa16a9db523f6a042,0x2329a26499cd23b0,0x222f1a3ea3a821a8,0xa30e22a71646a364,0xa2d58f2e230ea2c6,0x22f2a2e48b2e2300,0x23599879a22f238d,0xa2d5231c947ca286
.quad 0xa3b81cdc2113a3f3,0x22b7a34d18eb21f7,0x23f09f589f8b23f3,0xa29723799b8fa155,0xa40020cf1ca5a38d,0x2275a39f1d1220a1,0x23e8a1d0964622c6,0xa25323bf9e549fbd
.quad 0x220a1f58a3c60000,0x964623ec9deaa286,0xa194a01123b88000,0x1ca5a3ff1b8f2300,0x21132072a3a80000,0x9f8b23d99646a364,0xa08aa0cf23968000,0x2113a379916223b0
.quad 0x1fef2129a3830000,0xa22f22e419cda3e3,0x9ebda17f236f8000,0x230ea21d9d1223fd,0x1d7f21d0a3590000,0xa3a821291f25a3fd,0x9c37a21d23418000,0x23f6a011a08a23e3
.quad 0x19cd2264a3290000,0xa3f61db5216aa3b0,0x9646a2a7230e8000,0x23a89a3ea22f2364,0xb2e22e4a2f20000,0xa30e0f2e22d5a300,0x147ca31c22d58000,0x222f1879a3592286
.quad 0x98eb234da2b70000,0xa1139cdc23b8a1f7,0x1b8fa37922978000,0x1f8b1f58a3f02155,0x9d12239fa2750000,0x9ca5a0cf2400a0a1,0x1e54a3bf22538000,0x164621d0a3e81fbd
.quad 0xa2f2217f205aa38d,0xa3419a3e23fe9c6e,0x23d39f58a1e422c6,0x213f2072a396932d,0xa3f61a3e230ea1a8,0x9ca5a2a7222f1e1f,0x23591561a3c62042,0x980723d99fefa155
.quad 0xa20a9db524009d49,0x2029a3d918eb2300,0x202920cfa3b8172a,0xa29722a71aafa3e3,0x9b8fa26422f2172a,0x23dea072a05a23e3,0x947c2379a1bc9d49,0xa3c61a3e2275a300
.quad 0x1deaa3f920292042,0x22531a3ea3b82155,0xa11323d99ca5a1a8,0x9f8ba07223f69e1f,0x22b7a31c116222c6,0x147c22a7a329132d,0xa3b821d01aafa38d,0x1d7fa3d9216a1c6e
.quad 0x23fea0119f2523f3,0xa19423d99deaa0a1,0xa3831bfe213fa3f3,0x236fa2a70b2e2286,0x22530f2ea297238d,0xa3fe20721d7fa3b0,0xa08a9cdc2383a2c6,0x23299a3ea13f23fd
.quad 0x99cda34d20e620fd,0x2194a2e49ca523fd,0x9d7f23f999cda335,0xa3e81e89222fa286,0x222fa2a79ca52400,0x230e1a3ea3f61e1f,0xa3e81f582194a335,0x9ebda1d0230e195c
.quad 0x236f0f2ea39620fd,0x9aaf23ec9f8ba155,0xa0e6a01123e89b1f,0x220aa31c964623b0,0x180722e4a2759b1f,0xa3fb1f582113a3b0,0x1e54a3ff1f2520fd,0x22b71879a3a82155
.quad 0xa275231c0b2ea335,0x9d7fa17f23a8995c,0x23f6a0729f8b2400,0x9ca523d9a1139e1f,0xa34115612297a335,0x2275a34d16462286,0x208a1e89a3f020fd,0xa40020111f8ba3fd
.quad 0x947ca26423839b1f,0x22531561a30e2300,0x9f2523eca16a9b1f,0x9c37a12923f69fbd,0x22b7a3791c3720fd,0x9dea23bfa22f932d,0xa3fe21291aafa335,0x22d5a3791ca520a1
.quad 0x23e89561a3962042,0x1f25221da2759e1f,0xa0e6a0cf236f172a,0x1e54a3ec18072364,0x964623d99f8ba1a8,0xa3a820722113a364,0x220aa2e49aaf23f3,0x22b71bfea3fb1e1f
.quad 0xa3fe1cdc2253a2c6,0x9807a31c21e41e1f,0x21941e89a3fe1d49,0xa16a23798b2ea364,0x8b2ea34d21e41d49,0x23fe9db5a1bc2364,0xa16a239f9807a2c6,0xa0e69f5823fe9e1f
.quad 0x23fba011a05a23f3,0x9aaf23bfa13f9e1f,0xa22f9a3e23a8a1a8,0x230ea2a796462364,0x18072264a359172a,0xa36f18792253a364,0x20b8a3f91f252042,0x1d122129a3e81e1f
.quad 0xa3de217f1b8fa38d,0x2029a3ff208a1e1f,0x22b78f2ea275238d,0xa3e8217f1aafa364,0x9b8fa12923fba042,0x220a1561a2d52364,0x9fef23eca1bc972a,0xb2ea26423b89e1f
.quad 0x9f8b23bf0b2ea3cd,0xa3f01db52297a1f7,0x23f69db5a2752241,0x208a2129a341995c,0xa113a07223a88000,0x1f8ba3d916462364,0x9ca523ff9d7fa241,0xa4001cdc2275a286
.quad 0x23a8a0cfa05a23cd,0x1f25217fa359932d,0xa22f9cdc23fb9ef1,0x20b8a3bf18072300,0x9646239fa13f9ef1,0xa3e81bfe2253a300,0x230ea2649aaf23cd,0x1d1221d0a36f132d
.quad 0xa30e8f2e2341a241,0x2194a39f18eb2286,0x164622a7a30e0000,0xa3a81a3e222fa364,0x222fa37918eb2241,0x19cd221da383195c,0xa3a81bfe2194a3cd,0x2253a37919cd21f7
.quad 0x1ca52129a3f01ef1,0xa3411879220aa3b0,0x2113a3f91fef1ef1,0x11622264a3961c6e,0xa3f620111e54a3cd,0x22f2a34d1aaf2155,0x1f8b1e89a3c62241,0xa2b7156121e4a3e3
.quad 0xa16aa0722383172a,0x1aafa3ff1c372300,0x9f2523d9947ca38d,0xa3fe1cdc22b7a1f7,0x23f69a3ea30e21a8,0x1ca522a7a22f9e1f,0x9c37a2a722531d49,0x22d5a21d9dea23fd
.quad 0xa27522a71b8fa3f3,0xa1bc9e8923fb9c6e,0x22b71a3ea3de2042,0x9fef23ec9b8fa286,0x1aafa3d9208a2042,0x23b89879a2d52286,0xa3e820722029a3f3,0xb2ea34d220a1c6e
.quad 0x1fef2072a3f01d49,0xa3c621291e54a3fd,0x2113a3d91ca521a8,0x1f8b2072a3f61e1f,0xa3961a3e220aa38d,0x21e4a39f1aaf21f7,0x116222a7a341172a,0xa2b78f2e22f2a300
.quad 0x2359a2a78b2e22c6,0x9d1223bfa1e4995c,0xa1949a3e2359a2c6,0x23fba0119ebd23e3,0x9ebd23d9a1e4972a,0x99cda17f23f09fbd,0x23fba0729d12238d,0xa341231c99cda155
.quad 0x2359a0cfa1132335,0x22d51cdca3fb195c,0xa029a17f230e1b1f,0x1fefa3bf0b2e23b0,0xa22f22a71ca5a400,0xa30e9a3e23f69e1f,0x21e41e89a3f61b1f,0x9f2523ec99cda300
.quad 0x208aa3bf16462335,0x23411561a3b820a1,0xa329956123a8a0fd,0x1e54a3ff1d7f21f7,0x9d1223f99f8ba0fd,0xa36f0f2e2341a1f7,0x23de9bfea22f2335,0x9d7f23f99fefa0a1
.quad 0x1162a34d222f1b1f,0x23969879a2972300,0xa3f620721f8ba400,0x1ca5a3d921131e1f,0x1b8f21d0a3a81b1f,0xa3b81bfe21bca3b0,0x236fa26496462335,0x9b8f239fa20a995c
.quad 0x9fef9f5823f6a0fd,0x23d39db5a0b823fd,0xa253239f9ca5a0fd,0x19cda34d22d5932d,0x21bc1879a30e2335,0xa3e81f581f25a3e3,0x20b8a3ff21131b1f,0x980722e4a36f1c6e
.quad 0x147c239fa029a1a8,0xa22f22641e54a3e3,0x24009bfea2f221a8,0x1f8b21d0a2d59c6e,0x1646a3d91f8b21a8,0x23a8a072a1132364,0xa3de18792329a1a8,0x9646a34d216a1fbd
.quad 0x9c3723f99ebda1a8,0xa3f61bfe2297a286,0x23838f2ea35921a8,0x9ca523f99f25a155,0x1ebda3ff1dea21a8,0x230e1561a3962155,0xa2f295612383a1a8,0x2113a3bf19cd2286
.quad 0xa08a23ec9d12a1a8,0xa1139e8923fe9fbd,0x222f1a3ea3a821a8,0xa30e22a71646a364,0x2194a3bf1c3721a8,0x1ca5217fa3c61c6e,0xa13f9cdc23c6a1a8,0x23f6a0cf9dea23e3
.quad 0xa27523799aafa1a8,0x1646a31c22f2932d,0x20291e89a3de21a8,0xa3a81cdc20e6a3fd,0x2329a31c18eb21a8,0x9f8b23eca194995c,0x9deaa01123f0a1a8,0x222f0f2ea27523b0
.quad 0xa3b88f2e23d39ef1,0x9d7fa2a721e41fbd,0xa05a239f1162a3cd,0xa3fb1a3e2329a155,0x21132072a3a80000,0x9f8b23d99646a364,0x236fa129a02923cd,0x20e62072a3b8132d
.quad 0x947ca34d21941ef1,0x23c6a072a0b823b0,0xa3c6187922f2a241,0x19cda3d9205a20a1,0xa02923ec9c37a241,0xa2979a3e23d3a0a1,0x213f1e89a4001ef1,0xa2d522a718eba3b0
.quad 0x2359a21d9b8f23cd,0x180722a7a2f2932d,0x9646a2a7230e8000,0x23a89a3ea22f2364,0xa3d31cdc216aa3cd,0x213fa3d91d122155,0x9fef23ffa05a9ef1,0x9ebda07223fe9fbd
.quad 0x216a1bfea3962241,0xa40020721e54a3e3,0x2341a2e4147c2241,0x9e5423d9a1bc995c,0x9807a1d023de9ef1,0x216a1a3ea3412300,0xa3de1f581ebda3cd,0x2396a2a7147c21f7
.quad 0x208aa379980723f3,0x24009bfea30e2155,0x9ebda21d22971d49,0x20b8a379964623e3,0xa3f61a3e230ea1a8,0x9ca5a2a7222f1e1f,0xa0b8239f8b2ea38d,0xa3838f2e23a8a0a1
.quad 0x1e5421d0a329972a,0xa2b722641ca5a3fd,0x23f09bfea27522c6,0x947c239fa1139fbd,0x20e6a3bf18eb22c6,0x220a1cdca3f61fbd,0x9deaa17f2396972a,0x23d3a0cf9f8b23fd
.quad 0xa3e81cdc21bca38d,0x1ebda3ff1f8b20a1,0xa11323d99ca5a1a8,0x9f8ba07223f69e1f,0x1d7f2129a3de1d49,0xa3e81db52113a3e3,0x23de9db5a0e623f3,0xa1bc23bf9ca5a155
.quad 0x213fa3ec1ebd2042,0x1807221da3a81c6e,0x9d12a0cf23fea042,0x22f29561a22f23b0,0xa3d31e891fefa3f3,0x2359a2e4164621f7,0xa16a23f9a05a9d49,0x1b8fa34d230e995c
.quad 0x20b82129a3299b1f,0x9d1223f998eba364,0x23f09879a35920fd,0x1dea2264a2539e1f,0x222fa2a79ca52400,0x230e1a3ea3f61e1f,0x147ca3bf205a20fd,0x23d3a011a13f2364
.quad 0xa16a9f5823f09b1f,0x20e6a39f11622364,0xa4001db521e4a335,0x9162a34d21bc1e1f,0xa19423799162a335,0xa16a9e8924009e1f,0x1162231ca2539b1f,0xa3f01cdc21e4a364
.quad 0x220a1bfea3d320fd,0xa2b722e4147ca364,0x23f6a0729f8b2400,0x9ca523d9a1139e1f,0x20e6a3ec1dea20fd,0x1e5420cfa3f01e1f,0x98eba21d23969b1f,0x23299561a2752364
.quad 0xa2978f2e22d5a335,0x23c6a1d099cd2364,0xa3d321d018eba335,0x20b8a3ff205a1e1f,0xa02923f9a13f9b1f,0x947ca21d23c69e1f,0x1c3720cfa40020fd,0xa194987922f2a364
.quad 0xa3a8201121bca2c6,0xa2539e8923de932d,0xa113234d18eba3f3,0xa3de15612383a0a1,0x964623d99f8ba1a8,0xa3a820722113a364,0x1f8b217fa341972a,0xa1bc231c18eba3e3
.quad 0x230e1879a3d32042,0x9d1223ff9deaa1f7,0x23f69f58a13f238d,0x18eb22e4a2539c6e,0x222fa31c947c238d,0x20b82011a3f01c6e,0x1ca5a3ec205a2042,0x23290f2ea35921f7
.quad 0x9ca5a1d02383972a,0x24009f58a0b823e3,0xa22f9a3e23a8a1a8,0x230ea2a796462364,0xa3f61e8920b8a3f3,0x208aa3f91ebd20a1,0xa30e22e48b2ea2c6,0x1807a34d2297132d
.quad 0x9f8b23f9a0e69d49,0x9d7fa0cf23fb9fbd,0x1646221da3b81d49,0xa1e498792329a300,0x21131bfea36f22c6,0xa3b81db5205aa3fd,0x23a89db5a02923f3,0xa3d3221d1162a286
.quad 0x1162a3d91ebd2241,0x22b7a1d09fef23b0,0x9d12a2a7220a1ef1,0x216aa31c9aaf23fd,0xa113a07223a88000,0x1f8ba3d916462364,0xa2f29a3e23f09ef1,0x1b8fa3f91e5421f7
.quad 0xa3e81a3e22d5a241,0x8b2ea379213f1fbd,0xa3d32072208aa3cd,0x9c37a26422d5195c,0xa2b722a719cda3cd,0x9fefa0cf23c6995c,0xa0b823d99b8fa241,0xa1949db523fb9fbd
.quad 0x9c3723d9a0e69ef1,0xa2d59561236fa1f7,0x164622a7a30e0000,0xa3a81a3e222fa364,0x1f252072a3fb1ef1,0xa3fe1f58205aa3fd,0x21e41a3ea3832241,0xa3d3217f1c37a3b0
.quad 0x236f9a3ea1bc23cd,0xa32922e49162a286,0x2400a0729dea23cd,0xa20a23bf9d7fa0a1,0x2383a2a711622241,0xa08a23ffa0e69c6e,0x220aa3d91f251ef1,0x9d7f239fa297132d
.quad 0x236f1879a3f61d49,0x1b8f231ca13fa0a1,0x23c68f2ea3a82042,0x1c3722e4a1bc9fbd,0x23f69a3ea30e21a8,0x1ca522a7a22f9e1f,0x23fe9db5a22f22c6,0x1d122264a2979c6e
.quad 0x23dea011a113238d,0x1d7f221da2f2995c,0x2396a1299f8b23f3,0x1dea21d0a341932d,0x2329a21d9ca523f3,0x1e54217fa383132d,0x2297a2e49646238d,0x1ebd2129a3b8195c
.quad 0x21e4a379164622c6,0x1f2520cfa3de1c6e,0x2113a3d91ca521a8,0x1f8b2072a3f61e1f,0x2029a3ff1f8b2042,0x1fef2011a4001fbd,0x1e54a3ec21131d49,0x20291f58a3fb20a1
.quad 0x1c37a39f222f172a,0x205a1e89a3e82155,0x1807a31c230e972a,0x208a1db5a3c621f7,0x8b2ea26423a89d49,0x20b81cdca3962286,0x98eba17f23f6a042,0x20e61bfea3592300
.quad 0x220a1f58a3c68000,0x964623ec9deaa286,0x21942011a3b88000,0x9ca523ff9b8fa300,0x21132072a3a88000,0x9f8b23d99646a364,0x208a20cfa3968000,0xa11323791162a3b0
.quad 0x1fef2129a3838000,0xa22f22e419cda3e3,0x1ebd217fa36f8000,0xa30e221d1d12a3fd,0x1d7f21d0a3598000,0xa3a821291f25a3fd,0x1c37221da3418000,0xa3f62011208aa3e3
.quad 0x19cd2264a3298000,0xa3f61db5216aa3b0,0x164622a7a30e8000,0xa3a81a3e222fa364,0xb2e22e4a2f28000,0xa30e0f2e22d5a300,0x947c231ca2d58000,0xa22f98792359a286
.quad 0x98eb234da2b78000,0xa1139cdc23b8a1f7,0x9b8f2379a2978000,0x9f8b9f5823f0a155,0x9d12239fa2758000,0x9ca5a0cf2400a0a1,0x9e5423bfa2538000,0x9646a1d023e89fbd
.quad 0xa2f2217f205aa38d,0xa3419a3e23fe9c6e,0xa3d31f5821e4a2c6,0xa13fa0722396132d,0xa3f61a3e230ea1a8,0x9ca5a2a7222f1e1f,0xa359956123c6a042,0x1807a3d91fef2155
.quad 0xa20a9db524009d49,0x2029a3d918eb2300,0xa029a0cf23b8972a,0x2297a2a79aaf23e3,0x9b8fa26422f2172a,0x23dea072a05a23e3,0x147ca37921bc1d49,0x23c69a3ea2752300
.quad 0x1deaa3f920292042,0x22531a3ea3b82155,0x2113a3d91ca521a8,0x1f8b2072a3f61e1f,0x22b7a31c116222c6,0x147c22a7a329132d,0x23b8a1d09aaf238d,0x9d7f23d9a16a9c6e
.quad 0x23fea0119f2523f3,0xa19423d99deaa0a1,0x23839bfea13f23f3,0xa36f22a78b2ea286,0x22530f2ea297238d,0xa3fe20721d7fa3b0,0x208a1cdca38322c6,0xa3291a3e213fa3fd
.quad 0x99cda34d20e620fd,0x2194a2e49ca523fd,0x1d7fa3f919cd2335,0x23e89e89a22f2286,0x222fa2a79ca52400,0x230e1a3ea3f61e1f,0x23e89f58a1942335,0x1ebd21d0a30e995c
.quad 0x236f0f2ea39620fd,0x9aaf23ec9f8ba155,0x20e62011a3e81b1f,0xa20a231c1646a3b0,0x180722e4a2759b1f,0xa3fb1f582113a3b0,0x9e5423ff9f25a0fd,0xa2b7987923a8a155
.quad 0xa275231c0b2ea335,0x9d7fa17f23a8995c,0xa3f620721f8ba400,0x1ca5a3d921131e1f,0xa34115612297a335,0x2275a34d16462286,0xa08a9e8923f0a0fd,0x2400a0119f8b23fd
.quad 0x947ca26423839b1f,0x22531561a30e2300,0x1f25a3ec216a1b1f,0x1c372129a3f61fbd,0x22b7a3791c3720fd,0x9dea23bfa22f932d,0x23fea1299aaf2335,0xa2d523799ca5a0a1
.quad 0x23e89561a3962042,0x1f25221da2759e1f,0x20e620cfa36f972a,0x9e5423ec9807a364,0x964623d99f8ba1a8,0xa3a820722113a364,0xa20a22e41aafa3f3,0xa2b79bfe23fb9e1f
.quad 0xa3fe1cdc2253a2c6,0x9807a31c21e41e1f,0xa1949e8923fe9d49,0x216aa3790b2e2364,0x8b2ea34d21e41d49,0x23fe9db5a1bc2364,0x216aa39f180722c6,0x20e61f58a3fe1e1f
.quad 0x23fba011a05a23f3,0x9aaf23bfa13f9e1f,0x222f1a3ea3a821a8,0xa30e22a71646a364,0x18072264a359172a,0xa36f18792253a364,0xa0b823f99f25a042,0x9d12a12923e89e1f
.quad 0xa3de217f1b8fa38d,0x2029a3ff208a1e1f,0xa2b70f2e2275a38d,0x23e8a17f9aaf2364,0x9b8fa12923fba042,0x220a1561a2d52364,0x1fefa3ec21bc172a,0x8b2e2264a3b81e1f
.quad 0x9f8b23bf0b2ea3cd,0xa3f01db52297a1f7,0xa3f61db52275a241,0xa08aa1292341195c,0xa113a07223a88000,0x1f8ba3d916462364,0x1ca5a3ff1d7f2241,0x24009cdca2752286
.quad 0x23a8a0cfa05a23cd,0x1f25217fa359932d,0x222f1cdca3fb1ef1,0xa0b823bf9807a300,0x9646239fa13f9ef1,0xa3e81bfe2253a300,0xa30e22641aafa3cd,0x9d12a1d0236f932d
.quad 0xa30e8f2e2341a241,0x2194a39f18eb2286,0x9646a2a7230e8000,0x23a89a3ea22f2364,0x222fa37918eb2241,0x19cd221da383195c,0x23a89bfea19423cd,0xa253237999cda1f7
.quad 0x1ca52129a3f01ef1,0xa3411879220aa3b0,0xa11323f99fef9ef1,0x9162a26423969c6e,0xa3f620111e54a3cd,0x22f2a34d1aaf2155,0x9f8b9e8923c6a241,0x22b79561a1e423e3
.quad 0xa16aa0722383172a,0x1aafa3ff1c372300,0x1f25a3d9147c238d,0x23fe9cdca2b721f7,0x23f69a3ea30e21a8,0x1ca522a7a22f9e1f,0x1c3722a7a2539d49,0xa2d5221d1deaa3fd
.quad 0xa27522a71b8fa3f3,0xa1bc9e8923fb9c6e,0xa2b79a3e23dea042,0x1fefa3ec1b8f2286,0x1aafa3d9208a2042,0x23b89879a2d52286,0x23e8a072a02923f3,0x8b2e234da20a9c6e
.quad 0x1fef2072a3f01d49,0xa3c621291e54a3fd,0xa11323d99ca5a1a8,0x9f8ba07223f69e1f,0xa3961a3e220aa38d,0x21e4a39f1aaf21f7,0x9162a2a72341972a,0x22b70f2ea2f22300
.quad 0x2359a2a78b2e22c6,0x9d1223bfa1e4995c,0x21941a3ea35922c6,0xa3fb20111ebda3e3,0x9ebd23d9a1e4972a,0x99cda17f23f09fbd,0xa3fb20721d12a38d,0x2341a31c19cd2155
.quad 0x2359a0cfa1132335,0x22d51cdca3fb195c,0x2029217fa30e9b1f,0x9fef23bf8b2ea3b0,0xa22f22a71ca5a400,0xa30e9a3e23f69e1f,0xa1e49e8923f69b1f,0x1f25a3ec19cd2300
.quad 0x208aa3bf16462335,0x23411561a3b820a1,0x23291561a3a820fd,0x9e5423ff9d7fa1f7,0x9d1223f99f8ba0fd,0xa36f0f2e2341a1f7,0xa3de1bfe222fa335,0x1d7fa3f91fef20a1
.quad 0x1162a34d222f1b1f,0x23969879a2972300,0x23f6a0729f8b2400,0x9ca523d9a1139e1f,0x1b8f21d0a3a81b1f,0xa3b81bfe21bca3b0,0xa36f22641646a335,0x1b8fa39f220a195c
.quad 0x9fef9f5823f6a0fd,0x23d39db5a0b823fd,0x2253a39f1ca520fd,0x99cd234da2d5132d,0x21bc1879a30e2335,0xa3e81f581f25a3e3,0xa0b823ffa1139b1f,0x1807a2e4236f9c6e
.quad 0x147c239fa029a1a8,0xa22f22641e54a3e3,0xa4001bfe22f2a1a8,0x9f8ba1d022d51c6e,0x1646a3d91f8b21a8,0x23a8a072a1132364,0x23de9879a32921a8,0x1646234da16a9fbd
.quad 0x9c3723f99ebda1a8,0xa3f61bfe2297a286,0xa3830f2e2359a1a8,0x1ca5a3f91f252155,0x1ebda3ff1dea21a8,0x230e1561a3962155,0x22f21561a38321a8,0xa11323bf99cda286
.quad 0xa08a23ec9d12a1a8,0xa1139e8923fe9fbd,0xa22f9a3e23a8a1a8,0x230ea2a796462364,0x2194a3bf1c3721a8,0x1ca5217fa3c61c6e,0x213f1cdca3c621a8,0xa3f620cf1deaa3e3
.quad 0xa27523799aafa1a8,0x1646a31c22f2932d,0xa0299e8923dea1a8,0x23a89cdca0e623fd,0x2329a31c18eb21a8,0x9f8b23eca194995c,0x1dea2011a3f021a8,0xa22f8f2e2275a3b0
.quad 0xa3b88f2e23d39ef1,0x9d7fa2a721e41fbd,0x205aa39f916223cd,0x23fb9a3ea3292155,0x21132072a3a88000,0x9f8b23d99646a364,0xa36f21292029a3cd,0xa0e6a07223b8932d
.quad 0x947ca34d21941ef1,0x23c6a072a0b823b0,0x23c69879a2f22241,0x99cd23d9a05aa0a1,0xa02923ec9c37a241,0xa2979a3e23d3a0a1,0xa13f9e8924009ef1,0x22d5a2a798eb23b0
.quad 0x2359a21d9b8f23cd,0x180722a7a2f2932d,0x164622a7a30e8000,0xa3a81a3e222fa364,0xa3d31cdc216aa3cd,0x213fa3d91d122155,0x1fefa3ff205a1ef1,0x1ebd2072a3fe1fbd
.quad 0x216a1bfea3962241,0xa40020721e54a3e3,0xa34122e4947ca241,0x1e54a3d921bc195c,0x9807a1d023de9ef1,0x216a1a3ea3412300,0x23de9f589ebd23cd,0xa39622a7947ca1f7
.quad 0x208aa379980723f3,0x24009bfea30e2155,0x1ebd221da2979d49,0xa0b823791646a3e3,0xa3f61a3e230ea1a8,0x9ca5a2a7222f1e1f,0x20b8a39f0b2e238d,0x23830f2ea3a820a1
.quad 0x1e5421d0a329972a,0xa2b722641ca5a3fd,0xa3f01bfe2275a2c6,0x147ca39f21131fbd,0x20e6a3bf18eb22c6,0x220a1cdca3f61fbd,0x1dea217fa396172a,0xa3d320cf1f8ba3fd
.quad 0xa3e81cdc21bca38d,0x1ebda3ff1f8b20a1,0x2113a3d91ca521a8,0x1f8b2072a3f61e1f,0x1d7f2129a3de1d49,0xa3e81db52113a3e3,0xa3de1db520e6a3f3,0x21bca3bf1ca52155
.quad 0x213fa3ec1ebd2042,0x1807221da3a81c6e,0x1d1220cfa3fe2042,0xa2f21561222fa3b0,0xa3d31e891fefa3f3,0x2359a2e4164621f7,0x216aa3f9205a1d49,0x9b8f234da30e195c
.quad 0x20b82129a3299b1f,0x9d1223f998eba364,0xa3f018792359a0fd,0x9deaa26422531e1f,0x222fa2a79ca52400,0x230e1a3ea3f61e1f,0x947c23bfa05aa0fd,0xa3d32011213fa364
.quad 0xa16a9f5823f09b1f,0x20e6a39f11622364,0x24009db5a1e42335,0x1162234da1bc9e1f,0xa19423799162a335,0xa16a9e8924009e1f,0x9162a31c22531b1f,0x23f09cdca1e42364
.quad 0x220a1bfea3d320fd,0xa2b722e4147ca364,0xa3f620721f8ba400,0x1ca5a3d921131e1f,0x20e6a3ec1dea20fd,0x1e5420cfa3f01e1f,0x18eb221da3961b1f,0xa32915612275a364
.quad 0xa2978f2e22d5a335,0x23c6a1d099cd2364,0x23d3a1d098eb2335,0xa0b823ffa05a9e1f,0xa02923f9a13f9b1f,0x947ca21d23c69e1f,0x9c37a0cf2400a0fd,0x21941879a2f22364
.quad 0xa3a8201121bca2c6,0xa2539e8923de932d,0x2113a34d98eb23f3,0x23de9561a38320a1,0x964623d99f8ba1a8,0xa3a820722113a364,0x9f8ba17f2341172a,0x21bca31c98eb23e3
.quad 0x230e1879a3d32042,0x9d1223ff9deaa1f7,0xa3f61f58213fa38d,0x98eba2e422531c6e,0x222fa31c947c238d,0x20b82011a3f01c6e,0x9ca523eca05aa042,0xa3298f2e2359a1f7
.quad 0x9ca5a1d02383972a,0x24009f58a0b823e3,0x222f1a3ea3a821a8,0xa30e22a71646a364,0xa3f61e8920b8a3f3,0x208aa3f91ebd20a1,0x230ea2e40b2e22c6,0x9807234da297932d
.quad 0x9f8b23f9a0e69d49,0x9d7fa0cf23fb9fbd,0x9646a21d23b89d49,0x21e41879a3292300,0x21131bfea36f22c6,0xa3b81db5205aa3fd,0xa3a81db52029a3f3,0x23d3a21d91622286
.quad 0x1162a3d91ebd2241,0x22b7a1d09fef23b0,0x1d1222a7a20a9ef1,0xa16a231c1aafa3fd,0xa113a07223a88000,0x1f8ba3d916462364,0x22f21a3ea3f01ef1,0x9b8f23f99e54a1f7
.quad 0xa3e81a3e22d5a241,0x8b2ea379213f1fbd,0x23d3a072a08a23cd,0x1c372264a2d5995c,0xa2b722a719cda3cd,0x9fefa0cf23c6995c,0x20b8a3d91b8f2241,0x21941db5a3fb1fbd
.quad 0x9c3723d9a0e69ef1,0xa2d59561236fa1f7,0x9646a2a7230e8000,0x23a89a3ea22f2364,0x1f252072a3fb1ef1,0xa3fe1f58205aa3fd,0xa1e49a3e2383a241,0x23d3a17f9c3723b0
.quad 0x236f9a3ea1bc23cd,0xa32922e49162a286,0xa40020721deaa3cd,0x220aa3bf1d7f20a1,0x2383a2a711622241,0xa08a23ffa0e69c6e,0xa20a23d99f259ef1,0x1d7fa39f2297932d
.quad 0x236f1879a3f61d49,0x1b8f231ca13fa0a1,0xa3c60f2e23a8a042,0x9c37a2e421bc1fbd,0x23f69a3ea30e21a8,0x1ca522a7a22f9e1f,0xa3fe1db5222fa2c6,0x9d12a26422971c6e
.quad 0x23dea011a113238d,0x1d7f221da2f2995c,0xa39621291f8ba3f3,0x9deaa1d02341132d,0x2329a21d9ca523f3,0x1e54217fa383132d,0xa29722e41646a38d,0x9ebda12923b8995c
.quad 0x21e4a379164622c6,0x1f2520cfa3de1c6e,0xa11323d99ca5a1a8,0x9f8ba07223f69e1f,0x2029a3ff1f8b2042,0x1fef2011a4001fbd,0x9e5423eca1139d49,0xa0299f5823fba0a1
.quad 0x1c37a39f222f172a,0x205a1e89a3e82155,0x9807231ca30e172a,0xa08a9db523c6a1f7,0x8b2ea26423a89d49,0x20b81cdca3962286,0x18eb217fa3f62042,0xa0e69bfe2359a300
.quad 0xa13f231c1b8fa400,0xa3f61879236fa0a1,0x21bca2e49c372400,0x23a80f2ea3c61fbd,0xa22f22a71ca5a400,0xa30e9a3e23f69e1f,0x2297a2649d122400,0x222f1db5a3fe1c6e
.quad 0xa2f2221d1d7fa400,0xa113a01123de995c,0x2341a1d09dea2400,0x1f8b2129a396132d,0xa383217f1e54a400,0x9ca5a21d2329132d,0x23b8a1299ebd2400,0x164622e4a297995c
.quad 0xa3de20cf1f25a400,0x1646a37921e41c6e,0x23f6a0729f8b2400,0x9ca523d9a1139e1f,0xa40020111fefa400,0x1f8ba3ff20291fbd,0x23fb9f58a0292400,0xa11323ec9e54a0a1
.quad 0xa3e81e89205aa400,0x222fa39f1c372155,0x23c69db5a08a2400,0xa30e231c9807a1f7,0xa3961cdc20b8a400,0x23a8a2648b2e2286,0x23599bfea0e62400,0xa3f6217f18eba300
.quad 0x9fefa1d022b71d49,0x1ebda3d9116223b0,0x1aaf231ca16aa042,0xa20a22a71d12a3fd,0x1646a3d91f8b21a8,0x23a8a072a1132364,0x9e5423f99b8fa2c6,0xa3f01a3e22f2a1f7
.quad 0x213fa3798b2e238d,0x22d51a3ea3e81fbd,0xa2d522641c37a3f3,0xa08aa07223d3995c,0x23c6a0cf9fef23f3,0x19cd22a7a2b7995c,0xa3fb1db52194a38d,0x1b8fa3d920b81fbd
.quad 0x236f9561a2d522c6,0xa0e623d99c37a1f7,0xa22f9a3e23a8a1a8,0x230ea2a796462364,0x205a1f58a3fe2042,0xa3fb20721f25a3fd,0x9c37a17f23d39d49,0x23839a3ea1e423b0
.quad 0x916222e4a329172a,0xa1bc9a3e236fa286,0x1d7fa3bf220a172a,0x1dea2072a40020a1,0xa0e623ffa08a9d49,0x1162a2a723839c6e,0x2297a39f1d7f2042,0x9f2523d9a20a932d
.quad 0x23de9e89a2532241,0x21bc2011a3a8932d,0xa383956123de9ef1,0x98eba34d211320a1,0x21132072a3a88000,0x9f8b23d99646a364,0x98eba31c21bc1ef1,0x2341a17f9f8b23e3
.quad 0x9dea23ff9d12a241,0xa3d31879230ea1f7,0x2253a2e498eb23cd,0x213f1f58a3f61c6e,0xa3f0201120b8a3cd,0x947ca31c222f1c6e,0x23598f2ea3292241,0xa05a23ec9ca5a1f7
.quad 0xa0b89f5824009ef1,0x2383a1d09ca523e3,0x164622a7a30e8000,0xa3a81a3e222fa364,0x1ebda3f9208a1ef1,0x20b81e89a3f620a1,0xa297234d9807a241,0xb2ea2e4230e932d
.quad 0x23fba0cf9d7f23cd,0xa0e623f99f8b9fbd,0xa329187921e4a3cd,0x23b8a21d96462300,0x205a1db5a3b82241,0xa36f1bfe2113a3fd,0x9162a21d23d39ef1,0x20291db5a3a82286
.quad 0x98eb23f99d12a2c6,0xa329212920b8a364,0x2253a2649dea23f3,0x23591879a3f01e1f,0xa3f61a3e230ea1a8,0x9ca5a2a7222f1e1f,0x213f2011a3d3172a,0xa05a23bf947ca364
.quad 0x1162a39f20e62042,0x23f09f58a16a2364,0xa1bc234d1162a38d,0xa1e49db524009e1f,0x24009e89a16a238d,0x91622379a1949e1f,0xa1e49cdc23f0a042,0x2253a31c91622364
.quad 0x147c22e4a2b7972a,0xa3d31bfe220aa364,0x2113a3d91ca521a8,0x1f8b2072a3f61e1f,0xa3f020cf1e54a3f3,0x1deaa3ec20e61e1f,0x22751561a32922c6,0xa396221d18eba364
.quad 0x99cda1d023c69d49,0x22d58f2ea2972364,0xa05a23ffa0b89d49,0x98eba1d023d39e1f,0x23c6a21d947c22c6,0xa13f23f9a0299e1f,0xa2f218792194a3f3,0x2400a0cf9c372364
.quad 0xa30e9bfe24009b1f,0x9807a379208a2155,0x16462379a0b8a0fd,0xa297221d1ebda3e3,0x222fa2a79ca52400,0x230e1a3ea3f61e1f,0xa3a80f2e2383a0fd,0xb2ea39f20b820a1
.quad 0x1ca52264a2b79b1f,0xa32921d01e54a3fd,0x2113a39f147c2335,0x22751bfea3f01fbd,0xa3f61cdc220aa335,0x18eba3bf20e61fbd,0x1f8b20cfa3d31b1f,0xa396217f1deaa3fd
.quad 0x1f8ba3ff1ebd20fd,0x21bc1cdca3e820a1,0xa3f620721f8ba400,0x1ca5a3d921131e1f,0x21131db5a3e820fd,0xa3de21291d7fa3e3,0x1ca5a3bf21bc1b1f,0x20e61db5a3de2155
.quad 0xa3a8221d1807a335,0x1ebda3ec213f1c6e,0x222f1561a2f22335,0xa3fe20cf1d12a3b0,0x1646a2e423599b1f,0x1fef1e89a3d321f7,0xa30e234d9b8fa0fd,0x205aa3f9216a195c
.quad 0x21e4a2a79d7f23f3,0x23d38f2ea3b81fbd,0xa3299a3e23fb9d49,0x9162a39f205a2155,0x964623d99f8ba1a8,0xa3a820722113a364,0x23b8a072a0e6238d,0x20292129a36f932d
.quad 0xa0b8a07223c6972a,0x2194a34d947c23b0,0xa05a23d999cda2c6,0xa2f2987923c6a0a1,0x23d39a3ea29722c6,0x9c3723eca029a0a1,0x98eba2a722d5172a,0x24009e89a13f23b0
.quad 0xa2f222a71807a38d,0x9b8fa21d2359932d,0x222f1a3ea3a821a8,0xa30e22a71646a364,0x1d12a3d9213f1d49,0x216a1cdca3d32155,0xa3fe20721ebda3f3,0x205aa3ff1fef1fbd
.quad 0x1e542072a4002042,0xa3961bfe216aa3e3,0x21bca3d91e542042,0x947c22e4a341195c,0xa3411a3e216aa3f3,0x23dea1d098072300,0x947c22a7a3961d49,0x9ebd9f5823dea1f7
.quad 0x1e542264a22f9ef1,0xa029239f147ca3e3,0x22d5a1d09f8b23cd,0x22f21bfea4001c6e,0xa113a07223a88000,0x1f8ba3d916462364,0xa16a234d1646a3cd,0xa329987923de9fbd
.quad 0x22971bfea3f61ef1,0x9ebd23f99c37a286,0x1f25a3f91ca52241,0x23590f2ea3832155,0xa3961561230ea241,0x1deaa3ff1ebd2155,0x99cd23bfa1139ef1,0xa383156122f2a286
.quad 0x23fe9e89a11323cd,0x9d1223eca08a9fbd,0x9646a2a7230e8000,0x23a89a3ea22f2364,0xa3c6217f1ca5a3cd,0x1c37a3bf21941c6e,0x1dea20cfa3f61ef1,0xa3c61cdc213fa3e3
.quad 0x22f2a31c16462241,0x9aaf2379a275932d,0xa0e69cdc23a8a241,0x23de9e89a02923fd,0xa19423ec9f8b9ef1,0x18eba31c2329995c,0x22758f2ea22f23cd,0xa3f020111deaa3b0
.quad 0xa3fb1cdc22d5a1a8,0xa113a0cf2359195c,0x8b2e23bf9fefa1a8,0xa30e217f2029a3b0,0x23f69a3ea30e21a8,0x1ca522a7a22f9e1f,0x19cda3ec1f2521a8,0x23f69e89a1e42300
.quad 0xa3b815612341a1a8,0x1646a3bf208a20a1,0x9d7f23ff9e54a1a8,0xa3a815612329a1f7,0x23410f2ea36f21a8,0x9f8b23f99d12a1f7,0x1fefa3f91d7f21a8,0x222f1bfea3de20a1
.quad 0xa29798792396a1a8,0x222fa34d11622300,0xa11323d99ca5a1a8,0x9f8ba07223f69e1f,0x21bc1bfea3b821a8,0xa3a821d01b8fa3b0,0x220aa39f1b8f21a8,0x16462264a36f195c
.quad 0xa0b89db523d3a1a8,0x23f69f589fef23fd,0xa2d5234d99cda1a8,0x1ca5a39f2253132d,0x1f251f58a3e821a8,0xa30e187921bca3e3,0x236fa2e4180721a8,0xa11323ffa0b89c6e
.quad 0x1c37a3ff1aaf2335,0x2383a072a16a2300,0xa2b79cdc23fe9b1f,0x147ca3d91f2521f7,0xa22f22a71ca5a400,0xa30e9a3e23f69e1f,0x1dea221da2d59b1f,0xa25322a71c37a3fd
.quad 0x23fb9e89a1bc2335,0x1b8f22a7a2759c6e,0x1b8fa3ec1fef20fd,0x23de9a3ea2b72286,0xa2d5987923b8a0fd,0x208aa3d91aaf2286,0xa20a234d8b2ea335,0xa029a07223e89c6e
.quad 0x1e542129a3c61b1f,0xa3f020721fefa3fd,0x23f6a0729f8b2400,0x9ca523d9a1139e1f,0x1aafa39f21e41b1f,0x220a1a3ea39621f7,0xa2f20f2e22b7a335,0x2341a2a791622300
.quad 0xa1e423bf9d12a0fd,0x8b2ea2a72359995c,0x1ebd2011a3fb20fd,0xa3591a3e2194a3e3,0x23f0a17f99cd2335,0xa1e423d99ebd9fbd,0x19cda31c23419b1f,0x1d122072a3fb2155
.quad 0x22971db5a3f0172a,0xb2e23bf9f8ba1f7,0x2341a129a08a238d,0x22751db5a3f6195c,0x1646a3d91f8b21a8,0x23a8a072a1132364,0xa2759cdc24009d49,0x1d7fa3ff1ca52286
.quad 0xa359217f1f25a3f3,0xa05aa0cf23a8932d,0x980723bfa0b8a042,0xa3fb1cdc222fa300,0x22531bfea3e82042,0xa13f239f9646a300,0x236fa1d09d1223f3,0x1aaf2264a30e932d
.quad 0x18eba39f21941d49,0x23418f2ea30e2286,0xa22f9a3e23a8a1a8,0x230ea2a796462364,0xa383221d19cda38d,0x18eba379222f195c,0x99cd2379a253972a,0xa1949bfe23a8a1f7
.quad 0x220a1879a34122c6,0xa3f021291ca5a3b0,0x2396a264916222c6,0x9fef23f9a1139c6e,0x1aafa34d22f2972a,0x1e542011a3f62155,0xa1e4956122b7a38d,0x23c69e899f8b23e3
.quad 0xa275221d1f25a3cd,0xa396956123e89e1f,0x980723ec9e54a241,0xa36f20cf20e6a364,0x21132072a3a88000,0x9f8b23d99646a364,0x23fb9bfea2b72241,0x1aaf22e4a20a9e1f
.quad 0x21e4a31c980723cd,0x22531cdca3fe1e1f,0xb2ea379216a1ef1,0x23fe9e89a1942364,0xa1bc9db523fe9ef1,0x21e4a34d8b2e2364,0xa3fe1f5820e6a3cd,0x1807a39f216a1e1f
.quad 0xa13f23bf9aafa241,0xa05aa01123fb9e1f,0x164622a7a30e8000,0xa3a81a3e222fa364,0x22531879a36f2241,0xa35922641807a364,0x23e8a1299d1223cd,0x9f2523f9a0b89e1f
.quad 0x208aa3ff20291ef1,0x1b8f217fa3de1e1f,0x9aafa17f23e89ef1,0x22750f2ea2b72364,0xa2d51561220aa3cd,0x23fba1299b8f2364,0xa3b822648b2ea241,0x21bca3ec1fef1e1f
.quad 0x9ca5a2e421942042,0x20e6a34d99cd23fd,0xa22f9e8923e8972a,0x19cda3f91d7f2286,0xa3f61a3e230ea1a8,0x9ca5a2a7222f1e1f,0xa30e21d01ebda3f3,0xa1949f5823e8995c
.quad 0x9f8b23ec9aafa2c6,0xa3960f2e236fa155,0x1646231ca20a9d49,0xa3e8201120e6a3b0,0x21131f58a3fb1d49,0xa27522e41807a3b0,0x23a89879a2b722c6,0x9f2523ff9e54a155
.quad 0x23a8a17f9d7f23f3,0xb2e231ca275995c,0x2113a3d91ca521a8,0x1f8b2072a3f61e1f,0x1646a34d2275172a,0x22971561a3412286,0x9f8ba0112400a042,0x23f09e89a08a23fd
.quad 0xa30e15612253a38d,0x2383a264947c2300,0xa3f621291c37a38d,0x216aa3ec1f251fbd,0xa22f23bf9deaa042,0x1c37a37922b7932d,0x9ca52379a2d5172a,0x9aafa12923fea0a1
.quad 0x23fe9a3ea34120fd,0x205a217fa2f29c6e,0x2396a072a13f2335,0x21e41f58a3d3132d,0x222fa2a79ca52400,0x230e1a3ea3f61e1f,0x1fefa3d918072335,0x23c69561a3592155
.quad 0x18eba3d9202920fd,0x24009db5a20a2300,0x9aafa2a722971b1f,0x23b8a0cfa02923e3,0xa05aa07223de9b1f,0x22f2a2649b8f23e3,0xa2759a3e23c6a0fd,0x21bca379147c2300
.quad 0xa3b81a3e2253a335,0x2029a3f91dea2155,0xa3f620721f8ba400,0x1ca5a3d921131e1f,0xa32922a7147ca335,0x1162a31c22b7132d,0xa16a23d99d7fa0fd,0x9aafa1d023b89c6e
.quad 0x9dea23d9a1949b1f,0x9f25a01123fea0a1,0x8b2e22a7a36f1b1f,0xa13f9bfe2383a286,0x1d7f2072a3fe20fd,0xa2970f2e2253a3b0,0x213f1a3ea3292335,0xa3831cdc208aa3fd
.quad 0x9dea23ec9646a38d,0xa3c61f58220aa286,0x9b8f23ff9ca5a2c6,0xa3b820112194a300,0x964623d99f8ba1a8,0xa3a820722113a364,0x11622379a113a042,0xa39620cf208aa3b0
.quad 0x19cd22e4a22f9d49,0xa38321291fefa3e3,0x1d12221da30e972a,0xa36f217f1ebda3fd,0x1f252129a3a8172a,0xa35921d01d7fa3fd,0x208a2011a3f61d49,0xa341221d1c37a3e3
.quad 0x216a1db5a3f62042,0xa329226419cda3b0,0x222f1a3ea3a821a8,0xa30e22a71646a364,0x22d50f2ea30e22c6,0xa2f222e40b2ea300,0x23599879a22f238d,0xa2d5231c947ca286
.quad 0x23b89cdca11323f3,0xa2b7234d98eba1f7,0x23f09f589f8b23f3,0xa29723799b8fa155,0x2400a0cf9ca5238d,0xa275239f9d12a0a1,0x23e8a1d0964622c6,0xa25323bf9e549fbd
.quad 0x230e9a3ea1132400,0xa3f620721ca5a364,0x22b79879a13f2400,0xa3a81e891ebda3b0,0x22539561a16a2400,0xa30e1bfe205aa3e3,0x21e48f2ea1942400,0xa22f1561213fa3fd
.quad 0x216a0f2ea1bc2400,0xa1139561220aa3fd,0x20e61561a1e42400,0x9f8b9bfe22b7a3e3,0x205a1879a20a2400,0x9ca59e892341a3b0,0x1f8b1a3ea22f2400,0x9646a07223a8a364
.quad 0x1e541bfea2532400,0x1646a17f23e8a300,0x1d121cdca2752400,0x1ca5a2642400a286,0x1b8f1db5a2972400,0x1f8ba31c23f0a1f7,0x18eb1e89a2b72400,0x2113a39f23b8a155
.quad 0x147c1f58a2d52400,0x222fa3ec2359a0a1,0x8b2e2011a2f22400,0x230ea3ff22d59fbd,0x96462072a30e2400,0x23a8a3d9222f9e1f,0x99cd20cfa3292400,0x23f6a379216a9c6e
.quad 0x23a8a2a7164621a8,0xa22f23d99f8b9e1f,0x2400a12998eb22c6,0xa3b822a79807a155,0x23969e899e54238d,0xa3e820721b8fa300,0x22759879a0e623f3,0xa2b71a3e208aa3e3
.quad 0x20b81879a25323f3,0xa05a9a3e2297a3e3,0x1d121e89a359238d,0x98eba07223c6a300,0xb2e2129a3e822c6,0x1c37a2a723f0a155,0x9ca522a7a3f621a8,0x2113a3d9230e9e1f
.quad 0xa08a239fa3832042,0x2329a3d9213f932d,0xa25323ffa2971d49,0x23fea2a71d7f1c6e,0xa38323bfa13f172a,0x236fa0728b2e20a1,0xa3fe22e49f25972a,0x21949a3e9dea2286
.quad 0xa3b8217f9aaf9d49,0x1d7f1a3ea16a23b0,0xa2b71f581162a042,0x947c2072a32923fd,0xa1131a3e1ca5a1a8,0x9f8b22a7a3f62364,0x9dea95612029a2c6,0xa25323d9a3b821f7
.quad 0x1f8ba3d9222f8000,0x964622a7a3a81e1f,0x22d5a39f1e541ef1,0xa16a23ffa113995c,0x2400a17f947c2241,0xa3de22649646a155,0x22f29bfea02923cd,0xa3291cdc1f8ba3b0
.quad 0x1fef1bfea2d523cd,0x9f259cdc230ea3b0,0x8b2e217fa3fb2241,0x19cda26423f6a155,0xa029239fa3591ef1,0x21e4a3ff222f995c,0xa30e23d9a1130000,0x23f6a2a71ca51e1f
.quad 0xa3fe221d9aaf9ef1,0x22d59db59ca52286,0xa2b71db51c37a241,0x1dea1bfea22f23fd,0x9f259879216aa3cd,0x9c37221da3f62300,0x147ca0cf2383a3cd,0xa25323f9a30e1fbd
.quad 0x208aa34d23f0a241,0xa40022e49f8b932d,0x2341a3f922979ef1,0xa2751e891646a0a1,0x23f6a2a71f8b8000,0x9ca59a3e2113a364,0x22759f580b2e1ef1,0x1d7fa1d023a8a3e3
.quad 0x9ca5a07223f6a1a8,0x21131a3ea30e2364,0x1f25a3bf2297972a,0x99cd22e4a3961e1f,0x2383a31c1c372042,0xa2f2239f9ebd9e1f,0x23599db59ebd238d,0xa3831e891deaa364
.quad 0x1e541db5a341238d,0x9d7f9e89236fa364,0x9d7f231ca3b82042,0x1fefa39f23419e1f,0xa32923bfa08a972a,0x23dea2e41d121e1f,0xa3a820721646a1a8,0x222f9a3e9f8b2364
.quad 0x9fef987921bca3f3,0xb2e20cfa3b82364,0x1b8fa21d23fba2c6,0xa20a23f9a2d51e1f,0x22b7a3ff22759d49,0xa3e821d09aaf9e1f,0x23dea1d01b8f1d49,0xa0298f2e208aa364
.quad 0x20b895619f2522c6,0x1d12a21d23e8a364,0x980720cfa35923f3,0x236fa3ec22539e1f,0xa22f23d9a3a821a8,0x230ea07216461e1f,0xa3fb22e4a05a172a,0x1aaf1bfea13f2364
.quad 0xa30e1a3e2113a400,0x23f6a0729ca52364,0x9646a17f23fea0fd,0x1dea1f58a3c62286,0x222fa3ec208a1b1f,0xa13f23ffa194932d,0x23a89f589d122335,0xa3c620111c37a300
.quad 0x1ca51f58a3962335,0x9b8fa01123b8a300,0xa11323eca2971b1f,0x220aa3ff21bc932d,0xa3f6217f9162a0fd,0x236f9f589b8f2286,0x9f8b9a3e222fa400,0x16462072a3a82364
.quad 0x1f8ba34d23c6a0fd,0xa2b723f9a1e4195c,0x23f6a2e41e541b1f,0xa2f21e891aafa1f7,0x211395619fef2335,0x1162a0cf2396a3b0,0x9ca5221da3f02335,0x2341a3ec220a9c6e
.quad 0xa3a823bfa1941b1f,0x22539db599cd2155,0xa22f1db518eba0fd,0x99cd2129a38323e3,0x1646a072230ea400,0xa3a823d9a22f1e1f,0x230ea3ff2341a0fd,0xa1941cdc18eba0a1
.quad 0xa3a822a79646a1a8,0x222fa3d91f8b1e1f,0xa0e69a3e22f2a38d,0x22759561a19423fd,0x2029a3d92275972a,0x9dea2379a3291c6e,0x23dea0729aaf22c6,0xa3f020cf18eba286
.quad 0x19cd2072a3d322c6,0x9807a0cf23e8a286,0xa2d523d9a0b8972a,0x236fa3791f251c6e,0xa2531a3e1fefa38d,0x20b81561a1bc23fd,0x1ca5a2a723f6a1a8,0xa11323d9a30e1e1f
.quad 0x23fba2a71d121d49,0xa3411f5819cda1f7,0x1ebd1a3ea1e423f3,0x19cda1d023f0a300,0xa19423d9a3592042,0x23fba2e41ebd195c,0xa35920728b2ea042,0x1d121bfea1e423e3
.quad 0x1162a0722341a3f3,0xa2b723ffa2f21fbd,0x2396a3d9220a9d49,0xa1e41cdc1aafa155,0x21139a3e9ca521a8,0x1f8ba2a723f6a364,0x9fef22a7a3f0238d,0x23c6a21d1e54132d
.quad 0x9f8b23d9a22f0000,0x1646a2a723a89e1f,0xa3831db51f8ba3cd,0x23fba0cf9aaf2300,0x1aafa2e423a89ef1,0x9162221da3f020a1,0x23fba12996462241,0xa400217f1162a1f7
.quad 0x147c2129a3f62241,0x8b2ea17f23fea1f7,0xa3d322e49ca59ef1,0x23fea21d180720a1,0x9d7f9db5230ea3cd,0x147c20cfa3d32300,0x230ea3d921138000,0xa3f622a79ca59e1f
.quad 0x20b80f2ea11323cd,0x9807a011236fa3b0,0xa1bc23eca30e1ef1,0x23e8a31c1f25195c,0xa2531cdc1ca5a241,0x19cd1e89a2d523fd,0x1fefa31c23f6a241,0xa3d32379a0b8132d
.quad 0x236fa0cf16461ef1,0x9b8f9cdc220aa3e3,0x9b8f217fa3a823cd,0x23b8a3bf21bc9c6e,0xa3f622a79f8b0000,0x1ca51a3ea1132364,0x91629e89222fa3cd,0xa39623eca2971fbd
.quad 0x1ca52072a3f621a8,0xa1139a3e230ea364,0xa3d32264947ca1a8,0x230ea3791d7f1fbd,0x9807a12923fea1a8,0x1ca52011a3d32286,0x23fea1d00b2e21a8,0xa3f6221d947ca155
.quad 0x916221d0a40021a8,0x1646a21d23fba155,0xa3f021291162a1a8,0x23a8a0119aaf2286,0x1aafa26423fba1a8,0x9f8b2379a3831fbd,0x23a8a072964621a8,0xa22f1a3e1f8ba364
.quad 0x9dea22e4a3f021a8,0x222fa3ff22759c6e,0xa3291f5818eba1a8,0x1f8b1879a19423e3,0x2029a34d23dea1a8,0xa3a8239fa0e6132d,0x22759db59aaf21a8,0x96469f5822f2a3fd
.quad 0xa13f239fa3c621a8,0x23f6a2641dea195c,0xa1941bfe1c37a1a8,0x9ca521d0a3c623b0,0x222fa3d923a8a1a8,0xa30e207296469e1f,0x208a98799d1221a8,0x2113a34d23fea300
.quad 0x230e9a3ea1132400,0xa3f620721ca5a364,0xa1bc23f9a0b89b1f,0x1fefa3d92253932d,0x9f259db5236fa335,0x20b81a3ea2d523b0,0x23e8a264180720fd,0xa3d322a799cda0a1
.quad 0x98eb2264a3f020fd,0x1aafa2a723dea0a1,0xa3291db51deaa335,0x22759a3ea02923b0,0x2194a3f922759b1f,0xa2f223d9a0e6932d,0x1f8b1a3ea22f2400,0x9646a07223a8a364
.quad 0xa3de231c9ebd9b1f,0x2396a072947c2155,0x1807a17f23dea335,0xa16a23d9a3411fbd,0x2341a011947c20fd,0x9e549a3e21bca3e3,0xa16a23bfa39620fd,0x2400a2a71e54195c
.quad 0x9fef8f2e205aa335,0x9ebd22a7a3fe2300,0x23d3a39f216a9b1f,0xa13f1a3e1d12a1f7,0x96462072a30e2400,0x23a8a3d9222f9e1f,0xa35921299b8f9b1f,0x98072072a2f223fd
.quad 0x23a8a2a7164621a8,0xa22f23d99f8b9e1f,0x9b8f231ca36f1d49,0x9162a1d023f6a0a1,0xa1bc8f2e220aa3f3,0x22979879a11323fd,0x23b8a2e41b8f2042,0xa396231c9ca59fbd
.quad 0x9c3722e4a3c62042,0x1d12a31c23a89fbd,0xa1940f2e213fa3f3,0x208a1879a22f23fd,0x23c6a31c1dea1d49,0xa3fe21d09646a0a1,0x9ca522a7a3f621a8,0x2113a3d9230e9e1f
.quad 0xa16a1561205aa38d,0x1b8f1e89a30e23e3,0x23d3a34d1fef172a,0xa35920111646a155,0x9d122264a3fe22c6,0x22f2a3f9222f9c6e,0xa13f18791ebda2c6,0x98072129a3a823b0
.quad 0x23dea37920e6972a,0xa1bc1bfe1ca5a1f7,0x9d7f221da3de238d,0x23e8a3792113995c,0xa1131a3e1ca5a1a8,0x9f8b22a7a3f62364,0x23e8a39f21bc9d49,0x9ebd8f2e1f8ba286
.quad 0x1f8ba3d9222f8000,0x964622a7a3a81e1f,0x1d122011a3de2241,0xa08a9bfe2329a364,0xa3411cdc1fefa3cd,0x23b89f589d7f2364,0x236fa34d1d7f1ef1,0xa34123799e549e1f
.quad 0x9dea234da3831ef1,0x1ebda37923599e1f,0x9ebd9cdc22f2a3cd,0x1c371f58a3832364,0x2396a01199cd2241,0xa2971bfe1f25a364,0xa30e23d9a1130000,0x23f6a2a71ca51e1f
.quad 0x1c37a2642400a241,0xa19423eca2f21e1f,0x20291561a13f23cd,0x147ca12923c6a364,0xa3d3217f98eb9ef1,0x20b88f2ea05a2364,0x2297a3ff22d59ef1,0xa3c6217f99cd9e1f
.quad 0x98eb2129a39623cd,0x2329a3f922759e1f,0xa0e618791deaa241,0x9e542264a3f02364,0x23f6a2a71f8b8000,0x9ca59a3e2113a364,0xa20a23bfa3d32241,0x22b7a011147c1e1f
.quad 0x9ca5a07223f6a1a8,0x21131a3ea30e2364,0x222f8f2ea1e423f3,0xa3591cdc2029a3e3,0xa3f620cf19cda2c6,0x23fba1d08b2e21f7,0x230ea39f1f251d49,0xa2d523bf9fef9c6e
.quad 0x9f8b239fa3291d49,0x2029a3bf22f29c6e,0x9646a0cf23dea2c6,0x947c21d0a40021f7,0x21130f2ea16a23f3,0x9e549cdc22d5a3e3,0xa3a820721646a1a8,0x222f9a3e9f8b2364
.quad 0x23a8a3792029172a,0xa3d321299162a0a1,0xa11323bfa36f2042,0x23b8a379205a132d,0x1646a12923b8a38d,0xa1e423eca3291fbd,0x1f8b1561a0e6238d,0x1d7fa26423fba300
.quad 0xa30e20110b2ea042,0x18071e89a29723fd,0x23f6a34d20b8972a,0xa08a15611ebda286,0xa22f23d9a3a821a8,0x230ea07216461e1f,0x1ca5a17f2383a3f3,0xa400231ca0b8195c
.quad 0xa30e1a3e2113a400,0x23f6a0729ca52364,0x23f0a0729c372335,0xa3e8221d8b2ea1f7,0xa3c622a798eba0fd,0x2359a34d1d121fbd,0x2297a3d9205a1b1f,0xa25323eca0b8995c
.quad 0xa08a23d9a2b71b1f,0x20e6a3ec2275995c,0x1b8fa2a723e8a0fd,0x9e54234da3961fbd,0x18072072a3b82335,0x18eba21d2400a1f7,0x9f8b9a3e222fa400,0x16462072a3a82364
.quad 0x220a9a3e9f252335,0x9d7f9cdc2297a3fd,0xa38320721162a0fd,0x208a0f2ea0e623b0,0x2400a2a71dea1b1f,0xa20a1bfe1d7fa286,0xa36f23d9a1bc1b1f,0x2329a011916220a1
.quad 0x21e4a3d92383a0fd,0xa3d321d09c379c6e,0x9f2522a7a3fb2335,0x23fea31c205a932d,0x1646a072230ea400,0xa3a823d9a22f1e1f,0x1c371a3ea0e62335,0x22d5a3f9236fa155
.quad 0xa3a822a79646a1a8,0x222fa3d91f8b1e1f,0x2341a34d1ca52042,0xa20a23eca05a9c6e,0xa2b723bf9f8b9d49,0x21e4a3f920e6195c,0x220aa3f92113172a,0xa1bc23ffa16a932d
.quad 0xa13f23f9a22f172a,0x2194a3ff21e4932d,0x205aa3bf230e9d49,0xa16a23f9a253195c,0x9ebd234da3a82042,0x213fa3ec22b79c6e,0x1ca5a2a723f6a1a8,0xa11323d9a30e1e1f
.quad 0x98eb21d0a3f622c6,0x20e6a3bf23599fbd,0xb2ea0cf23a8a38d,0xa0b8239fa39620a1,0x18071f58a30e23f3,0x208aa37923c6a155,0x9c379cdc222fa3f3,0xa05a234da3e821f7
.quad 0x1e541879a113238d,0x2029a31c23fba286,0xa0290f2e1f8ba2c6,0x9fef22e4a4002300,0x21139a3e9ca521a8,0x1f8ba2a723f6a364,0xa1e41db51646a042,0x9f252264a3de23b0
.quad 0x9f8b23d9a22f0000,0x1646a2a723a89e1f,0x205aa3ec220a8000,0x9ca5234da3411c6e,0xa0e623f9a1e40000,0x1f8ba3bf22b7995c,0x216aa3ff21bc8000,0xa11323f9a20a132d
.quad 0xa1e423ffa1940000,0x222fa3f9213f132d,0x2253a3f9216a8000,0xa30e23bfa05a995c,0xa2b723eca13f0000,0x23a8a34d1ebd1c6e,0x230ea3d921138000,0xa3f622a79ca59e1f
.quad 0xa35923bfa0e60000,0x23f6a1d018eb1fbd,0x2396a39f20b88000,0xa3a820cf8b2ea0a1,0xa3c62379a08a0000,0x230e9f5898072155,0x23e8a34d205a8000,0xa22f1cdc1c37a1f7
.quad 0xa3fb231ca0290000,0x211398799e542286,0x2400a2e41fef8000,0x9f8b8f2e2029a300,0xa3f622a79f8b0000,0x1ca51a3ea1132364,0x23dea2641f258000,0x96469db521e4a3b0
.quad 0x1ca52072a3f621a8,0xa1139a3e230ea364,0xb2ea21d23e8a042,0x1c372072a3f021f7,0x9d12234da3591d49,0x18eba2a723c69fbd,0x20b8a3ec2253972a,0xa05a23d9a297195c
.quad 0xa27523eca0e6972a,0x22b7a3d9208a195c,0x2396a34d1e541d49,0xa3e822a79b8f9fbd,0xa400221d98eba042,0x23b8a072980721f7,0x23a8a072964621a8,0xa22f1a3e1f8ba364
.quad 0xa2971cdc1d7fa2c6,0x1f251a3ea20a23fd,0x20e68f2ea08a238d,0x9162a0722383a3b0,0x9d7f9bfe220aa3f3,0x9dea22a7a4002286,0x11622011a32923f3,0x21bca3d9236fa0a1
.quad 0x1c37a1d023d3a38d,0xa38323d9a1e41c6e,0xa05a231ca3fe22c6,0x23fba2a71f25132d,0x222fa3d923a8a1a8,0xa30e207296469e1f,0xa36f23f9a2d52042,0x20e69a3e9c372155
.quad 0x230e9a3ea1132400,0xa3f620721ca5a364,0xa0299cdc2359a335,0x21e40f2ea22f23e3,0xb2e21d0a3fb20fd,0x99cda0cf23f6a1f7,0x1fefa3bf22d59b1f,0x9f25239fa30e1c6e
.quad 0xa2f223bfa0299b1f,0x2329a39f1f8b1c6e,0x2400a1d0147c20fd,0xa3de20cf1646a1f7,0xa2d51cdc1e54a335,0x216a8f2ea11323e3,0x1f8b1a3ea22f2400,0x9646a07223a8a364
.quad 0x1162a12923d3a335,0xa0292379a3a820a1,0xa05a2379a3b820fd,0x236fa3bf2113932d,0x2329a3ec21e49b1f,0xa3b8212996469fbd,0xa3fb22649d7f9b1f,0x20e695619f8b2300
.quad 0x22979e89980720fd,0x8b2ea011230ea3fd,0x9ebd9561208aa335,0xa0b8234da3f62286,0x96462072a30e2400,0x23a8a3d9222f9e1f,0x20b8a31c2400a335,0xa383217f9ca5995c
.quad 0x23a8a2a7164621a8,0xa22f23d99f8b9e1f,0xa3291bfe208aa3f3,0x23dea0119d122364,0x1d7f1f58a3b822c6,0x9fef9cdc2341a364,0x1e54a37923419d49,0x9d7f234da36f1e1f
.quad 0xa35923799ebd9d49,0x2383a34d1dea1e1f,0x23839f589c3722c6,0xa2f21cdc1ebda364,0x9f259bfe2297a3f3,0x19cd2011a3962364,0x9ca522a7a3f621a8,0x2113a3d9230e9e1f
.quad 0x22f2a3ec2194972a,0xa40022649c379e1f,0xa3c62129947ca042,0x213f9561a0292364,0x205a0f2ea0b8238d,0x18eba17f23d3a364,0x19cda17f23c6a38d,0xa2d523ffa2971e1f
.quad 0xa27523f9a3292042,0x2396a12918eb1e1f,0x23f0a2641e54172a,0x9dea987920e6a364,0xa1131a3e1ca5a1a8,0x9f8b22a7a3f62364,0x947c2011a2b723f3,0x23d3a3bf220a9e1f
.quad 0x1f8ba3d9222f8000,0x964622a7a3a81e1f,0xa3f621d01162a241,0x236fa31c1b8f20a1,0x21131879a29723cd,0xa20a0f2e21bca3fd,0x1ca5a31c23969ef1,0x9b8f22e4a3b81fbd
.quad 0xa3a8231c9d129ef1,0x23c6a2e41c371fbd,0x222f9879a08a23cd,0xa13f8f2e2194a3fd,0x1646a1d023fea241,0x9dea231ca3c620a1,0xa30e23d9a1130000,0x23f6a2a71ca51e1f
.quad 0x230e9e899b8f2241,0xa05a9561216aa3e3,0x9646a0112359a3cd,0x9fef234da3d32155,0xa22f23f9a2f21ef1,0x23fea2641d121c6e,0x23a8a12918071ef1,0x9ebd9879213fa3b0
.quad 0x9ca59bfe21bca3cd,0xa0e62379a3de21f7,0xa1132379a3e82241,0x23dea21d1d7f195c,0x23f6a2a71f8b8000,0x9ca59a3e2113a364,0x9f8b0f2e1ebda241,0xa1bc239fa3e82286
.quad 0x9ca5a07223f6a1a8,0x21131a3ea30e2364,0xa25323d99fef9d49,0x20b8a3f921bc132d,0x22d59a3ea0b823f3,0xa36f1db51f25a3b0,0x19cda2a723d3a042,0x98072264a3e820a1
.quad 0xa3de22a79aafa042,0x23f0a26418eb20a1,0x20291a3ea27523f3,0x9dea9db52329a3b0,0x20e6a3d922f29d49,0xa27523f9a194132d,0xa3a820721646a1a8,0x222f9a3e9f8b2364
.quad 0x147c2072a396238d,0x1ebda31c23dea155,0x2341a3d9216a972a,0xa3de217f98079fbd,0xa1bc1a3e1e54a2c6,0x147c2011a34123e3,0x9e5422a7a40022c6,0x2396a3bf216a995c
.quad 0x23fea2a71ebd172a,0xa05a0f2e1fefa300,0x9d129a3e213fa38d,0xa16a239fa3d321f7,0xa22f23d9a3a821a8,0x230ea07216461e1f,0x22f2a07218071d49,0x1b8fa1292359a3fd
.quad 0xa30e1a3e2113a400,0x23f6a0729ca52364,0x9d7f2379a30e1b1f,0x147ca26423d39fbd,0x23d3a0119ca52335,0xa3fe21291807a286,0x147ca21d23f6a0fd,0x8b2e21d0a3fe2155
.quad 0xa3fb221d9646a0fd,0x2400a1d011622155,0x1aaf2011a3a82335,0x9162a12923f0a286,0x2383a3791f8b1b1f,0xa3fb22649aaf9fbd,0x9f8b9a3e222fa400,0x16462072a3a82364
.quad 0xa27523ffa22f1b1f,0x23f0a2e41dea1c6e,0x219498799f8b2335,0x98eb9f582329a3e3,0x20e6a39f23a8a0fd,0xa3de234da029932d,0xa2f21f581646a0fd,0x1aaf1db5a27523fd
.quad 0x9dea2264a3f62335,0x23c6a39f213f995c,0x23c6a1d01ca51b1f,0x9c379bfe2194a3b0,0x1646a072230ea400,0xa3a823d9a22f1e1f,0xa3fe234da1131b1f,0x1d121879a08a2300
.quad 0xa3a822a79646a1a8,0x222fa3d91f8b1e1f,0x1aaf20cfa3fb21a8,0x9f8b9db52383a300,0x23f0a21d116221a8,0xa3a822e49aafa0a1,0x9162a17f2400a1a8,0x16462129a3fb21f7
.quad 0xa3fe217f0b2ea1a8,0x23f6a129947c21f7,0x9807221da3fe21a8,0x1ca5a2e423d3a0a1,0x23d3a0cf947c21a8,0xa30e1db51d7fa300,0x1ca5a2a723f6a1a8,0xa11323d9a30e1e1f
.quad 0xa36f20111807a1a8,0x21138f2ea0b823b0,0x9f25231ca3e821a8,0x230ea3ec21bc995c,0x22d59e8999cd21a8,0x9ca59cdc2253a3fd,0x20b8a37923d3a1a8,0xa3f6231c9fef932d
.quad 0xa20a1cdc1b8fa1a8,0x964620cfa36f23e3,0xa1bc23bfa3b821a8,0x23a8a17f1b8f1c6e,0x21139a3e9ca521a8,0x1f8ba2a723f6a364,0x2297a3ec2396a1a8,0xa22f1e8911629fbd
.quad 0x9f8b23d9a22f0000,0x1646a2a723a89e1f,0x21941561a27523cd,0xa2f21a3e20e6a3fd,0x2329a3791dea1ef1,0xa27523d9a0299c6e,0x98eba0cf23f0a241,0x1aaf2072a3de2286
.quad 0xa3e820cf1807a241,0x23d3a07299cd2286,0x9f252379a36f1ef1,0x20b8a3d922d59c6e,0x21bc9561a0b823cd,0x9fef9a3e2253a3fd,0x230ea3d921138000,0xa3f622a79ca59e1f
.quad 0x99cd9f582341a3cd,0x9d1222a7a3fb21f7,0xa3f021d099cd9ef1,0x21e49a3e9ebd2300,0x9ebd22e4a3fb2241,0x2359a3d92194995c,0x21e49bfe9d122241,0xb2ea0722359a3e3
.quad 0x22f2a3ff22b79ef1,0xa341207291629fbd,0x9aaf9cdc21e4a3cd,0xa20a23d9a3962155,0xa3f622a79f8b0000,0x1ca51a3ea1132364,0x9e54221da3c623cd,0x23f0a2a71fef932d
.quad 0x1ca52072a3f621a8,0xa1139a3e230ea364,0x23c69f589dea238d,0xa3fe217f1646a286,0x2194a3ff213f172a,0xa08a23eca22f132d,0x9c37a01123c6a2c6,0x1d121f58a3a82300
.quad 0xa3b820111b8fa2c6,0x23969f589ca52300,0xa1bc23ffa20a172a,0x2297a3ec2113132d,0x1b8f1f58a36f238d,0x1162a17f23f6a286,0x23a8a072964621a8,0xa22f1a3e1f8ba364
.quad 0x21e4a3f922b79d49,0xa3c6234d9f8b995c,0x9aaf9e8922f2a3f3,0x9e5422e4a3f621f7,0xa39620cf9162a042,0x1fef1561a11323b0,0xa20a23eca3412042,0x23f0a21d1ca51c6e
.quad 0x19cd1db5a25323f3,0x2194a3bf23a8a155,0x2383a12919cd1d49,0x98eb9db5222fa3e3,0x222fa3d923a8a1a8,0xa30e207296469e1f,0x98eb9cdc2194a38d,0xa34123ffa30e20a1
.quad 0x230e9a3ea1132400,0xa3f620721ca5a364,0x2396a2e419cd20fd,0xa29723bf9f259e1f,0x1ebda39f22f29b1f,0x9c37231ca3831e1f,0x9dea9e892383a335,0x1ebd1db5a3592364
.quad 0xa36f1e891d7fa335,0x23419db59e542364,0xa341239f9fef9b1f,0x23b8a31c1d7f1e1f,0x9d1222e4a3de20fd,0x208aa3bf23299e1f,0x1f8b1a3ea22f2400,0x9646a07223a8a364
.quad 0x23b8a0cf8b2e20fd,0xa1bc18791fefa364,0x22d5a3f9220a9b1f,0xa3fb221d9b8f9e1f,0x1aafa1d023e8a335,0xa27523ffa2b71e1f,0xa08a0f2e2029a335,0x9b8f21d0a3de2364
.quad 0xa3e8221d9d129b1f,0x1f251561a0b82364,0xa25323eca36f20fd,0x2359a0cf18071e1f,0x96462072a30e2400,0x23a8a3d9222f9e1f,0x213f9bfe9aaf20fd,0x205aa2e423fba364
.quad 0x23a8a2a7164621a8,0xa22f23d99f8b9e1f,0x2113a3ff216a172a,0x9e54239fa2d5195c,0x1646a26423dea042,0x147c217fa4002155,0x9f8b9cdc2329a38d,0x20291bfea2f223b0
.quad 0xa30e1cdc1f25a38d,0x22d59bfe9fef23b0,0xa3f6226499cda042,0x23fba17f0b2e2155,0xa22f23ffa1e4172a,0x2359a39f2029195c,0x9ca522a7a3f621a8,0x2113a3d9230e9e1f
.quad 0x1ca51db5a2d523f3,0x1aafa21d23fea286,0x222f9bfe9dea22c6,0x9c379db522b7a3fd,0x23f6a21d1c371d49,0xa16a18791f25a300,0x230ea3f922539d49,0xa38320cf947c9fbd
.quad 0x1f8ba2e42400a2c6,0xa3f0234da08a132d,0x96469e892275a3f3,0xa29723f9a34120a1,0xa1131a3e1ca5a1a8,0x9f8b22a7a3f62364,0xa3a821d09d7f972a,0x8b2e1f58a27523e3
.quad 0x1f8ba3d9222f8000,0x964622a7a3a81e1f,0x1807a2a723b89ef1,0x18eb2129a4002155,0x9b8fa07223e8a241,0x1e541e89a3962300,0xa08a9a3e22b7a3cd,0x20e61879a27523e3
.quad 0xa2971a3e205aa3cd,0x22539879a0b823e3,0xa3c6207218eba241,0x23599e899d122300,0xa3f022a79c379ef1,0x23e8a1298b2e2155,0xa30e23d9a1130000,0x23f6a2a71ca51e1f
.quad 0xa13f23d9a3291ef1,0x2383a39f208a132d,0x9d7f22a7a3fe2241,0x2297a3ff22539c6e,0xb2e2072a36f23cd,0x213fa3bf2383a0a1,0x1dea1a3ea19423cd,0x1f25a2e423fea286
.quad 0x216a9a3e9d7f2241,0x1aafa17f23b8a3b0,0x2329a072147c1ef1,0x91629f5822b7a3fd,0x23f6a2a71f8b8000,0x9ca59a3e2113a364,0x23b8a3d922539ef1,0xa02915611deaa1f7
.quad 0x9ca5a07223f6a1a8,0x21131a3ea30e2364,0x9ebd9e8923a8a2c6,0x213f1879a2b723b0,0xa05a9bfe230ea38d,0x216a1561a25323e3,0xa13f9561222fa3f3,0x21940f2ea1e423fd
.quad 0xa20a15612113a3f3,0x21bc8f2ea16a23fd,0xa2b71bfe1f8ba38d,0x21e49561a0e623e3,0xa3411e891ca5a2c6,0x220a9879a05a23b0,0xa3a820721646a1a8,0x222f9a3e9f8b2364
.quad 0xa3e8217f9646a042,0x22539bfe9e542300,0xa40022649ca59d49,0x22759cdc9d122286,0xa3f0231c9f8b972a,0x22979db59b8f21f7,0xa3b8239fa113172a,0x22b79e8998eb2155
.quad 0xa35923eca22f1d49,0x22d59f58947c20a1,0xa2d523ffa30e2042,0x22f2a0110b2e1fbd,0xa22f23d9a3a821a8,0x230ea07216461e1f,0xa16a2379a3f622c6,0x2329a0cf19cd1c6e
.quad 0x9f8b23d9a22f8000,0x1646a2a723a89e1f,0xa05a23eca20a8000,0x1ca5a34d23419c6e,0xa0e623f9a1e48000,0x1f8ba3bf22b7995c,0xa16a23ffa1bc8000,0x2113a3f9220a932d
.quad 0xa1e423ffa1948000,0x222fa3f9213f132d,0xa25323f9a16a8000,0x230ea3bf205a195c,0xa2b723eca13f8000,0x23a8a34d1ebd1c6e,0xa30e23d9a1138000,0x23f6a2a71ca51e1f
.quad 0xa35923bfa0e68000,0x23f6a1d018eb1fbd,0xa396239fa0b88000,0x23a8a0cf0b2e20a1,0xa3c62379a08a8000,0x230e9f5898072155,0xa3e8234da05a8000,0x222f9cdc9c3721f7
.quad 0xa3fb231ca0298000,0x211398799e542286,0xa40022e49fef8000,0x1f8b0f2ea0292300,0xa3f622a79f8b8000,0x1ca51a3ea1132364,0xa3de22649f258000,0x16461db5a1e423b0
.quad 0x1ca52072a3f621a8,0xa1139a3e230ea364,0x8b2e221da3e82042,0x9c37a07223f0a1f7,0x9d12234da3591d49,0x18eba2a723c69fbd,0xa0b823eca253172a,0x205aa3d92297995c
.quad 0xa27523eca0e6972a,0x22b7a3d9208a195c,0xa396234d9e549d49,0x23e8a2a71b8f1fbd,0xa400221d98eba042,0x23b8a072980721f7,0xa3a820721646a1a8,0x222f9a3e9f8b2364
.quad 0xa2971cdc1d7fa2c6,0x1f251a3ea20a23fd,0xa0e60f2e208aa38d,0x11622072a38323b0,0x9d7f9bfe220aa3f3,0x9dea22a7a4002286,0x9162a0112329a3f3,0xa1bc23d9a36f20a1
.quad 0x1c37a1d023d3a38d,0xa38323d9a1e41c6e,0x205aa31c23fea2c6,0xa3fb22a79f25932d,0x222fa3d923a8a1a8,0xa30e207296469e1f,0x236fa3f922d5a042,0xa0e61a3e1c37a155
.quad 0x230e9a3ea1132400,0xa3f620721ca5a364,0x20291cdca3592335,0xa1e48f2e222fa3e3,0xb2e21d0a3fb20fd,0x99cda0cf23f6a1f7,0x9fef23bfa2d51b1f,0x1f25a39f230e9c6e
.quad 0xa2f223bfa0299b1f,0x2329a39f1f8b1c6e,0xa40021d0947ca0fd,0x23dea0cf964621f7,0xa2d51cdc1e54a335,0x216a8f2ea11323e3,0x9f8b9a3e222fa400,0x16462072a3a82364
.quad 0x1162a12923d3a335,0xa0292379a3a820a1,0x205aa37923b8a0fd,0xa36f23bfa113132d,0x2329a3ec21e49b1f,0xa3b8212996469fbd,0x23fba2641d7f1b1f,0xa0e615611f8ba300
.quad 0x22979e89980720fd,0x8b2ea011230ea3fd,0x1ebd1561a08a2335,0x20b8a34d23f6a286,0x96462072a30e2400,0x23a8a3d9222f9e1f,0xa0b8231ca4002335,0x2383a17f1ca5195c
.quad 0x23a8a2a7164621a8,0xa22f23d99f8b9e1f,0x23299bfea08a23f3,0xa3de20111d12a364,0x1d7f1f58a3b822c6,0x9fef9cdc2341a364,0x9e542379a3411d49,0x1d7fa34d236f9e1f
.quad 0xa35923799ebd9d49,0x2383a34d1dea1e1f,0xa3831f581c37a2c6,0x22f29cdc9ebd2364,0x9f259bfe2297a3f3,0x19cd2011a3962364,0x1ca5a2a723f6a1a8,0xa11323d9a30e1e1f
.quad 0x22f2a3ec2194972a,0xa40022649c379e1f,0x23c6a129147c2042,0xa13f15612029a364,0x205a0f2ea0b8238d,0x18eba17f23d3a364,0x99cd217fa3c6238d,0x22d5a3ff22979e1f
.quad 0xa27523f9a3292042,0x2396a12918eb1e1f,0xa3f022649e54972a,0x1dea1879a0e62364,0xa1131a3e1ca5a1a8,0x9f8b22a7a3f62364,0x147ca01122b7a3f3,0xa3d323bfa20a1e1f
.quad 0x1f8ba3d9222f8000,0x964622a7a3a81e1f,0x23f6a1d091622241,0xa36f231c9b8fa0a1,0x21131879a29723cd,0xa20a0f2e21bca3fd,0x9ca5231ca3961ef1,0x1b8fa2e423b89fbd
.quad 0xa3a8231c9d129ef1,0x23c6a2e41c371fbd,0xa22f1879208aa3cd,0x213f0f2ea19423fd,0x1646a1d023fea241,0x9dea231ca3c620a1,0x230ea3d921138000,0xa3f622a79ca59e1f
.quad 0x230e9e899b8f2241,0xa05a9561216aa3e3,0x16462011a35923cd,0x1fefa34d23d3a155,0xa22f23f9a2f21ef1,0x23fea2641d121c6e,0xa3a8212998079ef1,0x1ebd1879a13f23b0
.quad 0x9ca59bfe21bca3cd,0xa0e62379a3de21f7,0x2113a37923e8a241,0xa3de221d9d7f995c,0x23f6a2a71f8b8000,0x9ca59a3e2113a364,0x1f8b8f2e9ebd2241,0x21bca39f23e8a286
.quad 0x9ca5a07223f6a1a8,0x21131a3ea30e2364,0x2253a3d91fef1d49,0xa0b823f9a1bc932d,0x22d59a3ea0b823f3,0xa36f1db51f25a3b0,0x99cd22a7a3d32042,0x1807a26423e8a0a1
.quad 0xa3de22a79aafa042,0x23f0a26418eb20a1,0xa0299a3e2275a3f3,0x1dea1db5a32923b0,0x20e6a3d922f29d49,0xa27523f9a194132d,0x23a8a072964621a8,0xa22f1a3e1f8ba364
.quad 0x147c2072a396238d,0x1ebda31c23dea155,0xa34123d9a16a172a,0x23dea17f18071fbd,0xa1bc1a3e1e54a2c6,0x147c2011a34123e3,0x1e54a2a72400a2c6,0xa39623bfa16a195c
.quad 0x23fea2a71ebd172a,0xa05a0f2e1fefa300,0x1d121a3ea13f238d,0x216aa39f23d3a1f7,0xa22f23d9a3a821a8,0x230ea07216461e1f,0xa2f2207298079d49,0x9b8f2129a35923fd
.quad 0xa30e1a3e2113a400,0x23f6a0729ca52364,0x1d7fa379230e9b1f,0x947c2264a3d31fbd,0x23d3a0119ca52335,0xa3fe21291807a286,0x947c221da3f620fd,0xb2ea1d023fea155
.quad 0xa3fb221d9646a0fd,0x2400a1d011622155,0x9aafa01123a8a335,0x11622129a3f02286,0x2383a3791f8b1b1f,0xa3fb22649aaf9fbd,0x1f8b1a3ea22f2400,0x9646a07223a8a364
.quad 0xa27523ffa22f1b1f,0x23f0a2e41dea1c6e,0xa19418791f8ba335,0x18eb1f58a32923e3,0x20e6a39f23a8a0fd,0xa3de234da029932d,0x22f29f58964620fd,0x9aaf9db52275a3fd
.quad 0x9dea2264a3f62335,0x23c6a39f213f995c,0xa3c621d09ca59b1f,0x1c371bfea19423b0,0x1646a072230ea400,0xa3a823d9a22f1e1f,0x23fea34d21139b1f,0x9d129879208aa300
.quad 0xa3a822a79646a1a8,0x222fa3d91f8b1e1f,0x9aafa0cf23fba1a8,0x1f8b1db5a3832300,0x23f0a21d116221a8,0xa3a822e49aafa0a1,0x1162217fa40021a8,0x9646a12923fba1f7
.quad 0xa3fe217f0b2ea1a8,0x23f6a129947c21f7,0x1807a21d23fea1a8,0x9ca522e4a3d320a1,0x23d3a0cf947c21a8,0xa30e1db51d7fa300,0x9ca522a7a3f621a8,0x2113a3d9230e9e1f
.quad 0xa36f20111807a1a8,0x21138f2ea0b823b0,0x1f25a31c23e8a1a8,0xa30e23eca1bc195c,0x22d59e8999cd21a8,0x9ca59cdc2253a3fd,0xa0b82379a3d321a8,0x23f6a31c1fef132d
.quad 0xa20a1cdc1b8fa1a8,0x964620cfa36f23e3,0x21bca3bf23b8a1a8,0xa3a8217f9b8f9c6e,0x21139a3e9ca521a8,0x1f8ba2a723f6a364,0xa29723eca39621a8,0x222f9e8991621fbd
.quad 0x9f8b23d9a22f8000,0x1646a2a723a89e1f,0xa19495612275a3cd,0x22f29a3ea0e623fd,0x2329a3791dea1ef1,0xa27523d9a0299c6e,0x18eb20cfa3f02241,0x9aafa07223dea286
.quad 0xa3e820cf1807a241,0x23d3a07299cd2286,0x1f25a379236f9ef1,0xa0b823d9a2d51c6e,0x21bc9561a0b823cd,0x9fef9a3e2253a3fd,0xa30e23d9a1138000,0x23f6a2a71ca51e1f
.quad 0x99cd9f582341a3cd,0x9d1222a7a3fb21f7,0x23f0a1d019cd1ef1,0xa1e41a3e1ebda300,0x9ebd22e4a3fb2241,0x2359a3d92194995c,0xa1e41bfe1d12a241,0x8b2e2072a35923e3
.quad 0x22f2a3ff22b79ef1,0xa341207291629fbd,0x1aaf1cdca1e423cd,0x220aa3d92396a155,0xa3f622a79f8b8000,0x1ca51a3ea1132364,0x1e54a21d23c6a3cd,0xa3f022a79fef132d
.quad 0x1ca52072a3f621a8,0xa1139a3e230ea364,0xa3c61f581deaa38d,0x23fea17f96462286,0x2194a3ff213f172a,0xa08a23eca22f132d,0x1c372011a3c622c6,0x9d129f5823a8a300
.quad 0xa3b820111b8fa2c6,0x23969f589ca52300,0x21bca3ff220a972a,0xa29723eca113932d,0x1b8f1f58a36f238d,0x1162a17f23f6a286,0xa3a820721646a1a8,0x222f9a3e9f8b2364
.quad 0x21e4a3f922b79d49,0xa3c6234d9f8b995c,0x1aaf1e89a2f223f3,0x1e54a2e423f6a1f7,0xa39620cf9162a042,0x1fef1561a11323b0,0x220aa3ec2341a042,0xa3f0221d9ca59c6e
.quad 0x19cd1db5a25323f3,0x2194a3bf23a8a155,0xa383212999cd9d49,0x18eb1db5a22f23e3,0x222fa3d923a8a1a8,0xa30e207296469e1f,0x18eb1cdca194238d,0x2341a3ff230ea0a1
.quad 0x230e9a3ea1132400,0xa3f620721ca5a364,0xa39622e499cda0fd,0x2297a3bf1f251e1f,0x1ebda39f22f29b1f,0x9c37231ca3831e1f,0x1dea1e89a3832335,0x9ebd9db52359a364
.quad 0xa36f1e891d7fa335,0x23419db59e542364,0x2341a39f1fef1b1f,0xa3b8231c9d7f9e1f,0x9d1222e4a3de20fd,0x208aa3bf23299e1f,0x9f8b9a3e222fa400,0x16462072a3a82364
.quad 0x23b8a0cf8b2e20fd,0xa1bc18791fefa364,0xa2d523f9a20a1b1f,0x23fba21d1b8f1e1f,0x1aafa1d023e8a335,0xa27523ffa2b71e1f,0x208a8f2ea0292335,0x1b8fa1d023dea364
.quad 0xa3e8221d9d129b1f,0x1f251561a0b82364,0x2253a3ec236fa0fd,0xa35920cf98079e1f,0x96462072a30e2400,0x23a8a3d9222f9e1f,0xa13f1bfe1aafa0fd,0xa05a22e4a3fb2364
.quad 0x23a8a2a7164621a8,0xa22f23d99f8b9e1f,0xa11323ffa16a972a,0x1e54a39f22d5995c,0x1646a26423dea042,0x147c217fa4002155,0x1f8b1cdca329238d,0xa0299bfe22f2a3b0
.quad 0xa30e1cdc1f25a38d,0x22d59bfe9fef23b0,0x23f6a26419cd2042,0xa3fb217f8b2ea155,0xa22f23ffa1e4172a,0x2359a39f2029195c,0x1ca5a2a723f6a1a8,0xa11323d9a30e1e1f
.quad 0x1ca51db5a2d523f3,0x1aafa21d23fea286,0xa22f1bfe1deaa2c6,0x1c371db5a2b723fd,0x23f6a21d1c371d49,0xa16a18791f25a300,0xa30e23f9a2531d49,0x2383a0cf147c1fbd
.quad 0x1f8ba2e42400a2c6,0xa3f0234da08a132d,0x16461e89a27523f3,0x2297a3f92341a0a1,0xa1131a3e1ca5a1a8,0x9f8b22a7a3f62364,0x23a8a1d01d7f172a,0xb2e9f582275a3e3
.quad 0x1f8ba3d9222f8000,0x964622a7a3a81e1f,0x980722a7a3b81ef1,0x98eba1292400a155,0x9b8fa07223e8a241,0x1e541e89a3962300,0x208a1a3ea2b723cd,0xa0e698792275a3e3
.quad 0xa2971a3e205aa3cd,0x22539879a0b823e3,0x23c6a07298eb2241,0xa3591e891d12a300,0xa3f022a79c379ef1,0x23e8a1298b2e2155,0x230ea3d921138000,0xa3f622a79ca59e1f
.quad 0xa13f23d9a3291ef1,0x2383a39f208a132d,0x1d7fa2a723fea241,0xa29723ffa2531c6e,0xb2e2072a36f23cd,0x213fa3bf2383a0a1,0x9dea9a3e2194a3cd,0x9f2522e4a3fe2286
.quad 0x216a9a3e9d7f2241,0x1aafa17f23b8a3b0,0xa3292072947c9ef1,0x11621f58a2b723fd,0x23f6a2a71f8b8000,0x9ca59a3e2113a364,0xa3b823d9a2531ef1,0x202995619dea21f7
.quad 0x9ca5a07223f6a1a8,0x21131a3ea30e2364,0x1ebd1e89a3a822c6,0xa13f987922b7a3b0,0xa05a9bfe230ea38d,0x216a1561a25323e3,0x213f1561a22f23f3,0xa1948f2e21e4a3fd
.quad 0xa20a15612113a3f3,0x21bc8f2ea16a23fd,0x22b79bfe9f8b238d,0xa1e4156120e6a3e3,0xa3411e891ca5a2c6,0x220a9879a05a23b0,0x23a8a072964621a8,0xa22f1a3e1f8ba364
.quad 0xa3e8217f9646a042,0x22539bfe9e542300,0x2400a2641ca51d49,0xa2751cdc1d12a286,0xa3f0231c9f8b972a,0x22979db59b8f21f7,0x23b8a39f2113972a,0xa2b71e8918eba155
.quad 0xa35923eca22f1d49,0x22d59f58947c20a1,0x22d5a3ff230ea042,0xa2f220118b2e9fbd,0xa22f23d9a3a821a8,0x230ea07216461e1f,0x216aa37923f6a2c6,0xa32920cf99cd9c6e
.quad 0xa30e1a3e2113a400,0x23f6a0729ca52364,0x22b79879a13f2400,0xa3a81e891ebda3b0,0xa2531561216aa400,0x230e9bfea05a23e3,0x21e48f2ea1942400,0xa22f1561213fa3fd
.quad 0xa16a8f2e21bca400,0x21131561a20a23fd,0x20e61561a1e42400,0x9f8b9bfe22b7a3e3,0xa05a9879220aa400,0x1ca51e89a34123b0,0x1f8b1a3ea22f2400,0x9646a07223a8a364
.quad 0x9e549bfe2253a400,0x9646217fa3e82300,0x1d121cdca2752400,0x1ca5a2642400a286,0x9b8f9db52297a400,0x9f8b231ca3f021f7,0x18eb1e89a2b72400,0x2113a39f23b8a155
.quad 0x947c9f5822d5a400,0xa22f23eca35920a1,0x8b2e2011a2f22400,0x230ea3ff22d59fbd,0x1646a072230ea400,0xa3a823d9a22f1e1f,0x99cd20cfa3292400,0x23f6a379216a9c6e
.quad 0xa3a822a79646a1a8,0x222fa3d91f8b1e1f,0x2400a12998eb22c6,0xa3b822a79807a155,0xa3961e891e54a38d,0x23e8a0729b8f2300,0x22759879a0e623f3,0xa2b71a3e208aa3e3
.quad 0xa0b898792253a3f3,0x205a1a3ea29723e3,0x1d121e89a359238d,0x98eba07223c6a300,0x8b2ea12923e8a2c6,0x9c3722a7a3f02155,0x9ca522a7a3f621a8,0x2113a3d9230e9e1f
.quad 0x208aa39f2383a042,0xa32923d9a13f132d,0xa25323ffa2971d49,0x23fea2a71d7f1c6e,0x2383a3bf213f972a,0xa36f20720b2ea0a1,0xa3fe22e49f25972a,0x21949a3e9dea2286
.quad 0x23b8a17f1aaf1d49,0x9d7f9a3e216aa3b0,0xa2b71f581162a042,0x947c2072a32923fd,0x21139a3e9ca521a8,0x1f8ba2a723f6a364,0x9dea95612029a2c6,0xa25323d9a3b821f7
.quad 0x9f8b23d9a22f8000,0x1646a2a723a89e1f,0x22d5a39f1e541ef1,0xa16a23ffa113995c,0xa400217f147ca241,0x23dea26416462155,0x22f29bfea02923cd,0xa3291cdc1f8ba3b0
.quad 0x9fef9bfe22d5a3cd,0x1f251cdca30e23b0,0x8b2e217fa3fb2241,0x19cda26423f6a155,0x2029a39f23599ef1,0xa1e423ffa22f195c,0xa30e23d9a1138000,0x23f6a2a71ca51e1f
.quad 0x23fea21d1aaf1ef1,0xa2d51db51ca5a286,0xa2b71db51c37a241,0x1dea1bfea22f23fd,0x1f251879a16a23cd,0x1c37a21d23f6a300,0x147ca0cf2383a3cd,0xa25323f9a30e1fbd
.quad 0xa08a234da3f02241,0x2400a2e41f8b132d,0x2341a3f922979ef1,0xa2751e891646a0a1,0xa3f622a79f8b8000,0x1ca51a3ea1132364,0x22759f580b2e1ef1,0x1d7fa1d023a8a3e3
.quad 0x1ca52072a3f621a8,0xa1139a3e230ea364,0x1f25a3bf2297972a,0x99cd22e4a3961e1f,0xa383231c9c37a042,0x22f2a39f1ebd1e1f,0x23599db59ebd238d,0xa3831e891deaa364
.quad 0x9e549db52341a38d,0x1d7f1e89a36f2364,0x9d7f231ca3b82042,0x1fefa39f23419e1f,0x2329a3bf208a172a,0xa3de22e49d129e1f,0xa3a820721646a1a8,0x222f9a3e9f8b2364
.quad 0x1fef1879a1bc23f3,0x8b2ea0cf23b8a364,0x1b8fa21d23fba2c6,0xa20a23f9a2d51e1f,0xa2b723ffa2751d49,0x23e8a1d01aaf1e1f,0x23dea1d01b8f1d49,0xa0298f2e208aa364
.quad 0xa0b815611f25a2c6,0x9d12221da3e82364,0x980720cfa35923f3,0x236fa3ec22539e1f,0x222fa3d923a8a1a8,0xa30e207296469e1f,0xa3fb22e4a05a172a,0x1aaf1bfea13f2364
.quad 0x230e9a3ea1132400,0xa3f620721ca5a364,0x9646a17f23fea0fd,0x1dea1f58a3c62286,0xa22f23eca08a9b1f,0x213fa3ff2194132d,0x23a89f589d122335,0xa3c620111c37a300
.quad 0x9ca59f582396a335,0x1b8f2011a3b82300,0xa11323eca2971b1f,0x220aa3ff21bc932d,0x23f6a17f116220fd,0xa36f1f581b8fa286,0x9f8b9a3e222fa400,0x16462072a3a82364
.quad 0x9f8b234da3c620fd,0x22b7a3f921e4995c,0x23f6a2e41e541b1f,0xa2f21e891aafa1f7,0xa11315611fefa335,0x916220cfa39623b0,0x9ca5221da3f02335,0x2341a3ec220a9c6e
.quad 0x23a8a3bf21949b1f,0xa2531db519cda155,0xa22f1db518eba0fd,0x99cd2129a38323e3,0x96462072a30e2400,0x23a8a3d9222f9e1f,0x230ea3ff2341a0fd,0xa1941cdc18eba0a1
.quad 0x23a8a2a7164621a8,0xa22f23d99f8b9e1f,0xa0e69a3e22f2a38d,0x22759561a19423fd,0xa02923d9a275172a,0x1deaa37923299c6e,0x23dea0729aaf22c6,0xa3f020cf18eba286
.quad 0x99cda07223d3a2c6,0x180720cfa3e82286,0xa2d523d9a0b8972a,0x236fa3791f251c6e,0x22539a3e9fef238d,0xa0b8956121bca3fd,0x1ca5a2a723f6a1a8,0xa11323d9a30e1e1f
.quad 0xa3fb22a79d129d49,0x23419f5899cd21f7,0x1ebd1a3ea1e423f3,0x19cda1d023f0a300,0x2194a3d92359a042,0xa3fb22e49ebd995c,0xa35920728b2ea042,0x1d121bfea1e423e3
.quad 0x91622072a34123f3,0x22b7a3ff22f29fbd,0x2396a3d9220a9d49,0xa1e41cdc1aafa155,0xa1131a3e1ca5a1a8,0x9f8b22a7a3f62364,0x9fef22a7a3f0238d,0x23c6a21d1e54132d
.quad 0x1f8ba3d9222f8000,0x964622a7a3a81e1f,0xa3831db51f8ba3cd,0x23fba0cf9aaf2300,0x9aaf22e4a3a81ef1,0x1162a21d23f0a0a1,0x23fba12996462241,0xa400217f1162a1f7
.quad 0x947ca12923f6a241,0xb2e217fa3fe21f7,0xa3d322e49ca59ef1,0x23fea21d180720a1,0x1d7f1db5a30e23cd,0x947ca0cf23d3a300,0x230ea3d921138000,0xa3f622a79ca59e1f
.quad 0xa0b88f2e2113a3cd,0x18072011a36f23b0,0xa1bc23eca30e1ef1,0x23e8a31c1f25195c,0x22539cdc9ca52241,0x99cd9e8922d5a3fd,0x1fefa31c23f6a241,0xa3d32379a0b8132d
.quad 0xa36f20cf96469ef1,0x1b8f1cdca20a23e3,0x9b8f217fa3a823cd,0x23b8a3bf21bc9c6e,0x23f6a2a71f8b8000,0x9ca59a3e2113a364,0x91629e89222fa3cd,0xa39623eca2971fbd
.quad 0x9ca5a07223f6a1a8,0x21131a3ea30e2364,0xa3d32264947ca1a8,0x230ea3791d7f1fbd,0x18072129a3fe21a8,0x9ca5a01123d3a286,0x23fea1d00b2e21a8,0xa3f6221d947ca155
.quad 0x1162a1d02400a1a8,0x9646221da3fb2155,0xa3f021291162a1a8,0x23a8a0119aaf2286,0x9aaf2264a3fb21a8,0x1f8ba37923839fbd,0x23a8a072964621a8,0xa22f1a3e1f8ba364
.quad 0x1deaa2e423f0a1a8,0xa22f23ffa2751c6e,0xa3291f5818eba1a8,0x1f8b1879a19423e3,0xa029234da3de21a8,0x23a8a39f20e6932d,0x22759db59aaf21a8,0x96469f5822f2a3fd
.quad 0x213fa39f23c6a1a8,0xa3f622649dea995c,0xa1941bfe1c37a1a8,0x9ca521d0a3c623b0,0xa22f23d9a3a821a8,0x230ea07216461e1f,0x208a98799d1221a8,0x2113a34d23fea300
.quad 0xa30e1a3e2113a400,0x23f6a0729ca52364,0xa1bc23f9a0b89b1f,0x1fefa3d92253932d,0x1f251db5a36f2335,0xa0b89a3e22d5a3b0,0x23e8a264180720fd,0xa3d322a799cda0a1
.quad 0x18eba26423f0a0fd,0x9aaf22a7a3de20a1,0xa3291db51deaa335,0x22759a3ea02923b0,0xa19423f9a2751b1f,0x22f2a3d920e6132d,0x1f8b1a3ea22f2400,0x9646a07223a8a364
.quad 0x23dea31c1ebd1b1f,0xa3962072147ca155,0x1807a17f23dea335,0xa16a23d9a3411fbd,0xa3412011147ca0fd,0x1e541a3ea1bc23e3,0xa16a23bfa39620fd,0x2400a2a71e54195c
.quad 0x1fef0f2ea05a2335,0x1ebda2a723fea300,0x23d3a39f216a9b1f,0xa13f1a3e1d12a1f7,0x1646a072230ea400,0xa3a823d9a22f1e1f,0xa35921299b8f9b1f,0x98072072a2f223fd
.quad 0xa3a822a79646a1a8,0x222fa3d91f8b1e1f,0x9b8f231ca36f1d49,0x9162a1d023f6a0a1,0x21bc0f2ea20a23f3,0xa29718792113a3fd,0x23b8a2e41b8f2042,0xa396231c9ca59fbd
.quad 0x1c37a2e423c6a042,0x9d12231ca3a81fbd,0xa1940f2e213fa3f3,0x208a1879a22f23fd,0xa3c6231c9dea9d49,0x23fea1d0164620a1,0x9ca522a7a3f621a8,0x2113a3d9230e9e1f
.quad 0x216a9561a05a238d,0x9b8f9e89230ea3e3,0x23d3a34d1fef172a,0xa35920111646a155,0x1d12a26423fea2c6,0xa2f223f9a22f1c6e,0xa13f18791ebda2c6,0x98072129a3a823b0
.quad 0xa3de2379a0e6172a,0x21bc9bfe9ca521f7,0x9d7f221da3de238d,0x23e8a3792113995c,0x21139a3e9ca521a8,0x1f8ba2a723f6a364,0x23e8a39f21bc9d49,0x9ebd8f2e1f8ba286
.quad 0x9f8b23d9a22f8000,0x1646a2a723a89e1f,0x1d122011a3de2241,0xa08a9bfe2329a364,0x23419cdc9fef23cd,0xa3b81f581d7fa364,0x236fa34d1d7f1ef1,0xa34123799e549e1f
.quad 0x1deaa34d23839ef1,0x9ebd2379a3591e1f,0x9ebd9cdc22f2a3cd,0x1c371f58a3832364,0xa396201119cda241,0x22979bfe9f252364,0xa30e23d9a1138000,0x23f6a2a71ca51e1f
.quad 0x9c372264a4002241,0x2194a3ec22f29e1f,0x20291561a13f23cd,0x147ca12923c6a364,0x23d3a17f18eb1ef1,0xa0b80f2e205aa364,0x2297a3ff22d59ef1,0xa3c6217f99cd9e1f
.quad 0x18eba1292396a3cd,0xa32923f9a2751e1f,0xa0e618791deaa241,0x9e542264a3f02364,0xa3f622a79f8b8000,0x1ca51a3ea1132364,0xa20a23bfa3d32241,0x22b7a011147c1e1f
.quad 0x1ca52072a3f621a8,0xa1139a3e230ea364,0x222f8f2ea1e423f3,0xa3591cdc2029a3e3,0x23f6a0cf99cd22c6,0xa3fb21d00b2ea1f7,0x230ea39f1f251d49,0xa2d523bf9fef9c6e
.quad 0x1f8ba39f23299d49,0xa02923bfa2f21c6e,0x9646a0cf23dea2c6,0x947c21d0a40021f7,0xa1138f2e216aa3f3,0x1e541cdca2d523e3,0xa3a820721646a1a8,0x222f9a3e9f8b2364
.quad 0xa3a82379a029972a,0x23d3a129116220a1,0xa11323bfa36f2042,0x23b8a379205a132d,0x96462129a3b8238d,0x21e4a3ec23299fbd,0x1f8b1561a0e6238d,0x1d7fa26423fba300
.quad 0x230ea0118b2e2042,0x98079e892297a3fd,0x23f6a34d20b8972a,0xa08a15611ebda286,0x222fa3d923a8a1a8,0xa30e207296469e1f,0x1ca5a17f2383a3f3,0xa400231ca0b8195c
.quad 0x230e9a3ea1132400,0xa3f620721ca5a364,0x23f0a0729c372335,0xa3e8221d8b2ea1f7,0x23c6a2a718eb20fd,0xa359234d9d129fbd,0x2297a3d9205a1b1f,0xa25323eca0b8995c
.quad 0x208aa3d922b79b1f,0xa0e623eca275195c,0x1b8fa2a723e8a0fd,0x9e54234da3961fbd,0x9807a07223b8a335,0x98eb221da40021f7,0x9f8b9a3e222fa400,0x16462072a3a82364
.quad 0xa20a1a3e1f25a335,0x1d7f1cdca29723fd,0xa38320721162a0fd,0x208a0f2ea0e623b0,0xa40022a79dea9b1f,0x220a9bfe9d7f2286,0xa36f23d9a1bc1b1f,0x2329a011916220a1
.quad 0xa1e423d9a38320fd,0x23d3a1d01c371c6e,0x9f2522a7a3fb2335,0x23fea31c205a932d,0x96462072a30e2400,0x23a8a3d9222f9e1f,0x1c371a3ea0e62335,0x22d5a3f9236fa155
.quad 0x23a8a2a7164621a8,0xa22f23d99f8b9e1f,0x2341a34d1ca52042,0xa20a23eca05a9c6e,0x22b7a3bf1f8b1d49,0xa1e423f9a0e6995c,0x220aa3f92113172a,0xa1bc23ffa16a932d
.quad 0x213fa3f9222f972a,0xa19423ffa1e4132d,0x205aa3bf230e9d49,0xa16a23f9a253195c,0x1ebda34d23a8a042,0xa13f23eca2b71c6e,0x1ca5a2a723f6a1a8,0xa11323d9a30e1e1f
.quad 0x18eba1d023f6a2c6,0xa0e623bfa3591fbd,0xb2ea0cf23a8a38d,0xa0b8239fa39620a1,0x98079f58230ea3f3,0xa08a2379a3c62155,0x9c379cdc222fa3f3,0xa05a234da3e821f7
.quad 0x9e5498792113a38d,0xa029231ca3fb2286,0xa0290f2e1f8ba2c6,0x9fef22e4a4002300,0xa1131a3e1ca5a1a8,0x9f8b22a7a3f62364,0xa1e41db51646a042,0x9f252264a3de23b0
.quad 0x9c372129a3412400,0x23f6a2e4208a995c,0x9d7f217fa3592400,0x23a8a21d1f25932d,0x9ebd21d0a36f2400,0x230ea1291d12132d,0x9fef221da3832400,0x222fa01119cd195c
.quad 0xa08a2264a3962400,0x21139db511621c6e,0xa11322a7a3a82400,0x1f8b9a3e96461e1f,0xa19422e4a3b82400,0x1ca58f2e9b8f1fbd,0xa20a231ca3c62400,0x164618799dea20a1
.quad 0xa275234da3d32400,0x96461cdc9fef2155,0xa2d52379a3de2400,0x9ca51f58a0e621f7,0xa329239fa3e82400,0x9f8b20cfa1bc2286,0xa36f23bfa3f02400,0xa11321d0a2752300
.quad 0xa3a823d9a3f62400,0xa22f22a7a30e2364,0xa3d323eca3fb2400,0xa30e234da38323b0,0xa3f023f9a3fe2400,0xa3a823bfa3d323e3,0xa3fe23ffa4002400,0xa3f623f9a3fb23fd
.quad 0x947c9db521bca38d,0xa3c623d9a2751fbd,0x1b8fa0cf22f2a3f3,0xa3de22a7a05a195c,0x2029a26423b8a3f3,0xa29720729aaf995c,0x220aa3792400a38d,0xa0291a3e18eb9fbd
.quad 0x2359a3f923c6a2c6,0x98079a3e1fefa1f7,0x23f6a3d9230ea1a8,0x1ca5a072222fa364,0x23d3a31c21e4a042,0x213fa2a72396a3fd,0x22f2a1d0205a9d49,0x2341a3d923fea3b0
.quad 0x216aa0111d12972a,0x2400a3d92359a286,0x1ebd9bfe147c172a,0x2359a2a721bca0a1,0x18070f2e99cd1d49,0x216aa0721ebd9c6e,0x99cd1cdc9ebd2042,0x1d129a3e147c132d
.quad 0x9f8b2072a11321a8,0x96461a3e9ca51e1f,0xa1bc221da27522c6,0x9fef2072a0e62155,0xa329234da36f238d,0xa27522a7a2d52300,0xa3e823eca3f023f3,0xa3d323d9a3de23e3
.quad 0x1e540f2e9f252241,0x22b7a3ec23a8a1f7,0x98072011a27523cd,0x23fba31c21139c6e,0xa0e622e4a3e823cd,0x220a9f5816461c6e,0xa36f23ffa3962241,0x1aaf18799f8b21f7
.quad 0xa3e8231ca1941ef1,0x9ebd217fa30e23e3,0xa22f20729ca50000,0xa30e23d9a3f62364,0x9d7f156119cd9ef1,0xa3e8234da22f20a1,0x19cd9e8920e6a241,0xa19420119ca5132d
.quad 0x213fa2642341a3cd,0x980795611ca59fbd,0x2396a3ec23fea3cd,0x1fefa129222fa300,0x23d3a37922f2a241,0x2359a3bf23f6a3fd,0x21e4a129205a9ef1,0x23c6a379230ea286
.quad 0x1ca59a3e16468000,0x2113a0721f8b9e1f,0x9b8f1cdc9dea1ef1,0x11620f2e9646195c,0xa19421d0a20a2241,0xa08a20cfa1132155,0xa3b823bfa3c623cd,0xa396239fa3a823b0
.quad 0xa16a1cdc1807a042,0xa0e6231ca3fe2364,0xb2e9e8921e4a38d,0xa3fe2379a1bc1e1f,0x2194a34d23fea38d,0xa16a1db50b2e9e1f,0x23fea39f2253a042,0x18079f5821e4a364
.quad 0x220aa0111aaf172a,0x22b7a3bf23fba364,0x16461a3e9f8b21a8,0x23a8a2a721139e1f,0xa0e62264a36f23f3,0x1e54987998071e1f,0xa3e823f9a39622c6,0x9f252129a2752364
.quad 0xa297217fa0291d49,0xa3c623ffa3de2364,0x9aaf0f2e18eb9d49,0xa275217fa05a1e1f,0x2029a129220aa2c6,0x947c95611b8f9e1f,0x23b8a3ec2400a3f3,0x21bca26422f2a364
.quad 0x230ea2a7222fa1a8,0x23f6a3d923a8a364,0x1d129bfe19cd972a,0x208aa0111f259e1f,0x9ebd1f589fef2042,0x9c371cdc9d7f1e1f,0xa36f2379a383238d,0xa341234da3592364
.quad 0x230ea0cf1aaf1b1f,0x1d12a17f236fa3fd,0x16461cdca13f2335,0x23e8a3bf22539fbd,0xa22f239fa3fb2335,0x20b89bfe98071fbd,0xa3a82264a05a1b1f,0x9f2521d0a35923fd
.quad 0x9ca58f2e1d7fa0fd,0xa400239fa27520a1,0x2113a2a723a8a400,0x9f8b1a3e16469e1f,0x23f6a3792275a0fd,0x208aa21d2341a3e3,0x1f8b9bfe0b2e1b1f,0x23f0a3792297a155
.quad 0x9f8b2129a2532335,0x1d7f9879947c1c6e,0xa3f623f9a3b82335,0xa16a2264a32923b0,0xa11320119dea1b1f,0xa3b8234da2b721f7,0x1ca59e892029a0fd,0x9aaf15611162995c
.quad 0x23a8a3d923f6a400,0x222fa2a7230ea364,0x222fa1d0216aa0fd,0x2359a31c22d5a286,0x9646187999cd1b1f,0x147c8f2e8b2e132d,0xa30e231ca3292335,0xa2d522e4a2f22300
.quad 0xa3e822a7a029172a,0xb2e1e89a20a23b0,0x9aaf9a3e208aa2c6,0xa3b823eca2d520a1,0x22b7a3d923dea2c6,0x9fef18791b8fa0a1,0x2275a0721b8f172a,0x21bca34d23fba3b0
.quad 0x9c372072a253238d,0x22d5a1291dea932d,0xa3f623d9a30e21a8,0x9ca52072a22f2364,0x9f251a3e147c9d49,0xa3fe239fa2b72155,0x216aa2a72383a3f3,0x9aaf8f2e1c379fbd
.quad 0x236fa2a72194a042,0x2329a3bf23fea3e3,0x8b2e1a3e9dea2042,0x213fa0111d7f995c,0xa38323d9a3fe23f3,0xa08a217fa2532300,0xa13f20729f251d49,0xa383231ca29721f7
.quad 0x1f8ba0722113a1a8,0x16469a3e1ca59e1f,0x23f0a3d923b8a38d,0x23e8a3f92400a3fd,0x1b8f9a3e18eb972a,0x1e549db51d129c6e,0xa29722a7a2b722c6,0xa2532264a2752286
.quad 0x23dea3bf222f9ef1,0x9d7f95611fefa286,0x1d1215619f8b2241,0x236fa3ff2341a155,0xa32923f9a3a82241,0x1e548f2e9d7f2155,0xa08a1bfe16469ef1,0xa34123f9a3b82286
.quad 0x21e4a34d23f6a3cd,0x9f25187919cd9fbd,0x222fa0721ca58000,0x230ea3d923f6a364,0xa02921d0a30e23cd,0x1fef9bfe8b2e1c6e,0xa3592264a1131ef1,0xa2d5239fa3fb23e3
.quad 0x1c379f582113a241,0xa05a1db598eb932d,0x23f0a39f230ea241,0x2297a34d23c6a3fd,0xb2e18799ca51ef1,0x20b89f581d12995c,0xa3e823ffa3f623cd,0xa25322e4a35923b0
.quad 0x9ca51a3e96460000,0xa11320729f8b1e1f,0x2341a37923a8a3cd,0x220aa26422b7a300,0x205aa0111f8b9ef1,0x216aa12920e6a0a1,0xa20a221da22f2241,0xa1bc21d0a1e421f7
.quad 0xa2f223f9a38321a8,0x21139bfe99cd20a1,0x9ebd0f2e1deaa1a8,0xa30e23f9a39621f7,0x2383a3ff2359a1a8,0x9ca595611f25a1f7,0x1c3715619ebd21a8,0x23f6a3bf2297a0a1
.quad 0xa3de23eca32921a8,0x96461e89a16a2300,0x96469a3e1f8ba1a8,0xa3a822a7a1131e1f,0x2400a3bf22f2a1a8,0x1f8ba17f22d5a3b0,0x947c1cdca02921a8,0x222fa0cf1e54995c
.quad 0xa3e82379a2b721a8,0xa22f231ca3b823fd,0x1b8f9e89208aa1a8,0x9f8b1cdc9807932d,0x2396a31c2275a1a8,0x23a8a3ec2400a3e3,0x9e542011a0e621a8,0x16460f2e98eb1c6e
.quad 0xa30e22a7a22f21a8,0xa3f623d9a3a82364,0x205aa0cf213fa1a8,0x1ca59db51ebd9fbd,0x2253a21d21e4a1a8,0x230ea2e422b7a286,0xa16a217fa19421a8,0xa1132129a13f2155
.quad 0x213fa34d2400a335,0xa2d5207298eb9c6e,0x202998799c3720fd,0x2297a3d923d3a286,0xa3c623eca2f220fd,0x19cd1a3ea05a2286,0x147c9e892194a335,0xa3c622a7a0b81c6e
.quad 0x236fa21d20299b1f,0x20e6a2a723b8a3fd,0xa11322a7a3a82400,0x1f8b9a3e96461e1f,0xa05a1cdc91629b1f,0xa3fb23d9a32921f7,0x23b8a3ff23d3a335,0x1d7fa07221e4a300
.quad 0x91621bfe9f2520fd,0x21bca0721dea995c,0xa38322e4a20a20fd,0xa36f23d9a40023e3,0x20e6a1d02297a335,0x11629a3e1d7f9fbd,0x208a9f581d7f9b1f,0x2329a2a7220aa155
.quad 0xa3a823d9a3f62400,0xa22f22a7a30e2364,0xb2e956118eb9b1f,0x9c371a3e9807132d,0x2396a3792359a335,0x23e8a3d923c6a3b0,0xa0b820cfa0e620fd,0xa05a2072a08a20a1
.quad 0x9dea21d0a39623f3,0x23d3a2641f8b932d,0xa0e61bfe18eba042,0xa20a239fa3f62300,0x23f0a3bf2275a042,0x947c9cdc2113a300,0x9e54217fa32923f3,0x22b7a0cf1ca5132d
.quad 0xa0b81cdc0b2e9d49,0xa38323ffa3a82286,0x23f6a3d9230ea1a8,0x1ca5a072222fa364,0x9ebd2129a297238d,0x20b89db51646195c,0xa08a1db59807972a,0xa40023bfa30e21f7
.quad 0x23fba3ec2383a2c6,0x20e6a21d230ea3b0,0x9f2520cfa1e422c6,0x1c37956196461c6e,0xa05a1e899c37172a,0xa36f22e4a22f2155,0x23fea3f923d3a38d,0x22d5a34d23a8a3e3
.quad 0x9f8b2072a11321a8,0x96461a3e9ca51e1f,0xa0291f589e541d49,0xa1e4217fa11320a1,0x2400a3ff23fba3f3,0x23dea3ec23f6a3fd,0x9fef2011a0292042,0x9f251f589f8b1fbd
.quad 0x11629f582253a3cd,0xa3f0239fa1e41e1f,0x21949db591621ef1,0x216aa34d2400a364,0xa4002379a1e41ef1,0x91621e89a1bc2364,0x216aa31c23f0a3cd,0xa0e61cdc11629e1f
.quad 0x147c1bfea05a2241,0x23d3a2e4213f9e1f,0xa22f20729ca50000,0xa30e23d9a3f62364,0x23f0a3ec2359a241,0x1deaa0cf2253a364,0xa0b8221da32923cd,0x1d12956198eb1e1f
.quad 0x99cd8f2e1b8f9ef1,0xa2d521d0a08a1e1f,0x22b7a1d020b89ef1,0x23e8a3ff23d3a364,0xa3c623f9a3fb23cd,0xa13f221da2d52364,0x1fefa0cf2194a241,0xb2e98791c379e1f
.quad 0x1ca59a3e16468000,0x2113a0721f8b9e1f,0xa32922e4a2972241,0xa3de23bfa3962364,0x2383a39f23b8a3cd,0x22f2a31c2341a364,0x9e541e899ebd1ef1,0x9d7f1db59dea1e1f
.quad 0x1ca51879a05a22c6,0x2329a3ff2359a155,0xa22f1f58947c9d49,0xa0b822e4a3f023b0,0x23f6a31c213f9d49,0x18eba0112253a3b0,0xa30e23eca3d322c6,0x1d120f2e9dea2155
.quad 0x1f8ba1d02341a3f3,0xa1bc1f5898eb995c,0x16461a3e9f8b21a8,0x23a8a2a721139e1f,0xa1131e8998eb972a,0xa3de23f9a3832286,0x23a8a2e421bca042,0x2253a34d23dea3fd
.quad 0xa3a823f9a3f0238d,0x9ebd20cfa20a2300,0x2113a21d22f2a38d,0x916298791d129fbd,0x96461bfe9e542042,0x1fef9db51aaf932d,0x9f8b1db59b8f172a,0xa2b7221da16a20a1
.quad 0x230ea2a7222fa1a8,0x23f6a3d923a8a364,0xa3f623ffa3fe23f3,0xa36f239fa3c623e3,0x222fa2642297a2c6,0x213fa17f21bca1f7,0x9ca51cdc9d121d49,0x9b8f1bfe9c371c6e
.quad 0xa0b81a3e1b8fa0fd,0xa1942379a3fb2300,0x22b7a07219cd1b1f,0x1fefa26423c6a3e3,0xa3d322a7a08a1b1f,0x9c3720cfa2d523e3,0x23e8a3d922d5a0fd,0xb2e9db5213fa300
.quad 0xa2f223d9a3f02335,0x1b8f15619e542155,0x2113a2a723a8a400,0x9f8b1a3e16469e1f,0x9d122072a20a2335,0x216a9f581aaf132d,0x91629a3e1ebda0fd,0xa2b7217f9fef1c6e
.quad 0x1e549a3e8b2e1b1f,0x2396a2e421e4a0a1,0xa19420729e541b1f,0xa3fb23bfa3412286,0x2341a2a721e4a0fd,0x23dea3ff23f0a3b0,0xa3fb23d9a3962335,0xa341239fa3de23fd
.quad 0x23a8a3d923f6a400,0x222fa2a7230ea364,0xa25322a7a2f22335,0xa0b82129a19421f7,0x2029a07220b8a0fd,0x1dea9e891f259fbd,0x99cd1a3e9aaf1b1f,0x9807187998eb195c
.quad 0x2297a01116461d49,0x1ebda21d23b8a3e3,0xa32921299ca5972a,0x9e5421d0a38323fd,0x2396a21d1f8b972a,0x1deaa17f2341a3fd,0xa3de22e4a1131d49,0x9d7f2129a2f223e3
.quad 0x23fea379222fa042,0x1d12a0cf2297a3b0,0xa3f623d9a30e21a8,0x9ca52072a22f2364,0x23c6a3ff23a8a2c6,0x1c37a01121bca300,0xa36f23eca3f6238d,0x9b8f1f58a13f2286
.quad 0x22f2a39f23f6a3f3,0x1aaf9e8920b8a1f7,0xa253231ca3a823f3,0x99cd1db5a0292155,0x2194a264230ea38d,0x18eb9cdc1f25a0a1,0xa0b8217fa22f22c6,0x98071bfe9dea1fbd
.quad 0x1f8ba0722113a1a8,0x16469a3e1ca59e1f,0x9d7f1e899f8b2042,0x947c18799aaf1c6e,0x1aaf9bfe1ca59d49,0x116295611807995c,0x947c15619646172a,0x8b2e0f2e9162132d
.quad 0xa3b8221d9ebd0000,0x96462011a29723e3,0x2383a1d01e548000,0x1ca5a1292329a3fd,0xa341217f9dea0000,0x9f8b221da39623fd,0x22f2a1291d7f8000,0x2113a2e423dea3e3
.quad 0xa29720cf9d120000,0xa22f2379a3fe23b0,0x222fa0721ca58000,0x230ea3d923f6a364,0xa1bc20119c370000,0xa3a823ffa3c62300,0x213f9f581b8f8000,0x23f6a3ec236fa286
.quad 0xa0b81e899aaf0000,0xa3f6239fa2f221f7,0x20299db519cd8000,0x23a8a31c2253a155,0x9f251cdc98eb0000,0xa30e2264a19420a1,0x1dea9bfe18078000,0x222fa17f20b89fbd
.quad 0x9ca51a3e96460000,0xa11320729f8b1e1f,0x1aaf9879147c8000,0x1f8b9e891d7f9c6e,0x9807156191620000,0x9ca51bfe9aaf195c,0x11628f2e0b2e8000,0x16469561147c932d
.quad 0x23fba37921949d49,0x9b8f9a3e20b8a300,0xa3c622649fef172a,0x99cd2072a2b723e3,0x22d5a0cf1c37172a,0x208aa2a723d3a3e3,0xa13f1db58b2e9d49,0xa2d523d9a3e82300
.quad 0x1e5495619b8f2042,0x23f0a3d922f2a155,0x96469a3e1f8ba1a8,0xa3a822a7a1131e1f,0x9aaf1f58a16a22c6,0x220aa0721d12932d,0x1fefa17f22b7a38d,0x9ebd1a3e11629c6e
.quad 0xa1e422e4a39623f3,0xb2e1a3e9e5420a1,0x2341a3bf23fba3f3,0x1e54a0722194a286,0xa3f023ffa3de238d,0xa1e422a7a34123b0,0x23dea39f2341a2c6,0x2396a3d923fba3fd
.quad 0xa30e22a7a22f21a8,0xa3f623d9a3a82364,0x2194a12920b8a042,0x22f2a2a72253a1f7,0x9f251e899dea1d49,0xa0b82072a0291fbd,0x18eb98791807972a,0x1aaf9a3e19cd995c
.quad 0xa35923ffa32920fd,0x205a98799ca52155,0x23f0a2e420b89b1f,0x147c9f58222fa3b0,0xa253201198eb9b1f,0xa13f231ca3f623b0,0x1dea8f2e9d1220fd,0x23d3a3ec230ea155
.quad 0x18eb9f5821bca335,0xa34121d09f8b195c,0xa11322a7a3a82400,0x1f8b9a3e96461e1f,0x2383a3f923dea335,0x18eb9e892113a286,0xa3de234da25320fd,0xa1bc22e4a3a823fd
.quad 0x220aa0cf1ebd9b1f,0x23f0a3f923a8a300,0x9d12187911629b1f,0xa2f2221da1131fbd,0x9aaf1db59fef20fd,0x1e549bfe1646132d,0x216aa21d22b7a335,0x1b8f9db51f8ba0a1
.quad 0xa3a823d9a3f62400,0xa22f22a7a30e2364,0x23c6a39f236fa335,0x23fea3ff23f6a3e3,0xa1bc217fa13f20fd,0xa2972264a22f21f7,0x1c379bfe1b8f9b1f,0x1d129cdc1ca59c6e
.quad 0x21e4a39f23f0a2c6,0xa2531f5891629e1f,0xa400234da16a1d49,0x11621db5a1942364,0x21bc9e8911621d49,0x21e4a3792400a364,0x91629cdc20e6a2c6,0xa3f0231ca16a1e1f
.quad 0xa13f22e4a3d323f3,0x205a9bfe947c1e1f,0x23f6a3d9230ea1a8,0x1ca5a072222fa364,0xa25320cf9dea172a,0xa35923eca3f02364,0x18eb15619d122042,0x2329a21d20b89e1f
.quad 0x208aa1d022d5a38d,0x9b8f0f2e19cd9e1f,0xa3d323ffa3e8238d,0xa0b821d0a2b72364,0x22d5a21d213fa042,0x23fba3f923c6a364,0x9c3718798b2e972a,0xa19420cf9fef1e1f
.quad 0x9f8b2072a11321a8,0x96461a3e9ca51e1f,0x2396a3bf23dea3f3,0x2297a2e42329a364,0xa341231ca2f222c6,0xa3b8239fa3832364,0x1dea9db51d7f9d49,0x1ebd9e891e549e1f
.quad 0x9f8b2264a3d323cd,0x2396a1d01dea132d,0x23f6a39f220a9ef1,0x98eb9bfe20e6a300,0xa1131cdc147c9ef1,0xa27523bfa3f02300,0x9ca520cfa2b723cd,0x2329a17f1e54932d
.quad 0x23a8a3ff2383a241,0x8b2e9cdc20b8a286,0xa22f20729ca50000,0xa30e23d9a3f62364,0x96461db5a0b82241,0x2297a1291ebd995c,0x230ea3bf2400a3cd,0x18079db5208aa1f7
.quad 0xa30e221da0e61ef1,0xa38323eca3fb23b0,0x164615619c371ef1,0x21e4a0cf1f259c6e,0x222fa2e4236fa3cd,0x1c379e89205aa155,0xa3a8234da2d52241,0xa3d323f9a3fe23e3
.quad 0x1ca59a3e16468000,0x2113a0721f8b9e1f,0x2113a17f21e4a241,0x1e549f582029a0a1,0xa3f623eca3de23cd,0xa3fb23ffa40023fd,0x1f8b9f581f259ef1,0x2029a0111fef9fbd
.quad 0x18eba07222d5a3f3,0xa400234da13f1c6e,0xa3d323d9a2972042,0x1c371879a0292286,0x205a9a3e99cd2042,0x22f2a3ec23c6a286,0x20b8a2a723c6a3f3,0xa1941e89947c9c6e
.quad 0xa3b822a7a0e61d49,0xa029221da36f23fd,0x16461a3e9f8b21a8,0x23a8a2a721139e1f,0x2329a3d923fba38d,0x11629cdc205aa1f7,0xa1e420729d7f172a,0xa3d323ffa3b82300
.quad 0x9dea2072a1bc22c6,0x1f259bfe1162195c,0x2400a3d9236fa2c6,0x220aa2e42383a3e3,0x9d7f1a3e9162972a,0xa29721d0a0e61fbd,0xa20a22a7a329238d,0x9d7f1f58a08a2155
.quad 0x230ea2a7222fa1a8,0x23f6a3d923a8a364,0x18079a3e1c379d49,0x98eb15618b2e932d,0xa3c623d9a3e823f3,0xa3592379a39623b0,0x208aa072205aa042,0x20e6a0cf20b8a0a1
.quad 0x19cd1bfea1132335,0x2383a3f922f2a0a1,0x2396a3f9230ea0fd,0x9dea8f2e1ebda1f7,0x9f2515611ca5a0fd,0xa35923ffa38321f7,0xa29723bfa3f62335,0x1ebd95619c3720a1
.quad 0x216a9e8916461b1f,0x2329a3ec23dea300,0x2113a2a723a8a400,0x9f8b1a3e16469e1f,0xa2d5217f9f8b1b1f,0xa2f223bfa40023b0,0x9e5420cfa22f2335,0x20299cdc147c195c
.quad 0x23b8a31c222fa0fd,0x22b7a37923e8a3fd,0x18079cdc1f8ba0fd,0xa08a1e899b8f132d,0xa40023eca3a82335,0xa275231ca39623e3,0x18eb8f2e96461b1f,0x20e6a0111e549c6e
.quad 0x23a8a3d923f6a400,0x222fa2a7230ea364,0x9ebd1db59ca51b1f,0xa13f20cfa05a1fbd,0xa2b722e4a30e2335,0xa1e4221da2532286,0x213fa1292113a0fd,0x2194a17f216aa155
.quad 0x9fef15611d7fa1a8,0xa22f23bfa3de2286,0xa34123ffa36f21a8,0x1f8b95619d122155,0x1d7f0f2e9e5421a8,0x23a8a3f92329a155,0x23b8a3f92341a1a8,0x96469bfe208aa286
.quad 0x99cd98791f25a1a8,0xa3f6234da1e41fbd,0xa3f623d9a30e21a8,0x9ca52072a22f2364,0xb2e1bfe9fef21a8,0x230ea1d020299c6e,0x23fba39f22d5a1a8,0x2113a2642359a3e3
.quad 0x18eb9db5205aa1a8,0xa1131f589c37132d,0xa3c6234da29721a8,0xa30e239fa3f023fd,0x9d121f58a0b821a8,0x1ca598798b2e195c,0x2359a2e42253a1a8,0x23f6a3ff23e8a3b0
.quad 0x1f8ba0722113a1a8,0x16469a3e1ca59e1f,0xa2b72264a20a21a8,0xa3a82379a3412300,0xa0e62129a16a21a8,0x9f8b2011a05a20a1,0x21e4a1d021bca1a8,0x222fa21d220aa1f7
.quad 0x220a9e898b2e1ef1,0x2029a2a723e8a3b0,0x22d5a3ec23b8a241,0xa08a1a3e1aafa0a1,0x9b8f98791fefa241,0xa3de23d9a2b720a1,0xa3fb234da1bc1ef1,0x9b8f2072a27523b0
.quad 0x9dea2129a2d523cd,0x2253a0721c37132d,0x222fa0721ca58000,0x230ea3d923f6a364,0x22b7a39f23fea3cd,0x947c9a3e1f25a155,0x9c370f2e1aaf9ef1,0xa38322a7a16a1fbd
.quad 0xa3fe23bfa3292241,0xa19422a7a36f23e3,0x9d7f2011a13f2241,0x1dea9a3e0b2e195c,0x2253a17f208a9ef1,0x23fea3d92383a300,0x2297a31c2383a3cd,0x1f25a072213fa1f7
.quad 0x9ca51a3e96460000,0xa11320729f8b1e1f,0xa40023f9a3e823cd,0xa3b823d9a3f023fd,0x9d121db59e541ef1,0x98eb1a3e9b8f1c6e,0x2275a2642253a241,0x22b7a2a72297a286
.quad 0xa36f217f9d12972a,0x9aaf20cfa30e23fd,0xa25323bfa3e822c6,0x213f9cdc96461fbd,0x18071bfea0b822c6,0x23fba39f222f9fbd,0x2359a1d01f25972a,0x205aa26423a8a3fd
.quad 0x2275a39f2400a38d,0x9d7f0f2e1ca5a0a1,0x96469a3e1f8ba1a8,0xa3a822a7a1131e1f,0xa341221da08a1d49,0xa2752379a3f623e3,0xa2972379a3f023f3,0x8b2e1bfe9f8b2155
.quad 0x147c18799d7f2042,0x2253a1291f8b9c6e,0x2329a264216aa042,0x23b8a3f923f6a3b0,0x22b7a34d23b8a3f3,0x1deaa0112113a1f7,0x916295611aaf9d49,0xa0291e899ca5195c
.quad 0xa30e22a7a22f21a8,0xa3f623d9a3a82364,0xa2d5231ca359238d,0xa16a21d0a22f2286,0xb2e0f2e947c172a,0x19cd98791646932d,0x22f2a2e422d5a2c6,0x2329a31c230ea300
.quad 0x23fea31c20e69b1f,0x98079cdc216aa364,0x21bca37923fea335,0xa1e41e898b2e9e1f,0x8b2e9db5216aa335,0xa3fe234da1941e1f,0xa1e41f5898079b1f,0xa253239fa3fe2364
.quad 0xa3fb23bfa2b720fd,0x9aaf2011a20a2364,0xa11322a7a3a82400,0x1f8b9a3e96461e1f,0x180718799e5420fd,0x236fa26420e69e1f,0x2275a1291f259b1f,0x2396a3f923e8a364
.quad 0x23dea3ff23c6a335,0x2029a17f2297a364,0x205aa17f2275a335,0x98eb8f2e1aaf9e1f,0x9b8f1561147c9b1f,0xa20a2129a0291e1f,0xa2f22264a1bc20fd,0xa40023eca3b82364
.quad 0xa3a823d9a3f62400,0xa22f22a7a30e2364,0x9f252011a08a20fd,0x99cd1bfe9d121e1f,0x1d7f9cdc1c379b1f,0x1fef9f581ebd9e1f,0x2359a34d2341a335,0x2383a379236fa364
.quad 0xa3a823eca2b72042,0x1f258f2e9e5421f7,0xa113231ca3fb238d,0x2275a01118071c6e,0x96461f58a20a238d,0x23e8a2e420e69c6e,0x1f8b98799aaf2042,0x2396a3ff236fa1f7
.quad 0x230ea17f1ebd972a,0x2194a31c23e8a3e3,0x23f6a3d9230ea1a8,0x1ca5a072222fa364,0x222fa34d23e8a3f3,0x99cd95611d7fa0a1,0x1ca5a0112194a2c6,0xa0e61e8999cd932d
.quad 0x9ca5156118079d49,0xa3412264a13f1fbd,0xa22f21299fef1d49,0xa3fe23eca3962300,0xa3f623bfa35922c6,0xa2f22379a3d323fd,0xa30e2379a3c623f3,0xa05a2129a1e42286
.quad 0x9f8b2072a11321a8,0x96461a3e9ca51e1f,0x16468f2e9162172a,0x1dea9cdc1b8f995c,0x2113a0cf208aa042,0x220aa1d02194a155,0x23a8a39f2396a38d,0x23c6a3bf23b8a3b0
.quad 0x2275a3d923c6a241,0xa1bc1db5147c9fbd,0x205aa2a723dea3cd,0xa2f220cf9b8f995c,0x1aafa0722297a3cd,0xa3b82264a029195c,0x98eb9a3e2029a241,0xa4002379a20a1fbd
.quad 0x9fef1a3e18079ef1,0xa3c623f9a35921f7,0xa22f20729ca50000,0xa30e23d9a3f62364,0xa39622a7a13f1ef1,0xa1e4231ca3d323fd,0xa3fe23d9a3412241,0xa05a21d0a2f223b0
.quad 0xa35923d9a40023cd,0x9d122011a16a2286,0xa1bc22a7a35923cd,0x947c1bfe9ebd20a1,0x9ebd2072a16a2241,0x19cd8f2e98071c6e,0x947c1a3e9d121ef1,0x1ebd9cdc19cd932d
.quad 0x1ca59a3e16468000,0x2113a0721f8b9e1f,0x20e6a0721fef9ef1,0x2275a21d21bca155,0x22d5a2a72275a241,0x236fa34d2329a300,0x23dea3d923d3a3cd,0x23f0a3ec23e8a3e3
.quad 0xa08a22e4a3f6238d,0x2341a1291c37195c,0x9f25221da3a823f3,0x2359a17f1d7f132d,0x9d122129a30e23f3,0x236fa1d01ebd932d,0x99cd2011a22f238d,0x2383a21d1fef995c
.quad 0x91621db5a11322c6,0x2396a264208a9c6e,0x16461a3e9f8b21a8,0x23a8a2a721139e1f,0x1b8f0f2e9ca52042,0x23b8a2e421949fbd,0x1dea987996461d49,0x23c6a31c220aa0a1
.quad 0x1fef9cdc1646172a,0x23d3a34d2275a155,0x20e69f581ca5972a,0x23dea37922d5a1f7,0x21bca0cf1f8b9d49,0x23e8a39f2329a286,0x2275a1d02113a042,0x23f0a3bf236fa300
.quad 0x230ea2a7222fa1a8,0x23f6a3d923a8a364,0x2383a34d230ea2c6,0x23fba3ec23d3a3b0,0x23d3a3bf23a8a38d,0x23fea3f923f0a3e3,0x23fba3f923f6a3f3,0x2400a3ff23fea3fd
.quad 0xa3b8221d9ebd8000,0x96462011a29723e3,0xa38321d09e548000,0x9ca52129a32923fd,0xa341217f9dea8000,0x9f8b221da39623fd,0xa2f221299d7f8000,0xa11322e4a3de23e3
.quad 0xa29720cf9d128000,0xa22f2379a3fe23b0,0xa22f20729ca58000,0xa30e23d9a3f62364,0xa1bc20119c378000,0xa3a823ffa3c62300,0xa13f1f589b8f8000,0xa3f623eca36f2286
.quad 0xa0b81e899aaf8000,0xa3f6239fa2f221f7,0xa0291db599cd8000,0xa3a8231ca2532155,0x9f251cdc98eb8000,0xa30e2264a19420a1,0x9dea1bfe98078000,0xa22f217fa0b81fbd
.quad 0x9ca51a3e96468000,0xa11320729f8b1e1f,0x9aaf1879947c8000,0x9f8b1e899d7f1c6e,0x9807156191628000,0x9ca51bfe9aaf195c,0x91620f2e8b2e8000,0x96461561947c132d
.quad 0x23fba37921949d49,0x9b8f9a3e20b8a300,0x23c6a2641fef972a,0x19cda07222b7a3e3,0x22d5a0cf1c37172a,0x208aa2a723d3a3e3,0x213f9db50b2e1d49,0x22d5a3d923e8a300
.quad 0x1e5495619b8f2042,0x23f0a3d922f2a155,0x16461a3e9f8b21a8,0x23a8a2a721139e1f,0x9aaf1f58a16a22c6,0x220aa0721d12932d,0x9fef217fa2b7238d,0x1ebd9a3e91621c6e
.quad 0xa1e422e4a39623f3,0xb2e1a3e9e5420a1,0xa34123bfa3fb23f3,0x9e542072a1942286,0xa3f023ffa3de238d,0xa1e422a7a34123b0,0xa3de239fa34122c6,0xa39623d9a3fb23fd
.quad 0xa30e22a7a22f21a8,0xa3f623d9a3a82364,0xa1942129a0b82042,0xa2f222a7a25321f7,0x9f251e899dea1d49,0xa0b82072a0291fbd,0x98eb18799807172a,0x9aaf1a3e99cd195c
.quad 0xa35923ffa32920fd,0x205a98799ca52155,0xa3f022e4a0b81b1f,0x947c1f58a22f23b0,0xa253201198eb9b1f,0xa13f231ca3f623b0,0x9dea0f2e1d12a0fd,0xa3d323eca30e2155
.quad 0x18eb9f5821bca335,0xa34121d09f8b195c,0x2113a2a723a8a400,0x9f8b1a3e16469e1f,0x2383a3f923dea335,0x18eb9e892113a286,0x23dea34d2253a0fd,0x21bca2e423a8a3fd
.quad 0x220aa0cf1ebd9b1f,0x23f0a3f923a8a300,0x1d12987991621b1f,0x22f2a21d21139fbd,0x9aaf1db59fef20fd,0x1e549bfe1646132d,0xa16a221da2b72335,0x9b8f1db59f8b20a1
.quad 0xa3a823d9a3f62400,0xa22f22a7a30e2364,0xa3c6239fa36f2335,0xa3fe23ffa3f623e3,0xa1bc217fa13f20fd,0xa2972264a22f21f7,0x9c371bfe9b8f1b1f,0x9d121cdc9ca51c6e
.quad 0x21e4a39f23f0a2c6,0xa2531f5891629e1f,0x2400a34d216a9d49,0x91629db52194a364,0x21bc9e8911621d49,0x21e4a3792400a364,0x11621cdca0e622c6,0x23f0a31c216a9e1f
.quad 0xa13f22e4a3d323f3,0x205a9bfe947c1e1f,0xa3f623d9a30e21a8,0x9ca52072a22f2364,0xa25320cf9dea172a,0xa35923eca3f02364,0x98eb95611d12a042,0xa329221da0b81e1f
.quad 0x208aa1d022d5a38d,0x9b8f0f2e19cd9e1f,0x23d3a3ff23e8a38d,0x20b8a1d022b7a364,0x22d5a21d213fa042,0x23fba3f923c6a364,0x1c3798790b2e172a,0x2194a0cf1fef9e1f
.quad 0x9f8b2072a11321a8,0x96461a3e9ca51e1f,0xa39623bfa3de23f3,0xa29722e4a3292364,0xa341231ca2f222c6,0xa3b8239fa3832364,0x9dea1db59d7f1d49,0x9ebd1e899e541e1f
.quad 0x9f8b2264a3d323cd,0x2396a1d01dea132d,0xa3f6239fa20a1ef1,0x18eb1bfea0e62300,0xa1131cdc147c9ef1,0xa27523bfa3f02300,0x1ca5a0cf22b7a3cd,0xa329217f9e54132d
.quad 0x23a8a3ff2383a241,0x8b2e9cdc20b8a286,0x222fa0721ca58000,0x230ea3d923f6a364,0x96461db5a0b82241,0x2297a1291ebd995c,0xa30e23bfa40023cd,0x98071db5a08a21f7
.quad 0xa30e221da0e61ef1,0xa38323eca3fb23b0,0x964695611c379ef1,0xa1e420cf9f251c6e,0x222fa2e4236fa3cd,0x1c379e89205aa155,0x23a8a34d22d5a241,0x23d3a3f923fea3e3
.quad 0x1ca59a3e16468000,0x2113a0721f8b9e1f,0xa113217fa1e42241,0x9e541f58a02920a1,0xa3f623eca3de23cd,0xa3fb23ffa40023fd,0x9f8b1f589f251ef1,0xa02920119fef1fbd
.quad 0x18eba07222d5a3f3,0xa400234da13f1c6e,0x23d3a3d92297a042,0x9c3798792029a286,0x205a9a3e99cd2042,0x22f2a3ec23c6a286,0xa0b822a7a3c623f3,0x21949e89147c1c6e
.quad 0xa3b822a7a0e61d49,0xa029221da36f23fd,0x96469a3e1f8ba1a8,0xa3a822a7a1131e1f,0x2329a3d923fba38d,0x11629cdc205aa1f7,0x21e4a0721d7f972a,0x23d3a3ff23b8a300
.quad 0x9dea2072a1bc22c6,0x1f259bfe1162195c,0xa40023d9a36f22c6,0xa20a22e4a38323e3,0x9d7f1a3e9162972a,0xa29721d0a0e61fbd,0x220aa2a72329a38d,0x1d7f9f58208aa155
.quad 0x230ea2a7222fa1a8,0x23f6a3d923a8a364,0x98071a3e9c371d49,0x18eb95610b2e132d,0xa3c623d9a3e823f3,0xa3592379a39623b0,0xa08a2072a05a2042,0xa0e620cfa0b820a1
.quad 0x19cd1bfea1132335,0x2383a3f922f2a0a1,0xa39623f9a30e20fd,0x1dea0f2e9ebd21f7,0x9f2515611ca5a0fd,0xa35923ffa38321f7,0x2297a3bf23f6a335,0x9ebd15611c37a0a1
.quad 0x216a9e8916461b1f,0x2329a3ec23dea300,0xa11322a7a3a82400,0x1f8b9a3e96461e1f,0xa2d5217f9f8b1b1f,0xa2f223bfa40023b0,0x1e54a0cf222fa335,0xa0291cdc947c995c
.quad 0x23b8a31c222fa0fd,0x22b7a37923e8a3fd,0x98071cdc9f8b20fd,0x208a9e891b8f932d,0xa40023eca3a82335,0xa275231ca39623e3,0x98eb0f2e16469b1f,0xa0e620119e541c6e
.quad 0x23a8a3d923f6a400,0x222fa2a7230ea364,0x1ebd9db51ca59b1f,0x213fa0cf205a9fbd,0xa2b722e4a30e2335,0xa1e4221da2532286,0xa13f2129a11320fd,0xa194217fa16a2155
.quad 0x9fef15611d7fa1a8,0xa22f23bfa3de2286,0x2341a3ff236fa1a8,0x9f8b15611d12a155,0x1d7f0f2e9e5421a8,0x23a8a3f92329a155,0xa3b823f9a34121a8,0x16461bfea08a2286
.quad 0x99cd98791f25a1a8,0xa3f6234da1e41fbd,0x23f6a3d9230ea1a8,0x1ca5a072222fa364,0xb2e1bfe9fef21a8,0x230ea1d020299c6e,0xa3fb239fa2d521a8,0xa1132264a35923e3
.quad 0x18eb9db5205aa1a8,0xa1131f589c37132d,0x23c6a34d2297a1a8,0x230ea39f23f0a3fd,0x9d121f58a0b821a8,0x1ca598798b2e195c,0xa35922e4a25321a8,0xa3f623ffa3e823b0
.quad 0x1f8ba0722113a1a8,0x16469a3e1ca59e1f,0x22b7a264220aa1a8,0x23a8a3792341a300,0xa0e62129a16a21a8,0x9f8b2011a05a20a1,0xa1e421d0a1bc21a8,0xa22f221da20a21f7
.quad 0x220a9e898b2e1ef1,0x2029a2a723e8a3b0,0xa2d523eca3b82241,0x208a9a3e9aaf20a1,0x9b8f98791fefa241,0xa3de23d9a2b720a1,0x23fba34d21bc9ef1,0x1b8fa0722275a3b0
.quad 0x9dea2129a2d523cd,0x2253a0721c37132d,0xa22f20729ca58000,0xa30e23d9a3f62364,0x22b7a39f23fea3cd,0x947c9a3e1f25a155,0x1c378f2e9aaf1ef1,0x2383a2a7216a9fbd
.quad 0xa3fe23bfa3292241,0xa19422a7a36f23e3,0x1d7fa011213fa241,0x9dea1a3e8b2e995c,0x2253a17f208a9ef1,0x23fea3d92383a300,0xa297231ca38323cd,0x9f252072a13f21f7
.quad 0x9ca51a3e96468000,0xa11320729f8b1e1f,0x2400a3f923e8a3cd,0x23b8a3d923f0a3fd,0x9d121db59e541ef1,0x98eb1a3e9b8f1c6e,0xa2752264a2532241,0xa2b722a7a2972286
.quad 0xa36f217f9d12972a,0x9aaf20cfa30e23fd,0x2253a3bf23e8a2c6,0xa13f1cdc16469fbd,0x18071bfea0b822c6,0x23fba39f222f9fbd,0xa35921d09f25172a,0xa05a2264a3a823fd
.quad 0x2275a39f2400a38d,0x9d7f0f2e1ca5a0a1,0x16461a3e9f8b21a8,0x23a8a2a721139e1f,0xa341221da08a1d49,0xa2752379a3f623e3,0x2297a37923f0a3f3,0xb2e9bfe1f8ba155
.quad 0x147c18799d7f2042,0x2253a1291f8b9c6e,0xa3292264a16a2042,0xa3b823f9a3f623b0,0x22b7a34d23b8a3f3,0x1deaa0112113a1f7,0x116215619aaf1d49,0x20299e891ca5995c
.quad 0xa30e22a7a22f21a8,0xa3f623d9a3a82364,0x22d5a31c2359a38d,0x216aa1d0222fa286,0xb2e0f2e947c172a,0x19cd98791646932d,0xa2f222e4a2d522c6,0xa329231ca30e2300
.quad 0x23fea31c20e69b1f,0x98079cdc216aa364,0xa1bc2379a3fe2335,0x21e49e890b2e1e1f,0x8b2e9db5216aa335,0xa3fe234da1941e1f,0x21e49f5818071b1f,0x2253a39f23fea364
.quad 0xa3fb23bfa2b720fd,0x9aaf2011a20a2364,0x2113a2a723a8a400,0x9f8b1a3e16469e1f,0x180718799e5420fd,0x236fa26420e69e1f,0xa27521299f251b1f,0xa39623f9a3e82364
.quad 0x23dea3ff23c6a335,0x2029a17f2297a364,0xa05a217fa2752335,0x18eb0f2e9aaf1e1f,0x9b8f1561147c9b1f,0xa20a2129a0291e1f,0x22f2a26421bca0fd,0x2400a3ec23b8a364
.quad 0xa3a823d9a3f62400,0xa22f22a7a30e2364,0x1f25a011208aa0fd,0x19cd9bfe1d129e1f,0x1d7f9cdc1c379b1f,0x1fef9f581ebd9e1f,0xa359234da3412335,0xa3832379a36f2364
.quad 0xa3a823eca2b72042,0x1f258f2e9e5421f7,0x2113a31c23fba38d,0xa275201198079c6e,0x96461f58a20a238d,0x23e8a2e420e69c6e,0x9f8b18791aafa042,0xa39623ffa36f21f7
.quad 0x230ea17f1ebd972a,0x2194a31c23e8a3e3,0xa3f623d9a30e21a8,0x9ca52072a22f2364,0x222fa34d23e8a3f3,0x99cd95611d7fa0a1,0x9ca52011a19422c6,0x20e69e8919cd132d
.quad 0x9ca5156118079d49,0xa3412264a13f1fbd,0x222fa1291fef9d49,0x23fea3ec2396a300,0xa3f623bfa35922c6,0xa2f22379a3d323fd,0x230ea37923c6a3f3,0x205aa12921e4a286
.quad 0x9f8b2072a11321a8,0x96461a3e9ca51e1f,0x96460f2e1162972a,0x9dea1cdc9b8f195c,0x2113a0cf208aa042,0x220aa1d02194a155,0xa3a8239fa396238d,0xa3c623bfa3b823b0
.quad 0x2275a3d923c6a241,0xa1bc1db5147c9fbd,0xa05a22a7a3de23cd,0x22f2a0cf1b8f195c,0x1aafa0722297a3cd,0xa3b82264a029195c,0x18eb1a3ea0292241,0x2400a379220a9fbd
.quad 0x9fef1a3e18079ef1,0xa3c623f9a35921f7,0x222fa0721ca58000,0x230ea3d923f6a364,0xa39622a7a13f1ef1,0xa1e4231ca3d323fd,0x23fea3d92341a241,0x205aa1d022f2a3b0
.quad 0xa35923d9a40023cd,0x9d122011a16a2286,0x21bca2a72359a3cd,0x147c9bfe1ebda0a1,0x9ebd2072a16a2241,0x19cd8f2e98071c6e,0x147c9a3e1d129ef1,0x9ebd1cdc99cd132d
.quad 0x1ca59a3e16468000,0x2113a0721f8b9e1f,0xa0e620729fef1ef1,0xa275221da1bc2155,0x22d5a2a72275a241,0x236fa34d2329a300,0xa3de23d9a3d323cd,0xa3f023eca3e823e3
.quad 0xa08a22e4a3f6238d,0x2341a1291c37195c,0x1f25a21d23a8a3f3,0xa359217f9d7f932d,0x9d122129a30e23f3,0x236fa1d01ebd932d,0x19cda011222fa38d,0xa383221d9fef195c
.quad 0x91621db5a11322c6,0x2396a264208a9c6e,0x96469a3e1f8ba1a8,0xa3a822a7a1131e1f,0x1b8f0f2e9ca52042,0x23b8a2e421949fbd,0x9dea187916469d49,0xa3c6231ca20a20a1
.quad 0x1fef9cdc1646172a,0x23d3a34d2275a155,0xa0e61f589ca5172a,0xa3de2379a2d521f7,0x21bca0cf1f8b9d49,0x23e8a39f2329a286,0xa27521d0a1132042,0xa3f023bfa36f2300
.quad 0x230ea2a7222fa1a8,0x23f6a3d923a8a364,0xa383234da30e22c6,0xa3fb23eca3d323b0,0x23d3a3bf23a8a38d,0x23fea3f923f0a3e3,0xa3fb23f9a3f623f3,0xa40023ffa3fe23fd
.quad 0x1c37a1292341a400,0xa3f622e4a08a195c,0x9d7f217fa3592400,0x23a8a21d1f25932d,0x1ebda1d0236fa400,0xa30e21299d12932d,0x9fef221da3832400,0x222fa01119cd195c
.quad 0x208aa2642396a400,0xa1131db591629c6e,0xa11322a7a3a82400,0x1f8b9a3e96461e1f,0x2194a2e423b8a400,0x9ca50f2e1b8f9fbd,0xa20a231ca3c62400,0x164618799dea20a1
.quad 0x2275a34d23d3a400,0x16469cdc1fefa155,0xa2d52379a3de2400,0x9ca51f58a0e621f7,0x2329a39f23e8a400,0x1f8ba0cf21bca286,0xa36f23bfa3f02400,0xa11321d0a2752300
.quad 0x23a8a3d923f6a400,0x222fa2a7230ea364,0xa3d323eca3fb2400,0xa30e234da38323b0,0x23f0a3f923fea400,0x23a8a3bf23d3a3e3,0xa3fe23ffa4002400,0xa3f623f9a3fb23fd
.quad 0x147c1db5a1bc238d,0x23c6a3d922759fbd,0x1b8fa0cf22f2a3f3,0xa3de22a7a05a195c,0xa0292264a3b823f3,0x2297a0721aaf195c,0x220aa3792400a38d,0xa0291a3e18eb9fbd
.quad 0xa35923f9a3c622c6,0x18071a3e9fef21f7,0x23f6a3d9230ea1a8,0x1ca5a072222fa364,0xa3d3231ca1e42042,0xa13f22a7a39623fd,0x22f2a1d0205a9d49,0x2341a3d923fea3b0
.quad 0xa16a20119d12172a,0xa40023d9a3592286,0x1ebd9bfe147c172a,0x2359a2a721bca0a1,0x98078f2e19cd9d49,0xa16a20729ebd1c6e,0x99cd1cdc9ebd2042,0x1d129a3e147c132d
.quad 0x1f8ba0722113a1a8,0x16469a3e1ca59e1f,0xa1bc221da27522c6,0x9fef2072a0e62155,0x2329a34d236fa38d,0x2275a2a722d5a300,0xa3e823eca3f023f3,0xa3d323d9a3de23e3
.quad 0x9e548f2e1f25a241,0xa2b723eca3a821f7,0x98072011a27523cd,0x23fba31c21139c6e,0x20e6a2e423e8a3cd,0xa20a1f5896469c6e,0xa36f23ffa3962241,0x1aaf18799f8b21f7
.quad 0x23e8a31c21949ef1,0x1ebda17f230ea3e3,0xa22f20729ca58000,0xa30e23d9a3f62364,0x1d7f956199cd1ef1,0x23e8a34d222fa0a1,0x19cd9e8920e6a241,0xa19420119ca5132d
.quad 0xa13f2264a34123cd,0x180715619ca51fbd,0x2396a3ec23fea3cd,0x1fefa129222fa300,0xa3d32379a2f22241,0xa35923bfa3f623fd,0x21e4a129205a9ef1,0x23c6a379230ea286
.quad 0x9ca51a3e96468000,0xa11320729f8b1e1f,0x9b8f1cdc9dea1ef1,0x11620f2e9646195c,0x2194a1d0220aa241,0x208aa0cf2113a155,0xa3b823bfa3c623cd,0xa396239fa3a823b0
.quad 0x216a9cdc98072042,0x20e6a31c23fea364,0xb2e9e8921e4a38d,0xa3fe2379a1bc1e1f,0xa194234da3fe238d,0x216a9db58b2e1e1f,0x23fea39f2253a042,0x18079f5821e4a364
.quad 0xa20a20119aaf972a,0xa2b723bfa3fb2364,0x16461a3e9f8b21a8,0x23a8a2a721139e1f,0x20e6a264236fa3f3,0x9e54187918079e1f,0xa3e823f9a39622c6,0x9f252129a2752364
.quad 0x2297a17f20299d49,0x23c6a3ff23dea364,0x9aaf0f2e18eb9d49,0xa275217fa05a1e1f,0xa0292129a20a22c6,0x147c15619b8f1e1f,0x23b8a3ec2400a3f3,0x21bca26422f2a364
.quad 0xa30e22a7a22f21a8,0xa3f623d9a3a82364,0x1d129bfe19cd972a,0x208aa0111f259e1f,0x1ebd9f581fefa042,0x1c379cdc1d7f9e1f,0xa36f2379a383238d,0xa341234da3592364
.quad 0xa30e20cf9aaf9b1f,0x9d12217fa36f23fd,0x16461cdca13f2335,0x23e8a3bf22539fbd,0x222fa39f23fba335,0xa0b81bfe18079fbd,0xa3a82264a05a1b1f,0x9f2521d0a35923fd
.quad 0x1ca50f2e9d7f20fd,0x2400a39f2275a0a1,0x2113a2a723a8a400,0x9f8b1a3e16469e1f,0xa3f62379a27520fd,0xa08a221da34123e3,0x1f8b9bfe0b2e1b1f,0x23f0a3792297a155
.quad 0x1f8ba1292253a335,0x9d7f1879147c9c6e,0xa3f623f9a3b82335,0xa16a2264a32923b0,0x2113a0111dea9b1f,0x23b8a34d22b7a1f7,0x1ca59e892029a0fd,0x9aaf15611162995c
.quad 0xa3a823d9a3f62400,0xa22f22a7a30e2364,0x222fa1d0216aa0fd,0x2359a31c22d5a286,0x1646987919cd9b1f,0x947c0f2e0b2e932d,0xa30e231ca3292335,0xa2d522e4a2f22300
.quad 0x23e8a2a72029972a,0x8b2e9e89220aa3b0,0x9aaf9a3e208aa2c6,0xa3b823eca2d520a1,0xa2b723d9a3de22c6,0x1fef98799b8f20a1,0x2275a0721b8f172a,0x21bca34d23fba3b0
.quad 0x1c37a0722253a38d,0xa2d521299dea132d,0xa3f623d9a30e21a8,0x9ca52072a22f2364,0x1f259a3e947c1d49,0x23fea39f22b7a155,0x216aa2a72383a3f3,0x9aaf8f2e1c379fbd
.quad 0xa36f22a7a1942042,0xa32923bfa3fe23e3,0x8b2e1a3e9dea2042,0x213fa0111d7f995c,0x2383a3d923fea3f3,0x208aa17f2253a300,0xa13f20729f251d49,0xa383231ca29721f7
.quad 0x9f8b2072a11321a8,0x96461a3e9ca51e1f,0x23f0a3d923b8a38d,0x23e8a3f92400a3fd,0x9b8f1a3e98eb172a,0x9e541db59d121c6e,0xa29722a7a2b722c6,0xa2532264a2752286
.quad 0xa3de23bfa22f1ef1,0x1d7f15619fef2286,0x1d1215619f8b2241,0x236fa3ff2341a155,0x2329a3f923a8a241,0x9e540f2e1d7fa155,0xa08a1bfe16469ef1,0xa34123f9a3b82286
.quad 0xa1e4234da3f623cd,0x1f25987999cd1fbd,0x222fa0721ca58000,0x230ea3d923f6a364,0x2029a1d0230ea3cd,0x9fef1bfe0b2e9c6e,0xa3592264a1131ef1,0xa2d5239fa3fb23e3
.quad 0x9c371f58a1132241,0x205a9db518eb132d,0x23f0a39f230ea241,0x2297a34d23c6a3fd,0x8b2e98791ca59ef1,0xa0b81f589d12195c,0xa3e823ffa3f623cd,0xa25322e4a35923b0
.quad 0x1ca59a3e16468000,0x2113a0721f8b9e1f,0x2341a37923a8a3cd,0x220aa26422b7a300,0xa05a20119f8b1ef1,0xa16a2129a0e620a1,0xa20a221da22f2241,0xa1bc21d0a1e421f7
.quad 0x22f2a3f92383a1a8,0xa1131bfe19cda0a1,0x9ebd0f2e1deaa1a8,0xa30e23f9a39621f7,0xa38323ffa35921a8,0x1ca515619f2521f7,0x1c3715619ebd21a8,0x23f6a3bf2297a0a1
.quad 0x23dea3ec2329a1a8,0x16469e89216aa300,0x96469a3e1f8ba1a8,0xa3a822a7a1131e1f,0xa40023bfa2f221a8,0x9f8b217fa2d523b0,0x947c1cdca02921a8,0x222fa0cf1e54995c
.quad 0x23e8a37922b7a1a8,0x222fa31c23b8a3fd,0x1b8f9e89208aa1a8,0x9f8b1cdc9807932d,0xa396231ca27521a8,0xa3a823eca40023e3,0x9e542011a0e621a8,0x16460f2e98eb1c6e
.quad 0x230ea2a7222fa1a8,0x23f6a3d923a8a364,0x205aa0cf213fa1a8,0x1ca59db51ebd9fbd,0xa253221da1e421a8,0xa30e22e4a2b72286,0xa16a217fa19421a8,0xa1132129a13f2155
.quad 0xa13f234da4002335,0x22d5a07218eb1c6e,0x202998799c3720fd,0x2297a3d923d3a286,0x23c6a3ec22f2a0fd,0x99cd9a3e205aa286,0x147c9e892194a335,0xa3c622a7a0b81c6e
.quad 0xa36f221da0291b1f,0xa0e622a7a3b823fd,0xa11322a7a3a82400,0x1f8b9a3e96461e1f,0x205a9cdc11621b1f,0x23fba3d92329a1f7,0x23b8a3ff23d3a335,0x1d7fa07221e4a300
.quad 0x11629bfe1f25a0fd,0xa1bc20729dea195c,0xa38322e4a20a20fd,0xa36f23d9a40023e3,0xa0e621d0a2972335,0x91621a3e9d7f1fbd,0x208a9f581d7f9b1f,0x2329a2a7220aa155
.quad 0x23a8a3d923f6a400,0x222fa2a7230ea364,0xb2e956118eb9b1f,0x9c371a3e9807132d,0xa3962379a3592335,0xa3e823d9a3c623b0,0xa0b820cfa0e620fd,0xa05a2072a08a20a1
.quad 0x1deaa1d02396a3f3,0xa3d322649f8b132d,0xa0e61bfe18eba042,0xa20a239fa3f62300,0xa3f023bfa2752042,0x147c1cdca1132300,0x9e54217fa32923f3,0x22b7a0cf1ca5132d
.quad 0x20b89cdc8b2e1d49,0x2383a3ff23a8a286,0x23f6a3d9230ea1a8,0x1ca5a072222fa364,0x1ebda1292297a38d,0xa0b81db59646995c,0xa08a1db59807972a,0xa40023bfa30e21f7
.quad 0xa3fb23eca38322c6,0xa0e6221da30e23b0,0x9f2520cfa1e422c6,0x1c37956196461c6e,0x205a9e891c37972a,0x236fa2e4222fa155,0x23fea3f923d3a38d,0x22d5a34d23a8a3e3
.quad 0x1f8ba0722113a1a8,0x16469a3e1ca59e1f,0xa0291f589e541d49,0xa1e4217fa11320a1,0xa40023ffa3fb23f3,0xa3de23eca3f623fd,0x9fef2011a0292042,0x9f251f589f8b1fbd
.quad 0x91621f58a25323cd,0x23f0a39f21e49e1f,0x21949db591621ef1,0x216aa34d2400a364,0x2400a37921e49ef1,0x11629e8921bca364,0x216aa31c23f0a3cd,0xa0e61cdc11629e1f
.quad 0x947c9bfe205aa241,0xa3d322e4a13f1e1f,0xa22f20729ca58000,0xa30e23d9a3f62364,0xa3f023eca3592241,0x9dea20cfa2532364,0xa0b8221da32923cd,0x1d12956198eb1e1f
.quad 0x19cd0f2e9b8f1ef1,0x22d5a1d0208a9e1f,0x22b7a1d020b89ef1,0x23e8a3ff23d3a364,0x23c6a3f923fba3cd,0x213fa21d22d5a364,0x1fefa0cf2194a241,0xb2e98791c379e1f
.quad 0x9ca51a3e96468000,0xa11320729f8b1e1f,0xa32922e4a2972241,0xa3de23bfa3962364,0xa383239fa3b823cd,0xa2f2231ca3412364,0x9e541e899ebd1ef1,0x9d7f1db59dea1e1f
.quad 0x9ca59879205aa2c6,0xa32923ffa3592155,0xa22f1f58947c9d49,0xa0b822e4a3f023b0,0xa3f6231ca13f1d49,0x98eb2011a25323b0,0xa30e23eca3d322c6,0x1d120f2e9dea2155
.quad 0x9f8b21d0a34123f3,0x21bc9f5818eb195c,0x16461a3e9f8b21a8,0x23a8a2a721139e1f,0x21139e8918eb172a,0x23dea3f92383a286,0x23a8a2e421bca042,0x2253a34d23dea3fd
.quad 0x23a8a3f923f0a38d,0x1ebda0cf220aa300,0x2113a21d22f2a38d,0x916298791d129fbd,0x16469bfe1e54a042,0x9fef1db59aaf132d,0x9f8b1db59b8f172a,0xa2b7221da16a20a1
.quad 0xa30e22a7a22f21a8,0xa3f623d9a3a82364,0xa3f623ffa3fe23f3,0xa36f239fa3c623e3,0xa22f2264a29722c6,0xa13f217fa1bc21f7,0x9ca51cdc9d121d49,0x9b8f1bfe9c371c6e
.quad 0x20b89a3e9b8f20fd,0x2194a37923fba300,0x22b7a07219cd1b1f,0x1fefa26423c6a3e3,0x23d3a2a7208a9b1f,0x1c37a0cf22d5a3e3,0x23e8a3d922d5a0fd,0xb2e9db5213fa300
.quad 0x22f2a3d923f0a335,0x9b8f95611e54a155,0x2113a2a723a8a400,0x9f8b1a3e16469e1f,0x1d12a072220aa335,0xa16a1f589aaf932d,0x91629a3e1ebda0fd,0xa2b7217f9fef1c6e
.quad 0x9e541a3e0b2e9b1f,0xa39622e4a1e420a1,0xa19420729e541b1f,0xa3fb23bfa3412286,0xa34122a7a1e420fd,0xa3de23ffa3f023b0,0xa3fb23d9a3962335,0xa341239fa3de23fd
.quad 0xa3a823d9a3f62400,0xa22f22a7a30e2364,0xa25322a7a2f22335,0xa0b82129a19421f7,0xa0292072a0b820fd,0x9dea1e899f251fbd,0x99cd1a3e9aaf1b1f,0x9807187998eb195c
.quad 0xa297201196469d49,0x9ebd221da3b823e3,0xa32921299ca5972a,0x9e5421d0a38323fd,0xa396221d9f8b172a,0x9dea217fa34123fd,0xa3de22e4a1131d49,0x9d7f2129a2f223e3
.quad 0xa3fe2379a22f2042,0x9d1220cfa29723b0,0xa3f623d9a30e21a8,0x9ca52072a22f2364,0xa3c623ffa3a822c6,0x9c372011a1bc2300,0xa36f23eca3f6238d,0x9b8f1f58a13f2286
.quad 0xa2f2239fa3f623f3,0x9aaf1e89a0b821f7,0xa253231ca3a823f3,0x99cd1db5a0292155,0xa1942264a30e238d,0x98eb1cdc9f2520a1,0xa0b8217fa22f22c6,0x98071bfe9dea1fbd
.quad 0x9f8b2072a11321a8,0x96461a3e9ca51e1f,0x9d7f1e899f8b2042,0x947c18799aaf1c6e,0x9aaf1bfe9ca51d49,0x916215619807195c,0x947c15619646172a,0x8b2e0f2e9162132d
.size tbl, 256000
```
